```python
import torch

def _softmax(x, axis=-1):
    return torch.softmax(x, dim=axis)

def _gelu(x):
    return torch.nn.functional.gelu(x, approximate='tanh')

def _silu(x):
    return torch.nn.functional.silu(x)

def _sigmoid(x):
    return torch.sigmoid(x)

def _layernorm(x, axis=-1, eps=1e-05):
    m = x.mean(dim=axis, keepdim=True)
    v = x.var(dim=axis, keepdim=True, unbiased=False)
    return (x - m) / torch.sqrt(v + eps)

def _scatter_add(tgt, idx, src, axis=0):
    return tgt.clone().index_add_(axis, idx, src)

def _segment_sum(src, seg, n):
    out = torch.zeros((n,) + src.shape[1:], dtype=src.dtype)
    return out.index_add_(0, seg, src)

def _pad(x, pw):
    flat = tuple((v for pair in reversed(pw) for v in pair))
    return torch.nn.functional.pad(x, flat)
kernel_name = 'parallel_sum__memory_aug_recurrent_mem_tr__dense_activation_squared_relu__prompt'

def setup_inputs():

    _w = lambda a: (lambda t: t.to(torch.bfloat16) if t.is_floating_point() else t)(torch.as_tensor(a))

    def _A_setup():
        B, S, Dm = (1, 2048, 640)
        H, Dh = (32, 192)
        M, seg = (8, 32)
        seg = min(seg, S)
        S = S // seg * seg
        return {'x': _w((lambda *s: torch.randn(*s, dtype=torch.bfloat16) * 0.05)(B, S, Dm)), 'mem0': _w((lambda *s: torch.randn(*s, dtype=torch.bfloat16) * 1.6)(B, M, Dm)), 'Wq': _w((lambda *s: torch.randn(*s, dtype=torch.bfloat16) * 0.8)(Dm, H, Dh) * Dm ** (-0.5)), 'Wk': _w((lambda *s: torch.randn(*s, dtype=torch.bfloat16) * 0.8)(Dm, H, Dh) * Dm ** (-0.5)), 'Wv': _w((lambda *s: torch.randn(*s, dtype=torch.bfloat16) * 1.6)(Dm, H, Dh) * Dm ** (-0.5)), 'Wo': _w((lambda *s: torch.randn(*s, dtype=torch.bfloat16) * 1.6)(H, Dh, Dm) * (H * Dh) ** (-0.5)), 'seg_len': seg}
    _A_in = _A_setup()

    def _B_setup():
        B, S, D, F = (1, 2048, 640, 1536)
        return {'x': _w((lambda *s: torch.randn(*s, dtype=torch.bfloat16) * 0.05)(B, S, D)), 'w1': _w((lambda *s: torch.randn(*s, dtype=torch.bfloat16) * 0.05)(D, F)), 'b1': _w((lambda *s: torch.randn(*s, dtype=torch.bfloat16) * 0.05)(F)), 'w2': _w((lambda *s: torch.randn(*s, dtype=torch.bfloat16) * 0.05)(F, D)), 'b2': _w((lambda *s: torch.randn(*s, dtype=torch.bfloat16) * 0.05)(D))}
    _B_in = _B_setup()
    return {'A_x': _A_in['x'], 'A_mem0': _A_in['mem0'], 'A_Wq': _A_in['Wq'], 'A_Wk': _A_in['Wk'], 'A_Wv': _A_in['Wv'], 'A_Wo': _A_in['Wo'], 'A_seg_len': _A_in['seg_len'], 'B_x': _B_in['x'], 'B_w1': _B_in['w1'], 'B_b1': _B_in['b1'], 'B_w2': _B_in['w2'], 'B_b2': _B_in['b2']}

def reference(A_x, A_mem0, A_Wq, A_Wk, A_Wv, A_Wo, A_seg_len, B_x, B_w1, B_b1, B_w2, B_b2):

    def _A_ref(x, mem0, Wq, Wk, Wv, Wo, seg_len):
        B, S, Dm = x.shape
        H, Dh = (Wq.shape[1], Wq.shape[2])
        M = mem0.shape[1]
        scale = Dh ** (-0.5)
        n_seg = S // seg_len
        L = M + seg_len
        idx = torch.arange(L)
        mask = (idx[:, None] < M) | (idx[:, None] >= idx[None, :])
        mem = mem0
        outs = []
        for s in range(n_seg):
            xs = x[:, s * seg_len:(s + 1) * seg_len, :].clone()
            h = torch.concatenate([mem, xs], axis=1)
            q = torch.einsum('btd,dhe->bhte', h, Wq)
            k = torch.einsum('btd,dhe->bhte', h, Wk)
            v = torch.einsum('btd,dhe->bhte', h, Wv)
            scores = torch.einsum('bhqe,bhke->bhqk', q, k) * scale
            scores = torch.where(mask[None, None], scores, -1000000000.0)
            p = _softmax(scores, axis=-1)
            o = torch.einsum('bhqk,bhke->bhqe', p, v)
            o = torch.einsum('bhte,hed->btd', o, Wo)
            mem = o[:, :M, :].clone()
            outs.append(o[:, M:, :])
        return torch.concatenate(outs, axis=1)

    def _B_ref(x, w1, b1, w2, b2):
        h = torch.einsum('bsd,df->bsf', x, w1) + b1
        zero = torch.zeros_like(h)
        r = torch.where(h > zero, h, zero)
        h = r * r
        out = torch.einsum('bsf,fd->bsd', h, w2) + b2
        return out
    x = A_x
    xn = _layernorm(x, axis=-1)
    return x + _A_ref(xn, A_mem0, A_Wq, A_Wk, A_Wv, A_Wo, A_seg_len) + _B_ref(xn, B_w1, B_b1, B_w2, B_b2)
```

```asm
; @launch kernel=prep_kernel grid=(577,1,1) block=(256,1,1) lds=0
; @launch kernel=mega_kernel grid=(256,1,1) block=(256,1,1) lds=118784
.amdgcn_target "amdgcn-amd-amdhsa--gfx950"
.text
.globl prep_kernel
.p2align 8
.type prep_kernel,@function
prep_kernel:

s_cmp_ge_u32 s2, 577
s_cbranch_scc1 L_pr_done
s_load_dwordx4 s[4:7], s[0:1], 0
s_load_dwordx2 s[8:9], s[0:1], 112
v_and_b32 v1, 63, v0
v_lshrrev_b32 v2, 6, v0
s_nop 0
v_readfirstlane_b32 s3, v2
s_waitcnt lgkmcnt(0)
s_mov_b32 s12, s8
s_mov_b32 s13, s9
s_mov_b32 s14, 0x10000000
s_mov_b32 s15, 0x00020000
s_cmp_ge_u32 s2, 512
s_cbranch_scc1 L_pr_fill
s_mov_b32 s16, s4
s_mov_b32 s17, s5
s_mov_b32 s18, 2621440
s_mov_b32 s19, 0x00020000
s_lshl_b32 s20, s2, 2
s_add_u32 s20, s20, s3
s_mul_i32 s20, s20, 1280
v_lshlrev_b32 v2, 2, v1
buffer_load_dword v4, v2, s[16:19], s20 offen offset:0
buffer_load_dword v5, v2, s[16:19], s20 offen offset:256
buffer_load_dword v6, v2, s[16:19], s20 offen offset:512
buffer_load_dword v7, v2, s[16:19], s20 offen offset:768
buffer_load_dword v8, v2, s[16:19], s20 offen offset:1024
s_waitcnt vmcnt(0)
v_lshlrev_b32 v10, 16, v4
v_and_b32 v11, 0xffff0000, v4
v_lshlrev_b32 v12, 16, v5
v_and_b32 v13, 0xffff0000, v5
v_lshlrev_b32 v14, 16, v6
v_and_b32 v15, 0xffff0000, v6
v_lshlrev_b32 v16, 16, v7
v_and_b32 v17, 0xffff0000, v7
v_lshlrev_b32 v18, 16, v8
v_and_b32 v19, 0xffff0000, v8
v_add_f32 v20, v10, v11
v_add_f32 v20, v20, v12
v_add_f32 v20, v20, v13
v_add_f32 v20, v20, v14
v_add_f32 v20, v20, v15
v_add_f32 v20, v20, v16
v_add_f32 v20, v20, v17
v_add_f32 v20, v20, v18
v_add_f32 v20, v20, v19
s_nop 1
v_add_f32_dpp v20, v20, v20 row_ror:8 row_mask:0xf bank_mask:0xf
s_nop 1
v_add_f32_dpp v20, v20, v20 row_ror:4 row_mask:0xf bank_mask:0xf
s_nop 1
v_add_f32_dpp v20, v20, v20 row_ror:2 row_mask:0xf bank_mask:0xf
s_nop 1
v_add_f32_dpp v20, v20, v20 row_ror:1 row_mask:0xf bank_mask:0xf
v_mov_b32 v21, v20
s_nop 1
v_permlane16_swap_b32 v20, v21
v_add_f32 v20, v20, v21
v_mov_b32 v21, v20
s_nop 1
v_permlane32_swap_b32 v20, v21
v_add_f32 v20, v20, v21
v_mul_f32 v20, 0x3acccccd, v20
v_mov_b32 v22, 0
v_sub_f32 v23, v10, v20
v_fmac_f32 v22, v23, v23
v_sub_f32 v23, v11, v20
v_fmac_f32 v22, v23, v23
v_sub_f32 v23, v12, v20
v_fmac_f32 v22, v23, v23
v_sub_f32 v23, v13, v20
v_fmac_f32 v22, v23, v23
v_sub_f32 v23, v14, v20
v_fmac_f32 v22, v23, v23
v_sub_f32 v23, v15, v20
v_fmac_f32 v22, v23, v23
v_sub_f32 v23, v16, v20
v_fmac_f32 v22, v23, v23
v_sub_f32 v23, v17, v20
v_fmac_f32 v22, v23, v23
v_sub_f32 v23, v18, v20
v_fmac_f32 v22, v23, v23
v_sub_f32 v23, v19, v20
v_fmac_f32 v22, v23, v23
s_nop 1
v_add_f32_dpp v22, v22, v22 row_ror:8 row_mask:0xf bank_mask:0xf
s_nop 1
v_add_f32_dpp v22, v22, v22 row_ror:4 row_mask:0xf bank_mask:0xf
s_nop 1
v_add_f32_dpp v22, v22, v22 row_ror:2 row_mask:0xf bank_mask:0xf
s_nop 1
v_add_f32_dpp v22, v22, v22 row_ror:1 row_mask:0xf bank_mask:0xf
v_mov_b32 v21, v22
s_nop 1
v_permlane16_swap_b32 v22, v21
v_add_f32 v22, v22, v21
v_mov_b32 v21, v22
s_nop 1
v_permlane32_swap_b32 v22, v21
v_add_f32 v22, v22, v21
v_mul_f32 v22, 0x3acccccd, v22
v_cvt_pk_bf16_f32 v21, v22, v22
v_lshlrev_b32 v22, 16, v21
v_add_f32 v22, 0x3727c5ac, v22
v_cvt_pk_bf16_f32 v21, v22, v22
v_lshlrev_b32 v22, 16, v21
v_sqrt_f32 v22, v22
s_nop 0
v_cvt_pk_bf16_f32 v21, v22, v22
v_lshlrev_b32 v22, 16, v21
v_rcp_f32 v24, v22
v_cvt_pk_bf16_f32 v21, v20, v20
v_lshlrev_b32 v20, 16, v21
v_sub_f32 v10, v10, v20
v_sub_f32 v11, v11, v20
v_sub_f32 v12, v12, v20
v_sub_f32 v13, v13, v20
v_sub_f32 v14, v14, v20
v_sub_f32 v15, v15, v20
v_sub_f32 v16, v16, v20
v_sub_f32 v17, v17, v20
v_sub_f32 v18, v18, v20
v_sub_f32 v19, v19, v20
v_cvt_pk_bf16_f32 v21, v10, v11
v_lshlrev_b32 v10, 16, v21
v_and_b32 v11, 0xffff0000, v21
v_cvt_pk_bf16_f32 v21, v12, v13
v_lshlrev_b32 v12, 16, v21
v_and_b32 v13, 0xffff0000, v21
v_cvt_pk_bf16_f32 v21, v14, v15
v_lshlrev_b32 v14, 16, v21
v_and_b32 v15, 0xffff0000, v21
v_cvt_pk_bf16_f32 v21, v16, v17
v_lshlrev_b32 v16, 16, v21
v_and_b32 v17, 0xffff0000, v21
v_cvt_pk_bf16_f32 v21, v18, v19
v_lshlrev_b32 v18, 16, v21
v_and_b32 v19, 0xffff0000, v21
v_mul_f32 v25, v10, v24
v_fma_f32 v26, -v25, v22, v10
v_fma_f32 v10, v26, v24, v25
v_mul_f32 v25, v11, v24
v_fma_f32 v26, -v25, v22, v11
v_fma_f32 v11, v26, v24, v25
v_mul_f32 v25, v12, v24
v_fma_f32 v26, -v25, v22, v12
v_fma_f32 v12, v26, v24, v25
v_mul_f32 v25, v13, v24
v_fma_f32 v26, -v25, v22, v13
v_fma_f32 v13, v26, v24, v25
v_mul_f32 v25, v14, v24
v_fma_f32 v26, -v25, v22, v14
v_fma_f32 v14, v26, v24, v25
v_mul_f32 v25, v15, v24
v_fma_f32 v26, -v25, v22, v15
v_fma_f32 v15, v26, v24, v25
v_mul_f32 v25, v16, v24
v_fma_f32 v26, -v25, v22, v16
v_fma_f32 v16, v26, v24, v25
v_mul_f32 v25, v17, v24
v_fma_f32 v26, -v25, v22, v17
v_fma_f32 v17, v26, v24, v25
v_mul_f32 v25, v18, v24
v_fma_f32 v26, -v25, v22, v18
v_fma_f32 v18, v26, v24, v25
v_mul_f32 v25, v19, v24
v_fma_f32 v26, -v25, v22, v19
v_fma_f32 v19, v26, v24, v25
v_cvt_pk_bf16_f32 v4, v10, v11
v_cvt_pk_bf16_f32 v5, v12, v13
v_cvt_pk_bf16_f32 v6, v14, v15
v_cvt_pk_bf16_f32 v7, v16, v17
v_cvt_pk_bf16_f32 v8, v18, v19
s_lshl_b32 s21, s2, 2
s_add_u32 s21, s21, s3
s_lshr_b32 s22, s21, 8
s_and_b32 s23, s21, 255
s_mul_i32 s22, s22, 327680
s_lshl_b32 s24, s23, 6
s_add_u32 s22, s22, s24
s_add_u32 s22, s22, 90910720
s_lshr_b32 s24, s23, 2
s_and_b32 s24, s24, 3
v_bfe_u32 v20, v1, 2, 2
v_xor_b32 v20, s24, v20
v_lshlrev_b32 v20, 4, v20
v_and_b32 v21, 3, v1
v_lshl_add_u32 v20, v21, 2, v20
v_lshrrev_b32 v21, 4, v1
v_lshl_add_u32 v20, v21, 14, v20
s_add_u32 s25, s22, 0
buffer_store_dword v4, v20, s[12:15], s25 offen
s_add_u32 s25, s22, 65536
buffer_store_dword v5, v20, s[12:15], s25 offen
s_add_u32 s25, s22, 131072
buffer_store_dword v6, v20, s[12:15], s25 offen
s_add_u32 s25, s22, 196608
buffer_store_dword v7, v20, s[12:15], s25 offen
s_add_u32 s25, s22, 262144
buffer_store_dword v8, v20, s[12:15], s25 offen
s_branch L_pr_done
L_pr_fill:
s_cmp_eq_u32 s2, 576
s_cbranch_scc1 L_pr_mem
v_mov_b32 v4, 0
v_mov_b32 v5, 0
v_mov_b32 v6, 0
v_mov_b32 v7, 0
s_sub_u32 s20, s2, 512
s_lshl_b32 s20, s20, 8
v_add_u32 v2, s20, v0
v_lshlrev_b32 v3, 4, v2
s_mov_b32 s21, 178483200
s_mov_b32 s14, 178614272
buffer_store_dwordx4 v[4:7], v3, s[12:15], s21 offen
s_mov_b32 s14, 0x10000000
s_nop 0
v_mov_b32 v4, -1
v_mov_b32 v5, -1
v_mov_b32 v6, -1
v_mov_b32 v7, -1
s_sub_u32 s20, s2, 512
s_lshl_b32 s20, s20, 8
v_add_u32 v2, s20, v0
s_nop 1
L_pr_fl:
v_cmp_gt_u32 vcc, 130048, v2
s_nop 0
s_and_saveexec_b64 s[22:23], vcc
s_cbranch_execz L_pr_done
v_lshlrev_b32 v3, 4, v2
s_mov_b32 s21, 75579392
buffer_store_dwordx4 v[4:7], v3, s[12:15], s21 offen
v_add_u32 v2, 16384, v2
s_branch L_pr_fl
s_nop 0
L_pr_mem:
v_mov_b32 v4, 0
v_mov_b32 v5, 0
v_mov_b32 v6, 0
v_mov_b32 v7, 0
v_lshlrev_b32 v3, 4, v0
s_mov_b32 s21, 178466816
buffer_store_dwordx4 v[4:7], v3, s[12:15], s21 offen
s_mov_b32 s21, 178470912
buffer_store_dwordx4 v[4:7], v3, s[12:15], s21 offen
s_mov_b32 s21, 178475008
buffer_store_dwordx4 v[4:7], v3, s[12:15], s21 offen
s_mov_b32 s21, 178479104
buffer_store_dwordx4 v[4:7], v3, s[12:15], s21 offen
s_mov_b32 s16, s6
s_mov_b32 s17, s7
s_mov_b32 s18, 10240
s_mov_b32 s19, 0x00020000
v_mov_b32 v2, v0
s_nop 1
L_pr_ml:
v_cmp_gt_u32 vcc, 640, v2
s_nop 0
s_and_saveexec_b64 s[22:23], vcc
s_cbranch_execz L_pr_done
v_lshrrev_b32 v3, 5, v2
v_bfe_u32 v4, v2, 3, 2
v_and_b32 v5, 7, v2
v_mul_u32_u24 v6, 1280, v5
v_lshl_add_u32 v6, v3, 6, v6
v_lshl_add_u32 v6, v4, 3, v6
buffer_load_dwordx2 v[8:9], v6, s[16:19], 0 offen
buffer_load_dwordx2 v[10:11], v6, s[16:19], 0 offen offset:32
s_waitcnt vmcnt(0)
s_mov_b32 s24, 0xfffffffe
v_min_u32 v8, s24, v8
v_min_u32 v10, s24, v10
v_lshlrev_b32 v7, 4, v2
s_mov_b32 s21, 75497472
buffer_store_dwordx4 v[8:11], v7, s[12:15], s21 offen
s_mov_b32 s21, 75507712
buffer_store_dwordx4 v[8:11], v7, s[12:15], s21 offen
s_mov_b32 s21, 75517952
buffer_store_dwordx4 v[8:11], v7, s[12:15], s21 offen
s_mov_b32 s21, 75528192
buffer_store_dwordx4 v[8:11], v7, s[12:15], s21 offen
s_mov_b32 s21, 75538432
buffer_store_dwordx4 v[8:11], v7, s[12:15], s21 offen
s_mov_b32 s21, 75548672
buffer_store_dwordx4 v[8:11], v7, s[12:15], s21 offen
s_mov_b32 s21, 75558912
buffer_store_dwordx4 v[8:11], v7, s[12:15], s21 offen
s_mov_b32 s21, 75569152
buffer_store_dwordx4 v[8:11], v7, s[12:15], s21 offen
v_add_u32 v2, 256, v2
s_branch L_pr_ml
s_nop 0
L_pr_done:
s_endpgm
.section .rodata,"a"
.p2align 6
.amdhsa_kernel prep_kernel
  .amdhsa_next_free_vgpr 32
  .amdhsa_next_free_sgpr 32
  .amdhsa_accum_offset 32
  .amdhsa_group_segment_fixed_size 0
  .amdhsa_kernarg_size 120
  .amdhsa_user_sgpr_count 2
  .amdhsa_user_sgpr_kernarg_segment_ptr 1
  .amdhsa_system_sgpr_workgroup_id_x 1
.end_amdhsa_kernel
.text
.globl mega_kernel
.p2align 8
.type mega_kernel,@function
mega_kernel:

s_cmp_ge_u32 s2, 256
s_cbranch_scc1 L_exit
s_load_dwordx2 s[4:5], s[0:1], 112
s_load_dwordx2 s[6:7], s[0:1], 104
s_getreg_b32 s29, hwreg(HW_REG_XCC_ID)
s_and_b32 s29, s29, 7
v_and_b32 v1, 63, v0
v_lshrrev_b32 v2, 6, v0
s_nop 0
v_readfirstlane_b32 s28, v2
s_waitcnt lgkmcnt(0)
s_mov_b32 s20, s4
s_mov_b32 s21, s5
s_mov_b32 s22, 0x10000000
s_mov_b32 s23, 0x00020000
s_cmp_lg_u32 s28, 0
s_cbranch_scc1 L_m_rw
s_mov_b64 exec, 1
s_lshl_b32 s45, s29, 2
v_mov_b32 v2, s45
v_mov_b32 v3, 1
global_atomic_add v4, v2, v3, s[6:7] sc0
s_waitcnt vmcnt(0)
v_mov_b32 v2, 64
global_atomic_add v5, v2, v3, s[6:7] sc0
s_waitcnt vmcnt(0)
v_mov_b32 v2, 118528
ds_write_b64 v2, v[4:5]
s_waitcnt lgkmcnt(0)
s_mov_b64 exec, -1
L_m_rw:
s_barrier
v_mov_b32 v2, 118528
ds_read_b64 v[4:5], v2
s_waitcnt lgkmcnt(0)
v_readfirstlane_b32 s30, v4
v_readfirstlane_b32 s49, v5
s_nop 1
s_barrier
s_branch L_role_entry_A
s_nop 0
L_exit:
s_endpgm
L_role_entry_A:
s_mov_b32 s95, 0
s_cmp_ge_u32 s30, 16
s_cbranch_scc1 L_worker_A
s_load_dwordx4 s[8:11], s[0:1], 16
s_load_dwordx4 s[12:15], s[0:1], 32
s_waitcnt lgkmcnt(0)
s_and_b32 s30, s30, 15
s_lshr_b32 s45, s30, 2
s_lshl_b32 s31, s29, 2
s_add_u32 s31, s31, s45
s_and_b32 s32, s30, 3
s_mul_i32 s45, s30, 3
s_lshl_b32 s46, s30, 1
s_add_u32 s46, s46, 8
s_cmp_lt_u32 s30, 8
s_cselect_b32 s58, s45, s46
s_cselect_b32 s54, 3, 2
v_lshrrev_b32 v28, 4, v1
v_and_b32 v29, 7, v1
v_lshlrev_b32 v2, 7, v28
v_lshl_add_u32 v2, v29, 4, v2
v_lshlrev_b32 v3, 4, v1
s_mov_b32 s50, 0x00ff00ff
s_mov_b32 s51, 0x00ff00ff
s_mov_b32 s52, -1
s_mov_b32 s53, 0
v_mov_b32 v24, -1
v_mov_b32 v25, -1
v_mov_b32 v26, -1
v_mov_b32 v27, -1
s_mov_b32 s55, 43691
s_mul_i32 s45, s28, 18432
s_mul_i32 s46, s28, 1966080
s_mul_i32 s47, s31, 384
s_mul_i32 s48, s32, 96
s_add_u32 s46, s46, s47
s_add_u32 s46, s46, s48
s_mov_b32 s56, 12288
v_add_u32 v92, 0, v1
v_mul_u32_u24 v93, s55, v92
v_lshrrev_b32 v93, 18, v93
v_mul_u32_u24 v94, 6, v93
v_sub_u32 v94, v92, v94
v_mul_lo_u32 v93, v93, s56
v_lshl_add_u32 v96, v94, 4, v93
v_add_u32 v96, s46, v96
v_add_u32 v92, 64, v1
v_mul_u32_u24 v93, s55, v92
v_lshrrev_b32 v93, 18, v93
v_mul_u32_u24 v94, 6, v93
v_sub_u32 v94, v92, v94
v_mul_lo_u32 v93, v93, s56
v_lshl_add_u32 v97, v94, 4, v93
v_add_u32 v97, s46, v97
v_add_u32 v92, 128, v1
v_mul_u32_u24 v93, s55, v92
v_lshrrev_b32 v93, 18, v93
v_mul_u32_u24 v94, 6, v93
v_sub_u32 v94, v92, v94
v_mul_lo_u32 v93, v93, s56
v_lshl_add_u32 v98, v94, 4, v93
v_add_u32 v98, s46, v98
v_add_u32 v92, 192, v1
v_mul_u32_u24 v93, s55, v92
v_lshrrev_b32 v93, 18, v93
v_mul_u32_u24 v94, 6, v93
v_sub_u32 v94, v92, v94
v_mul_lo_u32 v93, v93, s56
v_lshl_add_u32 v99, v94, 4, v93
v_add_u32 v99, s46, v99
v_add_u32 v92, 256, v1
v_mul_u32_u24 v93, s55, v92
v_lshrrev_b32 v93, 18, v93
v_mul_u32_u24 v94, 6, v93
v_sub_u32 v94, v92, v94
v_mul_lo_u32 v93, v93, s56
v_lshl_add_u32 v100, v94, 4, v93
v_add_u32 v100, s46, v100
v_add_u32 v92, 320, v1
v_mul_u32_u24 v93, s55, v92
v_lshrrev_b32 v93, 18, v93
v_mul_u32_u24 v94, 6, v93
v_sub_u32 v94, v92, v94
v_mul_lo_u32 v93, v93, s56
v_lshl_add_u32 v101, v94, 4, v93
v_add_u32 v101, s46, v101
v_add_u32 v92, 384, v1
v_mul_u32_u24 v93, s55, v92
v_lshrrev_b32 v93, 18, v93
v_mul_u32_u24 v94, 6, v93
v_sub_u32 v94, v92, v94
v_mul_lo_u32 v93, v93, s56
v_lshl_add_u32 v102, v94, 4, v93
v_add_u32 v102, s46, v102
v_add_u32 v92, 448, v1
v_mul_u32_u24 v93, s55, v92
v_lshrrev_b32 v93, 18, v93
v_mul_u32_u24 v94, 6, v93
v_sub_u32 v94, v92, v94
v_mul_lo_u32 v93, v93, s56
v_lshl_add_u32 v103, v94, 4, v93
v_add_u32 v103, s46, v103
v_add_u32 v92, 512, v1
v_mul_u32_u24 v93, s55, v92
v_lshrrev_b32 v93, 18, v93
v_mul_u32_u24 v94, 6, v93
v_sub_u32 v94, v92, v94
v_mul_lo_u32 v93, v93, s56
v_lshl_add_u32 v104, v94, 4, v93
v_add_u32 v104, s46, v104
v_add_u32 v92, 576, v1
v_mul_u32_u24 v93, s55, v92
v_lshrrev_b32 v93, 18, v93
v_mul_u32_u24 v94, 6, v93
v_sub_u32 v94, v92, v94
v_mul_lo_u32 v93, v93, s56
v_lshl_add_u32 v105, v94, 4, v93
v_add_u32 v105, s46, v105
v_add_u32 v92, 640, v1
v_mul_u32_u24 v93, s55, v92
v_lshrrev_b32 v93, 18, v93
v_mul_u32_u24 v94, 6, v93
v_sub_u32 v94, v92, v94
v_mul_lo_u32 v93, v93, s56
v_lshl_add_u32 v106, v94, 4, v93
v_add_u32 v106, s46, v106
v_add_u32 v92, 704, v1
v_mul_u32_u24 v93, s55, v92
v_lshrrev_b32 v93, 18, v93
v_mul_u32_u24 v94, 6, v93
v_sub_u32 v94, v92, v94
v_mul_lo_u32 v93, v93, s56
v_lshl_add_u32 v107, v94, 4, v93
v_add_u32 v107, s46, v107
v_add_u32 v92, 768, v1
v_mul_u32_u24 v93, s55, v92
v_lshrrev_b32 v93, 18, v93
v_mul_u32_u24 v94, 6, v93
v_sub_u32 v94, v92, v94
v_mul_lo_u32 v93, v93, s56
v_lshl_add_u32 v108, v94, 4, v93
v_add_u32 v108, s46, v108
v_add_u32 v92, 832, v1
v_mul_u32_u24 v93, s55, v92
v_lshrrev_b32 v93, 18, v93
v_mul_u32_u24 v94, 6, v93
v_sub_u32 v94, v92, v94
v_mul_lo_u32 v93, v93, s56
v_lshl_add_u32 v109, v94, 4, v93
v_add_u32 v109, s46, v109
v_add_u32 v92, 896, v1
v_mul_u32_u24 v93, s55, v92
v_lshrrev_b32 v93, 18, v93
v_mul_u32_u24 v94, 6, v93
v_sub_u32 v94, v92, v94
v_mul_lo_u32 v93, v93, s56
v_lshl_add_u32 v110, v94, 4, v93
v_add_u32 v110, s46, v110
v_and_b32 v28, 15, v1
v_lshrrev_b32 v29, 2, v28
v_and_b32 v30, 3, v28
v_lshrrev_b32 v31, 4, v1
v_lshl_add_u32 v32, v31, 2, v29
v_mul_u32_u24 v32, 96, v32
v_lshl_add_u32 v116, v30, 3, v32
v_add_u32 v116, s45, v116
v_add_u32 v117, s45, v3
s_mov_b32 s24, s8
s_mov_b32 s25, s9
s_mov_b32 s26, 7864320
s_mov_b32 s27, 0x00020000
buffer_load_dwordx4 v[152:155], v96, s[24:27], 0 offen
buffer_load_dwordx4 v[156:159], v97, s[24:27], 0 offen
buffer_load_dwordx4 v[160:163], v98, s[24:27], 0 offen
buffer_load_dwordx4 v[164:167], v99, s[24:27], 0 offen
buffer_load_dwordx4 v[168:171], v100, s[24:27], 0 offen
buffer_load_dwordx4 v[172:175], v101, s[24:27], 0 offen
buffer_load_dwordx4 v[176:179], v102, s[24:27], 0 offen
buffer_load_dwordx4 v[180:183], v103, s[24:27], 0 offen
buffer_load_dwordx4 v[184:187], v104, s[24:27], 0 offen
buffer_load_dwordx4 v[188:191], v105, s[24:27], 0 offen
buffer_load_dwordx4 v[192:195], v106, s[24:27], 0 offen
buffer_load_dwordx4 v[196:199], v107, s[24:27], 0 offen
buffer_load_dwordx4 v[200:203], v108, s[24:27], 0 offen
buffer_load_dwordx4 v[204:207], v109, s[24:27], 0 offen
buffer_load_dwordx4 v[208:211], v110, s[24:27], 0 offen
s_waitcnt vmcnt(14)
ds_write_b128 v117, v[152:155] offset:0
s_waitcnt vmcnt(13)
ds_write_b128 v117, v[156:159] offset:1024
s_waitcnt vmcnt(12)
ds_write_b128 v117, v[160:163] offset:2048
s_waitcnt vmcnt(11)
ds_write_b128 v117, v[164:167] offset:3072
s_waitcnt vmcnt(10)
ds_write_b128 v117, v[168:171] offset:4096
s_waitcnt vmcnt(9)
ds_write_b128 v117, v[172:175] offset:5120
s_waitcnt vmcnt(8)
ds_write_b128 v117, v[176:179] offset:6144
s_waitcnt vmcnt(7)
ds_write_b128 v117, v[180:183] offset:7168
s_waitcnt vmcnt(6)
ds_write_b128 v117, v[184:187] offset:8192
s_waitcnt vmcnt(5)
ds_write_b128 v117, v[188:191] offset:9216
s_waitcnt vmcnt(4)
ds_write_b128 v117, v[192:195] offset:10240
s_waitcnt vmcnt(3)
ds_write_b128 v117, v[196:199] offset:11264
s_waitcnt vmcnt(2)
ds_write_b128 v117, v[200:203] offset:12288
s_waitcnt vmcnt(1)
ds_write_b128 v117, v[204:207] offset:13312
s_waitcnt vmcnt(0)
ds_write_b128 v117, v[208:211] offset:14336
s_waitcnt lgkmcnt(0)
ds_read_b64_tr_b16 v[152:153], v116 offset:0
ds_read_b64_tr_b16 v[154:155], v116 offset:1536
ds_read_b64_tr_b16 v[156:157], v116 offset:3072
ds_read_b64_tr_b16 v[158:159], v116 offset:4608
ds_read_b64_tr_b16 v[160:161], v116 offset:6144
ds_read_b64_tr_b16 v[162:163], v116 offset:7680
ds_read_b64_tr_b16 v[164:165], v116 offset:9216
ds_read_b64_tr_b16 v[166:167], v116 offset:10752
ds_read_b64_tr_b16 v[168:169], v116 offset:12288
ds_read_b64_tr_b16 v[170:171], v116 offset:13824
ds_read_b64_tr_b16 v[172:173], v116 offset:32
ds_read_b64_tr_b16 v[174:175], v116 offset:1568
ds_read_b64_tr_b16 v[176:177], v116 offset:3104
ds_read_b64_tr_b16 v[178:179], v116 offset:4640
ds_read_b64_tr_b16 v[180:181], v116 offset:6176
ds_read_b64_tr_b16 v[182:183], v116 offset:7712
ds_read_b64_tr_b16 v[184:185], v116 offset:9248
ds_read_b64_tr_b16 v[186:187], v116 offset:10784
ds_read_b64_tr_b16 v[188:189], v116 offset:12320
ds_read_b64_tr_b16 v[190:191], v116 offset:13856
ds_read_b64_tr_b16 v[192:193], v116 offset:64
ds_read_b64_tr_b16 v[194:195], v116 offset:1600
ds_read_b64_tr_b16 v[196:197], v116 offset:3136
ds_read_b64_tr_b16 v[198:199], v116 offset:4672
ds_read_b64_tr_b16 v[200:201], v116 offset:6208
ds_read_b64_tr_b16 v[202:203], v116 offset:7744
ds_read_b64_tr_b16 v[204:205], v116 offset:9280
ds_read_b64_tr_b16 v[206:207], v116 offset:10816
ds_read_b64_tr_b16 v[208:209], v116 offset:12352
ds_read_b64_tr_b16 v[210:211], v116 offset:13888
s_waitcnt lgkmcnt(0)
v_accvgpr_write_b32 a0, v152
v_accvgpr_write_b32 a1, v153
v_accvgpr_write_b32 a2, v154
v_accvgpr_write_b32 a3, v155
v_accvgpr_write_b32 a4, v156
v_accvgpr_write_b32 a5, v157
v_accvgpr_write_b32 a6, v158
v_accvgpr_write_b32 a7, v159
v_accvgpr_write_b32 a8, v160
v_accvgpr_write_b32 a9, v161
v_accvgpr_write_b32 a10, v162
v_accvgpr_write_b32 a11, v163
v_accvgpr_write_b32 a12, v164
v_accvgpr_write_b32 a13, v165
v_accvgpr_write_b32 a14, v166
v_accvgpr_write_b32 a15, v167
v_accvgpr_write_b32 a16, v168
v_accvgpr_write_b32 a17, v169
v_accvgpr_write_b32 a18, v170
v_accvgpr_write_b32 a19, v171
v_accvgpr_write_b32 a20, v172
v_accvgpr_write_b32 a21, v173
v_accvgpr_write_b32 a22, v174
v_accvgpr_write_b32 a23, v175
v_accvgpr_write_b32 a24, v176
v_accvgpr_write_b32 a25, v177
v_accvgpr_write_b32 a26, v178
v_accvgpr_write_b32 a27, v179
v_accvgpr_write_b32 a28, v180
v_accvgpr_write_b32 a29, v181
v_accvgpr_write_b32 a30, v182
v_accvgpr_write_b32 a31, v183
v_accvgpr_write_b32 a32, v184
v_accvgpr_write_b32 a33, v185
v_accvgpr_write_b32 a34, v186
v_accvgpr_write_b32 a35, v187
v_accvgpr_write_b32 a36, v188
v_accvgpr_write_b32 a37, v189
v_accvgpr_write_b32 a38, v190
v_accvgpr_write_b32 a39, v191
v_accvgpr_write_b32 a40, v192
v_accvgpr_write_b32 a41, v193
v_accvgpr_write_b32 a42, v194
v_accvgpr_write_b32 a43, v195
v_accvgpr_write_b32 a44, v196
v_accvgpr_write_b32 a45, v197
v_accvgpr_write_b32 a46, v198
v_accvgpr_write_b32 a47, v199
v_accvgpr_write_b32 a48, v200
v_accvgpr_write_b32 a49, v201
v_accvgpr_write_b32 a50, v202
v_accvgpr_write_b32 a51, v203
v_accvgpr_write_b32 a52, v204
v_accvgpr_write_b32 a53, v205
v_accvgpr_write_b32 a54, v206
v_accvgpr_write_b32 a55, v207
v_accvgpr_write_b32 a56, v208
v_accvgpr_write_b32 a57, v209
v_accvgpr_write_b32 a58, v210
v_accvgpr_write_b32 a59, v211
s_mov_b32 s24, s10
s_mov_b32 s25, s11
s_mov_b32 s26, 7864320
s_mov_b32 s27, 0x00020000
buffer_load_dwordx4 v[152:155], v96, s[24:27], 0 offen
buffer_load_dwordx4 v[156:159], v97, s[24:27], 0 offen
buffer_load_dwordx4 v[160:163], v98, s[24:27], 0 offen
buffer_load_dwordx4 v[164:167], v99, s[24:27], 0 offen
buffer_load_dwordx4 v[168:171], v100, s[24:27], 0 offen
buffer_load_dwordx4 v[172:175], v101, s[24:27], 0 offen
buffer_load_dwordx4 v[176:179], v102, s[24:27], 0 offen
buffer_load_dwordx4 v[180:183], v103, s[24:27], 0 offen
buffer_load_dwordx4 v[184:187], v104, s[24:27], 0 offen
buffer_load_dwordx4 v[188:191], v105, s[24:27], 0 offen
buffer_load_dwordx4 v[192:195], v106, s[24:27], 0 offen
buffer_load_dwordx4 v[196:199], v107, s[24:27], 0 offen
buffer_load_dwordx4 v[200:203], v108, s[24:27], 0 offen
buffer_load_dwordx4 v[204:207], v109, s[24:27], 0 offen
buffer_load_dwordx4 v[208:211], v110, s[24:27], 0 offen
s_waitcnt vmcnt(14)
ds_write_b128 v117, v[152:155] offset:0
s_waitcnt vmcnt(13)
ds_write_b128 v117, v[156:159] offset:1024
s_waitcnt vmcnt(12)
ds_write_b128 v117, v[160:163] offset:2048
s_waitcnt vmcnt(11)
ds_write_b128 v117, v[164:167] offset:3072
s_waitcnt vmcnt(10)
ds_write_b128 v117, v[168:171] offset:4096
s_waitcnt vmcnt(9)
ds_write_b128 v117, v[172:175] offset:5120
s_waitcnt vmcnt(8)
ds_write_b128 v117, v[176:179] offset:6144
s_waitcnt vmcnt(7)
ds_write_b128 v117, v[180:183] offset:7168
s_waitcnt vmcnt(6)
ds_write_b128 v117, v[184:187] offset:8192
s_waitcnt vmcnt(5)
ds_write_b128 v117, v[188:191] offset:9216
s_waitcnt vmcnt(4)
ds_write_b128 v117, v[192:195] offset:10240
s_waitcnt vmcnt(3)
ds_write_b128 v117, v[196:199] offset:11264
s_waitcnt vmcnt(2)
ds_write_b128 v117, v[200:203] offset:12288
s_waitcnt vmcnt(1)
ds_write_b128 v117, v[204:207] offset:13312
s_waitcnt vmcnt(0)
ds_write_b128 v117, v[208:211] offset:14336
s_waitcnt lgkmcnt(0)
ds_read_b64_tr_b16 v[152:153], v116 offset:0
ds_read_b64_tr_b16 v[154:155], v116 offset:1536
ds_read_b64_tr_b16 v[156:157], v116 offset:3072
ds_read_b64_tr_b16 v[158:159], v116 offset:4608
ds_read_b64_tr_b16 v[160:161], v116 offset:6144
ds_read_b64_tr_b16 v[162:163], v116 offset:7680
ds_read_b64_tr_b16 v[164:165], v116 offset:9216
ds_read_b64_tr_b16 v[166:167], v116 offset:10752
ds_read_b64_tr_b16 v[168:169], v116 offset:12288
ds_read_b64_tr_b16 v[170:171], v116 offset:13824
ds_read_b64_tr_b16 v[172:173], v116 offset:32
ds_read_b64_tr_b16 v[174:175], v116 offset:1568
ds_read_b64_tr_b16 v[176:177], v116 offset:3104
ds_read_b64_tr_b16 v[178:179], v116 offset:4640
ds_read_b64_tr_b16 v[180:181], v116 offset:6176
ds_read_b64_tr_b16 v[182:183], v116 offset:7712
ds_read_b64_tr_b16 v[184:185], v116 offset:9248
ds_read_b64_tr_b16 v[186:187], v116 offset:10784
ds_read_b64_tr_b16 v[188:189], v116 offset:12320
ds_read_b64_tr_b16 v[190:191], v116 offset:13856
ds_read_b64_tr_b16 v[192:193], v116 offset:64
ds_read_b64_tr_b16 v[194:195], v116 offset:1600
ds_read_b64_tr_b16 v[196:197], v116 offset:3136
ds_read_b64_tr_b16 v[198:199], v116 offset:4672
ds_read_b64_tr_b16 v[200:201], v116 offset:6208
ds_read_b64_tr_b16 v[202:203], v116 offset:7744
ds_read_b64_tr_b16 v[204:205], v116 offset:9280
ds_read_b64_tr_b16 v[206:207], v116 offset:10816
ds_read_b64_tr_b16 v[208:209], v116 offset:12352
ds_read_b64_tr_b16 v[210:211], v116 offset:13888
s_waitcnt lgkmcnt(0)
v_accvgpr_write_b32 a60, v152
v_accvgpr_write_b32 a61, v153
v_accvgpr_write_b32 a62, v154
v_accvgpr_write_b32 a63, v155
v_accvgpr_write_b32 a64, v156
v_accvgpr_write_b32 a65, v157
v_accvgpr_write_b32 a66, v158
v_accvgpr_write_b32 a67, v159
v_accvgpr_write_b32 a68, v160
v_accvgpr_write_b32 a69, v161
v_accvgpr_write_b32 a70, v162
v_accvgpr_write_b32 a71, v163
v_accvgpr_write_b32 a72, v164
v_accvgpr_write_b32 a73, v165
v_accvgpr_write_b32 a74, v166
v_accvgpr_write_b32 a75, v167
v_accvgpr_write_b32 a76, v168
v_accvgpr_write_b32 a77, v169
v_accvgpr_write_b32 a78, v170
v_accvgpr_write_b32 a79, v171
v_accvgpr_write_b32 a80, v172
v_accvgpr_write_b32 a81, v173
v_accvgpr_write_b32 a82, v174
v_accvgpr_write_b32 a83, v175
v_accvgpr_write_b32 a84, v176
v_accvgpr_write_b32 a85, v177
v_accvgpr_write_b32 a86, v178
v_accvgpr_write_b32 a87, v179
v_accvgpr_write_b32 a88, v180
v_accvgpr_write_b32 a89, v181
v_accvgpr_write_b32 a90, v182
v_accvgpr_write_b32 a91, v183
v_accvgpr_write_b32 a92, v184
v_accvgpr_write_b32 a93, v185
v_accvgpr_write_b32 a94, v186
v_accvgpr_write_b32 a95, v187
v_accvgpr_write_b32 a96, v188
v_accvgpr_write_b32 a97, v189
v_accvgpr_write_b32 a98, v190
v_accvgpr_write_b32 a99, v191
v_accvgpr_write_b32 a100, v192
v_accvgpr_write_b32 a101, v193
v_accvgpr_write_b32 a102, v194
v_accvgpr_write_b32 a103, v195
v_accvgpr_write_b32 a104, v196
v_accvgpr_write_b32 a105, v197
v_accvgpr_write_b32 a106, v198
v_accvgpr_write_b32 a107, v199
v_accvgpr_write_b32 a108, v200
v_accvgpr_write_b32 a109, v201
v_accvgpr_write_b32 a110, v202
v_accvgpr_write_b32 a111, v203
v_accvgpr_write_b32 a112, v204
v_accvgpr_write_b32 a113, v205
v_accvgpr_write_b32 a114, v206
v_accvgpr_write_b32 a115, v207
v_accvgpr_write_b32 a116, v208
v_accvgpr_write_b32 a117, v209
v_accvgpr_write_b32 a118, v210
v_accvgpr_write_b32 a119, v211
s_mov_b32 s24, s12
s_mov_b32 s25, s13
s_mov_b32 s26, 7864320
s_mov_b32 s27, 0x00020000
buffer_load_dwordx4 v[152:155], v96, s[24:27], 0 offen
buffer_load_dwordx4 v[156:159], v97, s[24:27], 0 offen
buffer_load_dwordx4 v[160:163], v98, s[24:27], 0 offen
buffer_load_dwordx4 v[164:167], v99, s[24:27], 0 offen
buffer_load_dwordx4 v[168:171], v100, s[24:27], 0 offen
buffer_load_dwordx4 v[172:175], v101, s[24:27], 0 offen
buffer_load_dwordx4 v[176:179], v102, s[24:27], 0 offen
buffer_load_dwordx4 v[180:183], v103, s[24:27], 0 offen
buffer_load_dwordx4 v[184:187], v104, s[24:27], 0 offen
buffer_load_dwordx4 v[188:191], v105, s[24:27], 0 offen
buffer_load_dwordx4 v[192:195], v106, s[24:27], 0 offen
buffer_load_dwordx4 v[196:199], v107, s[24:27], 0 offen
buffer_load_dwordx4 v[200:203], v108, s[24:27], 0 offen
buffer_load_dwordx4 v[204:207], v109, s[24:27], 0 offen
buffer_load_dwordx4 v[208:211], v110, s[24:27], 0 offen
s_waitcnt vmcnt(14)
ds_write_b128 v117, v[152:155] offset:0
s_waitcnt vmcnt(13)
ds_write_b128 v117, v[156:159] offset:1024
s_waitcnt vmcnt(12)
ds_write_b128 v117, v[160:163] offset:2048
s_waitcnt vmcnt(11)
ds_write_b128 v117, v[164:167] offset:3072
s_waitcnt vmcnt(10)
ds_write_b128 v117, v[168:171] offset:4096
s_waitcnt vmcnt(9)
ds_write_b128 v117, v[172:175] offset:5120
s_waitcnt vmcnt(8)
ds_write_b128 v117, v[176:179] offset:6144
s_waitcnt vmcnt(7)
ds_write_b128 v117, v[180:183] offset:7168
s_waitcnt vmcnt(6)
ds_write_b128 v117, v[184:187] offset:8192
s_waitcnt vmcnt(5)
ds_write_b128 v117, v[188:191] offset:9216
s_waitcnt vmcnt(4)
ds_write_b128 v117, v[192:195] offset:10240
s_waitcnt vmcnt(3)
ds_write_b128 v117, v[196:199] offset:11264
s_waitcnt vmcnt(2)
ds_write_b128 v117, v[200:203] offset:12288
s_waitcnt vmcnt(1)
ds_write_b128 v117, v[204:207] offset:13312
s_waitcnt vmcnt(0)
ds_write_b128 v117, v[208:211] offset:14336
s_waitcnt lgkmcnt(0)
ds_read_b64_tr_b16 v[152:153], v116 offset:0
ds_read_b64_tr_b16 v[154:155], v116 offset:1536
ds_read_b64_tr_b16 v[156:157], v116 offset:3072
ds_read_b64_tr_b16 v[158:159], v116 offset:4608
ds_read_b64_tr_b16 v[160:161], v116 offset:6144
ds_read_b64_tr_b16 v[162:163], v116 offset:7680
ds_read_b64_tr_b16 v[164:165], v116 offset:9216
ds_read_b64_tr_b16 v[166:167], v116 offset:10752
ds_read_b64_tr_b16 v[168:169], v116 offset:12288
ds_read_b64_tr_b16 v[170:171], v116 offset:13824
ds_read_b64_tr_b16 v[172:173], v116 offset:32
ds_read_b64_tr_b16 v[174:175], v116 offset:1568
ds_read_b64_tr_b16 v[176:177], v116 offset:3104
ds_read_b64_tr_b16 v[178:179], v116 offset:4640
ds_read_b64_tr_b16 v[180:181], v116 offset:6176
ds_read_b64_tr_b16 v[182:183], v116 offset:7712
ds_read_b64_tr_b16 v[184:185], v116 offset:9248
ds_read_b64_tr_b16 v[186:187], v116 offset:10784
ds_read_b64_tr_b16 v[188:189], v116 offset:12320
ds_read_b64_tr_b16 v[190:191], v116 offset:13856
ds_read_b64_tr_b16 v[192:193], v116 offset:64
ds_read_b64_tr_b16 v[194:195], v116 offset:1600
ds_read_b64_tr_b16 v[196:197], v116 offset:3136
ds_read_b64_tr_b16 v[198:199], v116 offset:4672
ds_read_b64_tr_b16 v[200:201], v116 offset:6208
ds_read_b64_tr_b16 v[202:203], v116 offset:7744
ds_read_b64_tr_b16 v[204:205], v116 offset:9280
ds_read_b64_tr_b16 v[206:207], v116 offset:10816
ds_read_b64_tr_b16 v[208:209], v116 offset:12352
ds_read_b64_tr_b16 v[210:211], v116 offset:13888
s_waitcnt lgkmcnt(0)
v_accvgpr_write_b32 a120, v152
v_accvgpr_write_b32 a121, v153
v_accvgpr_write_b32 a122, v154
v_accvgpr_write_b32 a123, v155
v_accvgpr_write_b32 a124, v156
v_accvgpr_write_b32 a125, v157
v_accvgpr_write_b32 a126, v158
v_accvgpr_write_b32 a127, v159
v_accvgpr_write_b32 a128, v160
v_accvgpr_write_b32 a129, v161
v_accvgpr_write_b32 a130, v162
v_accvgpr_write_b32 a131, v163
v_accvgpr_write_b32 a132, v164
v_accvgpr_write_b32 a133, v165
v_accvgpr_write_b32 a134, v166
v_accvgpr_write_b32 a135, v167
v_accvgpr_write_b32 a136, v168
v_accvgpr_write_b32 a137, v169
v_accvgpr_write_b32 a138, v170
v_accvgpr_write_b32 a139, v171
v_accvgpr_write_b32 a140, v172
v_accvgpr_write_b32 a141, v173
v_accvgpr_write_b32 a142, v174
v_accvgpr_write_b32 a143, v175
v_accvgpr_write_b32 a144, v176
v_accvgpr_write_b32 a145, v177
v_accvgpr_write_b32 a146, v178
v_accvgpr_write_b32 a147, v179
v_accvgpr_write_b32 a148, v180
v_accvgpr_write_b32 a149, v181
v_accvgpr_write_b32 a150, v182
v_accvgpr_write_b32 a151, v183
v_accvgpr_write_b32 a152, v184
v_accvgpr_write_b32 a153, v185
v_accvgpr_write_b32 a154, v186
v_accvgpr_write_b32 a155, v187
v_accvgpr_write_b32 a156, v188
v_accvgpr_write_b32 a157, v189
v_accvgpr_write_b32 a158, v190
v_accvgpr_write_b32 a159, v191
v_accvgpr_write_b32 a160, v192
v_accvgpr_write_b32 a161, v193
v_accvgpr_write_b32 a162, v194
v_accvgpr_write_b32 a163, v195
v_accvgpr_write_b32 a164, v196
v_accvgpr_write_b32 a165, v197
v_accvgpr_write_b32 a166, v198
v_accvgpr_write_b32 a167, v199
v_accvgpr_write_b32 a168, v200
v_accvgpr_write_b32 a169, v201
v_accvgpr_write_b32 a170, v202
v_accvgpr_write_b32 a171, v203
v_accvgpr_write_b32 a172, v204
v_accvgpr_write_b32 a173, v205
v_accvgpr_write_b32 a174, v206
v_accvgpr_write_b32 a175, v207
v_accvgpr_write_b32 a176, v208
v_accvgpr_write_b32 a177, v209
v_accvgpr_write_b32 a178, v210
v_accvgpr_write_b32 a179, v211
s_lshl_b32 s46, s29, 2
s_add_u32 s46, s46, s28
s_mul_i32 s47, s46, 3072
s_mul_i32 s46, s46, 245760
s_lshl_b32 s48, s58, 5
s_add_u32 s46, s46, s48
s_mov_b32 s56, 1280
s_add_u32 s47, s47, 76611584
v_add_u32 v6, s47, v2
v_add_u32 v92, 0, v1
v_mul_u32_u24 v93, s55, v92
v_lshrrev_b32 v93, 18, v93
v_mul_u32_u24 v94, 6, v93
v_sub_u32 v94, v92, v94
v_mul_lo_u32 v93, v93, s56
v_lshl_add_u32 v96, v94, 4, v93
v_add_u32 v96, s46, v96
v_add_u32 v92, 64, v1
v_mul_u32_u24 v93, s55, v92
v_lshrrev_b32 v93, 18, v93
v_mul_u32_u24 v94, 6, v93
v_sub_u32 v94, v92, v94
v_mul_lo_u32 v93, v93, s56
v_lshl_add_u32 v97, v94, 4, v93
v_add_u32 v97, s46, v97
v_add_u32 v92, 128, v1
v_mul_u32_u24 v93, s55, v92
v_lshrrev_b32 v93, 18, v93
v_mul_u32_u24 v94, 6, v93
v_sub_u32 v94, v92, v94
v_mul_lo_u32 v93, v93, s56
v_lshl_add_u32 v98, v94, 4, v93
v_add_u32 v98, s46, v98
v_add_u32 v92, 192, v1
v_mul_u32_u24 v93, s55, v92
v_lshrrev_b32 v93, 18, v93
v_mul_u32_u24 v94, 6, v93
v_sub_u32 v94, v92, v94
v_mul_lo_u32 v93, v93, s56
v_lshl_add_u32 v99, v94, 4, v93
v_add_u32 v99, s46, v99
v_add_u32 v92, 256, v1
v_mul_u32_u24 v93, s55, v92
v_lshrrev_b32 v93, 18, v93
v_mul_u32_u24 v94, 6, v93
v_sub_u32 v94, v92, v94
v_mul_lo_u32 v93, v93, s56
v_lshl_add_u32 v100, v94, 4, v93
v_add_u32 v100, s46, v100
v_add_u32 v92, 320, v1
v_mul_u32_u24 v93, s55, v92
v_lshrrev_b32 v93, 18, v93
v_mul_u32_u24 v94, 6, v93
v_sub_u32 v94, v92, v94
v_mul_lo_u32 v93, v93, s56
v_lshl_add_u32 v101, v94, 4, v93
v_add_u32 v101, s46, v101
v_add_u32 v92, 384, v1
v_mul_u32_u24 v93, s55, v92
v_lshrrev_b32 v93, 18, v93
v_mul_u32_u24 v94, 6, v93
v_sub_u32 v94, v92, v94
v_mul_lo_u32 v93, v93, s56
v_lshl_add_u32 v102, v94, 4, v93
v_add_u32 v102, s46, v102
v_add_u32 v92, 448, v1
v_mul_u32_u24 v93, s55, v92
v_lshrrev_b32 v93, 18, v93
v_mul_u32_u24 v94, 6, v93
v_sub_u32 v94, v92, v94
v_mul_lo_u32 v93, v93, s56
v_lshl_add_u32 v103, v94, 4, v93
v_add_u32 v103, s46, v103
v_add_u32 v92, 512, v1
v_mul_u32_u24 v93, s55, v92
v_lshrrev_b32 v93, 18, v93
v_mul_u32_u24 v94, 6, v93
v_sub_u32 v94, v92, v94
v_mul_lo_u32 v93, v93, s56
v_lshl_add_u32 v104, v94, 4, v93
v_add_u32 v104, s46, v104
v_add_u32 v92, 576, v1
v_mul_u32_u24 v93, s55, v92
v_lshrrev_b32 v93, 18, v93
v_mul_u32_u24 v94, 6, v93
v_sub_u32 v94, v92, v94
v_mul_lo_u32 v93, v93, s56
v_lshl_add_u32 v105, v94, 4, v93
v_add_u32 v105, s46, v105
v_add_u32 v92, 640, v1
v_mul_u32_u24 v93, s55, v92
v_lshrrev_b32 v93, 18, v93
v_mul_u32_u24 v94, 6, v93
v_sub_u32 v94, v92, v94
v_mul_lo_u32 v93, v93, s56
v_lshl_add_u32 v106, v94, 4, v93
v_add_u32 v106, s46, v106
v_add_u32 v92, 704, v1
v_mul_u32_u24 v93, s55, v92
v_lshrrev_b32 v93, 18, v93
v_mul_u32_u24 v94, 6, v93
v_sub_u32 v94, v92, v94
v_mul_lo_u32 v93, v93, s56
v_lshl_add_u32 v107, v94, 4, v93
v_add_u32 v107, s46, v107
v_add_u32 v92, 768, v1
v_mul_u32_u24 v93, s55, v92
v_lshrrev_b32 v93, 18, v93
v_mul_u32_u24 v94, 6, v93
v_sub_u32 v94, v92, v94
v_mul_lo_u32 v93, v93, s56
v_lshl_add_u32 v108, v94, 4, v93
v_add_u32 v108, s46, v108
v_add_u32 v92, 832, v1
v_mul_u32_u24 v93, s55, v92
v_lshrrev_b32 v93, 18, v93
v_mul_u32_u24 v94, 6, v93
v_sub_u32 v94, v92, v94
v_mul_lo_u32 v93, v93, s56
v_lshl_add_u32 v109, v94, 4, v93
v_add_u32 v109, s46, v109
v_add_u32 v92, 896, v1
v_mul_u32_u24 v93, s55, v92
v_lshrrev_b32 v93, 18, v93
v_mul_u32_u24 v94, 6, v93
v_sub_u32 v94, v92, v94
v_mul_lo_u32 v93, v93, s56
v_lshl_add_u32 v110, v94, 4, v93
v_add_u32 v110, s46, v110
v_add_u32 v92, 960, v1
v_mul_u32_u24 v93, s55, v92
v_lshrrev_b32 v93, 18, v93
v_mul_u32_u24 v94, 6, v93
v_sub_u32 v94, v92, v94
v_mul_lo_u32 v93, v93, s56
v_lshl_add_u32 v111, v94, 4, v93
v_add_u32 v111, s46, v111
v_add_u32 v92, 1024, v1
v_mul_u32_u24 v93, s55, v92
v_lshrrev_b32 v93, 18, v93
v_mul_u32_u24 v94, 6, v93
v_sub_u32 v94, v92, v94
v_mul_lo_u32 v93, v93, s56
v_lshl_add_u32 v112, v94, 4, v93
v_add_u32 v112, s46, v112
v_add_u32 v92, 1088, v1
v_mul_u32_u24 v93, s55, v92
v_lshrrev_b32 v93, 18, v93
v_mul_u32_u24 v94, 6, v93
v_sub_u32 v94, v92, v94
v_mul_lo_u32 v93, v93, s56
v_lshl_add_u32 v113, v94, 4, v93
v_add_u32 v113, s46, v113
s_mov_b32 s24, s14
s_mov_b32 s25, s15
s_mov_b32 s26, 7864320
s_mov_b32 s27, 0x00020000
buffer_load_dwordx4 v[152:155], v96, s[24:27], 0 offen
buffer_load_dwordx4 v[156:159], v97, s[24:27], 0 offen
buffer_load_dwordx4 v[160:163], v98, s[24:27], 0 offen
buffer_load_dwordx4 v[164:167], v99, s[24:27], 0 offen
buffer_load_dwordx4 v[168:171], v100, s[24:27], 0 offen
buffer_load_dwordx4 v[172:175], v101, s[24:27], 0 offen
buffer_load_dwordx4 v[176:179], v102, s[24:27], 0 offen
buffer_load_dwordx4 v[180:183], v103, s[24:27], 0 offen
buffer_load_dwordx4 v[184:187], v104, s[24:27], 0 offen
buffer_load_dwordx4 v[188:191], v105, s[24:27], 0 offen
buffer_load_dwordx4 v[192:195], v106, s[24:27], 0 offen
buffer_load_dwordx4 v[196:199], v107, s[24:27], 0 offen
buffer_load_dwordx4 v[200:203], v108, s[24:27], 0 offen
buffer_load_dwordx4 v[204:207], v109, s[24:27], 0 offen
buffer_load_dwordx4 v[208:211], v110, s[24:27], 0 offen
buffer_load_dwordx4 v[212:215], v111, s[24:27], 0 offen
buffer_load_dwordx4 v[216:219], v112, s[24:27], 0 offen
buffer_load_dwordx4 v[220:223], v113, s[24:27], 0 offen
s_waitcnt vmcnt(17)
ds_write_b128 v117, v[152:155] offset:0
s_waitcnt vmcnt(16)
ds_write_b128 v117, v[156:159] offset:1024
s_waitcnt vmcnt(15)
ds_write_b128 v117, v[160:163] offset:2048
s_waitcnt vmcnt(14)
ds_write_b128 v117, v[164:167] offset:3072
s_waitcnt vmcnt(13)
ds_write_b128 v117, v[168:171] offset:4096
s_waitcnt vmcnt(12)
ds_write_b128 v117, v[172:175] offset:5120
s_waitcnt vmcnt(11)
ds_write_b128 v117, v[176:179] offset:6144
s_waitcnt vmcnt(10)
ds_write_b128 v117, v[180:183] offset:7168
s_waitcnt vmcnt(9)
ds_write_b128 v117, v[184:187] offset:8192
s_waitcnt vmcnt(8)
ds_write_b128 v117, v[188:191] offset:9216
s_waitcnt vmcnt(7)
ds_write_b128 v117, v[192:195] offset:10240
s_waitcnt vmcnt(6)
ds_write_b128 v117, v[196:199] offset:11264
s_waitcnt vmcnt(5)
ds_write_b128 v117, v[200:203] offset:12288
s_waitcnt vmcnt(4)
ds_write_b128 v117, v[204:207] offset:13312
s_waitcnt vmcnt(3)
ds_write_b128 v117, v[208:211] offset:14336
s_waitcnt vmcnt(2)
ds_write_b128 v117, v[212:215] offset:15360
s_waitcnt vmcnt(1)
ds_write_b128 v117, v[216:219] offset:16384
s_waitcnt vmcnt(0)
ds_write_b128 v117, v[220:223] offset:17408
s_waitcnt lgkmcnt(0)
ds_read_b64_tr_b16 v[152:153], v116 offset:0
ds_read_b64_tr_b16 v[154:155], v116 offset:1536
ds_read_b64_tr_b16 v[156:157], v116 offset:3072
ds_read_b64_tr_b16 v[158:159], v116 offset:4608
ds_read_b64_tr_b16 v[160:161], v116 offset:6144
ds_read_b64_tr_b16 v[162:163], v116 offset:7680
ds_read_b64_tr_b16 v[164:165], v116 offset:9216
ds_read_b64_tr_b16 v[166:167], v116 offset:10752
ds_read_b64_tr_b16 v[168:169], v116 offset:12288
ds_read_b64_tr_b16 v[170:171], v116 offset:13824
ds_read_b64_tr_b16 v[172:173], v116 offset:15360
ds_read_b64_tr_b16 v[174:175], v116 offset:16896
ds_read_b64_tr_b16 v[176:177], v116 offset:32
ds_read_b64_tr_b16 v[178:179], v116 offset:1568
ds_read_b64_tr_b16 v[180:181], v116 offset:3104
ds_read_b64_tr_b16 v[182:183], v116 offset:4640
ds_read_b64_tr_b16 v[184:185], v116 offset:6176
ds_read_b64_tr_b16 v[186:187], v116 offset:7712
ds_read_b64_tr_b16 v[188:189], v116 offset:9248
ds_read_b64_tr_b16 v[190:191], v116 offset:10784
ds_read_b64_tr_b16 v[192:193], v116 offset:12320
ds_read_b64_tr_b16 v[194:195], v116 offset:13856
ds_read_b64_tr_b16 v[196:197], v116 offset:15392
ds_read_b64_tr_b16 v[198:199], v116 offset:16928
ds_read_b64_tr_b16 v[200:201], v116 offset:64
ds_read_b64_tr_b16 v[202:203], v116 offset:1600
ds_read_b64_tr_b16 v[204:205], v116 offset:3136
ds_read_b64_tr_b16 v[206:207], v116 offset:4672
ds_read_b64_tr_b16 v[208:209], v116 offset:6208
ds_read_b64_tr_b16 v[210:211], v116 offset:7744
ds_read_b64_tr_b16 v[212:213], v116 offset:9280
ds_read_b64_tr_b16 v[214:215], v116 offset:10816
ds_read_b64_tr_b16 v[216:217], v116 offset:12352
ds_read_b64_tr_b16 v[218:219], v116 offset:13888
ds_read_b64_tr_b16 v[220:221], v116 offset:15424
ds_read_b64_tr_b16 v[222:223], v116 offset:16960
s_waitcnt lgkmcnt(0)
v_accvgpr_write_b32 a180, v152
v_accvgpr_write_b32 a181, v153
v_accvgpr_write_b32 a182, v154
v_accvgpr_write_b32 a183, v155
v_accvgpr_write_b32 a184, v156
v_accvgpr_write_b32 a185, v157
v_accvgpr_write_b32 a186, v158
v_accvgpr_write_b32 a187, v159
v_accvgpr_write_b32 a188, v160
v_accvgpr_write_b32 a189, v161
v_accvgpr_write_b32 a190, v162
v_accvgpr_write_b32 a191, v163
v_accvgpr_write_b32 a192, v164
v_accvgpr_write_b32 a193, v165
v_accvgpr_write_b32 a194, v166
v_accvgpr_write_b32 a195, v167
v_accvgpr_write_b32 a196, v168
v_accvgpr_write_b32 a197, v169
v_accvgpr_write_b32 a198, v170
v_accvgpr_write_b32 a199, v171
v_accvgpr_write_b32 a200, v172
v_accvgpr_write_b32 a201, v173
v_accvgpr_write_b32 a202, v174
v_accvgpr_write_b32 a203, v175
v_accvgpr_write_b32 a204, v176
v_accvgpr_write_b32 a205, v177
v_accvgpr_write_b32 a206, v178
v_accvgpr_write_b32 a207, v179
v_accvgpr_write_b32 a208, v180
v_accvgpr_write_b32 a209, v181
v_accvgpr_write_b32 a210, v182
v_accvgpr_write_b32 a211, v183
v_accvgpr_write_b32 a212, v184
v_accvgpr_write_b32 a213, v185
v_accvgpr_write_b32 a214, v186
v_accvgpr_write_b32 a215, v187
v_accvgpr_write_b32 a216, v188
v_accvgpr_write_b32 a217, v189
v_accvgpr_write_b32 a218, v190
v_accvgpr_write_b32 a219, v191
v_accvgpr_write_b32 a220, v192
v_accvgpr_write_b32 a221, v193
v_accvgpr_write_b32 a222, v194
v_accvgpr_write_b32 a223, v195
v_accvgpr_write_b32 a224, v196
v_accvgpr_write_b32 a225, v197
v_accvgpr_write_b32 a226, v198
v_accvgpr_write_b32 a227, v199
v_accvgpr_write_b32 a228, v200
v_accvgpr_write_b32 a229, v201
v_accvgpr_write_b32 a230, v202
v_accvgpr_write_b32 a231, v203
v_accvgpr_write_b32 a232, v204
v_accvgpr_write_b32 a233, v205
v_accvgpr_write_b32 a234, v206
v_accvgpr_write_b32 a235, v207
v_accvgpr_write_b32 a236, v208
v_accvgpr_write_b32 a237, v209
v_accvgpr_write_b32 a238, v210
v_accvgpr_write_b32 a239, v211
v_accvgpr_write_b32 a240, v212
v_accvgpr_write_b32 a241, v213
v_accvgpr_write_b32 a242, v214
v_accvgpr_write_b32 a243, v215
v_accvgpr_write_b32 a244, v216
v_accvgpr_write_b32 a245, v217
v_accvgpr_write_b32 a246, v218
v_accvgpr_write_b32 a247, v219
v_accvgpr_write_b32 a248, v220
v_accvgpr_write_b32 a249, v221
v_accvgpr_write_b32 a250, v222
v_accvgpr_write_b32 a251, v223
s_mul_i32 s45, s29, 10240
s_mul_i32 s46, s28, 2560
s_add_u32 s45, s45, s46
s_add_u32 s45, s45, 75497472
v_add_u32 v4, s45, v2
s_mul_i32 s61, s31, 6144
s_add_u32 s61, s61, 75825152
v_add_u32 v5, s61, v2
s_lshl_b32 s45, s28, 9
v_add_u32 v7, s45, v2
v_add_u32 v8, s45, v3
s_lshl_b32 s46, s28, 11
v_add_u32 v11, s46, v3
s_mul_i32 s46, s32, 3
s_add_u32 s46, s46, s28
s_lshr_b32 s47, s46, 1
s_lshl_b32 s47, s47, 9
s_and_b32 s48, s46, 1
s_lshl_b32 s48, s48, 3
s_add_u32 s47, s47, s48
s_add_u32 s48, s47, s61
v_add_u32 v9, s48, v3
v_add_u32 v10, 3072, v9
s_mul_i32 s48, s31, 3072
s_add_u32 s48, s48, s47
s_add_u32 s48, s48, 77660160
v_add_u32 v14, s48, v3
v_and_b32 v28, 31, v1
v_lshlrev_b32 v13, 4, v28
s_mul_i32 s48, s31, 3072
s_mul_i32 s47, s32, 768
s_add_u32 s48, s48, s47
s_add_u32 s48, s48, 83951616
v_lshlrev_b32 v28, 3, v28
v_add_u32 v15, s48, v28
s_mul_i32 s45, s32, 3
s_add_u32 s45, s45, 0
s_lshr_b32 s46, s45, 1
s_lshl_b32 s46, s46, 9
s_and_b32 s47, s45, 1
s_lshl_b32 s47, s47, 3
s_add_u32 s46, s46, s47
s_mul_i32 s47, s31, 3072
s_add_u32 s46, s46, s47
s_add_u32 s46, s46, 76611584
v_add_u32 v16, s46, v2
s_mul_i32 s45, s32, 3
s_add_u32 s45, s45, 1
s_lshr_b32 s46, s45, 1
s_lshl_b32 s46, s46, 9
s_and_b32 s47, s45, 1
s_lshl_b32 s47, s47, 3
s_add_u32 s46, s46, s47
s_mul_i32 s47, s31, 3072
s_add_u32 s46, s46, s47
s_add_u32 s46, s46, 76611584
v_add_u32 v17, s46, v2
s_mul_i32 s45, s32, 3
s_add_u32 s45, s45, 2
s_lshr_b32 s46, s45, 1
s_lshl_b32 s46, s46, 9
s_and_b32 s47, s45, 1
s_lshl_b32 s47, s47, 3
s_add_u32 s46, s46, s47
s_mul_i32 s47, s31, 3072
s_add_u32 s46, s46, s47
s_add_u32 s46, s46, 76611584
v_add_u32 v18, s46, v2
s_add_u32 s45, s58, s28
s_lshl_b32 s46, s45, 12
s_add_u32 s46, s46, 77004800
v_add_u32 v20, s46, v3
s_lshl_b32 s47, s29, 9
s_add_u32 s46, s46, s47
v_add_u32 v19, s46, v3
s_lshr_b32 s46, s45, 1
s_lshl_b32 s46, s46, 9
s_and_b32 s47, s45, 1
s_lshl_b32 s47, s47, 3
s_add_u32 s46, s46, s47
s_add_u32 s48, s46, 90253312
v_add_u32 v22, s48, v3
s_mul_i32 s47, s29, 10240
s_add_u32 s46, s46, s47
s_add_u32 s46, s46, 75497472
v_add_u32 v21, s46, v3
s_mov_b32 s33, 0
s_mov_b32 s60, 0
s_mul_i32 s59, s31, 12288
s_mov_b32 s57, 0xfffffffe
s_mov_b32 s55, 0x3dd53b95
s_waitcnt vmcnt(0) lgkmcnt(0)
s_barrier
v_mov_b32 v250, 64
s_nop 1
L_mcr_A:
global_load_dword v251, v250, s[6:7] sc1
s_waitcnt vmcnt(0)
v_readfirstlane_b32 s94, v251
s_add_u32 s95, s95, 1
s_cmp_gt_u32 s95, 4000000
s_cbranch_scc1 L_rec_done_A
s_cmp_ge_u32 s94, 256
s_cbranch_scc1 L_mcrx_A
s_sleep 2
s_branch L_mcr_A
L_mcrx_A:
v_and_b32 v250, 7, v1
v_lshlrev_b32 v250, 2, v250
global_load_dword v251, v250, s[6:7] sc1
s_waitcnt vmcnt(0)
v_cmp_ne_u32 vcc, 32, v251
s_cbranch_vccz L_mcrok_A
s_lshr_b32 s29, s49, 5
s_and_b32 s30, s49, 31
s_waitcnt vmcnt(0) lgkmcnt(0)
s_barrier
s_branch L_role_entry_B
L_mcrok_A:
s_cmp_lg_u32 s28, 3
s_cbranch_scc1 L_nopf0_A
s_and_b32 s45, s33, 7
s_cmp_lg_u32 s45, 0
s_cbranch_scc1 L_kvw1_ok_A
s_lshr_b32 s45, s33, 3
s_lshl_b32 s46, s29, 3
s_add_u32 s45, s45, s46
s_lshl_b32 s45, s45, 6
s_add_u32 s45, s45, 178466816
v_and_b32 v34, 15, v1
v_lshlrev_b32 v34, 2, v34
s_nop 1
L_kvw1_A:
buffer_load_dword v35, v34, s[20:23], s45 offen sc1
s_waitcnt vmcnt(0)
v_cmp_eq_u32 vcc, 0, v35
s_add_u32 s60, s60, 1
s_cmp_gt_u32 s60, 400000
s_cbranch_scc1 L_rec_fail_A
s_cbranch_vccz L_kvw1_ok_A
s_sleep 4
s_branch L_kvw1_A
L_kvw1_ok_A:
s_add_u32 s45, s59, 0
s_add_u32 s46, s45, 4096
s_add_u32 s47, s45, 8192
buffer_load_dwordx4 v[92:95], v3, s[20:23], s45 offen offset:0 sc1
buffer_load_dwordx4 v[96:99], v3, s[20:23], s45 offen offset:1024 sc1
buffer_load_dwordx4 v[100:103], v3, s[20:23], s45 offen offset:2048 sc1
buffer_load_dwordx4 v[104:107], v3, s[20:23], s45 offen offset:3072 sc1
buffer_load_dwordx4 v[108:111], v3, s[20:23], s46 offen offset:0 sc1
buffer_load_dwordx4 v[112:115], v3, s[20:23], s46 offen offset:1024 sc1
buffer_load_dwordx4 v[116:119], v3, s[20:23], s46 offen offset:2048 sc1
buffer_load_dwordx4 v[120:123], v3, s[20:23], s46 offen offset:3072 sc1
buffer_load_dwordx4 v[124:127], v3, s[20:23], s47 offen offset:0 sc1
buffer_load_dwordx4 v[128:131], v3, s[20:23], s47 offen offset:1024 sc1
buffer_load_dwordx4 v[132:135], v3, s[20:23], s47 offen offset:2048 sc1
buffer_load_dwordx4 v[136:139], v3, s[20:23], s47 offen offset:3072 sc1
s_mul_i32 s48, s32, 3072
s_add_u32 s48, s48, s59
s_add_u32 s48, s48, 25165824
buffer_load_dwordx4 v[140:143], v3, s[20:23], s48 offen offset:0 sc1
buffer_load_dwordx4 v[144:147], v3, s[20:23], s48 offen offset:1024 sc1
buffer_load_dwordx4 v[148:151], v3, s[20:23], s48 offen offset:2048 sc1
L_nopf0_A:
s_mov_b32 s16, 0
s_mov_b32 s17, 0
s_mov_b32 s18, 8
v_add_u32 v232, 3072, v5
s_lshl_b32 s45, s28, 8
s_add_u32 s45, s45, 24576
v_lshlrev_b32 v28, 3, v1
v_add_u32 v233, s45, v28
v_and_b32 v28, 31, v1
v_lshlrev_b32 v28, 3, v28
v_add_u32 v234, 24576, v28
s_mul_i32 s48, s31, 3072
s_mul_i32 s47, s32, 768
s_add_u32 s48, s48, s47
s_lshl_b32 s47, s28, 8
s_add_u32 s48, s48, s47
s_add_u32 s48, s48, 83951616
v_lshlrev_b32 v28, 3, v1
v_add_u32 v15, s48, v28
s_mov_b32 s14, 0
s_mov_b32 s15, -1
v_and_b32 v28, 31, v1
v_lshlrev_b32 v28, 4, v28
v_lshrrev_b32 v29, 5, v1
v_mul_u32_u24 v30, 6144, v29
s_lshl_b32 s46, s28, 11
v_add3_u32 v235, v28, v30, s46
v_sub_u32 v31, v9, v3
v_mul_u32_u24 v30, 3072, v29
v_add3_u32 v236, v31, v28, v30
v_sub_u32 v31, v14, v3
v_add_u32 v14, v31, v28
v_mov_b32 v237, 73744
v_mov_b32 v238, 1
v_mov_b32 v28, 0
ds_write_b32 v237, v28
ds_write_b32 v237, v28 offset:16
s_mov_b32 s12, 0
s_mov_b32 s13, 0
s_mov_b32 s10, 0
s_waitcnt lgkmcnt(0)
s_barrier
v_mov_b32 v240, s55
v_mov_b32 v241, s55
v_mov_b32 v244, 0
v_mov_b32 v245, 0
v_mov_b32 v246, 0
v_mov_b32 v247, 0
s_mov_b64 exec, s[14:15]
v_mov_b32 v244, 0xff800000
v_mov_b32 v245, 0xff800000
v_mov_b32 v246, 0xff800000
v_mov_b32 v247, 0xff800000
s_mov_b64 exec, -1
v_bfe_u32 v28, v1, 3, 1
v_lshlrev_b32 v28, 9, v28
v_add_u32 v248, v4, v28
v_add_u32 v249, v6, v28
v_add_u32 v250, v5, v28
v_add_u32 v239, 3072, v250
s_nop 1
L_step_A:
s_add_u32 s34, s33, 0
s_and_b32 s34, s34, 3
s_mul_i32 s34, s34, 81920
s_mov_b32 s45, s16
L_pm_sl_A:
s_cmp_eq_u32 s45, 0
s_cbranch_scc1 L_pm_go_A
s_sleep 1
s_sub_u32 s45, s45, 1
s_branch L_pm_sl_A
L_pm_go_A:
v_mov_b32 v52, 0
v_mov_b32 v54, 0
s_mov_b32 s19, 0
buffer_load_dwordx4 v[36:39], v248, s[20:23], s34 offen offset:0 sc1
buffer_load_dwordx4 v[44:47], v248, s[20:23], s34 offen offset:1024 sc1
s_mov_b64 exec, s[50:51]
buffer_load_dwordx4 v[52:55], v248, s[20:23], s34 offen offset:2048 sc1
s_mov_b64 exec, -1
s_add_u32 s35, s33, 1
s_and_b32 s35, s35, 3
s_mul_i32 s35, s35, 81920
s_add_u32 s36, s33, 3
s_and_b32 s36, s36, 3
s_mul_i32 s36, s36, 81920
s_add_u32 s12, s12, 4
s_add_u32 s13, s13, 3
s_add_u32 s37, s33, 0
s_and_b32 s37, s37, 3
s_mul_i32 s37, s37, 196608
s_add_u32 s38, s33, 2
s_and_b32 s38, s38, 3
s_mul_i32 s38, s38, 196608
s_add_u32 s39, s33, 0
s_and_b32 s39, s39, 3
s_mul_i32 s39, s39, 98304
s_add_u32 s40, s33, 2
s_and_b32 s40, s40, 3
s_mul_i32 s40, s40, 98304
s_add_u32 s41, s33, 0
s_and_b32 s41, s41, 3
s_mul_i32 s41, s41, 163840
s_add_u32 s42, s33, 2
s_and_b32 s42, s42, 3
s_mul_i32 s42, s42, 163840
s_mul_i32 s43, s33, 98304
s_mov_b32 s19, 0
s_branch L_pm_w_A
L_pm_retry_A:
s_add_u32 s19, s19, 1
s_add_u32 s60, s60, 1
s_cmp_gt_u32 s60, 400000
s_cbranch_scc1 L_rec_fail_A
buffer_load_dwordx4 v[36:39], v248, s[20:23], s34 offen offset:0 sc1
buffer_load_dwordx4 v[44:47], v248, s[20:23], s34 offen offset:1024 sc1
s_mov_b64 exec, s[50:51]
buffer_load_dwordx4 v[52:55], v248, s[20:23], s34 offen offset:2048 sc1
s_mov_b64 exec, -1
L_pm_w_A:
s_waitcnt vmcnt(0)
v_max3_u32 v28, v36, v38, v44
v_max3_u32 v28, v28, v46, v52
v_max_u32 v28, v28, v54
v_cmp_eq_u32 vcc, -1, v28
s_cbranch_vccnz L_pm_retry_A
s_mov_b32 s3, s19
v_mfma_f32_16x16x32_bf16 v[56:59], a[0:3], v[36:39], 0
v_mov_b32_dpp v40, v36 row_ror:8 row_mask:0xf bank_mask:0xf
v_mfma_f32_16x16x32_bf16 v[60:63], a[20:23], v[36:39], 0
v_mov_b32_dpp v41, v37 row_ror:8 row_mask:0xf bank_mask:0xf
v_mfma_f32_16x16x32_bf16 v[64:67], a[40:43], v[36:39], 0
v_mov_b32_dpp v42, v38 row_ror:8 row_mask:0xf bank_mask:0xf
v_mfma_f32_16x16x32_bf16 v[56:59], a[8:11], v[44:47], v[56:59]
v_mov_b32_dpp v43, v39 row_ror:8 row_mask:0xf bank_mask:0xf
v_mfma_f32_16x16x32_bf16 v[60:63], a[28:31], v[44:47], v[60:63]
v_mov_b32_dpp v48, v44 row_ror:8 row_mask:0xf bank_mask:0xf
v_mfma_f32_16x16x32_bf16 v[64:67], a[48:51], v[44:47], v[64:67]
v_mov_b32_dpp v49, v45 row_ror:8 row_mask:0xf bank_mask:0xf
v_mfma_f32_16x16x32_bf16 v[56:59], a[16:19], v[52:55], v[56:59]
v_mov_b32_dpp v50, v46 row_ror:8 row_mask:0xf bank_mask:0xf
v_mfma_f32_16x16x32_bf16 v[60:63], a[36:39], v[52:55], v[60:63]
v_mov_b32_dpp v51, v47 row_ror:8 row_mask:0xf bank_mask:0xf
v_mfma_f32_16x16x32_bf16 v[64:67], a[56:59], v[52:55], v[64:67]
v_mfma_f32_16x16x32_bf16 v[56:59], a[4:7], v[40:43], v[56:59]
v_mfma_f32_16x16x32_bf16 v[60:63], a[24:27], v[40:43], v[60:63]
v_mfma_f32_16x16x32_bf16 v[64:67], a[44:47], v[40:43], v[64:67]
v_mfma_f32_16x16x32_bf16 v[56:59], a[12:15], v[48:51], v[56:59]
v_mfma_f32_16x16x32_bf16 v[60:63], a[32:35], v[48:51], v[60:63]
v_mfma_f32_16x16x32_bf16 v[64:67], a[52:55], v[48:51], v[64:67]
v_mfma_f32_16x16x32_bf16 v[68:71], a[60:63], v[36:39], 0
v_mfma_f32_16x16x32_bf16 v[72:75], a[80:83], v[36:39], 0
v_mfma_f32_16x16x32_bf16 v[76:79], a[100:103], v[36:39], 0
v_mfma_f32_16x16x32_bf16 v[68:71], a[68:71], v[44:47], v[68:71]
v_mfma_f32_16x16x32_bf16 v[72:75], a[88:91], v[44:47], v[72:75]
v_mfma_f32_16x16x32_bf16 v[76:79], a[108:111], v[44:47], v[76:79]
v_mfma_f32_16x16x32_bf16 v[68:71], a[76:79], v[52:55], v[68:71]
v_mfma_f32_16x16x32_bf16 v[72:75], a[96:99], v[52:55], v[72:75]
v_mfma_f32_16x16x32_bf16 v[76:79], a[116:119], v[52:55], v[76:79]
s_mov_b64 exec, s[50:51]
ds_write_b128 v7, v[56:59] offset:0
ds_write_b128 v7, v[60:63] offset:2048
ds_write_b128 v7, v[64:67] offset:4096
s_mov_b64 exec, -1
v_mfma_f32_16x16x32_bf16 v[68:71], a[64:67], v[40:43], v[68:71]
v_mfma_f32_16x16x32_bf16 v[72:75], a[84:87], v[40:43], v[72:75]
v_mfma_f32_16x16x32_bf16 v[76:79], a[104:107], v[40:43], v[76:79]
v_mfma_f32_16x16x32_bf16 v[68:71], a[72:75], v[48:51], v[68:71]
v_mfma_f32_16x16x32_bf16 v[72:75], a[92:95], v[48:51], v[72:75]
v_mfma_f32_16x16x32_bf16 v[76:79], a[112:115], v[48:51], v[76:79]
s_mov_b64 exec, s[50:51]
s_nop 4
ds_write_b128 v7, v[68:71] offset:6144
ds_write_b128 v7, v[72:75] offset:8192
ds_write_b128 v7, v[76:79] offset:10240
s_mov_b64 exec, -1
v_mfma_f32_16x16x32_bf16 v[80:83], v[36:39], a[120:123], 0
v_mfma_f32_16x16x32_bf16 v[84:87], v[36:39], a[140:143], 0
v_mfma_f32_16x16x32_bf16 v[88:91], v[36:39], a[160:163], 0
s_waitcnt lgkmcnt(0)
s_barrier
s_cmp_eq_u32 s28, 3
s_cbranch_scc1 L_w3_A
ds_read_b128 v[92:95], v235 offset:0
ds_read_b128 v[96:99], v235 offset:512
ds_read_b128 v[100:103], v235 offset:1024
ds_read_b128 v[104:107], v235 offset:1536
v_mfma_f32_16x16x32_bf16 v[80:83], v[40:43], a[124:127], v[80:83]
v_mfma_f32_16x16x32_bf16 v[84:87], v[40:43], a[144:147], v[84:87]
v_mfma_f32_16x16x32_bf16 v[88:91], v[40:43], a[164:167], v[88:91]
v_mfma_f32_16x16x32_bf16 v[80:83], v[44:47], a[128:131], v[80:83]
v_mfma_f32_16x16x32_bf16 v[84:87], v[44:47], a[148:151], v[84:87]
v_mfma_f32_16x16x32_bf16 v[88:91], v[44:47], a[168:171], v[88:91]
s_waitcnt lgkmcnt(0)
v_pk_add_f32 v[92:93], v[92:93], v[96:97]
v_pk_add_f32 v[100:101], v[100:101], v[104:105]
v_pk_add_f32 v[94:95], v[94:95], v[98:99]
v_pk_add_f32 v[102:103], v[102:103], v[106:107]
v_pk_add_f32 v[92:93], v[92:93], v[100:101]
v_pk_add_f32 v[94:95], v[94:95], v[102:103]
v_cvt_pk_bf16_f32 v96, v92, v93
v_cvt_pk_bf16_f32 v97, v94, v95
v_min_u32 v96, s57, v96
buffer_store_dwordx2 v[96:97], v236, s[20:23], s37 offen
v_mfma_f32_16x16x32_bf16 v[80:83], v[48:51], a[132:135], v[80:83]
v_mfma_f32_16x16x32_bf16 v[84:87], v[48:51], a[152:155], v[84:87]
v_mfma_f32_16x16x32_bf16 v[88:91], v[48:51], a[172:175], v[88:91]
v_mfma_f32_16x16x32_bf16 v[80:83], v[52:55], a[136:139], v[80:83]
v_mfma_f32_16x16x32_bf16 v[84:87], v[52:55], a[156:159], v[84:87]
v_mfma_f32_16x16x32_bf16 v[88:91], v[52:55], a[176:179], v[88:91]
buffer_store_dwordx2 v[24:25], v236, s[20:23], s38 offen
s_mov_b64 exec, s[14:15]
buffer_store_dwordx2 v[96:97], v14, s[20:23], s43 offen
s_mov_b64 exec, -1
s_mov_b64 exec, s[52:53]
s_nop 0
ds_write_b128 v8, v[80:83] offset:12288
ds_write_b128 v8, v[84:87] offset:14336
ds_write_b128 v8, v[88:91] offset:16384
s_mov_b64 exec, -1
s_waitcnt lgkmcnt(0)
s_mov_b64 exec, 1
ds_add_u32 v237, v238 offset:0
s_mov_b64 exec, -1
L_cw1_A:
ds_read_b32 v35, v237 offset:0
s_waitcnt lgkmcnt(0)
v_readfirstlane_b32 s45, v35
s_nop 0
s_cmp_lt_u32 s45, s12
s_cbranch_scc1 L_cw1_A
ds_read_b128 v[92:95], v11 offset:12288
ds_read_b128 v[96:99], v11 offset:12800
ds_read_b128 v[100:103], v11 offset:13312
ds_read_b128 v[104:107], v11 offset:13824
s_waitcnt lgkmcnt(0)
v_pk_add_f32 v[92:93], v[92:93], v[96:97]
v_pk_add_f32 v[100:101], v[100:101], v[104:105]
v_pk_add_f32 v[94:95], v[94:95], v[98:99]
v_pk_add_f32 v[102:103], v[102:103], v[106:107]
v_pk_add_f32 v[92:93], v[92:93], v[100:101]
v_pk_add_f32 v[94:95], v[94:95], v[102:103]
v_cvt_pk_bf16_f32 v96, v92, v93
v_cvt_pk_bf16_f32 v97, v94, v95
s_mov_b64 exec, s[52:53]
ds_write_b64 v233, v[96:97]
buffer_store_dwordx2 v[96:97], v15, s[20:23], s43 offen
s_mov_b64 exec, -1
s_waitcnt lgkmcnt(0)
s_mov_b64 exec, 1
ds_add_u32 v237, v238 offset:16
s_mov_b64 exec, -1
s_waitcnt vmcnt(0)
s_lshl_b32 s45, s33, 5
s_add_u32 s45, s45, s31
s_lshl_b32 s45, s45, 6
s_add_u32 s45, s45, 178483200
s_mul_i32 s46, s32, 12
s_lshl_b32 s47, s28, 2
s_add_u32 s45, s45, s46
s_add_u32 s45, s45, s47
s_mov_b64 exec, 1
v_mov_b32 v34, s45
buffer_store_dword v238, v34, s[20:23], 0 offen
s_mov_b64 exec, -1
s_branch L_p4_A
L_w3_A:
v_mfma_f32_16x16x32_bf16 v[80:83], v[40:43], a[124:127], v[80:83]
v_mfma_f32_16x16x32_bf16 v[84:87], v[40:43], a[144:147], v[84:87]
v_mfma_f32_16x16x32_bf16 v[88:91], v[40:43], a[164:167], v[88:91]
v_mfma_f32_16x16x32_bf16 v[80:83], v[44:47], a[128:131], v[80:83]
v_mfma_f32_16x16x32_bf16 v[84:87], v[44:47], a[148:151], v[84:87]
v_mfma_f32_16x16x32_bf16 v[88:91], v[44:47], a[168:171], v[88:91]
v_mfma_f32_16x16x32_bf16 v[80:83], v[48:51], a[132:135], v[80:83]
v_mfma_f32_16x16x32_bf16 v[84:87], v[48:51], a[152:155], v[84:87]
v_mfma_f32_16x16x32_bf16 v[88:91], v[48:51], a[172:175], v[88:91]
v_mfma_f32_16x16x32_bf16 v[80:83], v[52:55], a[136:139], v[80:83]
v_mfma_f32_16x16x32_bf16 v[84:87], v[52:55], a[156:159], v[84:87]
v_mfma_f32_16x16x32_bf16 v[88:91], v[52:55], a[176:179], v[88:91]
s_mov_b64 exec, s[52:53]
s_nop 4
ds_write_b128 v8, v[80:83] offset:12288
ds_write_b128 v8, v[84:87] offset:14336
ds_write_b128 v8, v[88:91] offset:16384
s_mov_b64 exec, -1
s_waitcnt lgkmcnt(0)
s_mov_b64 exec, 1
ds_add_u32 v237, v238 offset:0
s_mov_b64 exec, -1
s_mov_b32 s45, s10
L_pq_sl_A:
s_cmp_eq_u32 s45, 0
s_cbranch_scc1 L_pq_go_A
s_sleep 1
s_sub_u32 s45, s45, 1
s_branch L_pq_sl_A
L_pq_go_A:
s_mov_b32 s19, 0
buffer_load_dwordx4 v[152:155], v250, s[20:23], s37 offen offset:0 sc1
buffer_load_dwordx4 v[160:163], v250, s[20:23], s37 offen offset:1024 sc1
buffer_load_dwordx4 v[168:171], v250, s[20:23], s37 offen offset:2048 sc1
buffer_load_dwordx4 v[184:187], v239, s[20:23], s37 offen offset:0 sc1
buffer_load_dwordx4 v[192:195], v239, s[20:23], s37 offen offset:1024 sc1
buffer_load_dwordx4 v[200:203], v239, s[20:23], s37 offen offset:2048 sc1
s_branch L_pqk_w_A
L_pqk_retry_A:
s_add_u32 s19, s19, 1
s_add_u32 s60, s60, 1
s_cmp_gt_u32 s60, 400000
s_cbranch_scc1 L_rec_fail_A
buffer_load_dwordx4 v[152:155], v250, s[20:23], s37 offen offset:0 sc1
buffer_load_dwordx4 v[160:163], v250, s[20:23], s37 offen offset:1024 sc1
buffer_load_dwordx4 v[168:171], v250, s[20:23], s37 offen offset:2048 sc1
buffer_load_dwordx4 v[184:187], v239, s[20:23], s37 offen offset:0 sc1
buffer_load_dwordx4 v[192:195], v239, s[20:23], s37 offen offset:1024 sc1
buffer_load_dwordx4 v[200:203], v239, s[20:23], s37 offen offset:2048 sc1
L_pqk_w_A:
s_waitcnt vmcnt(0)
v_max3_u32 v28, v152, v154, v160
v_max3_u32 v28, v28, v162, v168
v_max3_u32 v28, v28, v170, v184
v_max3_u32 v28, v28, v186, v192
v_max3_u32 v28, v28, v194, v200
v_max_u32 v28, v28, v202
v_cmp_eq_u32 vcc, -1, v28
s_cbranch_vccnz L_pqk_retry_A
s_mov_b32 s9, s19
v_mfma_f32_16x16x32_bf16 v[36:39], v[92:95], v[152:155], 0
v_mov_b32_dpp v156, v152 row_ror:8 row_mask:0xf bank_mask:0xf
v_mov_b32_dpp v157, v153 row_ror:8 row_mask:0xf bank_mask:0xf
v_mov_b32_dpp v158, v154 row_ror:8 row_mask:0xf bank_mask:0xf
v_mfma_f32_16x16x32_bf16 v[40:43], v[116:119], v[152:155], 0
v_mov_b32_dpp v159, v155 row_ror:8 row_mask:0xf bank_mask:0xf
v_mov_b32_dpp v188, v184 row_ror:8 row_mask:0xf bank_mask:0xf
v_mov_b32_dpp v189, v185 row_ror:8 row_mask:0xf bank_mask:0xf
v_mfma_f32_16x16x32_bf16 v[44:47], v[184:187], v[152:155], v[244:247]
v_mov_b32_dpp v190, v186 row_ror:8 row_mask:0xf bank_mask:0xf
v_mov_b32_dpp v191, v187 row_ror:8 row_mask:0xf bank_mask:0xf
v_mov_b32_dpp v164, v160 row_ror:8 row_mask:0xf bank_mask:0xf
v_mfma_f32_16x16x32_bf16 v[36:39], v[100:103], v[160:163], v[36:39]
v_mov_b32_dpp v165, v161 row_ror:8 row_mask:0xf bank_mask:0xf
v_mov_b32_dpp v166, v162 row_ror:8 row_mask:0xf bank_mask:0xf
v_mov_b32_dpp v167, v163 row_ror:8 row_mask:0xf bank_mask:0xf
v_mfma_f32_16x16x32_bf16 v[40:43], v[124:127], v[160:163], v[40:43]
v_mov_b32_dpp v196, v192 row_ror:8 row_mask:0xf bank_mask:0xf
v_mov_b32_dpp v197, v193 row_ror:8 row_mask:0xf bank_mask:0xf
v_mov_b32_dpp v198, v194 row_ror:8 row_mask:0xf bank_mask:0xf
v_mfma_f32_16x16x32_bf16 v[44:47], v[192:195], v[160:163], v[44:47]
v_mov_b32_dpp v199, v195 row_ror:8 row_mask:0xf bank_mask:0xf
v_mov_b32_dpp v172, v168 row_ror:8 row_mask:0xf bank_mask:0xf
v_mov_b32_dpp v173, v169 row_ror:8 row_mask:0xf bank_mask:0xf
v_mfma_f32_16x16x32_bf16 v[36:39], v[108:111], v[168:171], v[36:39]
v_mov_b32_dpp v174, v170 row_ror:8 row_mask:0xf bank_mask:0xf
v_mov_b32_dpp v175, v171 row_ror:8 row_mask:0xf bank_mask:0xf
v_mov_b32_dpp v204, v200 row_ror:8 row_mask:0xf bank_mask:0xf
v_mfma_f32_16x16x32_bf16 v[40:43], v[132:135], v[168:171], v[40:43]
v_mov_b32_dpp v205, v201 row_ror:8 row_mask:0xf bank_mask:0xf
v_mov_b32_dpp v206, v202 row_ror:8 row_mask:0xf bank_mask:0xf
v_mov_b32_dpp v207, v203 row_ror:8 row_mask:0xf bank_mask:0xf
v_mfma_f32_16x16x32_bf16 v[44:47], v[200:203], v[168:171], v[44:47]
v_mfma_f32_16x16x32_bf16 v[36:39], v[96:99], v[156:159], v[36:39]
v_mfma_f32_16x16x32_bf16 v[40:43], v[120:123], v[156:159], v[40:43]
v_mfma_f32_16x16x32_bf16 v[44:47], v[188:191], v[156:159], v[44:47]
s_nop 7
L_cw2_A:
ds_read_b32 v35, v237 offset:16
s_waitcnt lgkmcnt(0)
v_readfirstlane_b32 s45, v35
s_nop 0
s_cmp_lt_u32 s45, s13
s_cbranch_scc1 L_cw2_A
ds_read_b64 v[176:177], v234 offset:0
ds_read_b64 v[178:179], v234 offset:256
ds_read_b64 v[180:181], v234 offset:512
v_mfma_f32_16x16x32_bf16 v[36:39], v[104:107], v[164:167], v[36:39]
v_mfma_f32_16x16x32_bf16 v[40:43], v[128:131], v[164:167], v[40:43]
v_mfma_f32_16x16x32_bf16 v[44:47], v[196:199], v[164:167], v[44:47]
v_mfma_f32_16x16x32_bf16 v[36:39], v[112:115], v[172:175], v[36:39]
v_mfma_f32_16x16x32_bf16 v[40:43], v[136:139], v[172:175], v[40:43]
v_mfma_f32_16x16x32_bf16 v[44:47], v[204:207], v[172:175], v[44:47]
s_nop 5
v_max3_f32 v28, v36, v37, v38
v_max3_f32 v29, v39, v40, v41
v_max3_f32 v28, v28, v42, v43
v_max3_f32 v29, v29, v44, v45
v_max3_f32 v28, v28, v46, v47
v_max_f32 v28, v28, v29
v_mov_b32 v29, v28
s_nop 1
v_permlane32_swap_b32 v28, v29
v_max_f32 v28, v28, v29
v_mov_b32 v29, v28
s_nop 1
v_permlane16_swap_b32 v28, v29
v_max_f32 v28, v28, v29
v_mov_b32 v29, v28
v_pk_add_f32 v[36:37], v[36:37], v[28:29] neg_lo:[0,1] neg_hi:[0,1]
v_pk_mul_f32 v[36:37], v[36:37], v[240:241]
v_pk_add_f32 v[38:39], v[38:39], v[28:29] neg_lo:[0,1] neg_hi:[0,1]
v_exp_f32 v36, v36
v_pk_mul_f32 v[38:39], v[38:39], v[240:241]
v_exp_f32 v37, v37
v_pk_add_f32 v[40:41], v[40:41], v[28:29] neg_lo:[0,1] neg_hi:[0,1]
v_exp_f32 v38, v38
v_pk_mul_f32 v[40:41], v[40:41], v[240:241]
v_exp_f32 v39, v39
v_cvt_pk_bf16_f32 v48, v36, v37
v_pk_add_f32 v[42:43], v[42:43], v[28:29] neg_lo:[0,1] neg_hi:[0,1]
v_exp_f32 v40, v40
v_pk_mul_f32 v[42:43], v[42:43], v[240:241]
v_exp_f32 v41, v41
v_cvt_pk_bf16_f32 v49, v38, v39
v_pk_add_f32 v[44:45], v[44:45], v[28:29] neg_lo:[0,1] neg_hi:[0,1]
v_exp_f32 v42, v42
v_pk_mul_f32 v[44:45], v[44:45], v[240:241]
v_exp_f32 v43, v43
v_cvt_pk_bf16_f32 v50, v40, v41
v_pk_add_f32 v[46:47], v[46:47], v[28:29] neg_lo:[0,1] neg_hi:[0,1]
v_exp_f32 v44, v44
v_pk_mul_f32 v[46:47], v[46:47], v[240:241]
v_exp_f32 v45, v45
v_cvt_pk_bf16_f32 v51, v42, v43
v_exp_f32 v46, v46
v_exp_f32 v47, v47
v_mfma_f32_16x16x32_bf16 v[56:59], v[140:143], v[48:51], 0
v_mfma_f32_16x16x32_bf16 v[60:63], v[144:147], v[48:51], 0
v_mfma_f32_16x16x32_bf16 v[64:67], v[148:151], v[48:51], 0
v_cvt_pk_bf16_f32 v52, v44, v45
v_cvt_pk_bf16_f32 v53, v46, v47
s_waitcnt lgkmcnt(0)
s_nop 0
v_mfma_f32_16x16x16_bf16 v[56:59], v[176:177], v[52:53], v[56:59]
v_mfma_f32_16x16x16_bf16 v[60:63], v[178:179], v[52:53], v[60:63]
v_mfma_f32_16x16x16_bf16 v[64:67], v[180:181], v[52:53], v[64:67]
v_pk_add_f32 v[36:37], v[36:37], v[42:43]
v_pk_add_f32 v[38:39], v[38:39], v[44:45]
v_pk_add_f32 v[40:41], v[40:41], v[46:47]
v_pk_add_f32 v[36:37], v[36:37], v[38:39]
v_pk_add_f32 v[36:37], v[36:37], v[40:41]
v_add_f32 v28, v36, v37
v_mov_b32 v29, v28
s_nop 1
v_permlane32_swap_b32 v28, v29
v_add_f32 v28, v28, v29
v_mov_b32 v29, v28
s_nop 1
v_permlane16_swap_b32 v28, v29
v_add_f32 v28, v28, v29
v_rcp_f32 v28, v28
s_nop 0
v_mov_b32 v29, v28
s_mov_b64 exec, s[50:51]
v_pk_mul_f32 v[56:57], v[56:57], v[28:29]
v_pk_mul_f32 v[58:59], v[58:59], v[28:29]
v_cvt_pk_bf16_f32 v30, v56, v57
v_cvt_pk_bf16_f32 v31, v58, v59
v_min_u32 v30, s57, v30
buffer_store_dwordx2 v[30:31], v16, s[20:23], s39 offen
v_pk_mul_f32 v[60:61], v[60:61], v[28:29]
v_pk_mul_f32 v[62:63], v[62:63], v[28:29]
v_cvt_pk_bf16_f32 v32, v60, v61
v_cvt_pk_bf16_f32 v33, v62, v63
v_min_u32 v32, s57, v32
buffer_store_dwordx2 v[32:33], v17, s[20:23], s39 offen
v_pk_mul_f32 v[64:65], v[64:65], v[28:29]
v_pk_mul_f32 v[66:67], v[66:67], v[28:29]
v_cvt_pk_bf16_f32 v34, v64, v65
v_cvt_pk_bf16_f32 v35, v66, v67
v_min_u32 v34, s57, v34
buffer_store_dwordx2 v[34:35], v18, s[20:23], s39 offen
buffer_store_dwordx2 v[24:25], v16, s[20:23], s40 offen
buffer_store_dwordx2 v[24:25], v17, s[20:23], s40 offen
buffer_store_dwordx2 v[24:25], v18, s[20:23], s40 offen
s_mov_b64 exec, -1
L_p4_A:
s_mov_b32 s45, s17
L_po_sl_A:
s_cmp_eq_u32 s45, 0
s_cbranch_scc1 L_po_go_A
s_sleep 1
s_sub_u32 s45, s45, 1
s_branch L_po_sl_A
L_po_go_A:
s_mov_b32 s19, 0
buffer_load_dwordx4 v[208:211], v249, s[20:23], s39 offen offset:0 sc1
buffer_load_dwordx4 v[216:219], v249, s[20:23], s39 offen offset:1024 sc1
buffer_load_dwordx4 v[224:227], v249, s[20:23], s39 offen offset:2048 sc1
s_branch L_po_w_A
L_po_retry_A:
s_add_u32 s19, s19, 1
s_add_u32 s60, s60, 1
s_cmp_gt_u32 s60, 400000
s_cbranch_scc1 L_rec_fail_A
buffer_load_dwordx4 v[208:211], v249, s[20:23], s39 offen offset:0 sc1
buffer_load_dwordx4 v[216:219], v249, s[20:23], s39 offen offset:1024 sc1
buffer_load_dwordx4 v[224:227], v249, s[20:23], s39 offen offset:2048 sc1
L_po_w_A:
s_waitcnt vmcnt(0)
v_max3_u32 v28, v208, v210, v216
v_max3_u32 v28, v28, v218, v224
v_max_u32 v28, v28, v226
v_cmp_eq_u32 vcc, -1, v28
s_cbranch_vccnz L_po_retry_A
v_mfma_f32_16x16x32_bf16 v[68:71], a[180:183], v[208:211], 0
v_mov_b32_dpp v212, v208 row_ror:8 row_mask:0xf bank_mask:0xf
v_mov_b32_dpp v213, v209 row_ror:8 row_mask:0xf bank_mask:0xf
v_mfma_f32_16x16x32_bf16 v[72:75], a[204:207], v[208:211], 0
v_mov_b32_dpp v214, v210 row_ror:8 row_mask:0xf bank_mask:0xf
v_mov_b32_dpp v215, v211 row_ror:8 row_mask:0xf bank_mask:0xf
v_mfma_f32_16x16x32_bf16 v[76:79], a[228:231], v[208:211], 0
v_mov_b32_dpp v220, v216 row_ror:8 row_mask:0xf bank_mask:0xf
v_mov_b32_dpp v221, v217 row_ror:8 row_mask:0xf bank_mask:0xf
v_mfma_f32_16x16x32_bf16 v[68:71], a[188:191], v[216:219], v[68:71]
v_mov_b32_dpp v222, v218 row_ror:8 row_mask:0xf bank_mask:0xf
v_mov_b32_dpp v223, v219 row_ror:8 row_mask:0xf bank_mask:0xf
v_mfma_f32_16x16x32_bf16 v[72:75], a[212:215], v[216:219], v[72:75]
v_mov_b32_dpp v228, v224 row_ror:8 row_mask:0xf bank_mask:0xf
v_mov_b32_dpp v229, v225 row_ror:8 row_mask:0xf bank_mask:0xf
v_mfma_f32_16x16x32_bf16 v[76:79], a[236:239], v[216:219], v[76:79]
v_mov_b32_dpp v230, v226 row_ror:8 row_mask:0xf bank_mask:0xf
v_mov_b32_dpp v231, v227 row_ror:8 row_mask:0xf bank_mask:0xf
v_mfma_f32_16x16x32_bf16 v[68:71], a[196:199], v[224:227], v[68:71]
v_mfma_f32_16x16x32_bf16 v[72:75], a[220:223], v[224:227], v[72:75]
v_mfma_f32_16x16x32_bf16 v[76:79], a[244:247], v[224:227], v[76:79]
v_mfma_f32_16x16x32_bf16 v[68:71], a[184:187], v[212:215], v[68:71]
v_mfma_f32_16x16x32_bf16 v[72:75], a[208:211], v[212:215], v[72:75]
v_mfma_f32_16x16x32_bf16 v[76:79], a[232:235], v[212:215], v[76:79]
v_mfma_f32_16x16x32_bf16 v[68:71], a[192:195], v[220:223], v[68:71]
v_mfma_f32_16x16x32_bf16 v[72:75], a[216:219], v[220:223], v[72:75]
v_mfma_f32_16x16x32_bf16 v[76:79], a[240:243], v[220:223], v[76:79]
v_mfma_f32_16x16x32_bf16 v[68:71], a[200:203], v[228:231], v[68:71]
v_mfma_f32_16x16x32_bf16 v[72:75], a[224:227], v[228:231], v[72:75]
v_mfma_f32_16x16x32_bf16 v[76:79], a[248:251], v[228:231], v[76:79]
s_nop 7
L_p4_two_A:
s_mov_b64 exec, s[50:51]
ds_write_b128 v7, v[68:71] offset:18432
ds_write_b128 v7, v[72:75] offset:20480
ds_write_b128 v7, v[76:79] offset:22528
s_mov_b64 exec, -1
s_mov_b32 s11, s19
s_add_u32 s33, s33, 1
s_add_u32 s59, s59, 393216
s_waitcnt lgkmcnt(0)
s_barrier
s_cmp_lg_u32 s28, 3
s_cbranch_scc1 L_nopf_A
s_mov_b32 s19, s11
s_cmp_lt_u32 s19, 1
s_cbranch_scc0 L_ad_1a_A
s_lshr_b32 s45, s17, 3
s_add_u32 s45, s45, 1
s_max_u32 s17, s17, s45
s_sub_u32 s17, s17, s45
s_branch L_ad_1b_A
L_ad_1a_A:
s_cmp_gt_u32 s19, 3
s_cbranch_scc0 L_ad_1b_A
s_sub_u32 s45, s19, 3
s_add_u32 s45, s45, 1
s_lshr_b32 s45, s45, 1
s_min_u32 s45, s45, 3
s_add_u32 s17, s17, s45
s_min_u32 s17, s17, 56
L_ad_1b_A:
s_mov_b32 s19, s3
s_cmp_lt_u32 s19, 1
s_cbranch_scc0 L_ad_2a_A
s_lshr_b32 s45, s16, 3
s_add_u32 s45, s45, 1
s_max_u32 s16, s16, s45
s_sub_u32 s16, s16, s45
s_branch L_ad_2b_A
L_ad_2a_A:
s_cmp_gt_u32 s19, 3
s_cbranch_scc0 L_ad_2b_A
s_sub_u32 s45, s19, 3
s_add_u32 s45, s45, 1
s_lshr_b32 s45, s45, 1
s_min_u32 s45, s45, 3
s_add_u32 s16, s16, s45
s_min_u32 s16, s16, 56
L_ad_2b_A:
s_mov_b32 s19, s9
s_cmp_lt_u32 s19, 1
s_cbranch_scc0 L_ad_3a_A
s_lshr_b32 s45, s10, 3
s_add_u32 s45, s45, 1
s_max_u32 s10, s10, s45
s_sub_u32 s10, s10, s45
s_branch L_ad_3b_A
L_ad_3a_A:
s_cmp_gt_u32 s19, 0
s_cbranch_scc0 L_ad_3b_A
s_sub_u32 s45, s19, 0
s_add_u32 s45, s45, 1
s_lshr_b32 s45, s45, 1
s_min_u32 s45, s45, 3
s_add_u32 s10, s10, s45
s_min_u32 s10, s10, 56
L_ad_3b_A:
s_cmp_ge_u32 s33, 64
s_cbranch_scc1 L_nored_A
s_waitcnt vmcnt(0)
s_and_b32 s45, s33, 7
s_cmp_lg_u32 s45, 0
s_cbranch_scc1 L_kvw2_ok_A
s_lshr_b32 s45, s33, 3
s_lshl_b32 s46, s29, 3
s_add_u32 s45, s45, s46
s_lshl_b32 s45, s45, 6
s_add_u32 s45, s45, 178466816
v_and_b32 v34, 15, v1
v_lshlrev_b32 v34, 2, v34
s_nop 1
L_kvw2_A:
buffer_load_dword v35, v34, s[20:23], s45 offen sc1
s_waitcnt vmcnt(0)
v_cmp_eq_u32 vcc, 0, v35
s_add_u32 s60, s60, 1
s_cmp_gt_u32 s60, 400000
s_cbranch_scc1 L_rec_fail_A
s_cbranch_vccz L_kvw2_ok_A
s_sleep 4
s_branch L_kvw2_A
L_kvw2_ok_A:
s_add_u32 s45, s59, 0
s_add_u32 s46, s45, 4096
s_add_u32 s47, s45, 8192
buffer_load_dwordx4 v[92:95], v3, s[20:23], s45 offen offset:0 sc1
buffer_load_dwordx4 v[96:99], v3, s[20:23], s45 offen offset:1024 sc1
buffer_load_dwordx4 v[100:103], v3, s[20:23], s45 offen offset:2048 sc1
buffer_load_dwordx4 v[104:107], v3, s[20:23], s45 offen offset:3072 sc1
buffer_load_dwordx4 v[108:111], v3, s[20:23], s46 offen offset:0 sc1
buffer_load_dwordx4 v[112:115], v3, s[20:23], s46 offen offset:1024 sc1
buffer_load_dwordx4 v[116:119], v3, s[20:23], s46 offen offset:2048 sc1
buffer_load_dwordx4 v[120:123], v3, s[20:23], s46 offen offset:3072 sc1
buffer_load_dwordx4 v[124:127], v3, s[20:23], s47 offen offset:0 sc1
buffer_load_dwordx4 v[128:131], v3, s[20:23], s47 offen offset:1024 sc1
buffer_load_dwordx4 v[132:135], v3, s[20:23], s47 offen offset:2048 sc1
buffer_load_dwordx4 v[136:139], v3, s[20:23], s47 offen offset:3072 sc1
s_mul_i32 s48, s32, 3072
s_add_u32 s48, s48, s59
s_add_u32 s48, s48, 25165824
buffer_load_dwordx4 v[140:143], v3, s[20:23], s48 offen offset:0 sc1
buffer_load_dwordx4 v[144:147], v3, s[20:23], s48 offen offset:1024 sc1
buffer_load_dwordx4 v[148:151], v3, s[20:23], s48 offen offset:2048 sc1
s_branch L_nored_A
L_nopf_A:
s_cmp_lt_u32 s28, s54
s_cbranch_scc1 L_owner_A
s_mov_b32 s19, s11
s_cmp_lt_u32 s19, 1
s_cbranch_scc0 L_ad_4a_A
s_lshr_b32 s45, s17, 3
s_add_u32 s45, s45, 1
s_max_u32 s17, s17, s45
s_sub_u32 s17, s17, s45
s_branch L_ad_4b_A
L_ad_4a_A:
s_cmp_gt_u32 s19, 3
s_cbranch_scc0 L_ad_4b_A
s_sub_u32 s45, s19, 3
s_add_u32 s45, s45, 1
s_lshr_b32 s45, s45, 1
s_min_u32 s45, s45, 3
s_add_u32 s17, s17, s45
s_min_u32 s17, s17, 56
L_ad_4b_A:
s_mov_b32 s19, s3
s_cmp_lt_u32 s19, 1
s_cbranch_scc0 L_ad_5a_A
s_lshr_b32 s45, s16, 3
s_add_u32 s45, s45, 1
s_max_u32 s16, s16, s45
s_sub_u32 s16, s16, s45
s_branch L_ad_5b_A
L_ad_5a_A:
s_cmp_gt_u32 s19, 3
s_cbranch_scc0 L_ad_5b_A
s_sub_u32 s45, s19, 3
s_add_u32 s45, s45, 1
s_lshr_b32 s45, s45, 1
s_min_u32 s45, s45, 3
s_add_u32 s16, s16, s45
s_min_u32 s16, s16, 56
L_ad_5b_A:
s_branch L_nored_A
L_owner_A:
ds_read_b128 v[92:95], v11 offset:18432
ds_read_b128 v[96:99], v11 offset:18944
ds_read_b128 v[100:103], v11 offset:19456
ds_read_b128 v[104:107], v11 offset:19968
s_waitcnt lgkmcnt(0)
v_pk_add_f32 v[92:93], v[92:93], v[96:97]
v_pk_add_f32 v[100:101], v[100:101], v[104:105]
v_pk_add_f32 v[94:95], v[94:95], v[98:99]
v_pk_add_f32 v[102:103], v[102:103], v[106:107]
v_pk_add_f32 v[92:93], v[92:93], v[100:101]
v_pk_add_f32 v[94:95], v[94:95], v[102:103]
v_min_u32 v92, s57, v92
s_mov_b64 exec, s[52:53]
buffer_store_dwordx4 v[92:95], v19, s[20:23], s41 offen sc1
buffer_store_dwordx4 v[24:27], v19, s[20:23], s42 offen sc1
s_mov_b64 exec, -1
s_mov_b32 s19, s11
s_cmp_lt_u32 s19, 1
s_cbranch_scc0 L_ad_6a_A
s_lshr_b32 s45, s17, 3
s_add_u32 s45, s45, 1
s_max_u32 s17, s17, s45
s_sub_u32 s17, s17, s45
s_branch L_ad_6b_A
L_ad_6a_A:
s_cmp_gt_u32 s19, 3
s_cbranch_scc0 L_ad_6b_A
s_sub_u32 s45, s19, 3
s_add_u32 s45, s45, 1
s_lshr_b32 s45, s45, 1
s_min_u32 s45, s45, 3
s_add_u32 s17, s17, s45
s_min_u32 s17, s17, 56
L_ad_6b_A:
s_mov_b32 s19, s3
s_cmp_lt_u32 s19, 1
s_cbranch_scc0 L_ad_7a_A
s_lshr_b32 s45, s16, 3
s_add_u32 s45, s45, 1
s_max_u32 s16, s16, s45
s_sub_u32 s16, s16, s45
s_branch L_ad_7b_A
L_ad_7a_A:
s_cmp_gt_u32 s19, 3
s_cbranch_scc0 L_ad_7b_A
s_sub_u32 s45, s19, 3
s_add_u32 s45, s45, 1
s_lshr_b32 s45, s45, 1
s_min_u32 s45, s45, 3
s_add_u32 s16, s16, s45
s_min_u32 s16, s16, 56
L_ad_7b_A:
s_sleep 11
s_mov_b32 s19, 0
buffer_load_dwordx4 v[152:155], v20, s[20:23], s41 offen offset:0 sc1
buffer_load_dwordx4 v[156:159], v20, s[20:23], s41 offen offset:1024 sc1
buffer_load_dwordx4 v[160:163], v20, s[20:23], s41 offen offset:2048 sc1
buffer_load_dwordx4 v[164:167], v20, s[20:23], s41 offen offset:3072 sc1
s_branch L_pg_w_A
L_pg_retry_A:
s_add_u32 s19, s19, 1
s_add_u32 s60, s60, 1
s_cmp_gt_u32 s60, 400000
s_cbranch_scc1 L_rec_fail_A
buffer_load_dwordx4 v[152:155], v20, s[20:23], s41 offen offset:0 sc1
buffer_load_dwordx4 v[156:159], v20, s[20:23], s41 offen offset:1024 sc1
buffer_load_dwordx4 v[160:163], v20, s[20:23], s41 offen offset:2048 sc1
buffer_load_dwordx4 v[164:167], v20, s[20:23], s41 offen offset:3072 sc1
L_pg_w_A:
s_waitcnt vmcnt(0)
v_max3_u32 v28, v152, v156, v160
v_max_u32 v28, v28, v164
v_cmp_eq_u32 vcc, -1, v28
s_cbranch_vccnz L_pg_retry_A
s_nop 3
L_skipg_A:
v_pk_add_f32 v[184:185], v[152:153], v[156:157]
v_pk_add_f32 v[188:189], v[160:161], v[164:165]
v_pk_add_f32 v[186:187], v[154:155], v[158:159]
v_pk_add_f32 v[190:191], v[162:163], v[166:167]
v_pk_add_f32 v[184:185], v[184:185], v[188:189]
v_pk_add_f32 v[186:187], v[186:187], v[190:191]
v_mov_b64 v[188:189], v[184:185]
v_mov_b64 v[190:191], v[186:187]
s_nop 0
v_permlane32_swap_b32 v184, v188
v_permlane32_swap_b32 v185, v189
v_permlane32_swap_b32 v186, v190
v_permlane32_swap_b32 v187, v191
v_pk_add_f32 v[184:185], v[184:185], v[188:189]
v_pk_add_f32 v[186:187], v[186:187], v[190:191]
v_cvt_pk_bf16_f32 v28, v184, v185
v_cvt_pk_bf16_f32 v29, v186, v187
v_min_u32 v28, s57, v28
s_mov_b64 exec, s[52:53]
buffer_store_dwordx2 v[28:29], v21, s[20:23], s35 offen
buffer_store_dwordx2 v[24:25], v21, s[20:23], s36 offen
s_mov_b64 exec, -1
L_nored_A:
s_cmp_lt_u32 s33, 64
s_cbranch_scc1 L_step_A
s_branch L_rec_done_A
L_rec_fail_A:
s_mov_b64 exec, 1
v_mov_b32 v28, 0xdead
v_mov_b32 v29, 128
global_store_dword v29, v28, s[6:7]
s_waitcnt vmcnt(0)
L_rec_done_A:
s_endpgm
L_worker_A:
s_load_dwordx4 s[8:11], s[0:1], 16
s_load_dwordx4 s[12:15], s[0:1], 32
s_load_dwordx4 s[16:19], s[0:1], 64
s_load_dwordx4 s[68:71], s[0:1], 80
s_load_dwordx2 s[72:73], s[0:1], 0
s_load_dwordx2 s[74:75], s[0:1], 96
s_waitcnt lgkmcnt(0)
s_sub_u32 s63, s30, 16
s_mov_b32 s48, 0
s_mov_b32 s64, 0
v_mov_b32 v16, 1
s_mov_b32 s92, 0
s_lshl_b32 s47, s28, 11
s_mul_i32 s46, s28, 3072
s_add_u32 s46, s46, 16384
v_lshrrev_b32 v19, 2, v1
v_and_b32 v4, 3, v1
v_lshrrev_b32 v5, 4, v1
v_xor_b32 v4, v4, v5
v_lshlrev_b32 v20, 4, v4
s_mul_i32 s40, s28, 192
s_add_u32 s40, s40, 0
v_add_u32 v4, s40, v1
s_mov_b32 s41, 43691
v_mul_u32_u24 v5, s41, v4
v_lshrrev_b32 v25, 20, v5
v_mul_u32_u24 v5, 24, v25
v_sub_u32 v5, v4, v5
v_bfe_u32 v6, v25, 1, 1
v_lshlrev_b32 v6, 2, v6
v_xor_b32 v5, v5, v6
v_lshlrev_b32 v28, 4, v5
s_mul_i32 s40, s28, 192
s_add_u32 s40, s40, 64
v_add_u32 v4, s40, v1
s_mov_b32 s41, 43691
v_mul_u32_u24 v5, s41, v4
v_lshrrev_b32 v26, 20, v5
v_mul_u32_u24 v5, 24, v26
v_sub_u32 v5, v4, v5
v_bfe_u32 v6, v26, 1, 1
v_lshlrev_b32 v6, 2, v6
v_xor_b32 v5, v5, v6
v_lshlrev_b32 v29, 4, v5
s_mul_i32 s40, s28, 192
s_add_u32 s40, s40, 128
v_add_u32 v4, s40, v1
s_mov_b32 s41, 43691
v_mul_u32_u24 v5, s41, v4
v_lshrrev_b32 v27, 20, v5
v_mul_u32_u24 v5, 24, v27
v_sub_u32 v5, v4, v5
v_bfe_u32 v6, v27, 1, 1
v_lshlrev_b32 v6, 2, v6
v_xor_b32 v5, v5, v6
v_lshlrev_b32 v30, 4, v5
v_and_b32 v4, 31, v1
v_lshrrev_b32 v5, 5, v1
v_bfe_u32 v6, v4, 2, 2
s_lshr_b32 s40, s28, 1
s_mul_i32 s40, s40, 4096
v_add_u32 v7, 0, v5
v_xor_b32 v7, v7, v6
v_lshlrev_b32 v7, 4, v7
v_lshl_add_u32 v7, v4, 6, v7
v_add_u32 v34, s40, v7
v_add_u32 v7, 2, v5
v_xor_b32 v7, v7, v6
v_lshlrev_b32 v7, 4, v7
v_lshl_add_u32 v7, v4, 6, v7
v_add_u32 v35, s40, v7
v_and_b32 v4, 15, v1
v_lshrrev_b32 v5, 4, v1
v_and_b32 v6, 1, v5
v_lshrrev_b32 v5, 1, v5
v_bfe_u32 v7, v4, 1, 1
v_lshl_add_u32 v6, v6, 1, v7
s_and_b32 s40, s28, 1
s_mul_i32 s40, s40, 12
v_add_u32 v6, s40, v6
v_bfe_u32 v8, v4, 3, 1
v_lshlrev_b32 v8, 2, v8
v_and_b32 v9, 1, v4
v_lshlrev_b32 v9, 3, v9
v_lshrrev_b32 v10, 2, v4
v_lshlrev_b32 v11, 3, v5
v_add_u32 v11, 0, v11
v_add_u32 v11, v11, v10
v_mul_u32_u24 v11, 384, v11
v_add_u32 v11, v11, v9
v_add_u32 v12, 0, v6
v_xor_b32 v12, v12, v8
v_lshl_add_u32 v36, v12, 4, v11
v_add_u32 v36, 16384, v36
v_add_u32 v12, 4, v6
v_xor_b32 v12, v12, v8
v_lshl_add_u32 v40, v12, 4, v11
v_add_u32 v40, 16384, v40
v_lshlrev_b32 v11, 3, v5
v_add_u32 v11, 4, v11
v_add_u32 v11, v11, v10
v_mul_u32_u24 v11, 384, v11
v_add_u32 v11, v11, v9
v_add_u32 v12, 0, v6
v_xor_b32 v12, v12, v8
v_lshl_add_u32 v37, v12, 4, v11
v_add_u32 v37, 16384, v37
v_add_u32 v12, 4, v6
v_xor_b32 v12, v12, v8
v_lshl_add_u32 v41, v12, 4, v11
v_add_u32 v41, 16384, v41
v_lshlrev_b32 v11, 3, v5
v_add_u32 v11, 16, v11
v_add_u32 v11, v11, v10
v_mul_u32_u24 v11, 384, v11
v_add_u32 v11, v11, v9
v_add_u32 v12, 0, v6
v_xor_b32 v12, v12, v8
v_lshl_add_u32 v38, v12, 4, v11
v_add_u32 v38, 16384, v38
v_add_u32 v12, 4, v6
v_xor_b32 v12, v12, v8
v_lshl_add_u32 v42, v12, 4, v11
v_add_u32 v42, 16384, v42
v_lshlrev_b32 v11, 3, v5
v_add_u32 v11, 20, v11
v_add_u32 v11, v11, v10
v_mul_u32_u24 v11, 384, v11
v_add_u32 v11, v11, v9
v_add_u32 v12, 0, v6
v_xor_b32 v12, v12, v8
v_lshl_add_u32 v39, v12, 4, v11
v_add_u32 v39, 16384, v39
v_add_u32 v12, 4, v6
v_xor_b32 v12, v12, v8
v_lshl_add_u32 v43, v12, 4, v11
v_add_u32 v43, 16384, v43
v_add_u32 v84, 57344, v34
v_add_u32 v85, 57344, v35
v_add_u32 v86, 57344, v36
v_add_u32 v87, 57344, v37
v_add_u32 v88, 57344, v38
v_add_u32 v89, 57344, v39
v_add_u32 v90, 57344, v40
v_add_u32 v91, 57344, v41
v_add_u32 v92, 57344, v42
v_add_u32 v93, 57344, v43
v_bfe_u32 v4, v1, 4, 1
v_lshrrev_b32 v5, 5, v1
v_and_b32 v6, 15, v1
v_lshlrev_b32 v7, 8, v5
v_lshl_add_u32 v7, v6, 4, v7
v_mul_u32_u24 v8, 6144, v4
v_add_u32 v94, v8, v7
v_lshl_add_u32 v95, v4, 10, v7
s_lshr_b32 s62, s63, 3
s_and_b32 s60, s63, 7
s_lshr_b32 s58, s60, 2
s_and_b32 s60, s60, 3
s_lshl_b32 s59, s29, 2
s_add_u32 s59, s59, s60
s_mov_b32 s56, 12288
s_mov_b32 s34, 7864320
s_mov_b32 s35, 0x00020000
s_cmp_eq_u32 s58, 1
s_cselect_b32 s32, s12, s10
s_cselect_b32 s33, s13, s11
s_lshl_b32 s57, s56, 5
s_mul_i32 s54, s59, 384
s_lshl_b32 s53, s62, 13
s_add_u32 s53, s53, 90910720
s_mul_i32 s40, s28, 2048
s_add_u32 s40, s40, 0
v_lshlrev_b32 v4, 4, v1
v_add_u32 v21, s40, v4
s_mul_i32 s40, s28, 2048
s_add_u32 s40, s40, 1024
v_lshlrev_b32 v4, 4, v1
v_add_u32 v22, s40, v4
v_mul_lo_u32 v4, v25, s56
v_add_u32 v31, v4, v28
v_mul_lo_u32 v4, v26, s56
v_add_u32 v32, v4, v29
v_mul_lo_u32 v4, v27, s56
v_add_u32 v33, v4, v30
s_cmp_eq_u32 s58, 1
s_cbranch_scc1 L_h_v_A
s_add_u32 m0, s47, 0
s_nop 0
buffer_load_dwordx4 v21, s[20:23], s53 offen lds
s_add_u32 m0, s47, 1024
s_nop 0
buffer_load_dwordx4 v22, s[20:23], s53 offen lds
s_add_u32 m0, s46, 0
s_nop 0
buffer_load_dwordx4 v31, s[32:35], s54 offen lds
s_add_u32 m0, s46, 1024
s_nop 0
buffer_load_dwordx4 v32, s[32:35], s54 offen lds
s_add_u32 m0, s46, 2048
s_nop 0
buffer_load_dwordx4 v33, s[32:35], s54 offen lds
s_add_u32 s53, s53, 16384
s_add_u32 s54, s54, s57
s_add_u32 m0, s47, 28672
s_nop 0
buffer_load_dwordx4 v21, s[20:23], s53 offen lds
s_add_u32 m0, s47, 29696
s_nop 0
buffer_load_dwordx4 v22, s[20:23], s53 offen lds
s_add_u32 m0, s46, 28672
s_nop 0
buffer_load_dwordx4 v31, s[32:35], s54 offen lds
s_add_u32 m0, s46, 29696
s_nop 0
buffer_load_dwordx4 v32, s[32:35], s54 offen lds
s_add_u32 m0, s46, 30720
s_nop 0
buffer_load_dwordx4 v33, s[32:35], s54 offen lds
s_add_u32 s53, s53, 16384
s_add_u32 s54, s54, s57
s_add_u32 m0, s47, 57344
s_nop 0
buffer_load_dwordx4 v21, s[20:23], s53 offen lds
s_add_u32 m0, s47, 58368
s_nop 0
buffer_load_dwordx4 v22, s[20:23], s53 offen lds
s_add_u32 m0, s46, 57344
s_nop 0
buffer_load_dwordx4 v31, s[32:35], s54 offen lds
s_add_u32 m0, s46, 58368
s_nop 0
buffer_load_dwordx4 v32, s[32:35], s54 offen lds
s_add_u32 m0, s46, 59392
s_nop 0
buffer_load_dwordx4 v33, s[32:35], s54 offen lds
s_add_u32 s53, s53, 16384
s_add_u32 s54, s54, s57
s_add_u32 m0, s47, 86016
s_nop 0
buffer_load_dwordx4 v21, s[20:23], s53 offen lds
s_add_u32 m0, s47, 87040
s_nop 0
buffer_load_dwordx4 v22, s[20:23], s53 offen lds
s_add_u32 m0, s46, 86016
s_nop 0
buffer_load_dwordx4 v31, s[32:35], s54 offen lds
s_add_u32 m0, s46, 87040
s_nop 0
buffer_load_dwordx4 v32, s[32:35], s54 offen lds
s_add_u32 m0, s46, 88064
s_nop 0
buffer_load_dwordx4 v33, s[32:35], s54 offen lds
s_add_u32 s53, s53, 16384
s_add_u32 s54, s54, s57
s_waitcnt vmcnt(15)
s_barrier
ds_read_b128 v[44:47], v34 offset:0
ds_read_b128 v[48:51], v34 offset:2048
ds_read_b64_tr_b16 v[60:61], v36 offset:0
ds_read_b64_tr_b16 v[62:63], v37 offset:0
ds_read_b64_tr_b16 v[64:65], v40 offset:0
ds_read_b64_tr_b16 v[66:67], v41 offset:0
ds_read_b64_tr_b16 v[68:69], v36 offset:128
ds_read_b64_tr_b16 v[70:71], v37 offset:128
s_waitcnt lgkmcnt(0)
v_mfma_f32_32x32x16_bf16 a[0:15], v[60:63], v[44:47], 0
ds_read_b128 v[52:55], v35 offset:0
v_mfma_f32_32x32x16_bf16 a[16:31], v[64:67], v[44:47], 0
ds_read_b128 v[56:59], v35 offset:2048
v_mfma_f32_32x32x16_bf16 a[32:47], v[68:71], v[44:47], 0
ds_read_b64_tr_b16 v[72:73], v38 offset:0
ds_read_b64_tr_b16 v[74:75], v39 offset:0
v_mfma_f32_32x32x16_bf16 a[48:63], v[60:63], v[48:51], 0
ds_read_b64_tr_b16 v[76:77], v42 offset:0
ds_read_b64_tr_b16 v[78:79], v43 offset:0
v_mfma_f32_32x32x16_bf16 a[64:79], v[64:67], v[48:51], 0
ds_read_b64_tr_b16 v[80:81], v38 offset:128
ds_read_b64_tr_b16 v[82:83], v39 offset:128
v_mfma_f32_32x32x16_bf16 a[80:95], v[68:71], v[48:51], 0
s_waitcnt lgkmcnt(0)
s_waitcnt vmcnt(10)
s_barrier
v_mfma_f32_32x32x16_bf16 a[0:15], v[72:75], v[52:55], a[0:15]
ds_read_b128 v[44:47], v34 offset:28672
ds_read_b128 v[48:51], v34 offset:30720
v_mfma_f32_32x32x16_bf16 a[16:31], v[76:79], v[52:55], a[16:31]
ds_read_b64_tr_b16 v[60:61], v36 offset:28672
ds_read_b64_tr_b16 v[62:63], v37 offset:28672
ds_read_b64_tr_b16 v[64:65], v40 offset:28672
ds_read_b64_tr_b16 v[66:67], v41 offset:28672
v_mfma_f32_32x32x16_bf16 a[32:47], v[80:83], v[52:55], a[32:47]
ds_read_b64_tr_b16 v[68:69], v36 offset:28800
ds_read_b64_tr_b16 v[70:71], v37 offset:28800
s_add_u32 m0, s47, 0
s_nop 0
buffer_load_dwordx4 v21, s[20:23], s53 offen lds
v_mfma_f32_32x32x16_bf16 a[48:63], v[72:75], v[56:59], a[48:63]
s_add_u32 m0, s47, 1024
s_nop 0
buffer_load_dwordx4 v22, s[20:23], s53 offen lds
s_add_u32 m0, s46, 0
s_nop 0
buffer_load_dwordx4 v31, s[32:35], s54 offen lds
v_mfma_f32_32x32x16_bf16 a[64:79], v[76:79], v[56:59], a[64:79]
s_add_u32 m0, s46, 1024
s_nop 0
buffer_load_dwordx4 v32, s[32:35], s54 offen lds
s_add_u32 m0, s46, 2048
s_nop 0
buffer_load_dwordx4 v33, s[32:35], s54 offen lds
s_add_u32 s53, s53, 16384
s_add_u32 s54, s54, s57
v_mfma_f32_32x32x16_bf16 a[80:95], v[80:83], v[56:59], a[80:95]
s_waitcnt lgkmcnt(0)
v_mfma_f32_32x32x16_bf16 a[0:15], v[60:63], v[44:47], a[0:15]
ds_read_b128 v[52:55], v35 offset:28672
v_mfma_f32_32x32x16_bf16 a[16:31], v[64:67], v[44:47], a[16:31]
ds_read_b128 v[56:59], v35 offset:30720
v_mfma_f32_32x32x16_bf16 a[32:47], v[68:71], v[44:47], a[32:47]
ds_read_b64_tr_b16 v[72:73], v38 offset:28672
ds_read_b64_tr_b16 v[74:75], v39 offset:28672
v_mfma_f32_32x32x16_bf16 a[48:63], v[60:63], v[48:51], a[48:63]
ds_read_b64_tr_b16 v[76:77], v42 offset:28672
ds_read_b64_tr_b16 v[78:79], v43 offset:28672
v_mfma_f32_32x32x16_bf16 a[64:79], v[64:67], v[48:51], a[64:79]
ds_read_b64_tr_b16 v[80:81], v38 offset:28800
ds_read_b64_tr_b16 v[82:83], v39 offset:28800
v_mfma_f32_32x32x16_bf16 a[80:95], v[68:71], v[48:51], a[80:95]
s_waitcnt lgkmcnt(0)
s_waitcnt vmcnt(10)
s_barrier
v_mfma_f32_32x32x16_bf16 a[0:15], v[72:75], v[52:55], a[0:15]
ds_read_b128 v[44:47], v84 offset:0
ds_read_b128 v[48:51], v84 offset:2048
v_mfma_f32_32x32x16_bf16 a[16:31], v[76:79], v[52:55], a[16:31]
ds_read_b64_tr_b16 v[60:61], v86 offset:0
ds_read_b64_tr_b16 v[62:63], v87 offset:0
ds_read_b64_tr_b16 v[64:65], v90 offset:0
ds_read_b64_tr_b16 v[66:67], v91 offset:0
v_mfma_f32_32x32x16_bf16 a[32:47], v[80:83], v[52:55], a[32:47]
ds_read_b64_tr_b16 v[68:69], v86 offset:128
ds_read_b64_tr_b16 v[70:71], v87 offset:128
s_add_u32 m0, s47, 28672
s_nop 0
buffer_load_dwordx4 v21, s[20:23], s53 offen lds
v_mfma_f32_32x32x16_bf16 a[48:63], v[72:75], v[56:59], a[48:63]
s_add_u32 m0, s47, 29696
s_nop 0
buffer_load_dwordx4 v22, s[20:23], s53 offen lds
s_add_u32 m0, s46, 28672
s_nop 0
buffer_load_dwordx4 v31, s[32:35], s54 offen lds
v_mfma_f32_32x32x16_bf16 a[64:79], v[76:79], v[56:59], a[64:79]
s_add_u32 m0, s46, 29696
s_nop 0
buffer_load_dwordx4 v32, s[32:35], s54 offen lds
s_add_u32 m0, s46, 30720
s_nop 0
buffer_load_dwordx4 v33, s[32:35], s54 offen lds
s_add_u32 s53, s53, 16384
s_add_u32 s54, s54, s57
v_mfma_f32_32x32x16_bf16 a[80:95], v[80:83], v[56:59], a[80:95]
s_waitcnt lgkmcnt(0)
v_mfma_f32_32x32x16_bf16 a[0:15], v[60:63], v[44:47], a[0:15]
ds_read_b128 v[52:55], v85 offset:0
v_mfma_f32_32x32x16_bf16 a[16:31], v[64:67], v[44:47], a[16:31]
ds_read_b128 v[56:59], v85 offset:2048
v_mfma_f32_32x32x16_bf16 a[32:47], v[68:71], v[44:47], a[32:47]
ds_read_b64_tr_b16 v[72:73], v88 offset:0
ds_read_b64_tr_b16 v[74:75], v89 offset:0
v_mfma_f32_32x32x16_bf16 a[48:63], v[60:63], v[48:51], a[48:63]
ds_read_b64_tr_b16 v[76:77], v92 offset:0
ds_read_b64_tr_b16 v[78:79], v93 offset:0
v_mfma_f32_32x32x16_bf16 a[64:79], v[64:67], v[48:51], a[64:79]
ds_read_b64_tr_b16 v[80:81], v88 offset:128
ds_read_b64_tr_b16 v[82:83], v89 offset:128
v_mfma_f32_32x32x16_bf16 a[80:95], v[68:71], v[48:51], a[80:95]
s_waitcnt lgkmcnt(0)
s_waitcnt vmcnt(10)
s_barrier
v_mfma_f32_32x32x16_bf16 a[0:15], v[72:75], v[52:55], a[0:15]
ds_read_b128 v[44:47], v84 offset:28672
ds_read_b128 v[48:51], v84 offset:30720
v_mfma_f32_32x32x16_bf16 a[16:31], v[76:79], v[52:55], a[16:31]
ds_read_b64_tr_b16 v[60:61], v86 offset:28672
ds_read_b64_tr_b16 v[62:63], v87 offset:28672
ds_read_b64_tr_b16 v[64:65], v90 offset:28672
ds_read_b64_tr_b16 v[66:67], v91 offset:28672
v_mfma_f32_32x32x16_bf16 a[32:47], v[80:83], v[52:55], a[32:47]
ds_read_b64_tr_b16 v[68:69], v86 offset:28800
ds_read_b64_tr_b16 v[70:71], v87 offset:28800
s_add_u32 m0, s47, 57344
s_nop 0
buffer_load_dwordx4 v21, s[20:23], s53 offen lds
v_mfma_f32_32x32x16_bf16 a[48:63], v[72:75], v[56:59], a[48:63]
s_add_u32 m0, s47, 58368
s_nop 0
buffer_load_dwordx4 v22, s[20:23], s53 offen lds
s_add_u32 m0, s46, 57344
s_nop 0
buffer_load_dwordx4 v31, s[32:35], s54 offen lds
v_mfma_f32_32x32x16_bf16 a[64:79], v[76:79], v[56:59], a[64:79]
s_add_u32 m0, s46, 58368
s_nop 0
buffer_load_dwordx4 v32, s[32:35], s54 offen lds
s_add_u32 m0, s46, 59392
s_nop 0
buffer_load_dwordx4 v33, s[32:35], s54 offen lds
s_add_u32 s53, s53, 16384
s_add_u32 s54, s54, s57
v_mfma_f32_32x32x16_bf16 a[80:95], v[80:83], v[56:59], a[80:95]
s_waitcnt lgkmcnt(0)
v_mfma_f32_32x32x16_bf16 a[0:15], v[60:63], v[44:47], a[0:15]
ds_read_b128 v[52:55], v85 offset:28672
v_mfma_f32_32x32x16_bf16 a[16:31], v[64:67], v[44:47], a[16:31]
ds_read_b128 v[56:59], v85 offset:30720
v_mfma_f32_32x32x16_bf16 a[32:47], v[68:71], v[44:47], a[32:47]
ds_read_b64_tr_b16 v[72:73], v88 offset:28672
ds_read_b64_tr_b16 v[74:75], v89 offset:28672
v_mfma_f32_32x32x16_bf16 a[48:63], v[60:63], v[48:51], a[48:63]
ds_read_b64_tr_b16 v[76:77], v92 offset:28672
ds_read_b64_tr_b16 v[78:79], v93 offset:28672
v_mfma_f32_32x32x16_bf16 a[64:79], v[64:67], v[48:51], a[64:79]
ds_read_b64_tr_b16 v[80:81], v88 offset:28800
ds_read_b64_tr_b16 v[82:83], v89 offset:28800
v_mfma_f32_32x32x16_bf16 a[80:95], v[68:71], v[48:51], a[80:95]
s_waitcnt lgkmcnt(0)
s_waitcnt vmcnt(10)
s_barrier
v_mfma_f32_32x32x16_bf16 a[0:15], v[72:75], v[52:55], a[0:15]
ds_read_b128 v[44:47], v34 offset:0
ds_read_b128 v[48:51], v34 offset:2048
v_mfma_f32_32x32x16_bf16 a[16:31], v[76:79], v[52:55], a[16:31]
ds_read_b64_tr_b16 v[60:61], v36 offset:0
ds_read_b64_tr_b16 v[62:63], v37 offset:0
ds_read_b64_tr_b16 v[64:65], v40 offset:0
ds_read_b64_tr_b16 v[66:67], v41 offset:0
v_mfma_f32_32x32x16_bf16 a[32:47], v[80:83], v[52:55], a[32:47]
ds_read_b64_tr_b16 v[68:69], v36 offset:128
ds_read_b64_tr_b16 v[70:71], v37 offset:128
s_add_u32 m0, s47, 86016
s_nop 0
buffer_load_dwordx4 v21, s[20:23], s53 offen lds
v_mfma_f32_32x32x16_bf16 a[48:63], v[72:75], v[56:59], a[48:63]
s_add_u32 m0, s47, 87040
s_nop 0
buffer_load_dwordx4 v22, s[20:23], s53 offen lds
s_add_u32 m0, s46, 86016
s_nop 0
buffer_load_dwordx4 v31, s[32:35], s54 offen lds
v_mfma_f32_32x32x16_bf16 a[64:79], v[76:79], v[56:59], a[64:79]
s_add_u32 m0, s46, 87040
s_nop 0
buffer_load_dwordx4 v32, s[32:35], s54 offen lds
s_add_u32 m0, s46, 88064
s_nop 0
buffer_load_dwordx4 v33, s[32:35], s54 offen lds
s_add_u32 s53, s53, 16384
s_add_u32 s54, s54, s57
v_mfma_f32_32x32x16_bf16 a[80:95], v[80:83], v[56:59], a[80:95]
s_mov_b32 s42, 3
s_cmp_eq_u32 s42, 0
s_cbranch_scc1 L_h_wx_last_A
s_nop 8
L_h_wx_A:
s_waitcnt lgkmcnt(0)
v_mfma_f32_32x32x16_bf16 a[0:15], v[60:63], v[44:47], a[0:15]
ds_read_b128 v[52:55], v35 offset:0
v_mfma_f32_32x32x16_bf16 a[16:31], v[64:67], v[44:47], a[16:31]
ds_read_b128 v[56:59], v35 offset:2048
v_mfma_f32_32x32x16_bf16 a[32:47], v[68:71], v[44:47], a[32:47]
ds_read_b64_tr_b16 v[72:73], v38 offset:0
ds_read_b64_tr_b16 v[74:75], v39 offset:0
v_mfma_f32_32x32x16_bf16 a[48:63], v[60:63], v[48:51], a[48:63]
ds_read_b64_tr_b16 v[76:77], v42 offset:0
ds_read_b64_tr_b16 v[78:79], v43 offset:0
v_mfma_f32_32x32x16_bf16 a[64:79], v[64:67], v[48:51], a[64:79]
ds_read_b64_tr_b16 v[80:81], v38 offset:128
ds_read_b64_tr_b16 v[82:83], v39 offset:128
v_mfma_f32_32x32x16_bf16 a[80:95], v[68:71], v[48:51], a[80:95]
s_waitcnt lgkmcnt(0)
s_waitcnt vmcnt(10)
s_barrier
v_mfma_f32_32x32x16_bf16 a[0:15], v[72:75], v[52:55], a[0:15]
ds_read_b128 v[44:47], v34 offset:28672
ds_read_b128 v[48:51], v34 offset:30720
v_mfma_f32_32x32x16_bf16 a[16:31], v[76:79], v[52:55], a[16:31]
ds_read_b64_tr_b16 v[60:61], v36 offset:28672
ds_read_b64_tr_b16 v[62:63], v37 offset:28672
ds_read_b64_tr_b16 v[64:65], v40 offset:28672
ds_read_b64_tr_b16 v[66:67], v41 offset:28672
v_mfma_f32_32x32x16_bf16 a[32:47], v[80:83], v[52:55], a[32:47]
ds_read_b64_tr_b16 v[68:69], v36 offset:28800
ds_read_b64_tr_b16 v[70:71], v37 offset:28800
s_add_u32 m0, s47, 0
s_nop 0
buffer_load_dwordx4 v21, s[20:23], s53 offen lds
v_mfma_f32_32x32x16_bf16 a[48:63], v[72:75], v[56:59], a[48:63]
s_add_u32 m0, s47, 1024
s_nop 0
buffer_load_dwordx4 v22, s[20:23], s53 offen lds
s_add_u32 m0, s46, 0
s_nop 0
buffer_load_dwordx4 v31, s[32:35], s54 offen lds
v_mfma_f32_32x32x16_bf16 a[64:79], v[76:79], v[56:59], a[64:79]
s_add_u32 m0, s46, 1024
s_nop 0
buffer_load_dwordx4 v32, s[32:35], s54 offen lds
s_add_u32 m0, s46, 2048
s_nop 0
buffer_load_dwordx4 v33, s[32:35], s54 offen lds
s_add_u32 s53, s53, 16384
s_add_u32 s54, s54, s57
v_mfma_f32_32x32x16_bf16 a[80:95], v[80:83], v[56:59], a[80:95]
s_waitcnt lgkmcnt(0)
v_mfma_f32_32x32x16_bf16 a[0:15], v[60:63], v[44:47], a[0:15]
ds_read_b128 v[52:55], v35 offset:28672
v_mfma_f32_32x32x16_bf16 a[16:31], v[64:67], v[44:47], a[16:31]
ds_read_b128 v[56:59], v35 offset:30720
v_mfma_f32_32x32x16_bf16 a[32:47], v[68:71], v[44:47], a[32:47]
ds_read_b64_tr_b16 v[72:73], v38 offset:28672
ds_read_b64_tr_b16 v[74:75], v39 offset:28672
v_mfma_f32_32x32x16_bf16 a[48:63], v[60:63], v[48:51], a[48:63]
ds_read_b64_tr_b16 v[76:77], v42 offset:28672
ds_read_b64_tr_b16 v[78:79], v43 offset:28672
v_mfma_f32_32x32x16_bf16 a[64:79], v[64:67], v[48:51], a[64:79]
ds_read_b64_tr_b16 v[80:81], v38 offset:28800
ds_read_b64_tr_b16 v[82:83], v39 offset:28800
v_mfma_f32_32x32x16_bf16 a[80:95], v[68:71], v[48:51], a[80:95]
s_waitcnt lgkmcnt(0)
s_waitcnt vmcnt(10)
s_barrier
v_mfma_f32_32x32x16_bf16 a[0:15], v[72:75], v[52:55], a[0:15]
ds_read_b128 v[44:47], v84 offset:0
ds_read_b128 v[48:51], v84 offset:2048
v_mfma_f32_32x32x16_bf16 a[16:31], v[76:79], v[52:55], a[16:31]
ds_read_b64_tr_b16 v[60:61], v86 offset:0
ds_read_b64_tr_b16 v[62:63], v87 offset:0
ds_read_b64_tr_b16 v[64:65], v90 offset:0
ds_read_b64_tr_b16 v[66:67], v91 offset:0
v_mfma_f32_32x32x16_bf16 a[32:47], v[80:83], v[52:55], a[32:47]
ds_read_b64_tr_b16 v[68:69], v86 offset:128
ds_read_b64_tr_b16 v[70:71], v87 offset:128
s_add_u32 m0, s47, 28672
s_nop 0
buffer_load_dwordx4 v21, s[20:23], s53 offen lds
v_mfma_f32_32x32x16_bf16 a[48:63], v[72:75], v[56:59], a[48:63]
s_add_u32 m0, s47, 29696
s_nop 0
buffer_load_dwordx4 v22, s[20:23], s53 offen lds
s_add_u32 m0, s46, 28672
s_nop 0
buffer_load_dwordx4 v31, s[32:35], s54 offen lds
v_mfma_f32_32x32x16_bf16 a[64:79], v[76:79], v[56:59], a[64:79]
s_add_u32 m0, s46, 29696
s_nop 0
buffer_load_dwordx4 v32, s[32:35], s54 offen lds
s_add_u32 m0, s46, 30720
s_nop 0
buffer_load_dwordx4 v33, s[32:35], s54 offen lds
s_add_u32 s53, s53, 16384
s_add_u32 s54, s54, s57
v_mfma_f32_32x32x16_bf16 a[80:95], v[80:83], v[56:59], a[80:95]
s_waitcnt lgkmcnt(0)
v_mfma_f32_32x32x16_bf16 a[0:15], v[60:63], v[44:47], a[0:15]
ds_read_b128 v[52:55], v85 offset:0
v_mfma_f32_32x32x16_bf16 a[16:31], v[64:67], v[44:47], a[16:31]
ds_read_b128 v[56:59], v85 offset:2048
v_mfma_f32_32x32x16_bf16 a[32:47], v[68:71], v[44:47], a[32:47]
ds_read_b64_tr_b16 v[72:73], v88 offset:0
ds_read_b64_tr_b16 v[74:75], v89 offset:0
v_mfma_f32_32x32x16_bf16 a[48:63], v[60:63], v[48:51], a[48:63]
ds_read_b64_tr_b16 v[76:77], v92 offset:0
ds_read_b64_tr_b16 v[78:79], v93 offset:0
v_mfma_f32_32x32x16_bf16 a[64:79], v[64:67], v[48:51], a[64:79]
ds_read_b64_tr_b16 v[80:81], v88 offset:128
ds_read_b64_tr_b16 v[82:83], v89 offset:128
v_mfma_f32_32x32x16_bf16 a[80:95], v[68:71], v[48:51], a[80:95]
s_waitcnt lgkmcnt(0)
s_waitcnt vmcnt(10)
s_barrier
v_mfma_f32_32x32x16_bf16 a[0:15], v[72:75], v[52:55], a[0:15]
ds_read_b128 v[44:47], v84 offset:28672
ds_read_b128 v[48:51], v84 offset:30720
v_mfma_f32_32x32x16_bf16 a[16:31], v[76:79], v[52:55], a[16:31]
ds_read_b64_tr_b16 v[60:61], v86 offset:28672
ds_read_b64_tr_b16 v[62:63], v87 offset:28672
ds_read_b64_tr_b16 v[64:65], v90 offset:28672
ds_read_b64_tr_b16 v[66:67], v91 offset:28672
v_mfma_f32_32x32x16_bf16 a[32:47], v[80:83], v[52:55], a[32:47]
ds_read_b64_tr_b16 v[68:69], v86 offset:28800
ds_read_b64_tr_b16 v[70:71], v87 offset:28800
s_add_u32 m0, s47, 57344
s_nop 0
buffer_load_dwordx4 v21, s[20:23], s53 offen lds
v_mfma_f32_32x32x16_bf16 a[48:63], v[72:75], v[56:59], a[48:63]
s_add_u32 m0, s47, 58368
s_nop 0
buffer_load_dwordx4 v22, s[20:23], s53 offen lds
s_add_u32 m0, s46, 57344
s_nop 0
buffer_load_dwordx4 v31, s[32:35], s54 offen lds
v_mfma_f32_32x32x16_bf16 a[64:79], v[76:79], v[56:59], a[64:79]
s_add_u32 m0, s46, 58368
s_nop 0
buffer_load_dwordx4 v32, s[32:35], s54 offen lds
s_add_u32 m0, s46, 59392
s_nop 0
buffer_load_dwordx4 v33, s[32:35], s54 offen lds
s_add_u32 s53, s53, 16384
s_add_u32 s54, s54, s57
v_mfma_f32_32x32x16_bf16 a[80:95], v[80:83], v[56:59], a[80:95]
s_waitcnt lgkmcnt(0)
v_mfma_f32_32x32x16_bf16 a[0:15], v[60:63], v[44:47], a[0:15]
ds_read_b128 v[52:55], v85 offset:28672
v_mfma_f32_32x32x16_bf16 a[16:31], v[64:67], v[44:47], a[16:31]
ds_read_b128 v[56:59], v85 offset:30720
v_mfma_f32_32x32x16_bf16 a[32:47], v[68:71], v[44:47], a[32:47]
ds_read_b64_tr_b16 v[72:73], v88 offset:28672
ds_read_b64_tr_b16 v[74:75], v89 offset:28672
v_mfma_f32_32x32x16_bf16 a[48:63], v[60:63], v[48:51], a[48:63]
ds_read_b64_tr_b16 v[76:77], v92 offset:28672
ds_read_b64_tr_b16 v[78:79], v93 offset:28672
v_mfma_f32_32x32x16_bf16 a[64:79], v[64:67], v[48:51], a[64:79]
ds_read_b64_tr_b16 v[80:81], v88 offset:28800
ds_read_b64_tr_b16 v[82:83], v89 offset:28800
v_mfma_f32_32x32x16_bf16 a[80:95], v[68:71], v[48:51], a[80:95]
s_waitcnt lgkmcnt(0)
s_waitcnt vmcnt(10)
s_barrier
v_mfma_f32_32x32x16_bf16 a[0:15], v[72:75], v[52:55], a[0:15]
ds_read_b128 v[44:47], v34 offset:0
ds_read_b128 v[48:51], v34 offset:2048
v_mfma_f32_32x32x16_bf16 a[16:31], v[76:79], v[52:55], a[16:31]
ds_read_b64_tr_b16 v[60:61], v36 offset:0
ds_read_b64_tr_b16 v[62:63], v37 offset:0
ds_read_b64_tr_b16 v[64:65], v40 offset:0
ds_read_b64_tr_b16 v[66:67], v41 offset:0
v_mfma_f32_32x32x16_bf16 a[32:47], v[80:83], v[52:55], a[32:47]
ds_read_b64_tr_b16 v[68:69], v36 offset:128
ds_read_b64_tr_b16 v[70:71], v37 offset:128
s_add_u32 m0, s47, 86016
s_nop 0
buffer_load_dwordx4 v21, s[20:23], s53 offen lds
v_mfma_f32_32x32x16_bf16 a[48:63], v[72:75], v[56:59], a[48:63]
s_add_u32 m0, s47, 87040
s_nop 0
buffer_load_dwordx4 v22, s[20:23], s53 offen lds
s_add_u32 m0, s46, 86016
s_nop 0
buffer_load_dwordx4 v31, s[32:35], s54 offen lds
v_mfma_f32_32x32x16_bf16 a[64:79], v[76:79], v[56:59], a[64:79]
s_add_u32 m0, s46, 87040
s_nop 0
buffer_load_dwordx4 v32, s[32:35], s54 offen lds
s_add_u32 m0, s46, 88064
s_nop 0
buffer_load_dwordx4 v33, s[32:35], s54 offen lds
s_add_u32 s53, s53, 16384
s_add_u32 s54, s54, s57
v_mfma_f32_32x32x16_bf16 a[80:95], v[80:83], v[56:59], a[80:95]
s_sub_u32 s42, s42, 1
s_cmp_lg_u32 s42, 0
s_nop 9
s_cbranch_scc1 L_h_wx_A
L_h_wx_last_A:
s_waitcnt lgkmcnt(0)
v_mfma_f32_32x32x16_bf16 a[0:15], v[60:63], v[44:47], a[0:15]
ds_read_b128 v[52:55], v35 offset:0
v_mfma_f32_32x32x16_bf16 a[16:31], v[64:67], v[44:47], a[16:31]
ds_read_b128 v[56:59], v35 offset:2048
v_mfma_f32_32x32x16_bf16 a[32:47], v[68:71], v[44:47], a[32:47]
ds_read_b64_tr_b16 v[72:73], v38 offset:0
ds_read_b64_tr_b16 v[74:75], v39 offset:0
v_mfma_f32_32x32x16_bf16 a[48:63], v[60:63], v[48:51], a[48:63]
ds_read_b64_tr_b16 v[76:77], v42 offset:0
ds_read_b64_tr_b16 v[78:79], v43 offset:0
v_mfma_f32_32x32x16_bf16 a[64:79], v[64:67], v[48:51], a[64:79]
ds_read_b64_tr_b16 v[80:81], v38 offset:128
ds_read_b64_tr_b16 v[82:83], v39 offset:128
v_mfma_f32_32x32x16_bf16 a[80:95], v[68:71], v[48:51], a[80:95]
s_waitcnt lgkmcnt(0)
s_waitcnt vmcnt(10)
s_barrier
v_mfma_f32_32x32x16_bf16 a[0:15], v[72:75], v[52:55], a[0:15]
ds_read_b128 v[44:47], v34 offset:28672
v_mfma_f32_32x32x16_bf16 a[16:31], v[76:79], v[52:55], a[16:31]
ds_read_b128 v[48:51], v34 offset:30720
v_mfma_f32_32x32x16_bf16 a[32:47], v[80:83], v[52:55], a[32:47]
ds_read_b64_tr_b16 v[60:61], v36 offset:28672
ds_read_b64_tr_b16 v[62:63], v37 offset:28672
v_mfma_f32_32x32x16_bf16 a[48:63], v[72:75], v[56:59], a[48:63]
ds_read_b64_tr_b16 v[64:65], v40 offset:28672
ds_read_b64_tr_b16 v[66:67], v41 offset:28672
v_mfma_f32_32x32x16_bf16 a[64:79], v[76:79], v[56:59], a[64:79]
ds_read_b64_tr_b16 v[68:69], v36 offset:28800
ds_read_b64_tr_b16 v[70:71], v37 offset:28800
v_mfma_f32_32x32x16_bf16 a[80:95], v[80:83], v[56:59], a[80:95]
s_waitcnt lgkmcnt(0)
v_mfma_f32_32x32x16_bf16 a[0:15], v[60:63], v[44:47], a[0:15]
ds_read_b128 v[52:55], v35 offset:28672
v_mfma_f32_32x32x16_bf16 a[16:31], v[64:67], v[44:47], a[16:31]
ds_read_b128 v[56:59], v35 offset:30720
v_mfma_f32_32x32x16_bf16 a[32:47], v[68:71], v[44:47], a[32:47]
ds_read_b64_tr_b16 v[72:73], v38 offset:28672
ds_read_b64_tr_b16 v[74:75], v39 offset:28672
v_mfma_f32_32x32x16_bf16 a[48:63], v[60:63], v[48:51], a[48:63]
ds_read_b64_tr_b16 v[76:77], v42 offset:28672
ds_read_b64_tr_b16 v[78:79], v43 offset:28672
v_mfma_f32_32x32x16_bf16 a[64:79], v[64:67], v[48:51], a[64:79]
ds_read_b64_tr_b16 v[80:81], v38 offset:28800
ds_read_b64_tr_b16 v[82:83], v39 offset:28800
v_mfma_f32_32x32x16_bf16 a[80:95], v[68:71], v[48:51], a[80:95]
s_waitcnt lgkmcnt(0)
s_waitcnt vmcnt(5)
s_barrier
v_mfma_f32_32x32x16_bf16 a[0:15], v[72:75], v[52:55], a[0:15]
ds_read_b128 v[44:47], v84 offset:0
v_mfma_f32_32x32x16_bf16 a[16:31], v[76:79], v[52:55], a[16:31]
ds_read_b128 v[48:51], v84 offset:2048
v_mfma_f32_32x32x16_bf16 a[32:47], v[80:83], v[52:55], a[32:47]
ds_read_b64_tr_b16 v[60:61], v86 offset:0
ds_read_b64_tr_b16 v[62:63], v87 offset:0
v_mfma_f32_32x32x16_bf16 a[48:63], v[72:75], v[56:59], a[48:63]
ds_read_b64_tr_b16 v[64:65], v90 offset:0
ds_read_b64_tr_b16 v[66:67], v91 offset:0
v_mfma_f32_32x32x16_bf16 a[64:79], v[76:79], v[56:59], a[64:79]
ds_read_b64_tr_b16 v[68:69], v86 offset:128
ds_read_b64_tr_b16 v[70:71], v87 offset:128
v_mfma_f32_32x32x16_bf16 a[80:95], v[80:83], v[56:59], a[80:95]
s_waitcnt lgkmcnt(0)
v_mfma_f32_32x32x16_bf16 a[0:15], v[60:63], v[44:47], a[0:15]
ds_read_b128 v[52:55], v85 offset:0
v_mfma_f32_32x32x16_bf16 a[16:31], v[64:67], v[44:47], a[16:31]
ds_read_b128 v[56:59], v85 offset:2048
v_mfma_f32_32x32x16_bf16 a[32:47], v[68:71], v[44:47], a[32:47]
ds_read_b64_tr_b16 v[72:73], v88 offset:0
ds_read_b64_tr_b16 v[74:75], v89 offset:0
v_mfma_f32_32x32x16_bf16 a[48:63], v[60:63], v[48:51], a[48:63]
ds_read_b64_tr_b16 v[76:77], v92 offset:0
ds_read_b64_tr_b16 v[78:79], v93 offset:0
v_mfma_f32_32x32x16_bf16 a[64:79], v[64:67], v[48:51], a[64:79]
ds_read_b64_tr_b16 v[80:81], v88 offset:128
ds_read_b64_tr_b16 v[82:83], v89 offset:128
v_mfma_f32_32x32x16_bf16 a[80:95], v[68:71], v[48:51], a[80:95]
s_waitcnt lgkmcnt(0)
s_waitcnt vmcnt(0)
s_barrier
v_mfma_f32_32x32x16_bf16 a[0:15], v[72:75], v[52:55], a[0:15]
ds_read_b128 v[44:47], v84 offset:28672
v_mfma_f32_32x32x16_bf16 a[16:31], v[76:79], v[52:55], a[16:31]
ds_read_b128 v[48:51], v84 offset:30720
v_mfma_f32_32x32x16_bf16 a[32:47], v[80:83], v[52:55], a[32:47]
ds_read_b64_tr_b16 v[60:61], v86 offset:28672
ds_read_b64_tr_b16 v[62:63], v87 offset:28672
v_mfma_f32_32x32x16_bf16 a[48:63], v[72:75], v[56:59], a[48:63]
ds_read_b64_tr_b16 v[64:65], v90 offset:28672
ds_read_b64_tr_b16 v[66:67], v91 offset:28672
v_mfma_f32_32x32x16_bf16 a[64:79], v[76:79], v[56:59], a[64:79]
ds_read_b64_tr_b16 v[68:69], v86 offset:28800
ds_read_b64_tr_b16 v[70:71], v87 offset:28800
v_mfma_f32_32x32x16_bf16 a[80:95], v[80:83], v[56:59], a[80:95]
s_waitcnt lgkmcnt(0)
v_mfma_f32_32x32x16_bf16 a[0:15], v[60:63], v[44:47], a[0:15]
ds_read_b128 v[52:55], v85 offset:28672
v_mfma_f32_32x32x16_bf16 a[16:31], v[64:67], v[44:47], a[16:31]
ds_read_b128 v[56:59], v85 offset:30720
v_mfma_f32_32x32x16_bf16 a[32:47], v[68:71], v[44:47], a[32:47]
ds_read_b64_tr_b16 v[72:73], v88 offset:28672
ds_read_b64_tr_b16 v[74:75], v89 offset:28672
v_mfma_f32_32x32x16_bf16 a[48:63], v[60:63], v[48:51], a[48:63]
ds_read_b64_tr_b16 v[76:77], v92 offset:28672
ds_read_b64_tr_b16 v[78:79], v93 offset:28672
v_mfma_f32_32x32x16_bf16 a[64:79], v[64:67], v[48:51], a[64:79]
ds_read_b64_tr_b16 v[80:81], v88 offset:28800
ds_read_b64_tr_b16 v[82:83], v89 offset:28800
v_mfma_f32_32x32x16_bf16 a[80:95], v[68:71], v[48:51], a[80:95]
s_waitcnt lgkmcnt(0)
s_waitcnt vmcnt(0)
s_barrier
v_mfma_f32_32x32x16_bf16 a[0:15], v[72:75], v[52:55], a[0:15]
v_mfma_f32_32x32x16_bf16 a[16:31], v[76:79], v[52:55], a[16:31]
v_mfma_f32_32x32x16_bf16 a[32:47], v[80:83], v[52:55], a[32:47]
v_mfma_f32_32x32x16_bf16 a[48:63], v[72:75], v[56:59], a[48:63]
v_mfma_f32_32x32x16_bf16 a[64:79], v[76:79], v[56:59], a[64:79]
v_mfma_f32_32x32x16_bf16 a[80:95], v[80:83], v[56:59], a[80:95]
s_nop 11
s_branch L_h_epi_A
L_h_v_A:
s_add_u32 m0, s47, 0
s_nop 0
buffer_load_dwordx4 v21, s[20:23], s53 offen lds
s_add_u32 m0, s47, 1024
s_nop 0
buffer_load_dwordx4 v22, s[20:23], s53 offen lds
s_add_u32 m0, s46, 0
s_nop 0
buffer_load_dwordx4 v31, s[32:35], s54 offen lds
s_add_u32 m0, s46, 1024
s_nop 0
buffer_load_dwordx4 v32, s[32:35], s54 offen lds
s_add_u32 m0, s46, 2048
s_nop 0
buffer_load_dwordx4 v33, s[32:35], s54 offen lds
s_add_u32 s53, s53, 16384
s_add_u32 s54, s54, s57
s_add_u32 m0, s47, 28672
s_nop 0
buffer_load_dwordx4 v21, s[20:23], s53 offen lds
s_add_u32 m0, s47, 29696
s_nop 0
buffer_load_dwordx4 v22, s[20:23], s53 offen lds
s_add_u32 m0, s46, 28672
s_nop 0
buffer_load_dwordx4 v31, s[32:35], s54 offen lds
s_add_u32 m0, s46, 29696
s_nop 0
buffer_load_dwordx4 v32, s[32:35], s54 offen lds
s_add_u32 m0, s46, 30720
s_nop 0
buffer_load_dwordx4 v33, s[32:35], s54 offen lds
s_add_u32 s53, s53, 16384
s_add_u32 s54, s54, s57
s_add_u32 m0, s47, 57344
s_nop 0
buffer_load_dwordx4 v21, s[20:23], s53 offen lds
s_add_u32 m0, s47, 58368
s_nop 0
buffer_load_dwordx4 v22, s[20:23], s53 offen lds
s_add_u32 m0, s46, 57344
s_nop 0
buffer_load_dwordx4 v31, s[32:35], s54 offen lds
s_add_u32 m0, s46, 58368
s_nop 0
buffer_load_dwordx4 v32, s[32:35], s54 offen lds
s_add_u32 m0, s46, 59392
s_nop 0
buffer_load_dwordx4 v33, s[32:35], s54 offen lds
s_add_u32 s53, s53, 16384
s_add_u32 s54, s54, s57
s_add_u32 m0, s47, 86016
s_nop 0
buffer_load_dwordx4 v21, s[20:23], s53 offen lds
s_add_u32 m0, s47, 87040
s_nop 0
buffer_load_dwordx4 v22, s[20:23], s53 offen lds
s_add_u32 m0, s46, 86016
s_nop 0
buffer_load_dwordx4 v31, s[32:35], s54 offen lds
s_add_u32 m0, s46, 87040
s_nop 0
buffer_load_dwordx4 v32, s[32:35], s54 offen lds
s_add_u32 m0, s46, 88064
s_nop 0
buffer_load_dwordx4 v33, s[32:35], s54 offen lds
s_add_u32 s53, s53, 16384
s_add_u32 s54, s54, s57
s_waitcnt vmcnt(15)
s_barrier
ds_read_b128 v[44:47], v34 offset:0
ds_read_b128 v[48:51], v34 offset:2048
ds_read_b64_tr_b16 v[60:61], v36 offset:0
ds_read_b64_tr_b16 v[62:63], v37 offset:0
ds_read_b64_tr_b16 v[64:65], v40 offset:0
ds_read_b64_tr_b16 v[66:67], v41 offset:0
ds_read_b64_tr_b16 v[68:69], v36 offset:128
ds_read_b64_tr_b16 v[70:71], v37 offset:128
s_waitcnt lgkmcnt(0)
v_mfma_f32_32x32x16_bf16 a[0:15], v[44:47], v[60:63], 0
ds_read_b128 v[52:55], v35 offset:0
v_mfma_f32_32x32x16_bf16 a[16:31], v[44:47], v[64:67], 0
ds_read_b128 v[56:59], v35 offset:2048
v_mfma_f32_32x32x16_bf16 a[32:47], v[44:47], v[68:71], 0
ds_read_b64_tr_b16 v[72:73], v38 offset:0
ds_read_b64_tr_b16 v[74:75], v39 offset:0
v_mfma_f32_32x32x16_bf16 a[48:63], v[48:51], v[60:63], 0
ds_read_b64_tr_b16 v[76:77], v42 offset:0
ds_read_b64_tr_b16 v[78:79], v43 offset:0
v_mfma_f32_32x32x16_bf16 a[64:79], v[48:51], v[64:67], 0
ds_read_b64_tr_b16 v[80:81], v38 offset:128
ds_read_b64_tr_b16 v[82:83], v39 offset:128
v_mfma_f32_32x32x16_bf16 a[80:95], v[48:51], v[68:71], 0
s_waitcnt lgkmcnt(0)
s_waitcnt vmcnt(10)
s_barrier
v_mfma_f32_32x32x16_bf16 a[0:15], v[52:55], v[72:75], a[0:15]
ds_read_b128 v[44:47], v34 offset:28672
ds_read_b128 v[48:51], v34 offset:30720
v_mfma_f32_32x32x16_bf16 a[16:31], v[52:55], v[76:79], a[16:31]
ds_read_b64_tr_b16 v[60:61], v36 offset:28672
ds_read_b64_tr_b16 v[62:63], v37 offset:28672
ds_read_b64_tr_b16 v[64:65], v40 offset:28672
ds_read_b64_tr_b16 v[66:67], v41 offset:28672
v_mfma_f32_32x32x16_bf16 a[32:47], v[52:55], v[80:83], a[32:47]
ds_read_b64_tr_b16 v[68:69], v36 offset:28800
ds_read_b64_tr_b16 v[70:71], v37 offset:28800
s_add_u32 m0, s47, 0
s_nop 0
buffer_load_dwordx4 v21, s[20:23], s53 offen lds
v_mfma_f32_32x32x16_bf16 a[48:63], v[56:59], v[72:75], a[48:63]
s_add_u32 m0, s47, 1024
s_nop 0
buffer_load_dwordx4 v22, s[20:23], s53 offen lds
s_add_u32 m0, s46, 0
s_nop 0
buffer_load_dwordx4 v31, s[32:35], s54 offen lds
v_mfma_f32_32x32x16_bf16 a[64:79], v[56:59], v[76:79], a[64:79]
s_add_u32 m0, s46, 1024
s_nop 0
buffer_load_dwordx4 v32, s[32:35], s54 offen lds
s_add_u32 m0, s46, 2048
s_nop 0
buffer_load_dwordx4 v33, s[32:35], s54 offen lds
s_add_u32 s53, s53, 16384
s_add_u32 s54, s54, s57
v_mfma_f32_32x32x16_bf16 a[80:95], v[56:59], v[80:83], a[80:95]
s_waitcnt lgkmcnt(0)
v_mfma_f32_32x32x16_bf16 a[0:15], v[44:47], v[60:63], a[0:15]
ds_read_b128 v[52:55], v35 offset:28672
v_mfma_f32_32x32x16_bf16 a[16:31], v[44:47], v[64:67], a[16:31]
ds_read_b128 v[56:59], v35 offset:30720
v_mfma_f32_32x32x16_bf16 a[32:47], v[44:47], v[68:71], a[32:47]
ds_read_b64_tr_b16 v[72:73], v38 offset:28672
ds_read_b64_tr_b16 v[74:75], v39 offset:28672
v_mfma_f32_32x32x16_bf16 a[48:63], v[48:51], v[60:63], a[48:63]
ds_read_b64_tr_b16 v[76:77], v42 offset:28672
ds_read_b64_tr_b16 v[78:79], v43 offset:28672
v_mfma_f32_32x32x16_bf16 a[64:79], v[48:51], v[64:67], a[64:79]
ds_read_b64_tr_b16 v[80:81], v38 offset:28800
ds_read_b64_tr_b16 v[82:83], v39 offset:28800
v_mfma_f32_32x32x16_bf16 a[80:95], v[48:51], v[68:71], a[80:95]
s_waitcnt lgkmcnt(0)
s_waitcnt vmcnt(10)
s_barrier
v_mfma_f32_32x32x16_bf16 a[0:15], v[52:55], v[72:75], a[0:15]
ds_read_b128 v[44:47], v84 offset:0
ds_read_b128 v[48:51], v84 offset:2048
v_mfma_f32_32x32x16_bf16 a[16:31], v[52:55], v[76:79], a[16:31]
ds_read_b64_tr_b16 v[60:61], v86 offset:0
ds_read_b64_tr_b16 v[62:63], v87 offset:0
ds_read_b64_tr_b16 v[64:65], v90 offset:0
ds_read_b64_tr_b16 v[66:67], v91 offset:0
v_mfma_f32_32x32x16_bf16 a[32:47], v[52:55], v[80:83], a[32:47]
ds_read_b64_tr_b16 v[68:69], v86 offset:128
ds_read_b64_tr_b16 v[70:71], v87 offset:128
s_add_u32 m0, s47, 28672
s_nop 0
buffer_load_dwordx4 v21, s[20:23], s53 offen lds
v_mfma_f32_32x32x16_bf16 a[48:63], v[56:59], v[72:75], a[48:63]
s_add_u32 m0, s47, 29696
s_nop 0
buffer_load_dwordx4 v22, s[20:23], s53 offen lds
s_add_u32 m0, s46, 28672
s_nop 0
buffer_load_dwordx4 v31, s[32:35], s54 offen lds
v_mfma_f32_32x32x16_bf16 a[64:79], v[56:59], v[76:79], a[64:79]
s_add_u32 m0, s46, 29696
s_nop 0
buffer_load_dwordx4 v32, s[32:35], s54 offen lds
s_add_u32 m0, s46, 30720
s_nop 0
buffer_load_dwordx4 v33, s[32:35], s54 offen lds
s_add_u32 s53, s53, 16384
s_add_u32 s54, s54, s57
v_mfma_f32_32x32x16_bf16 a[80:95], v[56:59], v[80:83], a[80:95]
s_waitcnt lgkmcnt(0)
v_mfma_f32_32x32x16_bf16 a[0:15], v[44:47], v[60:63], a[0:15]
ds_read_b128 v[52:55], v85 offset:0
v_mfma_f32_32x32x16_bf16 a[16:31], v[44:47], v[64:67], a[16:31]
ds_read_b128 v[56:59], v85 offset:2048
v_mfma_f32_32x32x16_bf16 a[32:47], v[44:47], v[68:71], a[32:47]
ds_read_b64_tr_b16 v[72:73], v88 offset:0
ds_read_b64_tr_b16 v[74:75], v89 offset:0
v_mfma_f32_32x32x16_bf16 a[48:63], v[48:51], v[60:63], a[48:63]
ds_read_b64_tr_b16 v[76:77], v92 offset:0
ds_read_b64_tr_b16 v[78:79], v93 offset:0
v_mfma_f32_32x32x16_bf16 a[64:79], v[48:51], v[64:67], a[64:79]
ds_read_b64_tr_b16 v[80:81], v88 offset:128
ds_read_b64_tr_b16 v[82:83], v89 offset:128
v_mfma_f32_32x32x16_bf16 a[80:95], v[48:51], v[68:71], a[80:95]
s_waitcnt lgkmcnt(0)
s_waitcnt vmcnt(10)
s_barrier
v_mfma_f32_32x32x16_bf16 a[0:15], v[52:55], v[72:75], a[0:15]
ds_read_b128 v[44:47], v84 offset:28672
ds_read_b128 v[48:51], v84 offset:30720
v_mfma_f32_32x32x16_bf16 a[16:31], v[52:55], v[76:79], a[16:31]
ds_read_b64_tr_b16 v[60:61], v86 offset:28672
ds_read_b64_tr_b16 v[62:63], v87 offset:28672
ds_read_b64_tr_b16 v[64:65], v90 offset:28672
ds_read_b64_tr_b16 v[66:67], v91 offset:28672
v_mfma_f32_32x32x16_bf16 a[32:47], v[52:55], v[80:83], a[32:47]
ds_read_b64_tr_b16 v[68:69], v86 offset:28800
ds_read_b64_tr_b16 v[70:71], v87 offset:28800
s_add_u32 m0, s47, 57344
s_nop 0
buffer_load_dwordx4 v21, s[20:23], s53 offen lds
v_mfma_f32_32x32x16_bf16 a[48:63], v[56:59], v[72:75], a[48:63]
s_add_u32 m0, s47, 58368
s_nop 0
buffer_load_dwordx4 v22, s[20:23], s53 offen lds
s_add_u32 m0, s46, 57344
s_nop 0
buffer_load_dwordx4 v31, s[32:35], s54 offen lds
v_mfma_f32_32x32x16_bf16 a[64:79], v[56:59], v[76:79], a[64:79]
s_add_u32 m0, s46, 58368
s_nop 0
buffer_load_dwordx4 v32, s[32:35], s54 offen lds
s_add_u32 m0, s46, 59392
s_nop 0
buffer_load_dwordx4 v33, s[32:35], s54 offen lds
s_add_u32 s53, s53, 16384
s_add_u32 s54, s54, s57
v_mfma_f32_32x32x16_bf16 a[80:95], v[56:59], v[80:83], a[80:95]
s_waitcnt lgkmcnt(0)
v_mfma_f32_32x32x16_bf16 a[0:15], v[44:47], v[60:63], a[0:15]
ds_read_b128 v[52:55], v85 offset:28672
v_mfma_f32_32x32x16_bf16 a[16:31], v[44:47], v[64:67], a[16:31]
ds_read_b128 v[56:59], v85 offset:30720
v_mfma_f32_32x32x16_bf16 a[32:47], v[44:47], v[68:71], a[32:47]
ds_read_b64_tr_b16 v[72:73], v88 offset:28672
ds_read_b64_tr_b16 v[74:75], v89 offset:28672
v_mfma_f32_32x32x16_bf16 a[48:63], v[48:51], v[60:63], a[48:63]
ds_read_b64_tr_b16 v[76:77], v92 offset:28672
ds_read_b64_tr_b16 v[78:79], v93 offset:28672
v_mfma_f32_32x32x16_bf16 a[64:79], v[48:51], v[64:67], a[64:79]
ds_read_b64_tr_b16 v[80:81], v88 offset:28800
ds_read_b64_tr_b16 v[82:83], v89 offset:28800
v_mfma_f32_32x32x16_bf16 a[80:95], v[48:51], v[68:71], a[80:95]
s_waitcnt lgkmcnt(0)
s_waitcnt vmcnt(10)
s_barrier
v_mfma_f32_32x32x16_bf16 a[0:15], v[52:55], v[72:75], a[0:15]
ds_read_b128 v[44:47], v34 offset:0
ds_read_b128 v[48:51], v34 offset:2048
v_mfma_f32_32x32x16_bf16 a[16:31], v[52:55], v[76:79], a[16:31]
ds_read_b64_tr_b16 v[60:61], v36 offset:0
ds_read_b64_tr_b16 v[62:63], v37 offset:0
ds_read_b64_tr_b16 v[64:65], v40 offset:0
ds_read_b64_tr_b16 v[66:67], v41 offset:0
v_mfma_f32_32x32x16_bf16 a[32:47], v[52:55], v[80:83], a[32:47]
ds_read_b64_tr_b16 v[68:69], v36 offset:128
ds_read_b64_tr_b16 v[70:71], v37 offset:128
s_add_u32 m0, s47, 86016
s_nop 0
buffer_load_dwordx4 v21, s[20:23], s53 offen lds
v_mfma_f32_32x32x16_bf16 a[48:63], v[56:59], v[72:75], a[48:63]
s_add_u32 m0, s47, 87040
s_nop 0
buffer_load_dwordx4 v22, s[20:23], s53 offen lds
s_add_u32 m0, s46, 86016
s_nop 0
buffer_load_dwordx4 v31, s[32:35], s54 offen lds
v_mfma_f32_32x32x16_bf16 a[64:79], v[56:59], v[76:79], a[64:79]
s_add_u32 m0, s46, 87040
s_nop 0
buffer_load_dwordx4 v32, s[32:35], s54 offen lds
s_add_u32 m0, s46, 88064
s_nop 0
buffer_load_dwordx4 v33, s[32:35], s54 offen lds
s_add_u32 s53, s53, 16384
s_add_u32 s54, s54, s57
v_mfma_f32_32x32x16_bf16 a[80:95], v[56:59], v[80:83], a[80:95]
s_mov_b32 s42, 3
s_cmp_eq_u32 s42, 0
s_cbranch_scc1 L_h_xw_last_A
s_nop 8
L_h_xw_A:
s_waitcnt lgkmcnt(0)
v_mfma_f32_32x32x16_bf16 a[0:15], v[44:47], v[60:63], a[0:15]
ds_read_b128 v[52:55], v35 offset:0
v_mfma_f32_32x32x16_bf16 a[16:31], v[44:47], v[64:67], a[16:31]
ds_read_b128 v[56:59], v35 offset:2048
v_mfma_f32_32x32x16_bf16 a[32:47], v[44:47], v[68:71], a[32:47]
ds_read_b64_tr_b16 v[72:73], v38 offset:0
ds_read_b64_tr_b16 v[74:75], v39 offset:0
v_mfma_f32_32x32x16_bf16 a[48:63], v[48:51], v[60:63], a[48:63]
ds_read_b64_tr_b16 v[76:77], v42 offset:0
ds_read_b64_tr_b16 v[78:79], v43 offset:0
v_mfma_f32_32x32x16_bf16 a[64:79], v[48:51], v[64:67], a[64:79]
ds_read_b64_tr_b16 v[80:81], v38 offset:128
ds_read_b64_tr_b16 v[82:83], v39 offset:128
v_mfma_f32_32x32x16_bf16 a[80:95], v[48:51], v[68:71], a[80:95]
s_waitcnt lgkmcnt(0)
s_waitcnt vmcnt(10)
s_barrier
v_mfma_f32_32x32x16_bf16 a[0:15], v[52:55], v[72:75], a[0:15]
ds_read_b128 v[44:47], v34 offset:28672
ds_read_b128 v[48:51], v34 offset:30720
v_mfma_f32_32x32x16_bf16 a[16:31], v[52:55], v[76:79], a[16:31]
ds_read_b64_tr_b16 v[60:61], v36 offset:28672
ds_read_b64_tr_b16 v[62:63], v37 offset:28672
ds_read_b64_tr_b16 v[64:65], v40 offset:28672
ds_read_b64_tr_b16 v[66:67], v41 offset:28672
v_mfma_f32_32x32x16_bf16 a[32:47], v[52:55], v[80:83], a[32:47]
ds_read_b64_tr_b16 v[68:69], v36 offset:28800
ds_read_b64_tr_b16 v[70:71], v37 offset:28800
s_add_u32 m0, s47, 0
s_nop 0
buffer_load_dwordx4 v21, s[20:23], s53 offen lds
v_mfma_f32_32x32x16_bf16 a[48:63], v[56:59], v[72:75], a[48:63]
s_add_u32 m0, s47, 1024
s_nop 0
buffer_load_dwordx4 v22, s[20:23], s53 offen lds
s_add_u32 m0, s46, 0
s_nop 0
buffer_load_dwordx4 v31, s[32:35], s54 offen lds
v_mfma_f32_32x32x16_bf16 a[64:79], v[56:59], v[76:79], a[64:79]
s_add_u32 m0, s46, 1024
s_nop 0
buffer_load_dwordx4 v32, s[32:35], s54 offen lds
s_add_u32 m0, s46, 2048
s_nop 0
buffer_load_dwordx4 v33, s[32:35], s54 offen lds
s_add_u32 s53, s53, 16384
s_add_u32 s54, s54, s57
v_mfma_f32_32x32x16_bf16 a[80:95], v[56:59], v[80:83], a[80:95]
s_waitcnt lgkmcnt(0)
v_mfma_f32_32x32x16_bf16 a[0:15], v[44:47], v[60:63], a[0:15]
ds_read_b128 v[52:55], v35 offset:28672
v_mfma_f32_32x32x16_bf16 a[16:31], v[44:47], v[64:67], a[16:31]
ds_read_b128 v[56:59], v35 offset:30720
v_mfma_f32_32x32x16_bf16 a[32:47], v[44:47], v[68:71], a[32:47]
ds_read_b64_tr_b16 v[72:73], v38 offset:28672
ds_read_b64_tr_b16 v[74:75], v39 offset:28672
v_mfma_f32_32x32x16_bf16 a[48:63], v[48:51], v[60:63], a[48:63]
ds_read_b64_tr_b16 v[76:77], v42 offset:28672
ds_read_b64_tr_b16 v[78:79], v43 offset:28672
v_mfma_f32_32x32x16_bf16 a[64:79], v[48:51], v[64:67], a[64:79]
ds_read_b64_tr_b16 v[80:81], v38 offset:28800
ds_read_b64_tr_b16 v[82:83], v39 offset:28800
v_mfma_f32_32x32x16_bf16 a[80:95], v[48:51], v[68:71], a[80:95]
s_waitcnt lgkmcnt(0)
s_waitcnt vmcnt(10)
s_barrier
v_mfma_f32_32x32x16_bf16 a[0:15], v[52:55], v[72:75], a[0:15]
ds_read_b128 v[44:47], v84 offset:0
ds_read_b128 v[48:51], v84 offset:2048
v_mfma_f32_32x32x16_bf16 a[16:31], v[52:55], v[76:79], a[16:31]
ds_read_b64_tr_b16 v[60:61], v86 offset:0
ds_read_b64_tr_b16 v[62:63], v87 offset:0
ds_read_b64_tr_b16 v[64:65], v90 offset:0
ds_read_b64_tr_b16 v[66:67], v91 offset:0
v_mfma_f32_32x32x16_bf16 a[32:47], v[52:55], v[80:83], a[32:47]
ds_read_b64_tr_b16 v[68:69], v86 offset:128
ds_read_b64_tr_b16 v[70:71], v87 offset:128
s_add_u32 m0, s47, 28672
s_nop 0
buffer_load_dwordx4 v21, s[20:23], s53 offen lds
v_mfma_f32_32x32x16_bf16 a[48:63], v[56:59], v[72:75], a[48:63]
s_add_u32 m0, s47, 29696
s_nop 0
buffer_load_dwordx4 v22, s[20:23], s53 offen lds
s_add_u32 m0, s46, 28672
s_nop 0
buffer_load_dwordx4 v31, s[32:35], s54 offen lds
v_mfma_f32_32x32x16_bf16 a[64:79], v[56:59], v[76:79], a[64:79]
s_add_u32 m0, s46, 29696
s_nop 0
buffer_load_dwordx4 v32, s[32:35], s54 offen lds
s_add_u32 m0, s46, 30720
s_nop 0
buffer_load_dwordx4 v33, s[32:35], s54 offen lds
s_add_u32 s53, s53, 16384
s_add_u32 s54, s54, s57
v_mfma_f32_32x32x16_bf16 a[80:95], v[56:59], v[80:83], a[80:95]
s_waitcnt lgkmcnt(0)
v_mfma_f32_32x32x16_bf16 a[0:15], v[44:47], v[60:63], a[0:15]
ds_read_b128 v[52:55], v85 offset:0
v_mfma_f32_32x32x16_bf16 a[16:31], v[44:47], v[64:67], a[16:31]
ds_read_b128 v[56:59], v85 offset:2048
v_mfma_f32_32x32x16_bf16 a[32:47], v[44:47], v[68:71], a[32:47]
ds_read_b64_tr_b16 v[72:73], v88 offset:0
ds_read_b64_tr_b16 v[74:75], v89 offset:0
v_mfma_f32_32x32x16_bf16 a[48:63], v[48:51], v[60:63], a[48:63]
ds_read_b64_tr_b16 v[76:77], v92 offset:0
ds_read_b64_tr_b16 v[78:79], v93 offset:0
v_mfma_f32_32x32x16_bf16 a[64:79], v[48:51], v[64:67], a[64:79]
ds_read_b64_tr_b16 v[80:81], v88 offset:128
ds_read_b64_tr_b16 v[82:83], v89 offset:128
v_mfma_f32_32x32x16_bf16 a[80:95], v[48:51], v[68:71], a[80:95]
s_waitcnt lgkmcnt(0)
s_waitcnt vmcnt(10)
s_barrier
v_mfma_f32_32x32x16_bf16 a[0:15], v[52:55], v[72:75], a[0:15]
ds_read_b128 v[44:47], v84 offset:28672
ds_read_b128 v[48:51], v84 offset:30720
v_mfma_f32_32x32x16_bf16 a[16:31], v[52:55], v[76:79], a[16:31]
ds_read_b64_tr_b16 v[60:61], v86 offset:28672
ds_read_b64_tr_b16 v[62:63], v87 offset:28672
ds_read_b64_tr_b16 v[64:65], v90 offset:28672
ds_read_b64_tr_b16 v[66:67], v91 offset:28672
v_mfma_f32_32x32x16_bf16 a[32:47], v[52:55], v[80:83], a[32:47]
ds_read_b64_tr_b16 v[68:69], v86 offset:28800
ds_read_b64_tr_b16 v[70:71], v87 offset:28800
s_add_u32 m0, s47, 57344
s_nop 0
buffer_load_dwordx4 v21, s[20:23], s53 offen lds
v_mfma_f32_32x32x16_bf16 a[48:63], v[56:59], v[72:75], a[48:63]
s_add_u32 m0, s47, 58368
s_nop 0
buffer_load_dwordx4 v22, s[20:23], s53 offen lds
s_add_u32 m0, s46, 57344
s_nop 0
buffer_load_dwordx4 v31, s[32:35], s54 offen lds
v_mfma_f32_32x32x16_bf16 a[64:79], v[56:59], v[76:79], a[64:79]
s_add_u32 m0, s46, 58368
s_nop 0
buffer_load_dwordx4 v32, s[32:35], s54 offen lds
s_add_u32 m0, s46, 59392
s_nop 0
buffer_load_dwordx4 v33, s[32:35], s54 offen lds
s_add_u32 s53, s53, 16384
s_add_u32 s54, s54, s57
v_mfma_f32_32x32x16_bf16 a[80:95], v[56:59], v[80:83], a[80:95]
s_waitcnt lgkmcnt(0)
v_mfma_f32_32x32x16_bf16 a[0:15], v[44:47], v[60:63], a[0:15]
ds_read_b128 v[52:55], v85 offset:28672
v_mfma_f32_32x32x16_bf16 a[16:31], v[44:47], v[64:67], a[16:31]
ds_read_b128 v[56:59], v85 offset:30720
v_mfma_f32_32x32x16_bf16 a[32:47], v[44:47], v[68:71], a[32:47]
ds_read_b64_tr_b16 v[72:73], v88 offset:28672
ds_read_b64_tr_b16 v[74:75], v89 offset:28672
v_mfma_f32_32x32x16_bf16 a[48:63], v[48:51], v[60:63], a[48:63]
ds_read_b64_tr_b16 v[76:77], v92 offset:28672
ds_read_b64_tr_b16 v[78:79], v93 offset:28672
v_mfma_f32_32x32x16_bf16 a[64:79], v[48:51], v[64:67], a[64:79]
ds_read_b64_tr_b16 v[80:81], v88 offset:28800
ds_read_b64_tr_b16 v[82:83], v89 offset:28800
v_mfma_f32_32x32x16_bf16 a[80:95], v[48:51], v[68:71], a[80:95]
s_waitcnt lgkmcnt(0)
s_waitcnt vmcnt(10)
s_barrier
v_mfma_f32_32x32x16_bf16 a[0:15], v[52:55], v[72:75], a[0:15]
ds_read_b128 v[44:47], v34 offset:0
ds_read_b128 v[48:51], v34 offset:2048
v_mfma_f32_32x32x16_bf16 a[16:31], v[52:55], v[76:79], a[16:31]
ds_read_b64_tr_b16 v[60:61], v36 offset:0
ds_read_b64_tr_b16 v[62:63], v37 offset:0
ds_read_b64_tr_b16 v[64:65], v40 offset:0
ds_read_b64_tr_b16 v[66:67], v41 offset:0
v_mfma_f32_32x32x16_bf16 a[32:47], v[52:55], v[80:83], a[32:47]
ds_read_b64_tr_b16 v[68:69], v36 offset:128
ds_read_b64_tr_b16 v[70:71], v37 offset:128
s_add_u32 m0, s47, 86016
s_nop 0
buffer_load_dwordx4 v21, s[20:23], s53 offen lds
v_mfma_f32_32x32x16_bf16 a[48:63], v[56:59], v[72:75], a[48:63]
s_add_u32 m0, s47, 87040
s_nop 0
buffer_load_dwordx4 v22, s[20:23], s53 offen lds
s_add_u32 m0, s46, 86016
s_nop 0
buffer_load_dwordx4 v31, s[32:35], s54 offen lds
v_mfma_f32_32x32x16_bf16 a[64:79], v[56:59], v[76:79], a[64:79]
s_add_u32 m0, s46, 87040
s_nop 0
buffer_load_dwordx4 v32, s[32:35], s54 offen lds
s_add_u32 m0, s46, 88064
s_nop 0
buffer_load_dwordx4 v33, s[32:35], s54 offen lds
s_add_u32 s53, s53, 16384
s_add_u32 s54, s54, s57
v_mfma_f32_32x32x16_bf16 a[80:95], v[56:59], v[80:83], a[80:95]
s_sub_u32 s42, s42, 1
s_cmp_lg_u32 s42, 0
s_nop 9
s_cbranch_scc1 L_h_xw_A
L_h_xw_last_A:
s_waitcnt lgkmcnt(0)
v_mfma_f32_32x32x16_bf16 a[0:15], v[44:47], v[60:63], a[0:15]
ds_read_b128 v[52:55], v35 offset:0
v_mfma_f32_32x32x16_bf16 a[16:31], v[44:47], v[64:67], a[16:31]
ds_read_b128 v[56:59], v35 offset:2048
v_mfma_f32_32x32x16_bf16 a[32:47], v[44:47], v[68:71], a[32:47]
ds_read_b64_tr_b16 v[72:73], v38 offset:0
ds_read_b64_tr_b16 v[74:75], v39 offset:0
v_mfma_f32_32x32x16_bf16 a[48:63], v[48:51], v[60:63], a[48:63]
ds_read_b64_tr_b16 v[76:77], v42 offset:0
ds_read_b64_tr_b16 v[78:79], v43 offset:0
v_mfma_f32_32x32x16_bf16 a[64:79], v[48:51], v[64:67], a[64:79]
ds_read_b64_tr_b16 v[80:81], v38 offset:128
ds_read_b64_tr_b16 v[82:83], v39 offset:128
v_mfma_f32_32x32x16_bf16 a[80:95], v[48:51], v[68:71], a[80:95]
s_waitcnt lgkmcnt(0)
s_waitcnt vmcnt(10)
s_barrier
v_mfma_f32_32x32x16_bf16 a[0:15], v[52:55], v[72:75], a[0:15]
ds_read_b128 v[44:47], v34 offset:28672
v_mfma_f32_32x32x16_bf16 a[16:31], v[52:55], v[76:79], a[16:31]
ds_read_b128 v[48:51], v34 offset:30720
v_mfma_f32_32x32x16_bf16 a[32:47], v[52:55], v[80:83], a[32:47]
ds_read_b64_tr_b16 v[60:61], v36 offset:28672
ds_read_b64_tr_b16 v[62:63], v37 offset:28672
v_mfma_f32_32x32x16_bf16 a[48:63], v[56:59], v[72:75], a[48:63]
ds_read_b64_tr_b16 v[64:65], v40 offset:28672
ds_read_b64_tr_b16 v[66:67], v41 offset:28672
v_mfma_f32_32x32x16_bf16 a[64:79], v[56:59], v[76:79], a[64:79]
ds_read_b64_tr_b16 v[68:69], v36 offset:28800
ds_read_b64_tr_b16 v[70:71], v37 offset:28800
v_mfma_f32_32x32x16_bf16 a[80:95], v[56:59], v[80:83], a[80:95]
s_waitcnt lgkmcnt(0)
v_mfma_f32_32x32x16_bf16 a[0:15], v[44:47], v[60:63], a[0:15]
ds_read_b128 v[52:55], v35 offset:28672
v_mfma_f32_32x32x16_bf16 a[16:31], v[44:47], v[64:67], a[16:31]
ds_read_b128 v[56:59], v35 offset:30720
v_mfma_f32_32x32x16_bf16 a[32:47], v[44:47], v[68:71], a[32:47]
ds_read_b64_tr_b16 v[72:73], v38 offset:28672
ds_read_b64_tr_b16 v[74:75], v39 offset:28672
v_mfma_f32_32x32x16_bf16 a[48:63], v[48:51], v[60:63], a[48:63]
ds_read_b64_tr_b16 v[76:77], v42 offset:28672
ds_read_b64_tr_b16 v[78:79], v43 offset:28672
v_mfma_f32_32x32x16_bf16 a[64:79], v[48:51], v[64:67], a[64:79]
ds_read_b64_tr_b16 v[80:81], v38 offset:28800
ds_read_b64_tr_b16 v[82:83], v39 offset:28800
v_mfma_f32_32x32x16_bf16 a[80:95], v[48:51], v[68:71], a[80:95]
s_waitcnt lgkmcnt(0)
s_waitcnt vmcnt(5)
s_barrier
v_mfma_f32_32x32x16_bf16 a[0:15], v[52:55], v[72:75], a[0:15]
ds_read_b128 v[44:47], v84 offset:0
v_mfma_f32_32x32x16_bf16 a[16:31], v[52:55], v[76:79], a[16:31]
ds_read_b128 v[48:51], v84 offset:2048
v_mfma_f32_32x32x16_bf16 a[32:47], v[52:55], v[80:83], a[32:47]
ds_read_b64_tr_b16 v[60:61], v86 offset:0
ds_read_b64_tr_b16 v[62:63], v87 offset:0
v_mfma_f32_32x32x16_bf16 a[48:63], v[56:59], v[72:75], a[48:63]
ds_read_b64_tr_b16 v[64:65], v90 offset:0
ds_read_b64_tr_b16 v[66:67], v91 offset:0
v_mfma_f32_32x32x16_bf16 a[64:79], v[56:59], v[76:79], a[64:79]
ds_read_b64_tr_b16 v[68:69], v86 offset:128
ds_read_b64_tr_b16 v[70:71], v87 offset:128
v_mfma_f32_32x32x16_bf16 a[80:95], v[56:59], v[80:83], a[80:95]
s_waitcnt lgkmcnt(0)
v_mfma_f32_32x32x16_bf16 a[0:15], v[44:47], v[60:63], a[0:15]
ds_read_b128 v[52:55], v85 offset:0
v_mfma_f32_32x32x16_bf16 a[16:31], v[44:47], v[64:67], a[16:31]
ds_read_b128 v[56:59], v85 offset:2048
v_mfma_f32_32x32x16_bf16 a[32:47], v[44:47], v[68:71], a[32:47]
ds_read_b64_tr_b16 v[72:73], v88 offset:0
ds_read_b64_tr_b16 v[74:75], v89 offset:0
v_mfma_f32_32x32x16_bf16 a[48:63], v[48:51], v[60:63], a[48:63]
ds_read_b64_tr_b16 v[76:77], v92 offset:0
ds_read_b64_tr_b16 v[78:79], v93 offset:0
v_mfma_f32_32x32x16_bf16 a[64:79], v[48:51], v[64:67], a[64:79]
ds_read_b64_tr_b16 v[80:81], v88 offset:128
ds_read_b64_tr_b16 v[82:83], v89 offset:128
v_mfma_f32_32x32x16_bf16 a[80:95], v[48:51], v[68:71], a[80:95]
s_waitcnt lgkmcnt(0)
s_waitcnt vmcnt(0)
s_barrier
v_mfma_f32_32x32x16_bf16 a[0:15], v[52:55], v[72:75], a[0:15]
ds_read_b128 v[44:47], v84 offset:28672
v_mfma_f32_32x32x16_bf16 a[16:31], v[52:55], v[76:79], a[16:31]
ds_read_b128 v[48:51], v84 offset:30720
v_mfma_f32_32x32x16_bf16 a[32:47], v[52:55], v[80:83], a[32:47]
ds_read_b64_tr_b16 v[60:61], v86 offset:28672
ds_read_b64_tr_b16 v[62:63], v87 offset:28672
v_mfma_f32_32x32x16_bf16 a[48:63], v[56:59], v[72:75], a[48:63]
ds_read_b64_tr_b16 v[64:65], v90 offset:28672
ds_read_b64_tr_b16 v[66:67], v91 offset:28672
v_mfma_f32_32x32x16_bf16 a[64:79], v[56:59], v[76:79], a[64:79]
ds_read_b64_tr_b16 v[68:69], v86 offset:28800
ds_read_b64_tr_b16 v[70:71], v87 offset:28800
v_mfma_f32_32x32x16_bf16 a[80:95], v[56:59], v[80:83], a[80:95]
s_waitcnt lgkmcnt(0)
v_mfma_f32_32x32x16_bf16 a[0:15], v[44:47], v[60:63], a[0:15]
ds_read_b128 v[52:55], v85 offset:28672
v_mfma_f32_32x32x16_bf16 a[16:31], v[44:47], v[64:67], a[16:31]
ds_read_b128 v[56:59], v85 offset:30720
v_mfma_f32_32x32x16_bf16 a[32:47], v[44:47], v[68:71], a[32:47]
ds_read_b64_tr_b16 v[72:73], v88 offset:28672
ds_read_b64_tr_b16 v[74:75], v89 offset:28672
v_mfma_f32_32x32x16_bf16 a[48:63], v[48:51], v[60:63], a[48:63]
ds_read_b64_tr_b16 v[76:77], v92 offset:28672
ds_read_b64_tr_b16 v[78:79], v93 offset:28672
v_mfma_f32_32x32x16_bf16 a[64:79], v[48:51], v[64:67], a[64:79]
ds_read_b64_tr_b16 v[80:81], v88 offset:28800
ds_read_b64_tr_b16 v[82:83], v89 offset:28800
v_mfma_f32_32x32x16_bf16 a[80:95], v[48:51], v[68:71], a[80:95]
s_waitcnt lgkmcnt(0)
s_waitcnt vmcnt(0)
s_barrier
v_mfma_f32_32x32x16_bf16 a[0:15], v[52:55], v[72:75], a[0:15]
v_mfma_f32_32x32x16_bf16 a[16:31], v[52:55], v[76:79], a[16:31]
v_mfma_f32_32x32x16_bf16 a[32:47], v[52:55], v[80:83], a[32:47]
v_mfma_f32_32x32x16_bf16 a[48:63], v[56:59], v[72:75], a[48:63]
v_mfma_f32_32x32x16_bf16 a[64:79], v[56:59], v[76:79], a[64:79]
v_mfma_f32_32x32x16_bf16 a[80:95], v[56:59], v[80:83], a[80:95]
s_nop 11
L_h_epi_A:
v_mov_b32 v250, 64
s_nop 1
L_mch_A:
global_load_dword v251, v250, s[6:7] sc1
s_waitcnt vmcnt(0)
v_readfirstlane_b32 s94, v251
s_add_u32 s95, s95, 1
s_cmp_gt_u32 s95, 4000000
s_cbranch_scc1 L_rec_done_A
s_cmp_ge_u32 s94, 256
s_cbranch_scc1 L_mchx_A
s_sleep 2
s_branch L_mch_A
L_mchx_A:
v_and_b32 v250, 7, v1
v_lshlrev_b32 v250, 2, v250
global_load_dword v251, v250, s[6:7] sc1
s_waitcnt vmcnt(0)
v_cmp_ne_u32 vcc, 32, v251
s_cbranch_vccz L_mchok_A
s_lshr_b32 s29, s49, 5
s_and_b32 s30, s49, 31
s_waitcnt vmcnt(0) lgkmcnt(0)
s_barrier
s_branch L_role_entry_B
L_mchok_A:
s_mov_b32 s48, 1
s_lshr_b32 s60, s28, 1
s_and_b32 s61, s28, 1
s_lshl_b32 s40, s62, 2
s_lshl_b32 s60, s60, 1
s_add_u32 s40, s40, s60
s_lshl_b32 s40, s40, 5
s_add_u32 s40, s40, s59
s_mul_i32 s40, s40, 12288
s_cmp_eq_u32 s58, 1
s_cbranch_scc1 L_h_ev_A
s_mul_i32 s61, s61, 3072
s_add_u32 s40, s40, s61
s_add_u32 s40, s40, 0
s_add_u32 s41, s40, 0
v_accvgpr_read_b32 v104, a0
v_accvgpr_read_b32 v105, a1
v_accvgpr_read_b32 v106, a2
v_accvgpr_read_b32 v107, a3
v_accvgpr_read_b32 v108, a4
v_accvgpr_read_b32 v109, a5
v_accvgpr_read_b32 v110, a6
v_accvgpr_read_b32 v111, a7
v_accvgpr_read_b32 v112, a8
v_accvgpr_read_b32 v113, a9
v_accvgpr_read_b32 v114, a10
v_accvgpr_read_b32 v115, a11
v_accvgpr_read_b32 v116, a12
v_accvgpr_read_b32 v117, a13
v_accvgpr_read_b32 v118, a14
v_accvgpr_read_b32 v119, a15
v_cvt_pk_bf16_f32 v96, v104, v105
v_cvt_pk_bf16_f32 v97, v106, v107
v_cvt_pk_bf16_f32 v98, v112, v113
v_cvt_pk_bf16_f32 v99, v114, v115
v_cvt_pk_bf16_f32 v100, v108, v109
v_cvt_pk_bf16_f32 v101, v110, v111
v_cvt_pk_bf16_f32 v102, v116, v117
v_cvt_pk_bf16_f32 v103, v118, v119
buffer_store_dwordx4 v[96:99], v94, s[20:23], s41 offen
buffer_store_dwordx4 v[100:103], v94, s[20:23], s41 offen offset:512
s_add_u32 s41, s40, 1024
v_accvgpr_read_b32 v104, a16
v_accvgpr_read_b32 v105, a17
v_accvgpr_read_b32 v106, a18
v_accvgpr_read_b32 v107, a19
v_accvgpr_read_b32 v108, a20
v_accvgpr_read_b32 v109, a21
v_accvgpr_read_b32 v110, a22
v_accvgpr_read_b32 v111, a23
v_accvgpr_read_b32 v112, a24
v_accvgpr_read_b32 v113, a25
v_accvgpr_read_b32 v114, a26
v_accvgpr_read_b32 v115, a27
v_accvgpr_read_b32 v116, a28
v_accvgpr_read_b32 v117, a29
v_accvgpr_read_b32 v118, a30
v_accvgpr_read_b32 v119, a31
v_cvt_pk_bf16_f32 v96, v104, v105
v_cvt_pk_bf16_f32 v97, v106, v107
v_cvt_pk_bf16_f32 v98, v112, v113
v_cvt_pk_bf16_f32 v99, v114, v115
v_cvt_pk_bf16_f32 v100, v108, v109
v_cvt_pk_bf16_f32 v101, v110, v111
v_cvt_pk_bf16_f32 v102, v116, v117
v_cvt_pk_bf16_f32 v103, v118, v119
buffer_store_dwordx4 v[96:99], v94, s[20:23], s41 offen
buffer_store_dwordx4 v[100:103], v94, s[20:23], s41 offen offset:512
s_add_u32 s41, s40, 2048
v_accvgpr_read_b32 v104, a32
v_accvgpr_read_b32 v105, a33
v_accvgpr_read_b32 v106, a34
v_accvgpr_read_b32 v107, a35
v_accvgpr_read_b32 v108, a36
v_accvgpr_read_b32 v109, a37
v_accvgpr_read_b32 v110, a38
v_accvgpr_read_b32 v111, a39
v_accvgpr_read_b32 v112, a40
v_accvgpr_read_b32 v113, a41
v_accvgpr_read_b32 v114, a42
v_accvgpr_read_b32 v115, a43
v_accvgpr_read_b32 v116, a44
v_accvgpr_read_b32 v117, a45
v_accvgpr_read_b32 v118, a46
v_accvgpr_read_b32 v119, a47
v_cvt_pk_bf16_f32 v96, v104, v105
v_cvt_pk_bf16_f32 v97, v106, v107
v_cvt_pk_bf16_f32 v98, v112, v113
v_cvt_pk_bf16_f32 v99, v114, v115
v_cvt_pk_bf16_f32 v100, v108, v109
v_cvt_pk_bf16_f32 v101, v110, v111
v_cvt_pk_bf16_f32 v102, v116, v117
v_cvt_pk_bf16_f32 v103, v118, v119
buffer_store_dwordx4 v[96:99], v94, s[20:23], s41 offen
buffer_store_dwordx4 v[100:103], v94, s[20:23], s41 offen offset:512
s_add_u32 s41, s40, 393216
v_accvgpr_read_b32 v104, a48
v_accvgpr_read_b32 v105, a49
v_accvgpr_read_b32 v106, a50
v_accvgpr_read_b32 v107, a51
v_accvgpr_read_b32 v108, a52
v_accvgpr_read_b32 v109, a53
v_accvgpr_read_b32 v110, a54
v_accvgpr_read_b32 v111, a55
v_accvgpr_read_b32 v112, a56
v_accvgpr_read_b32 v113, a57
v_accvgpr_read_b32 v114, a58
v_accvgpr_read_b32 v115, a59
v_accvgpr_read_b32 v116, a60
v_accvgpr_read_b32 v117, a61
v_accvgpr_read_b32 v118, a62
v_accvgpr_read_b32 v119, a63
v_cvt_pk_bf16_f32 v96, v104, v105
v_cvt_pk_bf16_f32 v97, v106, v107
v_cvt_pk_bf16_f32 v98, v112, v113
v_cvt_pk_bf16_f32 v99, v114, v115
v_cvt_pk_bf16_f32 v100, v108, v109
v_cvt_pk_bf16_f32 v101, v110, v111
v_cvt_pk_bf16_f32 v102, v116, v117
v_cvt_pk_bf16_f32 v103, v118, v119
buffer_store_dwordx4 v[96:99], v94, s[20:23], s41 offen
buffer_store_dwordx4 v[100:103], v94, s[20:23], s41 offen offset:512
s_add_u32 s41, s40, 394240
v_accvgpr_read_b32 v104, a64
v_accvgpr_read_b32 v105, a65
v_accvgpr_read_b32 v106, a66
v_accvgpr_read_b32 v107, a67
v_accvgpr_read_b32 v108, a68
v_accvgpr_read_b32 v109, a69
v_accvgpr_read_b32 v110, a70
v_accvgpr_read_b32 v111, a71
v_accvgpr_read_b32 v112, a72
v_accvgpr_read_b32 v113, a73
v_accvgpr_read_b32 v114, a74
v_accvgpr_read_b32 v115, a75
v_accvgpr_read_b32 v116, a76
v_accvgpr_read_b32 v117, a77
v_accvgpr_read_b32 v118, a78
v_accvgpr_read_b32 v119, a79
v_cvt_pk_bf16_f32 v96, v104, v105
v_cvt_pk_bf16_f32 v97, v106, v107
v_cvt_pk_bf16_f32 v98, v112, v113
v_cvt_pk_bf16_f32 v99, v114, v115
v_cvt_pk_bf16_f32 v100, v108, v109
v_cvt_pk_bf16_f32 v101, v110, v111
v_cvt_pk_bf16_f32 v102, v116, v117
v_cvt_pk_bf16_f32 v103, v118, v119
buffer_store_dwordx4 v[96:99], v94, s[20:23], s41 offen
buffer_store_dwordx4 v[100:103], v94, s[20:23], s41 offen offset:512
s_add_u32 s41, s40, 395264
v_accvgpr_read_b32 v104, a80
v_accvgpr_read_b32 v105, a81
v_accvgpr_read_b32 v106, a82
v_accvgpr_read_b32 v107, a83
v_accvgpr_read_b32 v108, a84
v_accvgpr_read_b32 v109, a85
v_accvgpr_read_b32 v110, a86
v_accvgpr_read_b32 v111, a87
v_accvgpr_read_b32 v112, a88
v_accvgpr_read_b32 v113, a89
v_accvgpr_read_b32 v114, a90
v_accvgpr_read_b32 v115, a91
v_accvgpr_read_b32 v116, a92
v_accvgpr_read_b32 v117, a93
v_accvgpr_read_b32 v118, a94
v_accvgpr_read_b32 v119, a95
v_cvt_pk_bf16_f32 v96, v104, v105
v_cvt_pk_bf16_f32 v97, v106, v107
v_cvt_pk_bf16_f32 v98, v112, v113
v_cvt_pk_bf16_f32 v99, v114, v115
v_cvt_pk_bf16_f32 v100, v108, v109
v_cvt_pk_bf16_f32 v101, v110, v111
v_cvt_pk_bf16_f32 v102, v116, v117
v_cvt_pk_bf16_f32 v103, v118, v119
buffer_store_dwordx4 v[96:99], v94, s[20:23], s41 offen
buffer_store_dwordx4 v[100:103], v94, s[20:23], s41 offen offset:512
s_branch L_h_sig_A
s_nop 0
L_h_ev_A:
s_mul_i32 s61, s61, 6144
s_add_u32 s40, s40, s61
s_add_u32 s40, s40, 25165824
s_add_u32 s41, s40, 0
v_accvgpr_read_b32 v104, a0
v_accvgpr_read_b32 v105, a1
v_accvgpr_read_b32 v106, a2
v_accvgpr_read_b32 v107, a3
v_accvgpr_read_b32 v108, a4
v_accvgpr_read_b32 v109, a5
v_accvgpr_read_b32 v110, a6
v_accvgpr_read_b32 v111, a7
v_accvgpr_read_b32 v112, a8
v_accvgpr_read_b32 v113, a9
v_accvgpr_read_b32 v114, a10
v_accvgpr_read_b32 v115, a11
v_accvgpr_read_b32 v116, a12
v_accvgpr_read_b32 v117, a13
v_accvgpr_read_b32 v118, a14
v_accvgpr_read_b32 v119, a15
v_cvt_pk_bf16_f32 v96, v104, v105
v_cvt_pk_bf16_f32 v97, v106, v107
v_cvt_pk_bf16_f32 v98, v112, v113
v_cvt_pk_bf16_f32 v99, v114, v115
v_cvt_pk_bf16_f32 v100, v108, v109
v_cvt_pk_bf16_f32 v101, v110, v111
v_cvt_pk_bf16_f32 v102, v116, v117
v_cvt_pk_bf16_f32 v103, v118, v119
buffer_store_dwordx4 v[96:99], v95, s[20:23], s41 offen
buffer_store_dwordx4 v[100:103], v95, s[20:23], s41 offen offset:512
s_add_u32 s41, s40, 2048
v_accvgpr_read_b32 v104, a16
v_accvgpr_read_b32 v105, a17
v_accvgpr_read_b32 v106, a18
v_accvgpr_read_b32 v107, a19
v_accvgpr_read_b32 v108, a20
v_accvgpr_read_b32 v109, a21
v_accvgpr_read_b32 v110, a22
v_accvgpr_read_b32 v111, a23
v_accvgpr_read_b32 v112, a24
v_accvgpr_read_b32 v113, a25
v_accvgpr_read_b32 v114, a26
v_accvgpr_read_b32 v115, a27
v_accvgpr_read_b32 v116, a28
v_accvgpr_read_b32 v117, a29
v_accvgpr_read_b32 v118, a30
v_accvgpr_read_b32 v119, a31
v_cvt_pk_bf16_f32 v96, v104, v105
v_cvt_pk_bf16_f32 v97, v106, v107
v_cvt_pk_bf16_f32 v98, v112, v113
v_cvt_pk_bf16_f32 v99, v114, v115
v_cvt_pk_bf16_f32 v100, v108, v109
v_cvt_pk_bf16_f32 v101, v110, v111
v_cvt_pk_bf16_f32 v102, v116, v117
v_cvt_pk_bf16_f32 v103, v118, v119
buffer_store_dwordx4 v[96:99], v95, s[20:23], s41 offen
buffer_store_dwordx4 v[100:103], v95, s[20:23], s41 offen offset:512
s_add_u32 s41, s40, 4096
v_accvgpr_read_b32 v104, a32
v_accvgpr_read_b32 v105, a33
v_accvgpr_read_b32 v106, a34
v_accvgpr_read_b32 v107, a35
v_accvgpr_read_b32 v108, a36
v_accvgpr_read_b32 v109, a37
v_accvgpr_read_b32 v110, a38
v_accvgpr_read_b32 v111, a39
v_accvgpr_read_b32 v112, a40
v_accvgpr_read_b32 v113, a41
v_accvgpr_read_b32 v114, a42
v_accvgpr_read_b32 v115, a43
v_accvgpr_read_b32 v116, a44
v_accvgpr_read_b32 v117, a45
v_accvgpr_read_b32 v118, a46
v_accvgpr_read_b32 v119, a47
v_cvt_pk_bf16_f32 v96, v104, v105
v_cvt_pk_bf16_f32 v97, v106, v107
v_cvt_pk_bf16_f32 v98, v112, v113
v_cvt_pk_bf16_f32 v99, v114, v115
v_cvt_pk_bf16_f32 v100, v108, v109
v_cvt_pk_bf16_f32 v101, v110, v111
v_cvt_pk_bf16_f32 v102, v116, v117
v_cvt_pk_bf16_f32 v103, v118, v119
buffer_store_dwordx4 v[96:99], v95, s[20:23], s41 offen
buffer_store_dwordx4 v[100:103], v95, s[20:23], s41 offen offset:512
s_add_u32 s41, s40, 393216
v_accvgpr_read_b32 v104, a48
v_accvgpr_read_b32 v105, a49
v_accvgpr_read_b32 v106, a50
v_accvgpr_read_b32 v107, a51
v_accvgpr_read_b32 v108, a52
v_accvgpr_read_b32 v109, a53
v_accvgpr_read_b32 v110, a54
v_accvgpr_read_b32 v111, a55
v_accvgpr_read_b32 v112, a56
v_accvgpr_read_b32 v113, a57
v_accvgpr_read_b32 v114, a58
v_accvgpr_read_b32 v115, a59
v_accvgpr_read_b32 v116, a60
v_accvgpr_read_b32 v117, a61
v_accvgpr_read_b32 v118, a62
v_accvgpr_read_b32 v119, a63
v_cvt_pk_bf16_f32 v96, v104, v105
v_cvt_pk_bf16_f32 v97, v106, v107
v_cvt_pk_bf16_f32 v98, v112, v113
v_cvt_pk_bf16_f32 v99, v114, v115
v_cvt_pk_bf16_f32 v100, v108, v109
v_cvt_pk_bf16_f32 v101, v110, v111
v_cvt_pk_bf16_f32 v102, v116, v117
v_cvt_pk_bf16_f32 v103, v118, v119
buffer_store_dwordx4 v[96:99], v95, s[20:23], s41 offen
buffer_store_dwordx4 v[100:103], v95, s[20:23], s41 offen offset:512
s_add_u32 s41, s40, 395264
v_accvgpr_read_b32 v104, a64
v_accvgpr_read_b32 v105, a65
v_accvgpr_read_b32 v106, a66
v_accvgpr_read_b32 v107, a67
v_accvgpr_read_b32 v108, a68
v_accvgpr_read_b32 v109, a69
v_accvgpr_read_b32 v110, a70
v_accvgpr_read_b32 v111, a71
v_accvgpr_read_b32 v112, a72
v_accvgpr_read_b32 v113, a73
v_accvgpr_read_b32 v114, a74
v_accvgpr_read_b32 v115, a75
v_accvgpr_read_b32 v116, a76
v_accvgpr_read_b32 v117, a77
v_accvgpr_read_b32 v118, a78
v_accvgpr_read_b32 v119, a79
v_cvt_pk_bf16_f32 v96, v104, v105
v_cvt_pk_bf16_f32 v97, v106, v107
v_cvt_pk_bf16_f32 v98, v112, v113
v_cvt_pk_bf16_f32 v99, v114, v115
v_cvt_pk_bf16_f32 v100, v108, v109
v_cvt_pk_bf16_f32 v101, v110, v111
v_cvt_pk_bf16_f32 v102, v116, v117
v_cvt_pk_bf16_f32 v103, v118, v119
buffer_store_dwordx4 v[96:99], v95, s[20:23], s41 offen
buffer_store_dwordx4 v[100:103], v95, s[20:23], s41 offen offset:512
s_add_u32 s41, s40, 397312
v_accvgpr_read_b32 v104, a80
v_accvgpr_read_b32 v105, a81
v_accvgpr_read_b32 v106, a82
v_accvgpr_read_b32 v107, a83
v_accvgpr_read_b32 v108, a84
v_accvgpr_read_b32 v109, a85
v_accvgpr_read_b32 v110, a86
v_accvgpr_read_b32 v111, a87
v_accvgpr_read_b32 v112, a88
v_accvgpr_read_b32 v113, a89
v_accvgpr_read_b32 v114, a90
v_accvgpr_read_b32 v115, a91
v_accvgpr_read_b32 v116, a92
v_accvgpr_read_b32 v117, a93
v_accvgpr_read_b32 v118, a94
v_accvgpr_read_b32 v119, a95
v_cvt_pk_bf16_f32 v96, v104, v105
v_cvt_pk_bf16_f32 v97, v106, v107
v_cvt_pk_bf16_f32 v98, v112, v113
v_cvt_pk_bf16_f32 v99, v114, v115
v_cvt_pk_bf16_f32 v100, v108, v109
v_cvt_pk_bf16_f32 v101, v110, v111
v_cvt_pk_bf16_f32 v102, v116, v117
v_cvt_pk_bf16_f32 v103, v118, v119
buffer_store_dwordx4 v[96:99], v95, s[20:23], s41 offen
buffer_store_dwordx4 v[100:103], v95, s[20:23], s41 offen offset:512
s_nop 1
L_h_sig_A:
s_lshl_b32 s60, s29, 9
s_lshl_b32 s61, s63, 2
s_add_u32 s60, s60, s61
s_add_u32 s60, s60, 178466816
s_waitcnt vmcnt(0)
s_barrier
s_cmp_lg_u32 s28, 0
s_cbranch_scc1 L_sigf_8_A
s_mov_b64 exec, 1
v_lshlrev_b32 v17, 5, v1
v_add_u32 v17, s60, v17
buffer_store_dword v16, v17, s[20:23], 0 offen
s_mov_b64 exec, -1
L_sigf_8_A:
s_lshl_b32 s45, s28, 12
s_mul_i32 s46, s28, 3072
s_add_u32 s46, s46, 16384
v_lshrrev_b32 v19, 2, v1
v_and_b32 v4, 3, v1
v_lshrrev_b32 v5, 4, v1
v_xor_b32 v4, v4, v5
v_lshlrev_b32 v20, 4, v4
s_mul_i32 s40, s28, 192
s_add_u32 s40, s40, 0
v_add_u32 v4, s40, v1
s_mov_b32 s41, 43691
v_mul_u32_u24 v5, s41, v4
v_lshrrev_b32 v25, 20, v5
v_mul_u32_u24 v5, 24, v25
v_sub_u32 v5, v4, v5
v_bfe_u32 v6, v25, 1, 1
v_lshlrev_b32 v6, 2, v6
v_xor_b32 v5, v5, v6
v_lshlrev_b32 v28, 4, v5
s_mul_i32 s40, s28, 192
s_add_u32 s40, s40, 64
v_add_u32 v4, s40, v1
s_mov_b32 s41, 43691
v_mul_u32_u24 v5, s41, v4
v_lshrrev_b32 v26, 20, v5
v_mul_u32_u24 v5, 24, v26
v_sub_u32 v5, v4, v5
v_bfe_u32 v6, v26, 1, 1
v_lshlrev_b32 v6, 2, v6
v_xor_b32 v5, v5, v6
v_lshlrev_b32 v29, 4, v5
s_mul_i32 s40, s28, 192
s_add_u32 s40, s40, 128
v_add_u32 v4, s40, v1
s_mov_b32 s41, 43691
v_mul_u32_u24 v5, s41, v4
v_lshrrev_b32 v27, 20, v5
v_mul_u32_u24 v5, 24, v27
v_sub_u32 v5, v4, v5
v_bfe_u32 v6, v27, 1, 1
v_lshlrev_b32 v6, 2, v6
v_xor_b32 v5, v5, v6
v_lshlrev_b32 v30, 4, v5
v_and_b32 v4, 31, v1
v_lshrrev_b32 v5, 5, v1
v_bfe_u32 v6, v4, 2, 2
s_lshr_b32 s40, s28, 1
s_mul_i32 s40, s40, 8192
v_add_u32 v7, 0, v5
v_xor_b32 v7, v7, v6
v_lshlrev_b32 v7, 4, v7
v_lshl_add_u32 v7, v4, 6, v7
v_add_u32 v34, s40, v7
v_add_u32 v7, 2, v5
v_xor_b32 v7, v7, v6
v_lshlrev_b32 v7, 4, v7
v_lshl_add_u32 v7, v4, 6, v7
v_add_u32 v35, s40, v7
v_and_b32 v4, 15, v1
v_lshrrev_b32 v5, 4, v1
v_and_b32 v6, 1, v5
v_lshrrev_b32 v5, 1, v5
v_bfe_u32 v7, v4, 1, 1
v_lshl_add_u32 v6, v6, 1, v7
s_and_b32 s40, s28, 1
s_mul_i32 s40, s40, 12
v_add_u32 v6, s40, v6
v_bfe_u32 v8, v4, 3, 1
v_lshlrev_b32 v8, 2, v8
v_and_b32 v9, 1, v4
v_lshlrev_b32 v9, 3, v9
v_lshrrev_b32 v10, 2, v4
v_lshlrev_b32 v11, 3, v5
v_add_u32 v11, 0, v11
v_add_u32 v11, v11, v10
v_mul_u32_u24 v11, 384, v11
v_add_u32 v11, v11, v9
v_add_u32 v12, 0, v6
v_xor_b32 v12, v12, v8
v_lshl_add_u32 v36, v12, 4, v11
v_add_u32 v36, 16384, v36
v_add_u32 v12, 4, v6
v_xor_b32 v12, v12, v8
v_lshl_add_u32 v40, v12, 4, v11
v_add_u32 v40, 16384, v40
v_lshlrev_b32 v11, 3, v5
v_add_u32 v11, 4, v11
v_add_u32 v11, v11, v10
v_mul_u32_u24 v11, 384, v11
v_add_u32 v11, v11, v9
v_add_u32 v12, 0, v6
v_xor_b32 v12, v12, v8
v_lshl_add_u32 v37, v12, 4, v11
v_add_u32 v37, 16384, v37
v_add_u32 v12, 4, v6
v_xor_b32 v12, v12, v8
v_lshl_add_u32 v41, v12, 4, v11
v_add_u32 v41, 16384, v41
v_lshlrev_b32 v11, 3, v5
v_add_u32 v11, 16, v11
v_add_u32 v11, v11, v10
v_mul_u32_u24 v11, 384, v11
v_add_u32 v11, v11, v9
v_add_u32 v12, 0, v6
v_xor_b32 v12, v12, v8
v_lshl_add_u32 v38, v12, 4, v11
v_add_u32 v38, 16384, v38
v_add_u32 v12, 4, v6
v_xor_b32 v12, v12, v8
v_lshl_add_u32 v42, v12, 4, v11
v_add_u32 v42, 16384, v42
v_lshlrev_b32 v11, 3, v5
v_add_u32 v11, 20, v11
v_add_u32 v11, v11, v10
v_mul_u32_u24 v11, 384, v11
v_add_u32 v11, v11, v9
v_add_u32 v12, 0, v6
v_xor_b32 v12, v12, v8
v_lshl_add_u32 v39, v12, 4, v11
v_add_u32 v39, 16384, v39
v_add_u32 v12, 4, v6
v_xor_b32 v12, v12, v8
v_lshl_add_u32 v43, v12, 4, v11
v_add_u32 v43, 16384, v43
v_add_u32 v100, 57344, v34
v_add_u32 v101, 57344, v35
v_add_u32 v102, 57344, v36
v_add_u32 v103, 57344, v37
v_add_u32 v104, 57344, v38
v_add_u32 v105, 57344, v39
v_add_u32 v106, 57344, v40
v_add_u32 v107, 57344, v41
v_add_u32 v108, 57344, v42
v_add_u32 v109, 57344, v43
v_bfe_u32 v4, v1, 4, 1
v_lshrrev_b32 v5, 5, v1
v_and_b32 v6, 15, v1
v_lshlrev_b32 v7, 8, v5
v_lshl_add_u32 v7, v6, 4, v7
v_mul_u32_u24 v8, 6144, v4
v_add_u32 v110, v8, v7
v_lshl_add_u32 v111, v4, 10, v7
v_and_b32 v8, 31, v1
v_bfe_u32 v9, v8, 2, 2
v_xor_b32 v10, v5, v9
v_lshlrev_b32 v10, 4, v10
v_lshl_add_u32 v112, v8, 6, v10
v_add_u32 v10, 2, v5
v_xor_b32 v10, v10, v9
v_lshlrev_b32 v10, 4, v10
v_lshl_add_u32 v148, v8, 6, v10
s_mov_b32 s50, s63
s_cmp_ge_u32 s50, 96
s_cbranch_scc1 L_g1_done_A
s_cmp_ge_u32 s50, 56
s_cbranch_scc1 L_g1_dqa_A
s_mov_b32 s84, 1
s_mov_b32 s60, s50
s_cmp_lt_u32 s50, 8
s_cbranch_scc1 L_g1_d0a_A
s_sub_u32 s61, s50, 8
s_mul_i32 s60, s61, 43
s_lshr_b32 s60, s60, 8
s_mul_i32 s84, s60, 6
s_sub_u32 s84, s61, s84
s_add_u32 s84, s84, 2
L_g1_d0a_A:
s_lshr_b32 s86, s60, 2
s_and_b32 s60, s60, 3
s_lshl_b32 s85, s29, 2
s_add_u32 s85, s85, s60
s_branch L_g1_dda_A
L_g1_dqa_A:
s_cmp_ge_u32 s50, 88
s_cbranch_scc1 L_g1_dha_A
s_sub_u32 s60, s50, 56
s_and_b32 s84, s60, 7
s_lshr_b32 s60, s60, 3
s_lshl_b32 s85, s29, 2
s_add_u32 s85, s85, s60
s_mov_b32 s86, 2
s_branch L_g1_dda_A
L_g1_dha_A:
s_sub_u32 s84, s50, 88
s_mov_b32 s85, s29
s_mov_b32 s86, 3
L_g1_dda_A:
s_mov_b32 s56, 12288
s_mov_b32 s34, 7864320
s_mov_b32 s35, 0x00020000
s_mov_b32 s32, s10
s_mov_b32 s33, s11
s_cmp_lg_u32 s86, 1
s_cbranch_scc1 L_g1_n1a_A
s_mov_b32 s32, s12
s_mov_b32 s33, s13
L_g1_n1a_A:
s_cmp_lg_u32 s86, 2
s_cbranch_scc1 L_g1_n2a_A
s_mov_b32 s32, s8
s_mov_b32 s33, s9
L_g1_n2a_A:
s_cmp_lg_u32 s86, 3
s_cbranch_scc1 L_g1_n3a_A
s_mov_b32 s32, s16
s_mov_b32 s33, s17
s_mov_b32 s56, 3072
s_mov_b32 s34, 1966080
L_g1_n3a_A:
s_mov_b32 s55, 1280
s_lshl_b32 s57, s56, 5
s_mul_i32 s54, s85, 384
s_mul_i32 s53, s84, 327680
s_add_u32 s53, s53, 90910720
s_mul_i32 s40, s28, 4096
s_add_u32 s40, s40, 0
v_lshlrev_b32 v4, 4, v1
v_add_u32 v21, s40, v4
s_mul_i32 s40, s28, 4096
s_add_u32 s40, s40, 1024
v_lshlrev_b32 v4, 4, v1
v_add_u32 v22, s40, v4
s_mul_i32 s40, s28, 4096
s_add_u32 s40, s40, 2048
v_lshlrev_b32 v4, 4, v1
v_add_u32 v23, s40, v4
s_mul_i32 s40, s28, 4096
s_add_u32 s40, s40, 3072
v_lshlrev_b32 v4, 4, v1
v_add_u32 v24, s40, v4
v_mul_lo_u32 v4, v25, s56
v_add_u32 v31, v4, v28
v_mul_lo_u32 v4, v26, s56
v_add_u32 v32, v4, v29
v_mul_lo_u32 v4, v27, s56
v_add_u32 v33, v4, v30
s_add_u32 m0, s45, 0
s_nop 0
buffer_load_dwordx4 v21, s[20:23], s53 offen lds
s_add_u32 m0, s45, 1024
s_nop 0
buffer_load_dwordx4 v22, s[20:23], s53 offen lds
s_add_u32 m0, s45, 2048
s_nop 0
buffer_load_dwordx4 v23, s[20:23], s53 offen lds
s_add_u32 m0, s45, 3072
s_nop 0
buffer_load_dwordx4 v24, s[20:23], s53 offen lds
s_add_u32 m0, s46, 0
s_nop 0
buffer_load_dwordx4 v31, s[32:35], s54 offen lds
s_add_u32 m0, s46, 1024
s_nop 0
buffer_load_dwordx4 v32, s[32:35], s54 offen lds
s_add_u32 m0, s46, 2048
s_nop 0
buffer_load_dwordx4 v33, s[32:35], s54 offen lds
s_add_u32 s53, s53, 16384
s_add_u32 s54, s54, s57
s_add_u32 m0, s45, 28672
s_nop 0
buffer_load_dwordx4 v21, s[20:23], s53 offen lds
s_add_u32 m0, s45, 29696
s_nop 0
buffer_load_dwordx4 v22, s[20:23], s53 offen lds
s_add_u32 m0, s45, 30720
s_nop 0
buffer_load_dwordx4 v23, s[20:23], s53 offen lds
s_add_u32 m0, s45, 31744
s_nop 0
buffer_load_dwordx4 v24, s[20:23], s53 offen lds
s_add_u32 m0, s46, 28672
s_nop 0
buffer_load_dwordx4 v31, s[32:35], s54 offen lds
s_add_u32 m0, s46, 29696
s_nop 0
buffer_load_dwordx4 v32, s[32:35], s54 offen lds
s_add_u32 m0, s46, 30720
s_nop 0
buffer_load_dwordx4 v33, s[32:35], s54 offen lds
s_add_u32 s53, s53, 16384
s_add_u32 s54, s54, s57
s_add_u32 m0, s45, 57344
s_nop 0
buffer_load_dwordx4 v21, s[20:23], s53 offen lds
s_add_u32 m0, s45, 58368
s_nop 0
buffer_load_dwordx4 v22, s[20:23], s53 offen lds
s_add_u32 m0, s45, 59392
s_nop 0
buffer_load_dwordx4 v23, s[20:23], s53 offen lds
s_add_u32 m0, s45, 60416
s_nop 0
buffer_load_dwordx4 v24, s[20:23], s53 offen lds
s_add_u32 m0, s46, 57344
s_nop 0
buffer_load_dwordx4 v31, s[32:35], s54 offen lds
s_add_u32 m0, s46, 58368
s_nop 0
buffer_load_dwordx4 v32, s[32:35], s54 offen lds
s_add_u32 m0, s46, 59392
s_nop 0
buffer_load_dwordx4 v33, s[32:35], s54 offen lds
s_add_u32 s53, s53, 16384
s_add_u32 s54, s54, s57
s_add_u32 m0, s45, 86016
s_nop 0
buffer_load_dwordx4 v21, s[20:23], s53 offen lds
s_add_u32 m0, s45, 87040
s_nop 0
buffer_load_dwordx4 v22, s[20:23], s53 offen lds
s_add_u32 m0, s45, 88064
s_nop 0
buffer_load_dwordx4 v23, s[20:23], s53 offen lds
s_add_u32 m0, s45, 89088
s_nop 0
buffer_load_dwordx4 v24, s[20:23], s53 offen lds
s_add_u32 m0, s46, 86016
s_nop 0
buffer_load_dwordx4 v31, s[32:35], s54 offen lds
s_add_u32 m0, s46, 87040
s_nop 0
buffer_load_dwordx4 v32, s[32:35], s54 offen lds
s_add_u32 m0, s46, 88064
s_nop 0
buffer_load_dwordx4 v33, s[32:35], s54 offen lds
s_add_u32 s53, s53, 16384
s_add_u32 s54, s54, s57
L_g1_task_A:
s_mov_b32 s52, s84
s_mov_b32 s59, s85
s_mov_b32 s58, s86
s_cmp_eq_u32 s58, 1
s_cbranch_scc1 L_g1_v_A
s_waitcnt vmcnt(21)
s_barrier
ds_read_b128 v[44:47], v34 offset:0
ds_read_b128 v[48:51], v34 offset:2048
ds_read_b128 v[52:55], v34 offset:4096
ds_read_b128 v[56:59], v34 offset:6144
ds_read_b64_tr_b16 v[76:77], v36 offset:0
ds_read_b64_tr_b16 v[78:79], v37 offset:0
ds_read_b64_tr_b16 v[80:81], v40 offset:0
ds_read_b64_tr_b16 v[82:83], v41 offset:0
ds_read_b64_tr_b16 v[84:85], v36 offset:128
ds_read_b64_tr_b16 v[86:87], v37 offset:128
s_waitcnt lgkmcnt(0)
v_mfma_f32_32x32x16_bf16 a[0:15], v[76:79], v[44:47], 0
ds_read_b128 v[60:63], v35 offset:0
v_mfma_f32_32x32x16_bf16 a[16:31], v[80:83], v[44:47], 0
ds_read_b128 v[64:67], v35 offset:2048
v_mfma_f32_32x32x16_bf16 a[32:47], v[84:87], v[44:47], 0
ds_read_b128 v[68:71], v35 offset:4096
v_mfma_f32_32x32x16_bf16 a[48:63], v[76:79], v[48:51], 0
ds_read_b128 v[72:75], v35 offset:6144
v_mfma_f32_32x32x16_bf16 a[64:79], v[80:83], v[48:51], 0
ds_read_b64_tr_b16 v[88:89], v38 offset:0
ds_read_b64_tr_b16 v[90:91], v39 offset:0
v_mfma_f32_32x32x16_bf16 a[80:95], v[84:87], v[48:51], 0
ds_read_b64_tr_b16 v[92:93], v42 offset:0
ds_read_b64_tr_b16 v[94:95], v43 offset:0
v_mfma_f32_32x32x16_bf16 a[96:111], v[76:79], v[52:55], 0
ds_read_b64_tr_b16 v[96:97], v38 offset:128
ds_read_b64_tr_b16 v[98:99], v39 offset:128
v_mfma_f32_32x32x16_bf16 a[112:127], v[80:83], v[52:55], 0
v_mfma_f32_32x32x16_bf16 a[128:143], v[84:87], v[52:55], 0
v_mfma_f32_32x32x16_bf16 a[144:159], v[76:79], v[56:59], 0
v_mfma_f32_32x32x16_bf16 a[160:175], v[80:83], v[56:59], 0
v_mfma_f32_32x32x16_bf16 a[176:191], v[84:87], v[56:59], 0
s_waitcnt lgkmcnt(0)
s_waitcnt vmcnt(14)
s_barrier
v_mfma_f32_32x32x16_bf16 a[0:15], v[88:91], v[60:63], a[0:15]
ds_read_b128 v[44:47], v34 offset:28672
ds_read_b128 v[48:51], v34 offset:30720
v_mfma_f32_32x32x16_bf16 a[16:31], v[92:95], v[60:63], a[16:31]
ds_read_b128 v[52:55], v34 offset:32768
ds_read_b128 v[56:59], v34 offset:34816
v_mfma_f32_32x32x16_bf16 a[32:47], v[96:99], v[60:63], a[32:47]
ds_read_b64_tr_b16 v[76:77], v36 offset:28672
ds_read_b64_tr_b16 v[78:79], v37 offset:28672
ds_read_b64_tr_b16 v[80:81], v40 offset:28672
ds_read_b64_tr_b16 v[82:83], v41 offset:28672
v_mfma_f32_32x32x16_bf16 a[48:63], v[88:91], v[64:67], a[48:63]
ds_read_b64_tr_b16 v[84:85], v36 offset:28800
ds_read_b64_tr_b16 v[86:87], v37 offset:28800
s_add_u32 m0, s45, 0
s_nop 0
buffer_load_dwordx4 v21, s[20:23], s53 offen lds
v_mfma_f32_32x32x16_bf16 a[64:79], v[92:95], v[64:67], a[64:79]
s_add_u32 m0, s45, 1024
s_nop 0
buffer_load_dwordx4 v22, s[20:23], s53 offen lds
s_add_u32 m0, s45, 2048
s_nop 0
buffer_load_dwordx4 v23, s[20:23], s53 offen lds
v_mfma_f32_32x32x16_bf16 a[80:95], v[96:99], v[64:67], a[80:95]
s_add_u32 m0, s45, 3072
s_nop 0
buffer_load_dwordx4 v24, s[20:23], s53 offen lds
s_add_u32 m0, s46, 0
s_nop 0
buffer_load_dwordx4 v31, s[32:35], s54 offen lds
v_mfma_f32_32x32x16_bf16 a[96:111], v[88:91], v[68:71], a[96:111]
s_add_u32 m0, s46, 1024
s_nop 0
buffer_load_dwordx4 v32, s[32:35], s54 offen lds
s_add_u32 m0, s46, 2048
s_nop 0
buffer_load_dwordx4 v33, s[32:35], s54 offen lds
s_add_u32 s53, s53, 16384
s_add_u32 s54, s54, s57
v_mfma_f32_32x32x16_bf16 a[112:127], v[92:95], v[68:71], a[112:127]
v_mfma_f32_32x32x16_bf16 a[128:143], v[96:99], v[68:71], a[128:143]
v_mfma_f32_32x32x16_bf16 a[144:159], v[88:91], v[72:75], a[144:159]
v_mfma_f32_32x32x16_bf16 a[160:175], v[92:95], v[72:75], a[160:175]
v_mfma_f32_32x32x16_bf16 a[176:191], v[96:99], v[72:75], a[176:191]
s_waitcnt lgkmcnt(0)
v_mfma_f32_32x32x16_bf16 a[0:15], v[76:79], v[44:47], a[0:15]
ds_read_b128 v[60:63], v35 offset:28672
v_mfma_f32_32x32x16_bf16 a[16:31], v[80:83], v[44:47], a[16:31]
ds_read_b128 v[64:67], v35 offset:30720
v_mfma_f32_32x32x16_bf16 a[32:47], v[84:87], v[44:47], a[32:47]
ds_read_b128 v[68:71], v35 offset:32768
v_mfma_f32_32x32x16_bf16 a[48:63], v[76:79], v[48:51], a[48:63]
ds_read_b128 v[72:75], v35 offset:34816
v_mfma_f32_32x32x16_bf16 a[64:79], v[80:83], v[48:51], a[64:79]
ds_read_b64_tr_b16 v[88:89], v38 offset:28672
ds_read_b64_tr_b16 v[90:91], v39 offset:28672
v_mfma_f32_32x32x16_bf16 a[80:95], v[84:87], v[48:51], a[80:95]
ds_read_b64_tr_b16 v[92:93], v42 offset:28672
ds_read_b64_tr_b16 v[94:95], v43 offset:28672
v_mfma_f32_32x32x16_bf16 a[96:111], v[76:79], v[52:55], a[96:111]
ds_read_b64_tr_b16 v[96:97], v38 offset:28800
ds_read_b64_tr_b16 v[98:99], v39 offset:28800
v_mfma_f32_32x32x16_bf16 a[112:127], v[80:83], v[52:55], a[112:127]
v_mfma_f32_32x32x16_bf16 a[128:143], v[84:87], v[52:55], a[128:143]
v_mfma_f32_32x32x16_bf16 a[144:159], v[76:79], v[56:59], a[144:159]
v_mfma_f32_32x32x16_bf16 a[160:175], v[80:83], v[56:59], a[160:175]
v_mfma_f32_32x32x16_bf16 a[176:191], v[84:87], v[56:59], a[176:191]
s_waitcnt lgkmcnt(0)
s_waitcnt vmcnt(14)
s_barrier
v_mfma_f32_32x32x16_bf16 a[0:15], v[88:91], v[60:63], a[0:15]
ds_read_b128 v[44:47], v100 offset:0
ds_read_b128 v[48:51], v100 offset:2048
v_mfma_f32_32x32x16_bf16 a[16:31], v[92:95], v[60:63], a[16:31]
ds_read_b128 v[52:55], v100 offset:4096
ds_read_b128 v[56:59], v100 offset:6144
v_mfma_f32_32x32x16_bf16 a[32:47], v[96:99], v[60:63], a[32:47]
ds_read_b64_tr_b16 v[76:77], v102 offset:0
ds_read_b64_tr_b16 v[78:79], v103 offset:0
ds_read_b64_tr_b16 v[80:81], v106 offset:0
ds_read_b64_tr_b16 v[82:83], v107 offset:0
v_mfma_f32_32x32x16_bf16 a[48:63], v[88:91], v[64:67], a[48:63]
ds_read_b64_tr_b16 v[84:85], v102 offset:128
ds_read_b64_tr_b16 v[86:87], v103 offset:128
s_add_u32 m0, s45, 28672
s_nop 0
buffer_load_dwordx4 v21, s[20:23], s53 offen lds
v_mfma_f32_32x32x16_bf16 a[64:79], v[92:95], v[64:67], a[64:79]
s_add_u32 m0, s45, 29696
s_nop 0
buffer_load_dwordx4 v22, s[20:23], s53 offen lds
s_add_u32 m0, s45, 30720
s_nop 0
buffer_load_dwordx4 v23, s[20:23], s53 offen lds
v_mfma_f32_32x32x16_bf16 a[80:95], v[96:99], v[64:67], a[80:95]
s_add_u32 m0, s45, 31744
s_nop 0
buffer_load_dwordx4 v24, s[20:23], s53 offen lds
s_add_u32 m0, s46, 28672
s_nop 0
buffer_load_dwordx4 v31, s[32:35], s54 offen lds
v_mfma_f32_32x32x16_bf16 a[96:111], v[88:91], v[68:71], a[96:111]
s_add_u32 m0, s46, 29696
s_nop 0
buffer_load_dwordx4 v32, s[32:35], s54 offen lds
s_add_u32 m0, s46, 30720
s_nop 0
buffer_load_dwordx4 v33, s[32:35], s54 offen lds
s_add_u32 s53, s53, 16384
s_add_u32 s54, s54, s57
v_mfma_f32_32x32x16_bf16 a[112:127], v[92:95], v[68:71], a[112:127]
v_mfma_f32_32x32x16_bf16 a[128:143], v[96:99], v[68:71], a[128:143]
v_mfma_f32_32x32x16_bf16 a[144:159], v[88:91], v[72:75], a[144:159]
v_mfma_f32_32x32x16_bf16 a[160:175], v[92:95], v[72:75], a[160:175]
v_mfma_f32_32x32x16_bf16 a[176:191], v[96:99], v[72:75], a[176:191]
s_waitcnt lgkmcnt(0)
v_mfma_f32_32x32x16_bf16 a[0:15], v[76:79], v[44:47], a[0:15]
ds_read_b128 v[60:63], v101 offset:0
v_mfma_f32_32x32x16_bf16 a[16:31], v[80:83], v[44:47], a[16:31]
ds_read_b128 v[64:67], v101 offset:2048
v_mfma_f32_32x32x16_bf16 a[32:47], v[84:87], v[44:47], a[32:47]
ds_read_b128 v[68:71], v101 offset:4096
v_mfma_f32_32x32x16_bf16 a[48:63], v[76:79], v[48:51], a[48:63]
ds_read_b128 v[72:75], v101 offset:6144
v_mfma_f32_32x32x16_bf16 a[64:79], v[80:83], v[48:51], a[64:79]
ds_read_b64_tr_b16 v[88:89], v104 offset:0
ds_read_b64_tr_b16 v[90:91], v105 offset:0
v_mfma_f32_32x32x16_bf16 a[80:95], v[84:87], v[48:51], a[80:95]
ds_read_b64_tr_b16 v[92:93], v108 offset:0
ds_read_b64_tr_b16 v[94:95], v109 offset:0
v_mfma_f32_32x32x16_bf16 a[96:111], v[76:79], v[52:55], a[96:111]
ds_read_b64_tr_b16 v[96:97], v104 offset:128
ds_read_b64_tr_b16 v[98:99], v105 offset:128
v_mfma_f32_32x32x16_bf16 a[112:127], v[80:83], v[52:55], a[112:127]
v_mfma_f32_32x32x16_bf16 a[128:143], v[84:87], v[52:55], a[128:143]
v_mfma_f32_32x32x16_bf16 a[144:159], v[76:79], v[56:59], a[144:159]
v_mfma_f32_32x32x16_bf16 a[160:175], v[80:83], v[56:59], a[160:175]
v_mfma_f32_32x32x16_bf16 a[176:191], v[84:87], v[56:59], a[176:191]
s_waitcnt lgkmcnt(0)
s_waitcnt vmcnt(14)
s_barrier
v_mfma_f32_32x32x16_bf16 a[0:15], v[88:91], v[60:63], a[0:15]
ds_read_b128 v[44:47], v100 offset:28672
ds_read_b128 v[48:51], v100 offset:30720
v_mfma_f32_32x32x16_bf16 a[16:31], v[92:95], v[60:63], a[16:31]
ds_read_b128 v[52:55], v100 offset:32768
ds_read_b128 v[56:59], v100 offset:34816
v_mfma_f32_32x32x16_bf16 a[32:47], v[96:99], v[60:63], a[32:47]
ds_read_b64_tr_b16 v[76:77], v102 offset:28672
ds_read_b64_tr_b16 v[78:79], v103 offset:28672
ds_read_b64_tr_b16 v[80:81], v106 offset:28672
ds_read_b64_tr_b16 v[82:83], v107 offset:28672
v_mfma_f32_32x32x16_bf16 a[48:63], v[88:91], v[64:67], a[48:63]
ds_read_b64_tr_b16 v[84:85], v102 offset:28800
ds_read_b64_tr_b16 v[86:87], v103 offset:28800
s_add_u32 m0, s45, 57344
s_nop 0
buffer_load_dwordx4 v21, s[20:23], s53 offen lds
v_mfma_f32_32x32x16_bf16 a[64:79], v[92:95], v[64:67], a[64:79]
s_add_u32 m0, s45, 58368
s_nop 0
buffer_load_dwordx4 v22, s[20:23], s53 offen lds
s_add_u32 m0, s45, 59392
s_nop 0
buffer_load_dwordx4 v23, s[20:23], s53 offen lds
v_mfma_f32_32x32x16_bf16 a[80:95], v[96:99], v[64:67], a[80:95]
s_add_u32 m0, s45, 60416
s_nop 0
buffer_load_dwordx4 v24, s[20:23], s53 offen lds
s_add_u32 m0, s46, 57344
s_nop 0
buffer_load_dwordx4 v31, s[32:35], s54 offen lds
v_mfma_f32_32x32x16_bf16 a[96:111], v[88:91], v[68:71], a[96:111]
s_add_u32 m0, s46, 58368
s_nop 0
buffer_load_dwordx4 v32, s[32:35], s54 offen lds
s_add_u32 m0, s46, 59392
s_nop 0
buffer_load_dwordx4 v33, s[32:35], s54 offen lds
s_add_u32 s53, s53, 16384
s_add_u32 s54, s54, s57
v_mfma_f32_32x32x16_bf16 a[112:127], v[92:95], v[68:71], a[112:127]
v_mfma_f32_32x32x16_bf16 a[128:143], v[96:99], v[68:71], a[128:143]
v_mfma_f32_32x32x16_bf16 a[144:159], v[88:91], v[72:75], a[144:159]
v_mfma_f32_32x32x16_bf16 a[160:175], v[92:95], v[72:75], a[160:175]
v_mfma_f32_32x32x16_bf16 a[176:191], v[96:99], v[72:75], a[176:191]
s_waitcnt lgkmcnt(0)
v_mfma_f32_32x32x16_bf16 a[0:15], v[76:79], v[44:47], a[0:15]
ds_read_b128 v[60:63], v101 offset:28672
v_mfma_f32_32x32x16_bf16 a[16:31], v[80:83], v[44:47], a[16:31]
ds_read_b128 v[64:67], v101 offset:30720
v_mfma_f32_32x32x16_bf16 a[32:47], v[84:87], v[44:47], a[32:47]
ds_read_b128 v[68:71], v101 offset:32768
v_mfma_f32_32x32x16_bf16 a[48:63], v[76:79], v[48:51], a[48:63]
ds_read_b128 v[72:75], v101 offset:34816
v_mfma_f32_32x32x16_bf16 a[64:79], v[80:83], v[48:51], a[64:79]
ds_read_b64_tr_b16 v[88:89], v104 offset:28672
ds_read_b64_tr_b16 v[90:91], v105 offset:28672
v_mfma_f32_32x32x16_bf16 a[80:95], v[84:87], v[48:51], a[80:95]
ds_read_b64_tr_b16 v[92:93], v108 offset:28672
ds_read_b64_tr_b16 v[94:95], v109 offset:28672
v_mfma_f32_32x32x16_bf16 a[96:111], v[76:79], v[52:55], a[96:111]
ds_read_b64_tr_b16 v[96:97], v104 offset:28800
ds_read_b64_tr_b16 v[98:99], v105 offset:28800
v_mfma_f32_32x32x16_bf16 a[112:127], v[80:83], v[52:55], a[112:127]
v_mfma_f32_32x32x16_bf16 a[128:143], v[84:87], v[52:55], a[128:143]
v_mfma_f32_32x32x16_bf16 a[144:159], v[76:79], v[56:59], a[144:159]
v_mfma_f32_32x32x16_bf16 a[160:175], v[80:83], v[56:59], a[160:175]
v_mfma_f32_32x32x16_bf16 a[176:191], v[84:87], v[56:59], a[176:191]
s_waitcnt lgkmcnt(0)
s_waitcnt vmcnt(14)
s_barrier
v_mfma_f32_32x32x16_bf16 a[0:15], v[88:91], v[60:63], a[0:15]
ds_read_b128 v[44:47], v34 offset:0
ds_read_b128 v[48:51], v34 offset:2048
v_mfma_f32_32x32x16_bf16 a[16:31], v[92:95], v[60:63], a[16:31]
ds_read_b128 v[52:55], v34 offset:4096
ds_read_b128 v[56:59], v34 offset:6144
v_mfma_f32_32x32x16_bf16 a[32:47], v[96:99], v[60:63], a[32:47]
ds_read_b64_tr_b16 v[76:77], v36 offset:0
ds_read_b64_tr_b16 v[78:79], v37 offset:0
ds_read_b64_tr_b16 v[80:81], v40 offset:0
ds_read_b64_tr_b16 v[82:83], v41 offset:0
v_mfma_f32_32x32x16_bf16 a[48:63], v[88:91], v[64:67], a[48:63]
ds_read_b64_tr_b16 v[84:85], v36 offset:128
ds_read_b64_tr_b16 v[86:87], v37 offset:128
s_add_u32 m0, s45, 86016
s_nop 0
buffer_load_dwordx4 v21, s[20:23], s53 offen lds
v_mfma_f32_32x32x16_bf16 a[64:79], v[92:95], v[64:67], a[64:79]
s_add_u32 m0, s45, 87040
s_nop 0
buffer_load_dwordx4 v22, s[20:23], s53 offen lds
s_add_u32 m0, s45, 88064
s_nop 0
buffer_load_dwordx4 v23, s[20:23], s53 offen lds
v_mfma_f32_32x32x16_bf16 a[80:95], v[96:99], v[64:67], a[80:95]
s_add_u32 m0, s45, 89088
s_nop 0
buffer_load_dwordx4 v24, s[20:23], s53 offen lds
s_add_u32 m0, s46, 86016
s_nop 0
buffer_load_dwordx4 v31, s[32:35], s54 offen lds
v_mfma_f32_32x32x16_bf16 a[96:111], v[88:91], v[68:71], a[96:111]
s_add_u32 m0, s46, 87040
s_nop 0
buffer_load_dwordx4 v32, s[32:35], s54 offen lds
s_add_u32 m0, s46, 88064
s_nop 0
buffer_load_dwordx4 v33, s[32:35], s54 offen lds
s_add_u32 s53, s53, 16384
s_add_u32 s54, s54, s57
v_mfma_f32_32x32x16_bf16 a[112:127], v[92:95], v[68:71], a[112:127]
v_mfma_f32_32x32x16_bf16 a[128:143], v[96:99], v[68:71], a[128:143]
v_mfma_f32_32x32x16_bf16 a[144:159], v[88:91], v[72:75], a[144:159]
v_mfma_f32_32x32x16_bf16 a[160:175], v[92:95], v[72:75], a[160:175]
v_mfma_f32_32x32x16_bf16 a[176:191], v[96:99], v[72:75], a[176:191]
s_mov_b32 s42, 3
s_cmp_eq_u32 s42, 0
s_cbranch_scc1 L_g1_wx_last_A
s_nop 8
L_g1_wx_A:
s_waitcnt lgkmcnt(0)
v_mfma_f32_32x32x16_bf16 a[0:15], v[76:79], v[44:47], a[0:15]
ds_read_b128 v[60:63], v35 offset:0
v_mfma_f32_32x32x16_bf16 a[16:31], v[80:83], v[44:47], a[16:31]
ds_read_b128 v[64:67], v35 offset:2048
v_mfma_f32_32x32x16_bf16 a[32:47], v[84:87], v[44:47], a[32:47]
ds_read_b128 v[68:71], v35 offset:4096
v_mfma_f32_32x32x16_bf16 a[48:63], v[76:79], v[48:51], a[48:63]
ds_read_b128 v[72:75], v35 offset:6144
v_mfma_f32_32x32x16_bf16 a[64:79], v[80:83], v[48:51], a[64:79]
ds_read_b64_tr_b16 v[88:89], v38 offset:0
ds_read_b64_tr_b16 v[90:91], v39 offset:0
v_mfma_f32_32x32x16_bf16 a[80:95], v[84:87], v[48:51], a[80:95]
ds_read_b64_tr_b16 v[92:93], v42 offset:0
ds_read_b64_tr_b16 v[94:95], v43 offset:0
v_mfma_f32_32x32x16_bf16 a[96:111], v[76:79], v[52:55], a[96:111]
ds_read_b64_tr_b16 v[96:97], v38 offset:128
ds_read_b64_tr_b16 v[98:99], v39 offset:128
v_mfma_f32_32x32x16_bf16 a[112:127], v[80:83], v[52:55], a[112:127]
v_mfma_f32_32x32x16_bf16 a[128:143], v[84:87], v[52:55], a[128:143]
v_mfma_f32_32x32x16_bf16 a[144:159], v[76:79], v[56:59], a[144:159]
v_mfma_f32_32x32x16_bf16 a[160:175], v[80:83], v[56:59], a[160:175]
v_mfma_f32_32x32x16_bf16 a[176:191], v[84:87], v[56:59], a[176:191]
s_waitcnt lgkmcnt(0)
s_waitcnt vmcnt(14)
s_barrier
v_mfma_f32_32x32x16_bf16 a[0:15], v[88:91], v[60:63], a[0:15]
ds_read_b128 v[44:47], v34 offset:28672
ds_read_b128 v[48:51], v34 offset:30720
v_mfma_f32_32x32x16_bf16 a[16:31], v[92:95], v[60:63], a[16:31]
ds_read_b128 v[52:55], v34 offset:32768
ds_read_b128 v[56:59], v34 offset:34816
v_mfma_f32_32x32x16_bf16 a[32:47], v[96:99], v[60:63], a[32:47]
ds_read_b64_tr_b16 v[76:77], v36 offset:28672
ds_read_b64_tr_b16 v[78:79], v37 offset:28672
ds_read_b64_tr_b16 v[80:81], v40 offset:28672
ds_read_b64_tr_b16 v[82:83], v41 offset:28672
v_mfma_f32_32x32x16_bf16 a[48:63], v[88:91], v[64:67], a[48:63]
ds_read_b64_tr_b16 v[84:85], v36 offset:28800
ds_read_b64_tr_b16 v[86:87], v37 offset:28800
s_add_u32 m0, s45, 0
s_nop 0
buffer_load_dwordx4 v21, s[20:23], s53 offen lds
v_mfma_f32_32x32x16_bf16 a[64:79], v[92:95], v[64:67], a[64:79]
s_add_u32 m0, s45, 1024
s_nop 0
buffer_load_dwordx4 v22, s[20:23], s53 offen lds
s_add_u32 m0, s45, 2048
s_nop 0
buffer_load_dwordx4 v23, s[20:23], s53 offen lds
v_mfma_f32_32x32x16_bf16 a[80:95], v[96:99], v[64:67], a[80:95]
s_add_u32 m0, s45, 3072
s_nop 0
buffer_load_dwordx4 v24, s[20:23], s53 offen lds
s_add_u32 m0, s46, 0
s_nop 0
buffer_load_dwordx4 v31, s[32:35], s54 offen lds
v_mfma_f32_32x32x16_bf16 a[96:111], v[88:91], v[68:71], a[96:111]
s_add_u32 m0, s46, 1024
s_nop 0
buffer_load_dwordx4 v32, s[32:35], s54 offen lds
s_add_u32 m0, s46, 2048
s_nop 0
buffer_load_dwordx4 v33, s[32:35], s54 offen lds
s_add_u32 s53, s53, 16384
s_add_u32 s54, s54, s57
v_mfma_f32_32x32x16_bf16 a[112:127], v[92:95], v[68:71], a[112:127]
v_mfma_f32_32x32x16_bf16 a[128:143], v[96:99], v[68:71], a[128:143]
v_mfma_f32_32x32x16_bf16 a[144:159], v[88:91], v[72:75], a[144:159]
v_mfma_f32_32x32x16_bf16 a[160:175], v[92:95], v[72:75], a[160:175]
v_mfma_f32_32x32x16_bf16 a[176:191], v[96:99], v[72:75], a[176:191]
s_waitcnt lgkmcnt(0)
v_mfma_f32_32x32x16_bf16 a[0:15], v[76:79], v[44:47], a[0:15]
ds_read_b128 v[60:63], v35 offset:28672
v_mfma_f32_32x32x16_bf16 a[16:31], v[80:83], v[44:47], a[16:31]
ds_read_b128 v[64:67], v35 offset:30720
v_mfma_f32_32x32x16_bf16 a[32:47], v[84:87], v[44:47], a[32:47]
ds_read_b128 v[68:71], v35 offset:32768
v_mfma_f32_32x32x16_bf16 a[48:63], v[76:79], v[48:51], a[48:63]
ds_read_b128 v[72:75], v35 offset:34816
v_mfma_f32_32x32x16_bf16 a[64:79], v[80:83], v[48:51], a[64:79]
ds_read_b64_tr_b16 v[88:89], v38 offset:28672
ds_read_b64_tr_b16 v[90:91], v39 offset:28672
v_mfma_f32_32x32x16_bf16 a[80:95], v[84:87], v[48:51], a[80:95]
ds_read_b64_tr_b16 v[92:93], v42 offset:28672
ds_read_b64_tr_b16 v[94:95], v43 offset:28672
v_mfma_f32_32x32x16_bf16 a[96:111], v[76:79], v[52:55], a[96:111]
ds_read_b64_tr_b16 v[96:97], v38 offset:28800
ds_read_b64_tr_b16 v[98:99], v39 offset:28800
v_mfma_f32_32x32x16_bf16 a[112:127], v[80:83], v[52:55], a[112:127]
v_mfma_f32_32x32x16_bf16 a[128:143], v[84:87], v[52:55], a[128:143]
v_mfma_f32_32x32x16_bf16 a[144:159], v[76:79], v[56:59], a[144:159]
v_mfma_f32_32x32x16_bf16 a[160:175], v[80:83], v[56:59], a[160:175]
v_mfma_f32_32x32x16_bf16 a[176:191], v[84:87], v[56:59], a[176:191]
s_waitcnt lgkmcnt(0)
s_waitcnt vmcnt(14)
s_barrier
v_mfma_f32_32x32x16_bf16 a[0:15], v[88:91], v[60:63], a[0:15]
ds_read_b128 v[44:47], v100 offset:0
ds_read_b128 v[48:51], v100 offset:2048
v_mfma_f32_32x32x16_bf16 a[16:31], v[92:95], v[60:63], a[16:31]
ds_read_b128 v[52:55], v100 offset:4096
ds_read_b128 v[56:59], v100 offset:6144
v_mfma_f32_32x32x16_bf16 a[32:47], v[96:99], v[60:63], a[32:47]
ds_read_b64_tr_b16 v[76:77], v102 offset:0
ds_read_b64_tr_b16 v[78:79], v103 offset:0
ds_read_b64_tr_b16 v[80:81], v106 offset:0
ds_read_b64_tr_b16 v[82:83], v107 offset:0
v_mfma_f32_32x32x16_bf16 a[48:63], v[88:91], v[64:67], a[48:63]
ds_read_b64_tr_b16 v[84:85], v102 offset:128
ds_read_b64_tr_b16 v[86:87], v103 offset:128
s_add_u32 m0, s45, 28672
s_nop 0
buffer_load_dwordx4 v21, s[20:23], s53 offen lds
v_mfma_f32_32x32x16_bf16 a[64:79], v[92:95], v[64:67], a[64:79]
s_add_u32 m0, s45, 29696
s_nop 0
buffer_load_dwordx4 v22, s[20:23], s53 offen lds
s_add_u32 m0, s45, 30720
s_nop 0
buffer_load_dwordx4 v23, s[20:23], s53 offen lds
v_mfma_f32_32x32x16_bf16 a[80:95], v[96:99], v[64:67], a[80:95]
s_add_u32 m0, s45, 31744
s_nop 0
buffer_load_dwordx4 v24, s[20:23], s53 offen lds
s_add_u32 m0, s46, 28672
s_nop 0
buffer_load_dwordx4 v31, s[32:35], s54 offen lds
v_mfma_f32_32x32x16_bf16 a[96:111], v[88:91], v[68:71], a[96:111]
s_add_u32 m0, s46, 29696
s_nop 0
buffer_load_dwordx4 v32, s[32:35], s54 offen lds
s_add_u32 m0, s46, 30720
s_nop 0
buffer_load_dwordx4 v33, s[32:35], s54 offen lds
s_add_u32 s53, s53, 16384
s_add_u32 s54, s54, s57
v_mfma_f32_32x32x16_bf16 a[112:127], v[92:95], v[68:71], a[112:127]
v_mfma_f32_32x32x16_bf16 a[128:143], v[96:99], v[68:71], a[128:143]
v_mfma_f32_32x32x16_bf16 a[144:159], v[88:91], v[72:75], a[144:159]
v_mfma_f32_32x32x16_bf16 a[160:175], v[92:95], v[72:75], a[160:175]
v_mfma_f32_32x32x16_bf16 a[176:191], v[96:99], v[72:75], a[176:191]
s_waitcnt lgkmcnt(0)
v_mfma_f32_32x32x16_bf16 a[0:15], v[76:79], v[44:47], a[0:15]
ds_read_b128 v[60:63], v101 offset:0
v_mfma_f32_32x32x16_bf16 a[16:31], v[80:83], v[44:47], a[16:31]
ds_read_b128 v[64:67], v101 offset:2048
v_mfma_f32_32x32x16_bf16 a[32:47], v[84:87], v[44:47], a[32:47]
ds_read_b128 v[68:71], v101 offset:4096
v_mfma_f32_32x32x16_bf16 a[48:63], v[76:79], v[48:51], a[48:63]
ds_read_b128 v[72:75], v101 offset:6144
v_mfma_f32_32x32x16_bf16 a[64:79], v[80:83], v[48:51], a[64:79]
ds_read_b64_tr_b16 v[88:89], v104 offset:0
ds_read_b64_tr_b16 v[90:91], v105 offset:0
v_mfma_f32_32x32x16_bf16 a[80:95], v[84:87], v[48:51], a[80:95]
ds_read_b64_tr_b16 v[92:93], v108 offset:0
ds_read_b64_tr_b16 v[94:95], v109 offset:0
v_mfma_f32_32x32x16_bf16 a[96:111], v[76:79], v[52:55], a[96:111]
ds_read_b64_tr_b16 v[96:97], v104 offset:128
ds_read_b64_tr_b16 v[98:99], v105 offset:128
v_mfma_f32_32x32x16_bf16 a[112:127], v[80:83], v[52:55], a[112:127]
v_mfma_f32_32x32x16_bf16 a[128:143], v[84:87], v[52:55], a[128:143]
v_mfma_f32_32x32x16_bf16 a[144:159], v[76:79], v[56:59], a[144:159]
v_mfma_f32_32x32x16_bf16 a[160:175], v[80:83], v[56:59], a[160:175]
v_mfma_f32_32x32x16_bf16 a[176:191], v[84:87], v[56:59], a[176:191]
s_waitcnt lgkmcnt(0)
s_waitcnt vmcnt(14)
s_barrier
v_mfma_f32_32x32x16_bf16 a[0:15], v[88:91], v[60:63], a[0:15]
ds_read_b128 v[44:47], v100 offset:28672
ds_read_b128 v[48:51], v100 offset:30720
v_mfma_f32_32x32x16_bf16 a[16:31], v[92:95], v[60:63], a[16:31]
ds_read_b128 v[52:55], v100 offset:32768
ds_read_b128 v[56:59], v100 offset:34816
v_mfma_f32_32x32x16_bf16 a[32:47], v[96:99], v[60:63], a[32:47]
ds_read_b64_tr_b16 v[76:77], v102 offset:28672
ds_read_b64_tr_b16 v[78:79], v103 offset:28672
ds_read_b64_tr_b16 v[80:81], v106 offset:28672
ds_read_b64_tr_b16 v[82:83], v107 offset:28672
v_mfma_f32_32x32x16_bf16 a[48:63], v[88:91], v[64:67], a[48:63]
ds_read_b64_tr_b16 v[84:85], v102 offset:28800
ds_read_b64_tr_b16 v[86:87], v103 offset:28800
s_add_u32 m0, s45, 57344
s_nop 0
buffer_load_dwordx4 v21, s[20:23], s53 offen lds
v_mfma_f32_32x32x16_bf16 a[64:79], v[92:95], v[64:67], a[64:79]
s_add_u32 m0, s45, 58368
s_nop 0
buffer_load_dwordx4 v22, s[20:23], s53 offen lds
s_add_u32 m0, s45, 59392
s_nop 0
buffer_load_dwordx4 v23, s[20:23], s53 offen lds
v_mfma_f32_32x32x16_bf16 a[80:95], v[96:99], v[64:67], a[80:95]
s_add_u32 m0, s45, 60416
s_nop 0
buffer_load_dwordx4 v24, s[20:23], s53 offen lds
s_add_u32 m0, s46, 57344
s_nop 0
buffer_load_dwordx4 v31, s[32:35], s54 offen lds
v_mfma_f32_32x32x16_bf16 a[96:111], v[88:91], v[68:71], a[96:111]
s_add_u32 m0, s46, 58368
s_nop 0
buffer_load_dwordx4 v32, s[32:35], s54 offen lds
s_add_u32 m0, s46, 59392
s_nop 0
buffer_load_dwordx4 v33, s[32:35], s54 offen lds
s_add_u32 s53, s53, 16384
s_add_u32 s54, s54, s57
v_mfma_f32_32x32x16_bf16 a[112:127], v[92:95], v[68:71], a[112:127]
v_mfma_f32_32x32x16_bf16 a[128:143], v[96:99], v[68:71], a[128:143]
v_mfma_f32_32x32x16_bf16 a[144:159], v[88:91], v[72:75], a[144:159]
v_mfma_f32_32x32x16_bf16 a[160:175], v[92:95], v[72:75], a[160:175]
v_mfma_f32_32x32x16_bf16 a[176:191], v[96:99], v[72:75], a[176:191]
s_waitcnt lgkmcnt(0)
v_mfma_f32_32x32x16_bf16 a[0:15], v[76:79], v[44:47], a[0:15]
ds_read_b128 v[60:63], v101 offset:28672
v_mfma_f32_32x32x16_bf16 a[16:31], v[80:83], v[44:47], a[16:31]
ds_read_b128 v[64:67], v101 offset:30720
v_mfma_f32_32x32x16_bf16 a[32:47], v[84:87], v[44:47], a[32:47]
ds_read_b128 v[68:71], v101 offset:32768
v_mfma_f32_32x32x16_bf16 a[48:63], v[76:79], v[48:51], a[48:63]
ds_read_b128 v[72:75], v101 offset:34816
v_mfma_f32_32x32x16_bf16 a[64:79], v[80:83], v[48:51], a[64:79]
ds_read_b64_tr_b16 v[88:89], v104 offset:28672
ds_read_b64_tr_b16 v[90:91], v105 offset:28672
v_mfma_f32_32x32x16_bf16 a[80:95], v[84:87], v[48:51], a[80:95]
ds_read_b64_tr_b16 v[92:93], v108 offset:28672
ds_read_b64_tr_b16 v[94:95], v109 offset:28672
v_mfma_f32_32x32x16_bf16 a[96:111], v[76:79], v[52:55], a[96:111]
ds_read_b64_tr_b16 v[96:97], v104 offset:28800
ds_read_b64_tr_b16 v[98:99], v105 offset:28800
v_mfma_f32_32x32x16_bf16 a[112:127], v[80:83], v[52:55], a[112:127]
v_mfma_f32_32x32x16_bf16 a[128:143], v[84:87], v[52:55], a[128:143]
v_mfma_f32_32x32x16_bf16 a[144:159], v[76:79], v[56:59], a[144:159]
v_mfma_f32_32x32x16_bf16 a[160:175], v[80:83], v[56:59], a[160:175]
v_mfma_f32_32x32x16_bf16 a[176:191], v[84:87], v[56:59], a[176:191]
s_waitcnt lgkmcnt(0)
s_waitcnt vmcnt(14)
s_barrier
v_mfma_f32_32x32x16_bf16 a[0:15], v[88:91], v[60:63], a[0:15]
ds_read_b128 v[44:47], v34 offset:0
ds_read_b128 v[48:51], v34 offset:2048
v_mfma_f32_32x32x16_bf16 a[16:31], v[92:95], v[60:63], a[16:31]
ds_read_b128 v[52:55], v34 offset:4096
ds_read_b128 v[56:59], v34 offset:6144
v_mfma_f32_32x32x16_bf16 a[32:47], v[96:99], v[60:63], a[32:47]
ds_read_b64_tr_b16 v[76:77], v36 offset:0
ds_read_b64_tr_b16 v[78:79], v37 offset:0
ds_read_b64_tr_b16 v[80:81], v40 offset:0
ds_read_b64_tr_b16 v[82:83], v41 offset:0
v_mfma_f32_32x32x16_bf16 a[48:63], v[88:91], v[64:67], a[48:63]
ds_read_b64_tr_b16 v[84:85], v36 offset:128
ds_read_b64_tr_b16 v[86:87], v37 offset:128
s_add_u32 m0, s45, 86016
s_nop 0
buffer_load_dwordx4 v21, s[20:23], s53 offen lds
v_mfma_f32_32x32x16_bf16 a[64:79], v[92:95], v[64:67], a[64:79]
s_add_u32 m0, s45, 87040
s_nop 0
buffer_load_dwordx4 v22, s[20:23], s53 offen lds
s_add_u32 m0, s45, 88064
s_nop 0
buffer_load_dwordx4 v23, s[20:23], s53 offen lds
v_mfma_f32_32x32x16_bf16 a[80:95], v[96:99], v[64:67], a[80:95]
s_add_u32 m0, s45, 89088
s_nop 0
buffer_load_dwordx4 v24, s[20:23], s53 offen lds
s_add_u32 m0, s46, 86016
s_nop 0
buffer_load_dwordx4 v31, s[32:35], s54 offen lds
v_mfma_f32_32x32x16_bf16 a[96:111], v[88:91], v[68:71], a[96:111]
s_add_u32 m0, s46, 87040
s_nop 0
buffer_load_dwordx4 v32, s[32:35], s54 offen lds
s_add_u32 m0, s46, 88064
s_nop 0
buffer_load_dwordx4 v33, s[32:35], s54 offen lds
s_add_u32 s53, s53, 16384
s_add_u32 s54, s54, s57
v_mfma_f32_32x32x16_bf16 a[112:127], v[92:95], v[68:71], a[112:127]
v_mfma_f32_32x32x16_bf16 a[128:143], v[96:99], v[68:71], a[128:143]
v_mfma_f32_32x32x16_bf16 a[144:159], v[88:91], v[72:75], a[144:159]
v_mfma_f32_32x32x16_bf16 a[160:175], v[92:95], v[72:75], a[160:175]
v_mfma_f32_32x32x16_bf16 a[176:191], v[96:99], v[72:75], a[176:191]
s_sub_u32 s42, s42, 1
s_cmp_lg_u32 s42, 0
s_nop 9
s_cbranch_scc1 L_g1_wx_A
L_g1_wx_last_A:
s_waitcnt lgkmcnt(0)
v_mfma_f32_32x32x16_bf16 a[0:15], v[76:79], v[44:47], a[0:15]
ds_read_b128 v[60:63], v35 offset:0
v_mfma_f32_32x32x16_bf16 a[16:31], v[80:83], v[44:47], a[16:31]
ds_read_b128 v[64:67], v35 offset:2048
v_mfma_f32_32x32x16_bf16 a[32:47], v[84:87], v[44:47], a[32:47]
ds_read_b128 v[68:71], v35 offset:4096
v_mfma_f32_32x32x16_bf16 a[48:63], v[76:79], v[48:51], a[48:63]
ds_read_b128 v[72:75], v35 offset:6144
v_mfma_f32_32x32x16_bf16 a[64:79], v[80:83], v[48:51], a[64:79]
ds_read_b64_tr_b16 v[88:89], v38 offset:0
ds_read_b64_tr_b16 v[90:91], v39 offset:0
v_mfma_f32_32x32x16_bf16 a[80:95], v[84:87], v[48:51], a[80:95]
ds_read_b64_tr_b16 v[92:93], v42 offset:0
ds_read_b64_tr_b16 v[94:95], v43 offset:0
v_mfma_f32_32x32x16_bf16 a[96:111], v[76:79], v[52:55], a[96:111]
ds_read_b64_tr_b16 v[96:97], v38 offset:128
ds_read_b64_tr_b16 v[98:99], v39 offset:128
v_mfma_f32_32x32x16_bf16 a[112:127], v[80:83], v[52:55], a[112:127]
v_mfma_f32_32x32x16_bf16 a[128:143], v[84:87], v[52:55], a[128:143]
v_mfma_f32_32x32x16_bf16 a[144:159], v[76:79], v[56:59], a[144:159]
v_mfma_f32_32x32x16_bf16 a[160:175], v[80:83], v[56:59], a[160:175]
v_mfma_f32_32x32x16_bf16 a[176:191], v[84:87], v[56:59], a[176:191]
s_waitcnt lgkmcnt(0)
s_waitcnt vmcnt(14)
s_barrier
v_mfma_f32_32x32x16_bf16 a[0:15], v[88:91], v[60:63], a[0:15]
ds_read_b128 v[44:47], v34 offset:28672
v_mfma_f32_32x32x16_bf16 a[16:31], v[92:95], v[60:63], a[16:31]
ds_read_b128 v[48:51], v34 offset:30720
v_mfma_f32_32x32x16_bf16 a[32:47], v[96:99], v[60:63], a[32:47]
ds_read_b128 v[52:55], v34 offset:32768
v_mfma_f32_32x32x16_bf16 a[48:63], v[88:91], v[64:67], a[48:63]
ds_read_b128 v[56:59], v34 offset:34816
v_mfma_f32_32x32x16_bf16 a[64:79], v[92:95], v[64:67], a[64:79]
ds_read_b64_tr_b16 v[76:77], v36 offset:28672
ds_read_b64_tr_b16 v[78:79], v37 offset:28672
v_mfma_f32_32x32x16_bf16 a[80:95], v[96:99], v[64:67], a[80:95]
ds_read_b64_tr_b16 v[80:81], v40 offset:28672
ds_read_b64_tr_b16 v[82:83], v41 offset:28672
v_mfma_f32_32x32x16_bf16 a[96:111], v[88:91], v[68:71], a[96:111]
ds_read_b64_tr_b16 v[84:85], v36 offset:28800
ds_read_b64_tr_b16 v[86:87], v37 offset:28800
v_mfma_f32_32x32x16_bf16 a[112:127], v[92:95], v[68:71], a[112:127]
v_mfma_f32_32x32x16_bf16 a[128:143], v[96:99], v[68:71], a[128:143]
v_mfma_f32_32x32x16_bf16 a[144:159], v[88:91], v[72:75], a[144:159]
v_mfma_f32_32x32x16_bf16 a[160:175], v[92:95], v[72:75], a[160:175]
v_mfma_f32_32x32x16_bf16 a[176:191], v[96:99], v[72:75], a[176:191]
s_waitcnt lgkmcnt(0)
v_mfma_f32_32x32x16_bf16 a[0:15], v[76:79], v[44:47], a[0:15]
ds_read_b128 v[60:63], v35 offset:28672
v_mfma_f32_32x32x16_bf16 a[16:31], v[80:83], v[44:47], a[16:31]
ds_read_b128 v[64:67], v35 offset:30720
v_mfma_f32_32x32x16_bf16 a[32:47], v[84:87], v[44:47], a[32:47]
ds_read_b128 v[68:71], v35 offset:32768
v_mfma_f32_32x32x16_bf16 a[48:63], v[76:79], v[48:51], a[48:63]
ds_read_b128 v[72:75], v35 offset:34816
v_mfma_f32_32x32x16_bf16 a[64:79], v[80:83], v[48:51], a[64:79]
ds_read_b64_tr_b16 v[88:89], v38 offset:28672
ds_read_b64_tr_b16 v[90:91], v39 offset:28672
v_mfma_f32_32x32x16_bf16 a[80:95], v[84:87], v[48:51], a[80:95]
ds_read_b64_tr_b16 v[92:93], v42 offset:28672
ds_read_b64_tr_b16 v[94:95], v43 offset:28672
v_mfma_f32_32x32x16_bf16 a[96:111], v[76:79], v[52:55], a[96:111]
ds_read_b64_tr_b16 v[96:97], v38 offset:28800
ds_read_b64_tr_b16 v[98:99], v39 offset:28800
v_mfma_f32_32x32x16_bf16 a[112:127], v[80:83], v[52:55], a[112:127]
v_mfma_f32_32x32x16_bf16 a[128:143], v[84:87], v[52:55], a[128:143]
v_mfma_f32_32x32x16_bf16 a[144:159], v[76:79], v[56:59], a[144:159]
v_mfma_f32_32x32x16_bf16 a[160:175], v[80:83], v[56:59], a[160:175]
v_mfma_f32_32x32x16_bf16 a[176:191], v[84:87], v[56:59], a[176:191]
s_waitcnt lgkmcnt(0)
s_waitcnt vmcnt(7)
s_barrier
v_mfma_f32_32x32x16_bf16 a[0:15], v[88:91], v[60:63], a[0:15]
ds_read_b128 v[44:47], v100 offset:0
v_mfma_f32_32x32x16_bf16 a[16:31], v[92:95], v[60:63], a[16:31]
ds_read_b128 v[48:51], v100 offset:2048
v_mfma_f32_32x32x16_bf16 a[32:47], v[96:99], v[60:63], a[32:47]
ds_read_b128 v[52:55], v100 offset:4096
v_mfma_f32_32x32x16_bf16 a[48:63], v[88:91], v[64:67], a[48:63]
ds_read_b128 v[56:59], v100 offset:6144
v_mfma_f32_32x32x16_bf16 a[64:79], v[92:95], v[64:67], a[64:79]
ds_read_b64_tr_b16 v[76:77], v102 offset:0
ds_read_b64_tr_b16 v[78:79], v103 offset:0
v_mfma_f32_32x32x16_bf16 a[80:95], v[96:99], v[64:67], a[80:95]
ds_read_b64_tr_b16 v[80:81], v106 offset:0
ds_read_b64_tr_b16 v[82:83], v107 offset:0
v_mfma_f32_32x32x16_bf16 a[96:111], v[88:91], v[68:71], a[96:111]
ds_read_b64_tr_b16 v[84:85], v102 offset:128
ds_read_b64_tr_b16 v[86:87], v103 offset:128
v_mfma_f32_32x32x16_bf16 a[112:127], v[92:95], v[68:71], a[112:127]
v_mfma_f32_32x32x16_bf16 a[128:143], v[96:99], v[68:71], a[128:143]
v_mfma_f32_32x32x16_bf16 a[144:159], v[88:91], v[72:75], a[144:159]
v_mfma_f32_32x32x16_bf16 a[160:175], v[92:95], v[72:75], a[160:175]
v_mfma_f32_32x32x16_bf16 a[176:191], v[96:99], v[72:75], a[176:191]
s_waitcnt lgkmcnt(0)
v_mfma_f32_32x32x16_bf16 a[0:15], v[76:79], v[44:47], a[0:15]
ds_read_b128 v[60:63], v101 offset:0
v_mfma_f32_32x32x16_bf16 a[16:31], v[80:83], v[44:47], a[16:31]
ds_read_b128 v[64:67], v101 offset:2048
v_mfma_f32_32x32x16_bf16 a[32:47], v[84:87], v[44:47], a[32:47]
ds_read_b128 v[68:71], v101 offset:4096
v_mfma_f32_32x32x16_bf16 a[48:63], v[76:79], v[48:51], a[48:63]
ds_read_b128 v[72:75], v101 offset:6144
v_mfma_f32_32x32x16_bf16 a[64:79], v[80:83], v[48:51], a[64:79]
ds_read_b64_tr_b16 v[88:89], v104 offset:0
ds_read_b64_tr_b16 v[90:91], v105 offset:0
v_mfma_f32_32x32x16_bf16 a[80:95], v[84:87], v[48:51], a[80:95]
ds_read_b64_tr_b16 v[92:93], v108 offset:0
ds_read_b64_tr_b16 v[94:95], v109 offset:0
v_mfma_f32_32x32x16_bf16 a[96:111], v[76:79], v[52:55], a[96:111]
ds_read_b64_tr_b16 v[96:97], v104 offset:128
ds_read_b64_tr_b16 v[98:99], v105 offset:128
v_mfma_f32_32x32x16_bf16 a[112:127], v[80:83], v[52:55], a[112:127]
v_mfma_f32_32x32x16_bf16 a[128:143], v[84:87], v[52:55], a[128:143]
v_mfma_f32_32x32x16_bf16 a[144:159], v[76:79], v[56:59], a[144:159]
v_mfma_f32_32x32x16_bf16 a[160:175], v[80:83], v[56:59], a[160:175]
v_mfma_f32_32x32x16_bf16 a[176:191], v[84:87], v[56:59], a[176:191]
s_waitcnt lgkmcnt(0)
s_waitcnt vmcnt(0)
s_barrier
v_mfma_f32_32x32x16_bf16 a[0:15], v[88:91], v[60:63], a[0:15]
ds_read_b128 v[44:47], v100 offset:28672
v_mfma_f32_32x32x16_bf16 a[16:31], v[92:95], v[60:63], a[16:31]
ds_read_b128 v[48:51], v100 offset:30720
v_mfma_f32_32x32x16_bf16 a[32:47], v[96:99], v[60:63], a[32:47]
ds_read_b128 v[52:55], v100 offset:32768
v_mfma_f32_32x32x16_bf16 a[48:63], v[88:91], v[64:67], a[48:63]
ds_read_b128 v[56:59], v100 offset:34816
v_mfma_f32_32x32x16_bf16 a[64:79], v[92:95], v[64:67], a[64:79]
ds_read_b64_tr_b16 v[76:77], v102 offset:28672
ds_read_b64_tr_b16 v[78:79], v103 offset:28672
v_mfma_f32_32x32x16_bf16 a[80:95], v[96:99], v[64:67], a[80:95]
ds_read_b64_tr_b16 v[80:81], v106 offset:28672
ds_read_b64_tr_b16 v[82:83], v107 offset:28672
v_mfma_f32_32x32x16_bf16 a[96:111], v[88:91], v[68:71], a[96:111]
ds_read_b64_tr_b16 v[84:85], v102 offset:28800
ds_read_b64_tr_b16 v[86:87], v103 offset:28800
v_mfma_f32_32x32x16_bf16 a[112:127], v[92:95], v[68:71], a[112:127]
v_mfma_f32_32x32x16_bf16 a[128:143], v[96:99], v[68:71], a[128:143]
v_mfma_f32_32x32x16_bf16 a[144:159], v[88:91], v[72:75], a[144:159]
v_mfma_f32_32x32x16_bf16 a[160:175], v[92:95], v[72:75], a[160:175]
v_mfma_f32_32x32x16_bf16 a[176:191], v[96:99], v[72:75], a[176:191]
s_waitcnt lgkmcnt(0)
v_mfma_f32_32x32x16_bf16 a[0:15], v[76:79], v[44:47], a[0:15]
ds_read_b128 v[60:63], v101 offset:28672
v_mfma_f32_32x32x16_bf16 a[16:31], v[80:83], v[44:47], a[16:31]
ds_read_b128 v[64:67], v101 offset:30720
v_mfma_f32_32x32x16_bf16 a[32:47], v[84:87], v[44:47], a[32:47]
ds_read_b128 v[68:71], v101 offset:32768
v_mfma_f32_32x32x16_bf16 a[48:63], v[76:79], v[48:51], a[48:63]
ds_read_b128 v[72:75], v101 offset:34816
v_mfma_f32_32x32x16_bf16 a[64:79], v[80:83], v[48:51], a[64:79]
ds_read_b64_tr_b16 v[88:89], v104 offset:28672
ds_read_b64_tr_b16 v[90:91], v105 offset:28672
v_mfma_f32_32x32x16_bf16 a[80:95], v[84:87], v[48:51], a[80:95]
ds_read_b64_tr_b16 v[92:93], v108 offset:28672
ds_read_b64_tr_b16 v[94:95], v109 offset:28672
v_mfma_f32_32x32x16_bf16 a[96:111], v[76:79], v[52:55], a[96:111]
ds_read_b64_tr_b16 v[96:97], v104 offset:28800
ds_read_b64_tr_b16 v[98:99], v105 offset:28800
v_mfma_f32_32x32x16_bf16 a[112:127], v[80:83], v[52:55], a[112:127]
v_mfma_f32_32x32x16_bf16 a[128:143], v[84:87], v[52:55], a[128:143]
v_mfma_f32_32x32x16_bf16 a[144:159], v[76:79], v[56:59], a[144:159]
v_mfma_f32_32x32x16_bf16 a[160:175], v[80:83], v[56:59], a[160:175]
v_mfma_f32_32x32x16_bf16 a[176:191], v[84:87], v[56:59], a[176:191]
s_waitcnt lgkmcnt(0)
s_waitcnt vmcnt(0)
s_barrier
v_mfma_f32_32x32x16_bf16 a[0:15], v[88:91], v[60:63], a[0:15]
v_mfma_f32_32x32x16_bf16 a[16:31], v[92:95], v[60:63], a[16:31]
v_mfma_f32_32x32x16_bf16 a[32:47], v[96:99], v[60:63], a[32:47]
v_mfma_f32_32x32x16_bf16 a[48:63], v[88:91], v[64:67], a[48:63]
v_mfma_f32_32x32x16_bf16 a[64:79], v[92:95], v[64:67], a[64:79]
v_mfma_f32_32x32x16_bf16 a[80:95], v[96:99], v[64:67], a[80:95]
v_mfma_f32_32x32x16_bf16 a[96:111], v[88:91], v[68:71], a[96:111]
v_mfma_f32_32x32x16_bf16 a[112:127], v[92:95], v[68:71], a[112:127]
v_mfma_f32_32x32x16_bf16 a[128:143], v[96:99], v[68:71], a[128:143]
v_mfma_f32_32x32x16_bf16 a[144:159], v[88:91], v[72:75], a[144:159]
v_mfma_f32_32x32x16_bf16 a[160:175], v[92:95], v[72:75], a[160:175]
v_mfma_f32_32x32x16_bf16 a[176:191], v[96:99], v[72:75], a[176:191]
s_nop 11
s_cmp_lg_u32 s48, 0
s_cbranch_scc1 L_chkw1_A
v_mov_b32 v250, 64
s_nop 1
L_mcw1_A:
global_load_dword v251, v250, s[6:7] sc1
s_waitcnt vmcnt(0)
v_readfirstlane_b32 s94, v251
s_add_u32 s95, s95, 1
s_cmp_gt_u32 s95, 4000000
s_cbranch_scc1 L_rec_done_A
s_cmp_ge_u32 s94, 256
s_cbranch_scc1 L_mcw1x_A
s_sleep 2
s_branch L_mcw1_A
L_mcw1x_A:
v_and_b32 v250, 7, v1
v_lshlrev_b32 v250, 2, v250
global_load_dword v251, v250, s[6:7] sc1
s_waitcnt vmcnt(0)
v_cmp_ne_u32 vcc, 32, v251
s_cbranch_vccz L_mcw1ok_A
s_lshr_b32 s29, s49, 5
s_and_b32 s30, s49, 31
s_waitcnt vmcnt(0) lgkmcnt(0)
s_barrier
s_branch L_role_entry_B
L_mcw1ok_A:
s_mov_b32 s48, 1
L_chkw1_A:
s_barrier
s_add_u32 s50, s50, 16
s_cmp_lt_u32 s50, 96
s_cselect_b32 s87, 1, 0
s_cbranch_scc0 L_g1_nonb_A
s_cmp_ge_u32 s50, 56
s_cbranch_scc1 L_g1_dqb_A
s_mov_b32 s84, 1
s_mov_b32 s60, s50
s_cmp_lt_u32 s50, 8
s_cbranch_scc1 L_g1_d0b_A
s_sub_u32 s61, s50, 8
s_mul_i32 s60, s61, 43
s_lshr_b32 s60, s60, 8
s_mul_i32 s84, s60, 6
s_sub_u32 s84, s61, s84
s_add_u32 s84, s84, 2
L_g1_d0b_A:
s_lshr_b32 s86, s60, 2
s_and_b32 s60, s60, 3
s_lshl_b32 s85, s29, 2
s_add_u32 s85, s85, s60
s_branch L_g1_ddb_A
L_g1_dqb_A:
s_cmp_ge_u32 s50, 88
s_cbranch_scc1 L_g1_dhb_A
s_sub_u32 s60, s50, 56
s_and_b32 s84, s60, 7
s_lshr_b32 s60, s60, 3
s_lshl_b32 s85, s29, 2
s_add_u32 s85, s85, s60
s_mov_b32 s86, 2
s_branch L_g1_ddb_A
L_g1_dhb_A:
s_sub_u32 s84, s50, 88
s_mov_b32 s85, s29
s_mov_b32 s86, 3
L_g1_ddb_A:
s_mov_b32 s56, 12288
s_mov_b32 s34, 7864320
s_mov_b32 s35, 0x00020000
s_mov_b32 s32, s10
s_mov_b32 s33, s11
s_cmp_lg_u32 s86, 1
s_cbranch_scc1 L_g1_n1b_A
s_mov_b32 s32, s12
s_mov_b32 s33, s13
L_g1_n1b_A:
s_cmp_lg_u32 s86, 2
s_cbranch_scc1 L_g1_n2b_A
s_mov_b32 s32, s8
s_mov_b32 s33, s9
L_g1_n2b_A:
s_cmp_lg_u32 s86, 3
s_cbranch_scc1 L_g1_n3b_A
s_mov_b32 s32, s16
s_mov_b32 s33, s17
s_mov_b32 s56, 3072
s_mov_b32 s34, 1966080
L_g1_n3b_A:
s_mov_b32 s55, 1280
s_lshl_b32 s57, s56, 5
s_mul_i32 s54, s85, 384
s_mul_i32 s53, s84, 327680
s_add_u32 s53, s53, 90910720
s_mul_i32 s40, s28, 4096
s_add_u32 s40, s40, 0
v_lshlrev_b32 v4, 4, v1
v_add_u32 v21, s40, v4
s_mul_i32 s40, s28, 4096
s_add_u32 s40, s40, 1024
v_lshlrev_b32 v4, 4, v1
v_add_u32 v22, s40, v4
s_mul_i32 s40, s28, 4096
s_add_u32 s40, s40, 2048
v_lshlrev_b32 v4, 4, v1
v_add_u32 v23, s40, v4
s_mul_i32 s40, s28, 4096
s_add_u32 s40, s40, 3072
v_lshlrev_b32 v4, 4, v1
v_add_u32 v24, s40, v4
v_mul_lo_u32 v4, v25, s56
v_add_u32 v31, v4, v28
v_mul_lo_u32 v4, v26, s56
v_add_u32 v32, v4, v29
v_mul_lo_u32 v4, v27, s56
v_add_u32 v33, v4, v30
s_add_u32 m0, s45, 0
s_nop 0
buffer_load_dwordx4 v21, s[20:23], s53 offen lds
s_add_u32 m0, s45, 1024
s_nop 0
buffer_load_dwordx4 v22, s[20:23], s53 offen lds
s_add_u32 m0, s45, 2048
s_nop 0
buffer_load_dwordx4 v23, s[20:23], s53 offen lds
s_add_u32 m0, s45, 3072
s_nop 0
buffer_load_dwordx4 v24, s[20:23], s53 offen lds
s_add_u32 m0, s46, 0
s_nop 0
buffer_load_dwordx4 v31, s[32:35], s54 offen lds
s_add_u32 m0, s46, 1024
s_nop 0
buffer_load_dwordx4 v32, s[32:35], s54 offen lds
s_add_u32 m0, s46, 2048
s_nop 0
buffer_load_dwordx4 v33, s[32:35], s54 offen lds
s_add_u32 s53, s53, 16384
s_add_u32 s54, s54, s57
s_add_u32 m0, s45, 28672
s_nop 0
buffer_load_dwordx4 v21, s[20:23], s53 offen lds
s_add_u32 m0, s45, 29696
s_nop 0
buffer_load_dwordx4 v22, s[20:23], s53 offen lds
s_add_u32 m0, s45, 30720
s_nop 0
buffer_load_dwordx4 v23, s[20:23], s53 offen lds
s_add_u32 m0, s45, 31744
s_nop 0
buffer_load_dwordx4 v24, s[20:23], s53 offen lds
s_add_u32 m0, s46, 28672
s_nop 0
buffer_load_dwordx4 v31, s[32:35], s54 offen lds
s_add_u32 m0, s46, 29696
s_nop 0
buffer_load_dwordx4 v32, s[32:35], s54 offen lds
s_add_u32 m0, s46, 30720
s_nop 0
buffer_load_dwordx4 v33, s[32:35], s54 offen lds
s_add_u32 s53, s53, 16384
s_add_u32 s54, s54, s57
s_add_u32 m0, s45, 57344
s_nop 0
buffer_load_dwordx4 v21, s[20:23], s53 offen lds
s_add_u32 m0, s45, 58368
s_nop 0
buffer_load_dwordx4 v22, s[20:23], s53 offen lds
s_add_u32 m0, s45, 59392
s_nop 0
buffer_load_dwordx4 v23, s[20:23], s53 offen lds
s_add_u32 m0, s45, 60416
s_nop 0
buffer_load_dwordx4 v24, s[20:23], s53 offen lds
s_add_u32 m0, s46, 57344
s_nop 0
buffer_load_dwordx4 v31, s[32:35], s54 offen lds
s_add_u32 m0, s46, 58368
s_nop 0
buffer_load_dwordx4 v32, s[32:35], s54 offen lds
s_add_u32 m0, s46, 59392
s_nop 0
buffer_load_dwordx4 v33, s[32:35], s54 offen lds
s_add_u32 s53, s53, 16384
s_add_u32 s54, s54, s57
s_add_u32 m0, s45, 86016
s_nop 0
buffer_load_dwordx4 v21, s[20:23], s53 offen lds
s_add_u32 m0, s45, 87040
s_nop 0
buffer_load_dwordx4 v22, s[20:23], s53 offen lds
s_add_u32 m0, s45, 88064
s_nop 0
buffer_load_dwordx4 v23, s[20:23], s53 offen lds
s_add_u32 m0, s45, 89088
s_nop 0
buffer_load_dwordx4 v24, s[20:23], s53 offen lds
s_add_u32 m0, s46, 86016
s_nop 0
buffer_load_dwordx4 v31, s[32:35], s54 offen lds
s_add_u32 m0, s46, 87040
s_nop 0
buffer_load_dwordx4 v32, s[32:35], s54 offen lds
s_add_u32 m0, s46, 88064
s_nop 0
buffer_load_dwordx4 v33, s[32:35], s54 offen lds
s_add_u32 s53, s53, 16384
s_add_u32 s54, s54, s57
L_g1_nonb_A:
s_cmp_eq_u32 s58, 3
s_cbranch_scc1 L_g1_ffn_A
s_lshr_b32 s60, s28, 1
s_and_b32 s61, s28, 1
s_lshl_b32 s40, s52, 3
s_lshl_b32 s60, s60, 2
s_add_u32 s40, s40, s60
s_lshl_b32 s40, s40, 5
s_add_u32 s40, s40, s59
s_mul_i32 s40, s40, 12288
s_mul_i32 s61, s61, 3072
s_add_u32 s40, s40, s61
s_cmp_eq_u32 s58, 0
s_cselect_b32 s41, 0, 50331648
s_add_u32 s40, s40, s41
s_add_u32 s41, s40, 0
v_accvgpr_read_b32 v132, a0
v_accvgpr_read_b32 v133, a1
v_accvgpr_read_b32 v134, a2
v_accvgpr_read_b32 v135, a3
v_accvgpr_read_b32 v136, a4
v_accvgpr_read_b32 v137, a5
v_accvgpr_read_b32 v138, a6
v_accvgpr_read_b32 v139, a7
v_accvgpr_read_b32 v140, a8
v_accvgpr_read_b32 v141, a9
v_accvgpr_read_b32 v142, a10
v_accvgpr_read_b32 v143, a11
v_accvgpr_read_b32 v144, a12
v_accvgpr_read_b32 v145, a13
v_accvgpr_read_b32 v146, a14
v_accvgpr_read_b32 v147, a15
v_cvt_pk_bf16_f32 v116, v132, v133
v_cvt_pk_bf16_f32 v117, v134, v135
v_cvt_pk_bf16_f32 v118, v140, v141
v_cvt_pk_bf16_f32 v119, v142, v143
v_cvt_pk_bf16_f32 v120, v136, v137
v_cvt_pk_bf16_f32 v121, v138, v139
v_cvt_pk_bf16_f32 v122, v144, v145
v_cvt_pk_bf16_f32 v123, v146, v147
buffer_store_dwordx4 v[116:119], v110, s[20:23], s41 offen
buffer_store_dwordx4 v[120:123], v110, s[20:23], s41 offen offset:512
s_add_u32 s41, s40, 1024
v_accvgpr_read_b32 v132, a16
v_accvgpr_read_b32 v133, a17
v_accvgpr_read_b32 v134, a18
v_accvgpr_read_b32 v135, a19
v_accvgpr_read_b32 v136, a20
v_accvgpr_read_b32 v137, a21
v_accvgpr_read_b32 v138, a22
v_accvgpr_read_b32 v139, a23
v_accvgpr_read_b32 v140, a24
v_accvgpr_read_b32 v141, a25
v_accvgpr_read_b32 v142, a26
v_accvgpr_read_b32 v143, a27
v_accvgpr_read_b32 v144, a28
v_accvgpr_read_b32 v145, a29
v_accvgpr_read_b32 v146, a30
v_accvgpr_read_b32 v147, a31
v_cvt_pk_bf16_f32 v116, v132, v133
v_cvt_pk_bf16_f32 v117, v134, v135
v_cvt_pk_bf16_f32 v118, v140, v141
v_cvt_pk_bf16_f32 v119, v142, v143
v_cvt_pk_bf16_f32 v120, v136, v137
v_cvt_pk_bf16_f32 v121, v138, v139
v_cvt_pk_bf16_f32 v122, v144, v145
v_cvt_pk_bf16_f32 v123, v146, v147
buffer_store_dwordx4 v[116:119], v110, s[20:23], s41 offen
buffer_store_dwordx4 v[120:123], v110, s[20:23], s41 offen offset:512
s_add_u32 s41, s40, 2048
v_accvgpr_read_b32 v132, a32
v_accvgpr_read_b32 v133, a33
v_accvgpr_read_b32 v134, a34
v_accvgpr_read_b32 v135, a35
v_accvgpr_read_b32 v136, a36
v_accvgpr_read_b32 v137, a37
v_accvgpr_read_b32 v138, a38
v_accvgpr_read_b32 v139, a39
v_accvgpr_read_b32 v140, a40
v_accvgpr_read_b32 v141, a41
v_accvgpr_read_b32 v142, a42
v_accvgpr_read_b32 v143, a43
v_accvgpr_read_b32 v144, a44
v_accvgpr_read_b32 v145, a45
v_accvgpr_read_b32 v146, a46
v_accvgpr_read_b32 v147, a47
v_cvt_pk_bf16_f32 v116, v132, v133
v_cvt_pk_bf16_f32 v117, v134, v135
v_cvt_pk_bf16_f32 v118, v140, v141
v_cvt_pk_bf16_f32 v119, v142, v143
v_cvt_pk_bf16_f32 v120, v136, v137
v_cvt_pk_bf16_f32 v121, v138, v139
v_cvt_pk_bf16_f32 v122, v144, v145
v_cvt_pk_bf16_f32 v123, v146, v147
buffer_store_dwordx4 v[116:119], v110, s[20:23], s41 offen
buffer_store_dwordx4 v[120:123], v110, s[20:23], s41 offen offset:512
s_add_u32 s41, s40, 393216
v_accvgpr_read_b32 v132, a48
v_accvgpr_read_b32 v133, a49
v_accvgpr_read_b32 v134, a50
v_accvgpr_read_b32 v135, a51
v_accvgpr_read_b32 v136, a52
v_accvgpr_read_b32 v137, a53
v_accvgpr_read_b32 v138, a54
v_accvgpr_read_b32 v139, a55
v_accvgpr_read_b32 v140, a56
v_accvgpr_read_b32 v141, a57
v_accvgpr_read_b32 v142, a58
v_accvgpr_read_b32 v143, a59
v_accvgpr_read_b32 v144, a60
v_accvgpr_read_b32 v145, a61
v_accvgpr_read_b32 v146, a62
v_accvgpr_read_b32 v147, a63
v_cvt_pk_bf16_f32 v116, v132, v133
v_cvt_pk_bf16_f32 v117, v134, v135
v_cvt_pk_bf16_f32 v118, v140, v141
v_cvt_pk_bf16_f32 v119, v142, v143
v_cvt_pk_bf16_f32 v120, v136, v137
v_cvt_pk_bf16_f32 v121, v138, v139
v_cvt_pk_bf16_f32 v122, v144, v145
v_cvt_pk_bf16_f32 v123, v146, v147
buffer_store_dwordx4 v[116:119], v110, s[20:23], s41 offen
buffer_store_dwordx4 v[120:123], v110, s[20:23], s41 offen offset:512
s_add_u32 s41, s40, 394240
v_accvgpr_read_b32 v132, a64
v_accvgpr_read_b32 v133, a65
v_accvgpr_read_b32 v134, a66
v_accvgpr_read_b32 v135, a67
v_accvgpr_read_b32 v136, a68
v_accvgpr_read_b32 v137, a69
v_accvgpr_read_b32 v138, a70
v_accvgpr_read_b32 v139, a71
v_accvgpr_read_b32 v140, a72
v_accvgpr_read_b32 v141, a73
v_accvgpr_read_b32 v142, a74
v_accvgpr_read_b32 v143, a75
v_accvgpr_read_b32 v144, a76
v_accvgpr_read_b32 v145, a77
v_accvgpr_read_b32 v146, a78
v_accvgpr_read_b32 v147, a79
v_cvt_pk_bf16_f32 v116, v132, v133
v_cvt_pk_bf16_f32 v117, v134, v135
v_cvt_pk_bf16_f32 v118, v140, v141
v_cvt_pk_bf16_f32 v119, v142, v143
v_cvt_pk_bf16_f32 v120, v136, v137
v_cvt_pk_bf16_f32 v121, v138, v139
v_cvt_pk_bf16_f32 v122, v144, v145
v_cvt_pk_bf16_f32 v123, v146, v147
buffer_store_dwordx4 v[116:119], v110, s[20:23], s41 offen
buffer_store_dwordx4 v[120:123], v110, s[20:23], s41 offen offset:512
s_add_u32 s41, s40, 395264
v_accvgpr_read_b32 v132, a80
v_accvgpr_read_b32 v133, a81
v_accvgpr_read_b32 v134, a82
v_accvgpr_read_b32 v135, a83
v_accvgpr_read_b32 v136, a84
v_accvgpr_read_b32 v137, a85
v_accvgpr_read_b32 v138, a86
v_accvgpr_read_b32 v139, a87
v_accvgpr_read_b32 v140, a88
v_accvgpr_read_b32 v141, a89
v_accvgpr_read_b32 v142, a90
v_accvgpr_read_b32 v143, a91
v_accvgpr_read_b32 v144, a92
v_accvgpr_read_b32 v145, a93
v_accvgpr_read_b32 v146, a94
v_accvgpr_read_b32 v147, a95
v_cvt_pk_bf16_f32 v116, v132, v133
v_cvt_pk_bf16_f32 v117, v134, v135
v_cvt_pk_bf16_f32 v118, v140, v141
v_cvt_pk_bf16_f32 v119, v142, v143
v_cvt_pk_bf16_f32 v120, v136, v137
v_cvt_pk_bf16_f32 v121, v138, v139
v_cvt_pk_bf16_f32 v122, v144, v145
v_cvt_pk_bf16_f32 v123, v146, v147
buffer_store_dwordx4 v[116:119], v110, s[20:23], s41 offen
buffer_store_dwordx4 v[120:123], v110, s[20:23], s41 offen offset:512
s_add_u32 s41, s40, 786432
v_accvgpr_read_b32 v132, a96
v_accvgpr_read_b32 v133, a97
v_accvgpr_read_b32 v134, a98
v_accvgpr_read_b32 v135, a99
v_accvgpr_read_b32 v136, a100
v_accvgpr_read_b32 v137, a101
v_accvgpr_read_b32 v138, a102
v_accvgpr_read_b32 v139, a103
v_accvgpr_read_b32 v140, a104
v_accvgpr_read_b32 v141, a105
v_accvgpr_read_b32 v142, a106
v_accvgpr_read_b32 v143, a107
v_accvgpr_read_b32 v144, a108
v_accvgpr_read_b32 v145, a109
v_accvgpr_read_b32 v146, a110
v_accvgpr_read_b32 v147, a111
v_cvt_pk_bf16_f32 v116, v132, v133
v_cvt_pk_bf16_f32 v117, v134, v135
v_cvt_pk_bf16_f32 v118, v140, v141
v_cvt_pk_bf16_f32 v119, v142, v143
v_cvt_pk_bf16_f32 v120, v136, v137
v_cvt_pk_bf16_f32 v121, v138, v139
v_cvt_pk_bf16_f32 v122, v144, v145
v_cvt_pk_bf16_f32 v123, v146, v147
buffer_store_dwordx4 v[116:119], v110, s[20:23], s41 offen
buffer_store_dwordx4 v[120:123], v110, s[20:23], s41 offen offset:512
s_add_u32 s41, s40, 787456
v_accvgpr_read_b32 v132, a112
v_accvgpr_read_b32 v133, a113
v_accvgpr_read_b32 v134, a114
v_accvgpr_read_b32 v135, a115
v_accvgpr_read_b32 v136, a116
v_accvgpr_read_b32 v137, a117
v_accvgpr_read_b32 v138, a118
v_accvgpr_read_b32 v139, a119
v_accvgpr_read_b32 v140, a120
v_accvgpr_read_b32 v141, a121
v_accvgpr_read_b32 v142, a122
v_accvgpr_read_b32 v143, a123
v_accvgpr_read_b32 v144, a124
v_accvgpr_read_b32 v145, a125
v_accvgpr_read_b32 v146, a126
v_accvgpr_read_b32 v147, a127
v_cvt_pk_bf16_f32 v116, v132, v133
v_cvt_pk_bf16_f32 v117, v134, v135
v_cvt_pk_bf16_f32 v118, v140, v141
v_cvt_pk_bf16_f32 v119, v142, v143
v_cvt_pk_bf16_f32 v120, v136, v137
v_cvt_pk_bf16_f32 v121, v138, v139
v_cvt_pk_bf16_f32 v122, v144, v145
v_cvt_pk_bf16_f32 v123, v146, v147
buffer_store_dwordx4 v[116:119], v110, s[20:23], s41 offen
buffer_store_dwordx4 v[120:123], v110, s[20:23], s41 offen offset:512
s_add_u32 s41, s40, 788480
v_accvgpr_read_b32 v132, a128
v_accvgpr_read_b32 v133, a129
v_accvgpr_read_b32 v134, a130
v_accvgpr_read_b32 v135, a131
v_accvgpr_read_b32 v136, a132
v_accvgpr_read_b32 v137, a133
v_accvgpr_read_b32 v138, a134
v_accvgpr_read_b32 v139, a135
v_accvgpr_read_b32 v140, a136
v_accvgpr_read_b32 v141, a137
v_accvgpr_read_b32 v142, a138
v_accvgpr_read_b32 v143, a139
v_accvgpr_read_b32 v144, a140
v_accvgpr_read_b32 v145, a141
v_accvgpr_read_b32 v146, a142
v_accvgpr_read_b32 v147, a143
v_cvt_pk_bf16_f32 v116, v132, v133
v_cvt_pk_bf16_f32 v117, v134, v135
v_cvt_pk_bf16_f32 v118, v140, v141
v_cvt_pk_bf16_f32 v119, v142, v143
v_cvt_pk_bf16_f32 v120, v136, v137
v_cvt_pk_bf16_f32 v121, v138, v139
v_cvt_pk_bf16_f32 v122, v144, v145
v_cvt_pk_bf16_f32 v123, v146, v147
buffer_store_dwordx4 v[116:119], v110, s[20:23], s41 offen
buffer_store_dwordx4 v[120:123], v110, s[20:23], s41 offen offset:512
s_add_u32 s41, s40, 1179648
v_accvgpr_read_b32 v132, a144
v_accvgpr_read_b32 v133, a145
v_accvgpr_read_b32 v134, a146
v_accvgpr_read_b32 v135, a147
v_accvgpr_read_b32 v136, a148
v_accvgpr_read_b32 v137, a149
v_accvgpr_read_b32 v138, a150
v_accvgpr_read_b32 v139, a151
v_accvgpr_read_b32 v140, a152
v_accvgpr_read_b32 v141, a153
v_accvgpr_read_b32 v142, a154
v_accvgpr_read_b32 v143, a155
v_accvgpr_read_b32 v144, a156
v_accvgpr_read_b32 v145, a157
v_accvgpr_read_b32 v146, a158
v_accvgpr_read_b32 v147, a159
v_cvt_pk_bf16_f32 v116, v132, v133
v_cvt_pk_bf16_f32 v117, v134, v135
v_cvt_pk_bf16_f32 v118, v140, v141
v_cvt_pk_bf16_f32 v119, v142, v143
v_cvt_pk_bf16_f32 v120, v136, v137
v_cvt_pk_bf16_f32 v121, v138, v139
v_cvt_pk_bf16_f32 v122, v144, v145
v_cvt_pk_bf16_f32 v123, v146, v147
buffer_store_dwordx4 v[116:119], v110, s[20:23], s41 offen
buffer_store_dwordx4 v[120:123], v110, s[20:23], s41 offen offset:512
s_add_u32 s41, s40, 1180672
v_accvgpr_read_b32 v132, a160
v_accvgpr_read_b32 v133, a161
v_accvgpr_read_b32 v134, a162
v_accvgpr_read_b32 v135, a163
v_accvgpr_read_b32 v136, a164
v_accvgpr_read_b32 v137, a165
v_accvgpr_read_b32 v138, a166
v_accvgpr_read_b32 v139, a167
v_accvgpr_read_b32 v140, a168
v_accvgpr_read_b32 v141, a169
v_accvgpr_read_b32 v142, a170
v_accvgpr_read_b32 v143, a171
v_accvgpr_read_b32 v144, a172
v_accvgpr_read_b32 v145, a173
v_accvgpr_read_b32 v146, a174
v_accvgpr_read_b32 v147, a175
v_cvt_pk_bf16_f32 v116, v132, v133
v_cvt_pk_bf16_f32 v117, v134, v135
v_cvt_pk_bf16_f32 v118, v140, v141
v_cvt_pk_bf16_f32 v119, v142, v143
v_cvt_pk_bf16_f32 v120, v136, v137
v_cvt_pk_bf16_f32 v121, v138, v139
v_cvt_pk_bf16_f32 v122, v144, v145
v_cvt_pk_bf16_f32 v123, v146, v147
buffer_store_dwordx4 v[116:119], v110, s[20:23], s41 offen
buffer_store_dwordx4 v[120:123], v110, s[20:23], s41 offen offset:512
s_add_u32 s41, s40, 1181696
v_accvgpr_read_b32 v132, a176
v_accvgpr_read_b32 v133, a177
v_accvgpr_read_b32 v134, a178
v_accvgpr_read_b32 v135, a179
v_accvgpr_read_b32 v136, a180
v_accvgpr_read_b32 v137, a181
v_accvgpr_read_b32 v138, a182
v_accvgpr_read_b32 v139, a183
v_accvgpr_read_b32 v140, a184
v_accvgpr_read_b32 v141, a185
v_accvgpr_read_b32 v142, a186
v_accvgpr_read_b32 v143, a187
v_accvgpr_read_b32 v144, a188
v_accvgpr_read_b32 v145, a189
v_accvgpr_read_b32 v146, a190
v_accvgpr_read_b32 v147, a191
v_cvt_pk_bf16_f32 v116, v132, v133
v_cvt_pk_bf16_f32 v117, v134, v135
v_cvt_pk_bf16_f32 v118, v140, v141
v_cvt_pk_bf16_f32 v119, v142, v143
v_cvt_pk_bf16_f32 v120, v136, v137
v_cvt_pk_bf16_f32 v121, v138, v139
v_cvt_pk_bf16_f32 v122, v144, v145
v_cvt_pk_bf16_f32 v123, v146, v147
buffer_store_dwordx4 v[116:119], v110, s[20:23], s41 offen
buffer_store_dwordx4 v[120:123], v110, s[20:23], s41 offen offset:512
s_mov_b32 s60, 178470912
s_cmp_eq_u32 s58, 0
s_cselect_b32 s60, 178466816, s60
s_lshl_b32 s61, s29, 9
s_add_u32 s60, s60, s61
s_branch L_g1_next_A
L_g1_ffn_A:
s_mov_b32 s80, s18
s_mov_b32 s81, s19
s_mov_b32 s82, 3072
s_mov_b32 s83, 0x00020000
s_lshr_b32 s60, s28, 1
s_and_b32 s61, s28, 1
s_mul_i32 s40, s52, 786432
s_lshl_b32 s60, s60, 13
s_add_u32 s40, s40, s60
s_mul_i32 s60, s59, 192
s_mul_i32 s61, s61, 96
s_add_u32 s60, s60, s61
s_lshl_b32 s61, s60, 1
s_lshl_b32 s60, s60, 9
s_add_u32 s40, s40, s60
s_add_u32 s40, s40, 93532160
v_lshrrev_b32 v4, 5, v1
v_lshlrev_b32 v4, 3, v4
s_add_u32 s41, s61, 0
buffer_load_dwordx2 v[124:125], v4, s[80:83], s41 offen offset:0
buffer_load_dwordx2 v[126:127], v4, s[80:83], s41 offen offset:16
buffer_load_dwordx2 v[128:129], v4, s[80:83], s41 offen offset:32
buffer_load_dwordx2 v[130:131], v4, s[80:83], s41 offen offset:48
s_waitcnt vmcnt(0)
v_accvgpr_read_b32 v132, a0
v_accvgpr_read_b32 v133, a1
v_accvgpr_read_b32 v134, a2
v_accvgpr_read_b32 v135, a3
v_accvgpr_read_b32 v136, a4
v_accvgpr_read_b32 v137, a5
v_accvgpr_read_b32 v138, a6
v_accvgpr_read_b32 v139, a7
v_accvgpr_read_b32 v140, a8
v_accvgpr_read_b32 v141, a9
v_accvgpr_read_b32 v142, a10
v_accvgpr_read_b32 v143, a11
v_accvgpr_read_b32 v144, a12
v_accvgpr_read_b32 v145, a13
v_accvgpr_read_b32 v146, a14
v_accvgpr_read_b32 v147, a15
v_cvt_pk_bf16_f32 v116, v132, v133
v_lshlrev_b32 v132, 16, v116
v_and_b32 v133, 0xffff0000, v116
v_lshlrev_b32 v117, 16, v124
v_and_b32 v118, 0xffff0000, v124
v_add_f32 v132, v132, v117
v_add_f32 v133, v133, v118
v_cvt_pk_bf16_f32 v116, v132, v133
v_lshlrev_b32 v132, 16, v116
v_and_b32 v133, 0xffff0000, v116
v_max_f32 v132, 0, v132
v_max_f32 v133, 0, v133
v_mul_f32 v132, v132, v132
v_mul_f32 v133, v133, v133
v_cvt_pk_bf16_f32 v116, v134, v135
v_lshlrev_b32 v134, 16, v116
v_and_b32 v135, 0xffff0000, v116
v_lshlrev_b32 v117, 16, v125
v_and_b32 v118, 0xffff0000, v125
v_add_f32 v134, v134, v117
v_add_f32 v135, v135, v118
v_cvt_pk_bf16_f32 v116, v134, v135
v_lshlrev_b32 v134, 16, v116
v_and_b32 v135, 0xffff0000, v116
v_max_f32 v134, 0, v134
v_max_f32 v135, 0, v135
v_mul_f32 v134, v134, v134
v_mul_f32 v135, v135, v135
v_cvt_pk_bf16_f32 v116, v136, v137
v_lshlrev_b32 v136, 16, v116
v_and_b32 v137, 0xffff0000, v116
v_lshlrev_b32 v117, 16, v126
v_and_b32 v118, 0xffff0000, v126
v_add_f32 v136, v136, v117
v_add_f32 v137, v137, v118
v_cvt_pk_bf16_f32 v116, v136, v137
v_lshlrev_b32 v136, 16, v116
v_and_b32 v137, 0xffff0000, v116
v_max_f32 v136, 0, v136
v_max_f32 v137, 0, v137
v_mul_f32 v136, v136, v136
v_mul_f32 v137, v137, v137
v_cvt_pk_bf16_f32 v116, v138, v139
v_lshlrev_b32 v138, 16, v116
v_and_b32 v139, 0xffff0000, v116
v_lshlrev_b32 v117, 16, v127
v_and_b32 v118, 0xffff0000, v127
v_add_f32 v138, v138, v117
v_add_f32 v139, v139, v118
v_cvt_pk_bf16_f32 v116, v138, v139
v_lshlrev_b32 v138, 16, v116
v_and_b32 v139, 0xffff0000, v116
v_max_f32 v138, 0, v138
v_max_f32 v139, 0, v139
v_mul_f32 v138, v138, v138
v_mul_f32 v139, v139, v139
v_cvt_pk_bf16_f32 v116, v140, v141
v_lshlrev_b32 v140, 16, v116
v_and_b32 v141, 0xffff0000, v116
v_lshlrev_b32 v117, 16, v128
v_and_b32 v118, 0xffff0000, v128
v_add_f32 v140, v140, v117
v_add_f32 v141, v141, v118
v_cvt_pk_bf16_f32 v116, v140, v141
v_lshlrev_b32 v140, 16, v116
v_and_b32 v141, 0xffff0000, v116
v_max_f32 v140, 0, v140
v_max_f32 v141, 0, v141
v_mul_f32 v140, v140, v140
v_mul_f32 v141, v141, v141
v_cvt_pk_bf16_f32 v116, v142, v143
v_lshlrev_b32 v142, 16, v116
v_and_b32 v143, 0xffff0000, v116
v_lshlrev_b32 v117, 16, v129
v_and_b32 v118, 0xffff0000, v129
v_add_f32 v142, v142, v117
v_add_f32 v143, v143, v118
v_cvt_pk_bf16_f32 v116, v142, v143
v_lshlrev_b32 v142, 16, v116
v_and_b32 v143, 0xffff0000, v116
v_max_f32 v142, 0, v142
v_max_f32 v143, 0, v143
v_mul_f32 v142, v142, v142
v_mul_f32 v143, v143, v143
v_cvt_pk_bf16_f32 v116, v144, v145
v_lshlrev_b32 v144, 16, v116
v_and_b32 v145, 0xffff0000, v116
v_lshlrev_b32 v117, 16, v130
v_and_b32 v118, 0xffff0000, v130
v_add_f32 v144, v144, v117
v_add_f32 v145, v145, v118
v_cvt_pk_bf16_f32 v116, v144, v145
v_lshlrev_b32 v144, 16, v116
v_and_b32 v145, 0xffff0000, v116
v_max_f32 v144, 0, v144
v_max_f32 v145, 0, v145
v_mul_f32 v144, v144, v144
v_mul_f32 v145, v145, v145
v_cvt_pk_bf16_f32 v116, v146, v147
v_lshlrev_b32 v146, 16, v116
v_and_b32 v147, 0xffff0000, v116
v_lshlrev_b32 v117, 16, v131
v_and_b32 v118, 0xffff0000, v131
v_add_f32 v146, v146, v117
v_add_f32 v147, v147, v118
v_cvt_pk_bf16_f32 v116, v146, v147
v_lshlrev_b32 v146, 16, v116
v_and_b32 v147, 0xffff0000, v116
v_max_f32 v146, 0, v146
v_max_f32 v147, 0, v147
v_mul_f32 v146, v146, v146
v_mul_f32 v147, v147, v147
v_cvt_pk_bf16_f32 v116, v132, v133
v_cvt_pk_bf16_f32 v117, v134, v135
v_cvt_pk_bf16_f32 v118, v140, v141
v_cvt_pk_bf16_f32 v119, v142, v143
v_cvt_pk_bf16_f32 v120, v136, v137
v_cvt_pk_bf16_f32 v121, v138, v139
v_cvt_pk_bf16_f32 v122, v144, v145
v_cvt_pk_bf16_f32 v123, v146, v147
s_add_u32 s41, s40, 0
buffer_store_dwordx4 v[116:119], v112, s[20:23], s41 offen sc1
buffer_store_dwordx4 v[120:123], v148, s[20:23], s41 offen sc1
v_accvgpr_read_b32 v132, a48
v_accvgpr_read_b32 v133, a49
v_accvgpr_read_b32 v134, a50
v_accvgpr_read_b32 v135, a51
v_accvgpr_read_b32 v136, a52
v_accvgpr_read_b32 v137, a53
v_accvgpr_read_b32 v138, a54
v_accvgpr_read_b32 v139, a55
v_accvgpr_read_b32 v140, a56
v_accvgpr_read_b32 v141, a57
v_accvgpr_read_b32 v142, a58
v_accvgpr_read_b32 v143, a59
v_accvgpr_read_b32 v144, a60
v_accvgpr_read_b32 v145, a61
v_accvgpr_read_b32 v146, a62
v_accvgpr_read_b32 v147, a63
v_cvt_pk_bf16_f32 v116, v132, v133
v_lshlrev_b32 v132, 16, v116
v_and_b32 v133, 0xffff0000, v116
v_lshlrev_b32 v117, 16, v124
v_and_b32 v118, 0xffff0000, v124
v_add_f32 v132, v132, v117
v_add_f32 v133, v133, v118
v_cvt_pk_bf16_f32 v116, v132, v133
v_lshlrev_b32 v132, 16, v116
v_and_b32 v133, 0xffff0000, v116
v_max_f32 v132, 0, v132
v_max_f32 v133, 0, v133
v_mul_f32 v132, v132, v132
v_mul_f32 v133, v133, v133
v_cvt_pk_bf16_f32 v116, v134, v135
v_lshlrev_b32 v134, 16, v116
v_and_b32 v135, 0xffff0000, v116
v_lshlrev_b32 v117, 16, v125
v_and_b32 v118, 0xffff0000, v125
v_add_f32 v134, v134, v117
v_add_f32 v135, v135, v118
v_cvt_pk_bf16_f32 v116, v134, v135
v_lshlrev_b32 v134, 16, v116
v_and_b32 v135, 0xffff0000, v116
v_max_f32 v134, 0, v134
v_max_f32 v135, 0, v135
v_mul_f32 v134, v134, v134
v_mul_f32 v135, v135, v135
v_cvt_pk_bf16_f32 v116, v136, v137
v_lshlrev_b32 v136, 16, v116
v_and_b32 v137, 0xffff0000, v116
v_lshlrev_b32 v117, 16, v126
v_and_b32 v118, 0xffff0000, v126
v_add_f32 v136, v136, v117
v_add_f32 v137, v137, v118
v_cvt_pk_bf16_f32 v116, v136, v137
v_lshlrev_b32 v136, 16, v116
v_and_b32 v137, 0xffff0000, v116
v_max_f32 v136, 0, v136
v_max_f32 v137, 0, v137
v_mul_f32 v136, v136, v136
v_mul_f32 v137, v137, v137
v_cvt_pk_bf16_f32 v116, v138, v139
v_lshlrev_b32 v138, 16, v116
v_and_b32 v139, 0xffff0000, v116
v_lshlrev_b32 v117, 16, v127
v_and_b32 v118, 0xffff0000, v127
v_add_f32 v138, v138, v117
v_add_f32 v139, v139, v118
v_cvt_pk_bf16_f32 v116, v138, v139
v_lshlrev_b32 v138, 16, v116
v_and_b32 v139, 0xffff0000, v116
v_max_f32 v138, 0, v138
v_max_f32 v139, 0, v139
v_mul_f32 v138, v138, v138
v_mul_f32 v139, v139, v139
v_cvt_pk_bf16_f32 v116, v140, v141
v_lshlrev_b32 v140, 16, v116
v_and_b32 v141, 0xffff0000, v116
v_lshlrev_b32 v117, 16, v128
v_and_b32 v118, 0xffff0000, v128
v_add_f32 v140, v140, v117
v_add_f32 v141, v141, v118
v_cvt_pk_bf16_f32 v116, v140, v141
v_lshlrev_b32 v140, 16, v116
v_and_b32 v141, 0xffff0000, v116
v_max_f32 v140, 0, v140
v_max_f32 v141, 0, v141
v_mul_f32 v140, v140, v140
v_mul_f32 v141, v141, v141
v_cvt_pk_bf16_f32 v116, v142, v143
v_lshlrev_b32 v142, 16, v116
v_and_b32 v143, 0xffff0000, v116
v_lshlrev_b32 v117, 16, v129
v_and_b32 v118, 0xffff0000, v129
v_add_f32 v142, v142, v117
v_add_f32 v143, v143, v118
v_cvt_pk_bf16_f32 v116, v142, v143
v_lshlrev_b32 v142, 16, v116
v_and_b32 v143, 0xffff0000, v116
v_max_f32 v142, 0, v142
v_max_f32 v143, 0, v143
v_mul_f32 v142, v142, v142
v_mul_f32 v143, v143, v143
v_cvt_pk_bf16_f32 v116, v144, v145
v_lshlrev_b32 v144, 16, v116
v_and_b32 v145, 0xffff0000, v116
v_lshlrev_b32 v117, 16, v130
v_and_b32 v118, 0xffff0000, v130
v_add_f32 v144, v144, v117
v_add_f32 v145, v145, v118
v_cvt_pk_bf16_f32 v116, v144, v145
v_lshlrev_b32 v144, 16, v116
v_and_b32 v145, 0xffff0000, v116
v_max_f32 v144, 0, v144
v_max_f32 v145, 0, v145
v_mul_f32 v144, v144, v144
v_mul_f32 v145, v145, v145
v_cvt_pk_bf16_f32 v116, v146, v147
v_lshlrev_b32 v146, 16, v116
v_and_b32 v147, 0xffff0000, v116
v_lshlrev_b32 v117, 16, v131
v_and_b32 v118, 0xffff0000, v131
v_add_f32 v146, v146, v117
v_add_f32 v147, v147, v118
v_cvt_pk_bf16_f32 v116, v146, v147
v_lshlrev_b32 v146, 16, v116
v_and_b32 v147, 0xffff0000, v116
v_max_f32 v146, 0, v146
v_max_f32 v147, 0, v147
v_mul_f32 v146, v146, v146
v_mul_f32 v147, v147, v147
v_cvt_pk_bf16_f32 v116, v132, v133
v_cvt_pk_bf16_f32 v117, v134, v135
v_cvt_pk_bf16_f32 v118, v140, v141
v_cvt_pk_bf16_f32 v119, v142, v143
v_cvt_pk_bf16_f32 v120, v136, v137
v_cvt_pk_bf16_f32 v121, v138, v139
v_cvt_pk_bf16_f32 v122, v144, v145
v_cvt_pk_bf16_f32 v123, v146, v147
s_add_u32 s41, s40, 2048
buffer_store_dwordx4 v[116:119], v112, s[20:23], s41 offen sc1
buffer_store_dwordx4 v[120:123], v148, s[20:23], s41 offen sc1
v_accvgpr_read_b32 v132, a96
v_accvgpr_read_b32 v133, a97
v_accvgpr_read_b32 v134, a98
v_accvgpr_read_b32 v135, a99
v_accvgpr_read_b32 v136, a100
v_accvgpr_read_b32 v137, a101
v_accvgpr_read_b32 v138, a102
v_accvgpr_read_b32 v139, a103
v_accvgpr_read_b32 v140, a104
v_accvgpr_read_b32 v141, a105
v_accvgpr_read_b32 v142, a106
v_accvgpr_read_b32 v143, a107
v_accvgpr_read_b32 v144, a108
v_accvgpr_read_b32 v145, a109
v_accvgpr_read_b32 v146, a110
v_accvgpr_read_b32 v147, a111
v_cvt_pk_bf16_f32 v116, v132, v133
v_lshlrev_b32 v132, 16, v116
v_and_b32 v133, 0xffff0000, v116
v_lshlrev_b32 v117, 16, v124
v_and_b32 v118, 0xffff0000, v124
v_add_f32 v132, v132, v117
v_add_f32 v133, v133, v118
v_cvt_pk_bf16_f32 v116, v132, v133
v_lshlrev_b32 v132, 16, v116
v_and_b32 v133, 0xffff0000, v116
v_max_f32 v132, 0, v132
v_max_f32 v133, 0, v133
v_mul_f32 v132, v132, v132
v_mul_f32 v133, v133, v133
v_cvt_pk_bf16_f32 v116, v134, v135
v_lshlrev_b32 v134, 16, v116
v_and_b32 v135, 0xffff0000, v116
v_lshlrev_b32 v117, 16, v125
v_and_b32 v118, 0xffff0000, v125
v_add_f32 v134, v134, v117
v_add_f32 v135, v135, v118
v_cvt_pk_bf16_f32 v116, v134, v135
v_lshlrev_b32 v134, 16, v116
v_and_b32 v135, 0xffff0000, v116
v_max_f32 v134, 0, v134
v_max_f32 v135, 0, v135
v_mul_f32 v134, v134, v134
v_mul_f32 v135, v135, v135
v_cvt_pk_bf16_f32 v116, v136, v137
v_lshlrev_b32 v136, 16, v116
v_and_b32 v137, 0xffff0000, v116
v_lshlrev_b32 v117, 16, v126
v_and_b32 v118, 0xffff0000, v126
v_add_f32 v136, v136, v117
v_add_f32 v137, v137, v118
v_cvt_pk_bf16_f32 v116, v136, v137
v_lshlrev_b32 v136, 16, v116
v_and_b32 v137, 0xffff0000, v116
v_max_f32 v136, 0, v136
v_max_f32 v137, 0, v137
v_mul_f32 v136, v136, v136
v_mul_f32 v137, v137, v137
v_cvt_pk_bf16_f32 v116, v138, v139
v_lshlrev_b32 v138, 16, v116
v_and_b32 v139, 0xffff0000, v116
v_lshlrev_b32 v117, 16, v127
v_and_b32 v118, 0xffff0000, v127
v_add_f32 v138, v138, v117
v_add_f32 v139, v139, v118
v_cvt_pk_bf16_f32 v116, v138, v139
v_lshlrev_b32 v138, 16, v116
v_and_b32 v139, 0xffff0000, v116
v_max_f32 v138, 0, v138
v_max_f32 v139, 0, v139
v_mul_f32 v138, v138, v138
v_mul_f32 v139, v139, v139
v_cvt_pk_bf16_f32 v116, v140, v141
v_lshlrev_b32 v140, 16, v116
v_and_b32 v141, 0xffff0000, v116
v_lshlrev_b32 v117, 16, v128
v_and_b32 v118, 0xffff0000, v128
v_add_f32 v140, v140, v117
v_add_f32 v141, v141, v118
v_cvt_pk_bf16_f32 v116, v140, v141
v_lshlrev_b32 v140, 16, v116
v_and_b32 v141, 0xffff0000, v116
v_max_f32 v140, 0, v140
v_max_f32 v141, 0, v141
v_mul_f32 v140, v140, v140
v_mul_f32 v141, v141, v141
v_cvt_pk_bf16_f32 v116, v142, v143
v_lshlrev_b32 v142, 16, v116
v_and_b32 v143, 0xffff0000, v116
v_lshlrev_b32 v117, 16, v129
v_and_b32 v118, 0xffff0000, v129
v_add_f32 v142, v142, v117
v_add_f32 v143, v143, v118
v_cvt_pk_bf16_f32 v116, v142, v143
v_lshlrev_b32 v142, 16, v116
v_and_b32 v143, 0xffff0000, v116
v_max_f32 v142, 0, v142
v_max_f32 v143, 0, v143
v_mul_f32 v142, v142, v142
v_mul_f32 v143, v143, v143
v_cvt_pk_bf16_f32 v116, v144, v145
v_lshlrev_b32 v144, 16, v116
v_and_b32 v145, 0xffff0000, v116
v_lshlrev_b32 v117, 16, v130
v_and_b32 v118, 0xffff0000, v130
v_add_f32 v144, v144, v117
v_add_f32 v145, v145, v118
v_cvt_pk_bf16_f32 v116, v144, v145
v_lshlrev_b32 v144, 16, v116
v_and_b32 v145, 0xffff0000, v116
v_max_f32 v144, 0, v144
v_max_f32 v145, 0, v145
v_mul_f32 v144, v144, v144
v_mul_f32 v145, v145, v145
v_cvt_pk_bf16_f32 v116, v146, v147
v_lshlrev_b32 v146, 16, v116
v_and_b32 v147, 0xffff0000, v116
v_lshlrev_b32 v117, 16, v131
v_and_b32 v118, 0xffff0000, v131
v_add_f32 v146, v146, v117
v_add_f32 v147, v147, v118
v_cvt_pk_bf16_f32 v116, v146, v147
v_lshlrev_b32 v146, 16, v116
v_and_b32 v147, 0xffff0000, v116
v_max_f32 v146, 0, v146
v_max_f32 v147, 0, v147
v_mul_f32 v146, v146, v146
v_mul_f32 v147, v147, v147
v_cvt_pk_bf16_f32 v116, v132, v133
v_cvt_pk_bf16_f32 v117, v134, v135
v_cvt_pk_bf16_f32 v118, v140, v141
v_cvt_pk_bf16_f32 v119, v142, v143
v_cvt_pk_bf16_f32 v120, v136, v137
v_cvt_pk_bf16_f32 v121, v138, v139
v_cvt_pk_bf16_f32 v122, v144, v145
v_cvt_pk_bf16_f32 v123, v146, v147
s_add_u32 s41, s40, 4096
buffer_store_dwordx4 v[116:119], v112, s[20:23], s41 offen sc1
buffer_store_dwordx4 v[120:123], v148, s[20:23], s41 offen sc1
v_accvgpr_read_b32 v132, a144
v_accvgpr_read_b32 v133, a145
v_accvgpr_read_b32 v134, a146
v_accvgpr_read_b32 v135, a147
v_accvgpr_read_b32 v136, a148
v_accvgpr_read_b32 v137, a149
v_accvgpr_read_b32 v138, a150
v_accvgpr_read_b32 v139, a151
v_accvgpr_read_b32 v140, a152
v_accvgpr_read_b32 v141, a153
v_accvgpr_read_b32 v142, a154
v_accvgpr_read_b32 v143, a155
v_accvgpr_read_b32 v144, a156
v_accvgpr_read_b32 v145, a157
v_accvgpr_read_b32 v146, a158
v_accvgpr_read_b32 v147, a159
v_cvt_pk_bf16_f32 v116, v132, v133
v_lshlrev_b32 v132, 16, v116
v_and_b32 v133, 0xffff0000, v116
v_lshlrev_b32 v117, 16, v124
v_and_b32 v118, 0xffff0000, v124
v_add_f32 v132, v132, v117
v_add_f32 v133, v133, v118
v_cvt_pk_bf16_f32 v116, v132, v133
v_lshlrev_b32 v132, 16, v116
v_and_b32 v133, 0xffff0000, v116
v_max_f32 v132, 0, v132
v_max_f32 v133, 0, v133
v_mul_f32 v132, v132, v132
v_mul_f32 v133, v133, v133
v_cvt_pk_bf16_f32 v116, v134, v135
v_lshlrev_b32 v134, 16, v116
v_and_b32 v135, 0xffff0000, v116
v_lshlrev_b32 v117, 16, v125
v_and_b32 v118, 0xffff0000, v125
v_add_f32 v134, v134, v117
v_add_f32 v135, v135, v118
v_cvt_pk_bf16_f32 v116, v134, v135
v_lshlrev_b32 v134, 16, v116
v_and_b32 v135, 0xffff0000, v116
v_max_f32 v134, 0, v134
v_max_f32 v135, 0, v135
v_mul_f32 v134, v134, v134
v_mul_f32 v135, v135, v135
v_cvt_pk_bf16_f32 v116, v136, v137
v_lshlrev_b32 v136, 16, v116
v_and_b32 v137, 0xffff0000, v116
v_lshlrev_b32 v117, 16, v126
v_and_b32 v118, 0xffff0000, v126
v_add_f32 v136, v136, v117
v_add_f32 v137, v137, v118
v_cvt_pk_bf16_f32 v116, v136, v137
v_lshlrev_b32 v136, 16, v116
v_and_b32 v137, 0xffff0000, v116
v_max_f32 v136, 0, v136
v_max_f32 v137, 0, v137
v_mul_f32 v136, v136, v136
v_mul_f32 v137, v137, v137
v_cvt_pk_bf16_f32 v116, v138, v139
v_lshlrev_b32 v138, 16, v116
v_and_b32 v139, 0xffff0000, v116
v_lshlrev_b32 v117, 16, v127
v_and_b32 v118, 0xffff0000, v127
v_add_f32 v138, v138, v117
v_add_f32 v139, v139, v118
v_cvt_pk_bf16_f32 v116, v138, v139
v_lshlrev_b32 v138, 16, v116
v_and_b32 v139, 0xffff0000, v116
v_max_f32 v138, 0, v138
v_max_f32 v139, 0, v139
v_mul_f32 v138, v138, v138
v_mul_f32 v139, v139, v139
v_cvt_pk_bf16_f32 v116, v140, v141
v_lshlrev_b32 v140, 16, v116
v_and_b32 v141, 0xffff0000, v116
v_lshlrev_b32 v117, 16, v128
v_and_b32 v118, 0xffff0000, v128
v_add_f32 v140, v140, v117
v_add_f32 v141, v141, v118
v_cvt_pk_bf16_f32 v116, v140, v141
v_lshlrev_b32 v140, 16, v116
v_and_b32 v141, 0xffff0000, v116
v_max_f32 v140, 0, v140
v_max_f32 v141, 0, v141
v_mul_f32 v140, v140, v140
v_mul_f32 v141, v141, v141
v_cvt_pk_bf16_f32 v116, v142, v143
v_lshlrev_b32 v142, 16, v116
v_and_b32 v143, 0xffff0000, v116
v_lshlrev_b32 v117, 16, v129
v_and_b32 v118, 0xffff0000, v129
v_add_f32 v142, v142, v117
v_add_f32 v143, v143, v118
v_cvt_pk_bf16_f32 v116, v142, v143
v_lshlrev_b32 v142, 16, v116
v_and_b32 v143, 0xffff0000, v116
v_max_f32 v142, 0, v142
v_max_f32 v143, 0, v143
v_mul_f32 v142, v142, v142
v_mul_f32 v143, v143, v143
v_cvt_pk_bf16_f32 v116, v144, v145
v_lshlrev_b32 v144, 16, v116
v_and_b32 v145, 0xffff0000, v116
v_lshlrev_b32 v117, 16, v130
v_and_b32 v118, 0xffff0000, v130
v_add_f32 v144, v144, v117
v_add_f32 v145, v145, v118
v_cvt_pk_bf16_f32 v116, v144, v145
v_lshlrev_b32 v144, 16, v116
v_and_b32 v145, 0xffff0000, v116
v_max_f32 v144, 0, v144
v_max_f32 v145, 0, v145
v_mul_f32 v144, v144, v144
v_mul_f32 v145, v145, v145
v_cvt_pk_bf16_f32 v116, v146, v147
v_lshlrev_b32 v146, 16, v116
v_and_b32 v147, 0xffff0000, v116
v_lshlrev_b32 v117, 16, v131
v_and_b32 v118, 0xffff0000, v131
v_add_f32 v146, v146, v117
v_add_f32 v147, v147, v118
v_cvt_pk_bf16_f32 v116, v146, v147
v_lshlrev_b32 v146, 16, v116
v_and_b32 v147, 0xffff0000, v116
v_max_f32 v146, 0, v146
v_max_f32 v147, 0, v147
v_mul_f32 v146, v146, v146
v_mul_f32 v147, v147, v147
v_cvt_pk_bf16_f32 v116, v132, v133
v_cvt_pk_bf16_f32 v117, v134, v135
v_cvt_pk_bf16_f32 v118, v140, v141
v_cvt_pk_bf16_f32 v119, v142, v143
v_cvt_pk_bf16_f32 v120, v136, v137
v_cvt_pk_bf16_f32 v121, v138, v139
v_cvt_pk_bf16_f32 v122, v144, v145
v_cvt_pk_bf16_f32 v123, v146, v147
s_add_u32 s41, s40, 6144
buffer_store_dwordx4 v[116:119], v112, s[20:23], s41 offen sc1
buffer_store_dwordx4 v[120:123], v148, s[20:23], s41 offen sc1
s_add_u32 s41, s61, 64
buffer_load_dwordx2 v[124:125], v4, s[80:83], s41 offen offset:0
buffer_load_dwordx2 v[126:127], v4, s[80:83], s41 offen offset:16
buffer_load_dwordx2 v[128:129], v4, s[80:83], s41 offen offset:32
buffer_load_dwordx2 v[130:131], v4, s[80:83], s41 offen offset:48
s_waitcnt vmcnt(0)
v_accvgpr_read_b32 v132, a16
v_accvgpr_read_b32 v133, a17
v_accvgpr_read_b32 v134, a18
v_accvgpr_read_b32 v135, a19
v_accvgpr_read_b32 v136, a20
v_accvgpr_read_b32 v137, a21
v_accvgpr_read_b32 v138, a22
v_accvgpr_read_b32 v139, a23
v_accvgpr_read_b32 v140, a24
v_accvgpr_read_b32 v141, a25
v_accvgpr_read_b32 v142, a26
v_accvgpr_read_b32 v143, a27
v_accvgpr_read_b32 v144, a28
v_accvgpr_read_b32 v145, a29
v_accvgpr_read_b32 v146, a30
v_accvgpr_read_b32 v147, a31
v_cvt_pk_bf16_f32 v116, v132, v133
v_lshlrev_b32 v132, 16, v116
v_and_b32 v133, 0xffff0000, v116
v_lshlrev_b32 v117, 16, v124
v_and_b32 v118, 0xffff0000, v124
v_add_f32 v132, v132, v117
v_add_f32 v133, v133, v118
v_cvt_pk_bf16_f32 v116, v132, v133
v_lshlrev_b32 v132, 16, v116
v_and_b32 v133, 0xffff0000, v116
v_max_f32 v132, 0, v132
v_max_f32 v133, 0, v133
v_mul_f32 v132, v132, v132
v_mul_f32 v133, v133, v133
v_cvt_pk_bf16_f32 v116, v134, v135
v_lshlrev_b32 v134, 16, v116
v_and_b32 v135, 0xffff0000, v116
v_lshlrev_b32 v117, 16, v125
v_and_b32 v118, 0xffff0000, v125
v_add_f32 v134, v134, v117
v_add_f32 v135, v135, v118
v_cvt_pk_bf16_f32 v116, v134, v135
v_lshlrev_b32 v134, 16, v116
v_and_b32 v135, 0xffff0000, v116
v_max_f32 v134, 0, v134
v_max_f32 v135, 0, v135
v_mul_f32 v134, v134, v134
v_mul_f32 v135, v135, v135
v_cvt_pk_bf16_f32 v116, v136, v137
v_lshlrev_b32 v136, 16, v116
v_and_b32 v137, 0xffff0000, v116
v_lshlrev_b32 v117, 16, v126
v_and_b32 v118, 0xffff0000, v126
v_add_f32 v136, v136, v117
v_add_f32 v137, v137, v118
v_cvt_pk_bf16_f32 v116, v136, v137
v_lshlrev_b32 v136, 16, v116
v_and_b32 v137, 0xffff0000, v116
v_max_f32 v136, 0, v136
v_max_f32 v137, 0, v137
v_mul_f32 v136, v136, v136
v_mul_f32 v137, v137, v137
v_cvt_pk_bf16_f32 v116, v138, v139
v_lshlrev_b32 v138, 16, v116
v_and_b32 v139, 0xffff0000, v116
v_lshlrev_b32 v117, 16, v127
v_and_b32 v118, 0xffff0000, v127
v_add_f32 v138, v138, v117
v_add_f32 v139, v139, v118
v_cvt_pk_bf16_f32 v116, v138, v139
v_lshlrev_b32 v138, 16, v116
v_and_b32 v139, 0xffff0000, v116
v_max_f32 v138, 0, v138
v_max_f32 v139, 0, v139
v_mul_f32 v138, v138, v138
v_mul_f32 v139, v139, v139
v_cvt_pk_bf16_f32 v116, v140, v141
v_lshlrev_b32 v140, 16, v116
v_and_b32 v141, 0xffff0000, v116
v_lshlrev_b32 v117, 16, v128
v_and_b32 v118, 0xffff0000, v128
v_add_f32 v140, v140, v117
v_add_f32 v141, v141, v118
v_cvt_pk_bf16_f32 v116, v140, v141
v_lshlrev_b32 v140, 16, v116
v_and_b32 v141, 0xffff0000, v116
v_max_f32 v140, 0, v140
v_max_f32 v141, 0, v141
v_mul_f32 v140, v140, v140
v_mul_f32 v141, v141, v141
v_cvt_pk_bf16_f32 v116, v142, v143
v_lshlrev_b32 v142, 16, v116
v_and_b32 v143, 0xffff0000, v116
v_lshlrev_b32 v117, 16, v129
v_and_b32 v118, 0xffff0000, v129
v_add_f32 v142, v142, v117
v_add_f32 v143, v143, v118
v_cvt_pk_bf16_f32 v116, v142, v143
v_lshlrev_b32 v142, 16, v116
v_and_b32 v143, 0xffff0000, v116
v_max_f32 v142, 0, v142
v_max_f32 v143, 0, v143
v_mul_f32 v142, v142, v142
v_mul_f32 v143, v143, v143
v_cvt_pk_bf16_f32 v116, v144, v145
v_lshlrev_b32 v144, 16, v116
v_and_b32 v145, 0xffff0000, v116
v_lshlrev_b32 v117, 16, v130
v_and_b32 v118, 0xffff0000, v130
v_add_f32 v144, v144, v117
v_add_f32 v145, v145, v118
v_cvt_pk_bf16_f32 v116, v144, v145
v_lshlrev_b32 v144, 16, v116
v_and_b32 v145, 0xffff0000, v116
v_max_f32 v144, 0, v144
v_max_f32 v145, 0, v145
v_mul_f32 v144, v144, v144
v_mul_f32 v145, v145, v145
v_cvt_pk_bf16_f32 v116, v146, v147
v_lshlrev_b32 v146, 16, v116
v_and_b32 v147, 0xffff0000, v116
v_lshlrev_b32 v117, 16, v131
v_and_b32 v118, 0xffff0000, v131
v_add_f32 v146, v146, v117
v_add_f32 v147, v147, v118
v_cvt_pk_bf16_f32 v116, v146, v147
v_lshlrev_b32 v146, 16, v116
v_and_b32 v147, 0xffff0000, v116
v_max_f32 v146, 0, v146
v_max_f32 v147, 0, v147
v_mul_f32 v146, v146, v146
v_mul_f32 v147, v147, v147
v_cvt_pk_bf16_f32 v116, v132, v133
v_cvt_pk_bf16_f32 v117, v134, v135
v_cvt_pk_bf16_f32 v118, v140, v141
v_cvt_pk_bf16_f32 v119, v142, v143
v_cvt_pk_bf16_f32 v120, v136, v137
v_cvt_pk_bf16_f32 v121, v138, v139
v_cvt_pk_bf16_f32 v122, v144, v145
v_cvt_pk_bf16_f32 v123, v146, v147
s_add_u32 s41, s40, 16384
buffer_store_dwordx4 v[116:119], v112, s[20:23], s41 offen sc1
buffer_store_dwordx4 v[120:123], v148, s[20:23], s41 offen sc1
v_accvgpr_read_b32 v132, a64
v_accvgpr_read_b32 v133, a65
v_accvgpr_read_b32 v134, a66
v_accvgpr_read_b32 v135, a67
v_accvgpr_read_b32 v136, a68
v_accvgpr_read_b32 v137, a69
v_accvgpr_read_b32 v138, a70
v_accvgpr_read_b32 v139, a71
v_accvgpr_read_b32 v140, a72
v_accvgpr_read_b32 v141, a73
v_accvgpr_read_b32 v142, a74
v_accvgpr_read_b32 v143, a75
v_accvgpr_read_b32 v144, a76
v_accvgpr_read_b32 v145, a77
v_accvgpr_read_b32 v146, a78
v_accvgpr_read_b32 v147, a79
v_cvt_pk_bf16_f32 v116, v132, v133
v_lshlrev_b32 v132, 16, v116
v_and_b32 v133, 0xffff0000, v116
v_lshlrev_b32 v117, 16, v124
v_and_b32 v118, 0xffff0000, v124
v_add_f32 v132, v132, v117
v_add_f32 v133, v133, v118
v_cvt_pk_bf16_f32 v116, v132, v133
v_lshlrev_b32 v132, 16, v116
v_and_b32 v133, 0xffff0000, v116
v_max_f32 v132, 0, v132
v_max_f32 v133, 0, v133
v_mul_f32 v132, v132, v132
v_mul_f32 v133, v133, v133
v_cvt_pk_bf16_f32 v116, v134, v135
v_lshlrev_b32 v134, 16, v116
v_and_b32 v135, 0xffff0000, v116
v_lshlrev_b32 v117, 16, v125
v_and_b32 v118, 0xffff0000, v125
v_add_f32 v134, v134, v117
v_add_f32 v135, v135, v118
v_cvt_pk_bf16_f32 v116, v134, v135
v_lshlrev_b32 v134, 16, v116
v_and_b32 v135, 0xffff0000, v116
v_max_f32 v134, 0, v134
v_max_f32 v135, 0, v135
v_mul_f32 v134, v134, v134
v_mul_f32 v135, v135, v135
v_cvt_pk_bf16_f32 v116, v136, v137
v_lshlrev_b32 v136, 16, v116
v_and_b32 v137, 0xffff0000, v116
v_lshlrev_b32 v117, 16, v126
v_and_b32 v118, 0xffff0000, v126
v_add_f32 v136, v136, v117
v_add_f32 v137, v137, v118
v_cvt_pk_bf16_f32 v116, v136, v137
v_lshlrev_b32 v136, 16, v116
v_and_b32 v137, 0xffff0000, v116
v_max_f32 v136, 0, v136
v_max_f32 v137, 0, v137
v_mul_f32 v136, v136, v136
v_mul_f32 v137, v137, v137
v_cvt_pk_bf16_f32 v116, v138, v139
v_lshlrev_b32 v138, 16, v116
v_and_b32 v139, 0xffff0000, v116
v_lshlrev_b32 v117, 16, v127
v_and_b32 v118, 0xffff0000, v127
v_add_f32 v138, v138, v117
v_add_f32 v139, v139, v118
v_cvt_pk_bf16_f32 v116, v138, v139
v_lshlrev_b32 v138, 16, v116
v_and_b32 v139, 0xffff0000, v116
v_max_f32 v138, 0, v138
v_max_f32 v139, 0, v139
v_mul_f32 v138, v138, v138
v_mul_f32 v139, v139, v139
v_cvt_pk_bf16_f32 v116, v140, v141
v_lshlrev_b32 v140, 16, v116
v_and_b32 v141, 0xffff0000, v116
v_lshlrev_b32 v117, 16, v128
v_and_b32 v118, 0xffff0000, v128
v_add_f32 v140, v140, v117
v_add_f32 v141, v141, v118
v_cvt_pk_bf16_f32 v116, v140, v141
v_lshlrev_b32 v140, 16, v116
v_and_b32 v141, 0xffff0000, v116
v_max_f32 v140, 0, v140
v_max_f32 v141, 0, v141
v_mul_f32 v140, v140, v140
v_mul_f32 v141, v141, v141
v_cvt_pk_bf16_f32 v116, v142, v143
v_lshlrev_b32 v142, 16, v116
v_and_b32 v143, 0xffff0000, v116
v_lshlrev_b32 v117, 16, v129
v_and_b32 v118, 0xffff0000, v129
v_add_f32 v142, v142, v117
v_add_f32 v143, v143, v118
v_cvt_pk_bf16_f32 v116, v142, v143
v_lshlrev_b32 v142, 16, v116
v_and_b32 v143, 0xffff0000, v116
v_max_f32 v142, 0, v142
v_max_f32 v143, 0, v143
v_mul_f32 v142, v142, v142
v_mul_f32 v143, v143, v143
v_cvt_pk_bf16_f32 v116, v144, v145
v_lshlrev_b32 v144, 16, v116
v_and_b32 v145, 0xffff0000, v116
v_lshlrev_b32 v117, 16, v130
v_and_b32 v118, 0xffff0000, v130
v_add_f32 v144, v144, v117
v_add_f32 v145, v145, v118
v_cvt_pk_bf16_f32 v116, v144, v145
v_lshlrev_b32 v144, 16, v116
v_and_b32 v145, 0xffff0000, v116
v_max_f32 v144, 0, v144
v_max_f32 v145, 0, v145
v_mul_f32 v144, v144, v144
v_mul_f32 v145, v145, v145
v_cvt_pk_bf16_f32 v116, v146, v147
v_lshlrev_b32 v146, 16, v116
v_and_b32 v147, 0xffff0000, v116
v_lshlrev_b32 v117, 16, v131
v_and_b32 v118, 0xffff0000, v131
v_add_f32 v146, v146, v117
v_add_f32 v147, v147, v118
v_cvt_pk_bf16_f32 v116, v146, v147
v_lshlrev_b32 v146, 16, v116
v_and_b32 v147, 0xffff0000, v116
v_max_f32 v146, 0, v146
v_max_f32 v147, 0, v147
v_mul_f32 v146, v146, v146
v_mul_f32 v147, v147, v147
v_cvt_pk_bf16_f32 v116, v132, v133
v_cvt_pk_bf16_f32 v117, v134, v135
v_cvt_pk_bf16_f32 v118, v140, v141
v_cvt_pk_bf16_f32 v119, v142, v143
v_cvt_pk_bf16_f32 v120, v136, v137
v_cvt_pk_bf16_f32 v121, v138, v139
v_cvt_pk_bf16_f32 v122, v144, v145
v_cvt_pk_bf16_f32 v123, v146, v147
s_add_u32 s41, s40, 18432
buffer_store_dwordx4 v[116:119], v112, s[20:23], s41 offen sc1
buffer_store_dwordx4 v[120:123], v148, s[20:23], s41 offen sc1
v_accvgpr_read_b32 v132, a112
v_accvgpr_read_b32 v133, a113
v_accvgpr_read_b32 v134, a114
v_accvgpr_read_b32 v135, a115
v_accvgpr_read_b32 v136, a116
v_accvgpr_read_b32 v137, a117
v_accvgpr_read_b32 v138, a118
v_accvgpr_read_b32 v139, a119
v_accvgpr_read_b32 v140, a120
v_accvgpr_read_b32 v141, a121
v_accvgpr_read_b32 v142, a122
v_accvgpr_read_b32 v143, a123
v_accvgpr_read_b32 v144, a124
v_accvgpr_read_b32 v145, a125
v_accvgpr_read_b32 v146, a126
v_accvgpr_read_b32 v147, a127
v_cvt_pk_bf16_f32 v116, v132, v133
v_lshlrev_b32 v132, 16, v116
v_and_b32 v133, 0xffff0000, v116
v_lshlrev_b32 v117, 16, v124
v_and_b32 v118, 0xffff0000, v124
v_add_f32 v132, v132, v117
v_add_f32 v133, v133, v118
v_cvt_pk_bf16_f32 v116, v132, v133
v_lshlrev_b32 v132, 16, v116
v_and_b32 v133, 0xffff0000, v116
v_max_f32 v132, 0, v132
v_max_f32 v133, 0, v133
v_mul_f32 v132, v132, v132
v_mul_f32 v133, v133, v133
v_cvt_pk_bf16_f32 v116, v134, v135
v_lshlrev_b32 v134, 16, v116
v_and_b32 v135, 0xffff0000, v116
v_lshlrev_b32 v117, 16, v125
v_and_b32 v118, 0xffff0000, v125
v_add_f32 v134, v134, v117
v_add_f32 v135, v135, v118
v_cvt_pk_bf16_f32 v116, v134, v135
v_lshlrev_b32 v134, 16, v116
v_and_b32 v135, 0xffff0000, v116
v_max_f32 v134, 0, v134
v_max_f32 v135, 0, v135
v_mul_f32 v134, v134, v134
v_mul_f32 v135, v135, v135
v_cvt_pk_bf16_f32 v116, v136, v137
v_lshlrev_b32 v136, 16, v116
v_and_b32 v137, 0xffff0000, v116
v_lshlrev_b32 v117, 16, v126
v_and_b32 v118, 0xffff0000, v126
v_add_f32 v136, v136, v117
v_add_f32 v137, v137, v118
v_cvt_pk_bf16_f32 v116, v136, v137
v_lshlrev_b32 v136, 16, v116
v_and_b32 v137, 0xffff0000, v116
v_max_f32 v136, 0, v136
v_max_f32 v137, 0, v137
v_mul_f32 v136, v136, v136
v_mul_f32 v137, v137, v137
v_cvt_pk_bf16_f32 v116, v138, v139
v_lshlrev_b32 v138, 16, v116
v_and_b32 v139, 0xffff0000, v116
v_lshlrev_b32 v117, 16, v127
v_and_b32 v118, 0xffff0000, v127
v_add_f32 v138, v138, v117
v_add_f32 v139, v139, v118
v_cvt_pk_bf16_f32 v116, v138, v139
v_lshlrev_b32 v138, 16, v116
v_and_b32 v139, 0xffff0000, v116
v_max_f32 v138, 0, v138
v_max_f32 v139, 0, v139
v_mul_f32 v138, v138, v138
v_mul_f32 v139, v139, v139
v_cvt_pk_bf16_f32 v116, v140, v141
v_lshlrev_b32 v140, 16, v116
v_and_b32 v141, 0xffff0000, v116
v_lshlrev_b32 v117, 16, v128
v_and_b32 v118, 0xffff0000, v128
v_add_f32 v140, v140, v117
v_add_f32 v141, v141, v118
v_cvt_pk_bf16_f32 v116, v140, v141
v_lshlrev_b32 v140, 16, v116
v_and_b32 v141, 0xffff0000, v116
v_max_f32 v140, 0, v140
v_max_f32 v141, 0, v141
v_mul_f32 v140, v140, v140
v_mul_f32 v141, v141, v141
v_cvt_pk_bf16_f32 v116, v142, v143
v_lshlrev_b32 v142, 16, v116
v_and_b32 v143, 0xffff0000, v116
v_lshlrev_b32 v117, 16, v129
v_and_b32 v118, 0xffff0000, v129
v_add_f32 v142, v142, v117
v_add_f32 v143, v143, v118
v_cvt_pk_bf16_f32 v116, v142, v143
v_lshlrev_b32 v142, 16, v116
v_and_b32 v143, 0xffff0000, v116
v_max_f32 v142, 0, v142
v_max_f32 v143, 0, v143
v_mul_f32 v142, v142, v142
v_mul_f32 v143, v143, v143
v_cvt_pk_bf16_f32 v116, v144, v145
v_lshlrev_b32 v144, 16, v116
v_and_b32 v145, 0xffff0000, v116
v_lshlrev_b32 v117, 16, v130
v_and_b32 v118, 0xffff0000, v130
v_add_f32 v144, v144, v117
v_add_f32 v145, v145, v118
v_cvt_pk_bf16_f32 v116, v144, v145
v_lshlrev_b32 v144, 16, v116
v_and_b32 v145, 0xffff0000, v116
v_max_f32 v144, 0, v144
v_max_f32 v145, 0, v145
v_mul_f32 v144, v144, v144
v_mul_f32 v145, v145, v145
v_cvt_pk_bf16_f32 v116, v146, v147
v_lshlrev_b32 v146, 16, v116
v_and_b32 v147, 0xffff0000, v116
v_lshlrev_b32 v117, 16, v131
v_and_b32 v118, 0xffff0000, v131
v_add_f32 v146, v146, v117
v_add_f32 v147, v147, v118
v_cvt_pk_bf16_f32 v116, v146, v147
v_lshlrev_b32 v146, 16, v116
v_and_b32 v147, 0xffff0000, v116
v_max_f32 v146, 0, v146
v_max_f32 v147, 0, v147
v_mul_f32 v146, v146, v146
v_mul_f32 v147, v147, v147
v_cvt_pk_bf16_f32 v116, v132, v133
v_cvt_pk_bf16_f32 v117, v134, v135
v_cvt_pk_bf16_f32 v118, v140, v141
v_cvt_pk_bf16_f32 v119, v142, v143
v_cvt_pk_bf16_f32 v120, v136, v137
v_cvt_pk_bf16_f32 v121, v138, v139
v_cvt_pk_bf16_f32 v122, v144, v145
v_cvt_pk_bf16_f32 v123, v146, v147
s_add_u32 s41, s40, 20480
buffer_store_dwordx4 v[116:119], v112, s[20:23], s41 offen sc1
buffer_store_dwordx4 v[120:123], v148, s[20:23], s41 offen sc1
v_accvgpr_read_b32 v132, a160
v_accvgpr_read_b32 v133, a161
v_accvgpr_read_b32 v134, a162
v_accvgpr_read_b32 v135, a163
v_accvgpr_read_b32 v136, a164
v_accvgpr_read_b32 v137, a165
v_accvgpr_read_b32 v138, a166
v_accvgpr_read_b32 v139, a167
v_accvgpr_read_b32 v140, a168
v_accvgpr_read_b32 v141, a169
v_accvgpr_read_b32 v142, a170
v_accvgpr_read_b32 v143, a171
v_accvgpr_read_b32 v144, a172
v_accvgpr_read_b32 v145, a173
v_accvgpr_read_b32 v146, a174
v_accvgpr_read_b32 v147, a175
v_cvt_pk_bf16_f32 v116, v132, v133
v_lshlrev_b32 v132, 16, v116
v_and_b32 v133, 0xffff0000, v116
v_lshlrev_b32 v117, 16, v124
v_and_b32 v118, 0xffff0000, v124
v_add_f32 v132, v132, v117
v_add_f32 v133, v133, v118
v_cvt_pk_bf16_f32 v116, v132, v133
v_lshlrev_b32 v132, 16, v116
v_and_b32 v133, 0xffff0000, v116
v_max_f32 v132, 0, v132
v_max_f32 v133, 0, v133
v_mul_f32 v132, v132, v132
v_mul_f32 v133, v133, v133
v_cvt_pk_bf16_f32 v116, v134, v135
v_lshlrev_b32 v134, 16, v116
v_and_b32 v135, 0xffff0000, v116
v_lshlrev_b32 v117, 16, v125
v_and_b32 v118, 0xffff0000, v125
v_add_f32 v134, v134, v117
v_add_f32 v135, v135, v118
v_cvt_pk_bf16_f32 v116, v134, v135
v_lshlrev_b32 v134, 16, v116
v_and_b32 v135, 0xffff0000, v116
v_max_f32 v134, 0, v134
v_max_f32 v135, 0, v135
v_mul_f32 v134, v134, v134
v_mul_f32 v135, v135, v135
v_cvt_pk_bf16_f32 v116, v136, v137
v_lshlrev_b32 v136, 16, v116
v_and_b32 v137, 0xffff0000, v116
v_lshlrev_b32 v117, 16, v126
v_and_b32 v118, 0xffff0000, v126
v_add_f32 v136, v136, v117
v_add_f32 v137, v137, v118
v_cvt_pk_bf16_f32 v116, v136, v137
v_lshlrev_b32 v136, 16, v116
v_and_b32 v137, 0xffff0000, v116
v_max_f32 v136, 0, v136
v_max_f32 v137, 0, v137
v_mul_f32 v136, v136, v136
v_mul_f32 v137, v137, v137
v_cvt_pk_bf16_f32 v116, v138, v139
v_lshlrev_b32 v138, 16, v116
v_and_b32 v139, 0xffff0000, v116
v_lshlrev_b32 v117, 16, v127
v_and_b32 v118, 0xffff0000, v127
v_add_f32 v138, v138, v117
v_add_f32 v139, v139, v118
v_cvt_pk_bf16_f32 v116, v138, v139
v_lshlrev_b32 v138, 16, v116
v_and_b32 v139, 0xffff0000, v116
v_max_f32 v138, 0, v138
v_max_f32 v139, 0, v139
v_mul_f32 v138, v138, v138
v_mul_f32 v139, v139, v139
v_cvt_pk_bf16_f32 v116, v140, v141
v_lshlrev_b32 v140, 16, v116
v_and_b32 v141, 0xffff0000, v116
v_lshlrev_b32 v117, 16, v128
v_and_b32 v118, 0xffff0000, v128
v_add_f32 v140, v140, v117
v_add_f32 v141, v141, v118
v_cvt_pk_bf16_f32 v116, v140, v141
v_lshlrev_b32 v140, 16, v116
v_and_b32 v141, 0xffff0000, v116
v_max_f32 v140, 0, v140
v_max_f32 v141, 0, v141
v_mul_f32 v140, v140, v140
v_mul_f32 v141, v141, v141
v_cvt_pk_bf16_f32 v116, v142, v143
v_lshlrev_b32 v142, 16, v116
v_and_b32 v143, 0xffff0000, v116
v_lshlrev_b32 v117, 16, v129
v_and_b32 v118, 0xffff0000, v129
v_add_f32 v142, v142, v117
v_add_f32 v143, v143, v118
v_cvt_pk_bf16_f32 v116, v142, v143
v_lshlrev_b32 v142, 16, v116
v_and_b32 v143, 0xffff0000, v116
v_max_f32 v142, 0, v142
v_max_f32 v143, 0, v143
v_mul_f32 v142, v142, v142
v_mul_f32 v143, v143, v143
v_cvt_pk_bf16_f32 v116, v144, v145
v_lshlrev_b32 v144, 16, v116
v_and_b32 v145, 0xffff0000, v116
v_lshlrev_b32 v117, 16, v130
v_and_b32 v118, 0xffff0000, v130
v_add_f32 v144, v144, v117
v_add_f32 v145, v145, v118
v_cvt_pk_bf16_f32 v116, v144, v145
v_lshlrev_b32 v144, 16, v116
v_and_b32 v145, 0xffff0000, v116
v_max_f32 v144, 0, v144
v_max_f32 v145, 0, v145
v_mul_f32 v144, v144, v144
v_mul_f32 v145, v145, v145
v_cvt_pk_bf16_f32 v116, v146, v147
v_lshlrev_b32 v146, 16, v116
v_and_b32 v147, 0xffff0000, v116
v_lshlrev_b32 v117, 16, v131
v_and_b32 v118, 0xffff0000, v131
v_add_f32 v146, v146, v117
v_add_f32 v147, v147, v118
v_cvt_pk_bf16_f32 v116, v146, v147
v_lshlrev_b32 v146, 16, v116
v_and_b32 v147, 0xffff0000, v116
v_max_f32 v146, 0, v146
v_max_f32 v147, 0, v147
v_mul_f32 v146, v146, v146
v_mul_f32 v147, v147, v147
v_cvt_pk_bf16_f32 v116, v132, v133
v_cvt_pk_bf16_f32 v117, v134, v135
v_cvt_pk_bf16_f32 v118, v140, v141
v_cvt_pk_bf16_f32 v119, v142, v143
v_cvt_pk_bf16_f32 v120, v136, v137
v_cvt_pk_bf16_f32 v121, v138, v139
v_cvt_pk_bf16_f32 v122, v144, v145
v_cvt_pk_bf16_f32 v123, v146, v147
s_add_u32 s41, s40, 22528
buffer_store_dwordx4 v[116:119], v112, s[20:23], s41 offen sc1
buffer_store_dwordx4 v[120:123], v148, s[20:23], s41 offen sc1
s_add_u32 s41, s61, 128
buffer_load_dwordx2 v[124:125], v4, s[80:83], s41 offen offset:0
buffer_load_dwordx2 v[126:127], v4, s[80:83], s41 offen offset:16
buffer_load_dwordx2 v[128:129], v4, s[80:83], s41 offen offset:32
buffer_load_dwordx2 v[130:131], v4, s[80:83], s41 offen offset:48
s_waitcnt vmcnt(0)
v_accvgpr_read_b32 v132, a32
v_accvgpr_read_b32 v133, a33
v_accvgpr_read_b32 v134, a34
v_accvgpr_read_b32 v135, a35
v_accvgpr_read_b32 v136, a36
v_accvgpr_read_b32 v137, a37
v_accvgpr_read_b32 v138, a38
v_accvgpr_read_b32 v139, a39
v_accvgpr_read_b32 v140, a40
v_accvgpr_read_b32 v141, a41
v_accvgpr_read_b32 v142, a42
v_accvgpr_read_b32 v143, a43
v_accvgpr_read_b32 v144, a44
v_accvgpr_read_b32 v145, a45
v_accvgpr_read_b32 v146, a46
v_accvgpr_read_b32 v147, a47
v_cvt_pk_bf16_f32 v116, v132, v133
v_lshlrev_b32 v132, 16, v116
v_and_b32 v133, 0xffff0000, v116
v_lshlrev_b32 v117, 16, v124
v_and_b32 v118, 0xffff0000, v124
v_add_f32 v132, v132, v117
v_add_f32 v133, v133, v118
v_cvt_pk_bf16_f32 v116, v132, v133
v_lshlrev_b32 v132, 16, v116
v_and_b32 v133, 0xffff0000, v116
v_max_f32 v132, 0, v132
v_max_f32 v133, 0, v133
v_mul_f32 v132, v132, v132
v_mul_f32 v133, v133, v133
v_cvt_pk_bf16_f32 v116, v134, v135
v_lshlrev_b32 v134, 16, v116
v_and_b32 v135, 0xffff0000, v116
v_lshlrev_b32 v117, 16, v125
v_and_b32 v118, 0xffff0000, v125
v_add_f32 v134, v134, v117
v_add_f32 v135, v135, v118
v_cvt_pk_bf16_f32 v116, v134, v135
v_lshlrev_b32 v134, 16, v116
v_and_b32 v135, 0xffff0000, v116
v_max_f32 v134, 0, v134
v_max_f32 v135, 0, v135
v_mul_f32 v134, v134, v134
v_mul_f32 v135, v135, v135
v_cvt_pk_bf16_f32 v116, v136, v137
v_lshlrev_b32 v136, 16, v116
v_and_b32 v137, 0xffff0000, v116
v_lshlrev_b32 v117, 16, v126
v_and_b32 v118, 0xffff0000, v126
v_add_f32 v136, v136, v117
v_add_f32 v137, v137, v118
v_cvt_pk_bf16_f32 v116, v136, v137
v_lshlrev_b32 v136, 16, v116
v_and_b32 v137, 0xffff0000, v116
v_max_f32 v136, 0, v136
v_max_f32 v137, 0, v137
v_mul_f32 v136, v136, v136
v_mul_f32 v137, v137, v137
v_cvt_pk_bf16_f32 v116, v138, v139
v_lshlrev_b32 v138, 16, v116
v_and_b32 v139, 0xffff0000, v116
v_lshlrev_b32 v117, 16, v127
v_and_b32 v118, 0xffff0000, v127
v_add_f32 v138, v138, v117
v_add_f32 v139, v139, v118
v_cvt_pk_bf16_f32 v116, v138, v139
v_lshlrev_b32 v138, 16, v116
v_and_b32 v139, 0xffff0000, v116
v_max_f32 v138, 0, v138
v_max_f32 v139, 0, v139
v_mul_f32 v138, v138, v138
v_mul_f32 v139, v139, v139
v_cvt_pk_bf16_f32 v116, v140, v141
v_lshlrev_b32 v140, 16, v116
v_and_b32 v141, 0xffff0000, v116
v_lshlrev_b32 v117, 16, v128
v_and_b32 v118, 0xffff0000, v128
v_add_f32 v140, v140, v117
v_add_f32 v141, v141, v118
v_cvt_pk_bf16_f32 v116, v140, v141
v_lshlrev_b32 v140, 16, v116
v_and_b32 v141, 0xffff0000, v116
v_max_f32 v140, 0, v140
v_max_f32 v141, 0, v141
v_mul_f32 v140, v140, v140
v_mul_f32 v141, v141, v141
v_cvt_pk_bf16_f32 v116, v142, v143
v_lshlrev_b32 v142, 16, v116
v_and_b32 v143, 0xffff0000, v116
v_lshlrev_b32 v117, 16, v129
v_and_b32 v118, 0xffff0000, v129
v_add_f32 v142, v142, v117
v_add_f32 v143, v143, v118
v_cvt_pk_bf16_f32 v116, v142, v143
v_lshlrev_b32 v142, 16, v116
v_and_b32 v143, 0xffff0000, v116
v_max_f32 v142, 0, v142
v_max_f32 v143, 0, v143
v_mul_f32 v142, v142, v142
v_mul_f32 v143, v143, v143
v_cvt_pk_bf16_f32 v116, v144, v145
v_lshlrev_b32 v144, 16, v116
v_and_b32 v145, 0xffff0000, v116
v_lshlrev_b32 v117, 16, v130
v_and_b32 v118, 0xffff0000, v130
v_add_f32 v144, v144, v117
v_add_f32 v145, v145, v118
v_cvt_pk_bf16_f32 v116, v144, v145
v_lshlrev_b32 v144, 16, v116
v_and_b32 v145, 0xffff0000, v116
v_max_f32 v144, 0, v144
v_max_f32 v145, 0, v145
v_mul_f32 v144, v144, v144
v_mul_f32 v145, v145, v145
v_cvt_pk_bf16_f32 v116, v146, v147
v_lshlrev_b32 v146, 16, v116
v_and_b32 v147, 0xffff0000, v116
v_lshlrev_b32 v117, 16, v131
v_and_b32 v118, 0xffff0000, v131
v_add_f32 v146, v146, v117
v_add_f32 v147, v147, v118
v_cvt_pk_bf16_f32 v116, v146, v147
v_lshlrev_b32 v146, 16, v116
v_and_b32 v147, 0xffff0000, v116
v_max_f32 v146, 0, v146
v_max_f32 v147, 0, v147
v_mul_f32 v146, v146, v146
v_mul_f32 v147, v147, v147
v_cvt_pk_bf16_f32 v116, v132, v133
v_cvt_pk_bf16_f32 v117, v134, v135
v_cvt_pk_bf16_f32 v118, v140, v141
v_cvt_pk_bf16_f32 v119, v142, v143
v_cvt_pk_bf16_f32 v120, v136, v137
v_cvt_pk_bf16_f32 v121, v138, v139
v_cvt_pk_bf16_f32 v122, v144, v145
v_cvt_pk_bf16_f32 v123, v146, v147
s_add_u32 s41, s40, 32768
buffer_store_dwordx4 v[116:119], v112, s[20:23], s41 offen sc1
buffer_store_dwordx4 v[120:123], v148, s[20:23], s41 offen sc1
v_accvgpr_read_b32 v132, a80
v_accvgpr_read_b32 v133, a81
v_accvgpr_read_b32 v134, a82
v_accvgpr_read_b32 v135, a83
v_accvgpr_read_b32 v136, a84
v_accvgpr_read_b32 v137, a85
v_accvgpr_read_b32 v138, a86
v_accvgpr_read_b32 v139, a87
v_accvgpr_read_b32 v140, a88
v_accvgpr_read_b32 v141, a89
v_accvgpr_read_b32 v142, a90
v_accvgpr_read_b32 v143, a91
v_accvgpr_read_b32 v144, a92
v_accvgpr_read_b32 v145, a93
v_accvgpr_read_b32 v146, a94
v_accvgpr_read_b32 v147, a95
v_cvt_pk_bf16_f32 v116, v132, v133
v_lshlrev_b32 v132, 16, v116
v_and_b32 v133, 0xffff0000, v116
v_lshlrev_b32 v117, 16, v124
v_and_b32 v118, 0xffff0000, v124
v_add_f32 v132, v132, v117
v_add_f32 v133, v133, v118
v_cvt_pk_bf16_f32 v116, v132, v133
v_lshlrev_b32 v132, 16, v116
v_and_b32 v133, 0xffff0000, v116
v_max_f32 v132, 0, v132
v_max_f32 v133, 0, v133
v_mul_f32 v132, v132, v132
v_mul_f32 v133, v133, v133
v_cvt_pk_bf16_f32 v116, v134, v135
v_lshlrev_b32 v134, 16, v116
v_and_b32 v135, 0xffff0000, v116
v_lshlrev_b32 v117, 16, v125
v_and_b32 v118, 0xffff0000, v125
v_add_f32 v134, v134, v117
v_add_f32 v135, v135, v118
v_cvt_pk_bf16_f32 v116, v134, v135
v_lshlrev_b32 v134, 16, v116
v_and_b32 v135, 0xffff0000, v116
v_max_f32 v134, 0, v134
v_max_f32 v135, 0, v135
v_mul_f32 v134, v134, v134
v_mul_f32 v135, v135, v135
v_cvt_pk_bf16_f32 v116, v136, v137
v_lshlrev_b32 v136, 16, v116
v_and_b32 v137, 0xffff0000, v116
v_lshlrev_b32 v117, 16, v126
v_and_b32 v118, 0xffff0000, v126
v_add_f32 v136, v136, v117
v_add_f32 v137, v137, v118
v_cvt_pk_bf16_f32 v116, v136, v137
v_lshlrev_b32 v136, 16, v116
v_and_b32 v137, 0xffff0000, v116
v_max_f32 v136, 0, v136
v_max_f32 v137, 0, v137
v_mul_f32 v136, v136, v136
v_mul_f32 v137, v137, v137
v_cvt_pk_bf16_f32 v116, v138, v139
v_lshlrev_b32 v138, 16, v116
v_and_b32 v139, 0xffff0000, v116
v_lshlrev_b32 v117, 16, v127
v_and_b32 v118, 0xffff0000, v127
v_add_f32 v138, v138, v117
v_add_f32 v139, v139, v118
v_cvt_pk_bf16_f32 v116, v138, v139
v_lshlrev_b32 v138, 16, v116
v_and_b32 v139, 0xffff0000, v116
v_max_f32 v138, 0, v138
v_max_f32 v139, 0, v139
v_mul_f32 v138, v138, v138
v_mul_f32 v139, v139, v139
v_cvt_pk_bf16_f32 v116, v140, v141
v_lshlrev_b32 v140, 16, v116
v_and_b32 v141, 0xffff0000, v116
v_lshlrev_b32 v117, 16, v128
v_and_b32 v118, 0xffff0000, v128
v_add_f32 v140, v140, v117
v_add_f32 v141, v141, v118
v_cvt_pk_bf16_f32 v116, v140, v141
v_lshlrev_b32 v140, 16, v116
v_and_b32 v141, 0xffff0000, v116
v_max_f32 v140, 0, v140
v_max_f32 v141, 0, v141
v_mul_f32 v140, v140, v140
v_mul_f32 v141, v141, v141
v_cvt_pk_bf16_f32 v116, v142, v143
v_lshlrev_b32 v142, 16, v116
v_and_b32 v143, 0xffff0000, v116
v_lshlrev_b32 v117, 16, v129
v_and_b32 v118, 0xffff0000, v129
v_add_f32 v142, v142, v117
v_add_f32 v143, v143, v118
v_cvt_pk_bf16_f32 v116, v142, v143
v_lshlrev_b32 v142, 16, v116
v_and_b32 v143, 0xffff0000, v116
v_max_f32 v142, 0, v142
v_max_f32 v143, 0, v143
v_mul_f32 v142, v142, v142
v_mul_f32 v143, v143, v143
v_cvt_pk_bf16_f32 v116, v144, v145
v_lshlrev_b32 v144, 16, v116
v_and_b32 v145, 0xffff0000, v116
v_lshlrev_b32 v117, 16, v130
v_and_b32 v118, 0xffff0000, v130
v_add_f32 v144, v144, v117
v_add_f32 v145, v145, v118
v_cvt_pk_bf16_f32 v116, v144, v145
v_lshlrev_b32 v144, 16, v116
v_and_b32 v145, 0xffff0000, v116
v_max_f32 v144, 0, v144
v_max_f32 v145, 0, v145
v_mul_f32 v144, v144, v144
v_mul_f32 v145, v145, v145
v_cvt_pk_bf16_f32 v116, v146, v147
v_lshlrev_b32 v146, 16, v116
v_and_b32 v147, 0xffff0000, v116
v_lshlrev_b32 v117, 16, v131
v_and_b32 v118, 0xffff0000, v131
v_add_f32 v146, v146, v117
v_add_f32 v147, v147, v118
v_cvt_pk_bf16_f32 v116, v146, v147
v_lshlrev_b32 v146, 16, v116
v_and_b32 v147, 0xffff0000, v116
v_max_f32 v146, 0, v146
v_max_f32 v147, 0, v147
v_mul_f32 v146, v146, v146
v_mul_f32 v147, v147, v147
v_cvt_pk_bf16_f32 v116, v132, v133
v_cvt_pk_bf16_f32 v117, v134, v135
v_cvt_pk_bf16_f32 v118, v140, v141
v_cvt_pk_bf16_f32 v119, v142, v143
v_cvt_pk_bf16_f32 v120, v136, v137
v_cvt_pk_bf16_f32 v121, v138, v139
v_cvt_pk_bf16_f32 v122, v144, v145
v_cvt_pk_bf16_f32 v123, v146, v147
s_add_u32 s41, s40, 34816
buffer_store_dwordx4 v[116:119], v112, s[20:23], s41 offen sc1
buffer_store_dwordx4 v[120:123], v148, s[20:23], s41 offen sc1
v_accvgpr_read_b32 v132, a128
v_accvgpr_read_b32 v133, a129
v_accvgpr_read_b32 v134, a130
v_accvgpr_read_b32 v135, a131
v_accvgpr_read_b32 v136, a132
v_accvgpr_read_b32 v137, a133
v_accvgpr_read_b32 v138, a134
v_accvgpr_read_b32 v139, a135
v_accvgpr_read_b32 v140, a136
v_accvgpr_read_b32 v141, a137
v_accvgpr_read_b32 v142, a138
v_accvgpr_read_b32 v143, a139
v_accvgpr_read_b32 v144, a140
v_accvgpr_read_b32 v145, a141
v_accvgpr_read_b32 v146, a142
v_accvgpr_read_b32 v147, a143
v_cvt_pk_bf16_f32 v116, v132, v133
v_lshlrev_b32 v132, 16, v116
v_and_b32 v133, 0xffff0000, v116
v_lshlrev_b32 v117, 16, v124
v_and_b32 v118, 0xffff0000, v124
v_add_f32 v132, v132, v117
v_add_f32 v133, v133, v118
v_cvt_pk_bf16_f32 v116, v132, v133
v_lshlrev_b32 v132, 16, v116
v_and_b32 v133, 0xffff0000, v116
v_max_f32 v132, 0, v132
v_max_f32 v133, 0, v133
v_mul_f32 v132, v132, v132
v_mul_f32 v133, v133, v133
v_cvt_pk_bf16_f32 v116, v134, v135
v_lshlrev_b32 v134, 16, v116
v_and_b32 v135, 0xffff0000, v116
v_lshlrev_b32 v117, 16, v125
v_and_b32 v118, 0xffff0000, v125
v_add_f32 v134, v134, v117
v_add_f32 v135, v135, v118
v_cvt_pk_bf16_f32 v116, v134, v135
v_lshlrev_b32 v134, 16, v116
v_and_b32 v135, 0xffff0000, v116
v_max_f32 v134, 0, v134
v_max_f32 v135, 0, v135
v_mul_f32 v134, v134, v134
v_mul_f32 v135, v135, v135
v_cvt_pk_bf16_f32 v116, v136, v137
v_lshlrev_b32 v136, 16, v116
v_and_b32 v137, 0xffff0000, v116
v_lshlrev_b32 v117, 16, v126
v_and_b32 v118, 0xffff0000, v126
v_add_f32 v136, v136, v117
v_add_f32 v137, v137, v118
v_cvt_pk_bf16_f32 v116, v136, v137
v_lshlrev_b32 v136, 16, v116
v_and_b32 v137, 0xffff0000, v116
v_max_f32 v136, 0, v136
v_max_f32 v137, 0, v137
v_mul_f32 v136, v136, v136
v_mul_f32 v137, v137, v137
v_cvt_pk_bf16_f32 v116, v138, v139
v_lshlrev_b32 v138, 16, v116
v_and_b32 v139, 0xffff0000, v116
v_lshlrev_b32 v117, 16, v127
v_and_b32 v118, 0xffff0000, v127
v_add_f32 v138, v138, v117
v_add_f32 v139, v139, v118
v_cvt_pk_bf16_f32 v116, v138, v139
v_lshlrev_b32 v138, 16, v116
v_and_b32 v139, 0xffff0000, v116
v_max_f32 v138, 0, v138
v_max_f32 v139, 0, v139
v_mul_f32 v138, v138, v138
v_mul_f32 v139, v139, v139
v_cvt_pk_bf16_f32 v116, v140, v141
v_lshlrev_b32 v140, 16, v116
v_and_b32 v141, 0xffff0000, v116
v_lshlrev_b32 v117, 16, v128
v_and_b32 v118, 0xffff0000, v128
v_add_f32 v140, v140, v117
v_add_f32 v141, v141, v118
v_cvt_pk_bf16_f32 v116, v140, v141
v_lshlrev_b32 v140, 16, v116
v_and_b32 v141, 0xffff0000, v116
v_max_f32 v140, 0, v140
v_max_f32 v141, 0, v141
v_mul_f32 v140, v140, v140
v_mul_f32 v141, v141, v141
v_cvt_pk_bf16_f32 v116, v142, v143
v_lshlrev_b32 v142, 16, v116
v_and_b32 v143, 0xffff0000, v116
v_lshlrev_b32 v117, 16, v129
v_and_b32 v118, 0xffff0000, v129
v_add_f32 v142, v142, v117
v_add_f32 v143, v143, v118
v_cvt_pk_bf16_f32 v116, v142, v143
v_lshlrev_b32 v142, 16, v116
v_and_b32 v143, 0xffff0000, v116
v_max_f32 v142, 0, v142
v_max_f32 v143, 0, v143
v_mul_f32 v142, v142, v142
v_mul_f32 v143, v143, v143
v_cvt_pk_bf16_f32 v116, v144, v145
v_lshlrev_b32 v144, 16, v116
v_and_b32 v145, 0xffff0000, v116
v_lshlrev_b32 v117, 16, v130
v_and_b32 v118, 0xffff0000, v130
v_add_f32 v144, v144, v117
v_add_f32 v145, v145, v118
v_cvt_pk_bf16_f32 v116, v144, v145
v_lshlrev_b32 v144, 16, v116
v_and_b32 v145, 0xffff0000, v116
v_max_f32 v144, 0, v144
v_max_f32 v145, 0, v145
v_mul_f32 v144, v144, v144
v_mul_f32 v145, v145, v145
v_cvt_pk_bf16_f32 v116, v146, v147
v_lshlrev_b32 v146, 16, v116
v_and_b32 v147, 0xffff0000, v116
v_lshlrev_b32 v117, 16, v131
v_and_b32 v118, 0xffff0000, v131
v_add_f32 v146, v146, v117
v_add_f32 v147, v147, v118
v_cvt_pk_bf16_f32 v116, v146, v147
v_lshlrev_b32 v146, 16, v116
v_and_b32 v147, 0xffff0000, v116
v_max_f32 v146, 0, v146
v_max_f32 v147, 0, v147
v_mul_f32 v146, v146, v146
v_mul_f32 v147, v147, v147
v_cvt_pk_bf16_f32 v116, v132, v133
v_cvt_pk_bf16_f32 v117, v134, v135
v_cvt_pk_bf16_f32 v118, v140, v141
v_cvt_pk_bf16_f32 v119, v142, v143
v_cvt_pk_bf16_f32 v120, v136, v137
v_cvt_pk_bf16_f32 v121, v138, v139
v_cvt_pk_bf16_f32 v122, v144, v145
v_cvt_pk_bf16_f32 v123, v146, v147
s_add_u32 s41, s40, 36864
buffer_store_dwordx4 v[116:119], v112, s[20:23], s41 offen sc1
buffer_store_dwordx4 v[120:123], v148, s[20:23], s41 offen sc1
v_accvgpr_read_b32 v132, a176
v_accvgpr_read_b32 v133, a177
v_accvgpr_read_b32 v134, a178
v_accvgpr_read_b32 v135, a179
v_accvgpr_read_b32 v136, a180
v_accvgpr_read_b32 v137, a181
v_accvgpr_read_b32 v138, a182
v_accvgpr_read_b32 v139, a183
v_accvgpr_read_b32 v140, a184
v_accvgpr_read_b32 v141, a185
v_accvgpr_read_b32 v142, a186
v_accvgpr_read_b32 v143, a187
v_accvgpr_read_b32 v144, a188
v_accvgpr_read_b32 v145, a189
v_accvgpr_read_b32 v146, a190
v_accvgpr_read_b32 v147, a191
v_cvt_pk_bf16_f32 v116, v132, v133
v_lshlrev_b32 v132, 16, v116
v_and_b32 v133, 0xffff0000, v116
v_lshlrev_b32 v117, 16, v124
v_and_b32 v118, 0xffff0000, v124
v_add_f32 v132, v132, v117
v_add_f32 v133, v133, v118
v_cvt_pk_bf16_f32 v116, v132, v133
v_lshlrev_b32 v132, 16, v116
v_and_b32 v133, 0xffff0000, v116
v_max_f32 v132, 0, v132
v_max_f32 v133, 0, v133
v_mul_f32 v132, v132, v132
v_mul_f32 v133, v133, v133
v_cvt_pk_bf16_f32 v116, v134, v135
v_lshlrev_b32 v134, 16, v116
v_and_b32 v135, 0xffff0000, v116
v_lshlrev_b32 v117, 16, v125
v_and_b32 v118, 0xffff0000, v125
v_add_f32 v134, v134, v117
v_add_f32 v135, v135, v118
v_cvt_pk_bf16_f32 v116, v134, v135
v_lshlrev_b32 v134, 16, v116
v_and_b32 v135, 0xffff0000, v116
v_max_f32 v134, 0, v134
v_max_f32 v135, 0, v135
v_mul_f32 v134, v134, v134
v_mul_f32 v135, v135, v135
v_cvt_pk_bf16_f32 v116, v136, v137
v_lshlrev_b32 v136, 16, v116
v_and_b32 v137, 0xffff0000, v116
v_lshlrev_b32 v117, 16, v126
v_and_b32 v118, 0xffff0000, v126
v_add_f32 v136, v136, v117
v_add_f32 v137, v137, v118
v_cvt_pk_bf16_f32 v116, v136, v137
v_lshlrev_b32 v136, 16, v116
v_and_b32 v137, 0xffff0000, v116
v_max_f32 v136, 0, v136
v_max_f32 v137, 0, v137
v_mul_f32 v136, v136, v136
v_mul_f32 v137, v137, v137
v_cvt_pk_bf16_f32 v116, v138, v139
v_lshlrev_b32 v138, 16, v116
v_and_b32 v139, 0xffff0000, v116
v_lshlrev_b32 v117, 16, v127
v_and_b32 v118, 0xffff0000, v127
v_add_f32 v138, v138, v117
v_add_f32 v139, v139, v118
v_cvt_pk_bf16_f32 v116, v138, v139
v_lshlrev_b32 v138, 16, v116
v_and_b32 v139, 0xffff0000, v116
v_max_f32 v138, 0, v138
v_max_f32 v139, 0, v139
v_mul_f32 v138, v138, v138
v_mul_f32 v139, v139, v139
v_cvt_pk_bf16_f32 v116, v140, v141
v_lshlrev_b32 v140, 16, v116
v_and_b32 v141, 0xffff0000, v116
v_lshlrev_b32 v117, 16, v128
v_and_b32 v118, 0xffff0000, v128
v_add_f32 v140, v140, v117
v_add_f32 v141, v141, v118
v_cvt_pk_bf16_f32 v116, v140, v141
v_lshlrev_b32 v140, 16, v116
v_and_b32 v141, 0xffff0000, v116
v_max_f32 v140, 0, v140
v_max_f32 v141, 0, v141
v_mul_f32 v140, v140, v140
v_mul_f32 v141, v141, v141
v_cvt_pk_bf16_f32 v116, v142, v143
v_lshlrev_b32 v142, 16, v116
v_and_b32 v143, 0xffff0000, v116
v_lshlrev_b32 v117, 16, v129
v_and_b32 v118, 0xffff0000, v129
v_add_f32 v142, v142, v117
v_add_f32 v143, v143, v118
v_cvt_pk_bf16_f32 v116, v142, v143
v_lshlrev_b32 v142, 16, v116
v_and_b32 v143, 0xffff0000, v116
v_max_f32 v142, 0, v142
v_max_f32 v143, 0, v143
v_mul_f32 v142, v142, v142
v_mul_f32 v143, v143, v143
v_cvt_pk_bf16_f32 v116, v144, v145
v_lshlrev_b32 v144, 16, v116
v_and_b32 v145, 0xffff0000, v116
v_lshlrev_b32 v117, 16, v130
v_and_b32 v118, 0xffff0000, v130
v_add_f32 v144, v144, v117
v_add_f32 v145, v145, v118
v_cvt_pk_bf16_f32 v116, v144, v145
v_lshlrev_b32 v144, 16, v116
v_and_b32 v145, 0xffff0000, v116
v_max_f32 v144, 0, v144
v_max_f32 v145, 0, v145
v_mul_f32 v144, v144, v144
v_mul_f32 v145, v145, v145
v_cvt_pk_bf16_f32 v116, v146, v147
v_lshlrev_b32 v146, 16, v116
v_and_b32 v147, 0xffff0000, v116
v_lshlrev_b32 v117, 16, v131
v_and_b32 v118, 0xffff0000, v131
v_add_f32 v146, v146, v117
v_add_f32 v147, v147, v118
v_cvt_pk_bf16_f32 v116, v146, v147
v_lshlrev_b32 v146, 16, v116
v_and_b32 v147, 0xffff0000, v116
v_max_f32 v146, 0, v146
v_max_f32 v147, 0, v147
v_mul_f32 v146, v146, v146
v_mul_f32 v147, v147, v147
v_cvt_pk_bf16_f32 v116, v132, v133
v_cvt_pk_bf16_f32 v117, v134, v135
v_cvt_pk_bf16_f32 v118, v140, v141
v_cvt_pk_bf16_f32 v119, v142, v143
v_cvt_pk_bf16_f32 v120, v136, v137
v_cvt_pk_bf16_f32 v121, v138, v139
v_cvt_pk_bf16_f32 v122, v144, v145
v_cvt_pk_bf16_f32 v123, v146, v147
s_add_u32 s41, s40, 38912
buffer_store_dwordx4 v[116:119], v112, s[20:23], s41 offen sc1
buffer_store_dwordx4 v[120:123], v148, s[20:23], s41 offen sc1
s_mov_b32 s60, 178479104
s_branch L_g1_next_A
L_g1_v_A:
s_waitcnt vmcnt(21)
s_barrier
ds_read_b128 v[44:47], v34 offset:0
ds_read_b128 v[48:51], v34 offset:2048
ds_read_b128 v[52:55], v34 offset:4096
ds_read_b128 v[56:59], v34 offset:6144
ds_read_b64_tr_b16 v[76:77], v36 offset:0
ds_read_b64_tr_b16 v[78:79], v37 offset:0
ds_read_b64_tr_b16 v[80:81], v40 offset:0
ds_read_b64_tr_b16 v[82:83], v41 offset:0
ds_read_b64_tr_b16 v[84:85], v36 offset:128
ds_read_b64_tr_b16 v[86:87], v37 offset:128
s_waitcnt lgkmcnt(0)
v_mfma_f32_32x32x16_bf16 a[0:15], v[44:47], v[76:79], 0
ds_read_b128 v[60:63], v35 offset:0
v_mfma_f32_32x32x16_bf16 a[16:31], v[44:47], v[80:83], 0
ds_read_b128 v[64:67], v35 offset:2048
v_mfma_f32_32x32x16_bf16 a[32:47], v[44:47], v[84:87], 0
ds_read_b128 v[68:71], v35 offset:4096
v_mfma_f32_32x32x16_bf16 a[48:63], v[48:51], v[76:79], 0
ds_read_b128 v[72:75], v35 offset:6144
v_mfma_f32_32x32x16_bf16 a[64:79], v[48:51], v[80:83], 0
ds_read_b64_tr_b16 v[88:89], v38 offset:0
ds_read_b64_tr_b16 v[90:91], v39 offset:0
v_mfma_f32_32x32x16_bf16 a[80:95], v[48:51], v[84:87], 0
ds_read_b64_tr_b16 v[92:93], v42 offset:0
ds_read_b64_tr_b16 v[94:95], v43 offset:0
v_mfma_f32_32x32x16_bf16 a[96:111], v[52:55], v[76:79], 0
ds_read_b64_tr_b16 v[96:97], v38 offset:128
ds_read_b64_tr_b16 v[98:99], v39 offset:128
v_mfma_f32_32x32x16_bf16 a[112:127], v[52:55], v[80:83], 0
v_mfma_f32_32x32x16_bf16 a[128:143], v[52:55], v[84:87], 0
v_mfma_f32_32x32x16_bf16 a[144:159], v[56:59], v[76:79], 0
v_mfma_f32_32x32x16_bf16 a[160:175], v[56:59], v[80:83], 0
v_mfma_f32_32x32x16_bf16 a[176:191], v[56:59], v[84:87], 0
s_waitcnt lgkmcnt(0)
s_waitcnt vmcnt(14)
s_barrier
v_mfma_f32_32x32x16_bf16 a[0:15], v[60:63], v[88:91], a[0:15]
ds_read_b128 v[44:47], v34 offset:28672
ds_read_b128 v[48:51], v34 offset:30720
v_mfma_f32_32x32x16_bf16 a[16:31], v[60:63], v[92:95], a[16:31]
ds_read_b128 v[52:55], v34 offset:32768
ds_read_b128 v[56:59], v34 offset:34816
v_mfma_f32_32x32x16_bf16 a[32:47], v[60:63], v[96:99], a[32:47]
ds_read_b64_tr_b16 v[76:77], v36 offset:28672
ds_read_b64_tr_b16 v[78:79], v37 offset:28672
ds_read_b64_tr_b16 v[80:81], v40 offset:28672
ds_read_b64_tr_b16 v[82:83], v41 offset:28672
v_mfma_f32_32x32x16_bf16 a[48:63], v[64:67], v[88:91], a[48:63]
ds_read_b64_tr_b16 v[84:85], v36 offset:28800
ds_read_b64_tr_b16 v[86:87], v37 offset:28800
s_add_u32 m0, s45, 0
s_nop 0
buffer_load_dwordx4 v21, s[20:23], s53 offen lds
v_mfma_f32_32x32x16_bf16 a[64:79], v[64:67], v[92:95], a[64:79]
s_add_u32 m0, s45, 1024
s_nop 0
buffer_load_dwordx4 v22, s[20:23], s53 offen lds
s_add_u32 m0, s45, 2048
s_nop 0
buffer_load_dwordx4 v23, s[20:23], s53 offen lds
v_mfma_f32_32x32x16_bf16 a[80:95], v[64:67], v[96:99], a[80:95]
s_add_u32 m0, s45, 3072
s_nop 0
buffer_load_dwordx4 v24, s[20:23], s53 offen lds
s_add_u32 m0, s46, 0
s_nop 0
buffer_load_dwordx4 v31, s[32:35], s54 offen lds
v_mfma_f32_32x32x16_bf16 a[96:111], v[68:71], v[88:91], a[96:111]
s_add_u32 m0, s46, 1024
s_nop 0
buffer_load_dwordx4 v32, s[32:35], s54 offen lds
s_add_u32 m0, s46, 2048
s_nop 0
buffer_load_dwordx4 v33, s[32:35], s54 offen lds
s_add_u32 s53, s53, 16384
s_add_u32 s54, s54, s57
v_mfma_f32_32x32x16_bf16 a[112:127], v[68:71], v[92:95], a[112:127]
v_mfma_f32_32x32x16_bf16 a[128:143], v[68:71], v[96:99], a[128:143]
v_mfma_f32_32x32x16_bf16 a[144:159], v[72:75], v[88:91], a[144:159]
v_mfma_f32_32x32x16_bf16 a[160:175], v[72:75], v[92:95], a[160:175]
v_mfma_f32_32x32x16_bf16 a[176:191], v[72:75], v[96:99], a[176:191]
s_waitcnt lgkmcnt(0)
v_mfma_f32_32x32x16_bf16 a[0:15], v[44:47], v[76:79], a[0:15]
ds_read_b128 v[60:63], v35 offset:28672
v_mfma_f32_32x32x16_bf16 a[16:31], v[44:47], v[80:83], a[16:31]
ds_read_b128 v[64:67], v35 offset:30720
v_mfma_f32_32x32x16_bf16 a[32:47], v[44:47], v[84:87], a[32:47]
ds_read_b128 v[68:71], v35 offset:32768
v_mfma_f32_32x32x16_bf16 a[48:63], v[48:51], v[76:79], a[48:63]
ds_read_b128 v[72:75], v35 offset:34816
v_mfma_f32_32x32x16_bf16 a[64:79], v[48:51], v[80:83], a[64:79]
ds_read_b64_tr_b16 v[88:89], v38 offset:28672
ds_read_b64_tr_b16 v[90:91], v39 offset:28672
v_mfma_f32_32x32x16_bf16 a[80:95], v[48:51], v[84:87], a[80:95]
ds_read_b64_tr_b16 v[92:93], v42 offset:28672
ds_read_b64_tr_b16 v[94:95], v43 offset:28672
v_mfma_f32_32x32x16_bf16 a[96:111], v[52:55], v[76:79], a[96:111]
ds_read_b64_tr_b16 v[96:97], v38 offset:28800
ds_read_b64_tr_b16 v[98:99], v39 offset:28800
v_mfma_f32_32x32x16_bf16 a[112:127], v[52:55], v[80:83], a[112:127]
v_mfma_f32_32x32x16_bf16 a[128:143], v[52:55], v[84:87], a[128:143]
v_mfma_f32_32x32x16_bf16 a[144:159], v[56:59], v[76:79], a[144:159]
v_mfma_f32_32x32x16_bf16 a[160:175], v[56:59], v[80:83], a[160:175]
v_mfma_f32_32x32x16_bf16 a[176:191], v[56:59], v[84:87], a[176:191]
s_waitcnt lgkmcnt(0)
s_waitcnt vmcnt(14)
s_barrier
v_mfma_f32_32x32x16_bf16 a[0:15], v[60:63], v[88:91], a[0:15]
ds_read_b128 v[44:47], v100 offset:0
ds_read_b128 v[48:51], v100 offset:2048
v_mfma_f32_32x32x16_bf16 a[16:31], v[60:63], v[92:95], a[16:31]
ds_read_b128 v[52:55], v100 offset:4096
ds_read_b128 v[56:59], v100 offset:6144
v_mfma_f32_32x32x16_bf16 a[32:47], v[60:63], v[96:99], a[32:47]
ds_read_b64_tr_b16 v[76:77], v102 offset:0
ds_read_b64_tr_b16 v[78:79], v103 offset:0
ds_read_b64_tr_b16 v[80:81], v106 offset:0
ds_read_b64_tr_b16 v[82:83], v107 offset:0
v_mfma_f32_32x32x16_bf16 a[48:63], v[64:67], v[88:91], a[48:63]
ds_read_b64_tr_b16 v[84:85], v102 offset:128
ds_read_b64_tr_b16 v[86:87], v103 offset:128
s_add_u32 m0, s45, 28672
s_nop 0
buffer_load_dwordx4 v21, s[20:23], s53 offen lds
v_mfma_f32_32x32x16_bf16 a[64:79], v[64:67], v[92:95], a[64:79]
s_add_u32 m0, s45, 29696
s_nop 0
buffer_load_dwordx4 v22, s[20:23], s53 offen lds
s_add_u32 m0, s45, 30720
s_nop 0
buffer_load_dwordx4 v23, s[20:23], s53 offen lds
v_mfma_f32_32x32x16_bf16 a[80:95], v[64:67], v[96:99], a[80:95]
s_add_u32 m0, s45, 31744
s_nop 0
buffer_load_dwordx4 v24, s[20:23], s53 offen lds
s_add_u32 m0, s46, 28672
s_nop 0
buffer_load_dwordx4 v31, s[32:35], s54 offen lds
v_mfma_f32_32x32x16_bf16 a[96:111], v[68:71], v[88:91], a[96:111]
s_add_u32 m0, s46, 29696
s_nop 0
buffer_load_dwordx4 v32, s[32:35], s54 offen lds
s_add_u32 m0, s46, 30720
s_nop 0
buffer_load_dwordx4 v33, s[32:35], s54 offen lds
s_add_u32 s53, s53, 16384
s_add_u32 s54, s54, s57
v_mfma_f32_32x32x16_bf16 a[112:127], v[68:71], v[92:95], a[112:127]
v_mfma_f32_32x32x16_bf16 a[128:143], v[68:71], v[96:99], a[128:143]
v_mfma_f32_32x32x16_bf16 a[144:159], v[72:75], v[88:91], a[144:159]
v_mfma_f32_32x32x16_bf16 a[160:175], v[72:75], v[92:95], a[160:175]
v_mfma_f32_32x32x16_bf16 a[176:191], v[72:75], v[96:99], a[176:191]
s_waitcnt lgkmcnt(0)
v_mfma_f32_32x32x16_bf16 a[0:15], v[44:47], v[76:79], a[0:15]
ds_read_b128 v[60:63], v101 offset:0
v_mfma_f32_32x32x16_bf16 a[16:31], v[44:47], v[80:83], a[16:31]
ds_read_b128 v[64:67], v101 offset:2048
v_mfma_f32_32x32x16_bf16 a[32:47], v[44:47], v[84:87], a[32:47]
ds_read_b128 v[68:71], v101 offset:4096
v_mfma_f32_32x32x16_bf16 a[48:63], v[48:51], v[76:79], a[48:63]
ds_read_b128 v[72:75], v101 offset:6144
v_mfma_f32_32x32x16_bf16 a[64:79], v[48:51], v[80:83], a[64:79]
ds_read_b64_tr_b16 v[88:89], v104 offset:0
ds_read_b64_tr_b16 v[90:91], v105 offset:0
v_mfma_f32_32x32x16_bf16 a[80:95], v[48:51], v[84:87], a[80:95]
ds_read_b64_tr_b16 v[92:93], v108 offset:0
ds_read_b64_tr_b16 v[94:95], v109 offset:0
v_mfma_f32_32x32x16_bf16 a[96:111], v[52:55], v[76:79], a[96:111]
ds_read_b64_tr_b16 v[96:97], v104 offset:128
ds_read_b64_tr_b16 v[98:99], v105 offset:128
v_mfma_f32_32x32x16_bf16 a[112:127], v[52:55], v[80:83], a[112:127]
v_mfma_f32_32x32x16_bf16 a[128:143], v[52:55], v[84:87], a[128:143]
v_mfma_f32_32x32x16_bf16 a[144:159], v[56:59], v[76:79], a[144:159]
v_mfma_f32_32x32x16_bf16 a[160:175], v[56:59], v[80:83], a[160:175]
v_mfma_f32_32x32x16_bf16 a[176:191], v[56:59], v[84:87], a[176:191]
s_waitcnt lgkmcnt(0)
s_waitcnt vmcnt(14)
s_barrier
v_mfma_f32_32x32x16_bf16 a[0:15], v[60:63], v[88:91], a[0:15]
ds_read_b128 v[44:47], v100 offset:28672
ds_read_b128 v[48:51], v100 offset:30720
v_mfma_f32_32x32x16_bf16 a[16:31], v[60:63], v[92:95], a[16:31]
ds_read_b128 v[52:55], v100 offset:32768
ds_read_b128 v[56:59], v100 offset:34816
v_mfma_f32_32x32x16_bf16 a[32:47], v[60:63], v[96:99], a[32:47]
ds_read_b64_tr_b16 v[76:77], v102 offset:28672
ds_read_b64_tr_b16 v[78:79], v103 offset:28672
ds_read_b64_tr_b16 v[80:81], v106 offset:28672
ds_read_b64_tr_b16 v[82:83], v107 offset:28672
v_mfma_f32_32x32x16_bf16 a[48:63], v[64:67], v[88:91], a[48:63]
ds_read_b64_tr_b16 v[84:85], v102 offset:28800
ds_read_b64_tr_b16 v[86:87], v103 offset:28800
s_add_u32 m0, s45, 57344
s_nop 0
buffer_load_dwordx4 v21, s[20:23], s53 offen lds
v_mfma_f32_32x32x16_bf16 a[64:79], v[64:67], v[92:95], a[64:79]
s_add_u32 m0, s45, 58368
s_nop 0
buffer_load_dwordx4 v22, s[20:23], s53 offen lds
s_add_u32 m0, s45, 59392
s_nop 0
buffer_load_dwordx4 v23, s[20:23], s53 offen lds
v_mfma_f32_32x32x16_bf16 a[80:95], v[64:67], v[96:99], a[80:95]
s_add_u32 m0, s45, 60416
s_nop 0
buffer_load_dwordx4 v24, s[20:23], s53 offen lds
s_add_u32 m0, s46, 57344
s_nop 0
buffer_load_dwordx4 v31, s[32:35], s54 offen lds
v_mfma_f32_32x32x16_bf16 a[96:111], v[68:71], v[88:91], a[96:111]
s_add_u32 m0, s46, 58368
s_nop 0
buffer_load_dwordx4 v32, s[32:35], s54 offen lds
s_add_u32 m0, s46, 59392
s_nop 0
buffer_load_dwordx4 v33, s[32:35], s54 offen lds
s_add_u32 s53, s53, 16384
s_add_u32 s54, s54, s57
v_mfma_f32_32x32x16_bf16 a[112:127], v[68:71], v[92:95], a[112:127]
v_mfma_f32_32x32x16_bf16 a[128:143], v[68:71], v[96:99], a[128:143]
v_mfma_f32_32x32x16_bf16 a[144:159], v[72:75], v[88:91], a[144:159]
v_mfma_f32_32x32x16_bf16 a[160:175], v[72:75], v[92:95], a[160:175]
v_mfma_f32_32x32x16_bf16 a[176:191], v[72:75], v[96:99], a[176:191]
s_waitcnt lgkmcnt(0)
v_mfma_f32_32x32x16_bf16 a[0:15], v[44:47], v[76:79], a[0:15]
ds_read_b128 v[60:63], v101 offset:28672
v_mfma_f32_32x32x16_bf16 a[16:31], v[44:47], v[80:83], a[16:31]
ds_read_b128 v[64:67], v101 offset:30720
v_mfma_f32_32x32x16_bf16 a[32:47], v[44:47], v[84:87], a[32:47]
ds_read_b128 v[68:71], v101 offset:32768
v_mfma_f32_32x32x16_bf16 a[48:63], v[48:51], v[76:79], a[48:63]
ds_read_b128 v[72:75], v101 offset:34816
v_mfma_f32_32x32x16_bf16 a[64:79], v[48:51], v[80:83], a[64:79]
ds_read_b64_tr_b16 v[88:89], v104 offset:28672
ds_read_b64_tr_b16 v[90:91], v105 offset:28672
v_mfma_f32_32x32x16_bf16 a[80:95], v[48:51], v[84:87], a[80:95]
ds_read_b64_tr_b16 v[92:93], v108 offset:28672
ds_read_b64_tr_b16 v[94:95], v109 offset:28672
v_mfma_f32_32x32x16_bf16 a[96:111], v[52:55], v[76:79], a[96:111]
ds_read_b64_tr_b16 v[96:97], v104 offset:28800
ds_read_b64_tr_b16 v[98:99], v105 offset:28800
v_mfma_f32_32x32x16_bf16 a[112:127], v[52:55], v[80:83], a[112:127]
v_mfma_f32_32x32x16_bf16 a[128:143], v[52:55], v[84:87], a[128:143]
v_mfma_f32_32x32x16_bf16 a[144:159], v[56:59], v[76:79], a[144:159]
v_mfma_f32_32x32x16_bf16 a[160:175], v[56:59], v[80:83], a[160:175]
v_mfma_f32_32x32x16_bf16 a[176:191], v[56:59], v[84:87], a[176:191]
s_waitcnt lgkmcnt(0)
s_waitcnt vmcnt(14)
s_barrier
v_mfma_f32_32x32x16_bf16 a[0:15], v[60:63], v[88:91], a[0:15]
ds_read_b128 v[44:47], v34 offset:0
ds_read_b128 v[48:51], v34 offset:2048
v_mfma_f32_32x32x16_bf16 a[16:31], v[60:63], v[92:95], a[16:31]
ds_read_b128 v[52:55], v34 offset:4096
ds_read_b128 v[56:59], v34 offset:6144
v_mfma_f32_32x32x16_bf16 a[32:47], v[60:63], v[96:99], a[32:47]
ds_read_b64_tr_b16 v[76:77], v36 offset:0
ds_read_b64_tr_b16 v[78:79], v37 offset:0
ds_read_b64_tr_b16 v[80:81], v40 offset:0
ds_read_b64_tr_b16 v[82:83], v41 offset:0
v_mfma_f32_32x32x16_bf16 a[48:63], v[64:67], v[88:91], a[48:63]
ds_read_b64_tr_b16 v[84:85], v36 offset:128
ds_read_b64_tr_b16 v[86:87], v37 offset:128
s_add_u32 m0, s45, 86016
s_nop 0
buffer_load_dwordx4 v21, s[20:23], s53 offen lds
v_mfma_f32_32x32x16_bf16 a[64:79], v[64:67], v[92:95], a[64:79]
s_add_u32 m0, s45, 87040
s_nop 0
buffer_load_dwordx4 v22, s[20:23], s53 offen lds
s_add_u32 m0, s45, 88064
s_nop 0
buffer_load_dwordx4 v23, s[20:23], s53 offen lds
v_mfma_f32_32x32x16_bf16 a[80:95], v[64:67], v[96:99], a[80:95]
s_add_u32 m0, s45, 89088
s_nop 0
buffer_load_dwordx4 v24, s[20:23], s53 offen lds
s_add_u32 m0, s46, 86016
s_nop 0
buffer_load_dwordx4 v31, s[32:35], s54 offen lds
v_mfma_f32_32x32x16_bf16 a[96:111], v[68:71], v[88:91], a[96:111]
s_add_u32 m0, s46, 87040
s_nop 0
buffer_load_dwordx4 v32, s[32:35], s54 offen lds
s_add_u32 m0, s46, 88064
s_nop 0
buffer_load_dwordx4 v33, s[32:35], s54 offen lds
s_add_u32 s53, s53, 16384
s_add_u32 s54, s54, s57
v_mfma_f32_32x32x16_bf16 a[112:127], v[68:71], v[92:95], a[112:127]
v_mfma_f32_32x32x16_bf16 a[128:143], v[68:71], v[96:99], a[128:143]
v_mfma_f32_32x32x16_bf16 a[144:159], v[72:75], v[88:91], a[144:159]
v_mfma_f32_32x32x16_bf16 a[160:175], v[72:75], v[92:95], a[160:175]
v_mfma_f32_32x32x16_bf16 a[176:191], v[72:75], v[96:99], a[176:191]
s_mov_b32 s42, 3
s_cmp_eq_u32 s42, 0
s_cbranch_scc1 L_g1_xw_last_A
s_nop 8
L_g1_xw_A:
s_waitcnt lgkmcnt(0)
v_mfma_f32_32x32x16_bf16 a[0:15], v[44:47], v[76:79], a[0:15]
ds_read_b128 v[60:63], v35 offset:0
v_mfma_f32_32x32x16_bf16 a[16:31], v[44:47], v[80:83], a[16:31]
ds_read_b128 v[64:67], v35 offset:2048
v_mfma_f32_32x32x16_bf16 a[32:47], v[44:47], v[84:87], a[32:47]
ds_read_b128 v[68:71], v35 offset:4096
v_mfma_f32_32x32x16_bf16 a[48:63], v[48:51], v[76:79], a[48:63]
ds_read_b128 v[72:75], v35 offset:6144
v_mfma_f32_32x32x16_bf16 a[64:79], v[48:51], v[80:83], a[64:79]
ds_read_b64_tr_b16 v[88:89], v38 offset:0
ds_read_b64_tr_b16 v[90:91], v39 offset:0
v_mfma_f32_32x32x16_bf16 a[80:95], v[48:51], v[84:87], a[80:95]
ds_read_b64_tr_b16 v[92:93], v42 offset:0
ds_read_b64_tr_b16 v[94:95], v43 offset:0
v_mfma_f32_32x32x16_bf16 a[96:111], v[52:55], v[76:79], a[96:111]
ds_read_b64_tr_b16 v[96:97], v38 offset:128
ds_read_b64_tr_b16 v[98:99], v39 offset:128
v_mfma_f32_32x32x16_bf16 a[112:127], v[52:55], v[80:83], a[112:127]
v_mfma_f32_32x32x16_bf16 a[128:143], v[52:55], v[84:87], a[128:143]
v_mfma_f32_32x32x16_bf16 a[144:159], v[56:59], v[76:79], a[144:159]
v_mfma_f32_32x32x16_bf16 a[160:175], v[56:59], v[80:83], a[160:175]
v_mfma_f32_32x32x16_bf16 a[176:191], v[56:59], v[84:87], a[176:191]
s_waitcnt lgkmcnt(0)
s_waitcnt vmcnt(14)
s_barrier
v_mfma_f32_32x32x16_bf16 a[0:15], v[60:63], v[88:91], a[0:15]
ds_read_b128 v[44:47], v34 offset:28672
ds_read_b128 v[48:51], v34 offset:30720
v_mfma_f32_32x32x16_bf16 a[16:31], v[60:63], v[92:95], a[16:31]
ds_read_b128 v[52:55], v34 offset:32768
ds_read_b128 v[56:59], v34 offset:34816
v_mfma_f32_32x32x16_bf16 a[32:47], v[60:63], v[96:99], a[32:47]
ds_read_b64_tr_b16 v[76:77], v36 offset:28672
ds_read_b64_tr_b16 v[78:79], v37 offset:28672
ds_read_b64_tr_b16 v[80:81], v40 offset:28672
ds_read_b64_tr_b16 v[82:83], v41 offset:28672
v_mfma_f32_32x32x16_bf16 a[48:63], v[64:67], v[88:91], a[48:63]
ds_read_b64_tr_b16 v[84:85], v36 offset:28800
ds_read_b64_tr_b16 v[86:87], v37 offset:28800
s_add_u32 m0, s45, 0
s_nop 0
buffer_load_dwordx4 v21, s[20:23], s53 offen lds
v_mfma_f32_32x32x16_bf16 a[64:79], v[64:67], v[92:95], a[64:79]
s_add_u32 m0, s45, 1024
s_nop 0
buffer_load_dwordx4 v22, s[20:23], s53 offen lds
s_add_u32 m0, s45, 2048
s_nop 0
buffer_load_dwordx4 v23, s[20:23], s53 offen lds
v_mfma_f32_32x32x16_bf16 a[80:95], v[64:67], v[96:99], a[80:95]
s_add_u32 m0, s45, 3072
s_nop 0
buffer_load_dwordx4 v24, s[20:23], s53 offen lds
s_add_u32 m0, s46, 0
s_nop 0
buffer_load_dwordx4 v31, s[32:35], s54 offen lds
v_mfma_f32_32x32x16_bf16 a[96:111], v[68:71], v[88:91], a[96:111]
s_add_u32 m0, s46, 1024
s_nop 0
buffer_load_dwordx4 v32, s[32:35], s54 offen lds
s_add_u32 m0, s46, 2048
s_nop 0
buffer_load_dwordx4 v33, s[32:35], s54 offen lds
s_add_u32 s53, s53, 16384
s_add_u32 s54, s54, s57
v_mfma_f32_32x32x16_bf16 a[112:127], v[68:71], v[92:95], a[112:127]
v_mfma_f32_32x32x16_bf16 a[128:143], v[68:71], v[96:99], a[128:143]
v_mfma_f32_32x32x16_bf16 a[144:159], v[72:75], v[88:91], a[144:159]
v_mfma_f32_32x32x16_bf16 a[160:175], v[72:75], v[92:95], a[160:175]
v_mfma_f32_32x32x16_bf16 a[176:191], v[72:75], v[96:99], a[176:191]
s_waitcnt lgkmcnt(0)
v_mfma_f32_32x32x16_bf16 a[0:15], v[44:47], v[76:79], a[0:15]
ds_read_b128 v[60:63], v35 offset:28672
v_mfma_f32_32x32x16_bf16 a[16:31], v[44:47], v[80:83], a[16:31]
ds_read_b128 v[64:67], v35 offset:30720
v_mfma_f32_32x32x16_bf16 a[32:47], v[44:47], v[84:87], a[32:47]
ds_read_b128 v[68:71], v35 offset:32768
v_mfma_f32_32x32x16_bf16 a[48:63], v[48:51], v[76:79], a[48:63]
ds_read_b128 v[72:75], v35 offset:34816
v_mfma_f32_32x32x16_bf16 a[64:79], v[48:51], v[80:83], a[64:79]
ds_read_b64_tr_b16 v[88:89], v38 offset:28672
ds_read_b64_tr_b16 v[90:91], v39 offset:28672
v_mfma_f32_32x32x16_bf16 a[80:95], v[48:51], v[84:87], a[80:95]
ds_read_b64_tr_b16 v[92:93], v42 offset:28672
ds_read_b64_tr_b16 v[94:95], v43 offset:28672
v_mfma_f32_32x32x16_bf16 a[96:111], v[52:55], v[76:79], a[96:111]
ds_read_b64_tr_b16 v[96:97], v38 offset:28800
ds_read_b64_tr_b16 v[98:99], v39 offset:28800
v_mfma_f32_32x32x16_bf16 a[112:127], v[52:55], v[80:83], a[112:127]
v_mfma_f32_32x32x16_bf16 a[128:143], v[52:55], v[84:87], a[128:143]
v_mfma_f32_32x32x16_bf16 a[144:159], v[56:59], v[76:79], a[144:159]
v_mfma_f32_32x32x16_bf16 a[160:175], v[56:59], v[80:83], a[160:175]
v_mfma_f32_32x32x16_bf16 a[176:191], v[56:59], v[84:87], a[176:191]
s_waitcnt lgkmcnt(0)
s_waitcnt vmcnt(14)
s_barrier
v_mfma_f32_32x32x16_bf16 a[0:15], v[60:63], v[88:91], a[0:15]
ds_read_b128 v[44:47], v100 offset:0
ds_read_b128 v[48:51], v100 offset:2048
v_mfma_f32_32x32x16_bf16 a[16:31], v[60:63], v[92:95], a[16:31]
ds_read_b128 v[52:55], v100 offset:4096
ds_read_b128 v[56:59], v100 offset:6144
v_mfma_f32_32x32x16_bf16 a[32:47], v[60:63], v[96:99], a[32:47]
ds_read_b64_tr_b16 v[76:77], v102 offset:0
ds_read_b64_tr_b16 v[78:79], v103 offset:0
ds_read_b64_tr_b16 v[80:81], v106 offset:0
ds_read_b64_tr_b16 v[82:83], v107 offset:0
v_mfma_f32_32x32x16_bf16 a[48:63], v[64:67], v[88:91], a[48:63]
ds_read_b64_tr_b16 v[84:85], v102 offset:128
ds_read_b64_tr_b16 v[86:87], v103 offset:128
s_add_u32 m0, s45, 28672
s_nop 0
buffer_load_dwordx4 v21, s[20:23], s53 offen lds
v_mfma_f32_32x32x16_bf16 a[64:79], v[64:67], v[92:95], a[64:79]
s_add_u32 m0, s45, 29696
s_nop 0
buffer_load_dwordx4 v22, s[20:23], s53 offen lds
s_add_u32 m0, s45, 30720
s_nop 0
buffer_load_dwordx4 v23, s[20:23], s53 offen lds
v_mfma_f32_32x32x16_bf16 a[80:95], v[64:67], v[96:99], a[80:95]
s_add_u32 m0, s45, 31744
s_nop 0
buffer_load_dwordx4 v24, s[20:23], s53 offen lds
s_add_u32 m0, s46, 28672
s_nop 0
buffer_load_dwordx4 v31, s[32:35], s54 offen lds
v_mfma_f32_32x32x16_bf16 a[96:111], v[68:71], v[88:91], a[96:111]
s_add_u32 m0, s46, 29696
s_nop 0
buffer_load_dwordx4 v32, s[32:35], s54 offen lds
s_add_u32 m0, s46, 30720
s_nop 0
buffer_load_dwordx4 v33, s[32:35], s54 offen lds
s_add_u32 s53, s53, 16384
s_add_u32 s54, s54, s57
v_mfma_f32_32x32x16_bf16 a[112:127], v[68:71], v[92:95], a[112:127]
v_mfma_f32_32x32x16_bf16 a[128:143], v[68:71], v[96:99], a[128:143]
v_mfma_f32_32x32x16_bf16 a[144:159], v[72:75], v[88:91], a[144:159]
v_mfma_f32_32x32x16_bf16 a[160:175], v[72:75], v[92:95], a[160:175]
v_mfma_f32_32x32x16_bf16 a[176:191], v[72:75], v[96:99], a[176:191]
s_waitcnt lgkmcnt(0)
v_mfma_f32_32x32x16_bf16 a[0:15], v[44:47], v[76:79], a[0:15]
ds_read_b128 v[60:63], v101 offset:0
v_mfma_f32_32x32x16_bf16 a[16:31], v[44:47], v[80:83], a[16:31]
ds_read_b128 v[64:67], v101 offset:2048
v_mfma_f32_32x32x16_bf16 a[32:47], v[44:47], v[84:87], a[32:47]
ds_read_b128 v[68:71], v101 offset:4096
v_mfma_f32_32x32x16_bf16 a[48:63], v[48:51], v[76:79], a[48:63]
ds_read_b128 v[72:75], v101 offset:6144
v_mfma_f32_32x32x16_bf16 a[64:79], v[48:51], v[80:83], a[64:79]
ds_read_b64_tr_b16 v[88:89], v104 offset:0
ds_read_b64_tr_b16 v[90:91], v105 offset:0
v_mfma_f32_32x32x16_bf16 a[80:95], v[48:51], v[84:87], a[80:95]
ds_read_b64_tr_b16 v[92:93], v108 offset:0
ds_read_b64_tr_b16 v[94:95], v109 offset:0
v_mfma_f32_32x32x16_bf16 a[96:111], v[52:55], v[76:79], a[96:111]
ds_read_b64_tr_b16 v[96:97], v104 offset:128
ds_read_b64_tr_b16 v[98:99], v105 offset:128
v_mfma_f32_32x32x16_bf16 a[112:127], v[52:55], v[80:83], a[112:127]
v_mfma_f32_32x32x16_bf16 a[128:143], v[52:55], v[84:87], a[128:143]
v_mfma_f32_32x32x16_bf16 a[144:159], v[56:59], v[76:79], a[144:159]
v_mfma_f32_32x32x16_bf16 a[160:175], v[56:59], v[80:83], a[160:175]
v_mfma_f32_32x32x16_bf16 a[176:191], v[56:59], v[84:87], a[176:191]
s_waitcnt lgkmcnt(0)
s_waitcnt vmcnt(14)
s_barrier
v_mfma_f32_32x32x16_bf16 a[0:15], v[60:63], v[88:91], a[0:15]
ds_read_b128 v[44:47], v100 offset:28672
ds_read_b128 v[48:51], v100 offset:30720
v_mfma_f32_32x32x16_bf16 a[16:31], v[60:63], v[92:95], a[16:31]
ds_read_b128 v[52:55], v100 offset:32768
ds_read_b128 v[56:59], v100 offset:34816
v_mfma_f32_32x32x16_bf16 a[32:47], v[60:63], v[96:99], a[32:47]
ds_read_b64_tr_b16 v[76:77], v102 offset:28672
ds_read_b64_tr_b16 v[78:79], v103 offset:28672
ds_read_b64_tr_b16 v[80:81], v106 offset:28672
ds_read_b64_tr_b16 v[82:83], v107 offset:28672
v_mfma_f32_32x32x16_bf16 a[48:63], v[64:67], v[88:91], a[48:63]
ds_read_b64_tr_b16 v[84:85], v102 offset:28800
ds_read_b64_tr_b16 v[86:87], v103 offset:28800
s_add_u32 m0, s45, 57344
s_nop 0
buffer_load_dwordx4 v21, s[20:23], s53 offen lds
v_mfma_f32_32x32x16_bf16 a[64:79], v[64:67], v[92:95], a[64:79]
s_add_u32 m0, s45, 58368
s_nop 0
buffer_load_dwordx4 v22, s[20:23], s53 offen lds
s_add_u32 m0, s45, 59392
s_nop 0
buffer_load_dwordx4 v23, s[20:23], s53 offen lds
v_mfma_f32_32x32x16_bf16 a[80:95], v[64:67], v[96:99], a[80:95]
s_add_u32 m0, s45, 60416
s_nop 0
buffer_load_dwordx4 v24, s[20:23], s53 offen lds
s_add_u32 m0, s46, 57344
s_nop 0
buffer_load_dwordx4 v31, s[32:35], s54 offen lds
v_mfma_f32_32x32x16_bf16 a[96:111], v[68:71], v[88:91], a[96:111]
s_add_u32 m0, s46, 58368
s_nop 0
buffer_load_dwordx4 v32, s[32:35], s54 offen lds
s_add_u32 m0, s46, 59392
s_nop 0
buffer_load_dwordx4 v33, s[32:35], s54 offen lds
s_add_u32 s53, s53, 16384
s_add_u32 s54, s54, s57
v_mfma_f32_32x32x16_bf16 a[112:127], v[68:71], v[92:95], a[112:127]
v_mfma_f32_32x32x16_bf16 a[128:143], v[68:71], v[96:99], a[128:143]
v_mfma_f32_32x32x16_bf16 a[144:159], v[72:75], v[88:91], a[144:159]
v_mfma_f32_32x32x16_bf16 a[160:175], v[72:75], v[92:95], a[160:175]
v_mfma_f32_32x32x16_bf16 a[176:191], v[72:75], v[96:99], a[176:191]
s_waitcnt lgkmcnt(0)
v_mfma_f32_32x32x16_bf16 a[0:15], v[44:47], v[76:79], a[0:15]
ds_read_b128 v[60:63], v101 offset:28672
v_mfma_f32_32x32x16_bf16 a[16:31], v[44:47], v[80:83], a[16:31]
ds_read_b128 v[64:67], v101 offset:30720
v_mfma_f32_32x32x16_bf16 a[32:47], v[44:47], v[84:87], a[32:47]
ds_read_b128 v[68:71], v101 offset:32768
v_mfma_f32_32x32x16_bf16 a[48:63], v[48:51], v[76:79], a[48:63]
ds_read_b128 v[72:75], v101 offset:34816
v_mfma_f32_32x32x16_bf16 a[64:79], v[48:51], v[80:83], a[64:79]
ds_read_b64_tr_b16 v[88:89], v104 offset:28672
ds_read_b64_tr_b16 v[90:91], v105 offset:28672
v_mfma_f32_32x32x16_bf16 a[80:95], v[48:51], v[84:87], a[80:95]
ds_read_b64_tr_b16 v[92:93], v108 offset:28672
ds_read_b64_tr_b16 v[94:95], v109 offset:28672
v_mfma_f32_32x32x16_bf16 a[96:111], v[52:55], v[76:79], a[96:111]
ds_read_b64_tr_b16 v[96:97], v104 offset:28800
ds_read_b64_tr_b16 v[98:99], v105 offset:28800
v_mfma_f32_32x32x16_bf16 a[112:127], v[52:55], v[80:83], a[112:127]
v_mfma_f32_32x32x16_bf16 a[128:143], v[52:55], v[84:87], a[128:143]
v_mfma_f32_32x32x16_bf16 a[144:159], v[56:59], v[76:79], a[144:159]
v_mfma_f32_32x32x16_bf16 a[160:175], v[56:59], v[80:83], a[160:175]
v_mfma_f32_32x32x16_bf16 a[176:191], v[56:59], v[84:87], a[176:191]
s_waitcnt lgkmcnt(0)
s_waitcnt vmcnt(14)
s_barrier
v_mfma_f32_32x32x16_bf16 a[0:15], v[60:63], v[88:91], a[0:15]
ds_read_b128 v[44:47], v34 offset:0
ds_read_b128 v[48:51], v34 offset:2048
v_mfma_f32_32x32x16_bf16 a[16:31], v[60:63], v[92:95], a[16:31]
ds_read_b128 v[52:55], v34 offset:4096
ds_read_b128 v[56:59], v34 offset:6144
v_mfma_f32_32x32x16_bf16 a[32:47], v[60:63], v[96:99], a[32:47]
ds_read_b64_tr_b16 v[76:77], v36 offset:0
ds_read_b64_tr_b16 v[78:79], v37 offset:0
ds_read_b64_tr_b16 v[80:81], v40 offset:0
ds_read_b64_tr_b16 v[82:83], v41 offset:0
v_mfma_f32_32x32x16_bf16 a[48:63], v[64:67], v[88:91], a[48:63]
ds_read_b64_tr_b16 v[84:85], v36 offset:128
ds_read_b64_tr_b16 v[86:87], v37 offset:128
s_add_u32 m0, s45, 86016
s_nop 0
buffer_load_dwordx4 v21, s[20:23], s53 offen lds
v_mfma_f32_32x32x16_bf16 a[64:79], v[64:67], v[92:95], a[64:79]
s_add_u32 m0, s45, 87040
s_nop 0
buffer_load_dwordx4 v22, s[20:23], s53 offen lds
s_add_u32 m0, s45, 88064
s_nop 0
buffer_load_dwordx4 v23, s[20:23], s53 offen lds
v_mfma_f32_32x32x16_bf16 a[80:95], v[64:67], v[96:99], a[80:95]
s_add_u32 m0, s45, 89088
s_nop 0
buffer_load_dwordx4 v24, s[20:23], s53 offen lds
s_add_u32 m0, s46, 86016
s_nop 0
buffer_load_dwordx4 v31, s[32:35], s54 offen lds
v_mfma_f32_32x32x16_bf16 a[96:111], v[68:71], v[88:91], a[96:111]
s_add_u32 m0, s46, 87040
s_nop 0
buffer_load_dwordx4 v32, s[32:35], s54 offen lds
s_add_u32 m0, s46, 88064
s_nop 0
buffer_load_dwordx4 v33, s[32:35], s54 offen lds
s_add_u32 s53, s53, 16384
s_add_u32 s54, s54, s57
v_mfma_f32_32x32x16_bf16 a[112:127], v[68:71], v[92:95], a[112:127]
v_mfma_f32_32x32x16_bf16 a[128:143], v[68:71], v[96:99], a[128:143]
v_mfma_f32_32x32x16_bf16 a[144:159], v[72:75], v[88:91], a[144:159]
v_mfma_f32_32x32x16_bf16 a[160:175], v[72:75], v[92:95], a[160:175]
v_mfma_f32_32x32x16_bf16 a[176:191], v[72:75], v[96:99], a[176:191]
s_sub_u32 s42, s42, 1
s_cmp_lg_u32 s42, 0
s_nop 9
s_cbranch_scc1 L_g1_xw_A
L_g1_xw_last_A:
s_waitcnt lgkmcnt(0)
v_mfma_f32_32x32x16_bf16 a[0:15], v[44:47], v[76:79], a[0:15]
ds_read_b128 v[60:63], v35 offset:0
v_mfma_f32_32x32x16_bf16 a[16:31], v[44:47], v[80:83], a[16:31]
ds_read_b128 v[64:67], v35 offset:2048
v_mfma_f32_32x32x16_bf16 a[32:47], v[44:47], v[84:87], a[32:47]
ds_read_b128 v[68:71], v35 offset:4096
v_mfma_f32_32x32x16_bf16 a[48:63], v[48:51], v[76:79], a[48:63]
ds_read_b128 v[72:75], v35 offset:6144
v_mfma_f32_32x32x16_bf16 a[64:79], v[48:51], v[80:83], a[64:79]
ds_read_b64_tr_b16 v[88:89], v38 offset:0
ds_read_b64_tr_b16 v[90:91], v39 offset:0
v_mfma_f32_32x32x16_bf16 a[80:95], v[48:51], v[84:87], a[80:95]
ds_read_b64_tr_b16 v[92:93], v42 offset:0
ds_read_b64_tr_b16 v[94:95], v43 offset:0
v_mfma_f32_32x32x16_bf16 a[96:111], v[52:55], v[76:79], a[96:111]
ds_read_b64_tr_b16 v[96:97], v38 offset:128
ds_read_b64_tr_b16 v[98:99], v39 offset:128
v_mfma_f32_32x32x16_bf16 a[112:127], v[52:55], v[80:83], a[112:127]
v_mfma_f32_32x32x16_bf16 a[128:143], v[52:55], v[84:87], a[128:143]
v_mfma_f32_32x32x16_bf16 a[144:159], v[56:59], v[76:79], a[144:159]
v_mfma_f32_32x32x16_bf16 a[160:175], v[56:59], v[80:83], a[160:175]
v_mfma_f32_32x32x16_bf16 a[176:191], v[56:59], v[84:87], a[176:191]
s_waitcnt lgkmcnt(0)
s_waitcnt vmcnt(14)
s_barrier
v_mfma_f32_32x32x16_bf16 a[0:15], v[60:63], v[88:91], a[0:15]
ds_read_b128 v[44:47], v34 offset:28672
v_mfma_f32_32x32x16_bf16 a[16:31], v[60:63], v[92:95], a[16:31]
ds_read_b128 v[48:51], v34 offset:30720
v_mfma_f32_32x32x16_bf16 a[32:47], v[60:63], v[96:99], a[32:47]
ds_read_b128 v[52:55], v34 offset:32768
v_mfma_f32_32x32x16_bf16 a[48:63], v[64:67], v[88:91], a[48:63]
ds_read_b128 v[56:59], v34 offset:34816
v_mfma_f32_32x32x16_bf16 a[64:79], v[64:67], v[92:95], a[64:79]
ds_read_b64_tr_b16 v[76:77], v36 offset:28672
ds_read_b64_tr_b16 v[78:79], v37 offset:28672
v_mfma_f32_32x32x16_bf16 a[80:95], v[64:67], v[96:99], a[80:95]
ds_read_b64_tr_b16 v[80:81], v40 offset:28672
ds_read_b64_tr_b16 v[82:83], v41 offset:28672
v_mfma_f32_32x32x16_bf16 a[96:111], v[68:71], v[88:91], a[96:111]
ds_read_b64_tr_b16 v[84:85], v36 offset:28800
ds_read_b64_tr_b16 v[86:87], v37 offset:28800
v_mfma_f32_32x32x16_bf16 a[112:127], v[68:71], v[92:95], a[112:127]
v_mfma_f32_32x32x16_bf16 a[128:143], v[68:71], v[96:99], a[128:143]
v_mfma_f32_32x32x16_bf16 a[144:159], v[72:75], v[88:91], a[144:159]
v_mfma_f32_32x32x16_bf16 a[160:175], v[72:75], v[92:95], a[160:175]
v_mfma_f32_32x32x16_bf16 a[176:191], v[72:75], v[96:99], a[176:191]
s_waitcnt lgkmcnt(0)
v_mfma_f32_32x32x16_bf16 a[0:15], v[44:47], v[76:79], a[0:15]
ds_read_b128 v[60:63], v35 offset:28672
v_mfma_f32_32x32x16_bf16 a[16:31], v[44:47], v[80:83], a[16:31]
ds_read_b128 v[64:67], v35 offset:30720
v_mfma_f32_32x32x16_bf16 a[32:47], v[44:47], v[84:87], a[32:47]
ds_read_b128 v[68:71], v35 offset:32768
v_mfma_f32_32x32x16_bf16 a[48:63], v[48:51], v[76:79], a[48:63]
ds_read_b128 v[72:75], v35 offset:34816
v_mfma_f32_32x32x16_bf16 a[64:79], v[48:51], v[80:83], a[64:79]
ds_read_b64_tr_b16 v[88:89], v38 offset:28672
ds_read_b64_tr_b16 v[90:91], v39 offset:28672
v_mfma_f32_32x32x16_bf16 a[80:95], v[48:51], v[84:87], a[80:95]
ds_read_b64_tr_b16 v[92:93], v42 offset:28672
ds_read_b64_tr_b16 v[94:95], v43 offset:28672
v_mfma_f32_32x32x16_bf16 a[96:111], v[52:55], v[76:79], a[96:111]
ds_read_b64_tr_b16 v[96:97], v38 offset:28800
ds_read_b64_tr_b16 v[98:99], v39 offset:28800
v_mfma_f32_32x32x16_bf16 a[112:127], v[52:55], v[80:83], a[112:127]
v_mfma_f32_32x32x16_bf16 a[128:143], v[52:55], v[84:87], a[128:143]
v_mfma_f32_32x32x16_bf16 a[144:159], v[56:59], v[76:79], a[144:159]
v_mfma_f32_32x32x16_bf16 a[160:175], v[56:59], v[80:83], a[160:175]
v_mfma_f32_32x32x16_bf16 a[176:191], v[56:59], v[84:87], a[176:191]
s_waitcnt lgkmcnt(0)
s_waitcnt vmcnt(7)
s_barrier
v_mfma_f32_32x32x16_bf16 a[0:15], v[60:63], v[88:91], a[0:15]
ds_read_b128 v[44:47], v100 offset:0
v_mfma_f32_32x32x16_bf16 a[16:31], v[60:63], v[92:95], a[16:31]
ds_read_b128 v[48:51], v100 offset:2048
v_mfma_f32_32x32x16_bf16 a[32:47], v[60:63], v[96:99], a[32:47]
ds_read_b128 v[52:55], v100 offset:4096
v_mfma_f32_32x32x16_bf16 a[48:63], v[64:67], v[88:91], a[48:63]
ds_read_b128 v[56:59], v100 offset:6144
v_mfma_f32_32x32x16_bf16 a[64:79], v[64:67], v[92:95], a[64:79]
ds_read_b64_tr_b16 v[76:77], v102 offset:0
ds_read_b64_tr_b16 v[78:79], v103 offset:0
v_mfma_f32_32x32x16_bf16 a[80:95], v[64:67], v[96:99], a[80:95]
ds_read_b64_tr_b16 v[80:81], v106 offset:0
ds_read_b64_tr_b16 v[82:83], v107 offset:0
v_mfma_f32_32x32x16_bf16 a[96:111], v[68:71], v[88:91], a[96:111]
ds_read_b64_tr_b16 v[84:85], v102 offset:128
ds_read_b64_tr_b16 v[86:87], v103 offset:128
v_mfma_f32_32x32x16_bf16 a[112:127], v[68:71], v[92:95], a[112:127]
v_mfma_f32_32x32x16_bf16 a[128:143], v[68:71], v[96:99], a[128:143]
v_mfma_f32_32x32x16_bf16 a[144:159], v[72:75], v[88:91], a[144:159]
v_mfma_f32_32x32x16_bf16 a[160:175], v[72:75], v[92:95], a[160:175]
v_mfma_f32_32x32x16_bf16 a[176:191], v[72:75], v[96:99], a[176:191]
s_waitcnt lgkmcnt(0)
v_mfma_f32_32x32x16_bf16 a[0:15], v[44:47], v[76:79], a[0:15]
ds_read_b128 v[60:63], v101 offset:0
v_mfma_f32_32x32x16_bf16 a[16:31], v[44:47], v[80:83], a[16:31]
ds_read_b128 v[64:67], v101 offset:2048
v_mfma_f32_32x32x16_bf16 a[32:47], v[44:47], v[84:87], a[32:47]
ds_read_b128 v[68:71], v101 offset:4096
v_mfma_f32_32x32x16_bf16 a[48:63], v[48:51], v[76:79], a[48:63]
ds_read_b128 v[72:75], v101 offset:6144
v_mfma_f32_32x32x16_bf16 a[64:79], v[48:51], v[80:83], a[64:79]
ds_read_b64_tr_b16 v[88:89], v104 offset:0
ds_read_b64_tr_b16 v[90:91], v105 offset:0
v_mfma_f32_32x32x16_bf16 a[80:95], v[48:51], v[84:87], a[80:95]
ds_read_b64_tr_b16 v[92:93], v108 offset:0
ds_read_b64_tr_b16 v[94:95], v109 offset:0
v_mfma_f32_32x32x16_bf16 a[96:111], v[52:55], v[76:79], a[96:111]
ds_read_b64_tr_b16 v[96:97], v104 offset:128
ds_read_b64_tr_b16 v[98:99], v105 offset:128
v_mfma_f32_32x32x16_bf16 a[112:127], v[52:55], v[80:83], a[112:127]
v_mfma_f32_32x32x16_bf16 a[128:143], v[52:55], v[84:87], a[128:143]
v_mfma_f32_32x32x16_bf16 a[144:159], v[56:59], v[76:79], a[144:159]
v_mfma_f32_32x32x16_bf16 a[160:175], v[56:59], v[80:83], a[160:175]
v_mfma_f32_32x32x16_bf16 a[176:191], v[56:59], v[84:87], a[176:191]
s_waitcnt lgkmcnt(0)
s_waitcnt vmcnt(0)
s_barrier
v_mfma_f32_32x32x16_bf16 a[0:15], v[60:63], v[88:91], a[0:15]
ds_read_b128 v[44:47], v100 offset:28672
v_mfma_f32_32x32x16_bf16 a[16:31], v[60:63], v[92:95], a[16:31]
ds_read_b128 v[48:51], v100 offset:30720
v_mfma_f32_32x32x16_bf16 a[32:47], v[60:63], v[96:99], a[32:47]
ds_read_b128 v[52:55], v100 offset:32768
v_mfma_f32_32x32x16_bf16 a[48:63], v[64:67], v[88:91], a[48:63]
ds_read_b128 v[56:59], v100 offset:34816
v_mfma_f32_32x32x16_bf16 a[64:79], v[64:67], v[92:95], a[64:79]
ds_read_b64_tr_b16 v[76:77], v102 offset:28672
ds_read_b64_tr_b16 v[78:79], v103 offset:28672
v_mfma_f32_32x32x16_bf16 a[80:95], v[64:67], v[96:99], a[80:95]
ds_read_b64_tr_b16 v[80:81], v106 offset:28672
ds_read_b64_tr_b16 v[82:83], v107 offset:28672
v_mfma_f32_32x32x16_bf16 a[96:111], v[68:71], v[88:91], a[96:111]
ds_read_b64_tr_b16 v[84:85], v102 offset:28800
ds_read_b64_tr_b16 v[86:87], v103 offset:28800
v_mfma_f32_32x32x16_bf16 a[112:127], v[68:71], v[92:95], a[112:127]
v_mfma_f32_32x32x16_bf16 a[128:143], v[68:71], v[96:99], a[128:143]
v_mfma_f32_32x32x16_bf16 a[144:159], v[72:75], v[88:91], a[144:159]
v_mfma_f32_32x32x16_bf16 a[160:175], v[72:75], v[92:95], a[160:175]
v_mfma_f32_32x32x16_bf16 a[176:191], v[72:75], v[96:99], a[176:191]
s_waitcnt lgkmcnt(0)
v_mfma_f32_32x32x16_bf16 a[0:15], v[44:47], v[76:79], a[0:15]
ds_read_b128 v[60:63], v101 offset:28672
v_mfma_f32_32x32x16_bf16 a[16:31], v[44:47], v[80:83], a[16:31]
ds_read_b128 v[64:67], v101 offset:30720
v_mfma_f32_32x32x16_bf16 a[32:47], v[44:47], v[84:87], a[32:47]
ds_read_b128 v[68:71], v101 offset:32768
v_mfma_f32_32x32x16_bf16 a[48:63], v[48:51], v[76:79], a[48:63]
ds_read_b128 v[72:75], v101 offset:34816
v_mfma_f32_32x32x16_bf16 a[64:79], v[48:51], v[80:83], a[64:79]
ds_read_b64_tr_b16 v[88:89], v104 offset:28672
ds_read_b64_tr_b16 v[90:91], v105 offset:28672
v_mfma_f32_32x32x16_bf16 a[80:95], v[48:51], v[84:87], a[80:95]
ds_read_b64_tr_b16 v[92:93], v108 offset:28672
ds_read_b64_tr_b16 v[94:95], v109 offset:28672
v_mfma_f32_32x32x16_bf16 a[96:111], v[52:55], v[76:79], a[96:111]
ds_read_b64_tr_b16 v[96:97], v104 offset:28800
ds_read_b64_tr_b16 v[98:99], v105 offset:28800
v_mfma_f32_32x32x16_bf16 a[112:127], v[52:55], v[80:83], a[112:127]
v_mfma_f32_32x32x16_bf16 a[128:143], v[52:55], v[84:87], a[128:143]
v_mfma_f32_32x32x16_bf16 a[144:159], v[56:59], v[76:79], a[144:159]
v_mfma_f32_32x32x16_bf16 a[160:175], v[56:59], v[80:83], a[160:175]
v_mfma_f32_32x32x16_bf16 a[176:191], v[56:59], v[84:87], a[176:191]
s_waitcnt lgkmcnt(0)
s_waitcnt vmcnt(0)
s_barrier
v_mfma_f32_32x32x16_bf16 a[0:15], v[60:63], v[88:91], a[0:15]
v_mfma_f32_32x32x16_bf16 a[16:31], v[60:63], v[92:95], a[16:31]
v_mfma_f32_32x32x16_bf16 a[32:47], v[60:63], v[96:99], a[32:47]
v_mfma_f32_32x32x16_bf16 a[48:63], v[64:67], v[88:91], a[48:63]
v_mfma_f32_32x32x16_bf16 a[64:79], v[64:67], v[92:95], a[64:79]
v_mfma_f32_32x32x16_bf16 a[80:95], v[64:67], v[96:99], a[80:95]
v_mfma_f32_32x32x16_bf16 a[96:111], v[68:71], v[88:91], a[96:111]
v_mfma_f32_32x32x16_bf16 a[112:127], v[68:71], v[92:95], a[112:127]
v_mfma_f32_32x32x16_bf16 a[128:143], v[68:71], v[96:99], a[128:143]
v_mfma_f32_32x32x16_bf16 a[144:159], v[72:75], v[88:91], a[144:159]
v_mfma_f32_32x32x16_bf16 a[160:175], v[72:75], v[92:95], a[160:175]
v_mfma_f32_32x32x16_bf16 a[176:191], v[72:75], v[96:99], a[176:191]
s_nop 11
s_cmp_lg_u32 s48, 0
s_cbranch_scc1 L_chkw2_A
v_mov_b32 v250, 64
s_nop 1
L_mcw2_A:
global_load_dword v251, v250, s[6:7] sc1
s_waitcnt vmcnt(0)
v_readfirstlane_b32 s94, v251
s_add_u32 s95, s95, 1
s_cmp_gt_u32 s95, 4000000
s_cbranch_scc1 L_rec_done_A
s_cmp_ge_u32 s94, 256
s_cbranch_scc1 L_mcw2x_A
s_sleep 2
s_branch L_mcw2_A
L_mcw2x_A:
v_and_b32 v250, 7, v1
v_lshlrev_b32 v250, 2, v250
global_load_dword v251, v250, s[6:7] sc1
s_waitcnt vmcnt(0)
v_cmp_ne_u32 vcc, 32, v251
s_cbranch_vccz L_mcw2ok_A
s_lshr_b32 s29, s49, 5
s_and_b32 s30, s49, 31
s_waitcnt vmcnt(0) lgkmcnt(0)
s_barrier
s_branch L_role_entry_B
L_mcw2ok_A:
s_mov_b32 s48, 1
L_chkw2_A:
s_barrier
s_add_u32 s50, s50, 16
s_cmp_lt_u32 s50, 96
s_cselect_b32 s87, 1, 0
s_cbranch_scc0 L_g1_nonc_A
s_cmp_ge_u32 s50, 56
s_cbranch_scc1 L_g1_dqc_A
s_mov_b32 s84, 1
s_mov_b32 s60, s50
s_cmp_lt_u32 s50, 8
s_cbranch_scc1 L_g1_d0c_A
s_sub_u32 s61, s50, 8
s_mul_i32 s60, s61, 43
s_lshr_b32 s60, s60, 8
s_mul_i32 s84, s60, 6
s_sub_u32 s84, s61, s84
s_add_u32 s84, s84, 2
L_g1_d0c_A:
s_lshr_b32 s86, s60, 2
s_and_b32 s60, s60, 3
s_lshl_b32 s85, s29, 2
s_add_u32 s85, s85, s60
s_branch L_g1_ddc_A
L_g1_dqc_A:
s_cmp_ge_u32 s50, 88
s_cbranch_scc1 L_g1_dhc_A
s_sub_u32 s60, s50, 56
s_and_b32 s84, s60, 7
s_lshr_b32 s60, s60, 3
s_lshl_b32 s85, s29, 2
s_add_u32 s85, s85, s60
s_mov_b32 s86, 2
s_branch L_g1_ddc_A
L_g1_dhc_A:
s_sub_u32 s84, s50, 88
s_mov_b32 s85, s29
s_mov_b32 s86, 3
L_g1_ddc_A:
s_mov_b32 s56, 12288
s_mov_b32 s34, 7864320
s_mov_b32 s35, 0x00020000
s_mov_b32 s32, s10
s_mov_b32 s33, s11
s_cmp_lg_u32 s86, 1
s_cbranch_scc1 L_g1_n1c_A
s_mov_b32 s32, s12
s_mov_b32 s33, s13
L_g1_n1c_A:
s_cmp_lg_u32 s86, 2
s_cbranch_scc1 L_g1_n2c_A
s_mov_b32 s32, s8
s_mov_b32 s33, s9
L_g1_n2c_A:
s_cmp_lg_u32 s86, 3
s_cbranch_scc1 L_g1_n3c_A
s_mov_b32 s32, s16
s_mov_b32 s33, s17
s_mov_b32 s56, 3072
s_mov_b32 s34, 1966080
L_g1_n3c_A:
s_mov_b32 s55, 1280
s_lshl_b32 s57, s56, 5
s_mul_i32 s54, s85, 384
s_mul_i32 s53, s84, 327680
s_add_u32 s53, s53, 90910720
s_mul_i32 s40, s28, 4096
s_add_u32 s40, s40, 0
v_lshlrev_b32 v4, 4, v1
v_add_u32 v21, s40, v4
s_mul_i32 s40, s28, 4096
s_add_u32 s40, s40, 1024
v_lshlrev_b32 v4, 4, v1
v_add_u32 v22, s40, v4
s_mul_i32 s40, s28, 4096
s_add_u32 s40, s40, 2048
v_lshlrev_b32 v4, 4, v1
v_add_u32 v23, s40, v4
s_mul_i32 s40, s28, 4096
s_add_u32 s40, s40, 3072
v_lshlrev_b32 v4, 4, v1
v_add_u32 v24, s40, v4
v_mul_lo_u32 v4, v25, s56
v_add_u32 v31, v4, v28
v_mul_lo_u32 v4, v26, s56
v_add_u32 v32, v4, v29
v_mul_lo_u32 v4, v27, s56
v_add_u32 v33, v4, v30
s_add_u32 m0, s45, 0
s_nop 0
buffer_load_dwordx4 v21, s[20:23], s53 offen lds
s_add_u32 m0, s45, 1024
s_nop 0
buffer_load_dwordx4 v22, s[20:23], s53 offen lds
s_add_u32 m0, s45, 2048
s_nop 0
buffer_load_dwordx4 v23, s[20:23], s53 offen lds
s_add_u32 m0, s45, 3072
s_nop 0
buffer_load_dwordx4 v24, s[20:23], s53 offen lds
s_add_u32 m0, s46, 0
s_nop 0
buffer_load_dwordx4 v31, s[32:35], s54 offen lds
s_add_u32 m0, s46, 1024
s_nop 0
buffer_load_dwordx4 v32, s[32:35], s54 offen lds
s_add_u32 m0, s46, 2048
s_nop 0
buffer_load_dwordx4 v33, s[32:35], s54 offen lds
s_add_u32 s53, s53, 16384
s_add_u32 s54, s54, s57
s_add_u32 m0, s45, 28672
s_nop 0
buffer_load_dwordx4 v21, s[20:23], s53 offen lds
s_add_u32 m0, s45, 29696
s_nop 0
buffer_load_dwordx4 v22, s[20:23], s53 offen lds
s_add_u32 m0, s45, 30720
s_nop 0
buffer_load_dwordx4 v23, s[20:23], s53 offen lds
s_add_u32 m0, s45, 31744
s_nop 0
buffer_load_dwordx4 v24, s[20:23], s53 offen lds
s_add_u32 m0, s46, 28672
s_nop 0
buffer_load_dwordx4 v31, s[32:35], s54 offen lds
s_add_u32 m0, s46, 29696
s_nop 0
buffer_load_dwordx4 v32, s[32:35], s54 offen lds
s_add_u32 m0, s46, 30720
s_nop 0
buffer_load_dwordx4 v33, s[32:35], s54 offen lds
s_add_u32 s53, s53, 16384
s_add_u32 s54, s54, s57
s_add_u32 m0, s45, 57344
s_nop 0
buffer_load_dwordx4 v21, s[20:23], s53 offen lds
s_add_u32 m0, s45, 58368
s_nop 0
buffer_load_dwordx4 v22, s[20:23], s53 offen lds
s_add_u32 m0, s45, 59392
s_nop 0
buffer_load_dwordx4 v23, s[20:23], s53 offen lds
s_add_u32 m0, s45, 60416
s_nop 0
buffer_load_dwordx4 v24, s[20:23], s53 offen lds
s_add_u32 m0, s46, 57344
s_nop 0
buffer_load_dwordx4 v31, s[32:35], s54 offen lds
s_add_u32 m0, s46, 58368
s_nop 0
buffer_load_dwordx4 v32, s[32:35], s54 offen lds
s_add_u32 m0, s46, 59392
s_nop 0
buffer_load_dwordx4 v33, s[32:35], s54 offen lds
s_add_u32 s53, s53, 16384
s_add_u32 s54, s54, s57
s_add_u32 m0, s45, 86016
s_nop 0
buffer_load_dwordx4 v21, s[20:23], s53 offen lds
s_add_u32 m0, s45, 87040
s_nop 0
buffer_load_dwordx4 v22, s[20:23], s53 offen lds
s_add_u32 m0, s45, 88064
s_nop 0
buffer_load_dwordx4 v23, s[20:23], s53 offen lds
s_add_u32 m0, s45, 89088
s_nop 0
buffer_load_dwordx4 v24, s[20:23], s53 offen lds
s_add_u32 m0, s46, 86016
s_nop 0
buffer_load_dwordx4 v31, s[32:35], s54 offen lds
s_add_u32 m0, s46, 87040
s_nop 0
buffer_load_dwordx4 v32, s[32:35], s54 offen lds
s_add_u32 m0, s46, 88064
s_nop 0
buffer_load_dwordx4 v33, s[32:35], s54 offen lds
s_add_u32 s53, s53, 16384
s_add_u32 s54, s54, s57
L_g1_nonc_A:
s_lshr_b32 s60, s28, 1
s_and_b32 s61, s28, 1
s_lshl_b32 s40, s52, 3
s_lshl_b32 s60, s60, 2
s_add_u32 s40, s40, s60
s_lshl_b32 s40, s40, 5
s_add_u32 s40, s40, s59
s_mul_i32 s40, s40, 12288
s_mul_i32 s61, s61, 6144
s_add_u32 s40, s40, s61
s_add_u32 s40, s40, 25165824
s_add_u32 s41, s40, 0
v_accvgpr_read_b32 v132, a0
v_accvgpr_read_b32 v133, a1
v_accvgpr_read_b32 v134, a2
v_accvgpr_read_b32 v135, a3
v_accvgpr_read_b32 v136, a4
v_accvgpr_read_b32 v137, a5
v_accvgpr_read_b32 v138, a6
v_accvgpr_read_b32 v139, a7
v_accvgpr_read_b32 v140, a8
v_accvgpr_read_b32 v141, a9
v_accvgpr_read_b32 v142, a10
v_accvgpr_read_b32 v143, a11
v_accvgpr_read_b32 v144, a12
v_accvgpr_read_b32 v145, a13
v_accvgpr_read_b32 v146, a14
v_accvgpr_read_b32 v147, a15
v_cvt_pk_bf16_f32 v116, v132, v133
v_cvt_pk_bf16_f32 v117, v134, v135
v_cvt_pk_bf16_f32 v118, v140, v141
v_cvt_pk_bf16_f32 v119, v142, v143
v_cvt_pk_bf16_f32 v120, v136, v137
v_cvt_pk_bf16_f32 v121, v138, v139
v_cvt_pk_bf16_f32 v122, v144, v145
v_cvt_pk_bf16_f32 v123, v146, v147
buffer_store_dwordx4 v[116:119], v111, s[20:23], s41 offen
buffer_store_dwordx4 v[120:123], v111, s[20:23], s41 offen offset:512
s_add_u32 s41, s40, 2048
v_accvgpr_read_b32 v132, a16
v_accvgpr_read_b32 v133, a17
v_accvgpr_read_b32 v134, a18
v_accvgpr_read_b32 v135, a19
v_accvgpr_read_b32 v136, a20
v_accvgpr_read_b32 v137, a21
v_accvgpr_read_b32 v138, a22
v_accvgpr_read_b32 v139, a23
v_accvgpr_read_b32 v140, a24
v_accvgpr_read_b32 v141, a25
v_accvgpr_read_b32 v142, a26
v_accvgpr_read_b32 v143, a27
v_accvgpr_read_b32 v144, a28
v_accvgpr_read_b32 v145, a29
v_accvgpr_read_b32 v146, a30
v_accvgpr_read_b32 v147, a31
v_cvt_pk_bf16_f32 v116, v132, v133
v_cvt_pk_bf16_f32 v117, v134, v135
v_cvt_pk_bf16_f32 v118, v140, v141
v_cvt_pk_bf16_f32 v119, v142, v143
v_cvt_pk_bf16_f32 v120, v136, v137
v_cvt_pk_bf16_f32 v121, v138, v139
v_cvt_pk_bf16_f32 v122, v144, v145
v_cvt_pk_bf16_f32 v123, v146, v147
buffer_store_dwordx4 v[116:119], v111, s[20:23], s41 offen
buffer_store_dwordx4 v[120:123], v111, s[20:23], s41 offen offset:512
s_add_u32 s41, s40, 4096
v_accvgpr_read_b32 v132, a32
v_accvgpr_read_b32 v133, a33
v_accvgpr_read_b32 v134, a34
v_accvgpr_read_b32 v135, a35
v_accvgpr_read_b32 v136, a36
v_accvgpr_read_b32 v137, a37
v_accvgpr_read_b32 v138, a38
v_accvgpr_read_b32 v139, a39
v_accvgpr_read_b32 v140, a40
v_accvgpr_read_b32 v141, a41
v_accvgpr_read_b32 v142, a42
v_accvgpr_read_b32 v143, a43
v_accvgpr_read_b32 v144, a44
v_accvgpr_read_b32 v145, a45
v_accvgpr_read_b32 v146, a46
v_accvgpr_read_b32 v147, a47
v_cvt_pk_bf16_f32 v116, v132, v133
v_cvt_pk_bf16_f32 v117, v134, v135
v_cvt_pk_bf16_f32 v118, v140, v141
v_cvt_pk_bf16_f32 v119, v142, v143
v_cvt_pk_bf16_f32 v120, v136, v137
v_cvt_pk_bf16_f32 v121, v138, v139
v_cvt_pk_bf16_f32 v122, v144, v145
v_cvt_pk_bf16_f32 v123, v146, v147
buffer_store_dwordx4 v[116:119], v111, s[20:23], s41 offen
buffer_store_dwordx4 v[120:123], v111, s[20:23], s41 offen offset:512
s_add_u32 s41, s40, 393216
v_accvgpr_read_b32 v132, a48
v_accvgpr_read_b32 v133, a49
v_accvgpr_read_b32 v134, a50
v_accvgpr_read_b32 v135, a51
v_accvgpr_read_b32 v136, a52
v_accvgpr_read_b32 v137, a53
v_accvgpr_read_b32 v138, a54
v_accvgpr_read_b32 v139, a55
v_accvgpr_read_b32 v140, a56
v_accvgpr_read_b32 v141, a57
v_accvgpr_read_b32 v142, a58
v_accvgpr_read_b32 v143, a59
v_accvgpr_read_b32 v144, a60
v_accvgpr_read_b32 v145, a61
v_accvgpr_read_b32 v146, a62
v_accvgpr_read_b32 v147, a63
v_cvt_pk_bf16_f32 v116, v132, v133
v_cvt_pk_bf16_f32 v117, v134, v135
v_cvt_pk_bf16_f32 v118, v140, v141
v_cvt_pk_bf16_f32 v119, v142, v143
v_cvt_pk_bf16_f32 v120, v136, v137
v_cvt_pk_bf16_f32 v121, v138, v139
v_cvt_pk_bf16_f32 v122, v144, v145
v_cvt_pk_bf16_f32 v123, v146, v147
buffer_store_dwordx4 v[116:119], v111, s[20:23], s41 offen
buffer_store_dwordx4 v[120:123], v111, s[20:23], s41 offen offset:512
s_add_u32 s41, s40, 395264
v_accvgpr_read_b32 v132, a64
v_accvgpr_read_b32 v133, a65
v_accvgpr_read_b32 v134, a66
v_accvgpr_read_b32 v135, a67
v_accvgpr_read_b32 v136, a68
v_accvgpr_read_b32 v137, a69
v_accvgpr_read_b32 v138, a70
v_accvgpr_read_b32 v139, a71
v_accvgpr_read_b32 v140, a72
v_accvgpr_read_b32 v141, a73
v_accvgpr_read_b32 v142, a74
v_accvgpr_read_b32 v143, a75
v_accvgpr_read_b32 v144, a76
v_accvgpr_read_b32 v145, a77
v_accvgpr_read_b32 v146, a78
v_accvgpr_read_b32 v147, a79
v_cvt_pk_bf16_f32 v116, v132, v133
v_cvt_pk_bf16_f32 v117, v134, v135
v_cvt_pk_bf16_f32 v118, v140, v141
v_cvt_pk_bf16_f32 v119, v142, v143
v_cvt_pk_bf16_f32 v120, v136, v137
v_cvt_pk_bf16_f32 v121, v138, v139
v_cvt_pk_bf16_f32 v122, v144, v145
v_cvt_pk_bf16_f32 v123, v146, v147
buffer_store_dwordx4 v[116:119], v111, s[20:23], s41 offen
buffer_store_dwordx4 v[120:123], v111, s[20:23], s41 offen offset:512
s_add_u32 s41, s40, 397312
v_accvgpr_read_b32 v132, a80
v_accvgpr_read_b32 v133, a81
v_accvgpr_read_b32 v134, a82
v_accvgpr_read_b32 v135, a83
v_accvgpr_read_b32 v136, a84
v_accvgpr_read_b32 v137, a85
v_accvgpr_read_b32 v138, a86
v_accvgpr_read_b32 v139, a87
v_accvgpr_read_b32 v140, a88
v_accvgpr_read_b32 v141, a89
v_accvgpr_read_b32 v142, a90
v_accvgpr_read_b32 v143, a91
v_accvgpr_read_b32 v144, a92
v_accvgpr_read_b32 v145, a93
v_accvgpr_read_b32 v146, a94
v_accvgpr_read_b32 v147, a95
v_cvt_pk_bf16_f32 v116, v132, v133
v_cvt_pk_bf16_f32 v117, v134, v135
v_cvt_pk_bf16_f32 v118, v140, v141
v_cvt_pk_bf16_f32 v119, v142, v143
v_cvt_pk_bf16_f32 v120, v136, v137
v_cvt_pk_bf16_f32 v121, v138, v139
v_cvt_pk_bf16_f32 v122, v144, v145
v_cvt_pk_bf16_f32 v123, v146, v147
buffer_store_dwordx4 v[116:119], v111, s[20:23], s41 offen
buffer_store_dwordx4 v[120:123], v111, s[20:23], s41 offen offset:512
s_add_u32 s41, s40, 786432
v_accvgpr_read_b32 v132, a96
v_accvgpr_read_b32 v133, a97
v_accvgpr_read_b32 v134, a98
v_accvgpr_read_b32 v135, a99
v_accvgpr_read_b32 v136, a100
v_accvgpr_read_b32 v137, a101
v_accvgpr_read_b32 v138, a102
v_accvgpr_read_b32 v139, a103
v_accvgpr_read_b32 v140, a104
v_accvgpr_read_b32 v141, a105
v_accvgpr_read_b32 v142, a106
v_accvgpr_read_b32 v143, a107
v_accvgpr_read_b32 v144, a108
v_accvgpr_read_b32 v145, a109
v_accvgpr_read_b32 v146, a110
v_accvgpr_read_b32 v147, a111
v_cvt_pk_bf16_f32 v116, v132, v133
v_cvt_pk_bf16_f32 v117, v134, v135
v_cvt_pk_bf16_f32 v118, v140, v141
v_cvt_pk_bf16_f32 v119, v142, v143
v_cvt_pk_bf16_f32 v120, v136, v137
v_cvt_pk_bf16_f32 v121, v138, v139
v_cvt_pk_bf16_f32 v122, v144, v145
v_cvt_pk_bf16_f32 v123, v146, v147
buffer_store_dwordx4 v[116:119], v111, s[20:23], s41 offen
buffer_store_dwordx4 v[120:123], v111, s[20:23], s41 offen offset:512
s_add_u32 s41, s40, 788480
v_accvgpr_read_b32 v132, a112
v_accvgpr_read_b32 v133, a113
v_accvgpr_read_b32 v134, a114
v_accvgpr_read_b32 v135, a115
v_accvgpr_read_b32 v136, a116
v_accvgpr_read_b32 v137, a117
v_accvgpr_read_b32 v138, a118
v_accvgpr_read_b32 v139, a119
v_accvgpr_read_b32 v140, a120
v_accvgpr_read_b32 v141, a121
v_accvgpr_read_b32 v142, a122
v_accvgpr_read_b32 v143, a123
v_accvgpr_read_b32 v144, a124
v_accvgpr_read_b32 v145, a125
v_accvgpr_read_b32 v146, a126
v_accvgpr_read_b32 v147, a127
v_cvt_pk_bf16_f32 v116, v132, v133
v_cvt_pk_bf16_f32 v117, v134, v135
v_cvt_pk_bf16_f32 v118, v140, v141
v_cvt_pk_bf16_f32 v119, v142, v143
v_cvt_pk_bf16_f32 v120, v136, v137
v_cvt_pk_bf16_f32 v121, v138, v139
v_cvt_pk_bf16_f32 v122, v144, v145
v_cvt_pk_bf16_f32 v123, v146, v147
buffer_store_dwordx4 v[116:119], v111, s[20:23], s41 offen
buffer_store_dwordx4 v[120:123], v111, s[20:23], s41 offen offset:512
s_add_u32 s41, s40, 790528
v_accvgpr_read_b32 v132, a128
v_accvgpr_read_b32 v133, a129
v_accvgpr_read_b32 v134, a130
v_accvgpr_read_b32 v135, a131
v_accvgpr_read_b32 v136, a132
v_accvgpr_read_b32 v137, a133
v_accvgpr_read_b32 v138, a134
v_accvgpr_read_b32 v139, a135
v_accvgpr_read_b32 v140, a136
v_accvgpr_read_b32 v141, a137
v_accvgpr_read_b32 v142, a138
v_accvgpr_read_b32 v143, a139
v_accvgpr_read_b32 v144, a140
v_accvgpr_read_b32 v145, a141
v_accvgpr_read_b32 v146, a142
v_accvgpr_read_b32 v147, a143
v_cvt_pk_bf16_f32 v116, v132, v133
v_cvt_pk_bf16_f32 v117, v134, v135
v_cvt_pk_bf16_f32 v118, v140, v141
v_cvt_pk_bf16_f32 v119, v142, v143
v_cvt_pk_bf16_f32 v120, v136, v137
v_cvt_pk_bf16_f32 v121, v138, v139
v_cvt_pk_bf16_f32 v122, v144, v145
v_cvt_pk_bf16_f32 v123, v146, v147
buffer_store_dwordx4 v[116:119], v111, s[20:23], s41 offen
buffer_store_dwordx4 v[120:123], v111, s[20:23], s41 offen offset:512
s_add_u32 s41, s40, 1179648
v_accvgpr_read_b32 v132, a144
v_accvgpr_read_b32 v133, a145
v_accvgpr_read_b32 v134, a146
v_accvgpr_read_b32 v135, a147
v_accvgpr_read_b32 v136, a148
v_accvgpr_read_b32 v137, a149
v_accvgpr_read_b32 v138, a150
v_accvgpr_read_b32 v139, a151
v_accvgpr_read_b32 v140, a152
v_accvgpr_read_b32 v141, a153
v_accvgpr_read_b32 v142, a154
v_accvgpr_read_b32 v143, a155
v_accvgpr_read_b32 v144, a156
v_accvgpr_read_b32 v145, a157
v_accvgpr_read_b32 v146, a158
v_accvgpr_read_b32 v147, a159
v_cvt_pk_bf16_f32 v116, v132, v133
v_cvt_pk_bf16_f32 v117, v134, v135
v_cvt_pk_bf16_f32 v118, v140, v141
v_cvt_pk_bf16_f32 v119, v142, v143
v_cvt_pk_bf16_f32 v120, v136, v137
v_cvt_pk_bf16_f32 v121, v138, v139
v_cvt_pk_bf16_f32 v122, v144, v145
v_cvt_pk_bf16_f32 v123, v146, v147
buffer_store_dwordx4 v[116:119], v111, s[20:23], s41 offen
buffer_store_dwordx4 v[120:123], v111, s[20:23], s41 offen offset:512
s_add_u32 s41, s40, 1181696
v_accvgpr_read_b32 v132, a160
v_accvgpr_read_b32 v133, a161
v_accvgpr_read_b32 v134, a162
v_accvgpr_read_b32 v135, a163
v_accvgpr_read_b32 v136, a164
v_accvgpr_read_b32 v137, a165
v_accvgpr_read_b32 v138, a166
v_accvgpr_read_b32 v139, a167
v_accvgpr_read_b32 v140, a168
v_accvgpr_read_b32 v141, a169
v_accvgpr_read_b32 v142, a170
v_accvgpr_read_b32 v143, a171
v_accvgpr_read_b32 v144, a172
v_accvgpr_read_b32 v145, a173
v_accvgpr_read_b32 v146, a174
v_accvgpr_read_b32 v147, a175
v_cvt_pk_bf16_f32 v116, v132, v133
v_cvt_pk_bf16_f32 v117, v134, v135
v_cvt_pk_bf16_f32 v118, v140, v141
v_cvt_pk_bf16_f32 v119, v142, v143
v_cvt_pk_bf16_f32 v120, v136, v137
v_cvt_pk_bf16_f32 v121, v138, v139
v_cvt_pk_bf16_f32 v122, v144, v145
v_cvt_pk_bf16_f32 v123, v146, v147
buffer_store_dwordx4 v[116:119], v111, s[20:23], s41 offen
buffer_store_dwordx4 v[120:123], v111, s[20:23], s41 offen offset:512
s_add_u32 s41, s40, 1183744
v_accvgpr_read_b32 v132, a176
v_accvgpr_read_b32 v133, a177
v_accvgpr_read_b32 v134, a178
v_accvgpr_read_b32 v135, a179
v_accvgpr_read_b32 v136, a180
v_accvgpr_read_b32 v137, a181
v_accvgpr_read_b32 v138, a182
v_accvgpr_read_b32 v139, a183
v_accvgpr_read_b32 v140, a184
v_accvgpr_read_b32 v141, a185
v_accvgpr_read_b32 v142, a186
v_accvgpr_read_b32 v143, a187
v_accvgpr_read_b32 v144, a188
v_accvgpr_read_b32 v145, a189
v_accvgpr_read_b32 v146, a190
v_accvgpr_read_b32 v147, a191
v_cvt_pk_bf16_f32 v116, v132, v133
v_cvt_pk_bf16_f32 v117, v134, v135
v_cvt_pk_bf16_f32 v118, v140, v141
v_cvt_pk_bf16_f32 v119, v142, v143
v_cvt_pk_bf16_f32 v120, v136, v137
v_cvt_pk_bf16_f32 v121, v138, v139
v_cvt_pk_bf16_f32 v122, v144, v145
v_cvt_pk_bf16_f32 v123, v146, v147
buffer_store_dwordx4 v[116:119], v111, s[20:23], s41 offen
buffer_store_dwordx4 v[120:123], v111, s[20:23], s41 offen offset:512
s_mov_b32 s60, 178466816
s_lshl_b32 s61, s29, 9
s_add_u32 s60, s60, s61
L_g1_next_A:
s_lshl_b32 s61, s52, 6
s_add_u32 s60, s60, s61
s_cmp_eq_u32 s58, 3
s_cbranch_scc1 L_g1_sigat_A
s_and_b32 s61, s59, 3
s_cmp_eq_u32 s58, 1
s_cselect_b32 s41, 4, 0
s_add_u32 s61, s61, s41
s_lshl_b32 s61, s61, 2
s_add_u32 s60, s60, s61
s_cmp_lt_u32 s58, 2
s_cselect_b32 s61, 1, 0
s_waitcnt vmcnt(0)
s_barrier
s_cmp_lg_u32 s28, 0
s_cbranch_scc1 L_sigf_9_A
s_mov_b64 exec, 1
s_cmp_lg_u32 s61, 0
s_cselect_b32 exec_lo, 3, 1
v_lshlrev_b32 v17, 5, v1
v_add_u32 v17, s60, v17
buffer_store_dword v16, v17, s[20:23], 0 offen
s_mov_b64 exec, -1
L_sigf_9_A:
s_branch L_g1_sigx_A
L_g1_sigat_A:
s_waitcnt vmcnt(0)
s_barrier
s_cmp_lg_u32 s28, 0
s_cbranch_scc1 L_sig_10_A
s_mov_b64 exec, 1
v_mov_b32 v17, s60
buffer_atomic_add v16, v17, s[20:23], 0 offen sc1
s_mov_b64 exec, -1
L_sig_10_A:
L_g1_sigx_A:
s_cmp_eq_u32 s87, 1
s_cbranch_scc1 L_g1_task_A
L_g1_done_A:
s_mul_i32 s46, s28, 3072
s_add_u32 s46, s46, 16384
v_lshrrev_b32 v19, 2, v1
v_and_b32 v4, 3, v1
v_lshrrev_b32 v5, 4, v1
v_xor_b32 v4, v4, v5
v_lshlrev_b32 v20, 4, v4
s_mul_i32 s40, s28, 192
s_add_u32 s40, s40, 0
v_add_u32 v4, s40, v1
s_mov_b32 s41, 52429
v_mul_u32_u24 v5, s41, v4
v_lshrrev_b32 v25, 20, v5
v_mul_u32_u24 v5, 20, v25
v_sub_u32 v5, v4, v5
v_lshlrev_b32 v28, 4, v5
s_mul_i32 s40, s28, 192
s_add_u32 s40, s40, 64
v_add_u32 v4, s40, v1
s_mov_b32 s41, 52429
v_mul_u32_u24 v5, s41, v4
v_lshrrev_b32 v26, 20, v5
v_mul_u32_u24 v5, 20, v26
v_sub_u32 v5, v4, v5
v_lshlrev_b32 v29, 4, v5
s_mul_i32 s40, s28, 192
s_add_u32 s40, s40, 128
v_add_u32 v4, s40, v1
s_mov_b32 s41, 52429
v_mul_u32_u24 v5, s41, v4
v_lshrrev_b32 v27, 20, v5
v_mul_u32_u24 v5, 20, v27
v_sub_u32 v5, v4, v5
v_lshlrev_b32 v30, 4, v5
v_and_b32 v4, 31, v1
v_lshrrev_b32 v5, 5, v1
v_bfe_u32 v6, v4, 2, 2
s_lshr_b32 s40, s28, 0
s_mul_i32 s40, s40, 4096
v_add_u32 v7, 0, v5
v_xor_b32 v7, v7, v6
v_lshlrev_b32 v7, 4, v7
v_lshl_add_u32 v7, v4, 6, v7
v_add_u32 v34, s40, v7
v_add_u32 v7, 2, v5
v_xor_b32 v7, v7, v6
v_lshlrev_b32 v7, 4, v7
v_lshl_add_u32 v7, v4, 6, v7
v_add_u32 v35, s40, v7
v_and_b32 v4, 15, v1
v_lshrrev_b32 v5, 4, v1
v_and_b32 v6, 1, v5
v_lshrrev_b32 v5, 1, v5
v_bfe_u32 v7, v4, 1, 1
v_lshl_add_u32 v6, v6, 1, v7
v_bfe_u32 v8, v4, 3, 1
v_lshlrev_b32 v8, 2, v8
v_and_b32 v9, 1, v4
v_lshlrev_b32 v9, 3, v9
v_lshrrev_b32 v10, 2, v4
v_lshlrev_b32 v11, 2, v5
v_add_u32 v11, 0, v11
v_add_u32 v11, v11, v10
v_mul_u32_u24 v11, 320, v11
v_add_u32 v11, v11, v9
v_add_u32 v12, 0, v6
v_lshl_add_u32 v36, v12, 4, v11
v_add_u32 v36, 16384, v36
v_add_u32 v12, 4, v6
v_lshl_add_u32 v40, v12, 4, v11
v_add_u32 v40, 16384, v40
v_lshlrev_b32 v11, 2, v5
v_add_u32 v11, 16, v11
v_add_u32 v11, v11, v10
v_mul_u32_u24 v11, 320, v11
v_add_u32 v11, v11, v9
v_add_u32 v12, 0, v6
v_lshl_add_u32 v37, v12, 4, v11
v_add_u32 v37, 16384, v37
v_add_u32 v12, 4, v6
v_lshl_add_u32 v41, v12, 4, v11
v_add_u32 v41, 16384, v41
v_lshlrev_b32 v11, 2, v5
v_add_u32 v11, 8, v11
v_add_u32 v11, v11, v10
v_mul_u32_u24 v11, 320, v11
v_add_u32 v11, v11, v9
v_add_u32 v12, 0, v6
v_lshl_add_u32 v38, v12, 4, v11
v_add_u32 v38, 16384, v38
v_add_u32 v12, 4, v6
v_lshl_add_u32 v42, v12, 4, v11
v_add_u32 v42, 16384, v42
v_lshlrev_b32 v11, 2, v5
v_add_u32 v11, 24, v11
v_add_u32 v11, v11, v10
v_mul_u32_u24 v11, 320, v11
v_add_u32 v11, v11, v9
v_add_u32 v12, 0, v6
v_lshl_add_u32 v39, v12, 4, v11
v_add_u32 v39, 16384, v39
v_add_u32 v12, 4, v6
v_lshl_add_u32 v43, v12, 4, v11
v_add_u32 v43, 16384, v43
v_add_u32 v100, 57344, v34
v_add_u32 v101, 57344, v35
v_add_u32 v102, 57344, v36
v_add_u32 v103, 57344, v37
v_add_u32 v104, 57344, v38
v_add_u32 v105, 57344, v39
v_add_u32 v106, 57344, v40
v_add_u32 v107, 57344, v41
v_add_u32 v108, 57344, v42
v_add_u32 v109, 57344, v43
v_and_b32 v4, 31, v1
v_mul_u32_u24 v4, 2560, v4
v_lshrrev_b32 v5, 5, v1
v_lshl_add_u32 v110, v5, 4, v4
v_lshlrev_b32 v128, 4, v1
v_lshrrev_b32 v4, 4, v1
v_and_b32 v5, 7, v1
v_lshlrev_b32 v129, 7, v4
v_lshl_add_u32 v129, v5, 4, v129
v_and_b32 v5, 31, v1
v_lshlrev_b32 v130, 3, v5
v_and_b32 v132, 15, v1
v_bfe_u32 v6, v132, 2, 2
v_xor_b32 v6, v6, v4
v_lshlrev_b32 v6, 4, v6
v_lshl_add_u32 v131, v132, 6, v6
v_lshlrev_b32 v4, 2, v4
v_sub_u32 v132, v132, v4
v_mov_b32 v133, 0xce6e6b28
s_mov_b32 s66, 0x3d93cd3a
s_mov_b32 s67, 0x3fb8aa3b
s_mov_b32 s98, 0
s_mov_b32 s50, 0
s_cmp_ge_u32 s63, 8
s_cbranch_scc1 L_b_task_A
s_mov_b32 s99, 1
s_mov_b32 s52, s29
s_mov_b32 s65, s63
s_branch L_b_g2_A
L_b_task_A:
s_mov_b32 s99, 0
s_cmp_ge_u32 s50, 8
s_cbranch_scc1 L_w_done_A
s_mov_b32 s52, s50
s_cmp_eq_u32 s52, 7
s_cselect_b32 s98, 1, 0
s_cbranch_scc1 L_b_fine_A
s_lshl_b32 s60, s52, 2
s_sub_u32 s65, s63, s60
s_and_b32 s65, s65, 15
s_cmp_ge_u32 s65, 12
s_cbranch_scc1 L_b_next_A
s_cmp_lt_u32 s65, 4
s_cbranch_scc1 L_b_g2_A
s_sub_u32 s65, s65, 4
s_branch L_b_e_A
L_b_fine_A:
s_mov_b32 s65, s63
s_cmp_ge_u32 s63, 8
s_cbranch_scc1 L_b_g2_A
L_b_e_A:
s_lshl_b32 s77, s52, 3
s_add_u32 s77, s77, s65
s_lshl_b32 s59, s29, 2
s_add_u32 s59, s59, s28
s_lshl_b32 s76, s77, 5
s_add_u32 s76, s76, s59
s_lshl_b32 s60, s29, 3
s_add_u32 s60, s60, s52
s_lshl_b32 s60, s60, 6
s_add_u32 s60, s60, 178470912
s_cmp_lg_u32 s28, 0
s_cbranch_scc1 L_wf_11x_A
v_min_u32 v17, 3, v1
v_lshlrev_b32 v17, 2, v17
s_nop 1
L_wf_11_A:
buffer_load_dword v18, v17, s[20:23], s60 offen sc1
s_waitcnt vmcnt(0)
v_cmp_eq_u32 vcc, 0, v18
s_add_u32 s64, s64, 1
s_cmp_gt_u32 s64, 2000000
s_cbranch_scc1 L_w_done_A
s_cbranch_vccz L_wf_11x_A
s_cmp_eq_u32 s98, 1
s_cbranch_scc1 L_sl_12_A
s_sleep 40
L_sl_12_A:
s_sleep 4
s_branch L_wf_11_A
L_wf_11x_A:
s_barrier
s_sub_u32 s60, s60, 4096
s_cmp_lg_u32 s28, 0
s_cbranch_scc1 L_wf_13x_A
v_min_u32 v17, 15, v1
v_lshlrev_b32 v17, 2, v17
s_nop 1
L_wf_13_A:
buffer_load_dword v18, v17, s[20:23], s60 offen sc1
s_waitcnt vmcnt(0)
v_cmp_eq_u32 vcc, 0, v18
s_add_u32 s64, s64, 1
s_cmp_gt_u32 s64, 2000000
s_cbranch_scc1 L_w_done_A
s_cbranch_vccz L_wf_13x_A
s_cmp_eq_u32 s98, 1
s_cbranch_scc1 L_sl_14_A
s_sleep 40
L_sl_14_A:
s_sleep 4
s_branch L_wf_13_A
L_wf_13x_A:
s_barrier
s_mul_i32 s53, s76, 12288
s_add_u32 s40, s53, 50331648
buffer_load_dwordx4 v[44:47], v128, s[20:23], s40 offen offset:0 sc1
buffer_load_dwordx4 v[48:51], v128, s[20:23], s40 offen offset:1024 sc1
buffer_load_dwordx4 v[52:55], v128, s[20:23], s40 offen offset:2048 sc1
buffer_load_dwordx4 v[56:59], v128, s[20:23], s40 offen offset:3072 sc1
s_add_u32 s40, s53, 50335744
buffer_load_dwordx4 v[60:63], v128, s[20:23], s40 offen offset:0 sc1
buffer_load_dwordx4 v[64:67], v128, s[20:23], s40 offen offset:1024 sc1
buffer_load_dwordx4 v[68:71], v128, s[20:23], s40 offen offset:2048 sc1
buffer_load_dwordx4 v[72:75], v128, s[20:23], s40 offen offset:3072 sc1
s_add_u32 s40, s53, 50339840
buffer_load_dwordx4 v[76:79], v128, s[20:23], s40 offen offset:0 sc1
buffer_load_dwordx4 v[80:83], v128, s[20:23], s40 offen offset:1024 sc1
buffer_load_dwordx4 v[84:87], v128, s[20:23], s40 offen offset:2048 sc1
buffer_load_dwordx4 v[88:91], v128, s[20:23], s40 offen offset:3072 sc1
s_add_u32 s40, s53, 0
buffer_load_dwordx4 a[0:3], v128, s[20:23], s40 offen offset:0 sc1
buffer_load_dwordx4 a[4:7], v128, s[20:23], s40 offen offset:1024 sc1
buffer_load_dwordx4 a[8:11], v128, s[20:23], s40 offen offset:2048 sc1
buffer_load_dwordx4 a[12:15], v128, s[20:23], s40 offen offset:3072 sc1
s_add_u32 s40, s53, 4096
buffer_load_dwordx4 a[16:19], v128, s[20:23], s40 offen offset:0 sc1
buffer_load_dwordx4 a[20:23], v128, s[20:23], s40 offen offset:1024 sc1
buffer_load_dwordx4 a[24:27], v128, s[20:23], s40 offen offset:2048 sc1
buffer_load_dwordx4 a[28:31], v128, s[20:23], s40 offen offset:3072 sc1
s_add_u32 s40, s53, 8192
buffer_load_dwordx4 a[32:35], v128, s[20:23], s40 offen offset:0 sc1
buffer_load_dwordx4 a[36:39], v128, s[20:23], s40 offen offset:1024 sc1
buffer_load_dwordx4 a[40:43], v128, s[20:23], s40 offen offset:2048 sc1
buffer_load_dwordx4 a[44:47], v128, s[20:23], s40 offen offset:3072 sc1
s_add_u32 s40, s53, 25165824
buffer_load_dwordx4 a[48:51], v128, s[20:23], s40 offen offset:0 sc1
buffer_load_dwordx4 a[52:55], v128, s[20:23], s40 offen offset:1024 sc1
buffer_load_dwordx4 a[56:59], v128, s[20:23], s40 offen offset:2048 sc1
buffer_load_dwordx4 a[60:63], v128, s[20:23], s40 offen offset:3072 sc1
s_add_u32 s40, s53, 25169920
buffer_load_dwordx4 a[64:67], v128, s[20:23], s40 offen offset:0 sc1
buffer_load_dwordx4 a[68:71], v128, s[20:23], s40 offen offset:1024 sc1
buffer_load_dwordx4 a[72:75], v128, s[20:23], s40 offen offset:2048 sc1
buffer_load_dwordx4 a[76:79], v128, s[20:23], s40 offen offset:3072 sc1
s_add_u32 s40, s53, 25174016
buffer_load_dwordx4 a[80:83], v128, s[20:23], s40 offen offset:0 sc1
buffer_load_dwordx4 a[84:87], v128, s[20:23], s40 offen offset:1024 sc1
buffer_load_dwordx4 a[88:91], v128, s[20:23], s40 offen offset:2048 sc1
buffer_load_dwordx4 a[92:95], v128, s[20:23], s40 offen offset:3072 sc1
s_lshl_b32 s60, s76, 6
s_add_u32 s60, s60, 178483200
v_min_u32 v17, 11, v1
v_lshlrev_b32 v17, 2, v17
s_nop 1
L_hw_A:
buffer_load_dword v18, v17, s[20:23], s60 offen sc1
s_waitcnt vmcnt(0)
v_cmp_eq_u32 vcc, 0, v18
s_add_u32 s64, s64, 1
s_cmp_gt_u32 s64, 2000000
s_cbranch_scc1 L_w_done_A
s_cbranch_vccz L_hwx_A
s_cmp_eq_u32 s98, 1
s_cbranch_scc1 L_sl_15_A
s_sleep 40
L_sl_15_A:
s_sleep 4
s_branch L_hw_A
L_hwx_A:
s_mul_i32 s41, s76, 3072
s_add_u32 s40, s41, 77660160
buffer_load_dwordx4 v[136:139], v129, s[20:23], s40 offen offset:0 sc1
buffer_load_dwordx4 v[140:143], v129, s[20:23], s40 offen offset:512 sc1
buffer_load_dwordx4 v[144:147], v129, s[20:23], s40 offen offset:1024 sc1
buffer_load_dwordx4 v[148:151], v129, s[20:23], s40 offen offset:1536 sc1
buffer_load_dwordx4 v[152:155], v129, s[20:23], s40 offen offset:2048 sc1
buffer_load_dwordx4 v[156:159], v129, s[20:23], s40 offen offset:2560 sc1
s_add_u32 s40, s41, 83951616
buffer_load_dwordx2 v[160:161], v130, s[20:23], s40 offen offset:0 sc1
buffer_load_dwordx2 v[162:163], v130, s[20:23], s40 offen offset:256 sc1
buffer_load_dwordx2 v[164:165], v130, s[20:23], s40 offen offset:512 sc1
buffer_load_dwordx2 v[166:167], v130, s[20:23], s40 offen offset:768 sc1
buffer_load_dwordx2 v[168:169], v130, s[20:23], s40 offen offset:1024 sc1
buffer_load_dwordx2 v[170:171], v130, s[20:23], s40 offen offset:1280 sc1
buffer_load_dwordx2 v[172:173], v130, s[20:23], s40 offen offset:1536 sc1
buffer_load_dwordx2 v[174:175], v130, s[20:23], s40 offen offset:1792 sc1
buffer_load_dwordx2 v[176:177], v130, s[20:23], s40 offen offset:2048 sc1
buffer_load_dwordx2 v[178:179], v130, s[20:23], s40 offen offset:2304 sc1
buffer_load_dwordx2 v[180:181], v130, s[20:23], s40 offen offset:2560 sc1
buffer_load_dwordx2 v[182:183], v130, s[20:23], s40 offen offset:2816 sc1
s_waitcnt vmcnt(0)
v_mfma_f32_16x16x32_bf16 v[184:187], a[0:3], v[44:47], 0
v_mfma_f32_16x16x32_bf16 v[188:191], v[136:139], v[44:47], 0
v_mfma_f32_16x16x32_bf16 v[192:195], a[0:3], v[68:71], 0
v_mfma_f32_16x16x32_bf16 v[196:199], a[24:27], v[68:71], 0
v_mfma_f32_16x16x32_bf16 v[200:203], v[136:139], v[68:71], 0
v_mfma_f32_16x16x32_bf16 v[184:187], a[4:7], v[48:51], v[184:187]
v_mfma_f32_16x16x32_bf16 v[188:191], v[140:143], v[48:51], v[188:191]
v_mfma_f32_16x16x32_bf16 v[192:195], a[4:7], v[72:75], v[192:195]
v_mfma_f32_16x16x32_bf16 v[196:199], a[28:31], v[72:75], v[196:199]
v_mfma_f32_16x16x32_bf16 v[200:203], v[140:143], v[72:75], v[200:203]
v_mfma_f32_16x16x32_bf16 v[184:187], a[8:11], v[52:55], v[184:187]
v_mfma_f32_16x16x32_bf16 v[188:191], v[144:147], v[52:55], v[188:191]
v_mfma_f32_16x16x32_bf16 v[192:195], a[8:11], v[76:79], v[192:195]
v_mfma_f32_16x16x32_bf16 v[196:199], a[32:35], v[76:79], v[196:199]
v_mfma_f32_16x16x32_bf16 v[200:203], v[144:147], v[76:79], v[200:203]
v_mfma_f32_16x16x32_bf16 v[184:187], a[12:15], v[56:59], v[184:187]
v_mfma_f32_16x16x32_bf16 v[188:191], v[148:151], v[56:59], v[188:191]
v_mfma_f32_16x16x32_bf16 v[192:195], a[12:15], v[80:83], v[192:195]
v_mfma_f32_16x16x32_bf16 v[196:199], a[36:39], v[80:83], v[196:199]
v_mfma_f32_16x16x32_bf16 v[200:203], v[148:151], v[80:83], v[200:203]
v_mfma_f32_16x16x32_bf16 v[184:187], a[16:19], v[60:63], v[184:187]
v_mfma_f32_16x16x32_bf16 v[188:191], v[152:155], v[60:63], v[188:191]
v_mfma_f32_16x16x32_bf16 v[192:195], a[16:19], v[84:87], v[192:195]
v_mfma_f32_16x16x32_bf16 v[196:199], a[40:43], v[84:87], v[196:199]
v_mfma_f32_16x16x32_bf16 v[200:203], v[152:155], v[84:87], v[200:203]
v_mfma_f32_16x16x32_bf16 v[184:187], a[20:23], v[64:67], v[184:187]
v_mfma_f32_16x16x32_bf16 v[188:191], v[156:159], v[64:67], v[188:191]
v_mfma_f32_16x16x32_bf16 v[192:195], a[20:23], v[88:91], v[192:195]
v_mfma_f32_16x16x32_bf16 v[196:199], a[44:47], v[88:91], v[196:199]
v_mfma_f32_16x16x32_bf16 v[200:203], v[156:159], v[88:91], v[200:203]
s_nop 3
v_cvt_pk_bf16_f32 v4, v184, v185
v_lshlrev_b32 v184, 16, v4
v_and_b32 v185, 0xffff0000, v4
v_mul_f32 v184, s66, v184
v_mul_f32 v185, s66, v185
v_cvt_pk_bf16_f32 v4, v184, v185
v_lshlrev_b32 v184, 16, v4
v_and_b32 v185, 0xffff0000, v4
v_cvt_pk_bf16_f32 v4, v186, v187
v_lshlrev_b32 v186, 16, v4
v_and_b32 v187, 0xffff0000, v4
v_mul_f32 v186, s66, v186
v_mul_f32 v187, s66, v187
v_cvt_pk_bf16_f32 v4, v186, v187
v_lshlrev_b32 v186, 16, v4
v_and_b32 v187, 0xffff0000, v4
v_cvt_pk_bf16_f32 v4, v188, v189
v_lshlrev_b32 v188, 16, v4
v_and_b32 v189, 0xffff0000, v4
v_mul_f32 v188, s66, v188
v_mul_f32 v189, s66, v189
v_cvt_pk_bf16_f32 v4, v188, v189
v_lshlrev_b32 v188, 16, v4
v_and_b32 v189, 0xffff0000, v4
v_cvt_pk_bf16_f32 v4, v190, v191
v_lshlrev_b32 v190, 16, v4
v_and_b32 v191, 0xffff0000, v4
v_mul_f32 v190, s66, v190
v_mul_f32 v191, s66, v191
v_cvt_pk_bf16_f32 v4, v190, v191
v_lshlrev_b32 v190, 16, v4
v_and_b32 v191, 0xffff0000, v4
v_cvt_pk_bf16_f32 v4, v192, v193
v_lshlrev_b32 v192, 16, v4
v_and_b32 v193, 0xffff0000, v4
v_mul_f32 v192, s66, v192
v_mul_f32 v193, s66, v193
v_cvt_pk_bf16_f32 v4, v192, v193
v_lshlrev_b32 v192, 16, v4
v_and_b32 v193, 0xffff0000, v4
v_cvt_pk_bf16_f32 v4, v194, v195
v_lshlrev_b32 v194, 16, v4
v_and_b32 v195, 0xffff0000, v4
v_mul_f32 v194, s66, v194
v_mul_f32 v195, s66, v195
v_cvt_pk_bf16_f32 v4, v194, v195
v_lshlrev_b32 v194, 16, v4
v_and_b32 v195, 0xffff0000, v4
v_cvt_pk_bf16_f32 v4, v196, v197
v_lshlrev_b32 v196, 16, v4
v_and_b32 v197, 0xffff0000, v4
v_mul_f32 v196, s66, v196
v_mul_f32 v197, s66, v197
v_cvt_pk_bf16_f32 v4, v196, v197
v_lshlrev_b32 v196, 16, v4
v_and_b32 v197, 0xffff0000, v4
v_cvt_pk_bf16_f32 v4, v198, v199
v_lshlrev_b32 v198, 16, v4
v_and_b32 v199, 0xffff0000, v4
v_mul_f32 v198, s66, v198
v_mul_f32 v199, s66, v199
v_cvt_pk_bf16_f32 v4, v198, v199
v_lshlrev_b32 v198, 16, v4
v_and_b32 v199, 0xffff0000, v4
v_cvt_pk_bf16_f32 v4, v200, v201
v_lshlrev_b32 v200, 16, v4
v_and_b32 v201, 0xffff0000, v4
v_mul_f32 v200, s66, v200
v_mul_f32 v201, s66, v201
v_cvt_pk_bf16_f32 v4, v200, v201
v_lshlrev_b32 v200, 16, v4
v_and_b32 v201, 0xffff0000, v4
v_cvt_pk_bf16_f32 v4, v202, v203
v_lshlrev_b32 v202, 16, v4
v_and_b32 v203, 0xffff0000, v4
v_mul_f32 v202, s66, v202
v_mul_f32 v203, s66, v203
v_cvt_pk_bf16_f32 v4, v202, v203
v_lshlrev_b32 v202, 16, v4
v_and_b32 v203, 0xffff0000, v4
v_cmp_le_i32 vcc, 0, v132
s_nop 1
v_cndmask_b32 v184, v133, v184, vcc
v_cmp_le_i32 vcc, 1, v132
s_nop 1
v_cndmask_b32 v185, v133, v185, vcc
v_cmp_le_i32 vcc, 2, v132
s_nop 1
v_cndmask_b32 v186, v133, v186, vcc
v_cmp_le_i32 vcc, 3, v132
s_nop 1
v_cndmask_b32 v187, v133, v187, vcc
v_cmp_le_i32 vcc, 0, v132
s_nop 1
v_cndmask_b32 v196, v133, v196, vcc
v_cmp_le_i32 vcc, 1, v132
s_nop 1
v_cndmask_b32 v197, v133, v197, vcc
v_cmp_le_i32 vcc, 2, v132
s_nop 1
v_cndmask_b32 v198, v133, v198, vcc
v_cmp_le_i32 vcc, 3, v132
s_nop 1
v_cndmask_b32 v199, v133, v199, vcc
s_mov_b32 s78, 0
s_mov_b32 s79, -1
s_mov_b64 exec, s[78:79]
v_mov_b32 v188, v133
v_mov_b32 v189, v133
v_mov_b32 v190, v133
v_mov_b32 v191, v133
v_mov_b32 v200, v133
v_mov_b32 v201, v133
v_mov_b32 v202, v133
v_mov_b32 v203, v133
s_mov_b64 exec, -1
v_max3_f32 v4, v184, v185, v186
v_max3_f32 v4, v4, v187, v188
v_max3_f32 v4, v4, v189, v190
v_max_f32 v4, v4, v191
v_mov_b32 v5, v4
s_nop 1
v_permlane32_swap_b32 v4, v5
v_max_f32 v4, v4, v5
v_mov_b32 v5, v4
s_nop 1
v_permlane16_swap_b32 v4, v5
v_max_f32 v4, v4, v5
v_sub_f32 v184, v184, v4
v_mul_f32 v184, s67, v184
v_exp_f32 v184, v184
v_sub_f32 v185, v185, v4
v_mul_f32 v185, s67, v185
v_exp_f32 v185, v185
v_sub_f32 v186, v186, v4
v_mul_f32 v186, s67, v186
v_exp_f32 v186, v186
v_sub_f32 v187, v187, v4
v_mul_f32 v187, s67, v187
v_exp_f32 v187, v187
v_sub_f32 v188, v188, v4
v_mul_f32 v188, s67, v188
v_exp_f32 v188, v188
v_sub_f32 v189, v189, v4
v_mul_f32 v189, s67, v189
v_exp_f32 v189, v189
v_sub_f32 v190, v190, v4
v_mul_f32 v190, s67, v190
v_exp_f32 v190, v190
v_sub_f32 v191, v191, v4
v_mul_f32 v191, s67, v191
v_exp_f32 v191, v191
v_add_f32 v4, v184, v185
v_add_f32 v4, v4, v186
v_add_f32 v4, v4, v187
v_add_f32 v4, v4, v188
v_add_f32 v4, v4, v189
v_add_f32 v4, v4, v190
v_add_f32 v4, v4, v191
v_mov_b32 v5, v4
s_nop 1
v_permlane32_swap_b32 v4, v5
v_add_f32 v4, v4, v5
v_mov_b32 v5, v4
s_nop 1
v_permlane16_swap_b32 v4, v5
v_add_f32 v4, v4, v5
v_rcp_f32 v4, v4
s_nop 0
v_mul_f32 v184, v184, v4
v_mul_f32 v185, v185, v4
v_mul_f32 v186, v186, v4
v_mul_f32 v187, v187, v4
v_mul_f32 v188, v188, v4
v_mul_f32 v189, v189, v4
v_mul_f32 v190, v190, v4
v_mul_f32 v191, v191, v4
v_max3_f32 v4, v192, v193, v194
v_max3_f32 v4, v4, v195, v196
v_max3_f32 v4, v4, v197, v198
v_max3_f32 v4, v4, v199, v200
v_max3_f32 v4, v4, v201, v202
v_max_f32 v4, v4, v203
v_mov_b32 v5, v4
s_nop 1
v_permlane32_swap_b32 v4, v5
v_max_f32 v4, v4, v5
v_mov_b32 v5, v4
s_nop 1
v_permlane16_swap_b32 v4, v5
v_max_f32 v4, v4, v5
v_sub_f32 v192, v192, v4
v_mul_f32 v192, s67, v192
v_exp_f32 v192, v192
v_sub_f32 v193, v193, v4
v_mul_f32 v193, s67, v193
v_exp_f32 v193, v193
v_sub_f32 v194, v194, v4
v_mul_f32 v194, s67, v194
v_exp_f32 v194, v194
v_sub_f32 v195, v195, v4
v_mul_f32 v195, s67, v195
v_exp_f32 v195, v195
v_sub_f32 v196, v196, v4
v_mul_f32 v196, s67, v196
v_exp_f32 v196, v196
v_sub_f32 v197, v197, v4
v_mul_f32 v197, s67, v197
v_exp_f32 v197, v197
v_sub_f32 v198, v198, v4
v_mul_f32 v198, s67, v198
v_exp_f32 v198, v198
v_sub_f32 v199, v199, v4
v_mul_f32 v199, s67, v199
v_exp_f32 v199, v199
v_sub_f32 v200, v200, v4
v_mul_f32 v200, s67, v200
v_exp_f32 v200, v200
v_sub_f32 v201, v201, v4
v_mul_f32 v201, s67, v201
v_exp_f32 v201, v201
v_sub_f32 v202, v202, v4
v_mul_f32 v202, s67, v202
v_exp_f32 v202, v202
v_sub_f32 v203, v203, v4
v_mul_f32 v203, s67, v203
v_exp_f32 v203, v203
v_add_f32 v4, v192, v193
v_add_f32 v4, v4, v194
v_add_f32 v4, v4, v195
v_add_f32 v4, v4, v196
v_add_f32 v4, v4, v197
v_add_f32 v4, v4, v198
v_add_f32 v4, v4, v199
v_add_f32 v4, v4, v200
v_add_f32 v4, v4, v201
v_add_f32 v4, v4, v202
v_add_f32 v4, v4, v203
v_mov_b32 v5, v4
s_nop 1
v_permlane32_swap_b32 v4, v5
v_add_f32 v4, v4, v5
v_mov_b32 v5, v4
s_nop 1
v_permlane16_swap_b32 v4, v5
v_add_f32 v4, v4, v5
v_rcp_f32 v4, v4
s_nop 0
v_mul_f32 v192, v192, v4
v_mul_f32 v193, v193, v4
v_mul_f32 v194, v194, v4
v_mul_f32 v195, v195, v4
v_mul_f32 v196, v196, v4
v_mul_f32 v197, v197, v4
v_mul_f32 v198, v198, v4
v_mul_f32 v199, v199, v4
v_mul_f32 v200, v200, v4
v_mul_f32 v201, v201, v4
v_mul_f32 v202, v202, v4
v_mul_f32 v203, v203, v4
v_cvt_pk_bf16_f32 v204, v184, v185
v_cvt_pk_bf16_f32 v205, v186, v187
v_mov_b32 v206, 0
v_mov_b32 v207, 0
v_cvt_pk_bf16_f32 v208, v188, v189
v_cvt_pk_bf16_f32 v209, v190, v191
v_cvt_pk_bf16_f32 v212, v192, v193
v_cvt_pk_bf16_f32 v213, v194, v195
v_cvt_pk_bf16_f32 v214, v196, v197
v_cvt_pk_bf16_f32 v215, v198, v199
v_cvt_pk_bf16_f32 v210, v200, v201
v_cvt_pk_bf16_f32 v211, v202, v203
s_mul_i32 s40, s52, 3145728
s_and_b32 s41, s77, 7
s_lshl_b32 s41, s41, 11
s_add_u32 s40, s40, s41
s_mul_i32 s41, s59, 98304
s_add_u32 s40, s40, s41
s_add_u32 s40, s40, 100347904
v_mfma_f32_16x16x32_bf16 v[184:187], a[48:51], v[204:207], 0
v_mfma_f32_16x16x32_bf16 v[188:191], a[52:55], v[204:207], 0
v_mfma_f32_16x16x16_bf16 v[184:187], v[160:161], v[208:209], v[184:187]
v_mfma_f32_16x16x16_bf16 v[188:191], v[162:163], v[208:209], v[188:191]
s_nop 6
v_cvt_pk_bf16_f32 v216, v184, v185
v_cvt_pk_bf16_f32 v217, v186, v187
v_cvt_pk_bf16_f32 v218, v188, v189
v_cvt_pk_bf16_f32 v219, v190, v191
s_add_u32 s41, s40, 0
buffer_store_dwordx4 v[216:219], v131, s[20:23], s41 offen
v_mfma_f32_16x16x32_bf16 v[192:195], a[56:59], v[204:207], 0
v_mfma_f32_16x16x32_bf16 v[196:199], a[60:63], v[204:207], 0
v_mfma_f32_16x16x16_bf16 v[192:195], v[164:165], v[208:209], v[192:195]
v_mfma_f32_16x16x16_bf16 v[196:199], v[166:167], v[208:209], v[196:199]
s_nop 6
v_cvt_pk_bf16_f32 v220, v192, v193
v_cvt_pk_bf16_f32 v221, v194, v195
v_cvt_pk_bf16_f32 v222, v196, v197
v_cvt_pk_bf16_f32 v223, v198, v199
s_add_u32 s41, s40, 16384
buffer_store_dwordx4 v[220:223], v131, s[20:23], s41 offen
v_mfma_f32_16x16x32_bf16 v[184:187], a[64:67], v[204:207], 0
v_mfma_f32_16x16x32_bf16 v[188:191], a[68:71], v[204:207], 0
v_mfma_f32_16x16x16_bf16 v[184:187], v[168:169], v[208:209], v[184:187]
v_mfma_f32_16x16x16_bf16 v[188:191], v[170:171], v[208:209], v[188:191]
s_nop 6
v_cvt_pk_bf16_f32 v216, v184, v185
v_cvt_pk_bf16_f32 v217, v186, v187
v_cvt_pk_bf16_f32 v218, v188, v189
v_cvt_pk_bf16_f32 v219, v190, v191
s_add_u32 s41, s40, 32768
buffer_store_dwordx4 v[216:219], v131, s[20:23], s41 offen
v_mfma_f32_16x16x32_bf16 v[192:195], a[72:75], v[204:207], 0
v_mfma_f32_16x16x32_bf16 v[196:199], a[76:79], v[204:207], 0
v_mfma_f32_16x16x16_bf16 v[192:195], v[172:173], v[208:209], v[192:195]
v_mfma_f32_16x16x16_bf16 v[196:199], v[174:175], v[208:209], v[196:199]
s_nop 6
v_cvt_pk_bf16_f32 v220, v192, v193
v_cvt_pk_bf16_f32 v221, v194, v195
v_cvt_pk_bf16_f32 v222, v196, v197
v_cvt_pk_bf16_f32 v223, v198, v199
s_add_u32 s41, s40, 49152
buffer_store_dwordx4 v[220:223], v131, s[20:23], s41 offen
v_mfma_f32_16x16x32_bf16 v[184:187], a[80:83], v[204:207], 0
v_mfma_f32_16x16x32_bf16 v[188:191], a[84:87], v[204:207], 0
v_mfma_f32_16x16x16_bf16 v[184:187], v[176:177], v[208:209], v[184:187]
v_mfma_f32_16x16x16_bf16 v[188:191], v[178:179], v[208:209], v[188:191]
s_nop 6
v_cvt_pk_bf16_f32 v216, v184, v185
v_cvt_pk_bf16_f32 v217, v186, v187
v_cvt_pk_bf16_f32 v218, v188, v189
v_cvt_pk_bf16_f32 v219, v190, v191
s_add_u32 s41, s40, 65536
buffer_store_dwordx4 v[216:219], v131, s[20:23], s41 offen
v_mfma_f32_16x16x32_bf16 v[192:195], a[88:91], v[204:207], 0
v_mfma_f32_16x16x32_bf16 v[196:199], a[92:95], v[204:207], 0
v_mfma_f32_16x16x16_bf16 v[192:195], v[180:181], v[208:209], v[192:195]
v_mfma_f32_16x16x16_bf16 v[196:199], v[182:183], v[208:209], v[196:199]
s_nop 6
v_cvt_pk_bf16_f32 v220, v192, v193
v_cvt_pk_bf16_f32 v221, v194, v195
v_cvt_pk_bf16_f32 v222, v196, v197
v_cvt_pk_bf16_f32 v223, v198, v199
s_add_u32 s41, s40, 81920
buffer_store_dwordx4 v[220:223], v131, s[20:23], s41 offen
v_mfma_f32_16x16x32_bf16 v[184:187], a[48:51], v[212:215], 0
v_mfma_f32_16x16x32_bf16 v[188:191], a[52:55], v[212:215], 0
v_mfma_f32_16x16x16_bf16 v[184:187], v[160:161], v[210:211], v[184:187]
v_mfma_f32_16x16x16_bf16 v[188:191], v[162:163], v[210:211], v[188:191]
s_nop 6
v_cvt_pk_bf16_f32 v216, v184, v185
v_cvt_pk_bf16_f32 v217, v186, v187
v_cvt_pk_bf16_f32 v218, v188, v189
v_cvt_pk_bf16_f32 v219, v190, v191
s_add_u32 s41, s40, 1024
buffer_store_dwordx4 v[216:219], v131, s[20:23], s41 offen
v_mfma_f32_16x16x32_bf16 v[192:195], a[56:59], v[212:215], 0
v_mfma_f32_16x16x32_bf16 v[196:199], a[60:63], v[212:215], 0
v_mfma_f32_16x16x16_bf16 v[192:195], v[164:165], v[210:211], v[192:195]
v_mfma_f32_16x16x16_bf16 v[196:199], v[166:167], v[210:211], v[196:199]
s_nop 6
v_cvt_pk_bf16_f32 v220, v192, v193
v_cvt_pk_bf16_f32 v221, v194, v195
v_cvt_pk_bf16_f32 v222, v196, v197
v_cvt_pk_bf16_f32 v223, v198, v199
s_add_u32 s41, s40, 17408
buffer_store_dwordx4 v[220:223], v131, s[20:23], s41 offen
v_mfma_f32_16x16x32_bf16 v[184:187], a[64:67], v[212:215], 0
v_mfma_f32_16x16x32_bf16 v[188:191], a[68:71], v[212:215], 0
v_mfma_f32_16x16x16_bf16 v[184:187], v[168:169], v[210:211], v[184:187]
v_mfma_f32_16x16x16_bf16 v[188:191], v[170:171], v[210:211], v[188:191]
s_nop 6
v_cvt_pk_bf16_f32 v216, v184, v185
v_cvt_pk_bf16_f32 v217, v186, v187
v_cvt_pk_bf16_f32 v218, v188, v189
v_cvt_pk_bf16_f32 v219, v190, v191
s_add_u32 s41, s40, 33792
buffer_store_dwordx4 v[216:219], v131, s[20:23], s41 offen
v_mfma_f32_16x16x32_bf16 v[192:195], a[72:75], v[212:215], 0
v_mfma_f32_16x16x32_bf16 v[196:199], a[76:79], v[212:215], 0
v_mfma_f32_16x16x16_bf16 v[192:195], v[172:173], v[210:211], v[192:195]
v_mfma_f32_16x16x16_bf16 v[196:199], v[174:175], v[210:211], v[196:199]
s_nop 6
v_cvt_pk_bf16_f32 v220, v192, v193
v_cvt_pk_bf16_f32 v221, v194, v195
v_cvt_pk_bf16_f32 v222, v196, v197
v_cvt_pk_bf16_f32 v223, v198, v199
s_add_u32 s41, s40, 50176
buffer_store_dwordx4 v[220:223], v131, s[20:23], s41 offen
v_mfma_f32_16x16x32_bf16 v[184:187], a[80:83], v[212:215], 0
v_mfma_f32_16x16x32_bf16 v[188:191], a[84:87], v[212:215], 0
v_mfma_f32_16x16x16_bf16 v[184:187], v[176:177], v[210:211], v[184:187]
v_mfma_f32_16x16x16_bf16 v[188:191], v[178:179], v[210:211], v[188:191]
s_nop 6
v_cvt_pk_bf16_f32 v216, v184, v185
v_cvt_pk_bf16_f32 v217, v186, v187
v_cvt_pk_bf16_f32 v218, v188, v189
v_cvt_pk_bf16_f32 v219, v190, v191
s_add_u32 s41, s40, 66560
buffer_store_dwordx4 v[216:219], v131, s[20:23], s41 offen
v_mfma_f32_16x16x32_bf16 v[192:195], a[88:91], v[212:215], 0
v_mfma_f32_16x16x32_bf16 v[196:199], a[92:95], v[212:215], 0
v_mfma_f32_16x16x16_bf16 v[192:195], v[180:181], v[210:211], v[192:195]
v_mfma_f32_16x16x16_bf16 v[196:199], v[182:183], v[210:211], v[196:199]
s_nop 6
v_cvt_pk_bf16_f32 v220, v192, v193
v_cvt_pk_bf16_f32 v221, v194, v195
v_cvt_pk_bf16_f32 v222, v196, v197
v_cvt_pk_bf16_f32 v223, v198, v199
s_add_u32 s41, s40, 82944
buffer_store_dwordx4 v[220:223], v131, s[20:23], s41 offen
s_lshl_b32 s60, s29, 3
s_add_u32 s60, s60, s52
s_lshl_b32 s60, s60, 6
s_add_u32 s60, s60, 178475008
s_lshl_b32 s61, s65, 2
s_add_u32 s60, s60, s61
s_waitcnt vmcnt(0)
s_barrier
s_cmp_lg_u32 s28, 0
s_cbranch_scc1 L_sigf_16_A
s_mov_b64 exec, 1
v_lshlrev_b32 v17, 5, v1
v_add_u32 v17, s60, v17
buffer_store_dword v16, v17, s[20:23], 0 offen
s_mov_b64 exec, -1
L_sigf_16_A:
s_cmp_eq_u32 s98, 0
s_cbranch_scc1 L_b_next_A
L_b_g2_A:
s_and_b32 s51, s65, 3
s_lshr_b32 s97, s65, 2
s_mov_b32 s34, 7864320
s_mov_b32 s35, 0x00020000
s_mov_b32 s56, 1280
s_mov_b32 s57, 40960
s_mov_b32 s62, 6
s_cmp_eq_u32 s99, 1
s_cbranch_scc1 L_g2_b_A
s_cmp_eq_u32 s97, 3
s_cbranch_scc1 L_b_final_A
s_lshl_b32 s60, s29, 3
s_add_u32 s60, s60, s52
s_lshl_b32 s60, s60, 6
s_add_u32 s60, s60, 178475008
s_cmp_lg_u32 s28, 0
s_cbranch_scc1 L_wf_17x_A
v_min_u32 v17, 7, v1
v_lshlrev_b32 v17, 2, v17
s_nop 1
L_wf_17_A:
buffer_load_dword v18, v17, s[20:23], s60 offen sc1
s_waitcnt vmcnt(0)
v_cmp_eq_u32 vcc, 0, v18
s_add_u32 s64, s64, 1
s_cmp_gt_u32 s64, 2000000
s_cbranch_scc1 L_w_done_A
s_cbranch_vccz L_wf_17x_A
s_cmp_eq_u32 s98, 1
s_cbranch_scc1 L_sl_18_A
s_sleep 40
L_sl_18_A:
s_sleep 4
s_branch L_wf_17_A
L_wf_17x_A:
s_barrier
s_mov_b32 s32, s14
s_mov_b32 s33, s15
s_mov_b32 s55, 12544
s_mul_i32 s61, s29, 768
s_lshl_b32 s60, s97, 8
s_add_u32 s61, s61, s60
s_mul_i32 s53, s52, 3145728
s_lshl_b32 s60, s61, 9
s_add_u32 s53, s53, s60
s_add_u32 s53, s53, 100347904
s_mul_i32 s54, s61, 1280
s_mul_i32 s96, s29, 5242880
s_mul_i32 s60, s52, 655360
s_add_u32 s96, s96, s60
s_add_u32 s96, s96, 126038016
s_mul_i32 s60, s29, 3
s_add_u32 s60, s60, s97
s_mul_i32 s60, s60, 655360
s_add_u32 s60, s60, 178614272
s_cmp_eq_u32 s98, 1
s_cselect_b32 s96, s60, s96
s_cselect_b32 s62, 2, s62
s_branch L_g2_c_A
L_g2_b_A:
s_lshl_b32 s60, s52, 6
s_add_u32 s60, s60, 178479104
s_cmp_lg_u32 s28, 0
s_cbranch_scc1 L_wc_19x_A
v_mov_b32 v17, s60
s_nop 1
L_wc_19_A:
buffer_load_dword v18, v17, s[20:23], 0 offen sc1
s_waitcnt vmcnt(0)
v_readfirstlane_b32 s41, v18
s_add_u32 s64, s64, 1
s_cmp_gt_u32 s64, 2000000
s_cbranch_scc1 L_w_done_A
s_cmp_ge_u32 s41, 8
s_cbranch_scc1 L_wc_19x_A
s_cmp_eq_u32 s98, 1
s_cbranch_scc1 L_sl_20_A
s_sleep 40
L_sl_20_A:
s_sleep 4
s_branch L_wc_19_A
L_wc_19x_A:
s_barrier
s_mov_b32 s32, s68
s_mov_b32 s33, s69
s_mov_b32 s34, 1966080
s_mov_b32 s55, 3328
s_mul_i32 s61, s97, 768
s_mul_i32 s53, s52, 786432
s_lshl_b32 s60, s61, 9
s_add_u32 s53, s53, s60
s_add_u32 s53, s53, 93532160
s_mul_i32 s54, s61, 1280
s_add_u32 s60, s97, 8
s_mul_i32 s96, s60, 5242880
s_mul_i32 s60, s52, 655360
s_add_u32 s96, s96, s60
s_add_u32 s96, s96, 126038016
L_g2_c_A:
s_mul_i32 s60, s51, 320
s_add_u32 s54, s54, s60
s_mul_i32 s40, s28, 4096
s_add_u32 s40, s40, 0
v_lshlrev_b32 v4, 4, v1
v_add_u32 v21, s40, v4
s_mul_i32 s40, s28, 4096
s_add_u32 s40, s40, 1024
v_lshlrev_b32 v4, 4, v1
v_add_u32 v22, s40, v4
s_mul_i32 s40, s28, 4096
s_add_u32 s40, s40, 2048
v_lshlrev_b32 v4, 4, v1
v_add_u32 v23, s40, v4
s_mul_i32 s40, s28, 4096
s_add_u32 s40, s40, 3072
v_lshlrev_b32 v4, 4, v1
v_add_u32 v24, s40, v4
v_mul_lo_u32 v4, v25, s56
v_add_u32 v31, v4, v28
v_mul_lo_u32 v4, v26, s56
v_add_u32 v32, v4, v29
v_mul_lo_u32 v4, v27, s56
v_add_u32 v33, v4, v30
s_barrier
s_add_u32 m0, s45, 0
s_nop 0
buffer_load_dwordx4 v21, s[20:23], s53 offen sc1 lds
s_add_u32 m0, s45, 1024
s_nop 0
buffer_load_dwordx4 v22, s[20:23], s53 offen sc1 lds
s_add_u32 m0, s45, 2048
s_nop 0
buffer_load_dwordx4 v23, s[20:23], s53 offen sc1 lds
s_add_u32 m0, s45, 3072
s_nop 0
buffer_load_dwordx4 v24, s[20:23], s53 offen sc1 lds
s_add_u32 m0, s46, 0
s_nop 0
buffer_load_dwordx4 v31, s[32:35], s54 offen lds
s_add_u32 m0, s46, 1024
s_nop 0
buffer_load_dwordx4 v32, s[32:35], s54 offen lds
s_add_u32 m0, s46, 2048
s_nop 0
buffer_load_dwordx4 v33, s[32:35], s54 offen lds
s_add_u32 s53, s53, 16384
s_add_u32 s54, s54, s57
s_add_u32 m0, s45, 28672
s_nop 0
buffer_load_dwordx4 v21, s[20:23], s53 offen sc1 lds
s_add_u32 m0, s45, 29696
s_nop 0
buffer_load_dwordx4 v22, s[20:23], s53 offen sc1 lds
s_add_u32 m0, s45, 30720
s_nop 0
buffer_load_dwordx4 v23, s[20:23], s53 offen sc1 lds
s_add_u32 m0, s45, 31744
s_nop 0
buffer_load_dwordx4 v24, s[20:23], s53 offen sc1 lds
s_add_u32 m0, s46, 28672
s_nop 0
buffer_load_dwordx4 v31, s[32:35], s54 offen lds
s_add_u32 m0, s46, 29696
s_nop 0
buffer_load_dwordx4 v32, s[32:35], s54 offen lds
s_add_u32 m0, s46, 30720
s_nop 0
buffer_load_dwordx4 v33, s[32:35], s54 offen lds
s_add_u32 s53, s53, 16384
s_add_u32 s54, s54, s57
s_add_u32 m0, s45, 57344
s_nop 0
buffer_load_dwordx4 v21, s[20:23], s53 offen sc1 lds
s_add_u32 m0, s45, 58368
s_nop 0
buffer_load_dwordx4 v22, s[20:23], s53 offen sc1 lds
s_add_u32 m0, s45, 59392
s_nop 0
buffer_load_dwordx4 v23, s[20:23], s53 offen sc1 lds
s_add_u32 m0, s45, 60416
s_nop 0
buffer_load_dwordx4 v24, s[20:23], s53 offen sc1 lds
s_add_u32 m0, s46, 57344
s_nop 0
buffer_load_dwordx4 v31, s[32:35], s54 offen lds
s_add_u32 m0, s46, 58368
s_nop 0
buffer_load_dwordx4 v32, s[32:35], s54 offen lds
s_add_u32 m0, s46, 59392
s_nop 0
buffer_load_dwordx4 v33, s[32:35], s54 offen lds
s_add_u32 s53, s53, 16384
s_add_u32 s54, s54, s57
s_add_u32 m0, s45, 86016
s_nop 0
buffer_load_dwordx4 v21, s[20:23], s53 offen sc1 lds
s_add_u32 m0, s45, 87040
s_nop 0
buffer_load_dwordx4 v22, s[20:23], s53 offen sc1 lds
s_add_u32 m0, s45, 88064
s_nop 0
buffer_load_dwordx4 v23, s[20:23], s53 offen sc1 lds
s_add_u32 m0, s45, 89088
s_nop 0
buffer_load_dwordx4 v24, s[20:23], s53 offen sc1 lds
s_add_u32 m0, s46, 86016
s_nop 0
buffer_load_dwordx4 v31, s[32:35], s54 offen lds
s_add_u32 m0, s46, 87040
s_nop 0
buffer_load_dwordx4 v32, s[32:35], s54 offen lds
s_add_u32 m0, s46, 88064
s_nop 0
buffer_load_dwordx4 v33, s[32:35], s54 offen lds
s_add_u32 s53, s53, 16384
s_add_u32 s54, s54, s57
s_waitcnt vmcnt(21)
s_barrier
ds_read_b128 v[44:47], v34 offset:0
ds_read_b128 v[48:51], v34 offset:2048
ds_read_b64_tr_b16 v[60:61], v36 offset:0
ds_read_b64_tr_b16 v[62:63], v37 offset:0
ds_read_b64_tr_b16 v[64:65], v40 offset:0
ds_read_b64_tr_b16 v[66:67], v41 offset:0
ds_read_b64_tr_b16 v[68:69], v36 offset:128
ds_read_b64_tr_b16 v[70:71], v37 offset:128
ds_read_b64_tr_b16 v[72:73], v40 offset:128
ds_read_b64_tr_b16 v[74:75], v41 offset:128
ds_read_b64_tr_b16 v[76:77], v36 offset:256
ds_read_b64_tr_b16 v[78:79], v37 offset:256
s_waitcnt lgkmcnt(0)
v_mfma_f32_32x32x16_bf16 a[0:15], v[60:63], v[44:47], 0
ds_read_b128 v[52:55], v35 offset:0
v_mfma_f32_32x32x16_bf16 a[16:31], v[64:67], v[44:47], 0
ds_read_b128 v[56:59], v35 offset:2048
v_mfma_f32_32x32x16_bf16 a[32:47], v[68:71], v[44:47], 0
ds_read_b64_tr_b16 v[80:81], v38 offset:0
ds_read_b64_tr_b16 v[82:83], v39 offset:0
v_mfma_f32_32x32x16_bf16 a[48:63], v[72:75], v[44:47], 0
ds_read_b64_tr_b16 v[84:85], v42 offset:0
ds_read_b64_tr_b16 v[86:87], v43 offset:0
v_mfma_f32_32x32x16_bf16 a[64:79], v[76:79], v[44:47], 0
ds_read_b64_tr_b16 v[88:89], v38 offset:128
ds_read_b64_tr_b16 v[90:91], v39 offset:128
v_mfma_f32_32x32x16_bf16 a[80:95], v[60:63], v[48:51], 0
ds_read_b64_tr_b16 v[92:93], v42 offset:128
ds_read_b64_tr_b16 v[94:95], v43 offset:128
v_mfma_f32_32x32x16_bf16 a[96:111], v[64:67], v[48:51], 0
ds_read_b64_tr_b16 v[96:97], v38 offset:256
ds_read_b64_tr_b16 v[98:99], v39 offset:256
v_mfma_f32_32x32x16_bf16 a[112:127], v[68:71], v[48:51], 0
v_mfma_f32_32x32x16_bf16 a[128:143], v[72:75], v[48:51], 0
v_mfma_f32_32x32x16_bf16 a[144:159], v[76:79], v[48:51], 0
s_waitcnt lgkmcnt(0)
s_waitcnt vmcnt(14)
s_barrier
v_mfma_f32_32x32x16_bf16 a[0:15], v[80:83], v[52:55], a[0:15]
ds_read_b128 v[44:47], v34 offset:28672
ds_read_b128 v[48:51], v34 offset:30720
v_mfma_f32_32x32x16_bf16 a[16:31], v[84:87], v[52:55], a[16:31]
ds_read_b64_tr_b16 v[60:61], v36 offset:28672
ds_read_b64_tr_b16 v[62:63], v37 offset:28672
ds_read_b64_tr_b16 v[64:65], v40 offset:28672
ds_read_b64_tr_b16 v[66:67], v41 offset:28672
v_mfma_f32_32x32x16_bf16 a[32:47], v[88:91], v[52:55], a[32:47]
ds_read_b64_tr_b16 v[68:69], v36 offset:28800
ds_read_b64_tr_b16 v[70:71], v37 offset:28800
ds_read_b64_tr_b16 v[72:73], v40 offset:28800
ds_read_b64_tr_b16 v[74:75], v41 offset:28800
v_mfma_f32_32x32x16_bf16 a[48:63], v[92:95], v[52:55], a[48:63]
ds_read_b64_tr_b16 v[76:77], v36 offset:28928
ds_read_b64_tr_b16 v[78:79], v37 offset:28928
s_add_u32 m0, s45, 0
s_nop 0
buffer_load_dwordx4 v21, s[20:23], s53 offen sc1 lds
v_mfma_f32_32x32x16_bf16 a[64:79], v[96:99], v[52:55], a[64:79]
s_add_u32 m0, s45, 1024
s_nop 0
buffer_load_dwordx4 v22, s[20:23], s53 offen sc1 lds
s_add_u32 m0, s45, 2048
s_nop 0
buffer_load_dwordx4 v23, s[20:23], s53 offen sc1 lds
v_mfma_f32_32x32x16_bf16 a[80:95], v[80:83], v[56:59], a[80:95]
s_add_u32 m0, s45, 3072
s_nop 0
buffer_load_dwordx4 v24, s[20:23], s53 offen sc1 lds
s_add_u32 m0, s46, 0
s_nop 0
buffer_load_dwordx4 v31, s[32:35], s54 offen lds
v_mfma_f32_32x32x16_bf16 a[96:111], v[84:87], v[56:59], a[96:111]
s_add_u32 m0, s46, 1024
s_nop 0
buffer_load_dwordx4 v32, s[32:35], s54 offen lds
s_add_u32 m0, s46, 2048
s_nop 0
buffer_load_dwordx4 v33, s[32:35], s54 offen lds
s_add_u32 s53, s53, 16384
s_add_u32 s54, s54, s57
v_mfma_f32_32x32x16_bf16 a[112:127], v[88:91], v[56:59], a[112:127]
v_mfma_f32_32x32x16_bf16 a[128:143], v[92:95], v[56:59], a[128:143]
v_mfma_f32_32x32x16_bf16 a[144:159], v[96:99], v[56:59], a[144:159]
s_waitcnt lgkmcnt(0)
v_mfma_f32_32x32x16_bf16 a[0:15], v[60:63], v[44:47], a[0:15]
ds_read_b128 v[52:55], v35 offset:28672
v_mfma_f32_32x32x16_bf16 a[16:31], v[64:67], v[44:47], a[16:31]
ds_read_b128 v[56:59], v35 offset:30720
v_mfma_f32_32x32x16_bf16 a[32:47], v[68:71], v[44:47], a[32:47]
ds_read_b64_tr_b16 v[80:81], v38 offset:28672
ds_read_b64_tr_b16 v[82:83], v39 offset:28672
v_mfma_f32_32x32x16_bf16 a[48:63], v[72:75], v[44:47], a[48:63]
ds_read_b64_tr_b16 v[84:85], v42 offset:28672
ds_read_b64_tr_b16 v[86:87], v43 offset:28672
v_mfma_f32_32x32x16_bf16 a[64:79], v[76:79], v[44:47], a[64:79]
ds_read_b64_tr_b16 v[88:89], v38 offset:28800
ds_read_b64_tr_b16 v[90:91], v39 offset:28800
v_mfma_f32_32x32x16_bf16 a[80:95], v[60:63], v[48:51], a[80:95]
ds_read_b64_tr_b16 v[92:93], v42 offset:28800
ds_read_b64_tr_b16 v[94:95], v43 offset:28800
v_mfma_f32_32x32x16_bf16 a[96:111], v[64:67], v[48:51], a[96:111]
ds_read_b64_tr_b16 v[96:97], v38 offset:28928
ds_read_b64_tr_b16 v[98:99], v39 offset:28928
v_mfma_f32_32x32x16_bf16 a[112:127], v[68:71], v[48:51], a[112:127]
v_mfma_f32_32x32x16_bf16 a[128:143], v[72:75], v[48:51], a[128:143]
v_mfma_f32_32x32x16_bf16 a[144:159], v[76:79], v[48:51], a[144:159]
s_waitcnt lgkmcnt(0)
s_waitcnt vmcnt(14)
s_barrier
v_mfma_f32_32x32x16_bf16 a[0:15], v[80:83], v[52:55], a[0:15]
ds_read_b128 v[44:47], v100 offset:0
ds_read_b128 v[48:51], v100 offset:2048
v_mfma_f32_32x32x16_bf16 a[16:31], v[84:87], v[52:55], a[16:31]
ds_read_b64_tr_b16 v[60:61], v102 offset:0
ds_read_b64_tr_b16 v[62:63], v103 offset:0
ds_read_b64_tr_b16 v[64:65], v106 offset:0
ds_read_b64_tr_b16 v[66:67], v107 offset:0
v_mfma_f32_32x32x16_bf16 a[32:47], v[88:91], v[52:55], a[32:47]
ds_read_b64_tr_b16 v[68:69], v102 offset:128
ds_read_b64_tr_b16 v[70:71], v103 offset:128
ds_read_b64_tr_b16 v[72:73], v106 offset:128
ds_read_b64_tr_b16 v[74:75], v107 offset:128
v_mfma_f32_32x32x16_bf16 a[48:63], v[92:95], v[52:55], a[48:63]
ds_read_b64_tr_b16 v[76:77], v102 offset:256
ds_read_b64_tr_b16 v[78:79], v103 offset:256
s_add_u32 m0, s45, 28672
s_nop 0
buffer_load_dwordx4 v21, s[20:23], s53 offen sc1 lds
v_mfma_f32_32x32x16_bf16 a[64:79], v[96:99], v[52:55], a[64:79]
s_add_u32 m0, s45, 29696
s_nop 0
buffer_load_dwordx4 v22, s[20:23], s53 offen sc1 lds
s_add_u32 m0, s45, 30720
s_nop 0
buffer_load_dwordx4 v23, s[20:23], s53 offen sc1 lds
v_mfma_f32_32x32x16_bf16 a[80:95], v[80:83], v[56:59], a[80:95]
s_add_u32 m0, s45, 31744
s_nop 0
buffer_load_dwordx4 v24, s[20:23], s53 offen sc1 lds
s_add_u32 m0, s46, 28672
s_nop 0
buffer_load_dwordx4 v31, s[32:35], s54 offen lds
v_mfma_f32_32x32x16_bf16 a[96:111], v[84:87], v[56:59], a[96:111]
s_add_u32 m0, s46, 29696
s_nop 0
buffer_load_dwordx4 v32, s[32:35], s54 offen lds
s_add_u32 m0, s46, 30720
s_nop 0
buffer_load_dwordx4 v33, s[32:35], s54 offen lds
s_add_u32 s53, s53, 16384
s_add_u32 s54, s54, s57
v_mfma_f32_32x32x16_bf16 a[112:127], v[88:91], v[56:59], a[112:127]
v_mfma_f32_32x32x16_bf16 a[128:143], v[92:95], v[56:59], a[128:143]
v_mfma_f32_32x32x16_bf16 a[144:159], v[96:99], v[56:59], a[144:159]
s_waitcnt lgkmcnt(0)
v_mfma_f32_32x32x16_bf16 a[0:15], v[60:63], v[44:47], a[0:15]
ds_read_b128 v[52:55], v101 offset:0
v_mfma_f32_32x32x16_bf16 a[16:31], v[64:67], v[44:47], a[16:31]
ds_read_b128 v[56:59], v101 offset:2048
v_mfma_f32_32x32x16_bf16 a[32:47], v[68:71], v[44:47], a[32:47]
ds_read_b64_tr_b16 v[80:81], v104 offset:0
ds_read_b64_tr_b16 v[82:83], v105 offset:0
v_mfma_f32_32x32x16_bf16 a[48:63], v[72:75], v[44:47], a[48:63]
ds_read_b64_tr_b16 v[84:85], v108 offset:0
ds_read_b64_tr_b16 v[86:87], v109 offset:0
v_mfma_f32_32x32x16_bf16 a[64:79], v[76:79], v[44:47], a[64:79]
ds_read_b64_tr_b16 v[88:89], v104 offset:128
ds_read_b64_tr_b16 v[90:91], v105 offset:128
v_mfma_f32_32x32x16_bf16 a[80:95], v[60:63], v[48:51], a[80:95]
ds_read_b64_tr_b16 v[92:93], v108 offset:128
ds_read_b64_tr_b16 v[94:95], v109 offset:128
v_mfma_f32_32x32x16_bf16 a[96:111], v[64:67], v[48:51], a[96:111]
ds_read_b64_tr_b16 v[96:97], v104 offset:256
ds_read_b64_tr_b16 v[98:99], v105 offset:256
v_mfma_f32_32x32x16_bf16 a[112:127], v[68:71], v[48:51], a[112:127]
v_mfma_f32_32x32x16_bf16 a[128:143], v[72:75], v[48:51], a[128:143]
v_mfma_f32_32x32x16_bf16 a[144:159], v[76:79], v[48:51], a[144:159]
s_waitcnt lgkmcnt(0)
s_waitcnt vmcnt(14)
s_barrier
v_mfma_f32_32x32x16_bf16 a[0:15], v[80:83], v[52:55], a[0:15]
ds_read_b128 v[44:47], v100 offset:28672
ds_read_b128 v[48:51], v100 offset:30720
v_mfma_f32_32x32x16_bf16 a[16:31], v[84:87], v[52:55], a[16:31]
ds_read_b64_tr_b16 v[60:61], v102 offset:28672
ds_read_b64_tr_b16 v[62:63], v103 offset:28672
ds_read_b64_tr_b16 v[64:65], v106 offset:28672
ds_read_b64_tr_b16 v[66:67], v107 offset:28672
v_mfma_f32_32x32x16_bf16 a[32:47], v[88:91], v[52:55], a[32:47]
ds_read_b64_tr_b16 v[68:69], v102 offset:28800
ds_read_b64_tr_b16 v[70:71], v103 offset:28800
ds_read_b64_tr_b16 v[72:73], v106 offset:28800
ds_read_b64_tr_b16 v[74:75], v107 offset:28800
v_mfma_f32_32x32x16_bf16 a[48:63], v[92:95], v[52:55], a[48:63]
ds_read_b64_tr_b16 v[76:77], v102 offset:28928
ds_read_b64_tr_b16 v[78:79], v103 offset:28928
s_add_u32 m0, s45, 57344
s_nop 0
buffer_load_dwordx4 v21, s[20:23], s53 offen sc1 lds
v_mfma_f32_32x32x16_bf16 a[64:79], v[96:99], v[52:55], a[64:79]
s_add_u32 m0, s45, 58368
s_nop 0
buffer_load_dwordx4 v22, s[20:23], s53 offen sc1 lds
s_add_u32 m0, s45, 59392
s_nop 0
buffer_load_dwordx4 v23, s[20:23], s53 offen sc1 lds
v_mfma_f32_32x32x16_bf16 a[80:95], v[80:83], v[56:59], a[80:95]
s_add_u32 m0, s45, 60416
s_nop 0
buffer_load_dwordx4 v24, s[20:23], s53 offen sc1 lds
s_add_u32 m0, s46, 57344
s_nop 0
buffer_load_dwordx4 v31, s[32:35], s54 offen lds
v_mfma_f32_32x32x16_bf16 a[96:111], v[84:87], v[56:59], a[96:111]
s_add_u32 m0, s46, 58368
s_nop 0
buffer_load_dwordx4 v32, s[32:35], s54 offen lds
s_add_u32 m0, s46, 59392
s_nop 0
buffer_load_dwordx4 v33, s[32:35], s54 offen lds
s_add_u32 s53, s53, 16384
s_add_u32 s54, s54, s57
v_mfma_f32_32x32x16_bf16 a[112:127], v[88:91], v[56:59], a[112:127]
v_mfma_f32_32x32x16_bf16 a[128:143], v[92:95], v[56:59], a[128:143]
v_mfma_f32_32x32x16_bf16 a[144:159], v[96:99], v[56:59], a[144:159]
s_waitcnt lgkmcnt(0)
v_mfma_f32_32x32x16_bf16 a[0:15], v[60:63], v[44:47], a[0:15]
ds_read_b128 v[52:55], v101 offset:28672
v_mfma_f32_32x32x16_bf16 a[16:31], v[64:67], v[44:47], a[16:31]
ds_read_b128 v[56:59], v101 offset:30720
v_mfma_f32_32x32x16_bf16 a[32:47], v[68:71], v[44:47], a[32:47]
ds_read_b64_tr_b16 v[80:81], v104 offset:28672
ds_read_b64_tr_b16 v[82:83], v105 offset:28672
v_mfma_f32_32x32x16_bf16 a[48:63], v[72:75], v[44:47], a[48:63]
ds_read_b64_tr_b16 v[84:85], v108 offset:28672
ds_read_b64_tr_b16 v[86:87], v109 offset:28672
v_mfma_f32_32x32x16_bf16 a[64:79], v[76:79], v[44:47], a[64:79]
ds_read_b64_tr_b16 v[88:89], v104 offset:28800
ds_read_b64_tr_b16 v[90:91], v105 offset:28800
v_mfma_f32_32x32x16_bf16 a[80:95], v[60:63], v[48:51], a[80:95]
ds_read_b64_tr_b16 v[92:93], v108 offset:28800
ds_read_b64_tr_b16 v[94:95], v109 offset:28800
v_mfma_f32_32x32x16_bf16 a[96:111], v[64:67], v[48:51], a[96:111]
ds_read_b64_tr_b16 v[96:97], v104 offset:28928
ds_read_b64_tr_b16 v[98:99], v105 offset:28928
v_mfma_f32_32x32x16_bf16 a[112:127], v[68:71], v[48:51], a[112:127]
v_mfma_f32_32x32x16_bf16 a[128:143], v[72:75], v[48:51], a[128:143]
v_mfma_f32_32x32x16_bf16 a[144:159], v[76:79], v[48:51], a[144:159]
s_waitcnt lgkmcnt(0)
s_waitcnt vmcnt(14)
s_barrier
v_mfma_f32_32x32x16_bf16 a[0:15], v[80:83], v[52:55], a[0:15]
ds_read_b128 v[44:47], v34 offset:0
ds_read_b128 v[48:51], v34 offset:2048
v_mfma_f32_32x32x16_bf16 a[16:31], v[84:87], v[52:55], a[16:31]
ds_read_b64_tr_b16 v[60:61], v36 offset:0
ds_read_b64_tr_b16 v[62:63], v37 offset:0
ds_read_b64_tr_b16 v[64:65], v40 offset:0
ds_read_b64_tr_b16 v[66:67], v41 offset:0
v_mfma_f32_32x32x16_bf16 a[32:47], v[88:91], v[52:55], a[32:47]
ds_read_b64_tr_b16 v[68:69], v36 offset:128
ds_read_b64_tr_b16 v[70:71], v37 offset:128
ds_read_b64_tr_b16 v[72:73], v40 offset:128
ds_read_b64_tr_b16 v[74:75], v41 offset:128
v_mfma_f32_32x32x16_bf16 a[48:63], v[92:95], v[52:55], a[48:63]
ds_read_b64_tr_b16 v[76:77], v36 offset:256
ds_read_b64_tr_b16 v[78:79], v37 offset:256
s_add_u32 m0, s45, 86016
s_nop 0
buffer_load_dwordx4 v21, s[20:23], s53 offen sc1 lds
v_mfma_f32_32x32x16_bf16 a[64:79], v[96:99], v[52:55], a[64:79]
s_add_u32 m0, s45, 87040
s_nop 0
buffer_load_dwordx4 v22, s[20:23], s53 offen sc1 lds
s_add_u32 m0, s45, 88064
s_nop 0
buffer_load_dwordx4 v23, s[20:23], s53 offen sc1 lds
v_mfma_f32_32x32x16_bf16 a[80:95], v[80:83], v[56:59], a[80:95]
s_add_u32 m0, s45, 89088
s_nop 0
buffer_load_dwordx4 v24, s[20:23], s53 offen sc1 lds
s_add_u32 m0, s46, 86016
s_nop 0
buffer_load_dwordx4 v31, s[32:35], s54 offen lds
v_mfma_f32_32x32x16_bf16 a[96:111], v[84:87], v[56:59], a[96:111]
s_add_u32 m0, s46, 87040
s_nop 0
buffer_load_dwordx4 v32, s[32:35], s54 offen lds
s_add_u32 m0, s46, 88064
s_nop 0
buffer_load_dwordx4 v33, s[32:35], s54 offen lds
s_add_u32 s53, s53, 16384
s_add_u32 s54, s54, s57
v_mfma_f32_32x32x16_bf16 a[112:127], v[88:91], v[56:59], a[112:127]
v_mfma_f32_32x32x16_bf16 a[128:143], v[92:95], v[56:59], a[128:143]
v_mfma_f32_32x32x16_bf16 a[144:159], v[96:99], v[56:59], a[144:159]
s_sub_u32 s42, s62, 2
s_cmp_eq_u32 s42, 0
s_cbranch_scc1 L_g2_wx_last_A
s_nop 8
L_g2_wx_A:
s_waitcnt lgkmcnt(0)
v_mfma_f32_32x32x16_bf16 a[0:15], v[60:63], v[44:47], a[0:15]
ds_read_b128 v[52:55], v35 offset:0
v_mfma_f32_32x32x16_bf16 a[16:31], v[64:67], v[44:47], a[16:31]
ds_read_b128 v[56:59], v35 offset:2048
v_mfma_f32_32x32x16_bf16 a[32:47], v[68:71], v[44:47], a[32:47]
ds_read_b64_tr_b16 v[80:81], v38 offset:0
ds_read_b64_tr_b16 v[82:83], v39 offset:0
v_mfma_f32_32x32x16_bf16 a[48:63], v[72:75], v[44:47], a[48:63]
ds_read_b64_tr_b16 v[84:85], v42 offset:0
ds_read_b64_tr_b16 v[86:87], v43 offset:0
v_mfma_f32_32x32x16_bf16 a[64:79], v[76:79], v[44:47], a[64:79]
ds_read_b64_tr_b16 v[88:89], v38 offset:128
ds_read_b64_tr_b16 v[90:91], v39 offset:128
v_mfma_f32_32x32x16_bf16 a[80:95], v[60:63], v[48:51], a[80:95]
ds_read_b64_tr_b16 v[92:93], v42 offset:128
ds_read_b64_tr_b16 v[94:95], v43 offset:128
v_mfma_f32_32x32x16_bf16 a[96:111], v[64:67], v[48:51], a[96:111]
ds_read_b64_tr_b16 v[96:97], v38 offset:256
ds_read_b64_tr_b16 v[98:99], v39 offset:256
v_mfma_f32_32x32x16_bf16 a[112:127], v[68:71], v[48:51], a[112:127]
v_mfma_f32_32x32x16_bf16 a[128:143], v[72:75], v[48:51], a[128:143]
v_mfma_f32_32x32x16_bf16 a[144:159], v[76:79], v[48:51], a[144:159]
s_waitcnt lgkmcnt(0)
s_waitcnt vmcnt(14)
s_barrier
v_mfma_f32_32x32x16_bf16 a[0:15], v[80:83], v[52:55], a[0:15]
ds_read_b128 v[44:47], v34 offset:28672
ds_read_b128 v[48:51], v34 offset:30720
v_mfma_f32_32x32x16_bf16 a[16:31], v[84:87], v[52:55], a[16:31]
ds_read_b64_tr_b16 v[60:61], v36 offset:28672
ds_read_b64_tr_b16 v[62:63], v37 offset:28672
ds_read_b64_tr_b16 v[64:65], v40 offset:28672
ds_read_b64_tr_b16 v[66:67], v41 offset:28672
v_mfma_f32_32x32x16_bf16 a[32:47], v[88:91], v[52:55], a[32:47]
ds_read_b64_tr_b16 v[68:69], v36 offset:28800
ds_read_b64_tr_b16 v[70:71], v37 offset:28800
ds_read_b64_tr_b16 v[72:73], v40 offset:28800
ds_read_b64_tr_b16 v[74:75], v41 offset:28800
v_mfma_f32_32x32x16_bf16 a[48:63], v[92:95], v[52:55], a[48:63]
ds_read_b64_tr_b16 v[76:77], v36 offset:28928
ds_read_b64_tr_b16 v[78:79], v37 offset:28928
s_add_u32 m0, s45, 0
s_nop 0
buffer_load_dwordx4 v21, s[20:23], s53 offen sc1 lds
v_mfma_f32_32x32x16_bf16 a[64:79], v[96:99], v[52:55], a[64:79]
s_add_u32 m0, s45, 1024
s_nop 0
buffer_load_dwordx4 v22, s[20:23], s53 offen sc1 lds
s_add_u32 m0, s45, 2048
s_nop 0
buffer_load_dwordx4 v23, s[20:23], s53 offen sc1 lds
v_mfma_f32_32x32x16_bf16 a[80:95], v[80:83], v[56:59], a[80:95]
s_add_u32 m0, s45, 3072
s_nop 0
buffer_load_dwordx4 v24, s[20:23], s53 offen sc1 lds
s_add_u32 m0, s46, 0
s_nop 0
buffer_load_dwordx4 v31, s[32:35], s54 offen lds
v_mfma_f32_32x32x16_bf16 a[96:111], v[84:87], v[56:59], a[96:111]
s_add_u32 m0, s46, 1024
s_nop 0
buffer_load_dwordx4 v32, s[32:35], s54 offen lds
s_add_u32 m0, s46, 2048
s_nop 0
buffer_load_dwordx4 v33, s[32:35], s54 offen lds
s_add_u32 s53, s53, 16384
s_add_u32 s54, s54, s57
v_mfma_f32_32x32x16_bf16 a[112:127], v[88:91], v[56:59], a[112:127]
v_mfma_f32_32x32x16_bf16 a[128:143], v[92:95], v[56:59], a[128:143]
v_mfma_f32_32x32x16_bf16 a[144:159], v[96:99], v[56:59], a[144:159]
s_waitcnt lgkmcnt(0)
v_mfma_f32_32x32x16_bf16 a[0:15], v[60:63], v[44:47], a[0:15]
ds_read_b128 v[52:55], v35 offset:28672
v_mfma_f32_32x32x16_bf16 a[16:31], v[64:67], v[44:47], a[16:31]
ds_read_b128 v[56:59], v35 offset:30720
v_mfma_f32_32x32x16_bf16 a[32:47], v[68:71], v[44:47], a[32:47]
ds_read_b64_tr_b16 v[80:81], v38 offset:28672
ds_read_b64_tr_b16 v[82:83], v39 offset:28672
v_mfma_f32_32x32x16_bf16 a[48:63], v[72:75], v[44:47], a[48:63]
ds_read_b64_tr_b16 v[84:85], v42 offset:28672
ds_read_b64_tr_b16 v[86:87], v43 offset:28672
v_mfma_f32_32x32x16_bf16 a[64:79], v[76:79], v[44:47], a[64:79]
ds_read_b64_tr_b16 v[88:89], v38 offset:28800
ds_read_b64_tr_b16 v[90:91], v39 offset:28800
v_mfma_f32_32x32x16_bf16 a[80:95], v[60:63], v[48:51], a[80:95]
ds_read_b64_tr_b16 v[92:93], v42 offset:28800
ds_read_b64_tr_b16 v[94:95], v43 offset:28800
v_mfma_f32_32x32x16_bf16 a[96:111], v[64:67], v[48:51], a[96:111]
ds_read_b64_tr_b16 v[96:97], v38 offset:28928
ds_read_b64_tr_b16 v[98:99], v39 offset:28928
v_mfma_f32_32x32x16_bf16 a[112:127], v[68:71], v[48:51], a[112:127]
v_mfma_f32_32x32x16_bf16 a[128:143], v[72:75], v[48:51], a[128:143]
v_mfma_f32_32x32x16_bf16 a[144:159], v[76:79], v[48:51], a[144:159]
s_waitcnt lgkmcnt(0)
s_waitcnt vmcnt(14)
s_barrier
v_mfma_f32_32x32x16_bf16 a[0:15], v[80:83], v[52:55], a[0:15]
ds_read_b128 v[44:47], v100 offset:0
ds_read_b128 v[48:51], v100 offset:2048
v_mfma_f32_32x32x16_bf16 a[16:31], v[84:87], v[52:55], a[16:31]
ds_read_b64_tr_b16 v[60:61], v102 offset:0
ds_read_b64_tr_b16 v[62:63], v103 offset:0
ds_read_b64_tr_b16 v[64:65], v106 offset:0
ds_read_b64_tr_b16 v[66:67], v107 offset:0
v_mfma_f32_32x32x16_bf16 a[32:47], v[88:91], v[52:55], a[32:47]
ds_read_b64_tr_b16 v[68:69], v102 offset:128
ds_read_b64_tr_b16 v[70:71], v103 offset:128
ds_read_b64_tr_b16 v[72:73], v106 offset:128
ds_read_b64_tr_b16 v[74:75], v107 offset:128
v_mfma_f32_32x32x16_bf16 a[48:63], v[92:95], v[52:55], a[48:63]
ds_read_b64_tr_b16 v[76:77], v102 offset:256
ds_read_b64_tr_b16 v[78:79], v103 offset:256
s_add_u32 m0, s45, 28672
s_nop 0
buffer_load_dwordx4 v21, s[20:23], s53 offen sc1 lds
v_mfma_f32_32x32x16_bf16 a[64:79], v[96:99], v[52:55], a[64:79]
s_add_u32 m0, s45, 29696
s_nop 0
buffer_load_dwordx4 v22, s[20:23], s53 offen sc1 lds
s_add_u32 m0, s45, 30720
s_nop 0
buffer_load_dwordx4 v23, s[20:23], s53 offen sc1 lds
v_mfma_f32_32x32x16_bf16 a[80:95], v[80:83], v[56:59], a[80:95]
s_add_u32 m0, s45, 31744
s_nop 0
buffer_load_dwordx4 v24, s[20:23], s53 offen sc1 lds
s_add_u32 m0, s46, 28672
s_nop 0
buffer_load_dwordx4 v31, s[32:35], s54 offen lds
v_mfma_f32_32x32x16_bf16 a[96:111], v[84:87], v[56:59], a[96:111]
s_add_u32 m0, s46, 29696
s_nop 0
buffer_load_dwordx4 v32, s[32:35], s54 offen lds
s_add_u32 m0, s46, 30720
s_nop 0
buffer_load_dwordx4 v33, s[32:35], s54 offen lds
s_add_u32 s53, s53, 16384
s_add_u32 s54, s54, s57
v_mfma_f32_32x32x16_bf16 a[112:127], v[88:91], v[56:59], a[112:127]
v_mfma_f32_32x32x16_bf16 a[128:143], v[92:95], v[56:59], a[128:143]
v_mfma_f32_32x32x16_bf16 a[144:159], v[96:99], v[56:59], a[144:159]
s_waitcnt lgkmcnt(0)
v_mfma_f32_32x32x16_bf16 a[0:15], v[60:63], v[44:47], a[0:15]
ds_read_b128 v[52:55], v101 offset:0
v_mfma_f32_32x32x16_bf16 a[16:31], v[64:67], v[44:47], a[16:31]
ds_read_b128 v[56:59], v101 offset:2048
v_mfma_f32_32x32x16_bf16 a[32:47], v[68:71], v[44:47], a[32:47]
ds_read_b64_tr_b16 v[80:81], v104 offset:0
ds_read_b64_tr_b16 v[82:83], v105 offset:0
v_mfma_f32_32x32x16_bf16 a[48:63], v[72:75], v[44:47], a[48:63]
ds_read_b64_tr_b16 v[84:85], v108 offset:0
ds_read_b64_tr_b16 v[86:87], v109 offset:0
v_mfma_f32_32x32x16_bf16 a[64:79], v[76:79], v[44:47], a[64:79]
ds_read_b64_tr_b16 v[88:89], v104 offset:128
ds_read_b64_tr_b16 v[90:91], v105 offset:128
v_mfma_f32_32x32x16_bf16 a[80:95], v[60:63], v[48:51], a[80:95]
ds_read_b64_tr_b16 v[92:93], v108 offset:128
ds_read_b64_tr_b16 v[94:95], v109 offset:128
v_mfma_f32_32x32x16_bf16 a[96:111], v[64:67], v[48:51], a[96:111]
ds_read_b64_tr_b16 v[96:97], v104 offset:256
ds_read_b64_tr_b16 v[98:99], v105 offset:256
v_mfma_f32_32x32x16_bf16 a[112:127], v[68:71], v[48:51], a[112:127]
v_mfma_f32_32x32x16_bf16 a[128:143], v[72:75], v[48:51], a[128:143]
v_mfma_f32_32x32x16_bf16 a[144:159], v[76:79], v[48:51], a[144:159]
s_waitcnt lgkmcnt(0)
s_waitcnt vmcnt(14)
s_barrier
v_mfma_f32_32x32x16_bf16 a[0:15], v[80:83], v[52:55], a[0:15]
ds_read_b128 v[44:47], v100 offset:28672
ds_read_b128 v[48:51], v100 offset:30720
v_mfma_f32_32x32x16_bf16 a[16:31], v[84:87], v[52:55], a[16:31]
ds_read_b64_tr_b16 v[60:61], v102 offset:28672
ds_read_b64_tr_b16 v[62:63], v103 offset:28672
ds_read_b64_tr_b16 v[64:65], v106 offset:28672
ds_read_b64_tr_b16 v[66:67], v107 offset:28672
v_mfma_f32_32x32x16_bf16 a[32:47], v[88:91], v[52:55], a[32:47]
ds_read_b64_tr_b16 v[68:69], v102 offset:28800
ds_read_b64_tr_b16 v[70:71], v103 offset:28800
ds_read_b64_tr_b16 v[72:73], v106 offset:28800
ds_read_b64_tr_b16 v[74:75], v107 offset:28800
v_mfma_f32_32x32x16_bf16 a[48:63], v[92:95], v[52:55], a[48:63]
ds_read_b64_tr_b16 v[76:77], v102 offset:28928
ds_read_b64_tr_b16 v[78:79], v103 offset:28928
s_add_u32 m0, s45, 57344
s_nop 0
buffer_load_dwordx4 v21, s[20:23], s53 offen sc1 lds
v_mfma_f32_32x32x16_bf16 a[64:79], v[96:99], v[52:55], a[64:79]
s_add_u32 m0, s45, 58368
s_nop 0
buffer_load_dwordx4 v22, s[20:23], s53 offen sc1 lds
s_add_u32 m0, s45, 59392
s_nop 0
buffer_load_dwordx4 v23, s[20:23], s53 offen sc1 lds
v_mfma_f32_32x32x16_bf16 a[80:95], v[80:83], v[56:59], a[80:95]
s_add_u32 m0, s45, 60416
s_nop 0
buffer_load_dwordx4 v24, s[20:23], s53 offen sc1 lds
s_add_u32 m0, s46, 57344
s_nop 0
buffer_load_dwordx4 v31, s[32:35], s54 offen lds
v_mfma_f32_32x32x16_bf16 a[96:111], v[84:87], v[56:59], a[96:111]
s_add_u32 m0, s46, 58368
s_nop 0
buffer_load_dwordx4 v32, s[32:35], s54 offen lds
s_add_u32 m0, s46, 59392
s_nop 0
buffer_load_dwordx4 v33, s[32:35], s54 offen lds
s_add_u32 s53, s53, 16384
s_add_u32 s54, s54, s57
v_mfma_f32_32x32x16_bf16 a[112:127], v[88:91], v[56:59], a[112:127]
v_mfma_f32_32x32x16_bf16 a[128:143], v[92:95], v[56:59], a[128:143]
v_mfma_f32_32x32x16_bf16 a[144:159], v[96:99], v[56:59], a[144:159]
s_waitcnt lgkmcnt(0)
v_mfma_f32_32x32x16_bf16 a[0:15], v[60:63], v[44:47], a[0:15]
ds_read_b128 v[52:55], v101 offset:28672
v_mfma_f32_32x32x16_bf16 a[16:31], v[64:67], v[44:47], a[16:31]
ds_read_b128 v[56:59], v101 offset:30720
v_mfma_f32_32x32x16_bf16 a[32:47], v[68:71], v[44:47], a[32:47]
ds_read_b64_tr_b16 v[80:81], v104 offset:28672
ds_read_b64_tr_b16 v[82:83], v105 offset:28672
v_mfma_f32_32x32x16_bf16 a[48:63], v[72:75], v[44:47], a[48:63]
ds_read_b64_tr_b16 v[84:85], v108 offset:28672
ds_read_b64_tr_b16 v[86:87], v109 offset:28672
v_mfma_f32_32x32x16_bf16 a[64:79], v[76:79], v[44:47], a[64:79]
ds_read_b64_tr_b16 v[88:89], v104 offset:28800
ds_read_b64_tr_b16 v[90:91], v105 offset:28800
v_mfma_f32_32x32x16_bf16 a[80:95], v[60:63], v[48:51], a[80:95]
ds_read_b64_tr_b16 v[92:93], v108 offset:28800
ds_read_b64_tr_b16 v[94:95], v109 offset:28800
v_mfma_f32_32x32x16_bf16 a[96:111], v[64:67], v[48:51], a[96:111]
ds_read_b64_tr_b16 v[96:97], v104 offset:28928
ds_read_b64_tr_b16 v[98:99], v105 offset:28928
v_mfma_f32_32x32x16_bf16 a[112:127], v[68:71], v[48:51], a[112:127]
v_mfma_f32_32x32x16_bf16 a[128:143], v[72:75], v[48:51], a[128:143]
v_mfma_f32_32x32x16_bf16 a[144:159], v[76:79], v[48:51], a[144:159]
s_waitcnt lgkmcnt(0)
s_waitcnt vmcnt(14)
s_barrier
v_mfma_f32_32x32x16_bf16 a[0:15], v[80:83], v[52:55], a[0:15]
ds_read_b128 v[44:47], v34 offset:0
ds_read_b128 v[48:51], v34 offset:2048
v_mfma_f32_32x32x16_bf16 a[16:31], v[84:87], v[52:55], a[16:31]
ds_read_b64_tr_b16 v[60:61], v36 offset:0
ds_read_b64_tr_b16 v[62:63], v37 offset:0
ds_read_b64_tr_b16 v[64:65], v40 offset:0
ds_read_b64_tr_b16 v[66:67], v41 offset:0
v_mfma_f32_32x32x16_bf16 a[32:47], v[88:91], v[52:55], a[32:47]
ds_read_b64_tr_b16 v[68:69], v36 offset:128
ds_read_b64_tr_b16 v[70:71], v37 offset:128
ds_read_b64_tr_b16 v[72:73], v40 offset:128
ds_read_b64_tr_b16 v[74:75], v41 offset:128
v_mfma_f32_32x32x16_bf16 a[48:63], v[92:95], v[52:55], a[48:63]
ds_read_b64_tr_b16 v[76:77], v36 offset:256
ds_read_b64_tr_b16 v[78:79], v37 offset:256
s_add_u32 m0, s45, 86016
s_nop 0
buffer_load_dwordx4 v21, s[20:23], s53 offen sc1 lds
v_mfma_f32_32x32x16_bf16 a[64:79], v[96:99], v[52:55], a[64:79]
s_add_u32 m0, s45, 87040
s_nop 0
buffer_load_dwordx4 v22, s[20:23], s53 offen sc1 lds
s_add_u32 m0, s45, 88064
s_nop 0
buffer_load_dwordx4 v23, s[20:23], s53 offen sc1 lds
v_mfma_f32_32x32x16_bf16 a[80:95], v[80:83], v[56:59], a[80:95]
s_add_u32 m0, s45, 89088
s_nop 0
buffer_load_dwordx4 v24, s[20:23], s53 offen sc1 lds
s_add_u32 m0, s46, 86016
s_nop 0
buffer_load_dwordx4 v31, s[32:35], s54 offen lds
v_mfma_f32_32x32x16_bf16 a[96:111], v[84:87], v[56:59], a[96:111]
s_add_u32 m0, s46, 87040
s_nop 0
buffer_load_dwordx4 v32, s[32:35], s54 offen lds
s_add_u32 m0, s46, 88064
s_nop 0
buffer_load_dwordx4 v33, s[32:35], s54 offen lds
s_add_u32 s53, s53, 16384
s_add_u32 s54, s54, s57
v_mfma_f32_32x32x16_bf16 a[112:127], v[88:91], v[56:59], a[112:127]
v_mfma_f32_32x32x16_bf16 a[128:143], v[92:95], v[56:59], a[128:143]
v_mfma_f32_32x32x16_bf16 a[144:159], v[96:99], v[56:59], a[144:159]
s_sub_u32 s42, s42, 1
s_cmp_lg_u32 s42, 0
s_nop 9
s_cbranch_scc1 L_g2_wx_A
L_g2_wx_last_A:
s_waitcnt lgkmcnt(0)
v_mfma_f32_32x32x16_bf16 a[0:15], v[60:63], v[44:47], a[0:15]
ds_read_b128 v[52:55], v35 offset:0
v_mfma_f32_32x32x16_bf16 a[16:31], v[64:67], v[44:47], a[16:31]
ds_read_b128 v[56:59], v35 offset:2048
v_mfma_f32_32x32x16_bf16 a[32:47], v[68:71], v[44:47], a[32:47]
ds_read_b64_tr_b16 v[80:81], v38 offset:0
ds_read_b64_tr_b16 v[82:83], v39 offset:0
v_mfma_f32_32x32x16_bf16 a[48:63], v[72:75], v[44:47], a[48:63]
ds_read_b64_tr_b16 v[84:85], v42 offset:0
ds_read_b64_tr_b16 v[86:87], v43 offset:0
v_mfma_f32_32x32x16_bf16 a[64:79], v[76:79], v[44:47], a[64:79]
ds_read_b64_tr_b16 v[88:89], v38 offset:128
ds_read_b64_tr_b16 v[90:91], v39 offset:128
v_mfma_f32_32x32x16_bf16 a[80:95], v[60:63], v[48:51], a[80:95]
ds_read_b64_tr_b16 v[92:93], v42 offset:128
ds_read_b64_tr_b16 v[94:95], v43 offset:128
v_mfma_f32_32x32x16_bf16 a[96:111], v[64:67], v[48:51], a[96:111]
ds_read_b64_tr_b16 v[96:97], v38 offset:256
ds_read_b64_tr_b16 v[98:99], v39 offset:256
v_mfma_f32_32x32x16_bf16 a[112:127], v[68:71], v[48:51], a[112:127]
v_mfma_f32_32x32x16_bf16 a[128:143], v[72:75], v[48:51], a[128:143]
v_mfma_f32_32x32x16_bf16 a[144:159], v[76:79], v[48:51], a[144:159]
s_waitcnt lgkmcnt(0)
s_waitcnt vmcnt(14)
s_barrier
v_mfma_f32_32x32x16_bf16 a[0:15], v[80:83], v[52:55], a[0:15]
ds_read_b128 v[44:47], v34 offset:28672
v_mfma_f32_32x32x16_bf16 a[16:31], v[84:87], v[52:55], a[16:31]
ds_read_b128 v[48:51], v34 offset:30720
v_mfma_f32_32x32x16_bf16 a[32:47], v[88:91], v[52:55], a[32:47]
ds_read_b64_tr_b16 v[60:61], v36 offset:28672
ds_read_b64_tr_b16 v[62:63], v37 offset:28672
v_mfma_f32_32x32x16_bf16 a[48:63], v[92:95], v[52:55], a[48:63]
ds_read_b64_tr_b16 v[64:65], v40 offset:28672
ds_read_b64_tr_b16 v[66:67], v41 offset:28672
v_mfma_f32_32x32x16_bf16 a[64:79], v[96:99], v[52:55], a[64:79]
ds_read_b64_tr_b16 v[68:69], v36 offset:28800
ds_read_b64_tr_b16 v[70:71], v37 offset:28800
v_mfma_f32_32x32x16_bf16 a[80:95], v[80:83], v[56:59], a[80:95]
ds_read_b64_tr_b16 v[72:73], v40 offset:28800
ds_read_b64_tr_b16 v[74:75], v41 offset:28800
v_mfma_f32_32x32x16_bf16 a[96:111], v[84:87], v[56:59], a[96:111]
ds_read_b64_tr_b16 v[76:77], v36 offset:28928
ds_read_b64_tr_b16 v[78:79], v37 offset:28928
v_mfma_f32_32x32x16_bf16 a[112:127], v[88:91], v[56:59], a[112:127]
v_mfma_f32_32x32x16_bf16 a[128:143], v[92:95], v[56:59], a[128:143]
v_mfma_f32_32x32x16_bf16 a[144:159], v[96:99], v[56:59], a[144:159]
s_waitcnt lgkmcnt(0)
v_mfma_f32_32x32x16_bf16 a[0:15], v[60:63], v[44:47], a[0:15]
ds_read_b128 v[52:55], v35 offset:28672
v_mfma_f32_32x32x16_bf16 a[16:31], v[64:67], v[44:47], a[16:31]
ds_read_b128 v[56:59], v35 offset:30720
v_mfma_f32_32x32x16_bf16 a[32:47], v[68:71], v[44:47], a[32:47]
ds_read_b64_tr_b16 v[80:81], v38 offset:28672
ds_read_b64_tr_b16 v[82:83], v39 offset:28672
v_mfma_f32_32x32x16_bf16 a[48:63], v[72:75], v[44:47], a[48:63]
ds_read_b64_tr_b16 v[84:85], v42 offset:28672
ds_read_b64_tr_b16 v[86:87], v43 offset:28672
v_mfma_f32_32x32x16_bf16 a[64:79], v[76:79], v[44:47], a[64:79]
ds_read_b64_tr_b16 v[88:89], v38 offset:28800
ds_read_b64_tr_b16 v[90:91], v39 offset:28800
v_mfma_f32_32x32x16_bf16 a[80:95], v[60:63], v[48:51], a[80:95]
ds_read_b64_tr_b16 v[92:93], v42 offset:28800
ds_read_b64_tr_b16 v[94:95], v43 offset:28800
v_mfma_f32_32x32x16_bf16 a[96:111], v[64:67], v[48:51], a[96:111]
ds_read_b64_tr_b16 v[96:97], v38 offset:28928
ds_read_b64_tr_b16 v[98:99], v39 offset:28928
v_mfma_f32_32x32x16_bf16 a[112:127], v[68:71], v[48:51], a[112:127]
v_mfma_f32_32x32x16_bf16 a[128:143], v[72:75], v[48:51], a[128:143]
v_mfma_f32_32x32x16_bf16 a[144:159], v[76:79], v[48:51], a[144:159]
s_waitcnt lgkmcnt(0)
s_waitcnt vmcnt(7)
s_barrier
v_mfma_f32_32x32x16_bf16 a[0:15], v[80:83], v[52:55], a[0:15]
ds_read_b128 v[44:47], v100 offset:0
v_mfma_f32_32x32x16_bf16 a[16:31], v[84:87], v[52:55], a[16:31]
ds_read_b128 v[48:51], v100 offset:2048
v_mfma_f32_32x32x16_bf16 a[32:47], v[88:91], v[52:55], a[32:47]
ds_read_b64_tr_b16 v[60:61], v102 offset:0
ds_read_b64_tr_b16 v[62:63], v103 offset:0
v_mfma_f32_32x32x16_bf16 a[48:63], v[92:95], v[52:55], a[48:63]
ds_read_b64_tr_b16 v[64:65], v106 offset:0
ds_read_b64_tr_b16 v[66:67], v107 offset:0
v_mfma_f32_32x32x16_bf16 a[64:79], v[96:99], v[52:55], a[64:79]
ds_read_b64_tr_b16 v[68:69], v102 offset:128
ds_read_b64_tr_b16 v[70:71], v103 offset:128
v_mfma_f32_32x32x16_bf16 a[80:95], v[80:83], v[56:59], a[80:95]
ds_read_b64_tr_b16 v[72:73], v106 offset:128
ds_read_b64_tr_b16 v[74:75], v107 offset:128
v_mfma_f32_32x32x16_bf16 a[96:111], v[84:87], v[56:59], a[96:111]
ds_read_b64_tr_b16 v[76:77], v102 offset:256
ds_read_b64_tr_b16 v[78:79], v103 offset:256
v_mfma_f32_32x32x16_bf16 a[112:127], v[88:91], v[56:59], a[112:127]
v_mfma_f32_32x32x16_bf16 a[128:143], v[92:95], v[56:59], a[128:143]
v_mfma_f32_32x32x16_bf16 a[144:159], v[96:99], v[56:59], a[144:159]
s_waitcnt lgkmcnt(0)
v_mfma_f32_32x32x16_bf16 a[0:15], v[60:63], v[44:47], a[0:15]
ds_read_b128 v[52:55], v101 offset:0
v_mfma_f32_32x32x16_bf16 a[16:31], v[64:67], v[44:47], a[16:31]
ds_read_b128 v[56:59], v101 offset:2048
v_mfma_f32_32x32x16_bf16 a[32:47], v[68:71], v[44:47], a[32:47]
ds_read_b64_tr_b16 v[80:81], v104 offset:0
ds_read_b64_tr_b16 v[82:83], v105 offset:0
v_mfma_f32_32x32x16_bf16 a[48:63], v[72:75], v[44:47], a[48:63]
ds_read_b64_tr_b16 v[84:85], v108 offset:0
ds_read_b64_tr_b16 v[86:87], v109 offset:0
v_mfma_f32_32x32x16_bf16 a[64:79], v[76:79], v[44:47], a[64:79]
ds_read_b64_tr_b16 v[88:89], v104 offset:128
ds_read_b64_tr_b16 v[90:91], v105 offset:128
v_mfma_f32_32x32x16_bf16 a[80:95], v[60:63], v[48:51], a[80:95]
ds_read_b64_tr_b16 v[92:93], v108 offset:128
ds_read_b64_tr_b16 v[94:95], v109 offset:128
v_mfma_f32_32x32x16_bf16 a[96:111], v[64:67], v[48:51], a[96:111]
ds_read_b64_tr_b16 v[96:97], v104 offset:256
ds_read_b64_tr_b16 v[98:99], v105 offset:256
v_mfma_f32_32x32x16_bf16 a[112:127], v[68:71], v[48:51], a[112:127]
v_mfma_f32_32x32x16_bf16 a[128:143], v[72:75], v[48:51], a[128:143]
v_mfma_f32_32x32x16_bf16 a[144:159], v[76:79], v[48:51], a[144:159]
s_waitcnt lgkmcnt(0)
s_waitcnt vmcnt(0)
s_barrier
v_mfma_f32_32x32x16_bf16 a[0:15], v[80:83], v[52:55], a[0:15]
ds_read_b128 v[44:47], v100 offset:28672
v_mfma_f32_32x32x16_bf16 a[16:31], v[84:87], v[52:55], a[16:31]
ds_read_b128 v[48:51], v100 offset:30720
v_mfma_f32_32x32x16_bf16 a[32:47], v[88:91], v[52:55], a[32:47]
ds_read_b64_tr_b16 v[60:61], v102 offset:28672
ds_read_b64_tr_b16 v[62:63], v103 offset:28672
v_mfma_f32_32x32x16_bf16 a[48:63], v[92:95], v[52:55], a[48:63]
ds_read_b64_tr_b16 v[64:65], v106 offset:28672
ds_read_b64_tr_b16 v[66:67], v107 offset:28672
v_mfma_f32_32x32x16_bf16 a[64:79], v[96:99], v[52:55], a[64:79]
ds_read_b64_tr_b16 v[68:69], v102 offset:28800
ds_read_b64_tr_b16 v[70:71], v103 offset:28800
v_mfma_f32_32x32x16_bf16 a[80:95], v[80:83], v[56:59], a[80:95]
ds_read_b64_tr_b16 v[72:73], v106 offset:28800
ds_read_b64_tr_b16 v[74:75], v107 offset:28800
v_mfma_f32_32x32x16_bf16 a[96:111], v[84:87], v[56:59], a[96:111]
ds_read_b64_tr_b16 v[76:77], v102 offset:28928
ds_read_b64_tr_b16 v[78:79], v103 offset:28928
v_mfma_f32_32x32x16_bf16 a[112:127], v[88:91], v[56:59], a[112:127]
v_mfma_f32_32x32x16_bf16 a[128:143], v[92:95], v[56:59], a[128:143]
v_mfma_f32_32x32x16_bf16 a[144:159], v[96:99], v[56:59], a[144:159]
s_waitcnt lgkmcnt(0)
v_mfma_f32_32x32x16_bf16 a[0:15], v[60:63], v[44:47], a[0:15]
ds_read_b128 v[52:55], v101 offset:28672
v_mfma_f32_32x32x16_bf16 a[16:31], v[64:67], v[44:47], a[16:31]
ds_read_b128 v[56:59], v101 offset:30720
v_mfma_f32_32x32x16_bf16 a[32:47], v[68:71], v[44:47], a[32:47]
ds_read_b64_tr_b16 v[80:81], v104 offset:28672
ds_read_b64_tr_b16 v[82:83], v105 offset:28672
v_mfma_f32_32x32x16_bf16 a[48:63], v[72:75], v[44:47], a[48:63]
ds_read_b64_tr_b16 v[84:85], v108 offset:28672
ds_read_b64_tr_b16 v[86:87], v109 offset:28672
v_mfma_f32_32x32x16_bf16 a[64:79], v[76:79], v[44:47], a[64:79]
ds_read_b64_tr_b16 v[88:89], v104 offset:28800
ds_read_b64_tr_b16 v[90:91], v105 offset:28800
v_mfma_f32_32x32x16_bf16 a[80:95], v[60:63], v[48:51], a[80:95]
ds_read_b64_tr_b16 v[92:93], v108 offset:28800
ds_read_b64_tr_b16 v[94:95], v109 offset:28800
v_mfma_f32_32x32x16_bf16 a[96:111], v[64:67], v[48:51], a[96:111]
ds_read_b64_tr_b16 v[96:97], v104 offset:28928
ds_read_b64_tr_b16 v[98:99], v105 offset:28928
v_mfma_f32_32x32x16_bf16 a[112:127], v[68:71], v[48:51], a[112:127]
v_mfma_f32_32x32x16_bf16 a[128:143], v[72:75], v[48:51], a[128:143]
v_mfma_f32_32x32x16_bf16 a[144:159], v[76:79], v[48:51], a[144:159]
s_waitcnt lgkmcnt(0)
s_waitcnt vmcnt(0)
s_barrier
v_mfma_f32_32x32x16_bf16 a[0:15], v[80:83], v[52:55], a[0:15]
v_mfma_f32_32x32x16_bf16 a[16:31], v[84:87], v[52:55], a[16:31]
v_mfma_f32_32x32x16_bf16 a[32:47], v[88:91], v[52:55], a[32:47]
v_mfma_f32_32x32x16_bf16 a[48:63], v[92:95], v[52:55], a[48:63]
v_mfma_f32_32x32x16_bf16 a[64:79], v[96:99], v[52:55], a[64:79]
v_mfma_f32_32x32x16_bf16 a[80:95], v[80:83], v[56:59], a[80:95]
v_mfma_f32_32x32x16_bf16 a[96:111], v[84:87], v[56:59], a[96:111]
v_mfma_f32_32x32x16_bf16 a[112:127], v[88:91], v[56:59], a[112:127]
v_mfma_f32_32x32x16_bf16 a[128:143], v[92:95], v[56:59], a[128:143]
v_mfma_f32_32x32x16_bf16 a[144:159], v[96:99], v[56:59], a[144:159]
s_nop 11
s_lshl_b32 s60, s51, 2
s_add_u32 s60, s60, s28
s_mul_i32 s60, s60, 40960
s_add_u32 s40, s96, s60
v_accvgpr_read_b32 v112, a0
v_accvgpr_read_b32 v113, a1
v_accvgpr_read_b32 v114, a2
v_accvgpr_read_b32 v115, a3
v_accvgpr_read_b32 v116, a4
v_accvgpr_read_b32 v117, a5
v_accvgpr_read_b32 v118, a6
v_accvgpr_read_b32 v119, a7
v_accvgpr_read_b32 v120, a8
v_accvgpr_read_b32 v121, a9
v_accvgpr_read_b32 v122, a10
v_accvgpr_read_b32 v123, a11
v_accvgpr_read_b32 v124, a12
v_accvgpr_read_b32 v125, a13
v_accvgpr_read_b32 v126, a14
v_accvgpr_read_b32 v127, a15
s_add_u32 s41, s40, 0
buffer_store_dwordx4 v[112:115], v128, s[20:23], s41 offen offset:0 sc1
buffer_store_dwordx4 v[116:119], v128, s[20:23], s41 offen offset:1024 sc1
buffer_store_dwordx4 v[120:123], v128, s[20:23], s41 offen offset:2048 sc1
buffer_store_dwordx4 v[124:127], v128, s[20:23], s41 offen offset:3072 sc1
v_accvgpr_read_b32 v112, a16
v_accvgpr_read_b32 v113, a17
v_accvgpr_read_b32 v114, a18
v_accvgpr_read_b32 v115, a19
v_accvgpr_read_b32 v116, a20
v_accvgpr_read_b32 v117, a21
v_accvgpr_read_b32 v118, a22
v_accvgpr_read_b32 v119, a23
v_accvgpr_read_b32 v120, a24
v_accvgpr_read_b32 v121, a25
v_accvgpr_read_b32 v122, a26
v_accvgpr_read_b32 v123, a27
v_accvgpr_read_b32 v124, a28
v_accvgpr_read_b32 v125, a29
v_accvgpr_read_b32 v126, a30
v_accvgpr_read_b32 v127, a31
s_add_u32 s41, s40, 4096
buffer_store_dwordx4 v[112:115], v128, s[20:23], s41 offen offset:0 sc1
buffer_store_dwordx4 v[116:119], v128, s[20:23], s41 offen offset:1024 sc1
buffer_store_dwordx4 v[120:123], v128, s[20:23], s41 offen offset:2048 sc1
buffer_store_dwordx4 v[124:127], v128, s[20:23], s41 offen offset:3072 sc1
v_accvgpr_read_b32 v112, a32
v_accvgpr_read_b32 v113, a33
v_accvgpr_read_b32 v114, a34
v_accvgpr_read_b32 v115, a35
v_accvgpr_read_b32 v116, a36
v_accvgpr_read_b32 v117, a37
v_accvgpr_read_b32 v118, a38
v_accvgpr_read_b32 v119, a39
v_accvgpr_read_b32 v120, a40
v_accvgpr_read_b32 v121, a41
v_accvgpr_read_b32 v122, a42
v_accvgpr_read_b32 v123, a43
v_accvgpr_read_b32 v124, a44
v_accvgpr_read_b32 v125, a45
v_accvgpr_read_b32 v126, a46
v_accvgpr_read_b32 v127, a47
s_add_u32 s41, s40, 8192
buffer_store_dwordx4 v[112:115], v128, s[20:23], s41 offen offset:0 sc1
buffer_store_dwordx4 v[116:119], v128, s[20:23], s41 offen offset:1024 sc1
buffer_store_dwordx4 v[120:123], v128, s[20:23], s41 offen offset:2048 sc1
buffer_store_dwordx4 v[124:127], v128, s[20:23], s41 offen offset:3072 sc1
v_accvgpr_read_b32 v112, a48
v_accvgpr_read_b32 v113, a49
v_accvgpr_read_b32 v114, a50
v_accvgpr_read_b32 v115, a51
v_accvgpr_read_b32 v116, a52
v_accvgpr_read_b32 v117, a53
v_accvgpr_read_b32 v118, a54
v_accvgpr_read_b32 v119, a55
v_accvgpr_read_b32 v120, a56
v_accvgpr_read_b32 v121, a57
v_accvgpr_read_b32 v122, a58
v_accvgpr_read_b32 v123, a59
v_accvgpr_read_b32 v124, a60
v_accvgpr_read_b32 v125, a61
v_accvgpr_read_b32 v126, a62
v_accvgpr_read_b32 v127, a63
s_add_u32 s41, s40, 12288
buffer_store_dwordx4 v[112:115], v128, s[20:23], s41 offen offset:0 sc1
buffer_store_dwordx4 v[116:119], v128, s[20:23], s41 offen offset:1024 sc1
buffer_store_dwordx4 v[120:123], v128, s[20:23], s41 offen offset:2048 sc1
buffer_store_dwordx4 v[124:127], v128, s[20:23], s41 offen offset:3072 sc1
v_accvgpr_read_b32 v112, a64
v_accvgpr_read_b32 v113, a65
v_accvgpr_read_b32 v114, a66
v_accvgpr_read_b32 v115, a67
v_accvgpr_read_b32 v116, a68
v_accvgpr_read_b32 v117, a69
v_accvgpr_read_b32 v118, a70
v_accvgpr_read_b32 v119, a71
v_accvgpr_read_b32 v120, a72
v_accvgpr_read_b32 v121, a73
v_accvgpr_read_b32 v122, a74
v_accvgpr_read_b32 v123, a75
v_accvgpr_read_b32 v124, a76
v_accvgpr_read_b32 v125, a77
v_accvgpr_read_b32 v126, a78
v_accvgpr_read_b32 v127, a79
s_add_u32 s41, s40, 16384
buffer_store_dwordx4 v[112:115], v128, s[20:23], s41 offen offset:0 sc1
buffer_store_dwordx4 v[116:119], v128, s[20:23], s41 offen offset:1024 sc1
buffer_store_dwordx4 v[120:123], v128, s[20:23], s41 offen offset:2048 sc1
buffer_store_dwordx4 v[124:127], v128, s[20:23], s41 offen offset:3072 sc1
v_accvgpr_read_b32 v112, a80
v_accvgpr_read_b32 v113, a81
v_accvgpr_read_b32 v114, a82
v_accvgpr_read_b32 v115, a83
v_accvgpr_read_b32 v116, a84
v_accvgpr_read_b32 v117, a85
v_accvgpr_read_b32 v118, a86
v_accvgpr_read_b32 v119, a87
v_accvgpr_read_b32 v120, a88
v_accvgpr_read_b32 v121, a89
v_accvgpr_read_b32 v122, a90
v_accvgpr_read_b32 v123, a91
v_accvgpr_read_b32 v124, a92
v_accvgpr_read_b32 v125, a93
v_accvgpr_read_b32 v126, a94
v_accvgpr_read_b32 v127, a95
s_add_u32 s41, s40, 20480
buffer_store_dwordx4 v[112:115], v128, s[20:23], s41 offen offset:0 sc1
buffer_store_dwordx4 v[116:119], v128, s[20:23], s41 offen offset:1024 sc1
buffer_store_dwordx4 v[120:123], v128, s[20:23], s41 offen offset:2048 sc1
buffer_store_dwordx4 v[124:127], v128, s[20:23], s41 offen offset:3072 sc1
v_accvgpr_read_b32 v112, a96
v_accvgpr_read_b32 v113, a97
v_accvgpr_read_b32 v114, a98
v_accvgpr_read_b32 v115, a99
v_accvgpr_read_b32 v116, a100
v_accvgpr_read_b32 v117, a101
v_accvgpr_read_b32 v118, a102
v_accvgpr_read_b32 v119, a103
v_accvgpr_read_b32 v120, a104
v_accvgpr_read_b32 v121, a105
v_accvgpr_read_b32 v122, a106
v_accvgpr_read_b32 v123, a107
v_accvgpr_read_b32 v124, a108
v_accvgpr_read_b32 v125, a109
v_accvgpr_read_b32 v126, a110
v_accvgpr_read_b32 v127, a111
s_add_u32 s41, s40, 24576
buffer_store_dwordx4 v[112:115], v128, s[20:23], s41 offen offset:0 sc1
buffer_store_dwordx4 v[116:119], v128, s[20:23], s41 offen offset:1024 sc1
buffer_store_dwordx4 v[120:123], v128, s[20:23], s41 offen offset:2048 sc1
buffer_store_dwordx4 v[124:127], v128, s[20:23], s41 offen offset:3072 sc1
v_accvgpr_read_b32 v112, a112
v_accvgpr_read_b32 v113, a113
v_accvgpr_read_b32 v114, a114
v_accvgpr_read_b32 v115, a115
v_accvgpr_read_b32 v116, a116
v_accvgpr_read_b32 v117, a117
v_accvgpr_read_b32 v118, a118
v_accvgpr_read_b32 v119, a119
v_accvgpr_read_b32 v120, a120
v_accvgpr_read_b32 v121, a121
v_accvgpr_read_b32 v122, a122
v_accvgpr_read_b32 v123, a123
v_accvgpr_read_b32 v124, a124
v_accvgpr_read_b32 v125, a125
v_accvgpr_read_b32 v126, a126
v_accvgpr_read_b32 v127, a127
s_add_u32 s41, s40, 28672
buffer_store_dwordx4 v[112:115], v128, s[20:23], s41 offen offset:0 sc1
buffer_store_dwordx4 v[116:119], v128, s[20:23], s41 offen offset:1024 sc1
buffer_store_dwordx4 v[120:123], v128, s[20:23], s41 offen offset:2048 sc1
buffer_store_dwordx4 v[124:127], v128, s[20:23], s41 offen offset:3072 sc1
v_accvgpr_read_b32 v112, a128
v_accvgpr_read_b32 v113, a129
v_accvgpr_read_b32 v114, a130
v_accvgpr_read_b32 v115, a131
v_accvgpr_read_b32 v116, a132
v_accvgpr_read_b32 v117, a133
v_accvgpr_read_b32 v118, a134
v_accvgpr_read_b32 v119, a135
v_accvgpr_read_b32 v120, a136
v_accvgpr_read_b32 v121, a137
v_accvgpr_read_b32 v122, a138
v_accvgpr_read_b32 v123, a139
v_accvgpr_read_b32 v124, a140
v_accvgpr_read_b32 v125, a141
v_accvgpr_read_b32 v126, a142
v_accvgpr_read_b32 v127, a143
s_add_u32 s41, s40, 32768
buffer_store_dwordx4 v[112:115], v128, s[20:23], s41 offen offset:0 sc1
buffer_store_dwordx4 v[116:119], v128, s[20:23], s41 offen offset:1024 sc1
buffer_store_dwordx4 v[120:123], v128, s[20:23], s41 offen offset:2048 sc1
buffer_store_dwordx4 v[124:127], v128, s[20:23], s41 offen offset:3072 sc1
v_accvgpr_read_b32 v112, a144
v_accvgpr_read_b32 v113, a145
v_accvgpr_read_b32 v114, a146
v_accvgpr_read_b32 v115, a147
v_accvgpr_read_b32 v116, a148
v_accvgpr_read_b32 v117, a149
v_accvgpr_read_b32 v118, a150
v_accvgpr_read_b32 v119, a151
v_accvgpr_read_b32 v120, a152
v_accvgpr_read_b32 v121, a153
v_accvgpr_read_b32 v122, a154
v_accvgpr_read_b32 v123, a155
v_accvgpr_read_b32 v124, a156
v_accvgpr_read_b32 v125, a157
v_accvgpr_read_b32 v126, a158
v_accvgpr_read_b32 v127, a159
s_add_u32 s41, s40, 36864
buffer_store_dwordx4 v[112:115], v128, s[20:23], s41 offen offset:0 sc1
buffer_store_dwordx4 v[116:119], v128, s[20:23], s41 offen offset:1024 sc1
buffer_store_dwordx4 v[120:123], v128, s[20:23], s41 offen offset:2048 sc1
buffer_store_dwordx4 v[124:127], v128, s[20:23], s41 offen offset:3072 sc1
s_lshl_b32 s60, s52, 6
s_add_u32 s60, s60, 178479616
s_waitcnt vmcnt(0)
s_barrier
s_cmp_lg_u32 s28, 0
s_cbranch_scc1 L_sig_21_A
s_mov_b64 exec, 1
v_mov_b32 v17, s60
buffer_atomic_add v16, v17, s[20:23], 0 offen sc1
s_mov_b64 exec, -1
L_sig_21_A:
s_cmp_eq_u32 s99, 1
s_cbranch_scc1 L_b_task_A
L_b_final_A:
s_lshl_b32 s60, s52, 6
s_add_u32 s60, s60, 178479616
s_cmp_eq_u32 s98, 1
s_cbranch_scc1 L_b_fw120_A
s_cmp_lg_u32 s28, 0
s_cbranch_scc1 L_wc_22x_A
v_mov_b32 v17, s60
s_nop 1
L_wc_22_A:
buffer_load_dword v18, v17, s[20:23], 0 offen sc1
s_waitcnt vmcnt(0)
v_readfirstlane_b32 s41, v18
s_add_u32 s64, s64, 1
s_cmp_gt_u32 s64, 2000000
s_cbranch_scc1 L_w_done_A
s_cmp_ge_u32 s41, 40
s_cbranch_scc1 L_wc_22x_A
s_cmp_eq_u32 s98, 1
s_cbranch_scc1 L_sl_23_A
s_sleep 40
L_sl_23_A:
s_sleep 4
s_branch L_wc_22_A
L_wc_22x_A:
s_barrier
s_branch L_b_fgo_A
L_b_fw120_A:
s_cmp_lg_u32 s28, 0
s_cbranch_scc1 L_wc_24x_A
v_mov_b32 v17, s60
s_nop 1
L_wc_24_A:
buffer_load_dword v18, v17, s[20:23], 0 offen sc1
s_waitcnt vmcnt(0)
v_readfirstlane_b32 s41, v18
s_add_u32 s64, s64, 1
s_cmp_gt_u32 s64, 2000000
s_cbranch_scc1 L_w_done_A
s_cmp_ge_u32 s41, 104
s_cbranch_scc1 L_wc_24x_A
s_cmp_eq_u32 s98, 1
s_cbranch_scc1 L_sl_25_A
s_sleep 40
L_sl_25_A:
s_sleep 4
s_branch L_wc_24_A
L_wc_24x_A:
s_barrier
L_b_fgo_A:
s_mov_b32 s80, s72
s_mov_b32 s81, s73
s_mov_b32 s82, 2621440
s_mov_b32 s83, 0x00020000
s_mov_b32 s84, s70
s_mov_b32 s85, s71
s_mov_b32 s86, 1280
s_mov_b32 s87, 0x00020000
s_mov_b32 s88, s74
s_mov_b32 s89, s75
s_mov_b32 s90, 2621440
s_mov_b32 s91, 0x00020000
v_and_b32 v134, 31, v1
v_mul_u32_u24 v134, 1280, v134
v_lshrrev_b32 v135, 5, v1
v_lshlrev_b32 v135, 3, v135
s_cmp_eq_u32 s98, 1
s_cbranch_scc1 L_f_fine_A
s_lshl_b32 s101, s65, 3
s_add_u32 s101, s101, s29
s_mul_i32 s101, s101, 20
s_add_u32 s101, s101, s28
s_add_u32 s100, s101, 0
s_mul_i32 s40, s52, 655360
s_add_u32 s40, s40, 126038016
s_lshl_b32 s41, s100, 10
s_add_u32 s40, s40, s41
buffer_load_dwordx4 v[136:139], v128, s[20:23], s40 offen sc1
s_mul_i32 s40, s52, 655360
s_add_u32 s40, s40, 131280896
s_lshl_b32 s41, s100, 10
s_add_u32 s40, s40, s41
buffer_load_dwordx4 v[140:143], v128, s[20:23], s40 offen sc1
s_mul_i32 s40, s52, 655360
s_add_u32 s40, s40, 136523776
s_lshl_b32 s41, s100, 10
s_add_u32 s40, s40, s41
buffer_load_dwordx4 v[144:147], v128, s[20:23], s40 offen sc1
s_mul_i32 s40, s52, 655360
s_add_u32 s40, s40, 141766656
s_lshl_b32 s41, s100, 10
s_add_u32 s40, s40, s41
buffer_load_dwordx4 v[148:151], v128, s[20:23], s40 offen sc1
s_mul_i32 s40, s52, 655360
s_add_u32 s40, s40, 147009536
s_lshl_b32 s41, s100, 10
s_add_u32 s40, s40, s41
buffer_load_dwordx4 v[152:155], v128, s[20:23], s40 offen sc1
s_mul_i32 s40, s52, 655360
s_add_u32 s40, s40, 152252416
s_lshl_b32 s41, s100, 10
s_add_u32 s40, s40, s41
buffer_load_dwordx4 v[156:159], v128, s[20:23], s40 offen sc1
s_mul_i32 s40, s52, 655360
s_add_u32 s40, s40, 157495296
s_lshl_b32 s41, s100, 10
s_add_u32 s40, s40, s41
buffer_load_dwordx4 v[160:163], v128, s[20:23], s40 offen sc1
s_mul_i32 s40, s52, 655360
s_add_u32 s40, s40, 162738176
s_lshl_b32 s41, s100, 10
s_add_u32 s40, s40, s41
buffer_load_dwordx4 v[164:167], v128, s[20:23], s40 offen sc1
s_mul_i32 s40, s52, 655360
s_add_u32 s40, s40, 167981056
s_lshl_b32 s41, s100, 10
s_add_u32 s40, s40, s41
buffer_load_dwordx4 v[168:171], v128, s[20:23], s40 offen sc1
s_mul_i32 s40, s52, 655360
s_add_u32 s40, s40, 173223936
s_lshl_b32 s41, s100, 10
s_add_u32 s40, s40, s41
buffer_load_dwordx4 v[172:175], v128, s[20:23], s40 offen sc1
s_and_b32 s60, s100, 3
s_lshr_b32 s61, s100, 2
s_mul_i32 s40, s61, 52429
s_lshr_b32 s40, s40, 18
s_mul_i32 s41, s40, 5
s_sub_u32 s61, s61, s41
s_lshl_b32 s61, s61, 5
s_lshl_b32 s60, s60, 3
s_add_u32 s61, s61, s60
s_lshr_b32 s41, s40, 3
s_mul_i32 s41, s41, 160
s_add_u32 s61, s61, s41
s_lshl_b32 s61, s61, 1
s_and_b32 s40, s40, 7
s_lshl_b32 s40, s40, 5
s_lshl_b32 s41, s52, 8
s_add_u32 s40, s40, s41
s_mul_i32 s40, s40, 1280
v_add_u32 v181, s61, v135
v_add3_u32 v180, v134, v181, s40
buffer_load_dwordx2 v[176:177], v180, s[80:83], 0 offen
buffer_load_dwordx2 v[178:179], v181, s[84:87], 0 offen
s_add_u32 s100, s101, 4
s_mul_i32 s40, s52, 655360
s_add_u32 s40, s40, 126038016
s_lshl_b32 s41, s100, 10
s_add_u32 s40, s40, s41
buffer_load_dwordx4 v[184:187], v128, s[20:23], s40 offen sc1
s_mul_i32 s40, s52, 655360
s_add_u32 s40, s40, 131280896
s_lshl_b32 s41, s100, 10
s_add_u32 s40, s40, s41
buffer_load_dwordx4 v[188:191], v128, s[20:23], s40 offen sc1
s_mul_i32 s40, s52, 655360
s_add_u32 s40, s40, 136523776
s_lshl_b32 s41, s100, 10
s_add_u32 s40, s40, s41
buffer_load_dwordx4 v[192:195], v128, s[20:23], s40 offen sc1
s_mul_i32 s40, s52, 655360
s_add_u32 s40, s40, 141766656
s_lshl_b32 s41, s100, 10
s_add_u32 s40, s40, s41
buffer_load_dwordx4 v[196:199], v128, s[20:23], s40 offen sc1
s_mul_i32 s40, s52, 655360
s_add_u32 s40, s40, 147009536
s_lshl_b32 s41, s100, 10
s_add_u32 s40, s40, s41
buffer_load_dwordx4 v[200:203], v128, s[20:23], s40 offen sc1
s_mul_i32 s40, s52, 655360
s_add_u32 s40, s40, 152252416
s_lshl_b32 s41, s100, 10
s_add_u32 s40, s40, s41
buffer_load_dwordx4 v[204:207], v128, s[20:23], s40 offen sc1
s_mul_i32 s40, s52, 655360
s_add_u32 s40, s40, 157495296
s_lshl_b32 s41, s100, 10
s_add_u32 s40, s40, s41
buffer_load_dwordx4 v[208:211], v128, s[20:23], s40 offen sc1
s_mul_i32 s40, s52, 655360
s_add_u32 s40, s40, 162738176
s_lshl_b32 s41, s100, 10
s_add_u32 s40, s40, s41
buffer_load_dwordx4 v[212:215], v128, s[20:23], s40 offen sc1
s_mul_i32 s40, s52, 655360
s_add_u32 s40, s40, 167981056
s_lshl_b32 s41, s100, 10
s_add_u32 s40, s40, s41
buffer_load_dwordx4 v[216:219], v128, s[20:23], s40 offen sc1
s_mul_i32 s40, s52, 655360
s_add_u32 s40, s40, 173223936
s_lshl_b32 s41, s100, 10
s_add_u32 s40, s40, s41
buffer_load_dwordx4 v[220:223], v128, s[20:23], s40 offen sc1
s_and_b32 s60, s100, 3
s_lshr_b32 s61, s100, 2
s_mul_i32 s40, s61, 52429
s_lshr_b32 s40, s40, 18
s_mul_i32 s41, s40, 5
s_sub_u32 s61, s61, s41
s_lshl_b32 s61, s61, 5
s_lshl_b32 s60, s60, 3
s_add_u32 s61, s61, s60
s_lshr_b32 s41, s40, 3
s_mul_i32 s41, s41, 160
s_add_u32 s61, s61, s41
s_lshl_b32 s61, s61, 1
s_and_b32 s40, s40, 7
s_lshl_b32 s40, s40, 5
s_lshl_b32 s41, s52, 8
s_add_u32 s40, s40, s41
s_mul_i32 s40, s40, 1280
v_add_u32 v229, s61, v135
v_add3_u32 v228, v134, v229, s40
buffer_load_dwordx2 v[224:225], v228, s[80:83], 0 offen
buffer_load_dwordx2 v[226:227], v229, s[84:87], 0 offen
s_waitcnt vmcnt(0)
v_pk_add_f32 v[136:137], v[136:137], v[164:165]
v_pk_add_f32 v[138:139], v[138:139], v[166:167]
v_pk_add_f32 v[140:141], v[140:141], v[160:161]
v_pk_add_f32 v[142:143], v[142:143], v[162:163]
v_pk_add_f32 v[144:145], v[144:145], v[156:157]
v_pk_add_f32 v[146:147], v[146:147], v[158:159]
v_pk_add_f32 v[148:149], v[148:149], v[152:153]
v_pk_add_f32 v[150:151], v[150:151], v[154:155]
v_pk_add_f32 v[136:137], v[136:137], v[148:149]
v_pk_add_f32 v[138:139], v[138:139], v[150:151]
v_pk_add_f32 v[140:141], v[140:141], v[144:145]
v_pk_add_f32 v[142:143], v[142:143], v[146:147]
v_pk_add_f32 v[136:137], v[136:137], v[140:141]
v_pk_add_f32 v[138:139], v[138:139], v[142:143]
v_pk_add_f32 v[168:169], v[168:169], v[172:173]
v_pk_add_f32 v[170:171], v[170:171], v[174:175]
v_cvt_pk_bf16_f32 v12, v136, v137
v_lshlrev_b32 v136, 16, v12
v_and_b32 v137, 0xffff0000, v12
v_cvt_pk_bf16_f32 v12, v138, v139
v_lshlrev_b32 v138, 16, v12
v_and_b32 v139, 0xffff0000, v12
v_cvt_pk_bf16_f32 v12, v168, v169
v_lshlrev_b32 v168, 16, v12
v_and_b32 v169, 0xffff0000, v12
v_cvt_pk_bf16_f32 v12, v170, v171
v_lshlrev_b32 v170, 16, v12
v_and_b32 v171, 0xffff0000, v12
v_lshlrev_b32 v4, 16, v176
v_and_b32 v5, 0xffff0000, v176
v_lshlrev_b32 v6, 16, v177
v_and_b32 v7, 0xffff0000, v177
v_lshlrev_b32 v8, 16, v178
v_and_b32 v9, 0xffff0000, v178
v_lshlrev_b32 v10, 16, v179
v_and_b32 v11, 0xffff0000, v179
v_add_f32 v136, v4, v136
v_add_f32 v168, v168, v8
v_add_f32 v137, v5, v137
v_add_f32 v169, v169, v9
v_add_f32 v138, v6, v138
v_add_f32 v170, v170, v10
v_add_f32 v139, v7, v139
v_add_f32 v171, v171, v11
v_cvt_pk_bf16_f32 v12, v136, v137
v_lshlrev_b32 v136, 16, v12
v_and_b32 v137, 0xffff0000, v12
v_cvt_pk_bf16_f32 v12, v138, v139
v_lshlrev_b32 v138, 16, v12
v_and_b32 v139, 0xffff0000, v12
v_cvt_pk_bf16_f32 v12, v168, v169
v_lshlrev_b32 v168, 16, v12
v_and_b32 v169, 0xffff0000, v12
v_cvt_pk_bf16_f32 v12, v170, v171
v_lshlrev_b32 v170, 16, v12
v_and_b32 v171, 0xffff0000, v12
v_add_f32 v136, v136, v168
v_add_f32 v137, v137, v169
v_add_f32 v138, v138, v170
v_add_f32 v139, v139, v171
v_cvt_pk_bf16_f32 v12, v136, v137
v_cvt_pk_bf16_f32 v13, v138, v139
buffer_store_dwordx2 v[12:13], v180, s[88:91], 0 offen
v_pk_add_f32 v[184:185], v[184:185], v[212:213]
v_pk_add_f32 v[186:187], v[186:187], v[214:215]
v_pk_add_f32 v[188:189], v[188:189], v[208:209]
v_pk_add_f32 v[190:191], v[190:191], v[210:211]
v_pk_add_f32 v[192:193], v[192:193], v[204:205]
v_pk_add_f32 v[194:195], v[194:195], v[206:207]
v_pk_add_f32 v[196:197], v[196:197], v[200:201]
v_pk_add_f32 v[198:199], v[198:199], v[202:203]
v_pk_add_f32 v[184:185], v[184:185], v[196:197]
v_pk_add_f32 v[186:187], v[186:187], v[198:199]
v_pk_add_f32 v[188:189], v[188:189], v[192:193]
v_pk_add_f32 v[190:191], v[190:191], v[194:195]
v_pk_add_f32 v[184:185], v[184:185], v[188:189]
v_pk_add_f32 v[186:187], v[186:187], v[190:191]
v_pk_add_f32 v[216:217], v[216:217], v[220:221]
v_pk_add_f32 v[218:219], v[218:219], v[222:223]
v_cvt_pk_bf16_f32 v12, v184, v185
v_lshlrev_b32 v184, 16, v12
v_and_b32 v185, 0xffff0000, v12
v_cvt_pk_bf16_f32 v12, v186, v187
v_lshlrev_b32 v186, 16, v12
v_and_b32 v187, 0xffff0000, v12
v_cvt_pk_bf16_f32 v12, v216, v217
v_lshlrev_b32 v216, 16, v12
v_and_b32 v217, 0xffff0000, v12
v_cvt_pk_bf16_f32 v12, v218, v219
v_lshlrev_b32 v218, 16, v12
v_and_b32 v219, 0xffff0000, v12
v_lshlrev_b32 v4, 16, v224
v_and_b32 v5, 0xffff0000, v224
v_lshlrev_b32 v6, 16, v225
v_and_b32 v7, 0xffff0000, v225
v_lshlrev_b32 v8, 16, v226
v_and_b32 v9, 0xffff0000, v226
v_lshlrev_b32 v10, 16, v227
v_and_b32 v11, 0xffff0000, v227
v_add_f32 v184, v4, v184
v_add_f32 v216, v216, v8
v_add_f32 v185, v5, v185
v_add_f32 v217, v217, v9
v_add_f32 v186, v6, v186
v_add_f32 v218, v218, v10
v_add_f32 v187, v7, v187
v_add_f32 v219, v219, v11
v_cvt_pk_bf16_f32 v12, v184, v185
v_lshlrev_b32 v184, 16, v12
v_and_b32 v185, 0xffff0000, v12
v_cvt_pk_bf16_f32 v12, v186, v187
v_lshlrev_b32 v186, 16, v12
v_and_b32 v187, 0xffff0000, v12
v_cvt_pk_bf16_f32 v12, v216, v217
v_lshlrev_b32 v216, 16, v12
v_and_b32 v217, 0xffff0000, v12
v_cvt_pk_bf16_f32 v12, v218, v219
v_lshlrev_b32 v218, 16, v12
v_and_b32 v219, 0xffff0000, v12
v_add_f32 v184, v184, v216
v_add_f32 v185, v185, v217
v_add_f32 v186, v186, v218
v_add_f32 v187, v187, v219
v_cvt_pk_bf16_f32 v12, v184, v185
v_cvt_pk_bf16_f32 v13, v186, v187
buffer_store_dwordx2 v[12:13], v228, s[88:91], 0 offen
s_add_u32 s100, s101, 8
s_mul_i32 s40, s52, 655360
s_add_u32 s40, s40, 126038016
s_lshl_b32 s41, s100, 10
s_add_u32 s40, s40, s41
buffer_load_dwordx4 v[136:139], v128, s[20:23], s40 offen sc1
s_mul_i32 s40, s52, 655360
s_add_u32 s40, s40, 131280896
s_lshl_b32 s41, s100, 10
s_add_u32 s40, s40, s41
buffer_load_dwordx4 v[140:143], v128, s[20:23], s40 offen sc1
s_mul_i32 s40, s52, 655360
s_add_u32 s40, s40, 136523776
s_lshl_b32 s41, s100, 10
s_add_u32 s40, s40, s41
buffer_load_dwordx4 v[144:147], v128, s[20:23], s40 offen sc1
s_mul_i32 s40, s52, 655360
s_add_u32 s40, s40, 141766656
s_lshl_b32 s41, s100, 10
s_add_u32 s40, s40, s41
buffer_load_dwordx4 v[148:151], v128, s[20:23], s40 offen sc1
s_mul_i32 s40, s52, 655360
s_add_u32 s40, s40, 147009536
s_lshl_b32 s41, s100, 10
s_add_u32 s40, s40, s41
buffer_load_dwordx4 v[152:155], v128, s[20:23], s40 offen sc1
s_mul_i32 s40, s52, 655360
s_add_u32 s40, s40, 152252416
s_lshl_b32 s41, s100, 10
s_add_u32 s40, s40, s41
buffer_load_dwordx4 v[156:159], v128, s[20:23], s40 offen sc1
s_mul_i32 s40, s52, 655360
s_add_u32 s40, s40, 157495296
s_lshl_b32 s41, s100, 10
s_add_u32 s40, s40, s41
buffer_load_dwordx4 v[160:163], v128, s[20:23], s40 offen sc1
s_mul_i32 s40, s52, 655360
s_add_u32 s40, s40, 162738176
s_lshl_b32 s41, s100, 10
s_add_u32 s40, s40, s41
buffer_load_dwordx4 v[164:167], v128, s[20:23], s40 offen sc1
s_mul_i32 s40, s52, 655360
s_add_u32 s40, s40, 167981056
s_lshl_b32 s41, s100, 10
s_add_u32 s40, s40, s41
buffer_load_dwordx4 v[168:171], v128, s[20:23], s40 offen sc1
s_mul_i32 s40, s52, 655360
s_add_u32 s40, s40, 173223936
s_lshl_b32 s41, s100, 10
s_add_u32 s40, s40, s41
buffer_load_dwordx4 v[172:175], v128, s[20:23], s40 offen sc1
s_and_b32 s60, s100, 3
s_lshr_b32 s61, s100, 2
s_mul_i32 s40, s61, 52429
s_lshr_b32 s40, s40, 18
s_mul_i32 s41, s40, 5
s_sub_u32 s61, s61, s41
s_lshl_b32 s61, s61, 5
s_lshl_b32 s60, s60, 3
s_add_u32 s61, s61, s60
s_lshr_b32 s41, s40, 3
s_mul_i32 s41, s41, 160
s_add_u32 s61, s61, s41
s_lshl_b32 s61, s61, 1
s_and_b32 s40, s40, 7
s_lshl_b32 s40, s40, 5
s_lshl_b32 s41, s52, 8
s_add_u32 s40, s40, s41
s_mul_i32 s40, s40, 1280
v_add_u32 v181, s61, v135
v_add3_u32 v180, v134, v181, s40
buffer_load_dwordx2 v[176:177], v180, s[80:83], 0 offen
buffer_load_dwordx2 v[178:179], v181, s[84:87], 0 offen
s_add_u32 s100, s101, 12
s_mul_i32 s40, s52, 655360
s_add_u32 s40, s40, 126038016
s_lshl_b32 s41, s100, 10
s_add_u32 s40, s40, s41
buffer_load_dwordx4 v[184:187], v128, s[20:23], s40 offen sc1
s_mul_i32 s40, s52, 655360
s_add_u32 s40, s40, 131280896
s_lshl_b32 s41, s100, 10
s_add_u32 s40, s40, s41
buffer_load_dwordx4 v[188:191], v128, s[20:23], s40 offen sc1
s_mul_i32 s40, s52, 655360
s_add_u32 s40, s40, 136523776
s_lshl_b32 s41, s100, 10
s_add_u32 s40, s40, s41
buffer_load_dwordx4 v[192:195], v128, s[20:23], s40 offen sc1
s_mul_i32 s40, s52, 655360
s_add_u32 s40, s40, 141766656
s_lshl_b32 s41, s100, 10
s_add_u32 s40, s40, s41
buffer_load_dwordx4 v[196:199], v128, s[20:23], s40 offen sc1
s_mul_i32 s40, s52, 655360
s_add_u32 s40, s40, 147009536
s_lshl_b32 s41, s100, 10
s_add_u32 s40, s40, s41
buffer_load_dwordx4 v[200:203], v128, s[20:23], s40 offen sc1
s_mul_i32 s40, s52, 655360
s_add_u32 s40, s40, 152252416
s_lshl_b32 s41, s100, 10
s_add_u32 s40, s40, s41
buffer_load_dwordx4 v[204:207], v128, s[20:23], s40 offen sc1
s_mul_i32 s40, s52, 655360
s_add_u32 s40, s40, 157495296
s_lshl_b32 s41, s100, 10
s_add_u32 s40, s40, s41
buffer_load_dwordx4 v[208:211], v128, s[20:23], s40 offen sc1
s_mul_i32 s40, s52, 655360
s_add_u32 s40, s40, 162738176
s_lshl_b32 s41, s100, 10
s_add_u32 s40, s40, s41
buffer_load_dwordx4 v[212:215], v128, s[20:23], s40 offen sc1
s_mul_i32 s40, s52, 655360
s_add_u32 s40, s40, 167981056
s_lshl_b32 s41, s100, 10
s_add_u32 s40, s40, s41
buffer_load_dwordx4 v[216:219], v128, s[20:23], s40 offen sc1
s_mul_i32 s40, s52, 655360
s_add_u32 s40, s40, 173223936
s_lshl_b32 s41, s100, 10
s_add_u32 s40, s40, s41
buffer_load_dwordx4 v[220:223], v128, s[20:23], s40 offen sc1
s_and_b32 s60, s100, 3
s_lshr_b32 s61, s100, 2
s_mul_i32 s40, s61, 52429
s_lshr_b32 s40, s40, 18
s_mul_i32 s41, s40, 5
s_sub_u32 s61, s61, s41
s_lshl_b32 s61, s61, 5
s_lshl_b32 s60, s60, 3
s_add_u32 s61, s61, s60
s_lshr_b32 s41, s40, 3
s_mul_i32 s41, s41, 160
s_add_u32 s61, s61, s41
s_lshl_b32 s61, s61, 1
s_and_b32 s40, s40, 7
s_lshl_b32 s40, s40, 5
s_lshl_b32 s41, s52, 8
s_add_u32 s40, s40, s41
s_mul_i32 s40, s40, 1280
v_add_u32 v229, s61, v135
v_add3_u32 v228, v134, v229, s40
buffer_load_dwordx2 v[224:225], v228, s[80:83], 0 offen
buffer_load_dwordx2 v[226:227], v229, s[84:87], 0 offen
s_waitcnt vmcnt(0)
v_pk_add_f32 v[136:137], v[136:137], v[164:165]
v_pk_add_f32 v[138:139], v[138:139], v[166:167]
v_pk_add_f32 v[140:141], v[140:141], v[160:161]
v_pk_add_f32 v[142:143], v[142:143], v[162:163]
v_pk_add_f32 v[144:145], v[144:145], v[156:157]
v_pk_add_f32 v[146:147], v[146:147], v[158:159]
v_pk_add_f32 v[148:149], v[148:149], v[152:153]
v_pk_add_f32 v[150:151], v[150:151], v[154:155]
v_pk_add_f32 v[136:137], v[136:137], v[148:149]
v_pk_add_f32 v[138:139], v[138:139], v[150:151]
v_pk_add_f32 v[140:141], v[140:141], v[144:145]
v_pk_add_f32 v[142:143], v[142:143], v[146:147]
v_pk_add_f32 v[136:137], v[136:137], v[140:141]
v_pk_add_f32 v[138:139], v[138:139], v[142:143]
v_pk_add_f32 v[168:169], v[168:169], v[172:173]
v_pk_add_f32 v[170:171], v[170:171], v[174:175]
v_cvt_pk_bf16_f32 v12, v136, v137
v_lshlrev_b32 v136, 16, v12
v_and_b32 v137, 0xffff0000, v12
v_cvt_pk_bf16_f32 v12, v138, v139
v_lshlrev_b32 v138, 16, v12
v_and_b32 v139, 0xffff0000, v12
v_cvt_pk_bf16_f32 v12, v168, v169
v_lshlrev_b32 v168, 16, v12
v_and_b32 v169, 0xffff0000, v12
v_cvt_pk_bf16_f32 v12, v170, v171
v_lshlrev_b32 v170, 16, v12
v_and_b32 v171, 0xffff0000, v12
v_lshlrev_b32 v4, 16, v176
v_and_b32 v5, 0xffff0000, v176
v_lshlrev_b32 v6, 16, v177
v_and_b32 v7, 0xffff0000, v177
v_lshlrev_b32 v8, 16, v178
v_and_b32 v9, 0xffff0000, v178
v_lshlrev_b32 v10, 16, v179
v_and_b32 v11, 0xffff0000, v179
v_add_f32 v136, v4, v136
v_add_f32 v168, v168, v8
v_add_f32 v137, v5, v137
v_add_f32 v169, v169, v9
v_add_f32 v138, v6, v138
v_add_f32 v170, v170, v10
v_add_f32 v139, v7, v139
v_add_f32 v171, v171, v11
v_cvt_pk_bf16_f32 v12, v136, v137
v_lshlrev_b32 v136, 16, v12
v_and_b32 v137, 0xffff0000, v12
v_cvt_pk_bf16_f32 v12, v138, v139
v_lshlrev_b32 v138, 16, v12
v_and_b32 v139, 0xffff0000, v12
v_cvt_pk_bf16_f32 v12, v168, v169
v_lshlrev_b32 v168, 16, v12
v_and_b32 v169, 0xffff0000, v12
v_cvt_pk_bf16_f32 v12, v170, v171
v_lshlrev_b32 v170, 16, v12
v_and_b32 v171, 0xffff0000, v12
v_add_f32 v136, v136, v168
v_add_f32 v137, v137, v169
v_add_f32 v138, v138, v170
v_add_f32 v139, v139, v171
v_cvt_pk_bf16_f32 v12, v136, v137
v_cvt_pk_bf16_f32 v13, v138, v139
buffer_store_dwordx2 v[12:13], v180, s[88:91], 0 offen
v_pk_add_f32 v[184:185], v[184:185], v[212:213]
v_pk_add_f32 v[186:187], v[186:187], v[214:215]
v_pk_add_f32 v[188:189], v[188:189], v[208:209]
v_pk_add_f32 v[190:191], v[190:191], v[210:211]
v_pk_add_f32 v[192:193], v[192:193], v[204:205]
v_pk_add_f32 v[194:195], v[194:195], v[206:207]
v_pk_add_f32 v[196:197], v[196:197], v[200:201]
v_pk_add_f32 v[198:199], v[198:199], v[202:203]
v_pk_add_f32 v[184:185], v[184:185], v[196:197]
v_pk_add_f32 v[186:187], v[186:187], v[198:199]
v_pk_add_f32 v[188:189], v[188:189], v[192:193]
v_pk_add_f32 v[190:191], v[190:191], v[194:195]
v_pk_add_f32 v[184:185], v[184:185], v[188:189]
v_pk_add_f32 v[186:187], v[186:187], v[190:191]
v_pk_add_f32 v[216:217], v[216:217], v[220:221]
v_pk_add_f32 v[218:219], v[218:219], v[222:223]
v_cvt_pk_bf16_f32 v12, v184, v185
v_lshlrev_b32 v184, 16, v12
v_and_b32 v185, 0xffff0000, v12
v_cvt_pk_bf16_f32 v12, v186, v187
v_lshlrev_b32 v186, 16, v12
v_and_b32 v187, 0xffff0000, v12
v_cvt_pk_bf16_f32 v12, v216, v217
v_lshlrev_b32 v216, 16, v12
v_and_b32 v217, 0xffff0000, v12
v_cvt_pk_bf16_f32 v12, v218, v219
v_lshlrev_b32 v218, 16, v12
v_and_b32 v219, 0xffff0000, v12
v_lshlrev_b32 v4, 16, v224
v_and_b32 v5, 0xffff0000, v224
v_lshlrev_b32 v6, 16, v225
v_and_b32 v7, 0xffff0000, v225
v_lshlrev_b32 v8, 16, v226
v_and_b32 v9, 0xffff0000, v226
v_lshlrev_b32 v10, 16, v227
v_and_b32 v11, 0xffff0000, v227
v_add_f32 v184, v4, v184
v_add_f32 v216, v216, v8
v_add_f32 v185, v5, v185
v_add_f32 v217, v217, v9
v_add_f32 v186, v6, v186
v_add_f32 v218, v218, v10
v_add_f32 v187, v7, v187
v_add_f32 v219, v219, v11
v_cvt_pk_bf16_f32 v12, v184, v185
v_lshlrev_b32 v184, 16, v12
v_and_b32 v185, 0xffff0000, v12
v_cvt_pk_bf16_f32 v12, v186, v187
v_lshlrev_b32 v186, 16, v12
v_and_b32 v187, 0xffff0000, v12
v_cvt_pk_bf16_f32 v12, v216, v217
v_lshlrev_b32 v216, 16, v12
v_and_b32 v217, 0xffff0000, v12
v_cvt_pk_bf16_f32 v12, v218, v219
v_lshlrev_b32 v218, 16, v12
v_and_b32 v219, 0xffff0000, v12
v_add_f32 v184, v184, v216
v_add_f32 v185, v185, v217
v_add_f32 v186, v186, v218
v_add_f32 v187, v187, v219
v_cvt_pk_bf16_f32 v12, v184, v185
v_cvt_pk_bf16_f32 v13, v186, v187
buffer_store_dwordx2 v[12:13], v228, s[88:91], 0 offen
s_add_u32 s100, s101, 16
s_mul_i32 s40, s52, 655360
s_add_u32 s40, s40, 126038016
s_lshl_b32 s41, s100, 10
s_add_u32 s40, s40, s41
buffer_load_dwordx4 v[136:139], v128, s[20:23], s40 offen sc1
s_mul_i32 s40, s52, 655360
s_add_u32 s40, s40, 131280896
s_lshl_b32 s41, s100, 10
s_add_u32 s40, s40, s41
buffer_load_dwordx4 v[140:143], v128, s[20:23], s40 offen sc1
s_mul_i32 s40, s52, 655360
s_add_u32 s40, s40, 136523776
s_lshl_b32 s41, s100, 10
s_add_u32 s40, s40, s41
buffer_load_dwordx4 v[144:147], v128, s[20:23], s40 offen sc1
s_mul_i32 s40, s52, 655360
s_add_u32 s40, s40, 141766656
s_lshl_b32 s41, s100, 10
s_add_u32 s40, s40, s41
buffer_load_dwordx4 v[148:151], v128, s[20:23], s40 offen sc1
s_mul_i32 s40, s52, 655360
s_add_u32 s40, s40, 147009536
s_lshl_b32 s41, s100, 10
s_add_u32 s40, s40, s41
buffer_load_dwordx4 v[152:155], v128, s[20:23], s40 offen sc1
s_mul_i32 s40, s52, 655360
s_add_u32 s40, s40, 152252416
s_lshl_b32 s41, s100, 10
s_add_u32 s40, s40, s41
buffer_load_dwordx4 v[156:159], v128, s[20:23], s40 offen sc1
s_mul_i32 s40, s52, 655360
s_add_u32 s40, s40, 157495296
s_lshl_b32 s41, s100, 10
s_add_u32 s40, s40, s41
buffer_load_dwordx4 v[160:163], v128, s[20:23], s40 offen sc1
s_mul_i32 s40, s52, 655360
s_add_u32 s40, s40, 162738176
s_lshl_b32 s41, s100, 10
s_add_u32 s40, s40, s41
buffer_load_dwordx4 v[164:167], v128, s[20:23], s40 offen sc1
s_mul_i32 s40, s52, 655360
s_add_u32 s40, s40, 167981056
s_lshl_b32 s41, s100, 10
s_add_u32 s40, s40, s41
buffer_load_dwordx4 v[168:171], v128, s[20:23], s40 offen sc1
s_mul_i32 s40, s52, 655360
s_add_u32 s40, s40, 173223936
s_lshl_b32 s41, s100, 10
s_add_u32 s40, s40, s41
buffer_load_dwordx4 v[172:175], v128, s[20:23], s40 offen sc1
s_and_b32 s60, s100, 3
s_lshr_b32 s61, s100, 2
s_mul_i32 s40, s61, 52429
s_lshr_b32 s40, s40, 18
s_mul_i32 s41, s40, 5
s_sub_u32 s61, s61, s41
s_lshl_b32 s61, s61, 5
s_lshl_b32 s60, s60, 3
s_add_u32 s61, s61, s60
s_lshr_b32 s41, s40, 3
s_mul_i32 s41, s41, 160
s_add_u32 s61, s61, s41
s_lshl_b32 s61, s61, 1
s_and_b32 s40, s40, 7
s_lshl_b32 s40, s40, 5
s_lshl_b32 s41, s52, 8
s_add_u32 s40, s40, s41
s_mul_i32 s40, s40, 1280
v_add_u32 v181, s61, v135
v_add3_u32 v180, v134, v181, s40
buffer_load_dwordx2 v[176:177], v180, s[80:83], 0 offen
buffer_load_dwordx2 v[178:179], v181, s[84:87], 0 offen
s_waitcnt vmcnt(0)
v_pk_add_f32 v[136:137], v[136:137], v[164:165]
v_pk_add_f32 v[138:139], v[138:139], v[166:167]
v_pk_add_f32 v[140:141], v[140:141], v[160:161]
v_pk_add_f32 v[142:143], v[142:143], v[162:163]
v_pk_add_f32 v[144:145], v[144:145], v[156:157]
v_pk_add_f32 v[146:147], v[146:147], v[158:159]
v_pk_add_f32 v[148:149], v[148:149], v[152:153]
v_pk_add_f32 v[150:151], v[150:151], v[154:155]
v_pk_add_f32 v[136:137], v[136:137], v[148:149]
v_pk_add_f32 v[138:139], v[138:139], v[150:151]
v_pk_add_f32 v[140:141], v[140:141], v[144:145]
v_pk_add_f32 v[142:143], v[142:143], v[146:147]
v_pk_add_f32 v[136:137], v[136:137], v[140:141]
v_pk_add_f32 v[138:139], v[138:139], v[142:143]
v_pk_add_f32 v[168:169], v[168:169], v[172:173]
v_pk_add_f32 v[170:171], v[170:171], v[174:175]
v_cvt_pk_bf16_f32 v12, v136, v137
v_lshlrev_b32 v136, 16, v12
v_and_b32 v137, 0xffff0000, v12
v_cvt_pk_bf16_f32 v12, v138, v139
v_lshlrev_b32 v138, 16, v12
v_and_b32 v139, 0xffff0000, v12
v_cvt_pk_bf16_f32 v12, v168, v169
v_lshlrev_b32 v168, 16, v12
v_and_b32 v169, 0xffff0000, v12
v_cvt_pk_bf16_f32 v12, v170, v171
v_lshlrev_b32 v170, 16, v12
v_and_b32 v171, 0xffff0000, v12
v_lshlrev_b32 v4, 16, v176
v_and_b32 v5, 0xffff0000, v176
v_lshlrev_b32 v6, 16, v177
v_and_b32 v7, 0xffff0000, v177
v_lshlrev_b32 v8, 16, v178
v_and_b32 v9, 0xffff0000, v178
v_lshlrev_b32 v10, 16, v179
v_and_b32 v11, 0xffff0000, v179
v_add_f32 v136, v4, v136
v_add_f32 v168, v168, v8
v_add_f32 v137, v5, v137
v_add_f32 v169, v169, v9
v_add_f32 v138, v6, v138
v_add_f32 v170, v170, v10
v_add_f32 v139, v7, v139
v_add_f32 v171, v171, v11
v_cvt_pk_bf16_f32 v12, v136, v137
v_lshlrev_b32 v136, 16, v12
v_and_b32 v137, 0xffff0000, v12
v_cvt_pk_bf16_f32 v12, v138, v139
v_lshlrev_b32 v138, 16, v12
v_and_b32 v139, 0xffff0000, v12
v_cvt_pk_bf16_f32 v12, v168, v169
v_lshlrev_b32 v168, 16, v12
v_and_b32 v169, 0xffff0000, v12
v_cvt_pk_bf16_f32 v12, v170, v171
v_lshlrev_b32 v170, 16, v12
v_and_b32 v171, 0xffff0000, v12
v_add_f32 v136, v136, v168
v_add_f32 v137, v137, v169
v_add_f32 v138, v138, v170
v_add_f32 v139, v139, v171
v_cvt_pk_bf16_f32 v12, v136, v137
v_cvt_pk_bf16_f32 v13, v138, v139
buffer_store_dwordx2 v[12:13], v180, s[88:91], 0 offen
s_branch L_b_next_A
L_f_fine_A:
s_lshl_b32 s101, s29, 4
s_add_u32 s101, s101, s63
s_mul_i32 s101, s101, 5
s_add_u32 s100, s101, s28
s_mov_b32 s40, 178614272
s_lshl_b32 s41, s100, 10
s_add_u32 s40, s40, s41
buffer_load_dwordx4 v[136:139], v128, s[20:23], s40 offen sc1
s_mov_b32 s40, 179269632
s_lshl_b32 s41, s100, 10
s_add_u32 s40, s40, s41
buffer_load_dwordx4 v[140:143], v128, s[20:23], s40 offen sc1
s_mov_b32 s40, 179924992
s_lshl_b32 s41, s100, 10
s_add_u32 s40, s40, s41
buffer_load_dwordx4 v[144:147], v128, s[20:23], s40 offen sc1
s_mov_b32 s40, 180580352
s_lshl_b32 s41, s100, 10
s_add_u32 s40, s40, s41
buffer_load_dwordx4 v[148:151], v128, s[20:23], s40 offen sc1
s_mov_b32 s40, 181235712
s_lshl_b32 s41, s100, 10
s_add_u32 s40, s40, s41
buffer_load_dwordx4 v[152:155], v128, s[20:23], s40 offen sc1
s_mov_b32 s40, 181891072
s_lshl_b32 s41, s100, 10
s_add_u32 s40, s40, s41
buffer_load_dwordx4 v[156:159], v128, s[20:23], s40 offen sc1
s_mov_b32 s40, 182546432
s_lshl_b32 s41, s100, 10
s_add_u32 s40, s40, s41
buffer_load_dwordx4 v[160:163], v128, s[20:23], s40 offen sc1
s_mov_b32 s40, 183201792
s_lshl_b32 s41, s100, 10
s_add_u32 s40, s40, s41
buffer_load_dwordx4 v[164:167], v128, s[20:23], s40 offen sc1
s_mov_b32 s40, 183857152
s_lshl_b32 s41, s100, 10
s_add_u32 s40, s40, s41
buffer_load_dwordx4 v[168:171], v128, s[20:23], s40 offen sc1
s_mov_b32 s40, 184512512
s_lshl_b32 s41, s100, 10
s_add_u32 s40, s40, s41
buffer_load_dwordx4 v[172:175], v128, s[20:23], s40 offen sc1
s_mov_b32 s40, 185167872
s_lshl_b32 s41, s100, 10
s_add_u32 s40, s40, s41
buffer_load_dwordx4 v[176:179], v128, s[20:23], s40 offen sc1
s_mov_b32 s40, 185823232
s_lshl_b32 s41, s100, 10
s_add_u32 s40, s40, s41
buffer_load_dwordx4 v[180:183], v128, s[20:23], s40 offen sc1
s_mov_b32 s40, 186478592
s_lshl_b32 s41, s100, 10
s_add_u32 s40, s40, s41
buffer_load_dwordx4 v[184:187], v128, s[20:23], s40 offen sc1
s_mov_b32 s40, 187133952
s_lshl_b32 s41, s100, 10
s_add_u32 s40, s40, s41
buffer_load_dwordx4 v[188:191], v128, s[20:23], s40 offen sc1
s_mov_b32 s40, 187789312
s_lshl_b32 s41, s100, 10
s_add_u32 s40, s40, s41
buffer_load_dwordx4 v[192:195], v128, s[20:23], s40 offen sc1
s_mov_b32 s40, 188444672
s_lshl_b32 s41, s100, 10
s_add_u32 s40, s40, s41
buffer_load_dwordx4 v[196:199], v128, s[20:23], s40 offen sc1
s_mov_b32 s40, 189100032
s_lshl_b32 s41, s100, 10
s_add_u32 s40, s40, s41
buffer_load_dwordx4 v[200:203], v128, s[20:23], s40 offen sc1
s_mov_b32 s40, 189755392
s_lshl_b32 s41, s100, 10
s_add_u32 s40, s40, s41
buffer_load_dwordx4 v[204:207], v128, s[20:23], s40 offen sc1
s_mov_b32 s40, 190410752
s_lshl_b32 s41, s100, 10
s_add_u32 s40, s40, s41
buffer_load_dwordx4 v[208:211], v128, s[20:23], s40 offen sc1
s_mov_b32 s40, 191066112
s_lshl_b32 s41, s100, 10
s_add_u32 s40, s40, s41
buffer_load_dwordx4 v[212:215], v128, s[20:23], s40 offen sc1
s_mov_b32 s40, 191721472
s_lshl_b32 s41, s100, 10
s_add_u32 s40, s40, s41
buffer_load_dwordx4 v[216:219], v128, s[20:23], s40 offen sc1
s_mov_b32 s40, 192376832
s_lshl_b32 s41, s100, 10
s_add_u32 s40, s40, s41
buffer_load_dwordx4 v[220:223], v128, s[20:23], s40 offen sc1
s_mov_b32 s40, 193032192
s_lshl_b32 s41, s100, 10
s_add_u32 s40, s40, s41
buffer_load_dwordx4 v[224:227], v128, s[20:23], s40 offen sc1
s_mov_b32 s40, 193687552
s_lshl_b32 s41, s100, 10
s_add_u32 s40, s40, s41
buffer_load_dwordx4 v[228:231], v128, s[20:23], s40 offen sc1
s_mov_b32 s40, 172568576
s_lshl_b32 s41, s100, 10
s_add_u32 s40, s40, s41
buffer_load_dwordx4 v[232:235], v128, s[20:23], s40 offen sc1
s_mov_b32 s40, 177811456
s_lshl_b32 s41, s100, 10
s_add_u32 s40, s40, s41
buffer_load_dwordx4 v[236:239], v128, s[20:23], s40 offen sc1
s_and_b32 s60, s100, 3
s_lshr_b32 s61, s100, 2
s_mul_i32 s40, s61, 52429
s_lshr_b32 s40, s40, 18
s_mul_i32 s41, s40, 5
s_sub_u32 s61, s61, s41
s_lshl_b32 s61, s61, 5
s_lshl_b32 s60, s60, 3
s_add_u32 s61, s61, s60
s_lshr_b32 s41, s40, 3
s_mul_i32 s41, s41, 160
s_add_u32 s61, s61, s41
s_lshl_b32 s61, s61, 1
s_and_b32 s40, s40, 7
s_lshl_b32 s40, s40, 5
s_lshl_b32 s41, s52, 8
s_add_u32 s40, s40, s41
s_mul_i32 s40, s40, 1280
v_add_u32 v245, s61, v135
v_add3_u32 v244, v134, v245, s40
buffer_load_dwordx2 v[240:241], v244, s[80:83], 0 offen
buffer_load_dwordx2 v[242:243], v245, s[84:87], 0 offen
s_waitcnt vmcnt(0)
v_pk_add_f32 v[136:137], v[136:137], v[228:229]
v_pk_add_f32 v[138:139], v[138:139], v[230:231]
v_pk_add_f32 v[140:141], v[140:141], v[224:225]
v_pk_add_f32 v[142:143], v[142:143], v[226:227]
v_pk_add_f32 v[144:145], v[144:145], v[220:221]
v_pk_add_f32 v[146:147], v[146:147], v[222:223]
v_pk_add_f32 v[148:149], v[148:149], v[216:217]
v_pk_add_f32 v[150:151], v[150:151], v[218:219]
v_pk_add_f32 v[152:153], v[152:153], v[212:213]
v_pk_add_f32 v[154:155], v[154:155], v[214:215]
v_pk_add_f32 v[156:157], v[156:157], v[208:209]
v_pk_add_f32 v[158:159], v[158:159], v[210:211]
v_pk_add_f32 v[160:161], v[160:161], v[204:205]
v_pk_add_f32 v[162:163], v[162:163], v[206:207]
v_pk_add_f32 v[164:165], v[164:165], v[200:201]
v_pk_add_f32 v[166:167], v[166:167], v[202:203]
v_pk_add_f32 v[168:169], v[168:169], v[196:197]
v_pk_add_f32 v[170:171], v[170:171], v[198:199]
v_pk_add_f32 v[172:173], v[172:173], v[192:193]
v_pk_add_f32 v[174:175], v[174:175], v[194:195]
v_pk_add_f32 v[176:177], v[176:177], v[188:189]
v_pk_add_f32 v[178:179], v[178:179], v[190:191]
v_pk_add_f32 v[180:181], v[180:181], v[184:185]
v_pk_add_f32 v[182:183], v[182:183], v[186:187]
v_pk_add_f32 v[136:137], v[136:137], v[180:181]
v_pk_add_f32 v[138:139], v[138:139], v[182:183]
v_pk_add_f32 v[140:141], v[140:141], v[176:177]
v_pk_add_f32 v[142:143], v[142:143], v[178:179]
v_pk_add_f32 v[144:145], v[144:145], v[172:173]
v_pk_add_f32 v[146:147], v[146:147], v[174:175]
v_pk_add_f32 v[148:149], v[148:149], v[168:169]
v_pk_add_f32 v[150:151], v[150:151], v[170:171]
v_pk_add_f32 v[152:153], v[152:153], v[164:165]
v_pk_add_f32 v[154:155], v[154:155], v[166:167]
v_pk_add_f32 v[156:157], v[156:157], v[160:161]
v_pk_add_f32 v[158:159], v[158:159], v[162:163]
v_pk_add_f32 v[136:137], v[136:137], v[156:157]
v_pk_add_f32 v[138:139], v[138:139], v[158:159]
v_pk_add_f32 v[140:141], v[140:141], v[152:153]
v_pk_add_f32 v[142:143], v[142:143], v[154:155]
v_pk_add_f32 v[144:145], v[144:145], v[148:149]
v_pk_add_f32 v[146:147], v[146:147], v[150:151]
v_pk_add_f32 v[136:137], v[136:137], v[144:145]
v_pk_add_f32 v[138:139], v[138:139], v[146:147]
v_pk_add_f32 v[136:137], v[136:137], v[140:141]
v_pk_add_f32 v[138:139], v[138:139], v[142:143]
v_pk_add_f32 v[232:233], v[232:233], v[236:237]
v_pk_add_f32 v[234:235], v[234:235], v[238:239]
v_cvt_pk_bf16_f32 v12, v136, v137
v_lshlrev_b32 v136, 16, v12
v_and_b32 v137, 0xffff0000, v12
v_cvt_pk_bf16_f32 v12, v138, v139
v_lshlrev_b32 v138, 16, v12
v_and_b32 v139, 0xffff0000, v12
v_cvt_pk_bf16_f32 v12, v232, v233
v_lshlrev_b32 v232, 16, v12
v_and_b32 v233, 0xffff0000, v12
v_cvt_pk_bf16_f32 v12, v234, v235
v_lshlrev_b32 v234, 16, v12
v_and_b32 v235, 0xffff0000, v12
v_lshlrev_b32 v4, 16, v240
v_and_b32 v5, 0xffff0000, v240
v_lshlrev_b32 v6, 16, v241
v_and_b32 v7, 0xffff0000, v241
v_lshlrev_b32 v8, 16, v242
v_and_b32 v9, 0xffff0000, v242
v_lshlrev_b32 v10, 16, v243
v_and_b32 v11, 0xffff0000, v243
v_add_f32 v136, v4, v136
v_add_f32 v232, v232, v8
v_add_f32 v137, v5, v137
v_add_f32 v233, v233, v9
v_add_f32 v138, v6, v138
v_add_f32 v234, v234, v10
v_add_f32 v139, v7, v139
v_add_f32 v235, v235, v11
v_cvt_pk_bf16_f32 v12, v136, v137
v_lshlrev_b32 v136, 16, v12
v_and_b32 v137, 0xffff0000, v12
v_cvt_pk_bf16_f32 v12, v138, v139
v_lshlrev_b32 v138, 16, v12
v_and_b32 v139, 0xffff0000, v12
v_cvt_pk_bf16_f32 v12, v232, v233
v_lshlrev_b32 v232, 16, v12
v_and_b32 v233, 0xffff0000, v12
v_cvt_pk_bf16_f32 v12, v234, v235
v_lshlrev_b32 v234, 16, v12
v_and_b32 v235, 0xffff0000, v12
v_add_f32 v136, v136, v232
v_add_f32 v137, v137, v233
v_add_f32 v138, v138, v234
v_add_f32 v139, v139, v235
v_cvt_pk_bf16_f32 v12, v136, v137
v_cvt_pk_bf16_f32 v13, v138, v139
buffer_store_dwordx2 v[12:13], v244, s[88:91], 0 offen
s_cmp_lg_u32 s28, 0
s_cbranch_scc1 L_b_next_A
s_add_u32 s100, s101, 4
s_mov_b32 s40, 178614272
s_lshl_b32 s41, s100, 10
s_add_u32 s40, s40, s41
buffer_load_dwordx4 v[136:139], v128, s[20:23], s40 offen sc1
s_mov_b32 s40, 179269632
s_lshl_b32 s41, s100, 10
s_add_u32 s40, s40, s41
buffer_load_dwordx4 v[140:143], v128, s[20:23], s40 offen sc1
s_mov_b32 s40, 179924992
s_lshl_b32 s41, s100, 10
s_add_u32 s40, s40, s41
buffer_load_dwordx4 v[144:147], v128, s[20:23], s40 offen sc1
s_mov_b32 s40, 180580352
s_lshl_b32 s41, s100, 10
s_add_u32 s40, s40, s41
buffer_load_dwordx4 v[148:151], v128, s[20:23], s40 offen sc1
s_mov_b32 s40, 181235712
s_lshl_b32 s41, s100, 10
s_add_u32 s40, s40, s41
buffer_load_dwordx4 v[152:155], v128, s[20:23], s40 offen sc1
s_mov_b32 s40, 181891072
s_lshl_b32 s41, s100, 10
s_add_u32 s40, s40, s41
buffer_load_dwordx4 v[156:159], v128, s[20:23], s40 offen sc1
s_mov_b32 s40, 182546432
s_lshl_b32 s41, s100, 10
s_add_u32 s40, s40, s41
buffer_load_dwordx4 v[160:163], v128, s[20:23], s40 offen sc1
s_mov_b32 s40, 183201792
s_lshl_b32 s41, s100, 10
s_add_u32 s40, s40, s41
buffer_load_dwordx4 v[164:167], v128, s[20:23], s40 offen sc1
s_mov_b32 s40, 183857152
s_lshl_b32 s41, s100, 10
s_add_u32 s40, s40, s41
buffer_load_dwordx4 v[168:171], v128, s[20:23], s40 offen sc1
s_mov_b32 s40, 184512512
s_lshl_b32 s41, s100, 10
s_add_u32 s40, s40, s41
buffer_load_dwordx4 v[172:175], v128, s[20:23], s40 offen sc1
s_mov_b32 s40, 185167872
s_lshl_b32 s41, s100, 10
s_add_u32 s40, s40, s41
buffer_load_dwordx4 v[176:179], v128, s[20:23], s40 offen sc1
s_mov_b32 s40, 185823232
s_lshl_b32 s41, s100, 10
s_add_u32 s40, s40, s41
buffer_load_dwordx4 v[180:183], v128, s[20:23], s40 offen sc1
s_mov_b32 s40, 186478592
s_lshl_b32 s41, s100, 10
s_add_u32 s40, s40, s41
buffer_load_dwordx4 v[184:187], v128, s[20:23], s40 offen sc1
s_mov_b32 s40, 187133952
s_lshl_b32 s41, s100, 10
s_add_u32 s40, s40, s41
buffer_load_dwordx4 v[188:191], v128, s[20:23], s40 offen sc1
s_mov_b32 s40, 187789312
s_lshl_b32 s41, s100, 10
s_add_u32 s40, s40, s41
buffer_load_dwordx4 v[192:195], v128, s[20:23], s40 offen sc1
s_mov_b32 s40, 188444672
s_lshl_b32 s41, s100, 10
s_add_u32 s40, s40, s41
buffer_load_dwordx4 v[196:199], v128, s[20:23], s40 offen sc1
s_mov_b32 s40, 189100032
s_lshl_b32 s41, s100, 10
s_add_u32 s40, s40, s41
buffer_load_dwordx4 v[200:203], v128, s[20:23], s40 offen sc1
s_mov_b32 s40, 189755392
s_lshl_b32 s41, s100, 10
s_add_u32 s40, s40, s41
buffer_load_dwordx4 v[204:207], v128, s[20:23], s40 offen sc1
s_mov_b32 s40, 190410752
s_lshl_b32 s41, s100, 10
s_add_u32 s40, s40, s41
buffer_load_dwordx4 v[208:211], v128, s[20:23], s40 offen sc1
s_mov_b32 s40, 191066112
s_lshl_b32 s41, s100, 10
s_add_u32 s40, s40, s41
buffer_load_dwordx4 v[212:215], v128, s[20:23], s40 offen sc1
s_mov_b32 s40, 191721472
s_lshl_b32 s41, s100, 10
s_add_u32 s40, s40, s41
buffer_load_dwordx4 v[216:219], v128, s[20:23], s40 offen sc1
s_mov_b32 s40, 192376832
s_lshl_b32 s41, s100, 10
s_add_u32 s40, s40, s41
buffer_load_dwordx4 v[220:223], v128, s[20:23], s40 offen sc1
s_mov_b32 s40, 193032192
s_lshl_b32 s41, s100, 10
s_add_u32 s40, s40, s41
buffer_load_dwordx4 v[224:227], v128, s[20:23], s40 offen sc1
s_mov_b32 s40, 193687552
s_lshl_b32 s41, s100, 10
s_add_u32 s40, s40, s41
buffer_load_dwordx4 v[228:231], v128, s[20:23], s40 offen sc1
s_mov_b32 s40, 172568576
s_lshl_b32 s41, s100, 10
s_add_u32 s40, s40, s41
buffer_load_dwordx4 v[232:235], v128, s[20:23], s40 offen sc1
s_mov_b32 s40, 177811456
s_lshl_b32 s41, s100, 10
s_add_u32 s40, s40, s41
buffer_load_dwordx4 v[236:239], v128, s[20:23], s40 offen sc1
s_and_b32 s60, s100, 3
s_lshr_b32 s61, s100, 2
s_mul_i32 s40, s61, 52429
s_lshr_b32 s40, s40, 18
s_mul_i32 s41, s40, 5
s_sub_u32 s61, s61, s41
s_lshl_b32 s61, s61, 5
s_lshl_b32 s60, s60, 3
s_add_u32 s61, s61, s60
s_lshr_b32 s41, s40, 3
s_mul_i32 s41, s41, 160
s_add_u32 s61, s61, s41
s_lshl_b32 s61, s61, 1
s_and_b32 s40, s40, 7
s_lshl_b32 s40, s40, 5
s_lshl_b32 s41, s52, 8
s_add_u32 s40, s40, s41
s_mul_i32 s40, s40, 1280
v_add_u32 v245, s61, v135
v_add3_u32 v244, v134, v245, s40
buffer_load_dwordx2 v[240:241], v244, s[80:83], 0 offen
buffer_load_dwordx2 v[242:243], v245, s[84:87], 0 offen
s_waitcnt vmcnt(0)
v_pk_add_f32 v[136:137], v[136:137], v[228:229]
v_pk_add_f32 v[138:139], v[138:139], v[230:231]
v_pk_add_f32 v[140:141], v[140:141], v[224:225]
v_pk_add_f32 v[142:143], v[142:143], v[226:227]
v_pk_add_f32 v[144:145], v[144:145], v[220:221]
v_pk_add_f32 v[146:147], v[146:147], v[222:223]
v_pk_add_f32 v[148:149], v[148:149], v[216:217]
v_pk_add_f32 v[150:151], v[150:151], v[218:219]
v_pk_add_f32 v[152:153], v[152:153], v[212:213]
v_pk_add_f32 v[154:155], v[154:155], v[214:215]
v_pk_add_f32 v[156:157], v[156:157], v[208:209]
v_pk_add_f32 v[158:159], v[158:159], v[210:211]
v_pk_add_f32 v[160:161], v[160:161], v[204:205]
v_pk_add_f32 v[162:163], v[162:163], v[206:207]
v_pk_add_f32 v[164:165], v[164:165], v[200:201]
v_pk_add_f32 v[166:167], v[166:167], v[202:203]
v_pk_add_f32 v[168:169], v[168:169], v[196:197]
v_pk_add_f32 v[170:171], v[170:171], v[198:199]
v_pk_add_f32 v[172:173], v[172:173], v[192:193]
v_pk_add_f32 v[174:175], v[174:175], v[194:195]
v_pk_add_f32 v[176:177], v[176:177], v[188:189]
v_pk_add_f32 v[178:179], v[178:179], v[190:191]
v_pk_add_f32 v[180:181], v[180:181], v[184:185]
v_pk_add_f32 v[182:183], v[182:183], v[186:187]
v_pk_add_f32 v[136:137], v[136:137], v[180:181]
v_pk_add_f32 v[138:139], v[138:139], v[182:183]
v_pk_add_f32 v[140:141], v[140:141], v[176:177]
v_pk_add_f32 v[142:143], v[142:143], v[178:179]
v_pk_add_f32 v[144:145], v[144:145], v[172:173]
v_pk_add_f32 v[146:147], v[146:147], v[174:175]
v_pk_add_f32 v[148:149], v[148:149], v[168:169]
v_pk_add_f32 v[150:151], v[150:151], v[170:171]
v_pk_add_f32 v[152:153], v[152:153], v[164:165]
v_pk_add_f32 v[154:155], v[154:155], v[166:167]
v_pk_add_f32 v[156:157], v[156:157], v[160:161]
v_pk_add_f32 v[158:159], v[158:159], v[162:163]
v_pk_add_f32 v[136:137], v[136:137], v[156:157]
v_pk_add_f32 v[138:139], v[138:139], v[158:159]
v_pk_add_f32 v[140:141], v[140:141], v[152:153]
v_pk_add_f32 v[142:143], v[142:143], v[154:155]
v_pk_add_f32 v[144:145], v[144:145], v[148:149]
v_pk_add_f32 v[146:147], v[146:147], v[150:151]
v_pk_add_f32 v[136:137], v[136:137], v[144:145]
v_pk_add_f32 v[138:139], v[138:139], v[146:147]
v_pk_add_f32 v[136:137], v[136:137], v[140:141]
v_pk_add_f32 v[138:139], v[138:139], v[142:143]
v_pk_add_f32 v[232:233], v[232:233], v[236:237]
v_pk_add_f32 v[234:235], v[234:235], v[238:239]
v_cvt_pk_bf16_f32 v12, v136, v137
v_lshlrev_b32 v136, 16, v12
v_and_b32 v137, 0xffff0000, v12
v_cvt_pk_bf16_f32 v12, v138, v139
v_lshlrev_b32 v138, 16, v12
v_and_b32 v139, 0xffff0000, v12
v_cvt_pk_bf16_f32 v12, v232, v233
v_lshlrev_b32 v232, 16, v12
v_and_b32 v233, 0xffff0000, v12
v_cvt_pk_bf16_f32 v12, v234, v235
v_lshlrev_b32 v234, 16, v12
v_and_b32 v235, 0xffff0000, v12
v_lshlrev_b32 v4, 16, v240
v_and_b32 v5, 0xffff0000, v240
v_lshlrev_b32 v6, 16, v241
v_and_b32 v7, 0xffff0000, v241
v_lshlrev_b32 v8, 16, v242
v_and_b32 v9, 0xffff0000, v242
v_lshlrev_b32 v10, 16, v243
v_and_b32 v11, 0xffff0000, v243
v_add_f32 v136, v4, v136
v_add_f32 v232, v232, v8
v_add_f32 v137, v5, v137
v_add_f32 v233, v233, v9
v_add_f32 v138, v6, v138
v_add_f32 v234, v234, v10
v_add_f32 v139, v7, v139
v_add_f32 v235, v235, v11
v_cvt_pk_bf16_f32 v12, v136, v137
v_lshlrev_b32 v136, 16, v12
v_and_b32 v137, 0xffff0000, v12
v_cvt_pk_bf16_f32 v12, v138, v139
v_lshlrev_b32 v138, 16, v12
v_and_b32 v139, 0xffff0000, v12
v_cvt_pk_bf16_f32 v12, v232, v233
v_lshlrev_b32 v232, 16, v12
v_and_b32 v233, 0xffff0000, v12
v_cvt_pk_bf16_f32 v12, v234, v235
v_lshlrev_b32 v234, 16, v12
v_and_b32 v235, 0xffff0000, v12
v_add_f32 v136, v136, v232
v_add_f32 v137, v137, v233
v_add_f32 v138, v138, v234
v_add_f32 v139, v139, v235
v_cvt_pk_bf16_f32 v12, v136, v137
v_cvt_pk_bf16_f32 v13, v138, v139
buffer_store_dwordx2 v[12:13], v244, s[88:91], 0 offen
s_nop 0
L_b_next_A:
s_add_u32 s50, s50, 1
s_branch L_b_task_A
L_w_done_A:
s_endpgm
L_role_entry_B:
s_mov_b32 s95, 0
s_cmp_ge_u32 s30, 16
s_cbranch_scc1 L_worker_B
s_load_dwordx4 s[8:11], s[0:1], 16
s_load_dwordx4 s[12:15], s[0:1], 32
s_waitcnt lgkmcnt(0)
s_and_b32 s30, s30, 15
s_lshr_b32 s45, s30, 2
s_lshl_b32 s31, s29, 2
s_add_u32 s31, s31, s45
s_and_b32 s32, s30, 3
s_mul_i32 s45, s30, 3
s_lshl_b32 s46, s30, 1
s_add_u32 s46, s46, 8
s_cmp_lt_u32 s30, 8
s_cselect_b32 s58, s45, s46
s_cselect_b32 s54, 3, 2
v_lshrrev_b32 v28, 4, v1
v_and_b32 v29, 7, v1
v_lshlrev_b32 v2, 7, v28
v_lshl_add_u32 v2, v29, 4, v2
v_lshlrev_b32 v3, 4, v1
s_mov_b32 s50, 0x00ff00ff
s_mov_b32 s51, 0x00ff00ff
s_mov_b32 s52, -1
s_mov_b32 s53, 0
v_mov_b32 v24, -1
v_mov_b32 v25, -1
v_mov_b32 v26, -1
v_mov_b32 v27, -1
s_mov_b32 s55, 43691
s_mul_i32 s45, s28, 18432
s_mul_i32 s46, s28, 1966080
s_mul_i32 s47, s31, 384
s_mul_i32 s48, s32, 96
s_add_u32 s46, s46, s47
s_add_u32 s46, s46, s48
s_mov_b32 s56, 12288
v_add_u32 v92, 0, v1
v_mul_u32_u24 v93, s55, v92
v_lshrrev_b32 v93, 18, v93
v_mul_u32_u24 v94, 6, v93
v_sub_u32 v94, v92, v94
v_mul_lo_u32 v93, v93, s56
v_lshl_add_u32 v96, v94, 4, v93
v_add_u32 v96, s46, v96
v_add_u32 v92, 64, v1
v_mul_u32_u24 v93, s55, v92
v_lshrrev_b32 v93, 18, v93
v_mul_u32_u24 v94, 6, v93
v_sub_u32 v94, v92, v94
v_mul_lo_u32 v93, v93, s56
v_lshl_add_u32 v97, v94, 4, v93
v_add_u32 v97, s46, v97
v_add_u32 v92, 128, v1
v_mul_u32_u24 v93, s55, v92
v_lshrrev_b32 v93, 18, v93
v_mul_u32_u24 v94, 6, v93
v_sub_u32 v94, v92, v94
v_mul_lo_u32 v93, v93, s56
v_lshl_add_u32 v98, v94, 4, v93
v_add_u32 v98, s46, v98
v_add_u32 v92, 192, v1
v_mul_u32_u24 v93, s55, v92
v_lshrrev_b32 v93, 18, v93
v_mul_u32_u24 v94, 6, v93
v_sub_u32 v94, v92, v94
v_mul_lo_u32 v93, v93, s56
v_lshl_add_u32 v99, v94, 4, v93
v_add_u32 v99, s46, v99
v_add_u32 v92, 256, v1
v_mul_u32_u24 v93, s55, v92
v_lshrrev_b32 v93, 18, v93
v_mul_u32_u24 v94, 6, v93
v_sub_u32 v94, v92, v94
v_mul_lo_u32 v93, v93, s56
v_lshl_add_u32 v100, v94, 4, v93
v_add_u32 v100, s46, v100
v_add_u32 v92, 320, v1
v_mul_u32_u24 v93, s55, v92
v_lshrrev_b32 v93, 18, v93
v_mul_u32_u24 v94, 6, v93
v_sub_u32 v94, v92, v94
v_mul_lo_u32 v93, v93, s56
v_lshl_add_u32 v101, v94, 4, v93
v_add_u32 v101, s46, v101
v_add_u32 v92, 384, v1
v_mul_u32_u24 v93, s55, v92
v_lshrrev_b32 v93, 18, v93
v_mul_u32_u24 v94, 6, v93
v_sub_u32 v94, v92, v94
v_mul_lo_u32 v93, v93, s56
v_lshl_add_u32 v102, v94, 4, v93
v_add_u32 v102, s46, v102
v_add_u32 v92, 448, v1
v_mul_u32_u24 v93, s55, v92
v_lshrrev_b32 v93, 18, v93
v_mul_u32_u24 v94, 6, v93
v_sub_u32 v94, v92, v94
v_mul_lo_u32 v93, v93, s56
v_lshl_add_u32 v103, v94, 4, v93
v_add_u32 v103, s46, v103
v_add_u32 v92, 512, v1
v_mul_u32_u24 v93, s55, v92
v_lshrrev_b32 v93, 18, v93
v_mul_u32_u24 v94, 6, v93
v_sub_u32 v94, v92, v94
v_mul_lo_u32 v93, v93, s56
v_lshl_add_u32 v104, v94, 4, v93
v_add_u32 v104, s46, v104
v_add_u32 v92, 576, v1
v_mul_u32_u24 v93, s55, v92
v_lshrrev_b32 v93, 18, v93
v_mul_u32_u24 v94, 6, v93
v_sub_u32 v94, v92, v94
v_mul_lo_u32 v93, v93, s56
v_lshl_add_u32 v105, v94, 4, v93
v_add_u32 v105, s46, v105
v_add_u32 v92, 640, v1
v_mul_u32_u24 v93, s55, v92
v_lshrrev_b32 v93, 18, v93
v_mul_u32_u24 v94, 6, v93
v_sub_u32 v94, v92, v94
v_mul_lo_u32 v93, v93, s56
v_lshl_add_u32 v106, v94, 4, v93
v_add_u32 v106, s46, v106
v_add_u32 v92, 704, v1
v_mul_u32_u24 v93, s55, v92
v_lshrrev_b32 v93, 18, v93
v_mul_u32_u24 v94, 6, v93
v_sub_u32 v94, v92, v94
v_mul_lo_u32 v93, v93, s56
v_lshl_add_u32 v107, v94, 4, v93
v_add_u32 v107, s46, v107
v_add_u32 v92, 768, v1
v_mul_u32_u24 v93, s55, v92
v_lshrrev_b32 v93, 18, v93
v_mul_u32_u24 v94, 6, v93
v_sub_u32 v94, v92, v94
v_mul_lo_u32 v93, v93, s56
v_lshl_add_u32 v108, v94, 4, v93
v_add_u32 v108, s46, v108
v_add_u32 v92, 832, v1
v_mul_u32_u24 v93, s55, v92
v_lshrrev_b32 v93, 18, v93
v_mul_u32_u24 v94, 6, v93
v_sub_u32 v94, v92, v94
v_mul_lo_u32 v93, v93, s56
v_lshl_add_u32 v109, v94, 4, v93
v_add_u32 v109, s46, v109
v_add_u32 v92, 896, v1
v_mul_u32_u24 v93, s55, v92
v_lshrrev_b32 v93, 18, v93
v_mul_u32_u24 v94, 6, v93
v_sub_u32 v94, v92, v94
v_mul_lo_u32 v93, v93, s56
v_lshl_add_u32 v110, v94, 4, v93
v_add_u32 v110, s46, v110
v_and_b32 v28, 15, v1
v_lshrrev_b32 v29, 2, v28
v_and_b32 v30, 3, v28
v_lshrrev_b32 v31, 4, v1
v_lshl_add_u32 v32, v31, 2, v29
v_mul_u32_u24 v32, 96, v32
v_lshl_add_u32 v116, v30, 3, v32
v_add_u32 v116, s45, v116
v_add_u32 v117, s45, v3
s_mov_b32 s24, s8
s_mov_b32 s25, s9
s_mov_b32 s26, 7864320
s_mov_b32 s27, 0x00020000
buffer_load_dwordx4 v[152:155], v96, s[24:27], 0 offen
buffer_load_dwordx4 v[156:159], v97, s[24:27], 0 offen
buffer_load_dwordx4 v[160:163], v98, s[24:27], 0 offen
buffer_load_dwordx4 v[164:167], v99, s[24:27], 0 offen
buffer_load_dwordx4 v[168:171], v100, s[24:27], 0 offen
buffer_load_dwordx4 v[172:175], v101, s[24:27], 0 offen
buffer_load_dwordx4 v[176:179], v102, s[24:27], 0 offen
buffer_load_dwordx4 v[180:183], v103, s[24:27], 0 offen
buffer_load_dwordx4 v[184:187], v104, s[24:27], 0 offen
buffer_load_dwordx4 v[188:191], v105, s[24:27], 0 offen
buffer_load_dwordx4 v[192:195], v106, s[24:27], 0 offen
buffer_load_dwordx4 v[196:199], v107, s[24:27], 0 offen
buffer_load_dwordx4 v[200:203], v108, s[24:27], 0 offen
buffer_load_dwordx4 v[204:207], v109, s[24:27], 0 offen
buffer_load_dwordx4 v[208:211], v110, s[24:27], 0 offen
s_waitcnt vmcnt(14)
ds_write_b128 v117, v[152:155] offset:0
s_waitcnt vmcnt(13)
ds_write_b128 v117, v[156:159] offset:1024
s_waitcnt vmcnt(12)
ds_write_b128 v117, v[160:163] offset:2048
s_waitcnt vmcnt(11)
ds_write_b128 v117, v[164:167] offset:3072
s_waitcnt vmcnt(10)
ds_write_b128 v117, v[168:171] offset:4096
s_waitcnt vmcnt(9)
ds_write_b128 v117, v[172:175] offset:5120
s_waitcnt vmcnt(8)
ds_write_b128 v117, v[176:179] offset:6144
s_waitcnt vmcnt(7)
ds_write_b128 v117, v[180:183] offset:7168
s_waitcnt vmcnt(6)
ds_write_b128 v117, v[184:187] offset:8192
s_waitcnt vmcnt(5)
ds_write_b128 v117, v[188:191] offset:9216
s_waitcnt vmcnt(4)
ds_write_b128 v117, v[192:195] offset:10240
s_waitcnt vmcnt(3)
ds_write_b128 v117, v[196:199] offset:11264
s_waitcnt vmcnt(2)
ds_write_b128 v117, v[200:203] offset:12288
s_waitcnt vmcnt(1)
ds_write_b128 v117, v[204:207] offset:13312
s_waitcnt vmcnt(0)
ds_write_b128 v117, v[208:211] offset:14336
s_waitcnt lgkmcnt(0)
ds_read_b64_tr_b16 v[152:153], v116 offset:0
ds_read_b64_tr_b16 v[154:155], v116 offset:1536
ds_read_b64_tr_b16 v[156:157], v116 offset:3072
ds_read_b64_tr_b16 v[158:159], v116 offset:4608
ds_read_b64_tr_b16 v[160:161], v116 offset:6144
ds_read_b64_tr_b16 v[162:163], v116 offset:7680
ds_read_b64_tr_b16 v[164:165], v116 offset:9216
ds_read_b64_tr_b16 v[166:167], v116 offset:10752
ds_read_b64_tr_b16 v[168:169], v116 offset:12288
ds_read_b64_tr_b16 v[170:171], v116 offset:13824
ds_read_b64_tr_b16 v[172:173], v116 offset:32
ds_read_b64_tr_b16 v[174:175], v116 offset:1568
ds_read_b64_tr_b16 v[176:177], v116 offset:3104
ds_read_b64_tr_b16 v[178:179], v116 offset:4640
ds_read_b64_tr_b16 v[180:181], v116 offset:6176
ds_read_b64_tr_b16 v[182:183], v116 offset:7712
ds_read_b64_tr_b16 v[184:185], v116 offset:9248
ds_read_b64_tr_b16 v[186:187], v116 offset:10784
ds_read_b64_tr_b16 v[188:189], v116 offset:12320
ds_read_b64_tr_b16 v[190:191], v116 offset:13856
ds_read_b64_tr_b16 v[192:193], v116 offset:64
ds_read_b64_tr_b16 v[194:195], v116 offset:1600
ds_read_b64_tr_b16 v[196:197], v116 offset:3136
ds_read_b64_tr_b16 v[198:199], v116 offset:4672
ds_read_b64_tr_b16 v[200:201], v116 offset:6208
ds_read_b64_tr_b16 v[202:203], v116 offset:7744
ds_read_b64_tr_b16 v[204:205], v116 offset:9280
ds_read_b64_tr_b16 v[206:207], v116 offset:10816
ds_read_b64_tr_b16 v[208:209], v116 offset:12352
ds_read_b64_tr_b16 v[210:211], v116 offset:13888
s_waitcnt lgkmcnt(0)
v_accvgpr_write_b32 a0, v152
v_accvgpr_write_b32 a1, v153
v_accvgpr_write_b32 a2, v154
v_accvgpr_write_b32 a3, v155
v_accvgpr_write_b32 a4, v156
v_accvgpr_write_b32 a5, v157
v_accvgpr_write_b32 a6, v158
v_accvgpr_write_b32 a7, v159
v_accvgpr_write_b32 a8, v160
v_accvgpr_write_b32 a9, v161
v_accvgpr_write_b32 a10, v162
v_accvgpr_write_b32 a11, v163
v_accvgpr_write_b32 a12, v164
v_accvgpr_write_b32 a13, v165
v_accvgpr_write_b32 a14, v166
v_accvgpr_write_b32 a15, v167
v_accvgpr_write_b32 a16, v168
v_accvgpr_write_b32 a17, v169
v_accvgpr_write_b32 a18, v170
v_accvgpr_write_b32 a19, v171
v_accvgpr_write_b32 a20, v172
v_accvgpr_write_b32 a21, v173
v_accvgpr_write_b32 a22, v174
v_accvgpr_write_b32 a23, v175
v_accvgpr_write_b32 a24, v176
v_accvgpr_write_b32 a25, v177
v_accvgpr_write_b32 a26, v178
v_accvgpr_write_b32 a27, v179
v_accvgpr_write_b32 a28, v180
v_accvgpr_write_b32 a29, v181
v_accvgpr_write_b32 a30, v182
v_accvgpr_write_b32 a31, v183
v_accvgpr_write_b32 a32, v184
v_accvgpr_write_b32 a33, v185
v_accvgpr_write_b32 a34, v186
v_accvgpr_write_b32 a35, v187
v_accvgpr_write_b32 a36, v188
v_accvgpr_write_b32 a37, v189
v_accvgpr_write_b32 a38, v190
v_accvgpr_write_b32 a39, v191
v_accvgpr_write_b32 a40, v192
v_accvgpr_write_b32 a41, v193
v_accvgpr_write_b32 a42, v194
v_accvgpr_write_b32 a43, v195
v_accvgpr_write_b32 a44, v196
v_accvgpr_write_b32 a45, v197
v_accvgpr_write_b32 a46, v198
v_accvgpr_write_b32 a47, v199
v_accvgpr_write_b32 a48, v200
v_accvgpr_write_b32 a49, v201
v_accvgpr_write_b32 a50, v202
v_accvgpr_write_b32 a51, v203
v_accvgpr_write_b32 a52, v204
v_accvgpr_write_b32 a53, v205
v_accvgpr_write_b32 a54, v206
v_accvgpr_write_b32 a55, v207
v_accvgpr_write_b32 a56, v208
v_accvgpr_write_b32 a57, v209
v_accvgpr_write_b32 a58, v210
v_accvgpr_write_b32 a59, v211
s_mov_b32 s24, s10
s_mov_b32 s25, s11
s_mov_b32 s26, 7864320
s_mov_b32 s27, 0x00020000
buffer_load_dwordx4 v[152:155], v96, s[24:27], 0 offen
buffer_load_dwordx4 v[156:159], v97, s[24:27], 0 offen
buffer_load_dwordx4 v[160:163], v98, s[24:27], 0 offen
buffer_load_dwordx4 v[164:167], v99, s[24:27], 0 offen
buffer_load_dwordx4 v[168:171], v100, s[24:27], 0 offen
buffer_load_dwordx4 v[172:175], v101, s[24:27], 0 offen
buffer_load_dwordx4 v[176:179], v102, s[24:27], 0 offen
buffer_load_dwordx4 v[180:183], v103, s[24:27], 0 offen
buffer_load_dwordx4 v[184:187], v104, s[24:27], 0 offen
buffer_load_dwordx4 v[188:191], v105, s[24:27], 0 offen
buffer_load_dwordx4 v[192:195], v106, s[24:27], 0 offen
buffer_load_dwordx4 v[196:199], v107, s[24:27], 0 offen
buffer_load_dwordx4 v[200:203], v108, s[24:27], 0 offen
buffer_load_dwordx4 v[204:207], v109, s[24:27], 0 offen
buffer_load_dwordx4 v[208:211], v110, s[24:27], 0 offen
s_waitcnt vmcnt(14)
ds_write_b128 v117, v[152:155] offset:0
s_waitcnt vmcnt(13)
ds_write_b128 v117, v[156:159] offset:1024
s_waitcnt vmcnt(12)
ds_write_b128 v117, v[160:163] offset:2048
s_waitcnt vmcnt(11)
ds_write_b128 v117, v[164:167] offset:3072
s_waitcnt vmcnt(10)
ds_write_b128 v117, v[168:171] offset:4096
s_waitcnt vmcnt(9)
ds_write_b128 v117, v[172:175] offset:5120
s_waitcnt vmcnt(8)
ds_write_b128 v117, v[176:179] offset:6144
s_waitcnt vmcnt(7)
ds_write_b128 v117, v[180:183] offset:7168
s_waitcnt vmcnt(6)
ds_write_b128 v117, v[184:187] offset:8192
s_waitcnt vmcnt(5)
ds_write_b128 v117, v[188:191] offset:9216
s_waitcnt vmcnt(4)
ds_write_b128 v117, v[192:195] offset:10240
s_waitcnt vmcnt(3)
ds_write_b128 v117, v[196:199] offset:11264
s_waitcnt vmcnt(2)
ds_write_b128 v117, v[200:203] offset:12288
s_waitcnt vmcnt(1)
ds_write_b128 v117, v[204:207] offset:13312
s_waitcnt vmcnt(0)
ds_write_b128 v117, v[208:211] offset:14336
s_waitcnt lgkmcnt(0)
ds_read_b64_tr_b16 v[152:153], v116 offset:0
ds_read_b64_tr_b16 v[154:155], v116 offset:1536
ds_read_b64_tr_b16 v[156:157], v116 offset:3072
ds_read_b64_tr_b16 v[158:159], v116 offset:4608
ds_read_b64_tr_b16 v[160:161], v116 offset:6144
ds_read_b64_tr_b16 v[162:163], v116 offset:7680
ds_read_b64_tr_b16 v[164:165], v116 offset:9216
ds_read_b64_tr_b16 v[166:167], v116 offset:10752
ds_read_b64_tr_b16 v[168:169], v116 offset:12288
ds_read_b64_tr_b16 v[170:171], v116 offset:13824
ds_read_b64_tr_b16 v[172:173], v116 offset:32
ds_read_b64_tr_b16 v[174:175], v116 offset:1568
ds_read_b64_tr_b16 v[176:177], v116 offset:3104
ds_read_b64_tr_b16 v[178:179], v116 offset:4640
ds_read_b64_tr_b16 v[180:181], v116 offset:6176
ds_read_b64_tr_b16 v[182:183], v116 offset:7712
ds_read_b64_tr_b16 v[184:185], v116 offset:9248
ds_read_b64_tr_b16 v[186:187], v116 offset:10784
ds_read_b64_tr_b16 v[188:189], v116 offset:12320
ds_read_b64_tr_b16 v[190:191], v116 offset:13856
ds_read_b64_tr_b16 v[192:193], v116 offset:64
ds_read_b64_tr_b16 v[194:195], v116 offset:1600
ds_read_b64_tr_b16 v[196:197], v116 offset:3136
ds_read_b64_tr_b16 v[198:199], v116 offset:4672
ds_read_b64_tr_b16 v[200:201], v116 offset:6208
ds_read_b64_tr_b16 v[202:203], v116 offset:7744
ds_read_b64_tr_b16 v[204:205], v116 offset:9280
ds_read_b64_tr_b16 v[206:207], v116 offset:10816
ds_read_b64_tr_b16 v[208:209], v116 offset:12352
ds_read_b64_tr_b16 v[210:211], v116 offset:13888
s_waitcnt lgkmcnt(0)
v_accvgpr_write_b32 a60, v152
v_accvgpr_write_b32 a61, v153
v_accvgpr_write_b32 a62, v154
v_accvgpr_write_b32 a63, v155
v_accvgpr_write_b32 a64, v156
v_accvgpr_write_b32 a65, v157
v_accvgpr_write_b32 a66, v158
v_accvgpr_write_b32 a67, v159
v_accvgpr_write_b32 a68, v160
v_accvgpr_write_b32 a69, v161
v_accvgpr_write_b32 a70, v162
v_accvgpr_write_b32 a71, v163
v_accvgpr_write_b32 a72, v164
v_accvgpr_write_b32 a73, v165
v_accvgpr_write_b32 a74, v166
v_accvgpr_write_b32 a75, v167
v_accvgpr_write_b32 a76, v168
v_accvgpr_write_b32 a77, v169
v_accvgpr_write_b32 a78, v170
v_accvgpr_write_b32 a79, v171
v_accvgpr_write_b32 a80, v172
v_accvgpr_write_b32 a81, v173
v_accvgpr_write_b32 a82, v174
v_accvgpr_write_b32 a83, v175
v_accvgpr_write_b32 a84, v176
v_accvgpr_write_b32 a85, v177
v_accvgpr_write_b32 a86, v178
v_accvgpr_write_b32 a87, v179
v_accvgpr_write_b32 a88, v180
v_accvgpr_write_b32 a89, v181
v_accvgpr_write_b32 a90, v182
v_accvgpr_write_b32 a91, v183
v_accvgpr_write_b32 a92, v184
v_accvgpr_write_b32 a93, v185
v_accvgpr_write_b32 a94, v186
v_accvgpr_write_b32 a95, v187
v_accvgpr_write_b32 a96, v188
v_accvgpr_write_b32 a97, v189
v_accvgpr_write_b32 a98, v190
v_accvgpr_write_b32 a99, v191
v_accvgpr_write_b32 a100, v192
v_accvgpr_write_b32 a101, v193
v_accvgpr_write_b32 a102, v194
v_accvgpr_write_b32 a103, v195
v_accvgpr_write_b32 a104, v196
v_accvgpr_write_b32 a105, v197
v_accvgpr_write_b32 a106, v198
v_accvgpr_write_b32 a107, v199
v_accvgpr_write_b32 a108, v200
v_accvgpr_write_b32 a109, v201
v_accvgpr_write_b32 a110, v202
v_accvgpr_write_b32 a111, v203
v_accvgpr_write_b32 a112, v204
v_accvgpr_write_b32 a113, v205
v_accvgpr_write_b32 a114, v206
v_accvgpr_write_b32 a115, v207
v_accvgpr_write_b32 a116, v208
v_accvgpr_write_b32 a117, v209
v_accvgpr_write_b32 a118, v210
v_accvgpr_write_b32 a119, v211
s_mov_b32 s24, s12
s_mov_b32 s25, s13
s_mov_b32 s26, 7864320
s_mov_b32 s27, 0x00020000
buffer_load_dwordx4 v[152:155], v96, s[24:27], 0 offen
buffer_load_dwordx4 v[156:159], v97, s[24:27], 0 offen
buffer_load_dwordx4 v[160:163], v98, s[24:27], 0 offen
buffer_load_dwordx4 v[164:167], v99, s[24:27], 0 offen
buffer_load_dwordx4 v[168:171], v100, s[24:27], 0 offen
buffer_load_dwordx4 v[172:175], v101, s[24:27], 0 offen
buffer_load_dwordx4 v[176:179], v102, s[24:27], 0 offen
buffer_load_dwordx4 v[180:183], v103, s[24:27], 0 offen
buffer_load_dwordx4 v[184:187], v104, s[24:27], 0 offen
buffer_load_dwordx4 v[188:191], v105, s[24:27], 0 offen
buffer_load_dwordx4 v[192:195], v106, s[24:27], 0 offen
buffer_load_dwordx4 v[196:199], v107, s[24:27], 0 offen
buffer_load_dwordx4 v[200:203], v108, s[24:27], 0 offen
buffer_load_dwordx4 v[204:207], v109, s[24:27], 0 offen
buffer_load_dwordx4 v[208:211], v110, s[24:27], 0 offen
s_waitcnt vmcnt(14)
ds_write_b128 v117, v[152:155] offset:0
s_waitcnt vmcnt(13)
ds_write_b128 v117, v[156:159] offset:1024
s_waitcnt vmcnt(12)
ds_write_b128 v117, v[160:163] offset:2048
s_waitcnt vmcnt(11)
ds_write_b128 v117, v[164:167] offset:3072
s_waitcnt vmcnt(10)
ds_write_b128 v117, v[168:171] offset:4096
s_waitcnt vmcnt(9)
ds_write_b128 v117, v[172:175] offset:5120
s_waitcnt vmcnt(8)
ds_write_b128 v117, v[176:179] offset:6144
s_waitcnt vmcnt(7)
ds_write_b128 v117, v[180:183] offset:7168
s_waitcnt vmcnt(6)
ds_write_b128 v117, v[184:187] offset:8192
s_waitcnt vmcnt(5)
ds_write_b128 v117, v[188:191] offset:9216
s_waitcnt vmcnt(4)
ds_write_b128 v117, v[192:195] offset:10240
s_waitcnt vmcnt(3)
ds_write_b128 v117, v[196:199] offset:11264
s_waitcnt vmcnt(2)
ds_write_b128 v117, v[200:203] offset:12288
s_waitcnt vmcnt(1)
ds_write_b128 v117, v[204:207] offset:13312
s_waitcnt vmcnt(0)
ds_write_b128 v117, v[208:211] offset:14336
s_waitcnt lgkmcnt(0)
ds_read_b64_tr_b16 v[152:153], v116 offset:0
ds_read_b64_tr_b16 v[154:155], v116 offset:1536
ds_read_b64_tr_b16 v[156:157], v116 offset:3072
ds_read_b64_tr_b16 v[158:159], v116 offset:4608
ds_read_b64_tr_b16 v[160:161], v116 offset:6144
ds_read_b64_tr_b16 v[162:163], v116 offset:7680
ds_read_b64_tr_b16 v[164:165], v116 offset:9216
ds_read_b64_tr_b16 v[166:167], v116 offset:10752
ds_read_b64_tr_b16 v[168:169], v116 offset:12288
ds_read_b64_tr_b16 v[170:171], v116 offset:13824
ds_read_b64_tr_b16 v[172:173], v116 offset:32
ds_read_b64_tr_b16 v[174:175], v116 offset:1568
ds_read_b64_tr_b16 v[176:177], v116 offset:3104
ds_read_b64_tr_b16 v[178:179], v116 offset:4640
ds_read_b64_tr_b16 v[180:181], v116 offset:6176
ds_read_b64_tr_b16 v[182:183], v116 offset:7712
ds_read_b64_tr_b16 v[184:185], v116 offset:9248
ds_read_b64_tr_b16 v[186:187], v116 offset:10784
ds_read_b64_tr_b16 v[188:189], v116 offset:12320
ds_read_b64_tr_b16 v[190:191], v116 offset:13856
ds_read_b64_tr_b16 v[192:193], v116 offset:64
ds_read_b64_tr_b16 v[194:195], v116 offset:1600
ds_read_b64_tr_b16 v[196:197], v116 offset:3136
ds_read_b64_tr_b16 v[198:199], v116 offset:4672
ds_read_b64_tr_b16 v[200:201], v116 offset:6208
ds_read_b64_tr_b16 v[202:203], v116 offset:7744
ds_read_b64_tr_b16 v[204:205], v116 offset:9280
ds_read_b64_tr_b16 v[206:207], v116 offset:10816
ds_read_b64_tr_b16 v[208:209], v116 offset:12352
ds_read_b64_tr_b16 v[210:211], v116 offset:13888
s_waitcnt lgkmcnt(0)
v_accvgpr_write_b32 a120, v152
v_accvgpr_write_b32 a121, v153
v_accvgpr_write_b32 a122, v154
v_accvgpr_write_b32 a123, v155
v_accvgpr_write_b32 a124, v156
v_accvgpr_write_b32 a125, v157
v_accvgpr_write_b32 a126, v158
v_accvgpr_write_b32 a127, v159
v_accvgpr_write_b32 a128, v160
v_accvgpr_write_b32 a129, v161
v_accvgpr_write_b32 a130, v162
v_accvgpr_write_b32 a131, v163
v_accvgpr_write_b32 a132, v164
v_accvgpr_write_b32 a133, v165
v_accvgpr_write_b32 a134, v166
v_accvgpr_write_b32 a135, v167
v_accvgpr_write_b32 a136, v168
v_accvgpr_write_b32 a137, v169
v_accvgpr_write_b32 a138, v170
v_accvgpr_write_b32 a139, v171
v_accvgpr_write_b32 a140, v172
v_accvgpr_write_b32 a141, v173
v_accvgpr_write_b32 a142, v174
v_accvgpr_write_b32 a143, v175
v_accvgpr_write_b32 a144, v176
v_accvgpr_write_b32 a145, v177
v_accvgpr_write_b32 a146, v178
v_accvgpr_write_b32 a147, v179
v_accvgpr_write_b32 a148, v180
v_accvgpr_write_b32 a149, v181
v_accvgpr_write_b32 a150, v182
v_accvgpr_write_b32 a151, v183
v_accvgpr_write_b32 a152, v184
v_accvgpr_write_b32 a153, v185
v_accvgpr_write_b32 a154, v186
v_accvgpr_write_b32 a155, v187
v_accvgpr_write_b32 a156, v188
v_accvgpr_write_b32 a157, v189
v_accvgpr_write_b32 a158, v190
v_accvgpr_write_b32 a159, v191
v_accvgpr_write_b32 a160, v192
v_accvgpr_write_b32 a161, v193
v_accvgpr_write_b32 a162, v194
v_accvgpr_write_b32 a163, v195
v_accvgpr_write_b32 a164, v196
v_accvgpr_write_b32 a165, v197
v_accvgpr_write_b32 a166, v198
v_accvgpr_write_b32 a167, v199
v_accvgpr_write_b32 a168, v200
v_accvgpr_write_b32 a169, v201
v_accvgpr_write_b32 a170, v202
v_accvgpr_write_b32 a171, v203
v_accvgpr_write_b32 a172, v204
v_accvgpr_write_b32 a173, v205
v_accvgpr_write_b32 a174, v206
v_accvgpr_write_b32 a175, v207
v_accvgpr_write_b32 a176, v208
v_accvgpr_write_b32 a177, v209
v_accvgpr_write_b32 a178, v210
v_accvgpr_write_b32 a179, v211
s_lshl_b32 s46, s29, 2
s_add_u32 s46, s46, s28
s_mul_i32 s47, s46, 3072
s_mul_i32 s46, s46, 245760
s_lshl_b32 s48, s58, 5
s_add_u32 s46, s46, s48
s_mov_b32 s56, 1280
s_add_u32 s47, s47, 76611584
v_add_u32 v6, s47, v2
v_add_u32 v92, 0, v1
v_mul_u32_u24 v93, s55, v92
v_lshrrev_b32 v93, 18, v93
v_mul_u32_u24 v94, 6, v93
v_sub_u32 v94, v92, v94
v_mul_lo_u32 v93, v93, s56
v_lshl_add_u32 v96, v94, 4, v93
v_add_u32 v96, s46, v96
v_add_u32 v92, 64, v1
v_mul_u32_u24 v93, s55, v92
v_lshrrev_b32 v93, 18, v93
v_mul_u32_u24 v94, 6, v93
v_sub_u32 v94, v92, v94
v_mul_lo_u32 v93, v93, s56
v_lshl_add_u32 v97, v94, 4, v93
v_add_u32 v97, s46, v97
v_add_u32 v92, 128, v1
v_mul_u32_u24 v93, s55, v92
v_lshrrev_b32 v93, 18, v93
v_mul_u32_u24 v94, 6, v93
v_sub_u32 v94, v92, v94
v_mul_lo_u32 v93, v93, s56
v_lshl_add_u32 v98, v94, 4, v93
v_add_u32 v98, s46, v98
v_add_u32 v92, 192, v1
v_mul_u32_u24 v93, s55, v92
v_lshrrev_b32 v93, 18, v93
v_mul_u32_u24 v94, 6, v93
v_sub_u32 v94, v92, v94
v_mul_lo_u32 v93, v93, s56
v_lshl_add_u32 v99, v94, 4, v93
v_add_u32 v99, s46, v99
v_add_u32 v92, 256, v1
v_mul_u32_u24 v93, s55, v92
v_lshrrev_b32 v93, 18, v93
v_mul_u32_u24 v94, 6, v93
v_sub_u32 v94, v92, v94
v_mul_lo_u32 v93, v93, s56
v_lshl_add_u32 v100, v94, 4, v93
v_add_u32 v100, s46, v100
v_add_u32 v92, 320, v1
v_mul_u32_u24 v93, s55, v92
v_lshrrev_b32 v93, 18, v93
v_mul_u32_u24 v94, 6, v93
v_sub_u32 v94, v92, v94
v_mul_lo_u32 v93, v93, s56
v_lshl_add_u32 v101, v94, 4, v93
v_add_u32 v101, s46, v101
v_add_u32 v92, 384, v1
v_mul_u32_u24 v93, s55, v92
v_lshrrev_b32 v93, 18, v93
v_mul_u32_u24 v94, 6, v93
v_sub_u32 v94, v92, v94
v_mul_lo_u32 v93, v93, s56
v_lshl_add_u32 v102, v94, 4, v93
v_add_u32 v102, s46, v102
v_add_u32 v92, 448, v1
v_mul_u32_u24 v93, s55, v92
v_lshrrev_b32 v93, 18, v93
v_mul_u32_u24 v94, 6, v93
v_sub_u32 v94, v92, v94
v_mul_lo_u32 v93, v93, s56
v_lshl_add_u32 v103, v94, 4, v93
v_add_u32 v103, s46, v103
v_add_u32 v92, 512, v1
v_mul_u32_u24 v93, s55, v92
v_lshrrev_b32 v93, 18, v93
v_mul_u32_u24 v94, 6, v93
v_sub_u32 v94, v92, v94
v_mul_lo_u32 v93, v93, s56
v_lshl_add_u32 v104, v94, 4, v93
v_add_u32 v104, s46, v104
v_add_u32 v92, 576, v1
v_mul_u32_u24 v93, s55, v92
v_lshrrev_b32 v93, 18, v93
v_mul_u32_u24 v94, 6, v93
v_sub_u32 v94, v92, v94
v_mul_lo_u32 v93, v93, s56
v_lshl_add_u32 v105, v94, 4, v93
v_add_u32 v105, s46, v105
v_add_u32 v92, 640, v1
v_mul_u32_u24 v93, s55, v92
v_lshrrev_b32 v93, 18, v93
v_mul_u32_u24 v94, 6, v93
v_sub_u32 v94, v92, v94
v_mul_lo_u32 v93, v93, s56
v_lshl_add_u32 v106, v94, 4, v93
v_add_u32 v106, s46, v106
v_add_u32 v92, 704, v1
v_mul_u32_u24 v93, s55, v92
v_lshrrev_b32 v93, 18, v93
v_mul_u32_u24 v94, 6, v93
v_sub_u32 v94, v92, v94
v_mul_lo_u32 v93, v93, s56
v_lshl_add_u32 v107, v94, 4, v93
v_add_u32 v107, s46, v107
v_add_u32 v92, 768, v1
v_mul_u32_u24 v93, s55, v92
v_lshrrev_b32 v93, 18, v93
v_mul_u32_u24 v94, 6, v93
v_sub_u32 v94, v92, v94
v_mul_lo_u32 v93, v93, s56
v_lshl_add_u32 v108, v94, 4, v93
v_add_u32 v108, s46, v108
v_add_u32 v92, 832, v1
v_mul_u32_u24 v93, s55, v92
v_lshrrev_b32 v93, 18, v93
v_mul_u32_u24 v94, 6, v93
v_sub_u32 v94, v92, v94
v_mul_lo_u32 v93, v93, s56
v_lshl_add_u32 v109, v94, 4, v93
v_add_u32 v109, s46, v109
v_add_u32 v92, 896, v1
v_mul_u32_u24 v93, s55, v92
v_lshrrev_b32 v93, 18, v93
v_mul_u32_u24 v94, 6, v93
v_sub_u32 v94, v92, v94
v_mul_lo_u32 v93, v93, s56
v_lshl_add_u32 v110, v94, 4, v93
v_add_u32 v110, s46, v110
v_add_u32 v92, 960, v1
v_mul_u32_u24 v93, s55, v92
v_lshrrev_b32 v93, 18, v93
v_mul_u32_u24 v94, 6, v93
v_sub_u32 v94, v92, v94
v_mul_lo_u32 v93, v93, s56
v_lshl_add_u32 v111, v94, 4, v93
v_add_u32 v111, s46, v111
v_add_u32 v92, 1024, v1
v_mul_u32_u24 v93, s55, v92
v_lshrrev_b32 v93, 18, v93
v_mul_u32_u24 v94, 6, v93
v_sub_u32 v94, v92, v94
v_mul_lo_u32 v93, v93, s56
v_lshl_add_u32 v112, v94, 4, v93
v_add_u32 v112, s46, v112
v_add_u32 v92, 1088, v1
v_mul_u32_u24 v93, s55, v92
v_lshrrev_b32 v93, 18, v93
v_mul_u32_u24 v94, 6, v93
v_sub_u32 v94, v92, v94
v_mul_lo_u32 v93, v93, s56
v_lshl_add_u32 v113, v94, 4, v93
v_add_u32 v113, s46, v113
s_mov_b32 s24, s14
s_mov_b32 s25, s15
s_mov_b32 s26, 7864320
s_mov_b32 s27, 0x00020000
buffer_load_dwordx4 v[152:155], v96, s[24:27], 0 offen
buffer_load_dwordx4 v[156:159], v97, s[24:27], 0 offen
buffer_load_dwordx4 v[160:163], v98, s[24:27], 0 offen
buffer_load_dwordx4 v[164:167], v99, s[24:27], 0 offen
buffer_load_dwordx4 v[168:171], v100, s[24:27], 0 offen
buffer_load_dwordx4 v[172:175], v101, s[24:27], 0 offen
buffer_load_dwordx4 v[176:179], v102, s[24:27], 0 offen
buffer_load_dwordx4 v[180:183], v103, s[24:27], 0 offen
buffer_load_dwordx4 v[184:187], v104, s[24:27], 0 offen
buffer_load_dwordx4 v[188:191], v105, s[24:27], 0 offen
buffer_load_dwordx4 v[192:195], v106, s[24:27], 0 offen
buffer_load_dwordx4 v[196:199], v107, s[24:27], 0 offen
buffer_load_dwordx4 v[200:203], v108, s[24:27], 0 offen
buffer_load_dwordx4 v[204:207], v109, s[24:27], 0 offen
buffer_load_dwordx4 v[208:211], v110, s[24:27], 0 offen
buffer_load_dwordx4 v[212:215], v111, s[24:27], 0 offen
buffer_load_dwordx4 v[216:219], v112, s[24:27], 0 offen
buffer_load_dwordx4 v[220:223], v113, s[24:27], 0 offen
s_waitcnt vmcnt(17)
ds_write_b128 v117, v[152:155] offset:0
s_waitcnt vmcnt(16)
ds_write_b128 v117, v[156:159] offset:1024
s_waitcnt vmcnt(15)
ds_write_b128 v117, v[160:163] offset:2048
s_waitcnt vmcnt(14)
ds_write_b128 v117, v[164:167] offset:3072
s_waitcnt vmcnt(13)
ds_write_b128 v117, v[168:171] offset:4096
s_waitcnt vmcnt(12)
ds_write_b128 v117, v[172:175] offset:5120
s_waitcnt vmcnt(11)
ds_write_b128 v117, v[176:179] offset:6144
s_waitcnt vmcnt(10)
ds_write_b128 v117, v[180:183] offset:7168
s_waitcnt vmcnt(9)
ds_write_b128 v117, v[184:187] offset:8192
s_waitcnt vmcnt(8)
ds_write_b128 v117, v[188:191] offset:9216
s_waitcnt vmcnt(7)
ds_write_b128 v117, v[192:195] offset:10240
s_waitcnt vmcnt(6)
ds_write_b128 v117, v[196:199] offset:11264
s_waitcnt vmcnt(5)
ds_write_b128 v117, v[200:203] offset:12288
s_waitcnt vmcnt(4)
ds_write_b128 v117, v[204:207] offset:13312
s_waitcnt vmcnt(3)
ds_write_b128 v117, v[208:211] offset:14336
s_waitcnt vmcnt(2)
ds_write_b128 v117, v[212:215] offset:15360
s_waitcnt vmcnt(1)
ds_write_b128 v117, v[216:219] offset:16384
s_waitcnt vmcnt(0)
ds_write_b128 v117, v[220:223] offset:17408
s_waitcnt lgkmcnt(0)
ds_read_b64_tr_b16 v[152:153], v116 offset:0
ds_read_b64_tr_b16 v[154:155], v116 offset:1536
ds_read_b64_tr_b16 v[156:157], v116 offset:3072
ds_read_b64_tr_b16 v[158:159], v116 offset:4608
ds_read_b64_tr_b16 v[160:161], v116 offset:6144
ds_read_b64_tr_b16 v[162:163], v116 offset:7680
ds_read_b64_tr_b16 v[164:165], v116 offset:9216
ds_read_b64_tr_b16 v[166:167], v116 offset:10752
ds_read_b64_tr_b16 v[168:169], v116 offset:12288
ds_read_b64_tr_b16 v[170:171], v116 offset:13824
ds_read_b64_tr_b16 v[172:173], v116 offset:15360
ds_read_b64_tr_b16 v[174:175], v116 offset:16896
ds_read_b64_tr_b16 v[176:177], v116 offset:32
ds_read_b64_tr_b16 v[178:179], v116 offset:1568
ds_read_b64_tr_b16 v[180:181], v116 offset:3104
ds_read_b64_tr_b16 v[182:183], v116 offset:4640
ds_read_b64_tr_b16 v[184:185], v116 offset:6176
ds_read_b64_tr_b16 v[186:187], v116 offset:7712
ds_read_b64_tr_b16 v[188:189], v116 offset:9248
ds_read_b64_tr_b16 v[190:191], v116 offset:10784
ds_read_b64_tr_b16 v[192:193], v116 offset:12320
ds_read_b64_tr_b16 v[194:195], v116 offset:13856
ds_read_b64_tr_b16 v[196:197], v116 offset:15392
ds_read_b64_tr_b16 v[198:199], v116 offset:16928
ds_read_b64_tr_b16 v[200:201], v116 offset:64
ds_read_b64_tr_b16 v[202:203], v116 offset:1600
ds_read_b64_tr_b16 v[204:205], v116 offset:3136
ds_read_b64_tr_b16 v[206:207], v116 offset:4672
ds_read_b64_tr_b16 v[208:209], v116 offset:6208
ds_read_b64_tr_b16 v[210:211], v116 offset:7744
ds_read_b64_tr_b16 v[212:213], v116 offset:9280
ds_read_b64_tr_b16 v[214:215], v116 offset:10816
ds_read_b64_tr_b16 v[216:217], v116 offset:12352
ds_read_b64_tr_b16 v[218:219], v116 offset:13888
ds_read_b64_tr_b16 v[220:221], v116 offset:15424
ds_read_b64_tr_b16 v[222:223], v116 offset:16960
s_waitcnt lgkmcnt(0)
v_accvgpr_write_b32 a180, v152
v_accvgpr_write_b32 a181, v153
v_accvgpr_write_b32 a182, v154
v_accvgpr_write_b32 a183, v155
v_accvgpr_write_b32 a184, v156
v_accvgpr_write_b32 a185, v157
v_accvgpr_write_b32 a186, v158
v_accvgpr_write_b32 a187, v159
v_accvgpr_write_b32 a188, v160
v_accvgpr_write_b32 a189, v161
v_accvgpr_write_b32 a190, v162
v_accvgpr_write_b32 a191, v163
v_accvgpr_write_b32 a192, v164
v_accvgpr_write_b32 a193, v165
v_accvgpr_write_b32 a194, v166
v_accvgpr_write_b32 a195, v167
v_accvgpr_write_b32 a196, v168
v_accvgpr_write_b32 a197, v169
v_accvgpr_write_b32 a198, v170
v_accvgpr_write_b32 a199, v171
v_accvgpr_write_b32 a200, v172
v_accvgpr_write_b32 a201, v173
v_accvgpr_write_b32 a202, v174
v_accvgpr_write_b32 a203, v175
v_accvgpr_write_b32 a204, v176
v_accvgpr_write_b32 a205, v177
v_accvgpr_write_b32 a206, v178
v_accvgpr_write_b32 a207, v179
v_accvgpr_write_b32 a208, v180
v_accvgpr_write_b32 a209, v181
v_accvgpr_write_b32 a210, v182
v_accvgpr_write_b32 a211, v183
v_accvgpr_write_b32 a212, v184
v_accvgpr_write_b32 a213, v185
v_accvgpr_write_b32 a214, v186
v_accvgpr_write_b32 a215, v187
v_accvgpr_write_b32 a216, v188
v_accvgpr_write_b32 a217, v189
v_accvgpr_write_b32 a218, v190
v_accvgpr_write_b32 a219, v191
v_accvgpr_write_b32 a220, v192
v_accvgpr_write_b32 a221, v193
v_accvgpr_write_b32 a222, v194
v_accvgpr_write_b32 a223, v195
v_accvgpr_write_b32 a224, v196
v_accvgpr_write_b32 a225, v197
v_accvgpr_write_b32 a226, v198
v_accvgpr_write_b32 a227, v199
v_accvgpr_write_b32 a228, v200
v_accvgpr_write_b32 a229, v201
v_accvgpr_write_b32 a230, v202
v_accvgpr_write_b32 a231, v203
v_accvgpr_write_b32 a232, v204
v_accvgpr_write_b32 a233, v205
v_accvgpr_write_b32 a234, v206
v_accvgpr_write_b32 a235, v207
v_accvgpr_write_b32 a236, v208
v_accvgpr_write_b32 a237, v209
v_accvgpr_write_b32 a238, v210
v_accvgpr_write_b32 a239, v211
v_accvgpr_write_b32 a240, v212
v_accvgpr_write_b32 a241, v213
v_accvgpr_write_b32 a242, v214
v_accvgpr_write_b32 a243, v215
v_accvgpr_write_b32 a244, v216
v_accvgpr_write_b32 a245, v217
v_accvgpr_write_b32 a246, v218
v_accvgpr_write_b32 a247, v219
v_accvgpr_write_b32 a248, v220
v_accvgpr_write_b32 a249, v221
v_accvgpr_write_b32 a250, v222
v_accvgpr_write_b32 a251, v223
s_mul_i32 s45, s29, 10240
s_mul_i32 s46, s28, 2560
s_add_u32 s45, s45, s46
s_add_u32 s45, s45, 75497472
v_add_u32 v4, s45, v2
s_mul_i32 s61, s31, 6144
s_add_u32 s61, s61, 75825152
v_add_u32 v5, s61, v2
s_lshl_b32 s45, s28, 9
v_add_u32 v7, s45, v2
v_add_u32 v8, s45, v3
s_lshl_b32 s46, s28, 11
v_add_u32 v11, s46, v3
s_mul_i32 s46, s32, 3
s_add_u32 s46, s46, s28
s_lshr_b32 s47, s46, 1
s_lshl_b32 s47, s47, 9
s_and_b32 s48, s46, 1
s_lshl_b32 s48, s48, 3
s_add_u32 s47, s47, s48
s_add_u32 s48, s47, s61
v_add_u32 v9, s48, v3
v_add_u32 v10, 3072, v9
s_mul_i32 s48, s31, 3072
s_add_u32 s48, s48, s47
s_add_u32 s48, s48, 77660160
v_add_u32 v14, s48, v3
v_and_b32 v28, 31, v1
v_lshlrev_b32 v13, 4, v28
s_mul_i32 s48, s31, 3072
s_mul_i32 s47, s32, 768
s_add_u32 s48, s48, s47
s_add_u32 s48, s48, 83951616
v_lshlrev_b32 v28, 3, v28
v_add_u32 v15, s48, v28
s_mul_i32 s45, s32, 3
s_add_u32 s45, s45, 0
s_lshr_b32 s46, s45, 1
s_lshl_b32 s46, s46, 9
s_and_b32 s47, s45, 1
s_lshl_b32 s47, s47, 3
s_add_u32 s46, s46, s47
s_mul_i32 s47, s31, 3072
s_add_u32 s46, s46, s47
s_add_u32 s46, s46, 76611584
v_add_u32 v16, s46, v2
s_mul_i32 s45, s32, 3
s_add_u32 s45, s45, 1
s_lshr_b32 s46, s45, 1
s_lshl_b32 s46, s46, 9
s_and_b32 s47, s45, 1
s_lshl_b32 s47, s47, 3
s_add_u32 s46, s46, s47
s_mul_i32 s47, s31, 3072
s_add_u32 s46, s46, s47
s_add_u32 s46, s46, 76611584
v_add_u32 v17, s46, v2
s_mul_i32 s45, s32, 3
s_add_u32 s45, s45, 2
s_lshr_b32 s46, s45, 1
s_lshl_b32 s46, s46, 9
s_and_b32 s47, s45, 1
s_lshl_b32 s47, s47, 3
s_add_u32 s46, s46, s47
s_mul_i32 s47, s31, 3072
s_add_u32 s46, s46, s47
s_add_u32 s46, s46, 76611584
v_add_u32 v18, s46, v2
s_add_u32 s45, s58, s28
s_lshl_b32 s46, s45, 12
s_add_u32 s46, s46, 77004800
v_add_u32 v20, s46, v3
s_lshl_b32 s47, s29, 9
s_add_u32 s46, s46, s47
v_add_u32 v19, s46, v3
s_lshr_b32 s46, s45, 1
s_lshl_b32 s46, s46, 9
s_and_b32 s47, s45, 1
s_lshl_b32 s47, s47, 3
s_add_u32 s46, s46, s47
s_add_u32 s48, s46, 90253312
v_add_u32 v22, s48, v3
s_mul_i32 s47, s29, 10240
s_add_u32 s46, s46, s47
s_add_u32 s46, s46, 75497472
v_add_u32 v21, s46, v3
s_mov_b32 s33, 0
s_mov_b32 s60, 0
s_mul_i32 s59, s31, 12288
s_mov_b32 s57, 0xfffffffe
s_mov_b32 s55, 0x3dd53b95
s_waitcnt vmcnt(0) lgkmcnt(0)
s_barrier
s_cmp_lg_u32 s28, 3
s_cbranch_scc1 L_nopf0_B
s_and_b32 s45, s33, 7
s_cmp_lg_u32 s45, 0
s_cbranch_scc1 L_kvw1_ok_B
s_lshr_b32 s45, s33, 3
s_lshl_b32 s46, s29, 3
s_add_u32 s45, s45, s46
s_lshl_b32 s45, s45, 6
s_add_u32 s45, s45, 178466816
v_and_b32 v34, 15, v1
v_lshlrev_b32 v34, 2, v34
s_nop 1
L_kvw1_B:
buffer_load_dword v35, v34, s[20:23], s45 offen sc1
s_waitcnt vmcnt(0)
v_cmp_eq_u32 vcc, 0, v35
s_add_u32 s60, s60, 1
s_cmp_gt_u32 s60, 400000
s_cbranch_scc1 L_rec_fail_B
s_cbranch_vccz L_kvw1_ok_B
s_sleep 4
s_branch L_kvw1_B
L_kvw1_ok_B:
s_add_u32 s45, s59, 0
s_add_u32 s46, s45, 4096
s_add_u32 s47, s45, 8192
buffer_load_dwordx4 v[92:95], v3, s[20:23], s45 offen offset:0 sc1
buffer_load_dwordx4 v[96:99], v3, s[20:23], s45 offen offset:1024 sc1
buffer_load_dwordx4 v[100:103], v3, s[20:23], s45 offen offset:2048 sc1
buffer_load_dwordx4 v[104:107], v3, s[20:23], s45 offen offset:3072 sc1
buffer_load_dwordx4 v[108:111], v3, s[20:23], s46 offen offset:0 sc1
buffer_load_dwordx4 v[112:115], v3, s[20:23], s46 offen offset:1024 sc1
buffer_load_dwordx4 v[116:119], v3, s[20:23], s46 offen offset:2048 sc1
buffer_load_dwordx4 v[120:123], v3, s[20:23], s46 offen offset:3072 sc1
buffer_load_dwordx4 v[124:127], v3, s[20:23], s47 offen offset:0 sc1
buffer_load_dwordx4 v[128:131], v3, s[20:23], s47 offen offset:1024 sc1
buffer_load_dwordx4 v[132:135], v3, s[20:23], s47 offen offset:2048 sc1
buffer_load_dwordx4 v[136:139], v3, s[20:23], s47 offen offset:3072 sc1
s_mul_i32 s48, s32, 3072
s_add_u32 s48, s48, s59
s_add_u32 s48, s48, 25165824
buffer_load_dwordx4 v[140:143], v3, s[20:23], s48 offen offset:0 sc1
buffer_load_dwordx4 v[144:147], v3, s[20:23], s48 offen offset:1024 sc1
buffer_load_dwordx4 v[148:151], v3, s[20:23], s48 offen offset:2048 sc1
L_nopf0_B:
s_mov_b32 s16, 0
s_mov_b32 s17, 0
s_mov_b32 s18, 8
v_add_u32 v232, 3072, v5
s_lshl_b32 s45, s28, 8
s_add_u32 s45, s45, 24576
v_lshlrev_b32 v28, 3, v1
v_add_u32 v233, s45, v28
v_and_b32 v28, 31, v1
v_lshlrev_b32 v28, 3, v28
v_add_u32 v234, 24576, v28
s_mul_i32 s48, s31, 3072
s_mul_i32 s47, s32, 768
s_add_u32 s48, s48, s47
s_lshl_b32 s47, s28, 8
s_add_u32 s48, s48, s47
s_add_u32 s48, s48, 83951616
v_lshlrev_b32 v28, 3, v1
v_add_u32 v15, s48, v28
s_mov_b32 s14, 0
s_mov_b32 s15, -1
v_and_b32 v28, 31, v1
v_lshlrev_b32 v28, 4, v28
v_lshrrev_b32 v29, 5, v1
v_mul_u32_u24 v30, 6144, v29
s_lshl_b32 s46, s28, 11
v_add3_u32 v235, v28, v30, s46
v_sub_u32 v31, v9, v3
v_mul_u32_u24 v30, 3072, v29
v_add3_u32 v236, v31, v28, v30
v_sub_u32 v31, v14, v3
v_add_u32 v14, v31, v28
v_mov_b32 v237, 73744
v_mov_b32 v238, 1
v_mov_b32 v28, 0
ds_write_b32 v237, v28
ds_write_b32 v237, v28 offset:16
s_mov_b32 s12, 0
s_mov_b32 s13, 0
s_mov_b32 s10, 0
s_waitcnt lgkmcnt(0)
s_barrier
v_mov_b32 v240, s55
v_mov_b32 v241, s55
v_mov_b32 v244, 0
v_mov_b32 v245, 0
v_mov_b32 v246, 0
v_mov_b32 v247, 0
s_mov_b64 exec, s[14:15]
v_mov_b32 v244, 0xff800000
v_mov_b32 v245, 0xff800000
v_mov_b32 v246, 0xff800000
v_mov_b32 v247, 0xff800000
s_mov_b64 exec, -1
v_bfe_u32 v28, v1, 3, 1
v_lshlrev_b32 v28, 9, v28
v_add_u32 v248, v4, v28
v_add_u32 v249, v6, v28
v_add_u32 v250, v5, v28
v_add_u32 v239, 3072, v250
s_nop 1
L_step_B:
s_add_u32 s34, s33, 0
s_and_b32 s34, s34, 3
s_mul_i32 s34, s34, 81920
s_mov_b32 s45, s16
L_pm_sl_B:
s_cmp_eq_u32 s45, 0
s_cbranch_scc1 L_pm_go_B
s_sleep 1
s_sub_u32 s45, s45, 1
s_branch L_pm_sl_B
L_pm_go_B:
v_mov_b32 v52, 0
v_mov_b32 v54, 0
s_mov_b32 s19, 0
buffer_load_dwordx4 v[36:39], v248, s[20:23], s34 offen offset:0 sc1
buffer_load_dwordx4 v[44:47], v248, s[20:23], s34 offen offset:1024 sc1
s_mov_b64 exec, s[50:51]
buffer_load_dwordx4 v[52:55], v248, s[20:23], s34 offen offset:2048 sc1
s_mov_b64 exec, -1
s_add_u32 s35, s33, 1
s_and_b32 s35, s35, 3
s_mul_i32 s35, s35, 81920
s_add_u32 s36, s33, 3
s_and_b32 s36, s36, 3
s_mul_i32 s36, s36, 81920
s_add_u32 s12, s12, 4
s_add_u32 s13, s13, 3
s_add_u32 s37, s33, 0
s_and_b32 s37, s37, 3
s_mul_i32 s37, s37, 196608
s_add_u32 s38, s33, 2
s_and_b32 s38, s38, 3
s_mul_i32 s38, s38, 196608
s_add_u32 s39, s33, 0
s_and_b32 s39, s39, 3
s_mul_i32 s39, s39, 98304
s_add_u32 s40, s33, 2
s_and_b32 s40, s40, 3
s_mul_i32 s40, s40, 98304
s_add_u32 s41, s33, 0
s_and_b32 s41, s41, 3
s_mul_i32 s41, s41, 163840
s_add_u32 s42, s33, 2
s_and_b32 s42, s42, 3
s_mul_i32 s42, s42, 163840
s_mul_i32 s43, s33, 98304
s_mov_b32 s19, 0
s_branch L_pm_w_B
L_pm_retry_B:
s_add_u32 s19, s19, 1
s_add_u32 s60, s60, 1
s_cmp_gt_u32 s60, 400000
s_cbranch_scc1 L_rec_fail_B
buffer_load_dwordx4 v[36:39], v248, s[20:23], s34 offen offset:0 sc1
buffer_load_dwordx4 v[44:47], v248, s[20:23], s34 offen offset:1024 sc1
s_mov_b64 exec, s[50:51]
buffer_load_dwordx4 v[52:55], v248, s[20:23], s34 offen offset:2048 sc1
s_mov_b64 exec, -1
L_pm_w_B:
s_waitcnt vmcnt(0)
v_max3_u32 v28, v36, v38, v44
v_max3_u32 v28, v28, v46, v52
v_max_u32 v28, v28, v54
v_cmp_eq_u32 vcc, -1, v28
s_cbranch_vccnz L_pm_retry_B
s_mov_b32 s3, s19
v_mfma_f32_16x16x32_bf16 v[56:59], a[0:3], v[36:39], 0
v_mov_b32_dpp v40, v36 row_ror:8 row_mask:0xf bank_mask:0xf
v_mfma_f32_16x16x32_bf16 v[60:63], a[20:23], v[36:39], 0
v_mov_b32_dpp v41, v37 row_ror:8 row_mask:0xf bank_mask:0xf
v_mfma_f32_16x16x32_bf16 v[64:67], a[40:43], v[36:39], 0
v_mov_b32_dpp v42, v38 row_ror:8 row_mask:0xf bank_mask:0xf
v_mfma_f32_16x16x32_bf16 v[56:59], a[8:11], v[44:47], v[56:59]
v_mov_b32_dpp v43, v39 row_ror:8 row_mask:0xf bank_mask:0xf
v_mfma_f32_16x16x32_bf16 v[60:63], a[28:31], v[44:47], v[60:63]
v_mov_b32_dpp v48, v44 row_ror:8 row_mask:0xf bank_mask:0xf
v_mfma_f32_16x16x32_bf16 v[64:67], a[48:51], v[44:47], v[64:67]
v_mov_b32_dpp v49, v45 row_ror:8 row_mask:0xf bank_mask:0xf
v_mfma_f32_16x16x32_bf16 v[56:59], a[16:19], v[52:55], v[56:59]
v_mov_b32_dpp v50, v46 row_ror:8 row_mask:0xf bank_mask:0xf
v_mfma_f32_16x16x32_bf16 v[60:63], a[36:39], v[52:55], v[60:63]
v_mov_b32_dpp v51, v47 row_ror:8 row_mask:0xf bank_mask:0xf
v_mfma_f32_16x16x32_bf16 v[64:67], a[56:59], v[52:55], v[64:67]
v_mfma_f32_16x16x32_bf16 v[56:59], a[4:7], v[40:43], v[56:59]
v_mfma_f32_16x16x32_bf16 v[60:63], a[24:27], v[40:43], v[60:63]
v_mfma_f32_16x16x32_bf16 v[64:67], a[44:47], v[40:43], v[64:67]
v_mfma_f32_16x16x32_bf16 v[56:59], a[12:15], v[48:51], v[56:59]
v_mfma_f32_16x16x32_bf16 v[60:63], a[32:35], v[48:51], v[60:63]
v_mfma_f32_16x16x32_bf16 v[64:67], a[52:55], v[48:51], v[64:67]
v_mfma_f32_16x16x32_bf16 v[68:71], a[60:63], v[36:39], 0
v_mfma_f32_16x16x32_bf16 v[72:75], a[80:83], v[36:39], 0
v_mfma_f32_16x16x32_bf16 v[76:79], a[100:103], v[36:39], 0
v_mfma_f32_16x16x32_bf16 v[68:71], a[68:71], v[44:47], v[68:71]
v_mfma_f32_16x16x32_bf16 v[72:75], a[88:91], v[44:47], v[72:75]
v_mfma_f32_16x16x32_bf16 v[76:79], a[108:111], v[44:47], v[76:79]
v_mfma_f32_16x16x32_bf16 v[68:71], a[76:79], v[52:55], v[68:71]
v_mfma_f32_16x16x32_bf16 v[72:75], a[96:99], v[52:55], v[72:75]
v_mfma_f32_16x16x32_bf16 v[76:79], a[116:119], v[52:55], v[76:79]
s_mov_b64 exec, s[50:51]
ds_write_b128 v7, v[56:59] offset:0
ds_write_b128 v7, v[60:63] offset:2048
ds_write_b128 v7, v[64:67] offset:4096
s_mov_b64 exec, -1
v_mfma_f32_16x16x32_bf16 v[68:71], a[64:67], v[40:43], v[68:71]
v_mfma_f32_16x16x32_bf16 v[72:75], a[84:87], v[40:43], v[72:75]
v_mfma_f32_16x16x32_bf16 v[76:79], a[104:107], v[40:43], v[76:79]
v_mfma_f32_16x16x32_bf16 v[68:71], a[72:75], v[48:51], v[68:71]
v_mfma_f32_16x16x32_bf16 v[72:75], a[92:95], v[48:51], v[72:75]
v_mfma_f32_16x16x32_bf16 v[76:79], a[112:115], v[48:51], v[76:79]
s_mov_b64 exec, s[50:51]
s_nop 4
ds_write_b128 v7, v[68:71] offset:6144
ds_write_b128 v7, v[72:75] offset:8192
ds_write_b128 v7, v[76:79] offset:10240
s_mov_b64 exec, -1
v_mfma_f32_16x16x32_bf16 v[80:83], v[36:39], a[120:123], 0
v_mfma_f32_16x16x32_bf16 v[84:87], v[36:39], a[140:143], 0
v_mfma_f32_16x16x32_bf16 v[88:91], v[36:39], a[160:163], 0
s_waitcnt lgkmcnt(0)
s_barrier
s_cmp_eq_u32 s28, 3
s_cbranch_scc1 L_w3_B
ds_read_b128 v[92:95], v235 offset:0
ds_read_b128 v[96:99], v235 offset:512
ds_read_b128 v[100:103], v235 offset:1024
ds_read_b128 v[104:107], v235 offset:1536
v_mfma_f32_16x16x32_bf16 v[80:83], v[40:43], a[124:127], v[80:83]
v_mfma_f32_16x16x32_bf16 v[84:87], v[40:43], a[144:147], v[84:87]
v_mfma_f32_16x16x32_bf16 v[88:91], v[40:43], a[164:167], v[88:91]
v_mfma_f32_16x16x32_bf16 v[80:83], v[44:47], a[128:131], v[80:83]
v_mfma_f32_16x16x32_bf16 v[84:87], v[44:47], a[148:151], v[84:87]
v_mfma_f32_16x16x32_bf16 v[88:91], v[44:47], a[168:171], v[88:91]
s_waitcnt lgkmcnt(0)
v_pk_add_f32 v[92:93], v[92:93], v[96:97]
v_pk_add_f32 v[100:101], v[100:101], v[104:105]
v_pk_add_f32 v[94:95], v[94:95], v[98:99]
v_pk_add_f32 v[102:103], v[102:103], v[106:107]
v_pk_add_f32 v[92:93], v[92:93], v[100:101]
v_pk_add_f32 v[94:95], v[94:95], v[102:103]
v_cvt_pk_bf16_f32 v96, v92, v93
v_cvt_pk_bf16_f32 v97, v94, v95
v_min_u32 v96, s57, v96
buffer_store_dwordx2 v[96:97], v236, s[20:23], s37 offen sc1
v_mfma_f32_16x16x32_bf16 v[80:83], v[48:51], a[132:135], v[80:83]
v_mfma_f32_16x16x32_bf16 v[84:87], v[48:51], a[152:155], v[84:87]
v_mfma_f32_16x16x32_bf16 v[88:91], v[48:51], a[172:175], v[88:91]
v_mfma_f32_16x16x32_bf16 v[80:83], v[52:55], a[136:139], v[80:83]
v_mfma_f32_16x16x32_bf16 v[84:87], v[52:55], a[156:159], v[84:87]
v_mfma_f32_16x16x32_bf16 v[88:91], v[52:55], a[176:179], v[88:91]
buffer_store_dwordx2 v[24:25], v236, s[20:23], s38 offen sc1
s_mov_b64 exec, s[14:15]
buffer_store_dwordx2 v[96:97], v14, s[20:23], s43 offen sc1
s_mov_b64 exec, -1
s_mov_b64 exec, s[52:53]
s_nop 0
ds_write_b128 v8, v[80:83] offset:12288
ds_write_b128 v8, v[84:87] offset:14336
ds_write_b128 v8, v[88:91] offset:16384
s_mov_b64 exec, -1
s_waitcnt lgkmcnt(0)
s_mov_b64 exec, 1
ds_add_u32 v237, v238 offset:0
s_mov_b64 exec, -1
L_cw1_B:
ds_read_b32 v35, v237 offset:0
s_waitcnt lgkmcnt(0)
v_readfirstlane_b32 s45, v35
s_nop 0
s_cmp_lt_u32 s45, s12
s_cbranch_scc1 L_cw1_B
ds_read_b128 v[92:95], v11 offset:12288
ds_read_b128 v[96:99], v11 offset:12800
ds_read_b128 v[100:103], v11 offset:13312
ds_read_b128 v[104:107], v11 offset:13824
s_waitcnt lgkmcnt(0)
v_pk_add_f32 v[92:93], v[92:93], v[96:97]
v_pk_add_f32 v[100:101], v[100:101], v[104:105]
v_pk_add_f32 v[94:95], v[94:95], v[98:99]
v_pk_add_f32 v[102:103], v[102:103], v[106:107]
v_pk_add_f32 v[92:93], v[92:93], v[100:101]
v_pk_add_f32 v[94:95], v[94:95], v[102:103]
v_cvt_pk_bf16_f32 v96, v92, v93
v_cvt_pk_bf16_f32 v97, v94, v95
s_mov_b64 exec, s[52:53]
ds_write_b64 v233, v[96:97]
buffer_store_dwordx2 v[96:97], v15, s[20:23], s43 offen sc1
s_mov_b64 exec, -1
s_waitcnt lgkmcnt(0)
s_mov_b64 exec, 1
ds_add_u32 v237, v238 offset:16
s_mov_b64 exec, -1
s_waitcnt vmcnt(0)
s_lshl_b32 s45, s33, 5
s_add_u32 s45, s45, s31
s_lshl_b32 s45, s45, 6
s_add_u32 s45, s45, 178483200
s_mul_i32 s46, s32, 12
s_lshl_b32 s47, s28, 2
s_add_u32 s45, s45, s46
s_add_u32 s45, s45, s47
s_mov_b64 exec, 1
v_mov_b32 v34, s45
buffer_store_dword v238, v34, s[20:23], 0 offen sc1
s_mov_b64 exec, -1
s_branch L_p4_B
L_w3_B:
v_mfma_f32_16x16x32_bf16 v[80:83], v[40:43], a[124:127], v[80:83]
v_mfma_f32_16x16x32_bf16 v[84:87], v[40:43], a[144:147], v[84:87]
v_mfma_f32_16x16x32_bf16 v[88:91], v[40:43], a[164:167], v[88:91]
v_mfma_f32_16x16x32_bf16 v[80:83], v[44:47], a[128:131], v[80:83]
v_mfma_f32_16x16x32_bf16 v[84:87], v[44:47], a[148:151], v[84:87]
v_mfma_f32_16x16x32_bf16 v[88:91], v[44:47], a[168:171], v[88:91]
v_mfma_f32_16x16x32_bf16 v[80:83], v[48:51], a[132:135], v[80:83]
v_mfma_f32_16x16x32_bf16 v[84:87], v[48:51], a[152:155], v[84:87]
v_mfma_f32_16x16x32_bf16 v[88:91], v[48:51], a[172:175], v[88:91]
v_mfma_f32_16x16x32_bf16 v[80:83], v[52:55], a[136:139], v[80:83]
v_mfma_f32_16x16x32_bf16 v[84:87], v[52:55], a[156:159], v[84:87]
v_mfma_f32_16x16x32_bf16 v[88:91], v[52:55], a[176:179], v[88:91]
s_mov_b64 exec, s[52:53]
s_nop 4
ds_write_b128 v8, v[80:83] offset:12288
ds_write_b128 v8, v[84:87] offset:14336
ds_write_b128 v8, v[88:91] offset:16384
s_mov_b64 exec, -1
s_waitcnt lgkmcnt(0)
s_mov_b64 exec, 1
ds_add_u32 v237, v238 offset:0
s_mov_b64 exec, -1
s_mov_b32 s45, s10
L_pq_sl_B:
s_cmp_eq_u32 s45, 0
s_cbranch_scc1 L_pq_go_B
s_sleep 1
s_sub_u32 s45, s45, 1
s_branch L_pq_sl_B
L_pq_go_B:
s_mov_b32 s19, 0
buffer_load_dwordx4 v[152:155], v250, s[20:23], s37 offen offset:0 sc1
buffer_load_dwordx4 v[160:163], v250, s[20:23], s37 offen offset:1024 sc1
buffer_load_dwordx4 v[168:171], v250, s[20:23], s37 offen offset:2048 sc1
buffer_load_dwordx4 v[184:187], v239, s[20:23], s37 offen offset:0 sc1
buffer_load_dwordx4 v[192:195], v239, s[20:23], s37 offen offset:1024 sc1
buffer_load_dwordx4 v[200:203], v239, s[20:23], s37 offen offset:2048 sc1
s_branch L_pqk_w_B
L_pqk_retry_B:
s_add_u32 s19, s19, 1
s_add_u32 s60, s60, 1
s_cmp_gt_u32 s60, 400000
s_cbranch_scc1 L_rec_fail_B
buffer_load_dwordx4 v[152:155], v250, s[20:23], s37 offen offset:0 sc1
buffer_load_dwordx4 v[160:163], v250, s[20:23], s37 offen offset:1024 sc1
buffer_load_dwordx4 v[168:171], v250, s[20:23], s37 offen offset:2048 sc1
buffer_load_dwordx4 v[184:187], v239, s[20:23], s37 offen offset:0 sc1
buffer_load_dwordx4 v[192:195], v239, s[20:23], s37 offen offset:1024 sc1
buffer_load_dwordx4 v[200:203], v239, s[20:23], s37 offen offset:2048 sc1
L_pqk_w_B:
s_waitcnt vmcnt(0)
v_max3_u32 v28, v152, v154, v160
v_max3_u32 v28, v28, v162, v168
v_max3_u32 v28, v28, v170, v184
v_max3_u32 v28, v28, v186, v192
v_max3_u32 v28, v28, v194, v200
v_max_u32 v28, v28, v202
v_cmp_eq_u32 vcc, -1, v28
s_cbranch_vccnz L_pqk_retry_B
s_mov_b32 s9, s19
v_mfma_f32_16x16x32_bf16 v[36:39], v[92:95], v[152:155], 0
v_mov_b32_dpp v156, v152 row_ror:8 row_mask:0xf bank_mask:0xf
v_mov_b32_dpp v157, v153 row_ror:8 row_mask:0xf bank_mask:0xf
v_mov_b32_dpp v158, v154 row_ror:8 row_mask:0xf bank_mask:0xf
v_mfma_f32_16x16x32_bf16 v[40:43], v[116:119], v[152:155], 0
v_mov_b32_dpp v159, v155 row_ror:8 row_mask:0xf bank_mask:0xf
v_mov_b32_dpp v188, v184 row_ror:8 row_mask:0xf bank_mask:0xf
v_mov_b32_dpp v189, v185 row_ror:8 row_mask:0xf bank_mask:0xf
v_mfma_f32_16x16x32_bf16 v[44:47], v[184:187], v[152:155], v[244:247]
v_mov_b32_dpp v190, v186 row_ror:8 row_mask:0xf bank_mask:0xf
v_mov_b32_dpp v191, v187 row_ror:8 row_mask:0xf bank_mask:0xf
v_mov_b32_dpp v164, v160 row_ror:8 row_mask:0xf bank_mask:0xf
v_mfma_f32_16x16x32_bf16 v[36:39], v[100:103], v[160:163], v[36:39]
v_mov_b32_dpp v165, v161 row_ror:8 row_mask:0xf bank_mask:0xf
v_mov_b32_dpp v166, v162 row_ror:8 row_mask:0xf bank_mask:0xf
v_mov_b32_dpp v167, v163 row_ror:8 row_mask:0xf bank_mask:0xf
v_mfma_f32_16x16x32_bf16 v[40:43], v[124:127], v[160:163], v[40:43]
v_mov_b32_dpp v196, v192 row_ror:8 row_mask:0xf bank_mask:0xf
v_mov_b32_dpp v197, v193 row_ror:8 row_mask:0xf bank_mask:0xf
v_mov_b32_dpp v198, v194 row_ror:8 row_mask:0xf bank_mask:0xf
v_mfma_f32_16x16x32_bf16 v[44:47], v[192:195], v[160:163], v[44:47]
v_mov_b32_dpp v199, v195 row_ror:8 row_mask:0xf bank_mask:0xf
v_mov_b32_dpp v172, v168 row_ror:8 row_mask:0xf bank_mask:0xf
v_mov_b32_dpp v173, v169 row_ror:8 row_mask:0xf bank_mask:0xf
v_mfma_f32_16x16x32_bf16 v[36:39], v[108:111], v[168:171], v[36:39]
v_mov_b32_dpp v174, v170 row_ror:8 row_mask:0xf bank_mask:0xf
v_mov_b32_dpp v175, v171 row_ror:8 row_mask:0xf bank_mask:0xf
v_mov_b32_dpp v204, v200 row_ror:8 row_mask:0xf bank_mask:0xf
v_mfma_f32_16x16x32_bf16 v[40:43], v[132:135], v[168:171], v[40:43]
v_mov_b32_dpp v205, v201 row_ror:8 row_mask:0xf bank_mask:0xf
v_mov_b32_dpp v206, v202 row_ror:8 row_mask:0xf bank_mask:0xf
v_mov_b32_dpp v207, v203 row_ror:8 row_mask:0xf bank_mask:0xf
v_mfma_f32_16x16x32_bf16 v[44:47], v[200:203], v[168:171], v[44:47]
v_mfma_f32_16x16x32_bf16 v[36:39], v[96:99], v[156:159], v[36:39]
v_mfma_f32_16x16x32_bf16 v[40:43], v[120:123], v[156:159], v[40:43]
v_mfma_f32_16x16x32_bf16 v[44:47], v[188:191], v[156:159], v[44:47]
s_nop 7
L_cw2_B:
ds_read_b32 v35, v237 offset:16
s_waitcnt lgkmcnt(0)
v_readfirstlane_b32 s45, v35
s_nop 0
s_cmp_lt_u32 s45, s13
s_cbranch_scc1 L_cw2_B
ds_read_b64 v[176:177], v234 offset:0
ds_read_b64 v[178:179], v234 offset:256
ds_read_b64 v[180:181], v234 offset:512
v_mfma_f32_16x16x32_bf16 v[36:39], v[104:107], v[164:167], v[36:39]
v_mfma_f32_16x16x32_bf16 v[40:43], v[128:131], v[164:167], v[40:43]
v_mfma_f32_16x16x32_bf16 v[44:47], v[196:199], v[164:167], v[44:47]
v_mfma_f32_16x16x32_bf16 v[36:39], v[112:115], v[172:175], v[36:39]
v_mfma_f32_16x16x32_bf16 v[40:43], v[136:139], v[172:175], v[40:43]
v_mfma_f32_16x16x32_bf16 v[44:47], v[204:207], v[172:175], v[44:47]
s_nop 5
v_max3_f32 v28, v36, v37, v38
v_max3_f32 v29, v39, v40, v41
v_max3_f32 v28, v28, v42, v43
v_max3_f32 v29, v29, v44, v45
v_max3_f32 v28, v28, v46, v47
v_max_f32 v28, v28, v29
v_mov_b32 v29, v28
s_nop 1
v_permlane32_swap_b32 v28, v29
v_max_f32 v28, v28, v29
v_mov_b32 v29, v28
s_nop 1
v_permlane16_swap_b32 v28, v29
v_max_f32 v28, v28, v29
v_mov_b32 v29, v28
v_pk_add_f32 v[36:37], v[36:37], v[28:29] neg_lo:[0,1] neg_hi:[0,1]
v_pk_mul_f32 v[36:37], v[36:37], v[240:241]
v_pk_add_f32 v[38:39], v[38:39], v[28:29] neg_lo:[0,1] neg_hi:[0,1]
v_exp_f32 v36, v36
v_pk_mul_f32 v[38:39], v[38:39], v[240:241]
v_exp_f32 v37, v37
v_pk_add_f32 v[40:41], v[40:41], v[28:29] neg_lo:[0,1] neg_hi:[0,1]
v_exp_f32 v38, v38
v_pk_mul_f32 v[40:41], v[40:41], v[240:241]
v_exp_f32 v39, v39
v_cvt_pk_bf16_f32 v48, v36, v37
v_pk_add_f32 v[42:43], v[42:43], v[28:29] neg_lo:[0,1] neg_hi:[0,1]
v_exp_f32 v40, v40
v_pk_mul_f32 v[42:43], v[42:43], v[240:241]
v_exp_f32 v41, v41
v_cvt_pk_bf16_f32 v49, v38, v39
v_pk_add_f32 v[44:45], v[44:45], v[28:29] neg_lo:[0,1] neg_hi:[0,1]
v_exp_f32 v42, v42
v_pk_mul_f32 v[44:45], v[44:45], v[240:241]
v_exp_f32 v43, v43
v_cvt_pk_bf16_f32 v50, v40, v41
v_pk_add_f32 v[46:47], v[46:47], v[28:29] neg_lo:[0,1] neg_hi:[0,1]
v_exp_f32 v44, v44
v_pk_mul_f32 v[46:47], v[46:47], v[240:241]
v_exp_f32 v45, v45
v_cvt_pk_bf16_f32 v51, v42, v43
v_exp_f32 v46, v46
v_exp_f32 v47, v47
v_mfma_f32_16x16x32_bf16 v[56:59], v[140:143], v[48:51], 0
v_mfma_f32_16x16x32_bf16 v[60:63], v[144:147], v[48:51], 0
v_mfma_f32_16x16x32_bf16 v[64:67], v[148:151], v[48:51], 0
v_cvt_pk_bf16_f32 v52, v44, v45
v_cvt_pk_bf16_f32 v53, v46, v47
s_waitcnt lgkmcnt(0)
s_nop 0
v_mfma_f32_16x16x16_bf16 v[56:59], v[176:177], v[52:53], v[56:59]
v_mfma_f32_16x16x16_bf16 v[60:63], v[178:179], v[52:53], v[60:63]
v_mfma_f32_16x16x16_bf16 v[64:67], v[180:181], v[52:53], v[64:67]
v_pk_add_f32 v[36:37], v[36:37], v[42:43]
v_pk_add_f32 v[38:39], v[38:39], v[44:45]
v_pk_add_f32 v[40:41], v[40:41], v[46:47]
v_pk_add_f32 v[36:37], v[36:37], v[38:39]
v_pk_add_f32 v[36:37], v[36:37], v[40:41]
v_add_f32 v28, v36, v37
v_mov_b32 v29, v28
s_nop 1
v_permlane32_swap_b32 v28, v29
v_add_f32 v28, v28, v29
v_mov_b32 v29, v28
s_nop 1
v_permlane16_swap_b32 v28, v29
v_add_f32 v28, v28, v29
v_rcp_f32 v28, v28
s_nop 0
v_mov_b32 v29, v28
s_mov_b64 exec, s[50:51]
v_pk_mul_f32 v[56:57], v[56:57], v[28:29]
v_pk_mul_f32 v[58:59], v[58:59], v[28:29]
v_cvt_pk_bf16_f32 v30, v56, v57
v_cvt_pk_bf16_f32 v31, v58, v59
v_min_u32 v30, s57, v30
buffer_store_dwordx2 v[30:31], v16, s[20:23], s39 offen sc1
v_pk_mul_f32 v[60:61], v[60:61], v[28:29]
v_pk_mul_f32 v[62:63], v[62:63], v[28:29]
v_cvt_pk_bf16_f32 v32, v60, v61
v_cvt_pk_bf16_f32 v33, v62, v63
v_min_u32 v32, s57, v32
buffer_store_dwordx2 v[32:33], v17, s[20:23], s39 offen sc1
v_pk_mul_f32 v[64:65], v[64:65], v[28:29]
v_pk_mul_f32 v[66:67], v[66:67], v[28:29]
v_cvt_pk_bf16_f32 v34, v64, v65
v_cvt_pk_bf16_f32 v35, v66, v67
v_min_u32 v34, s57, v34
buffer_store_dwordx2 v[34:35], v18, s[20:23], s39 offen sc1
buffer_store_dwordx2 v[24:25], v16, s[20:23], s40 offen sc1
buffer_store_dwordx2 v[24:25], v17, s[20:23], s40 offen sc1
buffer_store_dwordx2 v[24:25], v18, s[20:23], s40 offen sc1
s_mov_b64 exec, -1
L_p4_B:
s_mov_b32 s45, s17
L_po_sl_B:
s_cmp_eq_u32 s45, 0
s_cbranch_scc1 L_po_go_B
s_sleep 1
s_sub_u32 s45, s45, 1
s_branch L_po_sl_B
L_po_go_B:
s_mov_b32 s19, 0
buffer_load_dwordx4 v[208:211], v249, s[20:23], s39 offen offset:0 sc1
buffer_load_dwordx4 v[216:219], v249, s[20:23], s39 offen offset:1024 sc1
buffer_load_dwordx4 v[224:227], v249, s[20:23], s39 offen offset:2048 sc1
s_branch L_po_w_B
L_po_retry_B:
s_add_u32 s19, s19, 1
s_add_u32 s60, s60, 1
s_cmp_gt_u32 s60, 400000
s_cbranch_scc1 L_rec_fail_B
buffer_load_dwordx4 v[208:211], v249, s[20:23], s39 offen offset:0 sc1
buffer_load_dwordx4 v[216:219], v249, s[20:23], s39 offen offset:1024 sc1
buffer_load_dwordx4 v[224:227], v249, s[20:23], s39 offen offset:2048 sc1
L_po_w_B:
s_waitcnt vmcnt(0)
v_max3_u32 v28, v208, v210, v216
v_max3_u32 v28, v28, v218, v224
v_max_u32 v28, v28, v226
v_cmp_eq_u32 vcc, -1, v28
s_cbranch_vccnz L_po_retry_B
v_mfma_f32_16x16x32_bf16 v[68:71], a[180:183], v[208:211], 0
v_mov_b32_dpp v212, v208 row_ror:8 row_mask:0xf bank_mask:0xf
v_mov_b32_dpp v213, v209 row_ror:8 row_mask:0xf bank_mask:0xf
v_mfma_f32_16x16x32_bf16 v[72:75], a[204:207], v[208:211], 0
v_mov_b32_dpp v214, v210 row_ror:8 row_mask:0xf bank_mask:0xf
v_mov_b32_dpp v215, v211 row_ror:8 row_mask:0xf bank_mask:0xf
v_mfma_f32_16x16x32_bf16 v[76:79], a[228:231], v[208:211], 0
v_mov_b32_dpp v220, v216 row_ror:8 row_mask:0xf bank_mask:0xf
v_mov_b32_dpp v221, v217 row_ror:8 row_mask:0xf bank_mask:0xf
v_mfma_f32_16x16x32_bf16 v[68:71], a[188:191], v[216:219], v[68:71]
v_mov_b32_dpp v222, v218 row_ror:8 row_mask:0xf bank_mask:0xf
v_mov_b32_dpp v223, v219 row_ror:8 row_mask:0xf bank_mask:0xf
v_mfma_f32_16x16x32_bf16 v[72:75], a[212:215], v[216:219], v[72:75]
v_mov_b32_dpp v228, v224 row_ror:8 row_mask:0xf bank_mask:0xf
v_mov_b32_dpp v229, v225 row_ror:8 row_mask:0xf bank_mask:0xf
v_mfma_f32_16x16x32_bf16 v[76:79], a[236:239], v[216:219], v[76:79]
v_mov_b32_dpp v230, v226 row_ror:8 row_mask:0xf bank_mask:0xf
v_mov_b32_dpp v231, v227 row_ror:8 row_mask:0xf bank_mask:0xf
v_mfma_f32_16x16x32_bf16 v[68:71], a[196:199], v[224:227], v[68:71]
v_mfma_f32_16x16x32_bf16 v[72:75], a[220:223], v[224:227], v[72:75]
v_mfma_f32_16x16x32_bf16 v[76:79], a[244:247], v[224:227], v[76:79]
v_mfma_f32_16x16x32_bf16 v[68:71], a[184:187], v[212:215], v[68:71]
v_mfma_f32_16x16x32_bf16 v[72:75], a[208:211], v[212:215], v[72:75]
v_mfma_f32_16x16x32_bf16 v[76:79], a[232:235], v[212:215], v[76:79]
v_mfma_f32_16x16x32_bf16 v[68:71], a[192:195], v[220:223], v[68:71]
v_mfma_f32_16x16x32_bf16 v[72:75], a[216:219], v[220:223], v[72:75]
v_mfma_f32_16x16x32_bf16 v[76:79], a[240:243], v[220:223], v[76:79]
v_mfma_f32_16x16x32_bf16 v[68:71], a[200:203], v[228:231], v[68:71]
v_mfma_f32_16x16x32_bf16 v[72:75], a[224:227], v[228:231], v[72:75]
v_mfma_f32_16x16x32_bf16 v[76:79], a[248:251], v[228:231], v[76:79]
s_nop 7
L_p4_two_B:
s_mov_b64 exec, s[50:51]
ds_write_b128 v7, v[68:71] offset:18432
ds_write_b128 v7, v[72:75] offset:20480
ds_write_b128 v7, v[76:79] offset:22528
s_mov_b64 exec, -1
s_mov_b32 s11, s19
s_add_u32 s33, s33, 1
s_add_u32 s59, s59, 393216
s_waitcnt lgkmcnt(0)
s_barrier
s_cmp_lg_u32 s28, 3
s_cbranch_scc1 L_nopf_B
s_mov_b32 s19, s11
s_cmp_lt_u32 s19, 1
s_cbranch_scc0 L_ad_1a_B
s_lshr_b32 s45, s17, 3
s_add_u32 s45, s45, 1
s_max_u32 s17, s17, s45
s_sub_u32 s17, s17, s45
s_branch L_ad_1b_B
L_ad_1a_B:
s_cmp_gt_u32 s19, 3
s_cbranch_scc0 L_ad_1b_B
s_sub_u32 s45, s19, 3
s_add_u32 s45, s45, 1
s_lshr_b32 s45, s45, 1
s_min_u32 s45, s45, 3
s_add_u32 s17, s17, s45
s_min_u32 s17, s17, 56
L_ad_1b_B:
s_mov_b32 s19, s3
s_cmp_lt_u32 s19, 1
s_cbranch_scc0 L_ad_2a_B
s_lshr_b32 s45, s16, 3
s_add_u32 s45, s45, 1
s_max_u32 s16, s16, s45
s_sub_u32 s16, s16, s45
s_branch L_ad_2b_B
L_ad_2a_B:
s_cmp_gt_u32 s19, 3
s_cbranch_scc0 L_ad_2b_B
s_sub_u32 s45, s19, 3
s_add_u32 s45, s45, 1
s_lshr_b32 s45, s45, 1
s_min_u32 s45, s45, 3
s_add_u32 s16, s16, s45
s_min_u32 s16, s16, 56
L_ad_2b_B:
s_mov_b32 s19, s9
s_cmp_lt_u32 s19, 1
s_cbranch_scc0 L_ad_3a_B
s_lshr_b32 s45, s10, 3
s_add_u32 s45, s45, 1
s_max_u32 s10, s10, s45
s_sub_u32 s10, s10, s45
s_branch L_ad_3b_B
L_ad_3a_B:
s_cmp_gt_u32 s19, 0
s_cbranch_scc0 L_ad_3b_B
s_sub_u32 s45, s19, 0
s_add_u32 s45, s45, 1
s_lshr_b32 s45, s45, 1
s_min_u32 s45, s45, 3
s_add_u32 s10, s10, s45
s_min_u32 s10, s10, 56
L_ad_3b_B:
s_cmp_ge_u32 s33, 64
s_cbranch_scc1 L_nored_B
s_waitcnt vmcnt(0)
s_and_b32 s45, s33, 7
s_cmp_lg_u32 s45, 0
s_cbranch_scc1 L_kvw2_ok_B
s_lshr_b32 s45, s33, 3
s_lshl_b32 s46, s29, 3
s_add_u32 s45, s45, s46
s_lshl_b32 s45, s45, 6
s_add_u32 s45, s45, 178466816
v_and_b32 v34, 15, v1
v_lshlrev_b32 v34, 2, v34
s_nop 1
L_kvw2_B:
buffer_load_dword v35, v34, s[20:23], s45 offen sc1
s_waitcnt vmcnt(0)
v_cmp_eq_u32 vcc, 0, v35
s_add_u32 s60, s60, 1
s_cmp_gt_u32 s60, 400000
s_cbranch_scc1 L_rec_fail_B
s_cbranch_vccz L_kvw2_ok_B
s_sleep 4
s_branch L_kvw2_B
L_kvw2_ok_B:
s_add_u32 s45, s59, 0
s_add_u32 s46, s45, 4096
s_add_u32 s47, s45, 8192
buffer_load_dwordx4 v[92:95], v3, s[20:23], s45 offen offset:0 sc1
buffer_load_dwordx4 v[96:99], v3, s[20:23], s45 offen offset:1024 sc1
buffer_load_dwordx4 v[100:103], v3, s[20:23], s45 offen offset:2048 sc1
buffer_load_dwordx4 v[104:107], v3, s[20:23], s45 offen offset:3072 sc1
buffer_load_dwordx4 v[108:111], v3, s[20:23], s46 offen offset:0 sc1
buffer_load_dwordx4 v[112:115], v3, s[20:23], s46 offen offset:1024 sc1
buffer_load_dwordx4 v[116:119], v3, s[20:23], s46 offen offset:2048 sc1
buffer_load_dwordx4 v[120:123], v3, s[20:23], s46 offen offset:3072 sc1
buffer_load_dwordx4 v[124:127], v3, s[20:23], s47 offen offset:0 sc1
buffer_load_dwordx4 v[128:131], v3, s[20:23], s47 offen offset:1024 sc1
buffer_load_dwordx4 v[132:135], v3, s[20:23], s47 offen offset:2048 sc1
buffer_load_dwordx4 v[136:139], v3, s[20:23], s47 offen offset:3072 sc1
s_mul_i32 s48, s32, 3072
s_add_u32 s48, s48, s59
s_add_u32 s48, s48, 25165824
buffer_load_dwordx4 v[140:143], v3, s[20:23], s48 offen offset:0 sc1
buffer_load_dwordx4 v[144:147], v3, s[20:23], s48 offen offset:1024 sc1
buffer_load_dwordx4 v[148:151], v3, s[20:23], s48 offen offset:2048 sc1
s_branch L_nored_B
L_nopf_B:
s_cmp_lt_u32 s28, s54
s_cbranch_scc1 L_owner_B
s_mov_b32 s19, s11
s_cmp_lt_u32 s19, 1
s_cbranch_scc0 L_ad_4a_B
s_lshr_b32 s45, s17, 3
s_add_u32 s45, s45, 1
s_max_u32 s17, s17, s45
s_sub_u32 s17, s17, s45
s_branch L_ad_4b_B
L_ad_4a_B:
s_cmp_gt_u32 s19, 3
s_cbranch_scc0 L_ad_4b_B
s_sub_u32 s45, s19, 3
s_add_u32 s45, s45, 1
s_lshr_b32 s45, s45, 1
s_min_u32 s45, s45, 3
s_add_u32 s17, s17, s45
s_min_u32 s17, s17, 56
L_ad_4b_B:
s_mov_b32 s19, s3
s_cmp_lt_u32 s19, 1
s_cbranch_scc0 L_ad_5a_B
s_lshr_b32 s45, s16, 3
s_add_u32 s45, s45, 1
s_max_u32 s16, s16, s45
s_sub_u32 s16, s16, s45
s_branch L_ad_5b_B
L_ad_5a_B:
s_cmp_gt_u32 s19, 3
s_cbranch_scc0 L_ad_5b_B
s_sub_u32 s45, s19, 3
s_add_u32 s45, s45, 1
s_lshr_b32 s45, s45, 1
s_min_u32 s45, s45, 3
s_add_u32 s16, s16, s45
s_min_u32 s16, s16, 56
L_ad_5b_B:
s_branch L_nored_B
L_owner_B:
ds_read_b128 v[92:95], v11 offset:18432
ds_read_b128 v[96:99], v11 offset:18944
ds_read_b128 v[100:103], v11 offset:19456
ds_read_b128 v[104:107], v11 offset:19968
s_waitcnt lgkmcnt(0)
v_pk_add_f32 v[92:93], v[92:93], v[96:97]
v_pk_add_f32 v[100:101], v[100:101], v[104:105]
v_pk_add_f32 v[94:95], v[94:95], v[98:99]
v_pk_add_f32 v[102:103], v[102:103], v[106:107]
v_pk_add_f32 v[92:93], v[92:93], v[100:101]
v_pk_add_f32 v[94:95], v[94:95], v[102:103]
v_min_u32 v92, s57, v92
s_mov_b64 exec, s[52:53]
buffer_store_dwordx4 v[92:95], v19, s[20:23], s41 offen sc1
buffer_store_dwordx4 v[24:27], v19, s[20:23], s42 offen sc1
s_mov_b64 exec, -1
s_mov_b32 s19, s11
s_cmp_lt_u32 s19, 1
s_cbranch_scc0 L_ad_6a_B
s_lshr_b32 s45, s17, 3
s_add_u32 s45, s45, 1
s_max_u32 s17, s17, s45
s_sub_u32 s17, s17, s45
s_branch L_ad_6b_B
L_ad_6a_B:
s_cmp_gt_u32 s19, 3
s_cbranch_scc0 L_ad_6b_B
s_sub_u32 s45, s19, 3
s_add_u32 s45, s45, 1
s_lshr_b32 s45, s45, 1
s_min_u32 s45, s45, 3
s_add_u32 s17, s17, s45
s_min_u32 s17, s17, 56
L_ad_6b_B:
s_mov_b32 s19, s3
s_cmp_lt_u32 s19, 1
s_cbranch_scc0 L_ad_7a_B
s_lshr_b32 s45, s16, 3
s_add_u32 s45, s45, 1
s_max_u32 s16, s16, s45
s_sub_u32 s16, s16, s45
s_branch L_ad_7b_B
L_ad_7a_B:
s_cmp_gt_u32 s19, 3
s_cbranch_scc0 L_ad_7b_B
s_sub_u32 s45, s19, 3
s_add_u32 s45, s45, 1
s_lshr_b32 s45, s45, 1
s_min_u32 s45, s45, 3
s_add_u32 s16, s16, s45
s_min_u32 s16, s16, 56
L_ad_7b_B:
s_sleep 11
s_mov_b32 s19, 0
buffer_load_dwordx4 v[152:155], v20, s[20:23], s41 offen offset:0 sc1
buffer_load_dwordx4 v[156:159], v20, s[20:23], s41 offen offset:1024 sc1
buffer_load_dwordx4 v[160:163], v20, s[20:23], s41 offen offset:2048 sc1
buffer_load_dwordx4 v[164:167], v20, s[20:23], s41 offen offset:3072 sc1
s_branch L_pg_w_B
L_pg_retry_B:
s_add_u32 s19, s19, 1
s_add_u32 s60, s60, 1
s_cmp_gt_u32 s60, 400000
s_cbranch_scc1 L_rec_fail_B
buffer_load_dwordx4 v[152:155], v20, s[20:23], s41 offen offset:0 sc1
buffer_load_dwordx4 v[156:159], v20, s[20:23], s41 offen offset:1024 sc1
buffer_load_dwordx4 v[160:163], v20, s[20:23], s41 offen offset:2048 sc1
buffer_load_dwordx4 v[164:167], v20, s[20:23], s41 offen offset:3072 sc1
L_pg_w_B:
s_waitcnt vmcnt(0)
v_max3_u32 v28, v152, v156, v160
v_max_u32 v28, v28, v164
v_cmp_eq_u32 vcc, -1, v28
s_cbranch_vccnz L_pg_retry_B
s_nop 3
L_skipg_B:
v_pk_add_f32 v[184:185], v[152:153], v[156:157]
v_pk_add_f32 v[188:189], v[160:161], v[164:165]
v_pk_add_f32 v[186:187], v[154:155], v[158:159]
v_pk_add_f32 v[190:191], v[162:163], v[166:167]
v_pk_add_f32 v[184:185], v[184:185], v[188:189]
v_pk_add_f32 v[186:187], v[186:187], v[190:191]
v_mov_b64 v[188:189], v[184:185]
v_mov_b64 v[190:191], v[186:187]
s_nop 0
v_permlane32_swap_b32 v184, v188
v_permlane32_swap_b32 v185, v189
v_permlane32_swap_b32 v186, v190
v_permlane32_swap_b32 v187, v191
v_pk_add_f32 v[184:185], v[184:185], v[188:189]
v_pk_add_f32 v[186:187], v[186:187], v[190:191]
v_cvt_pk_bf16_f32 v28, v184, v185
v_cvt_pk_bf16_f32 v29, v186, v187
v_min_u32 v28, s57, v28
s_mov_b64 exec, s[52:53]
buffer_store_dwordx2 v[28:29], v21, s[20:23], s35 offen sc1
buffer_store_dwordx2 v[24:25], v21, s[20:23], s36 offen sc1
s_mov_b64 exec, -1
L_nored_B:
s_cmp_lt_u32 s33, 64
s_cbranch_scc1 L_step_B
s_branch L_rec_done_B
L_rec_fail_B:
s_mov_b64 exec, 1
v_mov_b32 v28, 0xdead
v_mov_b32 v29, 128
global_store_dword v29, v28, s[6:7]
s_waitcnt vmcnt(0)
L_rec_done_B:
s_endpgm
L_worker_B:
s_load_dwordx4 s[8:11], s[0:1], 16
s_load_dwordx4 s[12:15], s[0:1], 32
s_load_dwordx4 s[16:19], s[0:1], 64
s_load_dwordx4 s[68:71], s[0:1], 80
s_load_dwordx2 s[72:73], s[0:1], 0
s_load_dwordx2 s[74:75], s[0:1], 96
s_waitcnt lgkmcnt(0)
s_sub_u32 s63, s30, 16
s_mov_b32 s48, 0
s_mov_b32 s64, 0
v_mov_b32 v16, 1
s_mov_b32 s92, 0
s_lshl_b32 s47, s28, 11
s_mul_i32 s46, s28, 3072
s_add_u32 s46, s46, 16384
v_lshrrev_b32 v19, 2, v1
v_and_b32 v4, 3, v1
v_lshrrev_b32 v5, 4, v1
v_xor_b32 v4, v4, v5
v_lshlrev_b32 v20, 4, v4
s_mul_i32 s40, s28, 192
s_add_u32 s40, s40, 0
v_add_u32 v4, s40, v1
s_mov_b32 s41, 43691
v_mul_u32_u24 v5, s41, v4
v_lshrrev_b32 v25, 20, v5
v_mul_u32_u24 v5, 24, v25
v_sub_u32 v5, v4, v5
v_bfe_u32 v6, v25, 1, 1
v_lshlrev_b32 v6, 2, v6
v_xor_b32 v5, v5, v6
v_lshlrev_b32 v28, 4, v5
s_mul_i32 s40, s28, 192
s_add_u32 s40, s40, 64
v_add_u32 v4, s40, v1
s_mov_b32 s41, 43691
v_mul_u32_u24 v5, s41, v4
v_lshrrev_b32 v26, 20, v5
v_mul_u32_u24 v5, 24, v26
v_sub_u32 v5, v4, v5
v_bfe_u32 v6, v26, 1, 1
v_lshlrev_b32 v6, 2, v6
v_xor_b32 v5, v5, v6
v_lshlrev_b32 v29, 4, v5
s_mul_i32 s40, s28, 192
s_add_u32 s40, s40, 128
v_add_u32 v4, s40, v1
s_mov_b32 s41, 43691
v_mul_u32_u24 v5, s41, v4
v_lshrrev_b32 v27, 20, v5
v_mul_u32_u24 v5, 24, v27
v_sub_u32 v5, v4, v5
v_bfe_u32 v6, v27, 1, 1
v_lshlrev_b32 v6, 2, v6
v_xor_b32 v5, v5, v6
v_lshlrev_b32 v30, 4, v5
v_and_b32 v4, 31, v1
v_lshrrev_b32 v5, 5, v1
v_bfe_u32 v6, v4, 2, 2
s_lshr_b32 s40, s28, 1
s_mul_i32 s40, s40, 4096
v_add_u32 v7, 0, v5
v_xor_b32 v7, v7, v6
v_lshlrev_b32 v7, 4, v7
v_lshl_add_u32 v7, v4, 6, v7
v_add_u32 v34, s40, v7
v_add_u32 v7, 2, v5
v_xor_b32 v7, v7, v6
v_lshlrev_b32 v7, 4, v7
v_lshl_add_u32 v7, v4, 6, v7
v_add_u32 v35, s40, v7
v_and_b32 v4, 15, v1
v_lshrrev_b32 v5, 4, v1
v_and_b32 v6, 1, v5
v_lshrrev_b32 v5, 1, v5
v_bfe_u32 v7, v4, 1, 1
v_lshl_add_u32 v6, v6, 1, v7
s_and_b32 s40, s28, 1
s_mul_i32 s40, s40, 12
v_add_u32 v6, s40, v6
v_bfe_u32 v8, v4, 3, 1
v_lshlrev_b32 v8, 2, v8
v_and_b32 v9, 1, v4
v_lshlrev_b32 v9, 3, v9
v_lshrrev_b32 v10, 2, v4
v_lshlrev_b32 v11, 3, v5
v_add_u32 v11, 0, v11
v_add_u32 v11, v11, v10
v_mul_u32_u24 v11, 384, v11
v_add_u32 v11, v11, v9
v_add_u32 v12, 0, v6
v_xor_b32 v12, v12, v8
v_lshl_add_u32 v36, v12, 4, v11
v_add_u32 v36, 16384, v36
v_add_u32 v12, 4, v6
v_xor_b32 v12, v12, v8
v_lshl_add_u32 v40, v12, 4, v11
v_add_u32 v40, 16384, v40
v_lshlrev_b32 v11, 3, v5
v_add_u32 v11, 4, v11
v_add_u32 v11, v11, v10
v_mul_u32_u24 v11, 384, v11
v_add_u32 v11, v11, v9
v_add_u32 v12, 0, v6
v_xor_b32 v12, v12, v8
v_lshl_add_u32 v37, v12, 4, v11
v_add_u32 v37, 16384, v37
v_add_u32 v12, 4, v6
v_xor_b32 v12, v12, v8
v_lshl_add_u32 v41, v12, 4, v11
v_add_u32 v41, 16384, v41
v_lshlrev_b32 v11, 3, v5
v_add_u32 v11, 16, v11
v_add_u32 v11, v11, v10
v_mul_u32_u24 v11, 384, v11
v_add_u32 v11, v11, v9
v_add_u32 v12, 0, v6
v_xor_b32 v12, v12, v8
v_lshl_add_u32 v38, v12, 4, v11
v_add_u32 v38, 16384, v38
v_add_u32 v12, 4, v6
v_xor_b32 v12, v12, v8
v_lshl_add_u32 v42, v12, 4, v11
v_add_u32 v42, 16384, v42
v_lshlrev_b32 v11, 3, v5
v_add_u32 v11, 20, v11
v_add_u32 v11, v11, v10
v_mul_u32_u24 v11, 384, v11
v_add_u32 v11, v11, v9
v_add_u32 v12, 0, v6
v_xor_b32 v12, v12, v8
v_lshl_add_u32 v39, v12, 4, v11
v_add_u32 v39, 16384, v39
v_add_u32 v12, 4, v6
v_xor_b32 v12, v12, v8
v_lshl_add_u32 v43, v12, 4, v11
v_add_u32 v43, 16384, v43
v_add_u32 v84, 57344, v34
v_add_u32 v85, 57344, v35
v_add_u32 v86, 57344, v36
v_add_u32 v87, 57344, v37
v_add_u32 v88, 57344, v38
v_add_u32 v89, 57344, v39
v_add_u32 v90, 57344, v40
v_add_u32 v91, 57344, v41
v_add_u32 v92, 57344, v42
v_add_u32 v93, 57344, v43
v_bfe_u32 v4, v1, 4, 1
v_lshrrev_b32 v5, 5, v1
v_and_b32 v6, 15, v1
v_lshlrev_b32 v7, 8, v5
v_lshl_add_u32 v7, v6, 4, v7
v_mul_u32_u24 v8, 6144, v4
v_add_u32 v94, v8, v7
v_lshl_add_u32 v95, v4, 10, v7
s_lshr_b32 s62, s63, 3
s_and_b32 s60, s63, 7
s_lshr_b32 s58, s60, 2
s_and_b32 s60, s60, 3
s_lshl_b32 s59, s29, 2
s_add_u32 s59, s59, s60
s_mov_b32 s56, 12288
s_mov_b32 s34, 7864320
s_mov_b32 s35, 0x00020000
s_cmp_eq_u32 s58, 1
s_cselect_b32 s32, s12, s10
s_cselect_b32 s33, s13, s11
s_lshl_b32 s57, s56, 5
s_mul_i32 s54, s59, 384
s_lshl_b32 s53, s62, 13
s_add_u32 s53, s53, 90910720
s_mul_i32 s40, s28, 2048
s_add_u32 s40, s40, 0
v_lshlrev_b32 v4, 4, v1
v_add_u32 v21, s40, v4
s_mul_i32 s40, s28, 2048
s_add_u32 s40, s40, 1024
v_lshlrev_b32 v4, 4, v1
v_add_u32 v22, s40, v4
v_mul_lo_u32 v4, v25, s56
v_add_u32 v31, v4, v28
v_mul_lo_u32 v4, v26, s56
v_add_u32 v32, v4, v29
v_mul_lo_u32 v4, v27, s56
v_add_u32 v33, v4, v30
s_cmp_eq_u32 s58, 1
s_cbranch_scc1 L_h_v_B
s_add_u32 m0, s47, 0
s_nop 0
buffer_load_dwordx4 v21, s[20:23], s53 offen lds
s_add_u32 m0, s47, 1024
s_nop 0
buffer_load_dwordx4 v22, s[20:23], s53 offen lds
s_add_u32 m0, s46, 0
s_nop 0
buffer_load_dwordx4 v31, s[32:35], s54 offen lds
s_add_u32 m0, s46, 1024
s_nop 0
buffer_load_dwordx4 v32, s[32:35], s54 offen lds
s_add_u32 m0, s46, 2048
s_nop 0
buffer_load_dwordx4 v33, s[32:35], s54 offen lds
s_add_u32 s53, s53, 16384
s_add_u32 s54, s54, s57
s_add_u32 m0, s47, 28672
s_nop 0
buffer_load_dwordx4 v21, s[20:23], s53 offen lds
s_add_u32 m0, s47, 29696
s_nop 0
buffer_load_dwordx4 v22, s[20:23], s53 offen lds
s_add_u32 m0, s46, 28672
s_nop 0
buffer_load_dwordx4 v31, s[32:35], s54 offen lds
s_add_u32 m0, s46, 29696
s_nop 0
buffer_load_dwordx4 v32, s[32:35], s54 offen lds
s_add_u32 m0, s46, 30720
s_nop 0
buffer_load_dwordx4 v33, s[32:35], s54 offen lds
s_add_u32 s53, s53, 16384
s_add_u32 s54, s54, s57
s_add_u32 m0, s47, 57344
s_nop 0
buffer_load_dwordx4 v21, s[20:23], s53 offen lds
s_add_u32 m0, s47, 58368
s_nop 0
buffer_load_dwordx4 v22, s[20:23], s53 offen lds
s_add_u32 m0, s46, 57344
s_nop 0
buffer_load_dwordx4 v31, s[32:35], s54 offen lds
s_add_u32 m0, s46, 58368
s_nop 0
buffer_load_dwordx4 v32, s[32:35], s54 offen lds
s_add_u32 m0, s46, 59392
s_nop 0
buffer_load_dwordx4 v33, s[32:35], s54 offen lds
s_add_u32 s53, s53, 16384
s_add_u32 s54, s54, s57
s_add_u32 m0, s47, 86016
s_nop 0
buffer_load_dwordx4 v21, s[20:23], s53 offen lds
s_add_u32 m0, s47, 87040
s_nop 0
buffer_load_dwordx4 v22, s[20:23], s53 offen lds
s_add_u32 m0, s46, 86016
s_nop 0
buffer_load_dwordx4 v31, s[32:35], s54 offen lds
s_add_u32 m0, s46, 87040
s_nop 0
buffer_load_dwordx4 v32, s[32:35], s54 offen lds
s_add_u32 m0, s46, 88064
s_nop 0
buffer_load_dwordx4 v33, s[32:35], s54 offen lds
s_add_u32 s53, s53, 16384
s_add_u32 s54, s54, s57
s_waitcnt vmcnt(15)
s_barrier
ds_read_b128 v[44:47], v34 offset:0
ds_read_b128 v[48:51], v34 offset:2048
ds_read_b64_tr_b16 v[60:61], v36 offset:0
ds_read_b64_tr_b16 v[62:63], v37 offset:0
ds_read_b64_tr_b16 v[64:65], v40 offset:0
ds_read_b64_tr_b16 v[66:67], v41 offset:0
ds_read_b64_tr_b16 v[68:69], v36 offset:128
ds_read_b64_tr_b16 v[70:71], v37 offset:128
s_waitcnt lgkmcnt(0)
v_mfma_f32_32x32x16_bf16 a[0:15], v[60:63], v[44:47], 0
ds_read_b128 v[52:55], v35 offset:0
v_mfma_f32_32x32x16_bf16 a[16:31], v[64:67], v[44:47], 0
ds_read_b128 v[56:59], v35 offset:2048
v_mfma_f32_32x32x16_bf16 a[32:47], v[68:71], v[44:47], 0
ds_read_b64_tr_b16 v[72:73], v38 offset:0
ds_read_b64_tr_b16 v[74:75], v39 offset:0
v_mfma_f32_32x32x16_bf16 a[48:63], v[60:63], v[48:51], 0
ds_read_b64_tr_b16 v[76:77], v42 offset:0
ds_read_b64_tr_b16 v[78:79], v43 offset:0
v_mfma_f32_32x32x16_bf16 a[64:79], v[64:67], v[48:51], 0
ds_read_b64_tr_b16 v[80:81], v38 offset:128
ds_read_b64_tr_b16 v[82:83], v39 offset:128
v_mfma_f32_32x32x16_bf16 a[80:95], v[68:71], v[48:51], 0
s_waitcnt lgkmcnt(0)
s_waitcnt vmcnt(10)
s_barrier
v_mfma_f32_32x32x16_bf16 a[0:15], v[72:75], v[52:55], a[0:15]
ds_read_b128 v[44:47], v34 offset:28672
ds_read_b128 v[48:51], v34 offset:30720
v_mfma_f32_32x32x16_bf16 a[16:31], v[76:79], v[52:55], a[16:31]
ds_read_b64_tr_b16 v[60:61], v36 offset:28672
ds_read_b64_tr_b16 v[62:63], v37 offset:28672
ds_read_b64_tr_b16 v[64:65], v40 offset:28672
ds_read_b64_tr_b16 v[66:67], v41 offset:28672
v_mfma_f32_32x32x16_bf16 a[32:47], v[80:83], v[52:55], a[32:47]
ds_read_b64_tr_b16 v[68:69], v36 offset:28800
ds_read_b64_tr_b16 v[70:71], v37 offset:28800
s_add_u32 m0, s47, 0
s_nop 0
buffer_load_dwordx4 v21, s[20:23], s53 offen lds
v_mfma_f32_32x32x16_bf16 a[48:63], v[72:75], v[56:59], a[48:63]
s_add_u32 m0, s47, 1024
s_nop 0
buffer_load_dwordx4 v22, s[20:23], s53 offen lds
s_add_u32 m0, s46, 0
s_nop 0
buffer_load_dwordx4 v31, s[32:35], s54 offen lds
v_mfma_f32_32x32x16_bf16 a[64:79], v[76:79], v[56:59], a[64:79]
s_add_u32 m0, s46, 1024
s_nop 0
buffer_load_dwordx4 v32, s[32:35], s54 offen lds
s_add_u32 m0, s46, 2048
s_nop 0
buffer_load_dwordx4 v33, s[32:35], s54 offen lds
s_add_u32 s53, s53, 16384
s_add_u32 s54, s54, s57
v_mfma_f32_32x32x16_bf16 a[80:95], v[80:83], v[56:59], a[80:95]
s_waitcnt lgkmcnt(0)
v_mfma_f32_32x32x16_bf16 a[0:15], v[60:63], v[44:47], a[0:15]
ds_read_b128 v[52:55], v35 offset:28672
v_mfma_f32_32x32x16_bf16 a[16:31], v[64:67], v[44:47], a[16:31]
ds_read_b128 v[56:59], v35 offset:30720
v_mfma_f32_32x32x16_bf16 a[32:47], v[68:71], v[44:47], a[32:47]
ds_read_b64_tr_b16 v[72:73], v38 offset:28672
ds_read_b64_tr_b16 v[74:75], v39 offset:28672
v_mfma_f32_32x32x16_bf16 a[48:63], v[60:63], v[48:51], a[48:63]
ds_read_b64_tr_b16 v[76:77], v42 offset:28672
ds_read_b64_tr_b16 v[78:79], v43 offset:28672
v_mfma_f32_32x32x16_bf16 a[64:79], v[64:67], v[48:51], a[64:79]
ds_read_b64_tr_b16 v[80:81], v38 offset:28800
ds_read_b64_tr_b16 v[82:83], v39 offset:28800
v_mfma_f32_32x32x16_bf16 a[80:95], v[68:71], v[48:51], a[80:95]
s_waitcnt lgkmcnt(0)
s_waitcnt vmcnt(10)
s_barrier
v_mfma_f32_32x32x16_bf16 a[0:15], v[72:75], v[52:55], a[0:15]
ds_read_b128 v[44:47], v84 offset:0
ds_read_b128 v[48:51], v84 offset:2048
v_mfma_f32_32x32x16_bf16 a[16:31], v[76:79], v[52:55], a[16:31]
ds_read_b64_tr_b16 v[60:61], v86 offset:0
ds_read_b64_tr_b16 v[62:63], v87 offset:0
ds_read_b64_tr_b16 v[64:65], v90 offset:0
ds_read_b64_tr_b16 v[66:67], v91 offset:0
v_mfma_f32_32x32x16_bf16 a[32:47], v[80:83], v[52:55], a[32:47]
ds_read_b64_tr_b16 v[68:69], v86 offset:128
ds_read_b64_tr_b16 v[70:71], v87 offset:128
s_add_u32 m0, s47, 28672
s_nop 0
buffer_load_dwordx4 v21, s[20:23], s53 offen lds
v_mfma_f32_32x32x16_bf16 a[48:63], v[72:75], v[56:59], a[48:63]
s_add_u32 m0, s47, 29696
s_nop 0
buffer_load_dwordx4 v22, s[20:23], s53 offen lds
s_add_u32 m0, s46, 28672
s_nop 0
buffer_load_dwordx4 v31, s[32:35], s54 offen lds
v_mfma_f32_32x32x16_bf16 a[64:79], v[76:79], v[56:59], a[64:79]
s_add_u32 m0, s46, 29696
s_nop 0
buffer_load_dwordx4 v32, s[32:35], s54 offen lds
s_add_u32 m0, s46, 30720
s_nop 0
buffer_load_dwordx4 v33, s[32:35], s54 offen lds
s_add_u32 s53, s53, 16384
s_add_u32 s54, s54, s57
v_mfma_f32_32x32x16_bf16 a[80:95], v[80:83], v[56:59], a[80:95]
s_waitcnt lgkmcnt(0)
v_mfma_f32_32x32x16_bf16 a[0:15], v[60:63], v[44:47], a[0:15]
ds_read_b128 v[52:55], v85 offset:0
v_mfma_f32_32x32x16_bf16 a[16:31], v[64:67], v[44:47], a[16:31]
ds_read_b128 v[56:59], v85 offset:2048
v_mfma_f32_32x32x16_bf16 a[32:47], v[68:71], v[44:47], a[32:47]
ds_read_b64_tr_b16 v[72:73], v88 offset:0
ds_read_b64_tr_b16 v[74:75], v89 offset:0
v_mfma_f32_32x32x16_bf16 a[48:63], v[60:63], v[48:51], a[48:63]
ds_read_b64_tr_b16 v[76:77], v92 offset:0
ds_read_b64_tr_b16 v[78:79], v93 offset:0
v_mfma_f32_32x32x16_bf16 a[64:79], v[64:67], v[48:51], a[64:79]
ds_read_b64_tr_b16 v[80:81], v88 offset:128
ds_read_b64_tr_b16 v[82:83], v89 offset:128
v_mfma_f32_32x32x16_bf16 a[80:95], v[68:71], v[48:51], a[80:95]
s_waitcnt lgkmcnt(0)
s_waitcnt vmcnt(10)
s_barrier
v_mfma_f32_32x32x16_bf16 a[0:15], v[72:75], v[52:55], a[0:15]
ds_read_b128 v[44:47], v84 offset:28672
ds_read_b128 v[48:51], v84 offset:30720
v_mfma_f32_32x32x16_bf16 a[16:31], v[76:79], v[52:55], a[16:31]
ds_read_b64_tr_b16 v[60:61], v86 offset:28672
ds_read_b64_tr_b16 v[62:63], v87 offset:28672
ds_read_b64_tr_b16 v[64:65], v90 offset:28672
ds_read_b64_tr_b16 v[66:67], v91 offset:28672
v_mfma_f32_32x32x16_bf16 a[32:47], v[80:83], v[52:55], a[32:47]
ds_read_b64_tr_b16 v[68:69], v86 offset:28800
ds_read_b64_tr_b16 v[70:71], v87 offset:28800
s_add_u32 m0, s47, 57344
s_nop 0
buffer_load_dwordx4 v21, s[20:23], s53 offen lds
v_mfma_f32_32x32x16_bf16 a[48:63], v[72:75], v[56:59], a[48:63]
s_add_u32 m0, s47, 58368
s_nop 0
buffer_load_dwordx4 v22, s[20:23], s53 offen lds
s_add_u32 m0, s46, 57344
s_nop 0
buffer_load_dwordx4 v31, s[32:35], s54 offen lds
v_mfma_f32_32x32x16_bf16 a[64:79], v[76:79], v[56:59], a[64:79]
s_add_u32 m0, s46, 58368
s_nop 0
buffer_load_dwordx4 v32, s[32:35], s54 offen lds
s_add_u32 m0, s46, 59392
s_nop 0
buffer_load_dwordx4 v33, s[32:35], s54 offen lds
s_add_u32 s53, s53, 16384
s_add_u32 s54, s54, s57
v_mfma_f32_32x32x16_bf16 a[80:95], v[80:83], v[56:59], a[80:95]
s_waitcnt lgkmcnt(0)
v_mfma_f32_32x32x16_bf16 a[0:15], v[60:63], v[44:47], a[0:15]
ds_read_b128 v[52:55], v85 offset:28672
v_mfma_f32_32x32x16_bf16 a[16:31], v[64:67], v[44:47], a[16:31]
ds_read_b128 v[56:59], v85 offset:30720
v_mfma_f32_32x32x16_bf16 a[32:47], v[68:71], v[44:47], a[32:47]
ds_read_b64_tr_b16 v[72:73], v88 offset:28672
ds_read_b64_tr_b16 v[74:75], v89 offset:28672
v_mfma_f32_32x32x16_bf16 a[48:63], v[60:63], v[48:51], a[48:63]
ds_read_b64_tr_b16 v[76:77], v92 offset:28672
ds_read_b64_tr_b16 v[78:79], v93 offset:28672
v_mfma_f32_32x32x16_bf16 a[64:79], v[64:67], v[48:51], a[64:79]
ds_read_b64_tr_b16 v[80:81], v88 offset:28800
ds_read_b64_tr_b16 v[82:83], v89 offset:28800
v_mfma_f32_32x32x16_bf16 a[80:95], v[68:71], v[48:51], a[80:95]
s_waitcnt lgkmcnt(0)
s_waitcnt vmcnt(10)
s_barrier
v_mfma_f32_32x32x16_bf16 a[0:15], v[72:75], v[52:55], a[0:15]
ds_read_b128 v[44:47], v34 offset:0
ds_read_b128 v[48:51], v34 offset:2048
v_mfma_f32_32x32x16_bf16 a[16:31], v[76:79], v[52:55], a[16:31]
ds_read_b64_tr_b16 v[60:61], v36 offset:0
ds_read_b64_tr_b16 v[62:63], v37 offset:0
ds_read_b64_tr_b16 v[64:65], v40 offset:0
ds_read_b64_tr_b16 v[66:67], v41 offset:0
v_mfma_f32_32x32x16_bf16 a[32:47], v[80:83], v[52:55], a[32:47]
ds_read_b64_tr_b16 v[68:69], v36 offset:128
ds_read_b64_tr_b16 v[70:71], v37 offset:128
s_add_u32 m0, s47, 86016
s_nop 0
buffer_load_dwordx4 v21, s[20:23], s53 offen lds
v_mfma_f32_32x32x16_bf16 a[48:63], v[72:75], v[56:59], a[48:63]
s_add_u32 m0, s47, 87040
s_nop 0
buffer_load_dwordx4 v22, s[20:23], s53 offen lds
s_add_u32 m0, s46, 86016
s_nop 0
buffer_load_dwordx4 v31, s[32:35], s54 offen lds
v_mfma_f32_32x32x16_bf16 a[64:79], v[76:79], v[56:59], a[64:79]
s_add_u32 m0, s46, 87040
s_nop 0
buffer_load_dwordx4 v32, s[32:35], s54 offen lds
s_add_u32 m0, s46, 88064
s_nop 0
buffer_load_dwordx4 v33, s[32:35], s54 offen lds
s_add_u32 s53, s53, 16384
s_add_u32 s54, s54, s57
v_mfma_f32_32x32x16_bf16 a[80:95], v[80:83], v[56:59], a[80:95]
s_mov_b32 s42, 3
s_cmp_eq_u32 s42, 0
s_cbranch_scc1 L_h_wx_last_B
s_nop 8
L_h_wx_B:
s_waitcnt lgkmcnt(0)
v_mfma_f32_32x32x16_bf16 a[0:15], v[60:63], v[44:47], a[0:15]
ds_read_b128 v[52:55], v35 offset:0
v_mfma_f32_32x32x16_bf16 a[16:31], v[64:67], v[44:47], a[16:31]
ds_read_b128 v[56:59], v35 offset:2048
v_mfma_f32_32x32x16_bf16 a[32:47], v[68:71], v[44:47], a[32:47]
ds_read_b64_tr_b16 v[72:73], v38 offset:0
ds_read_b64_tr_b16 v[74:75], v39 offset:0
v_mfma_f32_32x32x16_bf16 a[48:63], v[60:63], v[48:51], a[48:63]
ds_read_b64_tr_b16 v[76:77], v42 offset:0
ds_read_b64_tr_b16 v[78:79], v43 offset:0
v_mfma_f32_32x32x16_bf16 a[64:79], v[64:67], v[48:51], a[64:79]
ds_read_b64_tr_b16 v[80:81], v38 offset:128
ds_read_b64_tr_b16 v[82:83], v39 offset:128
v_mfma_f32_32x32x16_bf16 a[80:95], v[68:71], v[48:51], a[80:95]
s_waitcnt lgkmcnt(0)
s_waitcnt vmcnt(10)
s_barrier
v_mfma_f32_32x32x16_bf16 a[0:15], v[72:75], v[52:55], a[0:15]
ds_read_b128 v[44:47], v34 offset:28672
ds_read_b128 v[48:51], v34 offset:30720
v_mfma_f32_32x32x16_bf16 a[16:31], v[76:79], v[52:55], a[16:31]
ds_read_b64_tr_b16 v[60:61], v36 offset:28672
ds_read_b64_tr_b16 v[62:63], v37 offset:28672
ds_read_b64_tr_b16 v[64:65], v40 offset:28672
ds_read_b64_tr_b16 v[66:67], v41 offset:28672
v_mfma_f32_32x32x16_bf16 a[32:47], v[80:83], v[52:55], a[32:47]
ds_read_b64_tr_b16 v[68:69], v36 offset:28800
ds_read_b64_tr_b16 v[70:71], v37 offset:28800
s_add_u32 m0, s47, 0
s_nop 0
buffer_load_dwordx4 v21, s[20:23], s53 offen lds
v_mfma_f32_32x32x16_bf16 a[48:63], v[72:75], v[56:59], a[48:63]
s_add_u32 m0, s47, 1024
s_nop 0
buffer_load_dwordx4 v22, s[20:23], s53 offen lds
s_add_u32 m0, s46, 0
s_nop 0
buffer_load_dwordx4 v31, s[32:35], s54 offen lds
v_mfma_f32_32x32x16_bf16 a[64:79], v[76:79], v[56:59], a[64:79]
s_add_u32 m0, s46, 1024
s_nop 0
buffer_load_dwordx4 v32, s[32:35], s54 offen lds
s_add_u32 m0, s46, 2048
s_nop 0
buffer_load_dwordx4 v33, s[32:35], s54 offen lds
s_add_u32 s53, s53, 16384
s_add_u32 s54, s54, s57
v_mfma_f32_32x32x16_bf16 a[80:95], v[80:83], v[56:59], a[80:95]
s_waitcnt lgkmcnt(0)
v_mfma_f32_32x32x16_bf16 a[0:15], v[60:63], v[44:47], a[0:15]
ds_read_b128 v[52:55], v35 offset:28672
v_mfma_f32_32x32x16_bf16 a[16:31], v[64:67], v[44:47], a[16:31]
ds_read_b128 v[56:59], v35 offset:30720
v_mfma_f32_32x32x16_bf16 a[32:47], v[68:71], v[44:47], a[32:47]
ds_read_b64_tr_b16 v[72:73], v38 offset:28672
ds_read_b64_tr_b16 v[74:75], v39 offset:28672
v_mfma_f32_32x32x16_bf16 a[48:63], v[60:63], v[48:51], a[48:63]
ds_read_b64_tr_b16 v[76:77], v42 offset:28672
ds_read_b64_tr_b16 v[78:79], v43 offset:28672
v_mfma_f32_32x32x16_bf16 a[64:79], v[64:67], v[48:51], a[64:79]
ds_read_b64_tr_b16 v[80:81], v38 offset:28800
ds_read_b64_tr_b16 v[82:83], v39 offset:28800
v_mfma_f32_32x32x16_bf16 a[80:95], v[68:71], v[48:51], a[80:95]
s_waitcnt lgkmcnt(0)
s_waitcnt vmcnt(10)
s_barrier
v_mfma_f32_32x32x16_bf16 a[0:15], v[72:75], v[52:55], a[0:15]
ds_read_b128 v[44:47], v84 offset:0
ds_read_b128 v[48:51], v84 offset:2048
v_mfma_f32_32x32x16_bf16 a[16:31], v[76:79], v[52:55], a[16:31]
ds_read_b64_tr_b16 v[60:61], v86 offset:0
ds_read_b64_tr_b16 v[62:63], v87 offset:0
ds_read_b64_tr_b16 v[64:65], v90 offset:0
ds_read_b64_tr_b16 v[66:67], v91 offset:0
v_mfma_f32_32x32x16_bf16 a[32:47], v[80:83], v[52:55], a[32:47]
ds_read_b64_tr_b16 v[68:69], v86 offset:128
ds_read_b64_tr_b16 v[70:71], v87 offset:128
s_add_u32 m0, s47, 28672
s_nop 0
buffer_load_dwordx4 v21, s[20:23], s53 offen lds
v_mfma_f32_32x32x16_bf16 a[48:63], v[72:75], v[56:59], a[48:63]
s_add_u32 m0, s47, 29696
s_nop 0
buffer_load_dwordx4 v22, s[20:23], s53 offen lds
s_add_u32 m0, s46, 28672
s_nop 0
buffer_load_dwordx4 v31, s[32:35], s54 offen lds
v_mfma_f32_32x32x16_bf16 a[64:79], v[76:79], v[56:59], a[64:79]
s_add_u32 m0, s46, 29696
s_nop 0
buffer_load_dwordx4 v32, s[32:35], s54 offen lds
s_add_u32 m0, s46, 30720
s_nop 0
buffer_load_dwordx4 v33, s[32:35], s54 offen lds
s_add_u32 s53, s53, 16384
s_add_u32 s54, s54, s57
v_mfma_f32_32x32x16_bf16 a[80:95], v[80:83], v[56:59], a[80:95]
s_waitcnt lgkmcnt(0)
v_mfma_f32_32x32x16_bf16 a[0:15], v[60:63], v[44:47], a[0:15]
ds_read_b128 v[52:55], v85 offset:0
v_mfma_f32_32x32x16_bf16 a[16:31], v[64:67], v[44:47], a[16:31]
ds_read_b128 v[56:59], v85 offset:2048
v_mfma_f32_32x32x16_bf16 a[32:47], v[68:71], v[44:47], a[32:47]
ds_read_b64_tr_b16 v[72:73], v88 offset:0
ds_read_b64_tr_b16 v[74:75], v89 offset:0
v_mfma_f32_32x32x16_bf16 a[48:63], v[60:63], v[48:51], a[48:63]
ds_read_b64_tr_b16 v[76:77], v92 offset:0
ds_read_b64_tr_b16 v[78:79], v93 offset:0
v_mfma_f32_32x32x16_bf16 a[64:79], v[64:67], v[48:51], a[64:79]
ds_read_b64_tr_b16 v[80:81], v88 offset:128
ds_read_b64_tr_b16 v[82:83], v89 offset:128
v_mfma_f32_32x32x16_bf16 a[80:95], v[68:71], v[48:51], a[80:95]
s_waitcnt lgkmcnt(0)
s_waitcnt vmcnt(10)
s_barrier
v_mfma_f32_32x32x16_bf16 a[0:15], v[72:75], v[52:55], a[0:15]
ds_read_b128 v[44:47], v84 offset:28672
ds_read_b128 v[48:51], v84 offset:30720
v_mfma_f32_32x32x16_bf16 a[16:31], v[76:79], v[52:55], a[16:31]
ds_read_b64_tr_b16 v[60:61], v86 offset:28672
ds_read_b64_tr_b16 v[62:63], v87 offset:28672
ds_read_b64_tr_b16 v[64:65], v90 offset:28672
ds_read_b64_tr_b16 v[66:67], v91 offset:28672
v_mfma_f32_32x32x16_bf16 a[32:47], v[80:83], v[52:55], a[32:47]
ds_read_b64_tr_b16 v[68:69], v86 offset:28800
ds_read_b64_tr_b16 v[70:71], v87 offset:28800
s_add_u32 m0, s47, 57344
s_nop 0
buffer_load_dwordx4 v21, s[20:23], s53 offen lds
v_mfma_f32_32x32x16_bf16 a[48:63], v[72:75], v[56:59], a[48:63]
s_add_u32 m0, s47, 58368
s_nop 0
buffer_load_dwordx4 v22, s[20:23], s53 offen lds
s_add_u32 m0, s46, 57344
s_nop 0
buffer_load_dwordx4 v31, s[32:35], s54 offen lds
v_mfma_f32_32x32x16_bf16 a[64:79], v[76:79], v[56:59], a[64:79]
s_add_u32 m0, s46, 58368
s_nop 0
buffer_load_dwordx4 v32, s[32:35], s54 offen lds
s_add_u32 m0, s46, 59392
s_nop 0
buffer_load_dwordx4 v33, s[32:35], s54 offen lds
s_add_u32 s53, s53, 16384
s_add_u32 s54, s54, s57
v_mfma_f32_32x32x16_bf16 a[80:95], v[80:83], v[56:59], a[80:95]
s_waitcnt lgkmcnt(0)
v_mfma_f32_32x32x16_bf16 a[0:15], v[60:63], v[44:47], a[0:15]
ds_read_b128 v[52:55], v85 offset:28672
v_mfma_f32_32x32x16_bf16 a[16:31], v[64:67], v[44:47], a[16:31]
ds_read_b128 v[56:59], v85 offset:30720
v_mfma_f32_32x32x16_bf16 a[32:47], v[68:71], v[44:47], a[32:47]
ds_read_b64_tr_b16 v[72:73], v88 offset:28672
ds_read_b64_tr_b16 v[74:75], v89 offset:28672
v_mfma_f32_32x32x16_bf16 a[48:63], v[60:63], v[48:51], a[48:63]
ds_read_b64_tr_b16 v[76:77], v92 offset:28672
ds_read_b64_tr_b16 v[78:79], v93 offset:28672
v_mfma_f32_32x32x16_bf16 a[64:79], v[64:67], v[48:51], a[64:79]
ds_read_b64_tr_b16 v[80:81], v88 offset:28800
ds_read_b64_tr_b16 v[82:83], v89 offset:28800
v_mfma_f32_32x32x16_bf16 a[80:95], v[68:71], v[48:51], a[80:95]
s_waitcnt lgkmcnt(0)
s_waitcnt vmcnt(10)
s_barrier
v_mfma_f32_32x32x16_bf16 a[0:15], v[72:75], v[52:55], a[0:15]
ds_read_b128 v[44:47], v34 offset:0
ds_read_b128 v[48:51], v34 offset:2048
v_mfma_f32_32x32x16_bf16 a[16:31], v[76:79], v[52:55], a[16:31]
ds_read_b64_tr_b16 v[60:61], v36 offset:0
ds_read_b64_tr_b16 v[62:63], v37 offset:0
ds_read_b64_tr_b16 v[64:65], v40 offset:0
ds_read_b64_tr_b16 v[66:67], v41 offset:0
v_mfma_f32_32x32x16_bf16 a[32:47], v[80:83], v[52:55], a[32:47]
ds_read_b64_tr_b16 v[68:69], v36 offset:128
ds_read_b64_tr_b16 v[70:71], v37 offset:128
s_add_u32 m0, s47, 86016
s_nop 0
buffer_load_dwordx4 v21, s[20:23], s53 offen lds
v_mfma_f32_32x32x16_bf16 a[48:63], v[72:75], v[56:59], a[48:63]
s_add_u32 m0, s47, 87040
s_nop 0
buffer_load_dwordx4 v22, s[20:23], s53 offen lds
s_add_u32 m0, s46, 86016
s_nop 0
buffer_load_dwordx4 v31, s[32:35], s54 offen lds
v_mfma_f32_32x32x16_bf16 a[64:79], v[76:79], v[56:59], a[64:79]
s_add_u32 m0, s46, 87040
s_nop 0
buffer_load_dwordx4 v32, s[32:35], s54 offen lds
s_add_u32 m0, s46, 88064
s_nop 0
buffer_load_dwordx4 v33, s[32:35], s54 offen lds
s_add_u32 s53, s53, 16384
s_add_u32 s54, s54, s57
v_mfma_f32_32x32x16_bf16 a[80:95], v[80:83], v[56:59], a[80:95]
s_sub_u32 s42, s42, 1
s_cmp_lg_u32 s42, 0
s_nop 9
s_cbranch_scc1 L_h_wx_B
L_h_wx_last_B:
s_waitcnt lgkmcnt(0)
v_mfma_f32_32x32x16_bf16 a[0:15], v[60:63], v[44:47], a[0:15]
ds_read_b128 v[52:55], v35 offset:0
v_mfma_f32_32x32x16_bf16 a[16:31], v[64:67], v[44:47], a[16:31]
ds_read_b128 v[56:59], v35 offset:2048
v_mfma_f32_32x32x16_bf16 a[32:47], v[68:71], v[44:47], a[32:47]
ds_read_b64_tr_b16 v[72:73], v38 offset:0
ds_read_b64_tr_b16 v[74:75], v39 offset:0
v_mfma_f32_32x32x16_bf16 a[48:63], v[60:63], v[48:51], a[48:63]
ds_read_b64_tr_b16 v[76:77], v42 offset:0
ds_read_b64_tr_b16 v[78:79], v43 offset:0
v_mfma_f32_32x32x16_bf16 a[64:79], v[64:67], v[48:51], a[64:79]
ds_read_b64_tr_b16 v[80:81], v38 offset:128
ds_read_b64_tr_b16 v[82:83], v39 offset:128
v_mfma_f32_32x32x16_bf16 a[80:95], v[68:71], v[48:51], a[80:95]
s_waitcnt lgkmcnt(0)
s_waitcnt vmcnt(10)
s_barrier
v_mfma_f32_32x32x16_bf16 a[0:15], v[72:75], v[52:55], a[0:15]
ds_read_b128 v[44:47], v34 offset:28672
v_mfma_f32_32x32x16_bf16 a[16:31], v[76:79], v[52:55], a[16:31]
ds_read_b128 v[48:51], v34 offset:30720
v_mfma_f32_32x32x16_bf16 a[32:47], v[80:83], v[52:55], a[32:47]
ds_read_b64_tr_b16 v[60:61], v36 offset:28672
ds_read_b64_tr_b16 v[62:63], v37 offset:28672
v_mfma_f32_32x32x16_bf16 a[48:63], v[72:75], v[56:59], a[48:63]
ds_read_b64_tr_b16 v[64:65], v40 offset:28672
ds_read_b64_tr_b16 v[66:67], v41 offset:28672
v_mfma_f32_32x32x16_bf16 a[64:79], v[76:79], v[56:59], a[64:79]
ds_read_b64_tr_b16 v[68:69], v36 offset:28800
ds_read_b64_tr_b16 v[70:71], v37 offset:28800
v_mfma_f32_32x32x16_bf16 a[80:95], v[80:83], v[56:59], a[80:95]
s_waitcnt lgkmcnt(0)
v_mfma_f32_32x32x16_bf16 a[0:15], v[60:63], v[44:47], a[0:15]
ds_read_b128 v[52:55], v35 offset:28672
v_mfma_f32_32x32x16_bf16 a[16:31], v[64:67], v[44:47], a[16:31]
ds_read_b128 v[56:59], v35 offset:30720
v_mfma_f32_32x32x16_bf16 a[32:47], v[68:71], v[44:47], a[32:47]
ds_read_b64_tr_b16 v[72:73], v38 offset:28672
ds_read_b64_tr_b16 v[74:75], v39 offset:28672
v_mfma_f32_32x32x16_bf16 a[48:63], v[60:63], v[48:51], a[48:63]
ds_read_b64_tr_b16 v[76:77], v42 offset:28672
ds_read_b64_tr_b16 v[78:79], v43 offset:28672
v_mfma_f32_32x32x16_bf16 a[64:79], v[64:67], v[48:51], a[64:79]
ds_read_b64_tr_b16 v[80:81], v38 offset:28800
ds_read_b64_tr_b16 v[82:83], v39 offset:28800
v_mfma_f32_32x32x16_bf16 a[80:95], v[68:71], v[48:51], a[80:95]
s_waitcnt lgkmcnt(0)
s_waitcnt vmcnt(5)
s_barrier
v_mfma_f32_32x32x16_bf16 a[0:15], v[72:75], v[52:55], a[0:15]
ds_read_b128 v[44:47], v84 offset:0
v_mfma_f32_32x32x16_bf16 a[16:31], v[76:79], v[52:55], a[16:31]
ds_read_b128 v[48:51], v84 offset:2048
v_mfma_f32_32x32x16_bf16 a[32:47], v[80:83], v[52:55], a[32:47]
ds_read_b64_tr_b16 v[60:61], v86 offset:0
ds_read_b64_tr_b16 v[62:63], v87 offset:0
v_mfma_f32_32x32x16_bf16 a[48:63], v[72:75], v[56:59], a[48:63]
ds_read_b64_tr_b16 v[64:65], v90 offset:0
ds_read_b64_tr_b16 v[66:67], v91 offset:0
v_mfma_f32_32x32x16_bf16 a[64:79], v[76:79], v[56:59], a[64:79]
ds_read_b64_tr_b16 v[68:69], v86 offset:128
ds_read_b64_tr_b16 v[70:71], v87 offset:128
v_mfma_f32_32x32x16_bf16 a[80:95], v[80:83], v[56:59], a[80:95]
s_waitcnt lgkmcnt(0)
v_mfma_f32_32x32x16_bf16 a[0:15], v[60:63], v[44:47], a[0:15]
ds_read_b128 v[52:55], v85 offset:0
v_mfma_f32_32x32x16_bf16 a[16:31], v[64:67], v[44:47], a[16:31]
ds_read_b128 v[56:59], v85 offset:2048
v_mfma_f32_32x32x16_bf16 a[32:47], v[68:71], v[44:47], a[32:47]
ds_read_b64_tr_b16 v[72:73], v88 offset:0
ds_read_b64_tr_b16 v[74:75], v89 offset:0
v_mfma_f32_32x32x16_bf16 a[48:63], v[60:63], v[48:51], a[48:63]
ds_read_b64_tr_b16 v[76:77], v92 offset:0
ds_read_b64_tr_b16 v[78:79], v93 offset:0
v_mfma_f32_32x32x16_bf16 a[64:79], v[64:67], v[48:51], a[64:79]
ds_read_b64_tr_b16 v[80:81], v88 offset:128
ds_read_b64_tr_b16 v[82:83], v89 offset:128
v_mfma_f32_32x32x16_bf16 a[80:95], v[68:71], v[48:51], a[80:95]
s_waitcnt lgkmcnt(0)
s_waitcnt vmcnt(0)
s_barrier
v_mfma_f32_32x32x16_bf16 a[0:15], v[72:75], v[52:55], a[0:15]
ds_read_b128 v[44:47], v84 offset:28672
v_mfma_f32_32x32x16_bf16 a[16:31], v[76:79], v[52:55], a[16:31]
ds_read_b128 v[48:51], v84 offset:30720
v_mfma_f32_32x32x16_bf16 a[32:47], v[80:83], v[52:55], a[32:47]
ds_read_b64_tr_b16 v[60:61], v86 offset:28672
ds_read_b64_tr_b16 v[62:63], v87 offset:28672
v_mfma_f32_32x32x16_bf16 a[48:63], v[72:75], v[56:59], a[48:63]
ds_read_b64_tr_b16 v[64:65], v90 offset:28672
ds_read_b64_tr_b16 v[66:67], v91 offset:28672
v_mfma_f32_32x32x16_bf16 a[64:79], v[76:79], v[56:59], a[64:79]
ds_read_b64_tr_b16 v[68:69], v86 offset:28800
ds_read_b64_tr_b16 v[70:71], v87 offset:28800
v_mfma_f32_32x32x16_bf16 a[80:95], v[80:83], v[56:59], a[80:95]
s_waitcnt lgkmcnt(0)
v_mfma_f32_32x32x16_bf16 a[0:15], v[60:63], v[44:47], a[0:15]
ds_read_b128 v[52:55], v85 offset:28672
v_mfma_f32_32x32x16_bf16 a[16:31], v[64:67], v[44:47], a[16:31]
ds_read_b128 v[56:59], v85 offset:30720
v_mfma_f32_32x32x16_bf16 a[32:47], v[68:71], v[44:47], a[32:47]
ds_read_b64_tr_b16 v[72:73], v88 offset:28672
ds_read_b64_tr_b16 v[74:75], v89 offset:28672
v_mfma_f32_32x32x16_bf16 a[48:63], v[60:63], v[48:51], a[48:63]
ds_read_b64_tr_b16 v[76:77], v92 offset:28672
ds_read_b64_tr_b16 v[78:79], v93 offset:28672
v_mfma_f32_32x32x16_bf16 a[64:79], v[64:67], v[48:51], a[64:79]
ds_read_b64_tr_b16 v[80:81], v88 offset:28800
ds_read_b64_tr_b16 v[82:83], v89 offset:28800
v_mfma_f32_32x32x16_bf16 a[80:95], v[68:71], v[48:51], a[80:95]
s_waitcnt lgkmcnt(0)
s_waitcnt vmcnt(0)
s_barrier
v_mfma_f32_32x32x16_bf16 a[0:15], v[72:75], v[52:55], a[0:15]
v_mfma_f32_32x32x16_bf16 a[16:31], v[76:79], v[52:55], a[16:31]
v_mfma_f32_32x32x16_bf16 a[32:47], v[80:83], v[52:55], a[32:47]
v_mfma_f32_32x32x16_bf16 a[48:63], v[72:75], v[56:59], a[48:63]
v_mfma_f32_32x32x16_bf16 a[64:79], v[76:79], v[56:59], a[64:79]
v_mfma_f32_32x32x16_bf16 a[80:95], v[80:83], v[56:59], a[80:95]
s_nop 11
s_branch L_h_epi_B
L_h_v_B:
s_add_u32 m0, s47, 0
s_nop 0
buffer_load_dwordx4 v21, s[20:23], s53 offen lds
s_add_u32 m0, s47, 1024
s_nop 0
buffer_load_dwordx4 v22, s[20:23], s53 offen lds
s_add_u32 m0, s46, 0
s_nop 0
buffer_load_dwordx4 v31, s[32:35], s54 offen lds
s_add_u32 m0, s46, 1024
s_nop 0
buffer_load_dwordx4 v32, s[32:35], s54 offen lds
s_add_u32 m0, s46, 2048
s_nop 0
buffer_load_dwordx4 v33, s[32:35], s54 offen lds
s_add_u32 s53, s53, 16384
s_add_u32 s54, s54, s57
s_add_u32 m0, s47, 28672
s_nop 0
buffer_load_dwordx4 v21, s[20:23], s53 offen lds
s_add_u32 m0, s47, 29696
s_nop 0
buffer_load_dwordx4 v22, s[20:23], s53 offen lds
s_add_u32 m0, s46, 28672
s_nop 0
buffer_load_dwordx4 v31, s[32:35], s54 offen lds
s_add_u32 m0, s46, 29696
s_nop 0
buffer_load_dwordx4 v32, s[32:35], s54 offen lds
s_add_u32 m0, s46, 30720
s_nop 0
buffer_load_dwordx4 v33, s[32:35], s54 offen lds
s_add_u32 s53, s53, 16384
s_add_u32 s54, s54, s57
s_add_u32 m0, s47, 57344
s_nop 0
buffer_load_dwordx4 v21, s[20:23], s53 offen lds
s_add_u32 m0, s47, 58368
s_nop 0
buffer_load_dwordx4 v22, s[20:23], s53 offen lds
s_add_u32 m0, s46, 57344
s_nop 0
buffer_load_dwordx4 v31, s[32:35], s54 offen lds
s_add_u32 m0, s46, 58368
s_nop 0
buffer_load_dwordx4 v32, s[32:35], s54 offen lds
s_add_u32 m0, s46, 59392
s_nop 0
buffer_load_dwordx4 v33, s[32:35], s54 offen lds
s_add_u32 s53, s53, 16384
s_add_u32 s54, s54, s57
s_add_u32 m0, s47, 86016
s_nop 0
buffer_load_dwordx4 v21, s[20:23], s53 offen lds
s_add_u32 m0, s47, 87040
s_nop 0
buffer_load_dwordx4 v22, s[20:23], s53 offen lds
s_add_u32 m0, s46, 86016
s_nop 0
buffer_load_dwordx4 v31, s[32:35], s54 offen lds
s_add_u32 m0, s46, 87040
s_nop 0
buffer_load_dwordx4 v32, s[32:35], s54 offen lds
s_add_u32 m0, s46, 88064
s_nop 0
buffer_load_dwordx4 v33, s[32:35], s54 offen lds
s_add_u32 s53, s53, 16384
s_add_u32 s54, s54, s57
s_waitcnt vmcnt(15)
s_barrier
ds_read_b128 v[44:47], v34 offset:0
ds_read_b128 v[48:51], v34 offset:2048
ds_read_b64_tr_b16 v[60:61], v36 offset:0
ds_read_b64_tr_b16 v[62:63], v37 offset:0
ds_read_b64_tr_b16 v[64:65], v40 offset:0
ds_read_b64_tr_b16 v[66:67], v41 offset:0
ds_read_b64_tr_b16 v[68:69], v36 offset:128
ds_read_b64_tr_b16 v[70:71], v37 offset:128
s_waitcnt lgkmcnt(0)
v_mfma_f32_32x32x16_bf16 a[0:15], v[44:47], v[60:63], 0
ds_read_b128 v[52:55], v35 offset:0
v_mfma_f32_32x32x16_bf16 a[16:31], v[44:47], v[64:67], 0
ds_read_b128 v[56:59], v35 offset:2048
v_mfma_f32_32x32x16_bf16 a[32:47], v[44:47], v[68:71], 0
ds_read_b64_tr_b16 v[72:73], v38 offset:0
ds_read_b64_tr_b16 v[74:75], v39 offset:0
v_mfma_f32_32x32x16_bf16 a[48:63], v[48:51], v[60:63], 0
ds_read_b64_tr_b16 v[76:77], v42 offset:0
ds_read_b64_tr_b16 v[78:79], v43 offset:0
v_mfma_f32_32x32x16_bf16 a[64:79], v[48:51], v[64:67], 0
ds_read_b64_tr_b16 v[80:81], v38 offset:128
ds_read_b64_tr_b16 v[82:83], v39 offset:128
v_mfma_f32_32x32x16_bf16 a[80:95], v[48:51], v[68:71], 0
s_waitcnt lgkmcnt(0)
s_waitcnt vmcnt(10)
s_barrier
v_mfma_f32_32x32x16_bf16 a[0:15], v[52:55], v[72:75], a[0:15]
ds_read_b128 v[44:47], v34 offset:28672
ds_read_b128 v[48:51], v34 offset:30720
v_mfma_f32_32x32x16_bf16 a[16:31], v[52:55], v[76:79], a[16:31]
ds_read_b64_tr_b16 v[60:61], v36 offset:28672
ds_read_b64_tr_b16 v[62:63], v37 offset:28672
ds_read_b64_tr_b16 v[64:65], v40 offset:28672
ds_read_b64_tr_b16 v[66:67], v41 offset:28672
v_mfma_f32_32x32x16_bf16 a[32:47], v[52:55], v[80:83], a[32:47]
ds_read_b64_tr_b16 v[68:69], v36 offset:28800
ds_read_b64_tr_b16 v[70:71], v37 offset:28800
s_add_u32 m0, s47, 0
s_nop 0
buffer_load_dwordx4 v21, s[20:23], s53 offen lds
v_mfma_f32_32x32x16_bf16 a[48:63], v[56:59], v[72:75], a[48:63]
s_add_u32 m0, s47, 1024
s_nop 0
buffer_load_dwordx4 v22, s[20:23], s53 offen lds
s_add_u32 m0, s46, 0
s_nop 0
buffer_load_dwordx4 v31, s[32:35], s54 offen lds
v_mfma_f32_32x32x16_bf16 a[64:79], v[56:59], v[76:79], a[64:79]
s_add_u32 m0, s46, 1024
s_nop 0
buffer_load_dwordx4 v32, s[32:35], s54 offen lds
s_add_u32 m0, s46, 2048
s_nop 0
buffer_load_dwordx4 v33, s[32:35], s54 offen lds
s_add_u32 s53, s53, 16384
s_add_u32 s54, s54, s57
v_mfma_f32_32x32x16_bf16 a[80:95], v[56:59], v[80:83], a[80:95]
s_waitcnt lgkmcnt(0)
v_mfma_f32_32x32x16_bf16 a[0:15], v[44:47], v[60:63], a[0:15]
ds_read_b128 v[52:55], v35 offset:28672
v_mfma_f32_32x32x16_bf16 a[16:31], v[44:47], v[64:67], a[16:31]
ds_read_b128 v[56:59], v35 offset:30720
v_mfma_f32_32x32x16_bf16 a[32:47], v[44:47], v[68:71], a[32:47]
ds_read_b64_tr_b16 v[72:73], v38 offset:28672
ds_read_b64_tr_b16 v[74:75], v39 offset:28672
v_mfma_f32_32x32x16_bf16 a[48:63], v[48:51], v[60:63], a[48:63]
ds_read_b64_tr_b16 v[76:77], v42 offset:28672
ds_read_b64_tr_b16 v[78:79], v43 offset:28672
v_mfma_f32_32x32x16_bf16 a[64:79], v[48:51], v[64:67], a[64:79]
ds_read_b64_tr_b16 v[80:81], v38 offset:28800
ds_read_b64_tr_b16 v[82:83], v39 offset:28800
v_mfma_f32_32x32x16_bf16 a[80:95], v[48:51], v[68:71], a[80:95]
s_waitcnt lgkmcnt(0)
s_waitcnt vmcnt(10)
s_barrier
v_mfma_f32_32x32x16_bf16 a[0:15], v[52:55], v[72:75], a[0:15]
ds_read_b128 v[44:47], v84 offset:0
ds_read_b128 v[48:51], v84 offset:2048
v_mfma_f32_32x32x16_bf16 a[16:31], v[52:55], v[76:79], a[16:31]
ds_read_b64_tr_b16 v[60:61], v86 offset:0
ds_read_b64_tr_b16 v[62:63], v87 offset:0
ds_read_b64_tr_b16 v[64:65], v90 offset:0
ds_read_b64_tr_b16 v[66:67], v91 offset:0
v_mfma_f32_32x32x16_bf16 a[32:47], v[52:55], v[80:83], a[32:47]
ds_read_b64_tr_b16 v[68:69], v86 offset:128
ds_read_b64_tr_b16 v[70:71], v87 offset:128
s_add_u32 m0, s47, 28672
s_nop 0
buffer_load_dwordx4 v21, s[20:23], s53 offen lds
v_mfma_f32_32x32x16_bf16 a[48:63], v[56:59], v[72:75], a[48:63]
s_add_u32 m0, s47, 29696
s_nop 0
buffer_load_dwordx4 v22, s[20:23], s53 offen lds
s_add_u32 m0, s46, 28672
s_nop 0
buffer_load_dwordx4 v31, s[32:35], s54 offen lds
v_mfma_f32_32x32x16_bf16 a[64:79], v[56:59], v[76:79], a[64:79]
s_add_u32 m0, s46, 29696
s_nop 0
buffer_load_dwordx4 v32, s[32:35], s54 offen lds
s_add_u32 m0, s46, 30720
s_nop 0
buffer_load_dwordx4 v33, s[32:35], s54 offen lds
s_add_u32 s53, s53, 16384
s_add_u32 s54, s54, s57
v_mfma_f32_32x32x16_bf16 a[80:95], v[56:59], v[80:83], a[80:95]
s_waitcnt lgkmcnt(0)
v_mfma_f32_32x32x16_bf16 a[0:15], v[44:47], v[60:63], a[0:15]
ds_read_b128 v[52:55], v85 offset:0
v_mfma_f32_32x32x16_bf16 a[16:31], v[44:47], v[64:67], a[16:31]
ds_read_b128 v[56:59], v85 offset:2048
v_mfma_f32_32x32x16_bf16 a[32:47], v[44:47], v[68:71], a[32:47]
ds_read_b64_tr_b16 v[72:73], v88 offset:0
ds_read_b64_tr_b16 v[74:75], v89 offset:0
v_mfma_f32_32x32x16_bf16 a[48:63], v[48:51], v[60:63], a[48:63]
ds_read_b64_tr_b16 v[76:77], v92 offset:0
ds_read_b64_tr_b16 v[78:79], v93 offset:0
v_mfma_f32_32x32x16_bf16 a[64:79], v[48:51], v[64:67], a[64:79]
ds_read_b64_tr_b16 v[80:81], v88 offset:128
ds_read_b64_tr_b16 v[82:83], v89 offset:128
v_mfma_f32_32x32x16_bf16 a[80:95], v[48:51], v[68:71], a[80:95]
s_waitcnt lgkmcnt(0)
s_waitcnt vmcnt(10)
s_barrier
v_mfma_f32_32x32x16_bf16 a[0:15], v[52:55], v[72:75], a[0:15]
ds_read_b128 v[44:47], v84 offset:28672
ds_read_b128 v[48:51], v84 offset:30720
v_mfma_f32_32x32x16_bf16 a[16:31], v[52:55], v[76:79], a[16:31]
ds_read_b64_tr_b16 v[60:61], v86 offset:28672
ds_read_b64_tr_b16 v[62:63], v87 offset:28672
ds_read_b64_tr_b16 v[64:65], v90 offset:28672
ds_read_b64_tr_b16 v[66:67], v91 offset:28672
v_mfma_f32_32x32x16_bf16 a[32:47], v[52:55], v[80:83], a[32:47]
ds_read_b64_tr_b16 v[68:69], v86 offset:28800
ds_read_b64_tr_b16 v[70:71], v87 offset:28800
s_add_u32 m0, s47, 57344
s_nop 0
buffer_load_dwordx4 v21, s[20:23], s53 offen lds
v_mfma_f32_32x32x16_bf16 a[48:63], v[56:59], v[72:75], a[48:63]
s_add_u32 m0, s47, 58368
s_nop 0
buffer_load_dwordx4 v22, s[20:23], s53 offen lds
s_add_u32 m0, s46, 57344
s_nop 0
buffer_load_dwordx4 v31, s[32:35], s54 offen lds
v_mfma_f32_32x32x16_bf16 a[64:79], v[56:59], v[76:79], a[64:79]
s_add_u32 m0, s46, 58368
s_nop 0
buffer_load_dwordx4 v32, s[32:35], s54 offen lds
s_add_u32 m0, s46, 59392
s_nop 0
buffer_load_dwordx4 v33, s[32:35], s54 offen lds
s_add_u32 s53, s53, 16384
s_add_u32 s54, s54, s57
v_mfma_f32_32x32x16_bf16 a[80:95], v[56:59], v[80:83], a[80:95]
s_waitcnt lgkmcnt(0)
v_mfma_f32_32x32x16_bf16 a[0:15], v[44:47], v[60:63], a[0:15]
ds_read_b128 v[52:55], v85 offset:28672
v_mfma_f32_32x32x16_bf16 a[16:31], v[44:47], v[64:67], a[16:31]
ds_read_b128 v[56:59], v85 offset:30720
v_mfma_f32_32x32x16_bf16 a[32:47], v[44:47], v[68:71], a[32:47]
ds_read_b64_tr_b16 v[72:73], v88 offset:28672
ds_read_b64_tr_b16 v[74:75], v89 offset:28672
v_mfma_f32_32x32x16_bf16 a[48:63], v[48:51], v[60:63], a[48:63]
ds_read_b64_tr_b16 v[76:77], v92 offset:28672
ds_read_b64_tr_b16 v[78:79], v93 offset:28672
v_mfma_f32_32x32x16_bf16 a[64:79], v[48:51], v[64:67], a[64:79]
ds_read_b64_tr_b16 v[80:81], v88 offset:28800
ds_read_b64_tr_b16 v[82:83], v89 offset:28800
v_mfma_f32_32x32x16_bf16 a[80:95], v[48:51], v[68:71], a[80:95]
s_waitcnt lgkmcnt(0)
s_waitcnt vmcnt(10)
s_barrier
v_mfma_f32_32x32x16_bf16 a[0:15], v[52:55], v[72:75], a[0:15]
ds_read_b128 v[44:47], v34 offset:0
ds_read_b128 v[48:51], v34 offset:2048
v_mfma_f32_32x32x16_bf16 a[16:31], v[52:55], v[76:79], a[16:31]
ds_read_b64_tr_b16 v[60:61], v36 offset:0
ds_read_b64_tr_b16 v[62:63], v37 offset:0
ds_read_b64_tr_b16 v[64:65], v40 offset:0
ds_read_b64_tr_b16 v[66:67], v41 offset:0
v_mfma_f32_32x32x16_bf16 a[32:47], v[52:55], v[80:83], a[32:47]
ds_read_b64_tr_b16 v[68:69], v36 offset:128
ds_read_b64_tr_b16 v[70:71], v37 offset:128
s_add_u32 m0, s47, 86016
s_nop 0
buffer_load_dwordx4 v21, s[20:23], s53 offen lds
v_mfma_f32_32x32x16_bf16 a[48:63], v[56:59], v[72:75], a[48:63]
s_add_u32 m0, s47, 87040
s_nop 0
buffer_load_dwordx4 v22, s[20:23], s53 offen lds
s_add_u32 m0, s46, 86016
s_nop 0
buffer_load_dwordx4 v31, s[32:35], s54 offen lds
v_mfma_f32_32x32x16_bf16 a[64:79], v[56:59], v[76:79], a[64:79]
s_add_u32 m0, s46, 87040
s_nop 0
buffer_load_dwordx4 v32, s[32:35], s54 offen lds
s_add_u32 m0, s46, 88064
s_nop 0
buffer_load_dwordx4 v33, s[32:35], s54 offen lds
s_add_u32 s53, s53, 16384
s_add_u32 s54, s54, s57
v_mfma_f32_32x32x16_bf16 a[80:95], v[56:59], v[80:83], a[80:95]
s_mov_b32 s42, 3
s_cmp_eq_u32 s42, 0
s_cbranch_scc1 L_h_xw_last_B
s_nop 8
L_h_xw_B:
s_waitcnt lgkmcnt(0)
v_mfma_f32_32x32x16_bf16 a[0:15], v[44:47], v[60:63], a[0:15]
ds_read_b128 v[52:55], v35 offset:0
v_mfma_f32_32x32x16_bf16 a[16:31], v[44:47], v[64:67], a[16:31]
ds_read_b128 v[56:59], v35 offset:2048
v_mfma_f32_32x32x16_bf16 a[32:47], v[44:47], v[68:71], a[32:47]
ds_read_b64_tr_b16 v[72:73], v38 offset:0
ds_read_b64_tr_b16 v[74:75], v39 offset:0
v_mfma_f32_32x32x16_bf16 a[48:63], v[48:51], v[60:63], a[48:63]
ds_read_b64_tr_b16 v[76:77], v42 offset:0
ds_read_b64_tr_b16 v[78:79], v43 offset:0
v_mfma_f32_32x32x16_bf16 a[64:79], v[48:51], v[64:67], a[64:79]
ds_read_b64_tr_b16 v[80:81], v38 offset:128
ds_read_b64_tr_b16 v[82:83], v39 offset:128
v_mfma_f32_32x32x16_bf16 a[80:95], v[48:51], v[68:71], a[80:95]
s_waitcnt lgkmcnt(0)
s_waitcnt vmcnt(10)
s_barrier
v_mfma_f32_32x32x16_bf16 a[0:15], v[52:55], v[72:75], a[0:15]
ds_read_b128 v[44:47], v34 offset:28672
ds_read_b128 v[48:51], v34 offset:30720
v_mfma_f32_32x32x16_bf16 a[16:31], v[52:55], v[76:79], a[16:31]
ds_read_b64_tr_b16 v[60:61], v36 offset:28672
ds_read_b64_tr_b16 v[62:63], v37 offset:28672
ds_read_b64_tr_b16 v[64:65], v40 offset:28672
ds_read_b64_tr_b16 v[66:67], v41 offset:28672
v_mfma_f32_32x32x16_bf16 a[32:47], v[52:55], v[80:83], a[32:47]
ds_read_b64_tr_b16 v[68:69], v36 offset:28800
ds_read_b64_tr_b16 v[70:71], v37 offset:28800
s_add_u32 m0, s47, 0
s_nop 0
buffer_load_dwordx4 v21, s[20:23], s53 offen lds
v_mfma_f32_32x32x16_bf16 a[48:63], v[56:59], v[72:75], a[48:63]
s_add_u32 m0, s47, 1024
s_nop 0
buffer_load_dwordx4 v22, s[20:23], s53 offen lds
s_add_u32 m0, s46, 0
s_nop 0
buffer_load_dwordx4 v31, s[32:35], s54 offen lds
v_mfma_f32_32x32x16_bf16 a[64:79], v[56:59], v[76:79], a[64:79]
s_add_u32 m0, s46, 1024
s_nop 0
buffer_load_dwordx4 v32, s[32:35], s54 offen lds
s_add_u32 m0, s46, 2048
s_nop 0
buffer_load_dwordx4 v33, s[32:35], s54 offen lds
s_add_u32 s53, s53, 16384
s_add_u32 s54, s54, s57
v_mfma_f32_32x32x16_bf16 a[80:95], v[56:59], v[80:83], a[80:95]
s_waitcnt lgkmcnt(0)
v_mfma_f32_32x32x16_bf16 a[0:15], v[44:47], v[60:63], a[0:15]
ds_read_b128 v[52:55], v35 offset:28672
v_mfma_f32_32x32x16_bf16 a[16:31], v[44:47], v[64:67], a[16:31]
ds_read_b128 v[56:59], v35 offset:30720
v_mfma_f32_32x32x16_bf16 a[32:47], v[44:47], v[68:71], a[32:47]
ds_read_b64_tr_b16 v[72:73], v38 offset:28672
ds_read_b64_tr_b16 v[74:75], v39 offset:28672
v_mfma_f32_32x32x16_bf16 a[48:63], v[48:51], v[60:63], a[48:63]
ds_read_b64_tr_b16 v[76:77], v42 offset:28672
ds_read_b64_tr_b16 v[78:79], v43 offset:28672
v_mfma_f32_32x32x16_bf16 a[64:79], v[48:51], v[64:67], a[64:79]
ds_read_b64_tr_b16 v[80:81], v38 offset:28800
ds_read_b64_tr_b16 v[82:83], v39 offset:28800
v_mfma_f32_32x32x16_bf16 a[80:95], v[48:51], v[68:71], a[80:95]
s_waitcnt lgkmcnt(0)
s_waitcnt vmcnt(10)
s_barrier
v_mfma_f32_32x32x16_bf16 a[0:15], v[52:55], v[72:75], a[0:15]
ds_read_b128 v[44:47], v84 offset:0
ds_read_b128 v[48:51], v84 offset:2048
v_mfma_f32_32x32x16_bf16 a[16:31], v[52:55], v[76:79], a[16:31]
ds_read_b64_tr_b16 v[60:61], v86 offset:0
ds_read_b64_tr_b16 v[62:63], v87 offset:0
ds_read_b64_tr_b16 v[64:65], v90 offset:0
ds_read_b64_tr_b16 v[66:67], v91 offset:0
v_mfma_f32_32x32x16_bf16 a[32:47], v[52:55], v[80:83], a[32:47]
ds_read_b64_tr_b16 v[68:69], v86 offset:128
ds_read_b64_tr_b16 v[70:71], v87 offset:128
s_add_u32 m0, s47, 28672
s_nop 0
buffer_load_dwordx4 v21, s[20:23], s53 offen lds
v_mfma_f32_32x32x16_bf16 a[48:63], v[56:59], v[72:75], a[48:63]
s_add_u32 m0, s47, 29696
s_nop 0
buffer_load_dwordx4 v22, s[20:23], s53 offen lds
s_add_u32 m0, s46, 28672
s_nop 0
buffer_load_dwordx4 v31, s[32:35], s54 offen lds
v_mfma_f32_32x32x16_bf16 a[64:79], v[56:59], v[76:79], a[64:79]
s_add_u32 m0, s46, 29696
s_nop 0
buffer_load_dwordx4 v32, s[32:35], s54 offen lds
s_add_u32 m0, s46, 30720
s_nop 0
buffer_load_dwordx4 v33, s[32:35], s54 offen lds
s_add_u32 s53, s53, 16384
s_add_u32 s54, s54, s57
v_mfma_f32_32x32x16_bf16 a[80:95], v[56:59], v[80:83], a[80:95]
s_waitcnt lgkmcnt(0)
v_mfma_f32_32x32x16_bf16 a[0:15], v[44:47], v[60:63], a[0:15]
ds_read_b128 v[52:55], v85 offset:0
v_mfma_f32_32x32x16_bf16 a[16:31], v[44:47], v[64:67], a[16:31]
ds_read_b128 v[56:59], v85 offset:2048
v_mfma_f32_32x32x16_bf16 a[32:47], v[44:47], v[68:71], a[32:47]
ds_read_b64_tr_b16 v[72:73], v88 offset:0
ds_read_b64_tr_b16 v[74:75], v89 offset:0
v_mfma_f32_32x32x16_bf16 a[48:63], v[48:51], v[60:63], a[48:63]
ds_read_b64_tr_b16 v[76:77], v92 offset:0
ds_read_b64_tr_b16 v[78:79], v93 offset:0
v_mfma_f32_32x32x16_bf16 a[64:79], v[48:51], v[64:67], a[64:79]
ds_read_b64_tr_b16 v[80:81], v88 offset:128
ds_read_b64_tr_b16 v[82:83], v89 offset:128
v_mfma_f32_32x32x16_bf16 a[80:95], v[48:51], v[68:71], a[80:95]
s_waitcnt lgkmcnt(0)
s_waitcnt vmcnt(10)
s_barrier
v_mfma_f32_32x32x16_bf16 a[0:15], v[52:55], v[72:75], a[0:15]
ds_read_b128 v[44:47], v84 offset:28672
ds_read_b128 v[48:51], v84 offset:30720
v_mfma_f32_32x32x16_bf16 a[16:31], v[52:55], v[76:79], a[16:31]
ds_read_b64_tr_b16 v[60:61], v86 offset:28672
ds_read_b64_tr_b16 v[62:63], v87 offset:28672
ds_read_b64_tr_b16 v[64:65], v90 offset:28672
ds_read_b64_tr_b16 v[66:67], v91 offset:28672
v_mfma_f32_32x32x16_bf16 a[32:47], v[52:55], v[80:83], a[32:47]
ds_read_b64_tr_b16 v[68:69], v86 offset:28800
ds_read_b64_tr_b16 v[70:71], v87 offset:28800
s_add_u32 m0, s47, 57344
s_nop 0
buffer_load_dwordx4 v21, s[20:23], s53 offen lds
v_mfma_f32_32x32x16_bf16 a[48:63], v[56:59], v[72:75], a[48:63]
s_add_u32 m0, s47, 58368
s_nop 0
buffer_load_dwordx4 v22, s[20:23], s53 offen lds
s_add_u32 m0, s46, 57344
s_nop 0
buffer_load_dwordx4 v31, s[32:35], s54 offen lds
v_mfma_f32_32x32x16_bf16 a[64:79], v[56:59], v[76:79], a[64:79]
s_add_u32 m0, s46, 58368
s_nop 0
buffer_load_dwordx4 v32, s[32:35], s54 offen lds
s_add_u32 m0, s46, 59392
s_nop 0
buffer_load_dwordx4 v33, s[32:35], s54 offen lds
s_add_u32 s53, s53, 16384
s_add_u32 s54, s54, s57
v_mfma_f32_32x32x16_bf16 a[80:95], v[56:59], v[80:83], a[80:95]
s_waitcnt lgkmcnt(0)
v_mfma_f32_32x32x16_bf16 a[0:15], v[44:47], v[60:63], a[0:15]
ds_read_b128 v[52:55], v85 offset:28672
v_mfma_f32_32x32x16_bf16 a[16:31], v[44:47], v[64:67], a[16:31]
ds_read_b128 v[56:59], v85 offset:30720
v_mfma_f32_32x32x16_bf16 a[32:47], v[44:47], v[68:71], a[32:47]
ds_read_b64_tr_b16 v[72:73], v88 offset:28672
ds_read_b64_tr_b16 v[74:75], v89 offset:28672
v_mfma_f32_32x32x16_bf16 a[48:63], v[48:51], v[60:63], a[48:63]
ds_read_b64_tr_b16 v[76:77], v92 offset:28672
ds_read_b64_tr_b16 v[78:79], v93 offset:28672
v_mfma_f32_32x32x16_bf16 a[64:79], v[48:51], v[64:67], a[64:79]
ds_read_b64_tr_b16 v[80:81], v88 offset:28800
ds_read_b64_tr_b16 v[82:83], v89 offset:28800
v_mfma_f32_32x32x16_bf16 a[80:95], v[48:51], v[68:71], a[80:95]
s_waitcnt lgkmcnt(0)
s_waitcnt vmcnt(10)
s_barrier
v_mfma_f32_32x32x16_bf16 a[0:15], v[52:55], v[72:75], a[0:15]
ds_read_b128 v[44:47], v34 offset:0
ds_read_b128 v[48:51], v34 offset:2048
v_mfma_f32_32x32x16_bf16 a[16:31], v[52:55], v[76:79], a[16:31]
ds_read_b64_tr_b16 v[60:61], v36 offset:0
ds_read_b64_tr_b16 v[62:63], v37 offset:0
ds_read_b64_tr_b16 v[64:65], v40 offset:0
ds_read_b64_tr_b16 v[66:67], v41 offset:0
v_mfma_f32_32x32x16_bf16 a[32:47], v[52:55], v[80:83], a[32:47]
ds_read_b64_tr_b16 v[68:69], v36 offset:128
ds_read_b64_tr_b16 v[70:71], v37 offset:128
s_add_u32 m0, s47, 86016
s_nop 0
buffer_load_dwordx4 v21, s[20:23], s53 offen lds
v_mfma_f32_32x32x16_bf16 a[48:63], v[56:59], v[72:75], a[48:63]
s_add_u32 m0, s47, 87040
s_nop 0
buffer_load_dwordx4 v22, s[20:23], s53 offen lds
s_add_u32 m0, s46, 86016
s_nop 0
buffer_load_dwordx4 v31, s[32:35], s54 offen lds
v_mfma_f32_32x32x16_bf16 a[64:79], v[56:59], v[76:79], a[64:79]
s_add_u32 m0, s46, 87040
s_nop 0
buffer_load_dwordx4 v32, s[32:35], s54 offen lds
s_add_u32 m0, s46, 88064
s_nop 0
buffer_load_dwordx4 v33, s[32:35], s54 offen lds
s_add_u32 s53, s53, 16384
s_add_u32 s54, s54, s57
v_mfma_f32_32x32x16_bf16 a[80:95], v[56:59], v[80:83], a[80:95]
s_sub_u32 s42, s42, 1
s_cmp_lg_u32 s42, 0
s_nop 9
s_cbranch_scc1 L_h_xw_B
L_h_xw_last_B:
s_waitcnt lgkmcnt(0)
v_mfma_f32_32x32x16_bf16 a[0:15], v[44:47], v[60:63], a[0:15]
ds_read_b128 v[52:55], v35 offset:0
v_mfma_f32_32x32x16_bf16 a[16:31], v[44:47], v[64:67], a[16:31]
ds_read_b128 v[56:59], v35 offset:2048
v_mfma_f32_32x32x16_bf16 a[32:47], v[44:47], v[68:71], a[32:47]
ds_read_b64_tr_b16 v[72:73], v38 offset:0
ds_read_b64_tr_b16 v[74:75], v39 offset:0
v_mfma_f32_32x32x16_bf16 a[48:63], v[48:51], v[60:63], a[48:63]
ds_read_b64_tr_b16 v[76:77], v42 offset:0
ds_read_b64_tr_b16 v[78:79], v43 offset:0
v_mfma_f32_32x32x16_bf16 a[64:79], v[48:51], v[64:67], a[64:79]
ds_read_b64_tr_b16 v[80:81], v38 offset:128
ds_read_b64_tr_b16 v[82:83], v39 offset:128
v_mfma_f32_32x32x16_bf16 a[80:95], v[48:51], v[68:71], a[80:95]
s_waitcnt lgkmcnt(0)
s_waitcnt vmcnt(10)
s_barrier
v_mfma_f32_32x32x16_bf16 a[0:15], v[52:55], v[72:75], a[0:15]
ds_read_b128 v[44:47], v34 offset:28672
v_mfma_f32_32x32x16_bf16 a[16:31], v[52:55], v[76:79], a[16:31]
ds_read_b128 v[48:51], v34 offset:30720
v_mfma_f32_32x32x16_bf16 a[32:47], v[52:55], v[80:83], a[32:47]
ds_read_b64_tr_b16 v[60:61], v36 offset:28672
ds_read_b64_tr_b16 v[62:63], v37 offset:28672
v_mfma_f32_32x32x16_bf16 a[48:63], v[56:59], v[72:75], a[48:63]
ds_read_b64_tr_b16 v[64:65], v40 offset:28672
ds_read_b64_tr_b16 v[66:67], v41 offset:28672
v_mfma_f32_32x32x16_bf16 a[64:79], v[56:59], v[76:79], a[64:79]
ds_read_b64_tr_b16 v[68:69], v36 offset:28800
ds_read_b64_tr_b16 v[70:71], v37 offset:28800
v_mfma_f32_32x32x16_bf16 a[80:95], v[56:59], v[80:83], a[80:95]
s_waitcnt lgkmcnt(0)
v_mfma_f32_32x32x16_bf16 a[0:15], v[44:47], v[60:63], a[0:15]
ds_read_b128 v[52:55], v35 offset:28672
v_mfma_f32_32x32x16_bf16 a[16:31], v[44:47], v[64:67], a[16:31]
ds_read_b128 v[56:59], v35 offset:30720
v_mfma_f32_32x32x16_bf16 a[32:47], v[44:47], v[68:71], a[32:47]
ds_read_b64_tr_b16 v[72:73], v38 offset:28672
ds_read_b64_tr_b16 v[74:75], v39 offset:28672
v_mfma_f32_32x32x16_bf16 a[48:63], v[48:51], v[60:63], a[48:63]
ds_read_b64_tr_b16 v[76:77], v42 offset:28672
ds_read_b64_tr_b16 v[78:79], v43 offset:28672
v_mfma_f32_32x32x16_bf16 a[64:79], v[48:51], v[64:67], a[64:79]
ds_read_b64_tr_b16 v[80:81], v38 offset:28800
ds_read_b64_tr_b16 v[82:83], v39 offset:28800
v_mfma_f32_32x32x16_bf16 a[80:95], v[48:51], v[68:71], a[80:95]
s_waitcnt lgkmcnt(0)
s_waitcnt vmcnt(5)
s_barrier
v_mfma_f32_32x32x16_bf16 a[0:15], v[52:55], v[72:75], a[0:15]
ds_read_b128 v[44:47], v84 offset:0
v_mfma_f32_32x32x16_bf16 a[16:31], v[52:55], v[76:79], a[16:31]
ds_read_b128 v[48:51], v84 offset:2048
v_mfma_f32_32x32x16_bf16 a[32:47], v[52:55], v[80:83], a[32:47]
ds_read_b64_tr_b16 v[60:61], v86 offset:0
ds_read_b64_tr_b16 v[62:63], v87 offset:0
v_mfma_f32_32x32x16_bf16 a[48:63], v[56:59], v[72:75], a[48:63]
ds_read_b64_tr_b16 v[64:65], v90 offset:0
ds_read_b64_tr_b16 v[66:67], v91 offset:0
v_mfma_f32_32x32x16_bf16 a[64:79], v[56:59], v[76:79], a[64:79]
ds_read_b64_tr_b16 v[68:69], v86 offset:128
ds_read_b64_tr_b16 v[70:71], v87 offset:128
v_mfma_f32_32x32x16_bf16 a[80:95], v[56:59], v[80:83], a[80:95]
s_waitcnt lgkmcnt(0)
v_mfma_f32_32x32x16_bf16 a[0:15], v[44:47], v[60:63], a[0:15]
ds_read_b128 v[52:55], v85 offset:0
v_mfma_f32_32x32x16_bf16 a[16:31], v[44:47], v[64:67], a[16:31]
ds_read_b128 v[56:59], v85 offset:2048
v_mfma_f32_32x32x16_bf16 a[32:47], v[44:47], v[68:71], a[32:47]
ds_read_b64_tr_b16 v[72:73], v88 offset:0
ds_read_b64_tr_b16 v[74:75], v89 offset:0
v_mfma_f32_32x32x16_bf16 a[48:63], v[48:51], v[60:63], a[48:63]
ds_read_b64_tr_b16 v[76:77], v92 offset:0
ds_read_b64_tr_b16 v[78:79], v93 offset:0
v_mfma_f32_32x32x16_bf16 a[64:79], v[48:51], v[64:67], a[64:79]
ds_read_b64_tr_b16 v[80:81], v88 offset:128
ds_read_b64_tr_b16 v[82:83], v89 offset:128
v_mfma_f32_32x32x16_bf16 a[80:95], v[48:51], v[68:71], a[80:95]
s_waitcnt lgkmcnt(0)
s_waitcnt vmcnt(0)
s_barrier
v_mfma_f32_32x32x16_bf16 a[0:15], v[52:55], v[72:75], a[0:15]
ds_read_b128 v[44:47], v84 offset:28672
v_mfma_f32_32x32x16_bf16 a[16:31], v[52:55], v[76:79], a[16:31]
ds_read_b128 v[48:51], v84 offset:30720
v_mfma_f32_32x32x16_bf16 a[32:47], v[52:55], v[80:83], a[32:47]
ds_read_b64_tr_b16 v[60:61], v86 offset:28672
ds_read_b64_tr_b16 v[62:63], v87 offset:28672
v_mfma_f32_32x32x16_bf16 a[48:63], v[56:59], v[72:75], a[48:63]
ds_read_b64_tr_b16 v[64:65], v90 offset:28672
ds_read_b64_tr_b16 v[66:67], v91 offset:28672
v_mfma_f32_32x32x16_bf16 a[64:79], v[56:59], v[76:79], a[64:79]
ds_read_b64_tr_b16 v[68:69], v86 offset:28800
ds_read_b64_tr_b16 v[70:71], v87 offset:28800
v_mfma_f32_32x32x16_bf16 a[80:95], v[56:59], v[80:83], a[80:95]
s_waitcnt lgkmcnt(0)
v_mfma_f32_32x32x16_bf16 a[0:15], v[44:47], v[60:63], a[0:15]
ds_read_b128 v[52:55], v85 offset:28672
v_mfma_f32_32x32x16_bf16 a[16:31], v[44:47], v[64:67], a[16:31]
ds_read_b128 v[56:59], v85 offset:30720
v_mfma_f32_32x32x16_bf16 a[32:47], v[44:47], v[68:71], a[32:47]
ds_read_b64_tr_b16 v[72:73], v88 offset:28672
ds_read_b64_tr_b16 v[74:75], v89 offset:28672
v_mfma_f32_32x32x16_bf16 a[48:63], v[48:51], v[60:63], a[48:63]
ds_read_b64_tr_b16 v[76:77], v92 offset:28672
ds_read_b64_tr_b16 v[78:79], v93 offset:28672
v_mfma_f32_32x32x16_bf16 a[64:79], v[48:51], v[64:67], a[64:79]
ds_read_b64_tr_b16 v[80:81], v88 offset:28800
ds_read_b64_tr_b16 v[82:83], v89 offset:28800
v_mfma_f32_32x32x16_bf16 a[80:95], v[48:51], v[68:71], a[80:95]
s_waitcnt lgkmcnt(0)
s_waitcnt vmcnt(0)
s_barrier
v_mfma_f32_32x32x16_bf16 a[0:15], v[52:55], v[72:75], a[0:15]
v_mfma_f32_32x32x16_bf16 a[16:31], v[52:55], v[76:79], a[16:31]
v_mfma_f32_32x32x16_bf16 a[32:47], v[52:55], v[80:83], a[32:47]
v_mfma_f32_32x32x16_bf16 a[48:63], v[56:59], v[72:75], a[48:63]
v_mfma_f32_32x32x16_bf16 a[64:79], v[56:59], v[76:79], a[64:79]
v_mfma_f32_32x32x16_bf16 a[80:95], v[56:59], v[80:83], a[80:95]
s_nop 11
L_h_epi_B:
s_mov_b32 s48, 1
s_lshr_b32 s60, s28, 1
s_and_b32 s61, s28, 1
s_lshl_b32 s40, s62, 2
s_lshl_b32 s60, s60, 1
s_add_u32 s40, s40, s60
s_lshl_b32 s40, s40, 5
s_add_u32 s40, s40, s59
s_mul_i32 s40, s40, 12288
s_cmp_eq_u32 s58, 1
s_cbranch_scc1 L_h_ev_B
s_mul_i32 s61, s61, 3072
s_add_u32 s40, s40, s61
s_add_u32 s40, s40, 0
s_add_u32 s41, s40, 0
v_accvgpr_read_b32 v104, a0
v_accvgpr_read_b32 v105, a1
v_accvgpr_read_b32 v106, a2
v_accvgpr_read_b32 v107, a3
v_accvgpr_read_b32 v108, a4
v_accvgpr_read_b32 v109, a5
v_accvgpr_read_b32 v110, a6
v_accvgpr_read_b32 v111, a7
v_accvgpr_read_b32 v112, a8
v_accvgpr_read_b32 v113, a9
v_accvgpr_read_b32 v114, a10
v_accvgpr_read_b32 v115, a11
v_accvgpr_read_b32 v116, a12
v_accvgpr_read_b32 v117, a13
v_accvgpr_read_b32 v118, a14
v_accvgpr_read_b32 v119, a15
v_cvt_pk_bf16_f32 v96, v104, v105
v_cvt_pk_bf16_f32 v97, v106, v107
v_cvt_pk_bf16_f32 v98, v112, v113
v_cvt_pk_bf16_f32 v99, v114, v115
v_cvt_pk_bf16_f32 v100, v108, v109
v_cvt_pk_bf16_f32 v101, v110, v111
v_cvt_pk_bf16_f32 v102, v116, v117
v_cvt_pk_bf16_f32 v103, v118, v119
buffer_store_dwordx4 v[96:99], v94, s[20:23], s41 offen sc1
buffer_store_dwordx4 v[100:103], v94, s[20:23], s41 offen offset:512 sc1
s_add_u32 s41, s40, 1024
v_accvgpr_read_b32 v104, a16
v_accvgpr_read_b32 v105, a17
v_accvgpr_read_b32 v106, a18
v_accvgpr_read_b32 v107, a19
v_accvgpr_read_b32 v108, a20
v_accvgpr_read_b32 v109, a21
v_accvgpr_read_b32 v110, a22
v_accvgpr_read_b32 v111, a23
v_accvgpr_read_b32 v112, a24
v_accvgpr_read_b32 v113, a25
v_accvgpr_read_b32 v114, a26
v_accvgpr_read_b32 v115, a27
v_accvgpr_read_b32 v116, a28
v_accvgpr_read_b32 v117, a29
v_accvgpr_read_b32 v118, a30
v_accvgpr_read_b32 v119, a31
v_cvt_pk_bf16_f32 v96, v104, v105
v_cvt_pk_bf16_f32 v97, v106, v107
v_cvt_pk_bf16_f32 v98, v112, v113
v_cvt_pk_bf16_f32 v99, v114, v115
v_cvt_pk_bf16_f32 v100, v108, v109
v_cvt_pk_bf16_f32 v101, v110, v111
v_cvt_pk_bf16_f32 v102, v116, v117
v_cvt_pk_bf16_f32 v103, v118, v119
buffer_store_dwordx4 v[96:99], v94, s[20:23], s41 offen sc1
buffer_store_dwordx4 v[100:103], v94, s[20:23], s41 offen offset:512 sc1
s_add_u32 s41, s40, 2048
v_accvgpr_read_b32 v104, a32
v_accvgpr_read_b32 v105, a33
v_accvgpr_read_b32 v106, a34
v_accvgpr_read_b32 v107, a35
v_accvgpr_read_b32 v108, a36
v_accvgpr_read_b32 v109, a37
v_accvgpr_read_b32 v110, a38
v_accvgpr_read_b32 v111, a39
v_accvgpr_read_b32 v112, a40
v_accvgpr_read_b32 v113, a41
v_accvgpr_read_b32 v114, a42
v_accvgpr_read_b32 v115, a43
v_accvgpr_read_b32 v116, a44
v_accvgpr_read_b32 v117, a45
v_accvgpr_read_b32 v118, a46
v_accvgpr_read_b32 v119, a47
v_cvt_pk_bf16_f32 v96, v104, v105
v_cvt_pk_bf16_f32 v97, v106, v107
v_cvt_pk_bf16_f32 v98, v112, v113
v_cvt_pk_bf16_f32 v99, v114, v115
v_cvt_pk_bf16_f32 v100, v108, v109
v_cvt_pk_bf16_f32 v101, v110, v111
v_cvt_pk_bf16_f32 v102, v116, v117
v_cvt_pk_bf16_f32 v103, v118, v119
buffer_store_dwordx4 v[96:99], v94, s[20:23], s41 offen sc1
buffer_store_dwordx4 v[100:103], v94, s[20:23], s41 offen offset:512 sc1
s_add_u32 s41, s40, 393216
v_accvgpr_read_b32 v104, a48
v_accvgpr_read_b32 v105, a49
v_accvgpr_read_b32 v106, a50
v_accvgpr_read_b32 v107, a51
v_accvgpr_read_b32 v108, a52
v_accvgpr_read_b32 v109, a53
v_accvgpr_read_b32 v110, a54
v_accvgpr_read_b32 v111, a55
v_accvgpr_read_b32 v112, a56
v_accvgpr_read_b32 v113, a57
v_accvgpr_read_b32 v114, a58
v_accvgpr_read_b32 v115, a59
v_accvgpr_read_b32 v116, a60
v_accvgpr_read_b32 v117, a61
v_accvgpr_read_b32 v118, a62
v_accvgpr_read_b32 v119, a63
v_cvt_pk_bf16_f32 v96, v104, v105
v_cvt_pk_bf16_f32 v97, v106, v107
v_cvt_pk_bf16_f32 v98, v112, v113
v_cvt_pk_bf16_f32 v99, v114, v115
v_cvt_pk_bf16_f32 v100, v108, v109
v_cvt_pk_bf16_f32 v101, v110, v111
v_cvt_pk_bf16_f32 v102, v116, v117
v_cvt_pk_bf16_f32 v103, v118, v119
buffer_store_dwordx4 v[96:99], v94, s[20:23], s41 offen sc1
buffer_store_dwordx4 v[100:103], v94, s[20:23], s41 offen offset:512 sc1
s_add_u32 s41, s40, 394240
v_accvgpr_read_b32 v104, a64
v_accvgpr_read_b32 v105, a65
v_accvgpr_read_b32 v106, a66
v_accvgpr_read_b32 v107, a67
v_accvgpr_read_b32 v108, a68
v_accvgpr_read_b32 v109, a69
v_accvgpr_read_b32 v110, a70
v_accvgpr_read_b32 v111, a71
v_accvgpr_read_b32 v112, a72
v_accvgpr_read_b32 v113, a73
v_accvgpr_read_b32 v114, a74
v_accvgpr_read_b32 v115, a75
v_accvgpr_read_b32 v116, a76
v_accvgpr_read_b32 v117, a77
v_accvgpr_read_b32 v118, a78
v_accvgpr_read_b32 v119, a79
v_cvt_pk_bf16_f32 v96, v104, v105
v_cvt_pk_bf16_f32 v97, v106, v107
v_cvt_pk_bf16_f32 v98, v112, v113
v_cvt_pk_bf16_f32 v99, v114, v115
v_cvt_pk_bf16_f32 v100, v108, v109
v_cvt_pk_bf16_f32 v101, v110, v111
v_cvt_pk_bf16_f32 v102, v116, v117
v_cvt_pk_bf16_f32 v103, v118, v119
buffer_store_dwordx4 v[96:99], v94, s[20:23], s41 offen sc1
buffer_store_dwordx4 v[100:103], v94, s[20:23], s41 offen offset:512 sc1
s_add_u32 s41, s40, 395264
v_accvgpr_read_b32 v104, a80
v_accvgpr_read_b32 v105, a81
v_accvgpr_read_b32 v106, a82
v_accvgpr_read_b32 v107, a83
v_accvgpr_read_b32 v108, a84
v_accvgpr_read_b32 v109, a85
v_accvgpr_read_b32 v110, a86
v_accvgpr_read_b32 v111, a87
v_accvgpr_read_b32 v112, a88
v_accvgpr_read_b32 v113, a89
v_accvgpr_read_b32 v114, a90
v_accvgpr_read_b32 v115, a91
v_accvgpr_read_b32 v116, a92
v_accvgpr_read_b32 v117, a93
v_accvgpr_read_b32 v118, a94
v_accvgpr_read_b32 v119, a95
v_cvt_pk_bf16_f32 v96, v104, v105
v_cvt_pk_bf16_f32 v97, v106, v107
v_cvt_pk_bf16_f32 v98, v112, v113
v_cvt_pk_bf16_f32 v99, v114, v115
v_cvt_pk_bf16_f32 v100, v108, v109
v_cvt_pk_bf16_f32 v101, v110, v111
v_cvt_pk_bf16_f32 v102, v116, v117
v_cvt_pk_bf16_f32 v103, v118, v119
buffer_store_dwordx4 v[96:99], v94, s[20:23], s41 offen sc1
buffer_store_dwordx4 v[100:103], v94, s[20:23], s41 offen offset:512 sc1
s_branch L_h_sig_B
s_nop 0
L_h_ev_B:
s_mul_i32 s61, s61, 6144
s_add_u32 s40, s40, s61
s_add_u32 s40, s40, 25165824
s_add_u32 s41, s40, 0
v_accvgpr_read_b32 v104, a0
v_accvgpr_read_b32 v105, a1
v_accvgpr_read_b32 v106, a2
v_accvgpr_read_b32 v107, a3
v_accvgpr_read_b32 v108, a4
v_accvgpr_read_b32 v109, a5
v_accvgpr_read_b32 v110, a6
v_accvgpr_read_b32 v111, a7
v_accvgpr_read_b32 v112, a8
v_accvgpr_read_b32 v113, a9
v_accvgpr_read_b32 v114, a10
v_accvgpr_read_b32 v115, a11
v_accvgpr_read_b32 v116, a12
v_accvgpr_read_b32 v117, a13
v_accvgpr_read_b32 v118, a14
v_accvgpr_read_b32 v119, a15
v_cvt_pk_bf16_f32 v96, v104, v105
v_cvt_pk_bf16_f32 v97, v106, v107
v_cvt_pk_bf16_f32 v98, v112, v113
v_cvt_pk_bf16_f32 v99, v114, v115
v_cvt_pk_bf16_f32 v100, v108, v109
v_cvt_pk_bf16_f32 v101, v110, v111
v_cvt_pk_bf16_f32 v102, v116, v117
v_cvt_pk_bf16_f32 v103, v118, v119
buffer_store_dwordx4 v[96:99], v95, s[20:23], s41 offen sc1
buffer_store_dwordx4 v[100:103], v95, s[20:23], s41 offen offset:512 sc1
s_add_u32 s41, s40, 2048
v_accvgpr_read_b32 v104, a16
v_accvgpr_read_b32 v105, a17
v_accvgpr_read_b32 v106, a18
v_accvgpr_read_b32 v107, a19
v_accvgpr_read_b32 v108, a20
v_accvgpr_read_b32 v109, a21
v_accvgpr_read_b32 v110, a22
v_accvgpr_read_b32 v111, a23
v_accvgpr_read_b32 v112, a24
v_accvgpr_read_b32 v113, a25
v_accvgpr_read_b32 v114, a26
v_accvgpr_read_b32 v115, a27
v_accvgpr_read_b32 v116, a28
v_accvgpr_read_b32 v117, a29
v_accvgpr_read_b32 v118, a30
v_accvgpr_read_b32 v119, a31
v_cvt_pk_bf16_f32 v96, v104, v105
v_cvt_pk_bf16_f32 v97, v106, v107
v_cvt_pk_bf16_f32 v98, v112, v113
v_cvt_pk_bf16_f32 v99, v114, v115
v_cvt_pk_bf16_f32 v100, v108, v109
v_cvt_pk_bf16_f32 v101, v110, v111
v_cvt_pk_bf16_f32 v102, v116, v117
v_cvt_pk_bf16_f32 v103, v118, v119
buffer_store_dwordx4 v[96:99], v95, s[20:23], s41 offen sc1
buffer_store_dwordx4 v[100:103], v95, s[20:23], s41 offen offset:512 sc1
s_add_u32 s41, s40, 4096
v_accvgpr_read_b32 v104, a32
v_accvgpr_read_b32 v105, a33
v_accvgpr_read_b32 v106, a34
v_accvgpr_read_b32 v107, a35
v_accvgpr_read_b32 v108, a36
v_accvgpr_read_b32 v109, a37
v_accvgpr_read_b32 v110, a38
v_accvgpr_read_b32 v111, a39
v_accvgpr_read_b32 v112, a40
v_accvgpr_read_b32 v113, a41
v_accvgpr_read_b32 v114, a42
v_accvgpr_read_b32 v115, a43
v_accvgpr_read_b32 v116, a44
v_accvgpr_read_b32 v117, a45
v_accvgpr_read_b32 v118, a46
v_accvgpr_read_b32 v119, a47
v_cvt_pk_bf16_f32 v96, v104, v105
v_cvt_pk_bf16_f32 v97, v106, v107
v_cvt_pk_bf16_f32 v98, v112, v113
v_cvt_pk_bf16_f32 v99, v114, v115
v_cvt_pk_bf16_f32 v100, v108, v109
v_cvt_pk_bf16_f32 v101, v110, v111
v_cvt_pk_bf16_f32 v102, v116, v117
v_cvt_pk_bf16_f32 v103, v118, v119
buffer_store_dwordx4 v[96:99], v95, s[20:23], s41 offen sc1
buffer_store_dwordx4 v[100:103], v95, s[20:23], s41 offen offset:512 sc1
s_add_u32 s41, s40, 393216
v_accvgpr_read_b32 v104, a48
v_accvgpr_read_b32 v105, a49
v_accvgpr_read_b32 v106, a50
v_accvgpr_read_b32 v107, a51
v_accvgpr_read_b32 v108, a52
v_accvgpr_read_b32 v109, a53
v_accvgpr_read_b32 v110, a54
v_accvgpr_read_b32 v111, a55
v_accvgpr_read_b32 v112, a56
v_accvgpr_read_b32 v113, a57
v_accvgpr_read_b32 v114, a58
v_accvgpr_read_b32 v115, a59
v_accvgpr_read_b32 v116, a60
v_accvgpr_read_b32 v117, a61
v_accvgpr_read_b32 v118, a62
v_accvgpr_read_b32 v119, a63
v_cvt_pk_bf16_f32 v96, v104, v105
v_cvt_pk_bf16_f32 v97, v106, v107
v_cvt_pk_bf16_f32 v98, v112, v113
v_cvt_pk_bf16_f32 v99, v114, v115
v_cvt_pk_bf16_f32 v100, v108, v109
v_cvt_pk_bf16_f32 v101, v110, v111
v_cvt_pk_bf16_f32 v102, v116, v117
v_cvt_pk_bf16_f32 v103, v118, v119
buffer_store_dwordx4 v[96:99], v95, s[20:23], s41 offen sc1
buffer_store_dwordx4 v[100:103], v95, s[20:23], s41 offen offset:512 sc1
s_add_u32 s41, s40, 395264
v_accvgpr_read_b32 v104, a64
v_accvgpr_read_b32 v105, a65
v_accvgpr_read_b32 v106, a66
v_accvgpr_read_b32 v107, a67
v_accvgpr_read_b32 v108, a68
v_accvgpr_read_b32 v109, a69
v_accvgpr_read_b32 v110, a70
v_accvgpr_read_b32 v111, a71
v_accvgpr_read_b32 v112, a72
v_accvgpr_read_b32 v113, a73
v_accvgpr_read_b32 v114, a74
v_accvgpr_read_b32 v115, a75
v_accvgpr_read_b32 v116, a76
v_accvgpr_read_b32 v117, a77
v_accvgpr_read_b32 v118, a78
v_accvgpr_read_b32 v119, a79
v_cvt_pk_bf16_f32 v96, v104, v105
v_cvt_pk_bf16_f32 v97, v106, v107
v_cvt_pk_bf16_f32 v98, v112, v113
v_cvt_pk_bf16_f32 v99, v114, v115
v_cvt_pk_bf16_f32 v100, v108, v109
v_cvt_pk_bf16_f32 v101, v110, v111
v_cvt_pk_bf16_f32 v102, v116, v117
v_cvt_pk_bf16_f32 v103, v118, v119
buffer_store_dwordx4 v[96:99], v95, s[20:23], s41 offen sc1
buffer_store_dwordx4 v[100:103], v95, s[20:23], s41 offen offset:512 sc1
s_add_u32 s41, s40, 397312
v_accvgpr_read_b32 v104, a80
v_accvgpr_read_b32 v105, a81
v_accvgpr_read_b32 v106, a82
v_accvgpr_read_b32 v107, a83
v_accvgpr_read_b32 v108, a84
v_accvgpr_read_b32 v109, a85
v_accvgpr_read_b32 v110, a86
v_accvgpr_read_b32 v111, a87
v_accvgpr_read_b32 v112, a88
v_accvgpr_read_b32 v113, a89
v_accvgpr_read_b32 v114, a90
v_accvgpr_read_b32 v115, a91
v_accvgpr_read_b32 v116, a92
v_accvgpr_read_b32 v117, a93
v_accvgpr_read_b32 v118, a94
v_accvgpr_read_b32 v119, a95
v_cvt_pk_bf16_f32 v96, v104, v105
v_cvt_pk_bf16_f32 v97, v106, v107
v_cvt_pk_bf16_f32 v98, v112, v113
v_cvt_pk_bf16_f32 v99, v114, v115
v_cvt_pk_bf16_f32 v100, v108, v109
v_cvt_pk_bf16_f32 v101, v110, v111
v_cvt_pk_bf16_f32 v102, v116, v117
v_cvt_pk_bf16_f32 v103, v118, v119
buffer_store_dwordx4 v[96:99], v95, s[20:23], s41 offen sc1
buffer_store_dwordx4 v[100:103], v95, s[20:23], s41 offen offset:512 sc1
s_nop 1
L_h_sig_B:
s_lshl_b32 s60, s29, 9
s_lshl_b32 s61, s63, 2
s_add_u32 s60, s60, s61
s_add_u32 s60, s60, 178466816
s_waitcnt vmcnt(0)
s_barrier
s_cmp_lg_u32 s28, 0
s_cbranch_scc1 L_sigf_8_B
s_mov_b64 exec, 1
v_lshlrev_b32 v17, 5, v1
v_add_u32 v17, s60, v17
buffer_store_dword v16, v17, s[20:23], 0 offen sc1
s_mov_b64 exec, -1
L_sigf_8_B:
s_lshl_b32 s45, s28, 12
s_mul_i32 s46, s28, 3072
s_add_u32 s46, s46, 16384
v_lshrrev_b32 v19, 2, v1
v_and_b32 v4, 3, v1
v_lshrrev_b32 v5, 4, v1
v_xor_b32 v4, v4, v5
v_lshlrev_b32 v20, 4, v4
s_mul_i32 s40, s28, 192
s_add_u32 s40, s40, 0
v_add_u32 v4, s40, v1
s_mov_b32 s41, 43691
v_mul_u32_u24 v5, s41, v4
v_lshrrev_b32 v25, 20, v5
v_mul_u32_u24 v5, 24, v25
v_sub_u32 v5, v4, v5
v_bfe_u32 v6, v25, 1, 1
v_lshlrev_b32 v6, 2, v6
v_xor_b32 v5, v5, v6
v_lshlrev_b32 v28, 4, v5
s_mul_i32 s40, s28, 192
s_add_u32 s40, s40, 64
v_add_u32 v4, s40, v1
s_mov_b32 s41, 43691
v_mul_u32_u24 v5, s41, v4
v_lshrrev_b32 v26, 20, v5
v_mul_u32_u24 v5, 24, v26
v_sub_u32 v5, v4, v5
v_bfe_u32 v6, v26, 1, 1
v_lshlrev_b32 v6, 2, v6
v_xor_b32 v5, v5, v6
v_lshlrev_b32 v29, 4, v5
s_mul_i32 s40, s28, 192
s_add_u32 s40, s40, 128
v_add_u32 v4, s40, v1
s_mov_b32 s41, 43691
v_mul_u32_u24 v5, s41, v4
v_lshrrev_b32 v27, 20, v5
v_mul_u32_u24 v5, 24, v27
v_sub_u32 v5, v4, v5
v_bfe_u32 v6, v27, 1, 1
v_lshlrev_b32 v6, 2, v6
v_xor_b32 v5, v5, v6
v_lshlrev_b32 v30, 4, v5
v_and_b32 v4, 31, v1
v_lshrrev_b32 v5, 5, v1
v_bfe_u32 v6, v4, 2, 2
s_lshr_b32 s40, s28, 1
s_mul_i32 s40, s40, 8192
v_add_u32 v7, 0, v5
v_xor_b32 v7, v7, v6
v_lshlrev_b32 v7, 4, v7
v_lshl_add_u32 v7, v4, 6, v7
v_add_u32 v34, s40, v7
v_add_u32 v7, 2, v5
v_xor_b32 v7, v7, v6
v_lshlrev_b32 v7, 4, v7
v_lshl_add_u32 v7, v4, 6, v7
v_add_u32 v35, s40, v7
v_and_b32 v4, 15, v1
v_lshrrev_b32 v5, 4, v1
v_and_b32 v6, 1, v5
v_lshrrev_b32 v5, 1, v5
v_bfe_u32 v7, v4, 1, 1
v_lshl_add_u32 v6, v6, 1, v7
s_and_b32 s40, s28, 1
s_mul_i32 s40, s40, 12
v_add_u32 v6, s40, v6
v_bfe_u32 v8, v4, 3, 1
v_lshlrev_b32 v8, 2, v8
v_and_b32 v9, 1, v4
v_lshlrev_b32 v9, 3, v9
v_lshrrev_b32 v10, 2, v4
v_lshlrev_b32 v11, 3, v5
v_add_u32 v11, 0, v11
v_add_u32 v11, v11, v10
v_mul_u32_u24 v11, 384, v11
v_add_u32 v11, v11, v9
v_add_u32 v12, 0, v6
v_xor_b32 v12, v12, v8
v_lshl_add_u32 v36, v12, 4, v11
v_add_u32 v36, 16384, v36
v_add_u32 v12, 4, v6
v_xor_b32 v12, v12, v8
v_lshl_add_u32 v40, v12, 4, v11
v_add_u32 v40, 16384, v40
v_lshlrev_b32 v11, 3, v5
v_add_u32 v11, 4, v11
v_add_u32 v11, v11, v10
v_mul_u32_u24 v11, 384, v11
v_add_u32 v11, v11, v9
v_add_u32 v12, 0, v6
v_xor_b32 v12, v12, v8
v_lshl_add_u32 v37, v12, 4, v11
v_add_u32 v37, 16384, v37
v_add_u32 v12, 4, v6
v_xor_b32 v12, v12, v8
v_lshl_add_u32 v41, v12, 4, v11
v_add_u32 v41, 16384, v41
v_lshlrev_b32 v11, 3, v5
v_add_u32 v11, 16, v11
v_add_u32 v11, v11, v10
v_mul_u32_u24 v11, 384, v11
v_add_u32 v11, v11, v9
v_add_u32 v12, 0, v6
v_xor_b32 v12, v12, v8
v_lshl_add_u32 v38, v12, 4, v11
v_add_u32 v38, 16384, v38
v_add_u32 v12, 4, v6
v_xor_b32 v12, v12, v8
v_lshl_add_u32 v42, v12, 4, v11
v_add_u32 v42, 16384, v42
v_lshlrev_b32 v11, 3, v5
v_add_u32 v11, 20, v11
v_add_u32 v11, v11, v10
v_mul_u32_u24 v11, 384, v11
v_add_u32 v11, v11, v9
v_add_u32 v12, 0, v6
v_xor_b32 v12, v12, v8
v_lshl_add_u32 v39, v12, 4, v11
v_add_u32 v39, 16384, v39
v_add_u32 v12, 4, v6
v_xor_b32 v12, v12, v8
v_lshl_add_u32 v43, v12, 4, v11
v_add_u32 v43, 16384, v43
v_add_u32 v100, 57344, v34
v_add_u32 v101, 57344, v35
v_add_u32 v102, 57344, v36
v_add_u32 v103, 57344, v37
v_add_u32 v104, 57344, v38
v_add_u32 v105, 57344, v39
v_add_u32 v106, 57344, v40
v_add_u32 v107, 57344, v41
v_add_u32 v108, 57344, v42
v_add_u32 v109, 57344, v43
v_bfe_u32 v4, v1, 4, 1
v_lshrrev_b32 v5, 5, v1
v_and_b32 v6, 15, v1
v_lshlrev_b32 v7, 8, v5
v_lshl_add_u32 v7, v6, 4, v7
v_mul_u32_u24 v8, 6144, v4
v_add_u32 v110, v8, v7
v_lshl_add_u32 v111, v4, 10, v7
v_and_b32 v8, 31, v1
v_bfe_u32 v9, v8, 2, 2
v_xor_b32 v10, v5, v9
v_lshlrev_b32 v10, 4, v10
v_lshl_add_u32 v112, v8, 6, v10
v_add_u32 v10, 2, v5
v_xor_b32 v10, v10, v9
v_lshlrev_b32 v10, 4, v10
v_lshl_add_u32 v148, v8, 6, v10
s_mov_b32 s50, s63
s_cmp_ge_u32 s50, 96
s_cbranch_scc1 L_g1_done_B
s_cmp_ge_u32 s50, 56
s_cbranch_scc1 L_g1_dqa_B
s_mov_b32 s84, 1
s_mov_b32 s60, s50
s_cmp_lt_u32 s50, 8
s_cbranch_scc1 L_g1_d0a_B
s_sub_u32 s61, s50, 8
s_mul_i32 s60, s61, 43
s_lshr_b32 s60, s60, 8
s_mul_i32 s84, s60, 6
s_sub_u32 s84, s61, s84
s_add_u32 s84, s84, 2
L_g1_d0a_B:
s_lshr_b32 s86, s60, 2
s_and_b32 s60, s60, 3
s_lshl_b32 s85, s29, 2
s_add_u32 s85, s85, s60
s_branch L_g1_dda_B
L_g1_dqa_B:
s_cmp_ge_u32 s50, 88
s_cbranch_scc1 L_g1_dha_B
s_sub_u32 s60, s50, 56
s_and_b32 s84, s60, 7
s_lshr_b32 s60, s60, 3
s_lshl_b32 s85, s29, 2
s_add_u32 s85, s85, s60
s_mov_b32 s86, 2
s_branch L_g1_dda_B
L_g1_dha_B:
s_sub_u32 s84, s50, 88
s_mov_b32 s85, s29
s_mov_b32 s86, 3
L_g1_dda_B:
s_mov_b32 s56, 12288
s_mov_b32 s34, 7864320
s_mov_b32 s35, 0x00020000
s_mov_b32 s32, s10
s_mov_b32 s33, s11
s_cmp_lg_u32 s86, 1
s_cbranch_scc1 L_g1_n1a_B
s_mov_b32 s32, s12
s_mov_b32 s33, s13
L_g1_n1a_B:
s_cmp_lg_u32 s86, 2
s_cbranch_scc1 L_g1_n2a_B
s_mov_b32 s32, s8
s_mov_b32 s33, s9
L_g1_n2a_B:
s_cmp_lg_u32 s86, 3
s_cbranch_scc1 L_g1_n3a_B
s_mov_b32 s32, s16
s_mov_b32 s33, s17
s_mov_b32 s56, 3072
s_mov_b32 s34, 1966080
L_g1_n3a_B:
s_mov_b32 s55, 1280
s_lshl_b32 s57, s56, 5
s_mul_i32 s54, s85, 384
s_mul_i32 s53, s84, 327680
s_add_u32 s53, s53, 90910720
s_mul_i32 s40, s28, 4096
s_add_u32 s40, s40, 0
v_lshlrev_b32 v4, 4, v1
v_add_u32 v21, s40, v4
s_mul_i32 s40, s28, 4096
s_add_u32 s40, s40, 1024
v_lshlrev_b32 v4, 4, v1
v_add_u32 v22, s40, v4
s_mul_i32 s40, s28, 4096
s_add_u32 s40, s40, 2048
v_lshlrev_b32 v4, 4, v1
v_add_u32 v23, s40, v4
s_mul_i32 s40, s28, 4096
s_add_u32 s40, s40, 3072
v_lshlrev_b32 v4, 4, v1
v_add_u32 v24, s40, v4
v_mul_lo_u32 v4, v25, s56
v_add_u32 v31, v4, v28
v_mul_lo_u32 v4, v26, s56
v_add_u32 v32, v4, v29
v_mul_lo_u32 v4, v27, s56
v_add_u32 v33, v4, v30
s_add_u32 m0, s45, 0
s_nop 0
buffer_load_dwordx4 v21, s[20:23], s53 offen lds
s_add_u32 m0, s45, 1024
s_nop 0
buffer_load_dwordx4 v22, s[20:23], s53 offen lds
s_add_u32 m0, s45, 2048
s_nop 0
buffer_load_dwordx4 v23, s[20:23], s53 offen lds
s_add_u32 m0, s45, 3072
s_nop 0
buffer_load_dwordx4 v24, s[20:23], s53 offen lds
s_add_u32 m0, s46, 0
s_nop 0
buffer_load_dwordx4 v31, s[32:35], s54 offen lds
s_add_u32 m0, s46, 1024
s_nop 0
buffer_load_dwordx4 v32, s[32:35], s54 offen lds
s_add_u32 m0, s46, 2048
s_nop 0
buffer_load_dwordx4 v33, s[32:35], s54 offen lds
s_add_u32 s53, s53, 16384
s_add_u32 s54, s54, s57
s_add_u32 m0, s45, 28672
s_nop 0
buffer_load_dwordx4 v21, s[20:23], s53 offen lds
s_add_u32 m0, s45, 29696
s_nop 0
buffer_load_dwordx4 v22, s[20:23], s53 offen lds
s_add_u32 m0, s45, 30720
s_nop 0
buffer_load_dwordx4 v23, s[20:23], s53 offen lds
s_add_u32 m0, s45, 31744
s_nop 0
buffer_load_dwordx4 v24, s[20:23], s53 offen lds
s_add_u32 m0, s46, 28672
s_nop 0
buffer_load_dwordx4 v31, s[32:35], s54 offen lds
s_add_u32 m0, s46, 29696
s_nop 0
buffer_load_dwordx4 v32, s[32:35], s54 offen lds
s_add_u32 m0, s46, 30720
s_nop 0
buffer_load_dwordx4 v33, s[32:35], s54 offen lds
s_add_u32 s53, s53, 16384
s_add_u32 s54, s54, s57
s_add_u32 m0, s45, 57344
s_nop 0
buffer_load_dwordx4 v21, s[20:23], s53 offen lds
s_add_u32 m0, s45, 58368
s_nop 0
buffer_load_dwordx4 v22, s[20:23], s53 offen lds
s_add_u32 m0, s45, 59392
s_nop 0
buffer_load_dwordx4 v23, s[20:23], s53 offen lds
s_add_u32 m0, s45, 60416
s_nop 0
buffer_load_dwordx4 v24, s[20:23], s53 offen lds
s_add_u32 m0, s46, 57344
s_nop 0
buffer_load_dwordx4 v31, s[32:35], s54 offen lds
s_add_u32 m0, s46, 58368
s_nop 0
buffer_load_dwordx4 v32, s[32:35], s54 offen lds
s_add_u32 m0, s46, 59392
s_nop 0
buffer_load_dwordx4 v33, s[32:35], s54 offen lds
s_add_u32 s53, s53, 16384
s_add_u32 s54, s54, s57
s_add_u32 m0, s45, 86016
s_nop 0
buffer_load_dwordx4 v21, s[20:23], s53 offen lds
s_add_u32 m0, s45, 87040
s_nop 0
buffer_load_dwordx4 v22, s[20:23], s53 offen lds
s_add_u32 m0, s45, 88064
s_nop 0
buffer_load_dwordx4 v23, s[20:23], s53 offen lds
s_add_u32 m0, s45, 89088
s_nop 0
buffer_load_dwordx4 v24, s[20:23], s53 offen lds
s_add_u32 m0, s46, 86016
s_nop 0
buffer_load_dwordx4 v31, s[32:35], s54 offen lds
s_add_u32 m0, s46, 87040
s_nop 0
buffer_load_dwordx4 v32, s[32:35], s54 offen lds
s_add_u32 m0, s46, 88064
s_nop 0
buffer_load_dwordx4 v33, s[32:35], s54 offen lds
s_add_u32 s53, s53, 16384
s_add_u32 s54, s54, s57
L_g1_task_B:
s_mov_b32 s52, s84
s_mov_b32 s59, s85
s_mov_b32 s58, s86
s_cmp_eq_u32 s58, 1
s_cbranch_scc1 L_g1_v_B
s_waitcnt vmcnt(21)
s_barrier
ds_read_b128 v[44:47], v34 offset:0
ds_read_b128 v[48:51], v34 offset:2048
ds_read_b128 v[52:55], v34 offset:4096
ds_read_b128 v[56:59], v34 offset:6144
ds_read_b64_tr_b16 v[76:77], v36 offset:0
ds_read_b64_tr_b16 v[78:79], v37 offset:0
ds_read_b64_tr_b16 v[80:81], v40 offset:0
ds_read_b64_tr_b16 v[82:83], v41 offset:0
ds_read_b64_tr_b16 v[84:85], v36 offset:128
ds_read_b64_tr_b16 v[86:87], v37 offset:128
s_waitcnt lgkmcnt(0)
v_mfma_f32_32x32x16_bf16 a[0:15], v[76:79], v[44:47], 0
ds_read_b128 v[60:63], v35 offset:0
v_mfma_f32_32x32x16_bf16 a[16:31], v[80:83], v[44:47], 0
ds_read_b128 v[64:67], v35 offset:2048
v_mfma_f32_32x32x16_bf16 a[32:47], v[84:87], v[44:47], 0
ds_read_b128 v[68:71], v35 offset:4096
v_mfma_f32_32x32x16_bf16 a[48:63], v[76:79], v[48:51], 0
ds_read_b128 v[72:75], v35 offset:6144
v_mfma_f32_32x32x16_bf16 a[64:79], v[80:83], v[48:51], 0
ds_read_b64_tr_b16 v[88:89], v38 offset:0
ds_read_b64_tr_b16 v[90:91], v39 offset:0
v_mfma_f32_32x32x16_bf16 a[80:95], v[84:87], v[48:51], 0
ds_read_b64_tr_b16 v[92:93], v42 offset:0
ds_read_b64_tr_b16 v[94:95], v43 offset:0
v_mfma_f32_32x32x16_bf16 a[96:111], v[76:79], v[52:55], 0
ds_read_b64_tr_b16 v[96:97], v38 offset:128
ds_read_b64_tr_b16 v[98:99], v39 offset:128
v_mfma_f32_32x32x16_bf16 a[112:127], v[80:83], v[52:55], 0
v_mfma_f32_32x32x16_bf16 a[128:143], v[84:87], v[52:55], 0
v_mfma_f32_32x32x16_bf16 a[144:159], v[76:79], v[56:59], 0
v_mfma_f32_32x32x16_bf16 a[160:175], v[80:83], v[56:59], 0
v_mfma_f32_32x32x16_bf16 a[176:191], v[84:87], v[56:59], 0
s_waitcnt lgkmcnt(0)
s_waitcnt vmcnt(14)
s_barrier
v_mfma_f32_32x32x16_bf16 a[0:15], v[88:91], v[60:63], a[0:15]
ds_read_b128 v[44:47], v34 offset:28672
ds_read_b128 v[48:51], v34 offset:30720
v_mfma_f32_32x32x16_bf16 a[16:31], v[92:95], v[60:63], a[16:31]
ds_read_b128 v[52:55], v34 offset:32768
ds_read_b128 v[56:59], v34 offset:34816
v_mfma_f32_32x32x16_bf16 a[32:47], v[96:99], v[60:63], a[32:47]
ds_read_b64_tr_b16 v[76:77], v36 offset:28672
ds_read_b64_tr_b16 v[78:79], v37 offset:28672
ds_read_b64_tr_b16 v[80:81], v40 offset:28672
ds_read_b64_tr_b16 v[82:83], v41 offset:28672
v_mfma_f32_32x32x16_bf16 a[48:63], v[88:91], v[64:67], a[48:63]
ds_read_b64_tr_b16 v[84:85], v36 offset:28800
ds_read_b64_tr_b16 v[86:87], v37 offset:28800
s_add_u32 m0, s45, 0
s_nop 0
buffer_load_dwordx4 v21, s[20:23], s53 offen lds
v_mfma_f32_32x32x16_bf16 a[64:79], v[92:95], v[64:67], a[64:79]
s_add_u32 m0, s45, 1024
s_nop 0
buffer_load_dwordx4 v22, s[20:23], s53 offen lds
s_add_u32 m0, s45, 2048
s_nop 0
buffer_load_dwordx4 v23, s[20:23], s53 offen lds
v_mfma_f32_32x32x16_bf16 a[80:95], v[96:99], v[64:67], a[80:95]
s_add_u32 m0, s45, 3072
s_nop 0
buffer_load_dwordx4 v24, s[20:23], s53 offen lds
s_add_u32 m0, s46, 0
s_nop 0
buffer_load_dwordx4 v31, s[32:35], s54 offen lds
v_mfma_f32_32x32x16_bf16 a[96:111], v[88:91], v[68:71], a[96:111]
s_add_u32 m0, s46, 1024
s_nop 0
buffer_load_dwordx4 v32, s[32:35], s54 offen lds
s_add_u32 m0, s46, 2048
s_nop 0
buffer_load_dwordx4 v33, s[32:35], s54 offen lds
s_add_u32 s53, s53, 16384
s_add_u32 s54, s54, s57
v_mfma_f32_32x32x16_bf16 a[112:127], v[92:95], v[68:71], a[112:127]
v_mfma_f32_32x32x16_bf16 a[128:143], v[96:99], v[68:71], a[128:143]
v_mfma_f32_32x32x16_bf16 a[144:159], v[88:91], v[72:75], a[144:159]
v_mfma_f32_32x32x16_bf16 a[160:175], v[92:95], v[72:75], a[160:175]
v_mfma_f32_32x32x16_bf16 a[176:191], v[96:99], v[72:75], a[176:191]
s_waitcnt lgkmcnt(0)
v_mfma_f32_32x32x16_bf16 a[0:15], v[76:79], v[44:47], a[0:15]
ds_read_b128 v[60:63], v35 offset:28672
v_mfma_f32_32x32x16_bf16 a[16:31], v[80:83], v[44:47], a[16:31]
ds_read_b128 v[64:67], v35 offset:30720
v_mfma_f32_32x32x16_bf16 a[32:47], v[84:87], v[44:47], a[32:47]
ds_read_b128 v[68:71], v35 offset:32768
v_mfma_f32_32x32x16_bf16 a[48:63], v[76:79], v[48:51], a[48:63]
ds_read_b128 v[72:75], v35 offset:34816
v_mfma_f32_32x32x16_bf16 a[64:79], v[80:83], v[48:51], a[64:79]
ds_read_b64_tr_b16 v[88:89], v38 offset:28672
ds_read_b64_tr_b16 v[90:91], v39 offset:28672
v_mfma_f32_32x32x16_bf16 a[80:95], v[84:87], v[48:51], a[80:95]
ds_read_b64_tr_b16 v[92:93], v42 offset:28672
ds_read_b64_tr_b16 v[94:95], v43 offset:28672
v_mfma_f32_32x32x16_bf16 a[96:111], v[76:79], v[52:55], a[96:111]
ds_read_b64_tr_b16 v[96:97], v38 offset:28800
ds_read_b64_tr_b16 v[98:99], v39 offset:28800
v_mfma_f32_32x32x16_bf16 a[112:127], v[80:83], v[52:55], a[112:127]
v_mfma_f32_32x32x16_bf16 a[128:143], v[84:87], v[52:55], a[128:143]
v_mfma_f32_32x32x16_bf16 a[144:159], v[76:79], v[56:59], a[144:159]
v_mfma_f32_32x32x16_bf16 a[160:175], v[80:83], v[56:59], a[160:175]
v_mfma_f32_32x32x16_bf16 a[176:191], v[84:87], v[56:59], a[176:191]
s_waitcnt lgkmcnt(0)
s_waitcnt vmcnt(14)
s_barrier
v_mfma_f32_32x32x16_bf16 a[0:15], v[88:91], v[60:63], a[0:15]
ds_read_b128 v[44:47], v100 offset:0
ds_read_b128 v[48:51], v100 offset:2048
v_mfma_f32_32x32x16_bf16 a[16:31], v[92:95], v[60:63], a[16:31]
ds_read_b128 v[52:55], v100 offset:4096
ds_read_b128 v[56:59], v100 offset:6144
v_mfma_f32_32x32x16_bf16 a[32:47], v[96:99], v[60:63], a[32:47]
ds_read_b64_tr_b16 v[76:77], v102 offset:0
ds_read_b64_tr_b16 v[78:79], v103 offset:0
ds_read_b64_tr_b16 v[80:81], v106 offset:0
ds_read_b64_tr_b16 v[82:83], v107 offset:0
v_mfma_f32_32x32x16_bf16 a[48:63], v[88:91], v[64:67], a[48:63]
ds_read_b64_tr_b16 v[84:85], v102 offset:128
ds_read_b64_tr_b16 v[86:87], v103 offset:128
s_add_u32 m0, s45, 28672
s_nop 0
buffer_load_dwordx4 v21, s[20:23], s53 offen lds
v_mfma_f32_32x32x16_bf16 a[64:79], v[92:95], v[64:67], a[64:79]
s_add_u32 m0, s45, 29696
s_nop 0
buffer_load_dwordx4 v22, s[20:23], s53 offen lds
s_add_u32 m0, s45, 30720
s_nop 0
buffer_load_dwordx4 v23, s[20:23], s53 offen lds
v_mfma_f32_32x32x16_bf16 a[80:95], v[96:99], v[64:67], a[80:95]
s_add_u32 m0, s45, 31744
s_nop 0
buffer_load_dwordx4 v24, s[20:23], s53 offen lds
s_add_u32 m0, s46, 28672
s_nop 0
buffer_load_dwordx4 v31, s[32:35], s54 offen lds
v_mfma_f32_32x32x16_bf16 a[96:111], v[88:91], v[68:71], a[96:111]
s_add_u32 m0, s46, 29696
s_nop 0
buffer_load_dwordx4 v32, s[32:35], s54 offen lds
s_add_u32 m0, s46, 30720
s_nop 0
buffer_load_dwordx4 v33, s[32:35], s54 offen lds
s_add_u32 s53, s53, 16384
s_add_u32 s54, s54, s57
v_mfma_f32_32x32x16_bf16 a[112:127], v[92:95], v[68:71], a[112:127]
v_mfma_f32_32x32x16_bf16 a[128:143], v[96:99], v[68:71], a[128:143]
v_mfma_f32_32x32x16_bf16 a[144:159], v[88:91], v[72:75], a[144:159]
v_mfma_f32_32x32x16_bf16 a[160:175], v[92:95], v[72:75], a[160:175]
v_mfma_f32_32x32x16_bf16 a[176:191], v[96:99], v[72:75], a[176:191]
s_waitcnt lgkmcnt(0)
v_mfma_f32_32x32x16_bf16 a[0:15], v[76:79], v[44:47], a[0:15]
ds_read_b128 v[60:63], v101 offset:0
v_mfma_f32_32x32x16_bf16 a[16:31], v[80:83], v[44:47], a[16:31]
ds_read_b128 v[64:67], v101 offset:2048
v_mfma_f32_32x32x16_bf16 a[32:47], v[84:87], v[44:47], a[32:47]
ds_read_b128 v[68:71], v101 offset:4096
v_mfma_f32_32x32x16_bf16 a[48:63], v[76:79], v[48:51], a[48:63]
ds_read_b128 v[72:75], v101 offset:6144
v_mfma_f32_32x32x16_bf16 a[64:79], v[80:83], v[48:51], a[64:79]
ds_read_b64_tr_b16 v[88:89], v104 offset:0
ds_read_b64_tr_b16 v[90:91], v105 offset:0
v_mfma_f32_32x32x16_bf16 a[80:95], v[84:87], v[48:51], a[80:95]
ds_read_b64_tr_b16 v[92:93], v108 offset:0
ds_read_b64_tr_b16 v[94:95], v109 offset:0
v_mfma_f32_32x32x16_bf16 a[96:111], v[76:79], v[52:55], a[96:111]
ds_read_b64_tr_b16 v[96:97], v104 offset:128
ds_read_b64_tr_b16 v[98:99], v105 offset:128
v_mfma_f32_32x32x16_bf16 a[112:127], v[80:83], v[52:55], a[112:127]
v_mfma_f32_32x32x16_bf16 a[128:143], v[84:87], v[52:55], a[128:143]
v_mfma_f32_32x32x16_bf16 a[144:159], v[76:79], v[56:59], a[144:159]
v_mfma_f32_32x32x16_bf16 a[160:175], v[80:83], v[56:59], a[160:175]
v_mfma_f32_32x32x16_bf16 a[176:191], v[84:87], v[56:59], a[176:191]
s_waitcnt lgkmcnt(0)
s_waitcnt vmcnt(14)
s_barrier
v_mfma_f32_32x32x16_bf16 a[0:15], v[88:91], v[60:63], a[0:15]
ds_read_b128 v[44:47], v100 offset:28672
ds_read_b128 v[48:51], v100 offset:30720
v_mfma_f32_32x32x16_bf16 a[16:31], v[92:95], v[60:63], a[16:31]
ds_read_b128 v[52:55], v100 offset:32768
ds_read_b128 v[56:59], v100 offset:34816
v_mfma_f32_32x32x16_bf16 a[32:47], v[96:99], v[60:63], a[32:47]
ds_read_b64_tr_b16 v[76:77], v102 offset:28672
ds_read_b64_tr_b16 v[78:79], v103 offset:28672
ds_read_b64_tr_b16 v[80:81], v106 offset:28672
ds_read_b64_tr_b16 v[82:83], v107 offset:28672
v_mfma_f32_32x32x16_bf16 a[48:63], v[88:91], v[64:67], a[48:63]
ds_read_b64_tr_b16 v[84:85], v102 offset:28800
ds_read_b64_tr_b16 v[86:87], v103 offset:28800
s_add_u32 m0, s45, 57344
s_nop 0
buffer_load_dwordx4 v21, s[20:23], s53 offen lds
v_mfma_f32_32x32x16_bf16 a[64:79], v[92:95], v[64:67], a[64:79]
s_add_u32 m0, s45, 58368
s_nop 0
buffer_load_dwordx4 v22, s[20:23], s53 offen lds
s_add_u32 m0, s45, 59392
s_nop 0
buffer_load_dwordx4 v23, s[20:23], s53 offen lds
v_mfma_f32_32x32x16_bf16 a[80:95], v[96:99], v[64:67], a[80:95]
s_add_u32 m0, s45, 60416
s_nop 0
buffer_load_dwordx4 v24, s[20:23], s53 offen lds
s_add_u32 m0, s46, 57344
s_nop 0
buffer_load_dwordx4 v31, s[32:35], s54 offen lds
v_mfma_f32_32x32x16_bf16 a[96:111], v[88:91], v[68:71], a[96:111]
s_add_u32 m0, s46, 58368
s_nop 0
buffer_load_dwordx4 v32, s[32:35], s54 offen lds
s_add_u32 m0, s46, 59392
s_nop 0
buffer_load_dwordx4 v33, s[32:35], s54 offen lds
s_add_u32 s53, s53, 16384
s_add_u32 s54, s54, s57
v_mfma_f32_32x32x16_bf16 a[112:127], v[92:95], v[68:71], a[112:127]
v_mfma_f32_32x32x16_bf16 a[128:143], v[96:99], v[68:71], a[128:143]
v_mfma_f32_32x32x16_bf16 a[144:159], v[88:91], v[72:75], a[144:159]
v_mfma_f32_32x32x16_bf16 a[160:175], v[92:95], v[72:75], a[160:175]
v_mfma_f32_32x32x16_bf16 a[176:191], v[96:99], v[72:75], a[176:191]
s_waitcnt lgkmcnt(0)
v_mfma_f32_32x32x16_bf16 a[0:15], v[76:79], v[44:47], a[0:15]
ds_read_b128 v[60:63], v101 offset:28672
v_mfma_f32_32x32x16_bf16 a[16:31], v[80:83], v[44:47], a[16:31]
ds_read_b128 v[64:67], v101 offset:30720
v_mfma_f32_32x32x16_bf16 a[32:47], v[84:87], v[44:47], a[32:47]
ds_read_b128 v[68:71], v101 offset:32768
v_mfma_f32_32x32x16_bf16 a[48:63], v[76:79], v[48:51], a[48:63]
ds_read_b128 v[72:75], v101 offset:34816
v_mfma_f32_32x32x16_bf16 a[64:79], v[80:83], v[48:51], a[64:79]
ds_read_b64_tr_b16 v[88:89], v104 offset:28672
ds_read_b64_tr_b16 v[90:91], v105 offset:28672
v_mfma_f32_32x32x16_bf16 a[80:95], v[84:87], v[48:51], a[80:95]
ds_read_b64_tr_b16 v[92:93], v108 offset:28672
ds_read_b64_tr_b16 v[94:95], v109 offset:28672
v_mfma_f32_32x32x16_bf16 a[96:111], v[76:79], v[52:55], a[96:111]
ds_read_b64_tr_b16 v[96:97], v104 offset:28800
ds_read_b64_tr_b16 v[98:99], v105 offset:28800
v_mfma_f32_32x32x16_bf16 a[112:127], v[80:83], v[52:55], a[112:127]
v_mfma_f32_32x32x16_bf16 a[128:143], v[84:87], v[52:55], a[128:143]
v_mfma_f32_32x32x16_bf16 a[144:159], v[76:79], v[56:59], a[144:159]
v_mfma_f32_32x32x16_bf16 a[160:175], v[80:83], v[56:59], a[160:175]
v_mfma_f32_32x32x16_bf16 a[176:191], v[84:87], v[56:59], a[176:191]
s_waitcnt lgkmcnt(0)
s_waitcnt vmcnt(14)
s_barrier
v_mfma_f32_32x32x16_bf16 a[0:15], v[88:91], v[60:63], a[0:15]
ds_read_b128 v[44:47], v34 offset:0
ds_read_b128 v[48:51], v34 offset:2048
v_mfma_f32_32x32x16_bf16 a[16:31], v[92:95], v[60:63], a[16:31]
ds_read_b128 v[52:55], v34 offset:4096
ds_read_b128 v[56:59], v34 offset:6144
v_mfma_f32_32x32x16_bf16 a[32:47], v[96:99], v[60:63], a[32:47]
ds_read_b64_tr_b16 v[76:77], v36 offset:0
ds_read_b64_tr_b16 v[78:79], v37 offset:0
ds_read_b64_tr_b16 v[80:81], v40 offset:0
ds_read_b64_tr_b16 v[82:83], v41 offset:0
v_mfma_f32_32x32x16_bf16 a[48:63], v[88:91], v[64:67], a[48:63]
ds_read_b64_tr_b16 v[84:85], v36 offset:128
ds_read_b64_tr_b16 v[86:87], v37 offset:128
s_add_u32 m0, s45, 86016
s_nop 0
buffer_load_dwordx4 v21, s[20:23], s53 offen lds
v_mfma_f32_32x32x16_bf16 a[64:79], v[92:95], v[64:67], a[64:79]
s_add_u32 m0, s45, 87040
s_nop 0
buffer_load_dwordx4 v22, s[20:23], s53 offen lds
s_add_u32 m0, s45, 88064
s_nop 0
buffer_load_dwordx4 v23, s[20:23], s53 offen lds
v_mfma_f32_32x32x16_bf16 a[80:95], v[96:99], v[64:67], a[80:95]
s_add_u32 m0, s45, 89088
s_nop 0
buffer_load_dwordx4 v24, s[20:23], s53 offen lds
s_add_u32 m0, s46, 86016
s_nop 0
buffer_load_dwordx4 v31, s[32:35], s54 offen lds
v_mfma_f32_32x32x16_bf16 a[96:111], v[88:91], v[68:71], a[96:111]
s_add_u32 m0, s46, 87040
s_nop 0
buffer_load_dwordx4 v32, s[32:35], s54 offen lds
s_add_u32 m0, s46, 88064
s_nop 0
buffer_load_dwordx4 v33, s[32:35], s54 offen lds
s_add_u32 s53, s53, 16384
s_add_u32 s54, s54, s57
v_mfma_f32_32x32x16_bf16 a[112:127], v[92:95], v[68:71], a[112:127]
v_mfma_f32_32x32x16_bf16 a[128:143], v[96:99], v[68:71], a[128:143]
v_mfma_f32_32x32x16_bf16 a[144:159], v[88:91], v[72:75], a[144:159]
v_mfma_f32_32x32x16_bf16 a[160:175], v[92:95], v[72:75], a[160:175]
v_mfma_f32_32x32x16_bf16 a[176:191], v[96:99], v[72:75], a[176:191]
s_mov_b32 s42, 3
s_cmp_eq_u32 s42, 0
s_cbranch_scc1 L_g1_wx_last_B
s_nop 8
L_g1_wx_B:
s_waitcnt lgkmcnt(0)
v_mfma_f32_32x32x16_bf16 a[0:15], v[76:79], v[44:47], a[0:15]
ds_read_b128 v[60:63], v35 offset:0
v_mfma_f32_32x32x16_bf16 a[16:31], v[80:83], v[44:47], a[16:31]
ds_read_b128 v[64:67], v35 offset:2048
v_mfma_f32_32x32x16_bf16 a[32:47], v[84:87], v[44:47], a[32:47]
ds_read_b128 v[68:71], v35 offset:4096
v_mfma_f32_32x32x16_bf16 a[48:63], v[76:79], v[48:51], a[48:63]
ds_read_b128 v[72:75], v35 offset:6144
v_mfma_f32_32x32x16_bf16 a[64:79], v[80:83], v[48:51], a[64:79]
ds_read_b64_tr_b16 v[88:89], v38 offset:0
ds_read_b64_tr_b16 v[90:91], v39 offset:0
v_mfma_f32_32x32x16_bf16 a[80:95], v[84:87], v[48:51], a[80:95]
ds_read_b64_tr_b16 v[92:93], v42 offset:0
ds_read_b64_tr_b16 v[94:95], v43 offset:0
v_mfma_f32_32x32x16_bf16 a[96:111], v[76:79], v[52:55], a[96:111]
ds_read_b64_tr_b16 v[96:97], v38 offset:128
ds_read_b64_tr_b16 v[98:99], v39 offset:128
v_mfma_f32_32x32x16_bf16 a[112:127], v[80:83], v[52:55], a[112:127]
v_mfma_f32_32x32x16_bf16 a[128:143], v[84:87], v[52:55], a[128:143]
v_mfma_f32_32x32x16_bf16 a[144:159], v[76:79], v[56:59], a[144:159]
v_mfma_f32_32x32x16_bf16 a[160:175], v[80:83], v[56:59], a[160:175]
v_mfma_f32_32x32x16_bf16 a[176:191], v[84:87], v[56:59], a[176:191]
s_waitcnt lgkmcnt(0)
s_waitcnt vmcnt(14)
s_barrier
v_mfma_f32_32x32x16_bf16 a[0:15], v[88:91], v[60:63], a[0:15]
ds_read_b128 v[44:47], v34 offset:28672
ds_read_b128 v[48:51], v34 offset:30720
v_mfma_f32_32x32x16_bf16 a[16:31], v[92:95], v[60:63], a[16:31]
ds_read_b128 v[52:55], v34 offset:32768
ds_read_b128 v[56:59], v34 offset:34816
v_mfma_f32_32x32x16_bf16 a[32:47], v[96:99], v[60:63], a[32:47]
ds_read_b64_tr_b16 v[76:77], v36 offset:28672
ds_read_b64_tr_b16 v[78:79], v37 offset:28672
ds_read_b64_tr_b16 v[80:81], v40 offset:28672
ds_read_b64_tr_b16 v[82:83], v41 offset:28672
v_mfma_f32_32x32x16_bf16 a[48:63], v[88:91], v[64:67], a[48:63]
ds_read_b64_tr_b16 v[84:85], v36 offset:28800
ds_read_b64_tr_b16 v[86:87], v37 offset:28800
s_add_u32 m0, s45, 0
s_nop 0
buffer_load_dwordx4 v21, s[20:23], s53 offen lds
v_mfma_f32_32x32x16_bf16 a[64:79], v[92:95], v[64:67], a[64:79]
s_add_u32 m0, s45, 1024
s_nop 0
buffer_load_dwordx4 v22, s[20:23], s53 offen lds
s_add_u32 m0, s45, 2048
s_nop 0
buffer_load_dwordx4 v23, s[20:23], s53 offen lds
v_mfma_f32_32x32x16_bf16 a[80:95], v[96:99], v[64:67], a[80:95]
s_add_u32 m0, s45, 3072
s_nop 0
buffer_load_dwordx4 v24, s[20:23], s53 offen lds
s_add_u32 m0, s46, 0
s_nop 0
buffer_load_dwordx4 v31, s[32:35], s54 offen lds
v_mfma_f32_32x32x16_bf16 a[96:111], v[88:91], v[68:71], a[96:111]
s_add_u32 m0, s46, 1024
s_nop 0
buffer_load_dwordx4 v32, s[32:35], s54 offen lds
s_add_u32 m0, s46, 2048
s_nop 0
buffer_load_dwordx4 v33, s[32:35], s54 offen lds
s_add_u32 s53, s53, 16384
s_add_u32 s54, s54, s57
v_mfma_f32_32x32x16_bf16 a[112:127], v[92:95], v[68:71], a[112:127]
v_mfma_f32_32x32x16_bf16 a[128:143], v[96:99], v[68:71], a[128:143]
v_mfma_f32_32x32x16_bf16 a[144:159], v[88:91], v[72:75], a[144:159]
v_mfma_f32_32x32x16_bf16 a[160:175], v[92:95], v[72:75], a[160:175]
v_mfma_f32_32x32x16_bf16 a[176:191], v[96:99], v[72:75], a[176:191]
s_waitcnt lgkmcnt(0)
v_mfma_f32_32x32x16_bf16 a[0:15], v[76:79], v[44:47], a[0:15]
ds_read_b128 v[60:63], v35 offset:28672
v_mfma_f32_32x32x16_bf16 a[16:31], v[80:83], v[44:47], a[16:31]
ds_read_b128 v[64:67], v35 offset:30720
v_mfma_f32_32x32x16_bf16 a[32:47], v[84:87], v[44:47], a[32:47]
ds_read_b128 v[68:71], v35 offset:32768
v_mfma_f32_32x32x16_bf16 a[48:63], v[76:79], v[48:51], a[48:63]
ds_read_b128 v[72:75], v35 offset:34816
v_mfma_f32_32x32x16_bf16 a[64:79], v[80:83], v[48:51], a[64:79]
ds_read_b64_tr_b16 v[88:89], v38 offset:28672
ds_read_b64_tr_b16 v[90:91], v39 offset:28672
v_mfma_f32_32x32x16_bf16 a[80:95], v[84:87], v[48:51], a[80:95]
ds_read_b64_tr_b16 v[92:93], v42 offset:28672
ds_read_b64_tr_b16 v[94:95], v43 offset:28672
v_mfma_f32_32x32x16_bf16 a[96:111], v[76:79], v[52:55], a[96:111]
ds_read_b64_tr_b16 v[96:97], v38 offset:28800
ds_read_b64_tr_b16 v[98:99], v39 offset:28800
v_mfma_f32_32x32x16_bf16 a[112:127], v[80:83], v[52:55], a[112:127]
v_mfma_f32_32x32x16_bf16 a[128:143], v[84:87], v[52:55], a[128:143]
v_mfma_f32_32x32x16_bf16 a[144:159], v[76:79], v[56:59], a[144:159]
v_mfma_f32_32x32x16_bf16 a[160:175], v[80:83], v[56:59], a[160:175]
v_mfma_f32_32x32x16_bf16 a[176:191], v[84:87], v[56:59], a[176:191]
s_waitcnt lgkmcnt(0)
s_waitcnt vmcnt(14)
s_barrier
v_mfma_f32_32x32x16_bf16 a[0:15], v[88:91], v[60:63], a[0:15]
ds_read_b128 v[44:47], v100 offset:0
ds_read_b128 v[48:51], v100 offset:2048
v_mfma_f32_32x32x16_bf16 a[16:31], v[92:95], v[60:63], a[16:31]
ds_read_b128 v[52:55], v100 offset:4096
ds_read_b128 v[56:59], v100 offset:6144
v_mfma_f32_32x32x16_bf16 a[32:47], v[96:99], v[60:63], a[32:47]
ds_read_b64_tr_b16 v[76:77], v102 offset:0
ds_read_b64_tr_b16 v[78:79], v103 offset:0
ds_read_b64_tr_b16 v[80:81], v106 offset:0
ds_read_b64_tr_b16 v[82:83], v107 offset:0
v_mfma_f32_32x32x16_bf16 a[48:63], v[88:91], v[64:67], a[48:63]
ds_read_b64_tr_b16 v[84:85], v102 offset:128
ds_read_b64_tr_b16 v[86:87], v103 offset:128
s_add_u32 m0, s45, 28672
s_nop 0
buffer_load_dwordx4 v21, s[20:23], s53 offen lds
v_mfma_f32_32x32x16_bf16 a[64:79], v[92:95], v[64:67], a[64:79]
s_add_u32 m0, s45, 29696
s_nop 0
buffer_load_dwordx4 v22, s[20:23], s53 offen lds
s_add_u32 m0, s45, 30720
s_nop 0
buffer_load_dwordx4 v23, s[20:23], s53 offen lds
v_mfma_f32_32x32x16_bf16 a[80:95], v[96:99], v[64:67], a[80:95]
s_add_u32 m0, s45, 31744
s_nop 0
buffer_load_dwordx4 v24, s[20:23], s53 offen lds
s_add_u32 m0, s46, 28672
s_nop 0
buffer_load_dwordx4 v31, s[32:35], s54 offen lds
v_mfma_f32_32x32x16_bf16 a[96:111], v[88:91], v[68:71], a[96:111]
s_add_u32 m0, s46, 29696
s_nop 0
buffer_load_dwordx4 v32, s[32:35], s54 offen lds
s_add_u32 m0, s46, 30720
s_nop 0
buffer_load_dwordx4 v33, s[32:35], s54 offen lds
s_add_u32 s53, s53, 16384
s_add_u32 s54, s54, s57
v_mfma_f32_32x32x16_bf16 a[112:127], v[92:95], v[68:71], a[112:127]
v_mfma_f32_32x32x16_bf16 a[128:143], v[96:99], v[68:71], a[128:143]
v_mfma_f32_32x32x16_bf16 a[144:159], v[88:91], v[72:75], a[144:159]
v_mfma_f32_32x32x16_bf16 a[160:175], v[92:95], v[72:75], a[160:175]
v_mfma_f32_32x32x16_bf16 a[176:191], v[96:99], v[72:75], a[176:191]
s_waitcnt lgkmcnt(0)
v_mfma_f32_32x32x16_bf16 a[0:15], v[76:79], v[44:47], a[0:15]
ds_read_b128 v[60:63], v101 offset:0
v_mfma_f32_32x32x16_bf16 a[16:31], v[80:83], v[44:47], a[16:31]
ds_read_b128 v[64:67], v101 offset:2048
v_mfma_f32_32x32x16_bf16 a[32:47], v[84:87], v[44:47], a[32:47]
ds_read_b128 v[68:71], v101 offset:4096
v_mfma_f32_32x32x16_bf16 a[48:63], v[76:79], v[48:51], a[48:63]
ds_read_b128 v[72:75], v101 offset:6144
v_mfma_f32_32x32x16_bf16 a[64:79], v[80:83], v[48:51], a[64:79]
ds_read_b64_tr_b16 v[88:89], v104 offset:0
ds_read_b64_tr_b16 v[90:91], v105 offset:0
v_mfma_f32_32x32x16_bf16 a[80:95], v[84:87], v[48:51], a[80:95]
ds_read_b64_tr_b16 v[92:93], v108 offset:0
ds_read_b64_tr_b16 v[94:95], v109 offset:0
v_mfma_f32_32x32x16_bf16 a[96:111], v[76:79], v[52:55], a[96:111]
ds_read_b64_tr_b16 v[96:97], v104 offset:128
ds_read_b64_tr_b16 v[98:99], v105 offset:128
v_mfma_f32_32x32x16_bf16 a[112:127], v[80:83], v[52:55], a[112:127]
v_mfma_f32_32x32x16_bf16 a[128:143], v[84:87], v[52:55], a[128:143]
v_mfma_f32_32x32x16_bf16 a[144:159], v[76:79], v[56:59], a[144:159]
v_mfma_f32_32x32x16_bf16 a[160:175], v[80:83], v[56:59], a[160:175]
v_mfma_f32_32x32x16_bf16 a[176:191], v[84:87], v[56:59], a[176:191]
s_waitcnt lgkmcnt(0)
s_waitcnt vmcnt(14)
s_barrier
v_mfma_f32_32x32x16_bf16 a[0:15], v[88:91], v[60:63], a[0:15]
ds_read_b128 v[44:47], v100 offset:28672
ds_read_b128 v[48:51], v100 offset:30720
v_mfma_f32_32x32x16_bf16 a[16:31], v[92:95], v[60:63], a[16:31]
ds_read_b128 v[52:55], v100 offset:32768
ds_read_b128 v[56:59], v100 offset:34816
v_mfma_f32_32x32x16_bf16 a[32:47], v[96:99], v[60:63], a[32:47]
ds_read_b64_tr_b16 v[76:77], v102 offset:28672
ds_read_b64_tr_b16 v[78:79], v103 offset:28672
ds_read_b64_tr_b16 v[80:81], v106 offset:28672
ds_read_b64_tr_b16 v[82:83], v107 offset:28672
v_mfma_f32_32x32x16_bf16 a[48:63], v[88:91], v[64:67], a[48:63]
ds_read_b64_tr_b16 v[84:85], v102 offset:28800
ds_read_b64_tr_b16 v[86:87], v103 offset:28800
s_add_u32 m0, s45, 57344
s_nop 0
buffer_load_dwordx4 v21, s[20:23], s53 offen lds
v_mfma_f32_32x32x16_bf16 a[64:79], v[92:95], v[64:67], a[64:79]
s_add_u32 m0, s45, 58368
s_nop 0
buffer_load_dwordx4 v22, s[20:23], s53 offen lds
s_add_u32 m0, s45, 59392
s_nop 0
buffer_load_dwordx4 v23, s[20:23], s53 offen lds
v_mfma_f32_32x32x16_bf16 a[80:95], v[96:99], v[64:67], a[80:95]
s_add_u32 m0, s45, 60416
s_nop 0
buffer_load_dwordx4 v24, s[20:23], s53 offen lds
s_add_u32 m0, s46, 57344
s_nop 0
buffer_load_dwordx4 v31, s[32:35], s54 offen lds
v_mfma_f32_32x32x16_bf16 a[96:111], v[88:91], v[68:71], a[96:111]
s_add_u32 m0, s46, 58368
s_nop 0
buffer_load_dwordx4 v32, s[32:35], s54 offen lds
s_add_u32 m0, s46, 59392
s_nop 0
buffer_load_dwordx4 v33, s[32:35], s54 offen lds
s_add_u32 s53, s53, 16384
s_add_u32 s54, s54, s57
v_mfma_f32_32x32x16_bf16 a[112:127], v[92:95], v[68:71], a[112:127]
v_mfma_f32_32x32x16_bf16 a[128:143], v[96:99], v[68:71], a[128:143]
v_mfma_f32_32x32x16_bf16 a[144:159], v[88:91], v[72:75], a[144:159]
v_mfma_f32_32x32x16_bf16 a[160:175], v[92:95], v[72:75], a[160:175]
v_mfma_f32_32x32x16_bf16 a[176:191], v[96:99], v[72:75], a[176:191]
s_waitcnt lgkmcnt(0)
v_mfma_f32_32x32x16_bf16 a[0:15], v[76:79], v[44:47], a[0:15]
ds_read_b128 v[60:63], v101 offset:28672
v_mfma_f32_32x32x16_bf16 a[16:31], v[80:83], v[44:47], a[16:31]
ds_read_b128 v[64:67], v101 offset:30720
v_mfma_f32_32x32x16_bf16 a[32:47], v[84:87], v[44:47], a[32:47]
ds_read_b128 v[68:71], v101 offset:32768
v_mfma_f32_32x32x16_bf16 a[48:63], v[76:79], v[48:51], a[48:63]
ds_read_b128 v[72:75], v101 offset:34816
v_mfma_f32_32x32x16_bf16 a[64:79], v[80:83], v[48:51], a[64:79]
ds_read_b64_tr_b16 v[88:89], v104 offset:28672
ds_read_b64_tr_b16 v[90:91], v105 offset:28672
v_mfma_f32_32x32x16_bf16 a[80:95], v[84:87], v[48:51], a[80:95]
ds_read_b64_tr_b16 v[92:93], v108 offset:28672
ds_read_b64_tr_b16 v[94:95], v109 offset:28672
v_mfma_f32_32x32x16_bf16 a[96:111], v[76:79], v[52:55], a[96:111]
ds_read_b64_tr_b16 v[96:97], v104 offset:28800
ds_read_b64_tr_b16 v[98:99], v105 offset:28800
v_mfma_f32_32x32x16_bf16 a[112:127], v[80:83], v[52:55], a[112:127]
v_mfma_f32_32x32x16_bf16 a[128:143], v[84:87], v[52:55], a[128:143]
v_mfma_f32_32x32x16_bf16 a[144:159], v[76:79], v[56:59], a[144:159]
v_mfma_f32_32x32x16_bf16 a[160:175], v[80:83], v[56:59], a[160:175]
v_mfma_f32_32x32x16_bf16 a[176:191], v[84:87], v[56:59], a[176:191]
s_waitcnt lgkmcnt(0)
s_waitcnt vmcnt(14)
s_barrier
v_mfma_f32_32x32x16_bf16 a[0:15], v[88:91], v[60:63], a[0:15]
ds_read_b128 v[44:47], v34 offset:0
ds_read_b128 v[48:51], v34 offset:2048
v_mfma_f32_32x32x16_bf16 a[16:31], v[92:95], v[60:63], a[16:31]
ds_read_b128 v[52:55], v34 offset:4096
ds_read_b128 v[56:59], v34 offset:6144
v_mfma_f32_32x32x16_bf16 a[32:47], v[96:99], v[60:63], a[32:47]
ds_read_b64_tr_b16 v[76:77], v36 offset:0
ds_read_b64_tr_b16 v[78:79], v37 offset:0
ds_read_b64_tr_b16 v[80:81], v40 offset:0
ds_read_b64_tr_b16 v[82:83], v41 offset:0
v_mfma_f32_32x32x16_bf16 a[48:63], v[88:91], v[64:67], a[48:63]
ds_read_b64_tr_b16 v[84:85], v36 offset:128
ds_read_b64_tr_b16 v[86:87], v37 offset:128
s_add_u32 m0, s45, 86016
s_nop 0
buffer_load_dwordx4 v21, s[20:23], s53 offen lds
v_mfma_f32_32x32x16_bf16 a[64:79], v[92:95], v[64:67], a[64:79]
s_add_u32 m0, s45, 87040
s_nop 0
buffer_load_dwordx4 v22, s[20:23], s53 offen lds
s_add_u32 m0, s45, 88064
s_nop 0
buffer_load_dwordx4 v23, s[20:23], s53 offen lds
v_mfma_f32_32x32x16_bf16 a[80:95], v[96:99], v[64:67], a[80:95]
s_add_u32 m0, s45, 89088
s_nop 0
buffer_load_dwordx4 v24, s[20:23], s53 offen lds
s_add_u32 m0, s46, 86016
s_nop 0
buffer_load_dwordx4 v31, s[32:35], s54 offen lds
v_mfma_f32_32x32x16_bf16 a[96:111], v[88:91], v[68:71], a[96:111]
s_add_u32 m0, s46, 87040
s_nop 0
buffer_load_dwordx4 v32, s[32:35], s54 offen lds
s_add_u32 m0, s46, 88064
s_nop 0
buffer_load_dwordx4 v33, s[32:35], s54 offen lds
s_add_u32 s53, s53, 16384
s_add_u32 s54, s54, s57
v_mfma_f32_32x32x16_bf16 a[112:127], v[92:95], v[68:71], a[112:127]
v_mfma_f32_32x32x16_bf16 a[128:143], v[96:99], v[68:71], a[128:143]
v_mfma_f32_32x32x16_bf16 a[144:159], v[88:91], v[72:75], a[144:159]
v_mfma_f32_32x32x16_bf16 a[160:175], v[92:95], v[72:75], a[160:175]
v_mfma_f32_32x32x16_bf16 a[176:191], v[96:99], v[72:75], a[176:191]
s_sub_u32 s42, s42, 1
s_cmp_lg_u32 s42, 0
s_nop 9
s_cbranch_scc1 L_g1_wx_B
L_g1_wx_last_B:
s_waitcnt lgkmcnt(0)
v_mfma_f32_32x32x16_bf16 a[0:15], v[76:79], v[44:47], a[0:15]
ds_read_b128 v[60:63], v35 offset:0
v_mfma_f32_32x32x16_bf16 a[16:31], v[80:83], v[44:47], a[16:31]
ds_read_b128 v[64:67], v35 offset:2048
v_mfma_f32_32x32x16_bf16 a[32:47], v[84:87], v[44:47], a[32:47]
ds_read_b128 v[68:71], v35 offset:4096
v_mfma_f32_32x32x16_bf16 a[48:63], v[76:79], v[48:51], a[48:63]
ds_read_b128 v[72:75], v35 offset:6144
v_mfma_f32_32x32x16_bf16 a[64:79], v[80:83], v[48:51], a[64:79]
ds_read_b64_tr_b16 v[88:89], v38 offset:0
ds_read_b64_tr_b16 v[90:91], v39 offset:0
v_mfma_f32_32x32x16_bf16 a[80:95], v[84:87], v[48:51], a[80:95]
ds_read_b64_tr_b16 v[92:93], v42 offset:0
ds_read_b64_tr_b16 v[94:95], v43 offset:0
v_mfma_f32_32x32x16_bf16 a[96:111], v[76:79], v[52:55], a[96:111]
ds_read_b64_tr_b16 v[96:97], v38 offset:128
ds_read_b64_tr_b16 v[98:99], v39 offset:128
v_mfma_f32_32x32x16_bf16 a[112:127], v[80:83], v[52:55], a[112:127]
v_mfma_f32_32x32x16_bf16 a[128:143], v[84:87], v[52:55], a[128:143]
v_mfma_f32_32x32x16_bf16 a[144:159], v[76:79], v[56:59], a[144:159]
v_mfma_f32_32x32x16_bf16 a[160:175], v[80:83], v[56:59], a[160:175]
v_mfma_f32_32x32x16_bf16 a[176:191], v[84:87], v[56:59], a[176:191]
s_waitcnt lgkmcnt(0)
s_waitcnt vmcnt(14)
s_barrier
v_mfma_f32_32x32x16_bf16 a[0:15], v[88:91], v[60:63], a[0:15]
ds_read_b128 v[44:47], v34 offset:28672
v_mfma_f32_32x32x16_bf16 a[16:31], v[92:95], v[60:63], a[16:31]
ds_read_b128 v[48:51], v34 offset:30720
v_mfma_f32_32x32x16_bf16 a[32:47], v[96:99], v[60:63], a[32:47]
ds_read_b128 v[52:55], v34 offset:32768
v_mfma_f32_32x32x16_bf16 a[48:63], v[88:91], v[64:67], a[48:63]
ds_read_b128 v[56:59], v34 offset:34816
v_mfma_f32_32x32x16_bf16 a[64:79], v[92:95], v[64:67], a[64:79]
ds_read_b64_tr_b16 v[76:77], v36 offset:28672
ds_read_b64_tr_b16 v[78:79], v37 offset:28672
v_mfma_f32_32x32x16_bf16 a[80:95], v[96:99], v[64:67], a[80:95]
ds_read_b64_tr_b16 v[80:81], v40 offset:28672
ds_read_b64_tr_b16 v[82:83], v41 offset:28672
v_mfma_f32_32x32x16_bf16 a[96:111], v[88:91], v[68:71], a[96:111]
ds_read_b64_tr_b16 v[84:85], v36 offset:28800
ds_read_b64_tr_b16 v[86:87], v37 offset:28800
v_mfma_f32_32x32x16_bf16 a[112:127], v[92:95], v[68:71], a[112:127]
v_mfma_f32_32x32x16_bf16 a[128:143], v[96:99], v[68:71], a[128:143]
v_mfma_f32_32x32x16_bf16 a[144:159], v[88:91], v[72:75], a[144:159]
v_mfma_f32_32x32x16_bf16 a[160:175], v[92:95], v[72:75], a[160:175]
v_mfma_f32_32x32x16_bf16 a[176:191], v[96:99], v[72:75], a[176:191]
s_waitcnt lgkmcnt(0)
v_mfma_f32_32x32x16_bf16 a[0:15], v[76:79], v[44:47], a[0:15]
ds_read_b128 v[60:63], v35 offset:28672
v_mfma_f32_32x32x16_bf16 a[16:31], v[80:83], v[44:47], a[16:31]
ds_read_b128 v[64:67], v35 offset:30720
v_mfma_f32_32x32x16_bf16 a[32:47], v[84:87], v[44:47], a[32:47]
ds_read_b128 v[68:71], v35 offset:32768
v_mfma_f32_32x32x16_bf16 a[48:63], v[76:79], v[48:51], a[48:63]
ds_read_b128 v[72:75], v35 offset:34816
v_mfma_f32_32x32x16_bf16 a[64:79], v[80:83], v[48:51], a[64:79]
ds_read_b64_tr_b16 v[88:89], v38 offset:28672
ds_read_b64_tr_b16 v[90:91], v39 offset:28672
v_mfma_f32_32x32x16_bf16 a[80:95], v[84:87], v[48:51], a[80:95]
ds_read_b64_tr_b16 v[92:93], v42 offset:28672
ds_read_b64_tr_b16 v[94:95], v43 offset:28672
v_mfma_f32_32x32x16_bf16 a[96:111], v[76:79], v[52:55], a[96:111]
ds_read_b64_tr_b16 v[96:97], v38 offset:28800
ds_read_b64_tr_b16 v[98:99], v39 offset:28800
v_mfma_f32_32x32x16_bf16 a[112:127], v[80:83], v[52:55], a[112:127]
v_mfma_f32_32x32x16_bf16 a[128:143], v[84:87], v[52:55], a[128:143]
v_mfma_f32_32x32x16_bf16 a[144:159], v[76:79], v[56:59], a[144:159]
v_mfma_f32_32x32x16_bf16 a[160:175], v[80:83], v[56:59], a[160:175]
v_mfma_f32_32x32x16_bf16 a[176:191], v[84:87], v[56:59], a[176:191]
s_waitcnt lgkmcnt(0)
s_waitcnt vmcnt(7)
s_barrier
v_mfma_f32_32x32x16_bf16 a[0:15], v[88:91], v[60:63], a[0:15]
ds_read_b128 v[44:47], v100 offset:0
v_mfma_f32_32x32x16_bf16 a[16:31], v[92:95], v[60:63], a[16:31]
ds_read_b128 v[48:51], v100 offset:2048
v_mfma_f32_32x32x16_bf16 a[32:47], v[96:99], v[60:63], a[32:47]
ds_read_b128 v[52:55], v100 offset:4096
v_mfma_f32_32x32x16_bf16 a[48:63], v[88:91], v[64:67], a[48:63]
ds_read_b128 v[56:59], v100 offset:6144
v_mfma_f32_32x32x16_bf16 a[64:79], v[92:95], v[64:67], a[64:79]
ds_read_b64_tr_b16 v[76:77], v102 offset:0
ds_read_b64_tr_b16 v[78:79], v103 offset:0
v_mfma_f32_32x32x16_bf16 a[80:95], v[96:99], v[64:67], a[80:95]
ds_read_b64_tr_b16 v[80:81], v106 offset:0
ds_read_b64_tr_b16 v[82:83], v107 offset:0
v_mfma_f32_32x32x16_bf16 a[96:111], v[88:91], v[68:71], a[96:111]
ds_read_b64_tr_b16 v[84:85], v102 offset:128
ds_read_b64_tr_b16 v[86:87], v103 offset:128
v_mfma_f32_32x32x16_bf16 a[112:127], v[92:95], v[68:71], a[112:127]
v_mfma_f32_32x32x16_bf16 a[128:143], v[96:99], v[68:71], a[128:143]
v_mfma_f32_32x32x16_bf16 a[144:159], v[88:91], v[72:75], a[144:159]
v_mfma_f32_32x32x16_bf16 a[160:175], v[92:95], v[72:75], a[160:175]
v_mfma_f32_32x32x16_bf16 a[176:191], v[96:99], v[72:75], a[176:191]
s_waitcnt lgkmcnt(0)
v_mfma_f32_32x32x16_bf16 a[0:15], v[76:79], v[44:47], a[0:15]
ds_read_b128 v[60:63], v101 offset:0
v_mfma_f32_32x32x16_bf16 a[16:31], v[80:83], v[44:47], a[16:31]
ds_read_b128 v[64:67], v101 offset:2048
v_mfma_f32_32x32x16_bf16 a[32:47], v[84:87], v[44:47], a[32:47]
ds_read_b128 v[68:71], v101 offset:4096
v_mfma_f32_32x32x16_bf16 a[48:63], v[76:79], v[48:51], a[48:63]
ds_read_b128 v[72:75], v101 offset:6144
v_mfma_f32_32x32x16_bf16 a[64:79], v[80:83], v[48:51], a[64:79]
ds_read_b64_tr_b16 v[88:89], v104 offset:0
ds_read_b64_tr_b16 v[90:91], v105 offset:0
v_mfma_f32_32x32x16_bf16 a[80:95], v[84:87], v[48:51], a[80:95]
ds_read_b64_tr_b16 v[92:93], v108 offset:0
ds_read_b64_tr_b16 v[94:95], v109 offset:0
v_mfma_f32_32x32x16_bf16 a[96:111], v[76:79], v[52:55], a[96:111]
ds_read_b64_tr_b16 v[96:97], v104 offset:128
ds_read_b64_tr_b16 v[98:99], v105 offset:128
v_mfma_f32_32x32x16_bf16 a[112:127], v[80:83], v[52:55], a[112:127]
v_mfma_f32_32x32x16_bf16 a[128:143], v[84:87], v[52:55], a[128:143]
v_mfma_f32_32x32x16_bf16 a[144:159], v[76:79], v[56:59], a[144:159]
v_mfma_f32_32x32x16_bf16 a[160:175], v[80:83], v[56:59], a[160:175]
v_mfma_f32_32x32x16_bf16 a[176:191], v[84:87], v[56:59], a[176:191]
s_waitcnt lgkmcnt(0)
s_waitcnt vmcnt(0)
s_barrier
v_mfma_f32_32x32x16_bf16 a[0:15], v[88:91], v[60:63], a[0:15]
ds_read_b128 v[44:47], v100 offset:28672
v_mfma_f32_32x32x16_bf16 a[16:31], v[92:95], v[60:63], a[16:31]
ds_read_b128 v[48:51], v100 offset:30720
v_mfma_f32_32x32x16_bf16 a[32:47], v[96:99], v[60:63], a[32:47]
ds_read_b128 v[52:55], v100 offset:32768
v_mfma_f32_32x32x16_bf16 a[48:63], v[88:91], v[64:67], a[48:63]
ds_read_b128 v[56:59], v100 offset:34816
v_mfma_f32_32x32x16_bf16 a[64:79], v[92:95], v[64:67], a[64:79]
ds_read_b64_tr_b16 v[76:77], v102 offset:28672
ds_read_b64_tr_b16 v[78:79], v103 offset:28672
v_mfma_f32_32x32x16_bf16 a[80:95], v[96:99], v[64:67], a[80:95]
ds_read_b64_tr_b16 v[80:81], v106 offset:28672
ds_read_b64_tr_b16 v[82:83], v107 offset:28672
v_mfma_f32_32x32x16_bf16 a[96:111], v[88:91], v[68:71], a[96:111]
ds_read_b64_tr_b16 v[84:85], v102 offset:28800
ds_read_b64_tr_b16 v[86:87], v103 offset:28800
v_mfma_f32_32x32x16_bf16 a[112:127], v[92:95], v[68:71], a[112:127]
v_mfma_f32_32x32x16_bf16 a[128:143], v[96:99], v[68:71], a[128:143]
v_mfma_f32_32x32x16_bf16 a[144:159], v[88:91], v[72:75], a[144:159]
v_mfma_f32_32x32x16_bf16 a[160:175], v[92:95], v[72:75], a[160:175]
v_mfma_f32_32x32x16_bf16 a[176:191], v[96:99], v[72:75], a[176:191]
s_waitcnt lgkmcnt(0)
v_mfma_f32_32x32x16_bf16 a[0:15], v[76:79], v[44:47], a[0:15]
ds_read_b128 v[60:63], v101 offset:28672
v_mfma_f32_32x32x16_bf16 a[16:31], v[80:83], v[44:47], a[16:31]
ds_read_b128 v[64:67], v101 offset:30720
v_mfma_f32_32x32x16_bf16 a[32:47], v[84:87], v[44:47], a[32:47]
ds_read_b128 v[68:71], v101 offset:32768
v_mfma_f32_32x32x16_bf16 a[48:63], v[76:79], v[48:51], a[48:63]
ds_read_b128 v[72:75], v101 offset:34816
v_mfma_f32_32x32x16_bf16 a[64:79], v[80:83], v[48:51], a[64:79]
ds_read_b64_tr_b16 v[88:89], v104 offset:28672
ds_read_b64_tr_b16 v[90:91], v105 offset:28672
v_mfma_f32_32x32x16_bf16 a[80:95], v[84:87], v[48:51], a[80:95]
ds_read_b64_tr_b16 v[92:93], v108 offset:28672
ds_read_b64_tr_b16 v[94:95], v109 offset:28672
v_mfma_f32_32x32x16_bf16 a[96:111], v[76:79], v[52:55], a[96:111]
ds_read_b64_tr_b16 v[96:97], v104 offset:28800
ds_read_b64_tr_b16 v[98:99], v105 offset:28800
v_mfma_f32_32x32x16_bf16 a[112:127], v[80:83], v[52:55], a[112:127]
v_mfma_f32_32x32x16_bf16 a[128:143], v[84:87], v[52:55], a[128:143]
v_mfma_f32_32x32x16_bf16 a[144:159], v[76:79], v[56:59], a[144:159]
v_mfma_f32_32x32x16_bf16 a[160:175], v[80:83], v[56:59], a[160:175]
v_mfma_f32_32x32x16_bf16 a[176:191], v[84:87], v[56:59], a[176:191]
s_waitcnt lgkmcnt(0)
s_waitcnt vmcnt(0)
s_barrier
v_mfma_f32_32x32x16_bf16 a[0:15], v[88:91], v[60:63], a[0:15]
v_mfma_f32_32x32x16_bf16 a[16:31], v[92:95], v[60:63], a[16:31]
v_mfma_f32_32x32x16_bf16 a[32:47], v[96:99], v[60:63], a[32:47]
v_mfma_f32_32x32x16_bf16 a[48:63], v[88:91], v[64:67], a[48:63]
v_mfma_f32_32x32x16_bf16 a[64:79], v[92:95], v[64:67], a[64:79]
v_mfma_f32_32x32x16_bf16 a[80:95], v[96:99], v[64:67], a[80:95]
v_mfma_f32_32x32x16_bf16 a[96:111], v[88:91], v[68:71], a[96:111]
v_mfma_f32_32x32x16_bf16 a[112:127], v[92:95], v[68:71], a[112:127]
v_mfma_f32_32x32x16_bf16 a[128:143], v[96:99], v[68:71], a[128:143]
v_mfma_f32_32x32x16_bf16 a[144:159], v[88:91], v[72:75], a[144:159]
v_mfma_f32_32x32x16_bf16 a[160:175], v[92:95], v[72:75], a[160:175]
v_mfma_f32_32x32x16_bf16 a[176:191], v[96:99], v[72:75], a[176:191]
s_nop 11
s_barrier
s_add_u32 s50, s50, 16
s_cmp_lt_u32 s50, 96
s_cselect_b32 s87, 1, 0
s_cbranch_scc0 L_g1_nonb_B
s_cmp_ge_u32 s50, 56
s_cbranch_scc1 L_g1_dqb_B
s_mov_b32 s84, 1
s_mov_b32 s60, s50
s_cmp_lt_u32 s50, 8
s_cbranch_scc1 L_g1_d0b_B
s_sub_u32 s61, s50, 8
s_mul_i32 s60, s61, 43
s_lshr_b32 s60, s60, 8
s_mul_i32 s84, s60, 6
s_sub_u32 s84, s61, s84
s_add_u32 s84, s84, 2
L_g1_d0b_B:
s_lshr_b32 s86, s60, 2
s_and_b32 s60, s60, 3
s_lshl_b32 s85, s29, 2
s_add_u32 s85, s85, s60
s_branch L_g1_ddb_B
L_g1_dqb_B:
s_cmp_ge_u32 s50, 88
s_cbranch_scc1 L_g1_dhb_B
s_sub_u32 s60, s50, 56
s_and_b32 s84, s60, 7
s_lshr_b32 s60, s60, 3
s_lshl_b32 s85, s29, 2
s_add_u32 s85, s85, s60
s_mov_b32 s86, 2
s_branch L_g1_ddb_B
L_g1_dhb_B:
s_sub_u32 s84, s50, 88
s_mov_b32 s85, s29
s_mov_b32 s86, 3
L_g1_ddb_B:
s_mov_b32 s56, 12288
s_mov_b32 s34, 7864320
s_mov_b32 s35, 0x00020000
s_mov_b32 s32, s10
s_mov_b32 s33, s11
s_cmp_lg_u32 s86, 1
s_cbranch_scc1 L_g1_n1b_B
s_mov_b32 s32, s12
s_mov_b32 s33, s13
L_g1_n1b_B:
s_cmp_lg_u32 s86, 2
s_cbranch_scc1 L_g1_n2b_B
s_mov_b32 s32, s8
s_mov_b32 s33, s9
L_g1_n2b_B:
s_cmp_lg_u32 s86, 3
s_cbranch_scc1 L_g1_n3b_B
s_mov_b32 s32, s16
s_mov_b32 s33, s17
s_mov_b32 s56, 3072
s_mov_b32 s34, 1966080
L_g1_n3b_B:
s_mov_b32 s55, 1280
s_lshl_b32 s57, s56, 5
s_mul_i32 s54, s85, 384
s_mul_i32 s53, s84, 327680
s_add_u32 s53, s53, 90910720
s_mul_i32 s40, s28, 4096
s_add_u32 s40, s40, 0
v_lshlrev_b32 v4, 4, v1
v_add_u32 v21, s40, v4
s_mul_i32 s40, s28, 4096
s_add_u32 s40, s40, 1024
v_lshlrev_b32 v4, 4, v1
v_add_u32 v22, s40, v4
s_mul_i32 s40, s28, 4096
s_add_u32 s40, s40, 2048
v_lshlrev_b32 v4, 4, v1
v_add_u32 v23, s40, v4
s_mul_i32 s40, s28, 4096
s_add_u32 s40, s40, 3072
v_lshlrev_b32 v4, 4, v1
v_add_u32 v24, s40, v4
v_mul_lo_u32 v4, v25, s56
v_add_u32 v31, v4, v28
v_mul_lo_u32 v4, v26, s56
v_add_u32 v32, v4, v29
v_mul_lo_u32 v4, v27, s56
v_add_u32 v33, v4, v30
s_add_u32 m0, s45, 0
s_nop 0
buffer_load_dwordx4 v21, s[20:23], s53 offen lds
s_add_u32 m0, s45, 1024
s_nop 0
buffer_load_dwordx4 v22, s[20:23], s53 offen lds
s_add_u32 m0, s45, 2048
s_nop 0
buffer_load_dwordx4 v23, s[20:23], s53 offen lds
s_add_u32 m0, s45, 3072
s_nop 0
buffer_load_dwordx4 v24, s[20:23], s53 offen lds
s_add_u32 m0, s46, 0
s_nop 0
buffer_load_dwordx4 v31, s[32:35], s54 offen lds
s_add_u32 m0, s46, 1024
s_nop 0
buffer_load_dwordx4 v32, s[32:35], s54 offen lds
s_add_u32 m0, s46, 2048
s_nop 0
buffer_load_dwordx4 v33, s[32:35], s54 offen lds
s_add_u32 s53, s53, 16384
s_add_u32 s54, s54, s57
s_add_u32 m0, s45, 28672
s_nop 0
buffer_load_dwordx4 v21, s[20:23], s53 offen lds
s_add_u32 m0, s45, 29696
s_nop 0
buffer_load_dwordx4 v22, s[20:23], s53 offen lds
s_add_u32 m0, s45, 30720
s_nop 0
buffer_load_dwordx4 v23, s[20:23], s53 offen lds
s_add_u32 m0, s45, 31744
s_nop 0
buffer_load_dwordx4 v24, s[20:23], s53 offen lds
s_add_u32 m0, s46, 28672
s_nop 0
buffer_load_dwordx4 v31, s[32:35], s54 offen lds
s_add_u32 m0, s46, 29696
s_nop 0
buffer_load_dwordx4 v32, s[32:35], s54 offen lds
s_add_u32 m0, s46, 30720
s_nop 0
buffer_load_dwordx4 v33, s[32:35], s54 offen lds
s_add_u32 s53, s53, 16384
s_add_u32 s54, s54, s57
s_add_u32 m0, s45, 57344
s_nop 0
buffer_load_dwordx4 v21, s[20:23], s53 offen lds
s_add_u32 m0, s45, 58368
s_nop 0
buffer_load_dwordx4 v22, s[20:23], s53 offen lds
s_add_u32 m0, s45, 59392
s_nop 0
buffer_load_dwordx4 v23, s[20:23], s53 offen lds
s_add_u32 m0, s45, 60416
s_nop 0
buffer_load_dwordx4 v24, s[20:23], s53 offen lds
s_add_u32 m0, s46, 57344
s_nop 0
buffer_load_dwordx4 v31, s[32:35], s54 offen lds
s_add_u32 m0, s46, 58368
s_nop 0
buffer_load_dwordx4 v32, s[32:35], s54 offen lds
s_add_u32 m0, s46, 59392
s_nop 0
buffer_load_dwordx4 v33, s[32:35], s54 offen lds
s_add_u32 s53, s53, 16384
s_add_u32 s54, s54, s57
s_add_u32 m0, s45, 86016
s_nop 0
buffer_load_dwordx4 v21, s[20:23], s53 offen lds
s_add_u32 m0, s45, 87040
s_nop 0
buffer_load_dwordx4 v22, s[20:23], s53 offen lds
s_add_u32 m0, s45, 88064
s_nop 0
buffer_load_dwordx4 v23, s[20:23], s53 offen lds
s_add_u32 m0, s45, 89088
s_nop 0
buffer_load_dwordx4 v24, s[20:23], s53 offen lds
s_add_u32 m0, s46, 86016
s_nop 0
buffer_load_dwordx4 v31, s[32:35], s54 offen lds
s_add_u32 m0, s46, 87040
s_nop 0
buffer_load_dwordx4 v32, s[32:35], s54 offen lds
s_add_u32 m0, s46, 88064
s_nop 0
buffer_load_dwordx4 v33, s[32:35], s54 offen lds
s_add_u32 s53, s53, 16384
s_add_u32 s54, s54, s57
L_g1_nonb_B:
s_cmp_eq_u32 s58, 3
s_cbranch_scc1 L_g1_ffn_B
s_lshr_b32 s60, s28, 1
s_and_b32 s61, s28, 1
s_lshl_b32 s40, s52, 3
s_lshl_b32 s60, s60, 2
s_add_u32 s40, s40, s60
s_lshl_b32 s40, s40, 5
s_add_u32 s40, s40, s59
s_mul_i32 s40, s40, 12288
s_mul_i32 s61, s61, 3072
s_add_u32 s40, s40, s61
s_cmp_eq_u32 s58, 0
s_cselect_b32 s41, 0, 50331648
s_add_u32 s40, s40, s41
s_add_u32 s41, s40, 0
v_accvgpr_read_b32 v132, a0
v_accvgpr_read_b32 v133, a1
v_accvgpr_read_b32 v134, a2
v_accvgpr_read_b32 v135, a3
v_accvgpr_read_b32 v136, a4
v_accvgpr_read_b32 v137, a5
v_accvgpr_read_b32 v138, a6
v_accvgpr_read_b32 v139, a7
v_accvgpr_read_b32 v140, a8
v_accvgpr_read_b32 v141, a9
v_accvgpr_read_b32 v142, a10
v_accvgpr_read_b32 v143, a11
v_accvgpr_read_b32 v144, a12
v_accvgpr_read_b32 v145, a13
v_accvgpr_read_b32 v146, a14
v_accvgpr_read_b32 v147, a15
v_cvt_pk_bf16_f32 v116, v132, v133
v_cvt_pk_bf16_f32 v117, v134, v135
v_cvt_pk_bf16_f32 v118, v140, v141
v_cvt_pk_bf16_f32 v119, v142, v143
v_cvt_pk_bf16_f32 v120, v136, v137
v_cvt_pk_bf16_f32 v121, v138, v139
v_cvt_pk_bf16_f32 v122, v144, v145
v_cvt_pk_bf16_f32 v123, v146, v147
buffer_store_dwordx4 v[116:119], v110, s[20:23], s41 offen sc1
buffer_store_dwordx4 v[120:123], v110, s[20:23], s41 offen offset:512 sc1
s_add_u32 s41, s40, 1024
v_accvgpr_read_b32 v132, a16
v_accvgpr_read_b32 v133, a17
v_accvgpr_read_b32 v134, a18
v_accvgpr_read_b32 v135, a19
v_accvgpr_read_b32 v136, a20
v_accvgpr_read_b32 v137, a21
v_accvgpr_read_b32 v138, a22
v_accvgpr_read_b32 v139, a23
v_accvgpr_read_b32 v140, a24
v_accvgpr_read_b32 v141, a25
v_accvgpr_read_b32 v142, a26
v_accvgpr_read_b32 v143, a27
v_accvgpr_read_b32 v144, a28
v_accvgpr_read_b32 v145, a29
v_accvgpr_read_b32 v146, a30
v_accvgpr_read_b32 v147, a31
v_cvt_pk_bf16_f32 v116, v132, v133
v_cvt_pk_bf16_f32 v117, v134, v135
v_cvt_pk_bf16_f32 v118, v140, v141
v_cvt_pk_bf16_f32 v119, v142, v143
v_cvt_pk_bf16_f32 v120, v136, v137
v_cvt_pk_bf16_f32 v121, v138, v139
v_cvt_pk_bf16_f32 v122, v144, v145
v_cvt_pk_bf16_f32 v123, v146, v147
buffer_store_dwordx4 v[116:119], v110, s[20:23], s41 offen sc1
buffer_store_dwordx4 v[120:123], v110, s[20:23], s41 offen offset:512 sc1
s_add_u32 s41, s40, 2048
v_accvgpr_read_b32 v132, a32
v_accvgpr_read_b32 v133, a33
v_accvgpr_read_b32 v134, a34
v_accvgpr_read_b32 v135, a35
v_accvgpr_read_b32 v136, a36
v_accvgpr_read_b32 v137, a37
v_accvgpr_read_b32 v138, a38
v_accvgpr_read_b32 v139, a39
v_accvgpr_read_b32 v140, a40
v_accvgpr_read_b32 v141, a41
v_accvgpr_read_b32 v142, a42
v_accvgpr_read_b32 v143, a43
v_accvgpr_read_b32 v144, a44
v_accvgpr_read_b32 v145, a45
v_accvgpr_read_b32 v146, a46
v_accvgpr_read_b32 v147, a47
v_cvt_pk_bf16_f32 v116, v132, v133
v_cvt_pk_bf16_f32 v117, v134, v135
v_cvt_pk_bf16_f32 v118, v140, v141
v_cvt_pk_bf16_f32 v119, v142, v143
v_cvt_pk_bf16_f32 v120, v136, v137
v_cvt_pk_bf16_f32 v121, v138, v139
v_cvt_pk_bf16_f32 v122, v144, v145
v_cvt_pk_bf16_f32 v123, v146, v147
buffer_store_dwordx4 v[116:119], v110, s[20:23], s41 offen sc1
buffer_store_dwordx4 v[120:123], v110, s[20:23], s41 offen offset:512 sc1
s_add_u32 s41, s40, 393216
v_accvgpr_read_b32 v132, a48
v_accvgpr_read_b32 v133, a49
v_accvgpr_read_b32 v134, a50
v_accvgpr_read_b32 v135, a51
v_accvgpr_read_b32 v136, a52
v_accvgpr_read_b32 v137, a53
v_accvgpr_read_b32 v138, a54
v_accvgpr_read_b32 v139, a55
v_accvgpr_read_b32 v140, a56
v_accvgpr_read_b32 v141, a57
v_accvgpr_read_b32 v142, a58
v_accvgpr_read_b32 v143, a59
v_accvgpr_read_b32 v144, a60
v_accvgpr_read_b32 v145, a61
v_accvgpr_read_b32 v146, a62
v_accvgpr_read_b32 v147, a63
v_cvt_pk_bf16_f32 v116, v132, v133
v_cvt_pk_bf16_f32 v117, v134, v135
v_cvt_pk_bf16_f32 v118, v140, v141
v_cvt_pk_bf16_f32 v119, v142, v143
v_cvt_pk_bf16_f32 v120, v136, v137
v_cvt_pk_bf16_f32 v121, v138, v139
v_cvt_pk_bf16_f32 v122, v144, v145
v_cvt_pk_bf16_f32 v123, v146, v147
buffer_store_dwordx4 v[116:119], v110, s[20:23], s41 offen sc1
buffer_store_dwordx4 v[120:123], v110, s[20:23], s41 offen offset:512 sc1
s_add_u32 s41, s40, 394240
v_accvgpr_read_b32 v132, a64
v_accvgpr_read_b32 v133, a65
v_accvgpr_read_b32 v134, a66
v_accvgpr_read_b32 v135, a67
v_accvgpr_read_b32 v136, a68
v_accvgpr_read_b32 v137, a69
v_accvgpr_read_b32 v138, a70
v_accvgpr_read_b32 v139, a71
v_accvgpr_read_b32 v140, a72
v_accvgpr_read_b32 v141, a73
v_accvgpr_read_b32 v142, a74
v_accvgpr_read_b32 v143, a75
v_accvgpr_read_b32 v144, a76
v_accvgpr_read_b32 v145, a77
v_accvgpr_read_b32 v146, a78
v_accvgpr_read_b32 v147, a79
v_cvt_pk_bf16_f32 v116, v132, v133
v_cvt_pk_bf16_f32 v117, v134, v135
v_cvt_pk_bf16_f32 v118, v140, v141
v_cvt_pk_bf16_f32 v119, v142, v143
v_cvt_pk_bf16_f32 v120, v136, v137
v_cvt_pk_bf16_f32 v121, v138, v139
v_cvt_pk_bf16_f32 v122, v144, v145
v_cvt_pk_bf16_f32 v123, v146, v147
buffer_store_dwordx4 v[116:119], v110, s[20:23], s41 offen sc1
buffer_store_dwordx4 v[120:123], v110, s[20:23], s41 offen offset:512 sc1
s_add_u32 s41, s40, 395264
v_accvgpr_read_b32 v132, a80
v_accvgpr_read_b32 v133, a81
v_accvgpr_read_b32 v134, a82
v_accvgpr_read_b32 v135, a83
v_accvgpr_read_b32 v136, a84
v_accvgpr_read_b32 v137, a85
v_accvgpr_read_b32 v138, a86
v_accvgpr_read_b32 v139, a87
v_accvgpr_read_b32 v140, a88
v_accvgpr_read_b32 v141, a89
v_accvgpr_read_b32 v142, a90
v_accvgpr_read_b32 v143, a91
v_accvgpr_read_b32 v144, a92
v_accvgpr_read_b32 v145, a93
v_accvgpr_read_b32 v146, a94
v_accvgpr_read_b32 v147, a95
v_cvt_pk_bf16_f32 v116, v132, v133
v_cvt_pk_bf16_f32 v117, v134, v135
v_cvt_pk_bf16_f32 v118, v140, v141
v_cvt_pk_bf16_f32 v119, v142, v143
v_cvt_pk_bf16_f32 v120, v136, v137
v_cvt_pk_bf16_f32 v121, v138, v139
v_cvt_pk_bf16_f32 v122, v144, v145
v_cvt_pk_bf16_f32 v123, v146, v147
buffer_store_dwordx4 v[116:119], v110, s[20:23], s41 offen sc1
buffer_store_dwordx4 v[120:123], v110, s[20:23], s41 offen offset:512 sc1
s_add_u32 s41, s40, 786432
v_accvgpr_read_b32 v132, a96
v_accvgpr_read_b32 v133, a97
v_accvgpr_read_b32 v134, a98
v_accvgpr_read_b32 v135, a99
v_accvgpr_read_b32 v136, a100
v_accvgpr_read_b32 v137, a101
v_accvgpr_read_b32 v138, a102
v_accvgpr_read_b32 v139, a103
v_accvgpr_read_b32 v140, a104
v_accvgpr_read_b32 v141, a105
v_accvgpr_read_b32 v142, a106
v_accvgpr_read_b32 v143, a107
v_accvgpr_read_b32 v144, a108
v_accvgpr_read_b32 v145, a109
v_accvgpr_read_b32 v146, a110
v_accvgpr_read_b32 v147, a111
v_cvt_pk_bf16_f32 v116, v132, v133
v_cvt_pk_bf16_f32 v117, v134, v135
v_cvt_pk_bf16_f32 v118, v140, v141
v_cvt_pk_bf16_f32 v119, v142, v143
v_cvt_pk_bf16_f32 v120, v136, v137
v_cvt_pk_bf16_f32 v121, v138, v139
v_cvt_pk_bf16_f32 v122, v144, v145
v_cvt_pk_bf16_f32 v123, v146, v147
buffer_store_dwordx4 v[116:119], v110, s[20:23], s41 offen sc1
buffer_store_dwordx4 v[120:123], v110, s[20:23], s41 offen offset:512 sc1
s_add_u32 s41, s40, 787456
v_accvgpr_read_b32 v132, a112
v_accvgpr_read_b32 v133, a113
v_accvgpr_read_b32 v134, a114
v_accvgpr_read_b32 v135, a115
v_accvgpr_read_b32 v136, a116
v_accvgpr_read_b32 v137, a117
v_accvgpr_read_b32 v138, a118
v_accvgpr_read_b32 v139, a119
v_accvgpr_read_b32 v140, a120
v_accvgpr_read_b32 v141, a121
v_accvgpr_read_b32 v142, a122
v_accvgpr_read_b32 v143, a123
v_accvgpr_read_b32 v144, a124
v_accvgpr_read_b32 v145, a125
v_accvgpr_read_b32 v146, a126
v_accvgpr_read_b32 v147, a127
v_cvt_pk_bf16_f32 v116, v132, v133
v_cvt_pk_bf16_f32 v117, v134, v135
v_cvt_pk_bf16_f32 v118, v140, v141
v_cvt_pk_bf16_f32 v119, v142, v143
v_cvt_pk_bf16_f32 v120, v136, v137
v_cvt_pk_bf16_f32 v121, v138, v139
v_cvt_pk_bf16_f32 v122, v144, v145
v_cvt_pk_bf16_f32 v123, v146, v147
buffer_store_dwordx4 v[116:119], v110, s[20:23], s41 offen sc1
buffer_store_dwordx4 v[120:123], v110, s[20:23], s41 offen offset:512 sc1
s_add_u32 s41, s40, 788480
v_accvgpr_read_b32 v132, a128
v_accvgpr_read_b32 v133, a129
v_accvgpr_read_b32 v134, a130
v_accvgpr_read_b32 v135, a131
v_accvgpr_read_b32 v136, a132
v_accvgpr_read_b32 v137, a133
v_accvgpr_read_b32 v138, a134
v_accvgpr_read_b32 v139, a135
v_accvgpr_read_b32 v140, a136
v_accvgpr_read_b32 v141, a137
v_accvgpr_read_b32 v142, a138
v_accvgpr_read_b32 v143, a139
v_accvgpr_read_b32 v144, a140
v_accvgpr_read_b32 v145, a141
v_accvgpr_read_b32 v146, a142
v_accvgpr_read_b32 v147, a143
v_cvt_pk_bf16_f32 v116, v132, v133
v_cvt_pk_bf16_f32 v117, v134, v135
v_cvt_pk_bf16_f32 v118, v140, v141
v_cvt_pk_bf16_f32 v119, v142, v143
v_cvt_pk_bf16_f32 v120, v136, v137
v_cvt_pk_bf16_f32 v121, v138, v139
v_cvt_pk_bf16_f32 v122, v144, v145
v_cvt_pk_bf16_f32 v123, v146, v147
buffer_store_dwordx4 v[116:119], v110, s[20:23], s41 offen sc1
buffer_store_dwordx4 v[120:123], v110, s[20:23], s41 offen offset:512 sc1
s_add_u32 s41, s40, 1179648
v_accvgpr_read_b32 v132, a144
v_accvgpr_read_b32 v133, a145
v_accvgpr_read_b32 v134, a146
v_accvgpr_read_b32 v135, a147
v_accvgpr_read_b32 v136, a148
v_accvgpr_read_b32 v137, a149
v_accvgpr_read_b32 v138, a150
v_accvgpr_read_b32 v139, a151
v_accvgpr_read_b32 v140, a152
v_accvgpr_read_b32 v141, a153
v_accvgpr_read_b32 v142, a154
v_accvgpr_read_b32 v143, a155
v_accvgpr_read_b32 v144, a156
v_accvgpr_read_b32 v145, a157
v_accvgpr_read_b32 v146, a158
v_accvgpr_read_b32 v147, a159
v_cvt_pk_bf16_f32 v116, v132, v133
v_cvt_pk_bf16_f32 v117, v134, v135
v_cvt_pk_bf16_f32 v118, v140, v141
v_cvt_pk_bf16_f32 v119, v142, v143
v_cvt_pk_bf16_f32 v120, v136, v137
v_cvt_pk_bf16_f32 v121, v138, v139
v_cvt_pk_bf16_f32 v122, v144, v145
v_cvt_pk_bf16_f32 v123, v146, v147
buffer_store_dwordx4 v[116:119], v110, s[20:23], s41 offen sc1
buffer_store_dwordx4 v[120:123], v110, s[20:23], s41 offen offset:512 sc1
s_add_u32 s41, s40, 1180672
v_accvgpr_read_b32 v132, a160
v_accvgpr_read_b32 v133, a161
v_accvgpr_read_b32 v134, a162
v_accvgpr_read_b32 v135, a163
v_accvgpr_read_b32 v136, a164
v_accvgpr_read_b32 v137, a165
v_accvgpr_read_b32 v138, a166
v_accvgpr_read_b32 v139, a167
v_accvgpr_read_b32 v140, a168
v_accvgpr_read_b32 v141, a169
v_accvgpr_read_b32 v142, a170
v_accvgpr_read_b32 v143, a171
v_accvgpr_read_b32 v144, a172
v_accvgpr_read_b32 v145, a173
v_accvgpr_read_b32 v146, a174
v_accvgpr_read_b32 v147, a175
v_cvt_pk_bf16_f32 v116, v132, v133
v_cvt_pk_bf16_f32 v117, v134, v135
v_cvt_pk_bf16_f32 v118, v140, v141
v_cvt_pk_bf16_f32 v119, v142, v143
v_cvt_pk_bf16_f32 v120, v136, v137
v_cvt_pk_bf16_f32 v121, v138, v139
v_cvt_pk_bf16_f32 v122, v144, v145
v_cvt_pk_bf16_f32 v123, v146, v147
buffer_store_dwordx4 v[116:119], v110, s[20:23], s41 offen sc1
buffer_store_dwordx4 v[120:123], v110, s[20:23], s41 offen offset:512 sc1
s_add_u32 s41, s40, 1181696
v_accvgpr_read_b32 v132, a176
v_accvgpr_read_b32 v133, a177
v_accvgpr_read_b32 v134, a178
v_accvgpr_read_b32 v135, a179
v_accvgpr_read_b32 v136, a180
v_accvgpr_read_b32 v137, a181
v_accvgpr_read_b32 v138, a182
v_accvgpr_read_b32 v139, a183
v_accvgpr_read_b32 v140, a184
v_accvgpr_read_b32 v141, a185
v_accvgpr_read_b32 v142, a186
v_accvgpr_read_b32 v143, a187
v_accvgpr_read_b32 v144, a188
v_accvgpr_read_b32 v145, a189
v_accvgpr_read_b32 v146, a190
v_accvgpr_read_b32 v147, a191
v_cvt_pk_bf16_f32 v116, v132, v133
v_cvt_pk_bf16_f32 v117, v134, v135
v_cvt_pk_bf16_f32 v118, v140, v141
v_cvt_pk_bf16_f32 v119, v142, v143
v_cvt_pk_bf16_f32 v120, v136, v137
v_cvt_pk_bf16_f32 v121, v138, v139
v_cvt_pk_bf16_f32 v122, v144, v145
v_cvt_pk_bf16_f32 v123, v146, v147
buffer_store_dwordx4 v[116:119], v110, s[20:23], s41 offen sc1
buffer_store_dwordx4 v[120:123], v110, s[20:23], s41 offen offset:512 sc1
s_mov_b32 s60, 178470912
s_cmp_eq_u32 s58, 0
s_cselect_b32 s60, 178466816, s60
s_lshl_b32 s61, s29, 9
s_add_u32 s60, s60, s61
s_branch L_g1_next_B
L_g1_ffn_B:
s_mov_b32 s80, s18
s_mov_b32 s81, s19
s_mov_b32 s82, 3072
s_mov_b32 s83, 0x00020000
s_lshr_b32 s60, s28, 1
s_and_b32 s61, s28, 1
s_mul_i32 s40, s52, 786432
s_lshl_b32 s60, s60, 13
s_add_u32 s40, s40, s60
s_mul_i32 s60, s59, 192
s_mul_i32 s61, s61, 96
s_add_u32 s60, s60, s61
s_lshl_b32 s61, s60, 1
s_lshl_b32 s60, s60, 9
s_add_u32 s40, s40, s60
s_add_u32 s40, s40, 93532160
v_lshrrev_b32 v4, 5, v1
v_lshlrev_b32 v4, 3, v4
s_add_u32 s41, s61, 0
buffer_load_dwordx2 v[124:125], v4, s[80:83], s41 offen offset:0
buffer_load_dwordx2 v[126:127], v4, s[80:83], s41 offen offset:16
buffer_load_dwordx2 v[128:129], v4, s[80:83], s41 offen offset:32
buffer_load_dwordx2 v[130:131], v4, s[80:83], s41 offen offset:48
s_waitcnt vmcnt(0)
v_accvgpr_read_b32 v132, a0
v_accvgpr_read_b32 v133, a1
v_accvgpr_read_b32 v134, a2
v_accvgpr_read_b32 v135, a3
v_accvgpr_read_b32 v136, a4
v_accvgpr_read_b32 v137, a5
v_accvgpr_read_b32 v138, a6
v_accvgpr_read_b32 v139, a7
v_accvgpr_read_b32 v140, a8
v_accvgpr_read_b32 v141, a9
v_accvgpr_read_b32 v142, a10
v_accvgpr_read_b32 v143, a11
v_accvgpr_read_b32 v144, a12
v_accvgpr_read_b32 v145, a13
v_accvgpr_read_b32 v146, a14
v_accvgpr_read_b32 v147, a15
v_cvt_pk_bf16_f32 v116, v132, v133
v_lshlrev_b32 v132, 16, v116
v_and_b32 v133, 0xffff0000, v116
v_lshlrev_b32 v117, 16, v124
v_and_b32 v118, 0xffff0000, v124
v_add_f32 v132, v132, v117
v_add_f32 v133, v133, v118
v_cvt_pk_bf16_f32 v116, v132, v133
v_lshlrev_b32 v132, 16, v116
v_and_b32 v133, 0xffff0000, v116
v_max_f32 v132, 0, v132
v_max_f32 v133, 0, v133
v_mul_f32 v132, v132, v132
v_mul_f32 v133, v133, v133
v_cvt_pk_bf16_f32 v116, v134, v135
v_lshlrev_b32 v134, 16, v116
v_and_b32 v135, 0xffff0000, v116
v_lshlrev_b32 v117, 16, v125
v_and_b32 v118, 0xffff0000, v125
v_add_f32 v134, v134, v117
v_add_f32 v135, v135, v118
v_cvt_pk_bf16_f32 v116, v134, v135
v_lshlrev_b32 v134, 16, v116
v_and_b32 v135, 0xffff0000, v116
v_max_f32 v134, 0, v134
v_max_f32 v135, 0, v135
v_mul_f32 v134, v134, v134
v_mul_f32 v135, v135, v135
v_cvt_pk_bf16_f32 v116, v136, v137
v_lshlrev_b32 v136, 16, v116
v_and_b32 v137, 0xffff0000, v116
v_lshlrev_b32 v117, 16, v126
v_and_b32 v118, 0xffff0000, v126
v_add_f32 v136, v136, v117
v_add_f32 v137, v137, v118
v_cvt_pk_bf16_f32 v116, v136, v137
v_lshlrev_b32 v136, 16, v116
v_and_b32 v137, 0xffff0000, v116
v_max_f32 v136, 0, v136
v_max_f32 v137, 0, v137
v_mul_f32 v136, v136, v136
v_mul_f32 v137, v137, v137
v_cvt_pk_bf16_f32 v116, v138, v139
v_lshlrev_b32 v138, 16, v116
v_and_b32 v139, 0xffff0000, v116
v_lshlrev_b32 v117, 16, v127
v_and_b32 v118, 0xffff0000, v127
v_add_f32 v138, v138, v117
v_add_f32 v139, v139, v118
v_cvt_pk_bf16_f32 v116, v138, v139
v_lshlrev_b32 v138, 16, v116
v_and_b32 v139, 0xffff0000, v116
v_max_f32 v138, 0, v138
v_max_f32 v139, 0, v139
v_mul_f32 v138, v138, v138
v_mul_f32 v139, v139, v139
v_cvt_pk_bf16_f32 v116, v140, v141
v_lshlrev_b32 v140, 16, v116
v_and_b32 v141, 0xffff0000, v116
v_lshlrev_b32 v117, 16, v128
v_and_b32 v118, 0xffff0000, v128
v_add_f32 v140, v140, v117
v_add_f32 v141, v141, v118
v_cvt_pk_bf16_f32 v116, v140, v141
v_lshlrev_b32 v140, 16, v116
v_and_b32 v141, 0xffff0000, v116
v_max_f32 v140, 0, v140
v_max_f32 v141, 0, v141
v_mul_f32 v140, v140, v140
v_mul_f32 v141, v141, v141
v_cvt_pk_bf16_f32 v116, v142, v143
v_lshlrev_b32 v142, 16, v116
v_and_b32 v143, 0xffff0000, v116
v_lshlrev_b32 v117, 16, v129
v_and_b32 v118, 0xffff0000, v129
v_add_f32 v142, v142, v117
v_add_f32 v143, v143, v118
v_cvt_pk_bf16_f32 v116, v142, v143
v_lshlrev_b32 v142, 16, v116
v_and_b32 v143, 0xffff0000, v116
v_max_f32 v142, 0, v142
v_max_f32 v143, 0, v143
v_mul_f32 v142, v142, v142
v_mul_f32 v143, v143, v143
v_cvt_pk_bf16_f32 v116, v144, v145
v_lshlrev_b32 v144, 16, v116
v_and_b32 v145, 0xffff0000, v116
v_lshlrev_b32 v117, 16, v130
v_and_b32 v118, 0xffff0000, v130
v_add_f32 v144, v144, v117
v_add_f32 v145, v145, v118
v_cvt_pk_bf16_f32 v116, v144, v145
v_lshlrev_b32 v144, 16, v116
v_and_b32 v145, 0xffff0000, v116
v_max_f32 v144, 0, v144
v_max_f32 v145, 0, v145
v_mul_f32 v144, v144, v144
v_mul_f32 v145, v145, v145
v_cvt_pk_bf16_f32 v116, v146, v147
v_lshlrev_b32 v146, 16, v116
v_and_b32 v147, 0xffff0000, v116
v_lshlrev_b32 v117, 16, v131
v_and_b32 v118, 0xffff0000, v131
v_add_f32 v146, v146, v117
v_add_f32 v147, v147, v118
v_cvt_pk_bf16_f32 v116, v146, v147
v_lshlrev_b32 v146, 16, v116
v_and_b32 v147, 0xffff0000, v116
v_max_f32 v146, 0, v146
v_max_f32 v147, 0, v147
v_mul_f32 v146, v146, v146
v_mul_f32 v147, v147, v147
v_cvt_pk_bf16_f32 v116, v132, v133
v_cvt_pk_bf16_f32 v117, v134, v135
v_cvt_pk_bf16_f32 v118, v140, v141
v_cvt_pk_bf16_f32 v119, v142, v143
v_cvt_pk_bf16_f32 v120, v136, v137
v_cvt_pk_bf16_f32 v121, v138, v139
v_cvt_pk_bf16_f32 v122, v144, v145
v_cvt_pk_bf16_f32 v123, v146, v147
s_add_u32 s41, s40, 0
buffer_store_dwordx4 v[116:119], v112, s[20:23], s41 offen sc1
buffer_store_dwordx4 v[120:123], v148, s[20:23], s41 offen sc1
v_accvgpr_read_b32 v132, a48
v_accvgpr_read_b32 v133, a49
v_accvgpr_read_b32 v134, a50
v_accvgpr_read_b32 v135, a51
v_accvgpr_read_b32 v136, a52
v_accvgpr_read_b32 v137, a53
v_accvgpr_read_b32 v138, a54
v_accvgpr_read_b32 v139, a55
v_accvgpr_read_b32 v140, a56
v_accvgpr_read_b32 v141, a57
v_accvgpr_read_b32 v142, a58
v_accvgpr_read_b32 v143, a59
v_accvgpr_read_b32 v144, a60
v_accvgpr_read_b32 v145, a61
v_accvgpr_read_b32 v146, a62
v_accvgpr_read_b32 v147, a63
v_cvt_pk_bf16_f32 v116, v132, v133
v_lshlrev_b32 v132, 16, v116
v_and_b32 v133, 0xffff0000, v116
v_lshlrev_b32 v117, 16, v124
v_and_b32 v118, 0xffff0000, v124
v_add_f32 v132, v132, v117
v_add_f32 v133, v133, v118
v_cvt_pk_bf16_f32 v116, v132, v133
v_lshlrev_b32 v132, 16, v116
v_and_b32 v133, 0xffff0000, v116
v_max_f32 v132, 0, v132
v_max_f32 v133, 0, v133
v_mul_f32 v132, v132, v132
v_mul_f32 v133, v133, v133
v_cvt_pk_bf16_f32 v116, v134, v135
v_lshlrev_b32 v134, 16, v116
v_and_b32 v135, 0xffff0000, v116
v_lshlrev_b32 v117, 16, v125
v_and_b32 v118, 0xffff0000, v125
v_add_f32 v134, v134, v117
v_add_f32 v135, v135, v118
v_cvt_pk_bf16_f32 v116, v134, v135
v_lshlrev_b32 v134, 16, v116
v_and_b32 v135, 0xffff0000, v116
v_max_f32 v134, 0, v134
v_max_f32 v135, 0, v135
v_mul_f32 v134, v134, v134
v_mul_f32 v135, v135, v135
v_cvt_pk_bf16_f32 v116, v136, v137
v_lshlrev_b32 v136, 16, v116
v_and_b32 v137, 0xffff0000, v116
v_lshlrev_b32 v117, 16, v126
v_and_b32 v118, 0xffff0000, v126
v_add_f32 v136, v136, v117
v_add_f32 v137, v137, v118
v_cvt_pk_bf16_f32 v116, v136, v137
v_lshlrev_b32 v136, 16, v116
v_and_b32 v137, 0xffff0000, v116
v_max_f32 v136, 0, v136
v_max_f32 v137, 0, v137
v_mul_f32 v136, v136, v136
v_mul_f32 v137, v137, v137
v_cvt_pk_bf16_f32 v116, v138, v139
v_lshlrev_b32 v138, 16, v116
v_and_b32 v139, 0xffff0000, v116
v_lshlrev_b32 v117, 16, v127
v_and_b32 v118, 0xffff0000, v127
v_add_f32 v138, v138, v117
v_add_f32 v139, v139, v118
v_cvt_pk_bf16_f32 v116, v138, v139
v_lshlrev_b32 v138, 16, v116
v_and_b32 v139, 0xffff0000, v116
v_max_f32 v138, 0, v138
v_max_f32 v139, 0, v139
v_mul_f32 v138, v138, v138
v_mul_f32 v139, v139, v139
v_cvt_pk_bf16_f32 v116, v140, v141
v_lshlrev_b32 v140, 16, v116
v_and_b32 v141, 0xffff0000, v116
v_lshlrev_b32 v117, 16, v128
v_and_b32 v118, 0xffff0000, v128
v_add_f32 v140, v140, v117
v_add_f32 v141, v141, v118
v_cvt_pk_bf16_f32 v116, v140, v141
v_lshlrev_b32 v140, 16, v116
v_and_b32 v141, 0xffff0000, v116
v_max_f32 v140, 0, v140
v_max_f32 v141, 0, v141
v_mul_f32 v140, v140, v140
v_mul_f32 v141, v141, v141
v_cvt_pk_bf16_f32 v116, v142, v143
v_lshlrev_b32 v142, 16, v116
v_and_b32 v143, 0xffff0000, v116
v_lshlrev_b32 v117, 16, v129
v_and_b32 v118, 0xffff0000, v129
v_add_f32 v142, v142, v117
v_add_f32 v143, v143, v118
v_cvt_pk_bf16_f32 v116, v142, v143
v_lshlrev_b32 v142, 16, v116
v_and_b32 v143, 0xffff0000, v116
v_max_f32 v142, 0, v142
v_max_f32 v143, 0, v143
v_mul_f32 v142, v142, v142
v_mul_f32 v143, v143, v143
v_cvt_pk_bf16_f32 v116, v144, v145
v_lshlrev_b32 v144, 16, v116
v_and_b32 v145, 0xffff0000, v116
v_lshlrev_b32 v117, 16, v130
v_and_b32 v118, 0xffff0000, v130
v_add_f32 v144, v144, v117
v_add_f32 v145, v145, v118
v_cvt_pk_bf16_f32 v116, v144, v145
v_lshlrev_b32 v144, 16, v116
v_and_b32 v145, 0xffff0000, v116
v_max_f32 v144, 0, v144
v_max_f32 v145, 0, v145
v_mul_f32 v144, v144, v144
v_mul_f32 v145, v145, v145
v_cvt_pk_bf16_f32 v116, v146, v147
v_lshlrev_b32 v146, 16, v116
v_and_b32 v147, 0xffff0000, v116
v_lshlrev_b32 v117, 16, v131
v_and_b32 v118, 0xffff0000, v131
v_add_f32 v146, v146, v117
v_add_f32 v147, v147, v118
v_cvt_pk_bf16_f32 v116, v146, v147
v_lshlrev_b32 v146, 16, v116
v_and_b32 v147, 0xffff0000, v116
v_max_f32 v146, 0, v146
v_max_f32 v147, 0, v147
v_mul_f32 v146, v146, v146
v_mul_f32 v147, v147, v147
v_cvt_pk_bf16_f32 v116, v132, v133
v_cvt_pk_bf16_f32 v117, v134, v135
v_cvt_pk_bf16_f32 v118, v140, v141
v_cvt_pk_bf16_f32 v119, v142, v143
v_cvt_pk_bf16_f32 v120, v136, v137
v_cvt_pk_bf16_f32 v121, v138, v139
v_cvt_pk_bf16_f32 v122, v144, v145
v_cvt_pk_bf16_f32 v123, v146, v147
s_add_u32 s41, s40, 2048
buffer_store_dwordx4 v[116:119], v112, s[20:23], s41 offen sc1
buffer_store_dwordx4 v[120:123], v148, s[20:23], s41 offen sc1
v_accvgpr_read_b32 v132, a96
v_accvgpr_read_b32 v133, a97
v_accvgpr_read_b32 v134, a98
v_accvgpr_read_b32 v135, a99
v_accvgpr_read_b32 v136, a100
v_accvgpr_read_b32 v137, a101
v_accvgpr_read_b32 v138, a102
v_accvgpr_read_b32 v139, a103
v_accvgpr_read_b32 v140, a104
v_accvgpr_read_b32 v141, a105
v_accvgpr_read_b32 v142, a106
v_accvgpr_read_b32 v143, a107
v_accvgpr_read_b32 v144, a108
v_accvgpr_read_b32 v145, a109
v_accvgpr_read_b32 v146, a110
v_accvgpr_read_b32 v147, a111
v_cvt_pk_bf16_f32 v116, v132, v133
v_lshlrev_b32 v132, 16, v116
v_and_b32 v133, 0xffff0000, v116
v_lshlrev_b32 v117, 16, v124
v_and_b32 v118, 0xffff0000, v124
v_add_f32 v132, v132, v117
v_add_f32 v133, v133, v118
v_cvt_pk_bf16_f32 v116, v132, v133
v_lshlrev_b32 v132, 16, v116
v_and_b32 v133, 0xffff0000, v116
v_max_f32 v132, 0, v132
v_max_f32 v133, 0, v133
v_mul_f32 v132, v132, v132
v_mul_f32 v133, v133, v133
v_cvt_pk_bf16_f32 v116, v134, v135
v_lshlrev_b32 v134, 16, v116
v_and_b32 v135, 0xffff0000, v116
v_lshlrev_b32 v117, 16, v125
v_and_b32 v118, 0xffff0000, v125
v_add_f32 v134, v134, v117
v_add_f32 v135, v135, v118
v_cvt_pk_bf16_f32 v116, v134, v135
v_lshlrev_b32 v134, 16, v116
v_and_b32 v135, 0xffff0000, v116
v_max_f32 v134, 0, v134
v_max_f32 v135, 0, v135
v_mul_f32 v134, v134, v134
v_mul_f32 v135, v135, v135
v_cvt_pk_bf16_f32 v116, v136, v137
v_lshlrev_b32 v136, 16, v116
v_and_b32 v137, 0xffff0000, v116
v_lshlrev_b32 v117, 16, v126
v_and_b32 v118, 0xffff0000, v126
v_add_f32 v136, v136, v117
v_add_f32 v137, v137, v118
v_cvt_pk_bf16_f32 v116, v136, v137
v_lshlrev_b32 v136, 16, v116
v_and_b32 v137, 0xffff0000, v116
v_max_f32 v136, 0, v136
v_max_f32 v137, 0, v137
v_mul_f32 v136, v136, v136
v_mul_f32 v137, v137, v137
v_cvt_pk_bf16_f32 v116, v138, v139
v_lshlrev_b32 v138, 16, v116
v_and_b32 v139, 0xffff0000, v116
v_lshlrev_b32 v117, 16, v127
v_and_b32 v118, 0xffff0000, v127
v_add_f32 v138, v138, v117
v_add_f32 v139, v139, v118
v_cvt_pk_bf16_f32 v116, v138, v139
v_lshlrev_b32 v138, 16, v116
v_and_b32 v139, 0xffff0000, v116
v_max_f32 v138, 0, v138
v_max_f32 v139, 0, v139
v_mul_f32 v138, v138, v138
v_mul_f32 v139, v139, v139
v_cvt_pk_bf16_f32 v116, v140, v141
v_lshlrev_b32 v140, 16, v116
v_and_b32 v141, 0xffff0000, v116
v_lshlrev_b32 v117, 16, v128
v_and_b32 v118, 0xffff0000, v128
v_add_f32 v140, v140, v117
v_add_f32 v141, v141, v118
v_cvt_pk_bf16_f32 v116, v140, v141
v_lshlrev_b32 v140, 16, v116
v_and_b32 v141, 0xffff0000, v116
v_max_f32 v140, 0, v140
v_max_f32 v141, 0, v141
v_mul_f32 v140, v140, v140
v_mul_f32 v141, v141, v141
v_cvt_pk_bf16_f32 v116, v142, v143
v_lshlrev_b32 v142, 16, v116
v_and_b32 v143, 0xffff0000, v116
v_lshlrev_b32 v117, 16, v129
v_and_b32 v118, 0xffff0000, v129
v_add_f32 v142, v142, v117
v_add_f32 v143, v143, v118
v_cvt_pk_bf16_f32 v116, v142, v143
v_lshlrev_b32 v142, 16, v116
v_and_b32 v143, 0xffff0000, v116
v_max_f32 v142, 0, v142
v_max_f32 v143, 0, v143
v_mul_f32 v142, v142, v142
v_mul_f32 v143, v143, v143
v_cvt_pk_bf16_f32 v116, v144, v145
v_lshlrev_b32 v144, 16, v116
v_and_b32 v145, 0xffff0000, v116
v_lshlrev_b32 v117, 16, v130
v_and_b32 v118, 0xffff0000, v130
v_add_f32 v144, v144, v117
v_add_f32 v145, v145, v118
v_cvt_pk_bf16_f32 v116, v144, v145
v_lshlrev_b32 v144, 16, v116
v_and_b32 v145, 0xffff0000, v116
v_max_f32 v144, 0, v144
v_max_f32 v145, 0, v145
v_mul_f32 v144, v144, v144
v_mul_f32 v145, v145, v145
v_cvt_pk_bf16_f32 v116, v146, v147
v_lshlrev_b32 v146, 16, v116
v_and_b32 v147, 0xffff0000, v116
v_lshlrev_b32 v117, 16, v131
v_and_b32 v118, 0xffff0000, v131
v_add_f32 v146, v146, v117
v_add_f32 v147, v147, v118
v_cvt_pk_bf16_f32 v116, v146, v147
v_lshlrev_b32 v146, 16, v116
v_and_b32 v147, 0xffff0000, v116
v_max_f32 v146, 0, v146
v_max_f32 v147, 0, v147
v_mul_f32 v146, v146, v146
v_mul_f32 v147, v147, v147
v_cvt_pk_bf16_f32 v116, v132, v133
v_cvt_pk_bf16_f32 v117, v134, v135
v_cvt_pk_bf16_f32 v118, v140, v141
v_cvt_pk_bf16_f32 v119, v142, v143
v_cvt_pk_bf16_f32 v120, v136, v137
v_cvt_pk_bf16_f32 v121, v138, v139
v_cvt_pk_bf16_f32 v122, v144, v145
v_cvt_pk_bf16_f32 v123, v146, v147
s_add_u32 s41, s40, 4096
buffer_store_dwordx4 v[116:119], v112, s[20:23], s41 offen sc1
buffer_store_dwordx4 v[120:123], v148, s[20:23], s41 offen sc1
v_accvgpr_read_b32 v132, a144
v_accvgpr_read_b32 v133, a145
v_accvgpr_read_b32 v134, a146
v_accvgpr_read_b32 v135, a147
v_accvgpr_read_b32 v136, a148
v_accvgpr_read_b32 v137, a149
v_accvgpr_read_b32 v138, a150
v_accvgpr_read_b32 v139, a151
v_accvgpr_read_b32 v140, a152
v_accvgpr_read_b32 v141, a153
v_accvgpr_read_b32 v142, a154
v_accvgpr_read_b32 v143, a155
v_accvgpr_read_b32 v144, a156
v_accvgpr_read_b32 v145, a157
v_accvgpr_read_b32 v146, a158
v_accvgpr_read_b32 v147, a159
v_cvt_pk_bf16_f32 v116, v132, v133
v_lshlrev_b32 v132, 16, v116
v_and_b32 v133, 0xffff0000, v116
v_lshlrev_b32 v117, 16, v124
v_and_b32 v118, 0xffff0000, v124
v_add_f32 v132, v132, v117
v_add_f32 v133, v133, v118
v_cvt_pk_bf16_f32 v116, v132, v133
v_lshlrev_b32 v132, 16, v116
v_and_b32 v133, 0xffff0000, v116
v_max_f32 v132, 0, v132
v_max_f32 v133, 0, v133
v_mul_f32 v132, v132, v132
v_mul_f32 v133, v133, v133
v_cvt_pk_bf16_f32 v116, v134, v135
v_lshlrev_b32 v134, 16, v116
v_and_b32 v135, 0xffff0000, v116
v_lshlrev_b32 v117, 16, v125
v_and_b32 v118, 0xffff0000, v125
v_add_f32 v134, v134, v117
v_add_f32 v135, v135, v118
v_cvt_pk_bf16_f32 v116, v134, v135
v_lshlrev_b32 v134, 16, v116
v_and_b32 v135, 0xffff0000, v116
v_max_f32 v134, 0, v134
v_max_f32 v135, 0, v135
v_mul_f32 v134, v134, v134
v_mul_f32 v135, v135, v135
v_cvt_pk_bf16_f32 v116, v136, v137
v_lshlrev_b32 v136, 16, v116
v_and_b32 v137, 0xffff0000, v116
v_lshlrev_b32 v117, 16, v126
v_and_b32 v118, 0xffff0000, v126
v_add_f32 v136, v136, v117
v_add_f32 v137, v137, v118
v_cvt_pk_bf16_f32 v116, v136, v137
v_lshlrev_b32 v136, 16, v116
v_and_b32 v137, 0xffff0000, v116
v_max_f32 v136, 0, v136
v_max_f32 v137, 0, v137
v_mul_f32 v136, v136, v136
v_mul_f32 v137, v137, v137
v_cvt_pk_bf16_f32 v116, v138, v139
v_lshlrev_b32 v138, 16, v116
v_and_b32 v139, 0xffff0000, v116
v_lshlrev_b32 v117, 16, v127
v_and_b32 v118, 0xffff0000, v127
v_add_f32 v138, v138, v117
v_add_f32 v139, v139, v118
v_cvt_pk_bf16_f32 v116, v138, v139
v_lshlrev_b32 v138, 16, v116
v_and_b32 v139, 0xffff0000, v116
v_max_f32 v138, 0, v138
v_max_f32 v139, 0, v139
v_mul_f32 v138, v138, v138
v_mul_f32 v139, v139, v139
v_cvt_pk_bf16_f32 v116, v140, v141
v_lshlrev_b32 v140, 16, v116
v_and_b32 v141, 0xffff0000, v116
v_lshlrev_b32 v117, 16, v128
v_and_b32 v118, 0xffff0000, v128
v_add_f32 v140, v140, v117
v_add_f32 v141, v141, v118
v_cvt_pk_bf16_f32 v116, v140, v141
v_lshlrev_b32 v140, 16, v116
v_and_b32 v141, 0xffff0000, v116
v_max_f32 v140, 0, v140
v_max_f32 v141, 0, v141
v_mul_f32 v140, v140, v140
v_mul_f32 v141, v141, v141
v_cvt_pk_bf16_f32 v116, v142, v143
v_lshlrev_b32 v142, 16, v116
v_and_b32 v143, 0xffff0000, v116
v_lshlrev_b32 v117, 16, v129
v_and_b32 v118, 0xffff0000, v129
v_add_f32 v142, v142, v117
v_add_f32 v143, v143, v118
v_cvt_pk_bf16_f32 v116, v142, v143
v_lshlrev_b32 v142, 16, v116
v_and_b32 v143, 0xffff0000, v116
v_max_f32 v142, 0, v142
v_max_f32 v143, 0, v143
v_mul_f32 v142, v142, v142
v_mul_f32 v143, v143, v143
v_cvt_pk_bf16_f32 v116, v144, v145
v_lshlrev_b32 v144, 16, v116
v_and_b32 v145, 0xffff0000, v116
v_lshlrev_b32 v117, 16, v130
v_and_b32 v118, 0xffff0000, v130
v_add_f32 v144, v144, v117
v_add_f32 v145, v145, v118
v_cvt_pk_bf16_f32 v116, v144, v145
v_lshlrev_b32 v144, 16, v116
v_and_b32 v145, 0xffff0000, v116
v_max_f32 v144, 0, v144
v_max_f32 v145, 0, v145
v_mul_f32 v144, v144, v144
v_mul_f32 v145, v145, v145
v_cvt_pk_bf16_f32 v116, v146, v147
v_lshlrev_b32 v146, 16, v116
v_and_b32 v147, 0xffff0000, v116
v_lshlrev_b32 v117, 16, v131
v_and_b32 v118, 0xffff0000, v131
v_add_f32 v146, v146, v117
v_add_f32 v147, v147, v118
v_cvt_pk_bf16_f32 v116, v146, v147
v_lshlrev_b32 v146, 16, v116
v_and_b32 v147, 0xffff0000, v116
v_max_f32 v146, 0, v146
v_max_f32 v147, 0, v147
v_mul_f32 v146, v146, v146
v_mul_f32 v147, v147, v147
v_cvt_pk_bf16_f32 v116, v132, v133
v_cvt_pk_bf16_f32 v117, v134, v135
v_cvt_pk_bf16_f32 v118, v140, v141
v_cvt_pk_bf16_f32 v119, v142, v143
v_cvt_pk_bf16_f32 v120, v136, v137
v_cvt_pk_bf16_f32 v121, v138, v139
v_cvt_pk_bf16_f32 v122, v144, v145
v_cvt_pk_bf16_f32 v123, v146, v147
s_add_u32 s41, s40, 6144
buffer_store_dwordx4 v[116:119], v112, s[20:23], s41 offen sc1
buffer_store_dwordx4 v[120:123], v148, s[20:23], s41 offen sc1
s_add_u32 s41, s61, 64
buffer_load_dwordx2 v[124:125], v4, s[80:83], s41 offen offset:0
buffer_load_dwordx2 v[126:127], v4, s[80:83], s41 offen offset:16
buffer_load_dwordx2 v[128:129], v4, s[80:83], s41 offen offset:32
buffer_load_dwordx2 v[130:131], v4, s[80:83], s41 offen offset:48
s_waitcnt vmcnt(0)
v_accvgpr_read_b32 v132, a16
v_accvgpr_read_b32 v133, a17
v_accvgpr_read_b32 v134, a18
v_accvgpr_read_b32 v135, a19
v_accvgpr_read_b32 v136, a20
v_accvgpr_read_b32 v137, a21
v_accvgpr_read_b32 v138, a22
v_accvgpr_read_b32 v139, a23
v_accvgpr_read_b32 v140, a24
v_accvgpr_read_b32 v141, a25
v_accvgpr_read_b32 v142, a26
v_accvgpr_read_b32 v143, a27
v_accvgpr_read_b32 v144, a28
v_accvgpr_read_b32 v145, a29
v_accvgpr_read_b32 v146, a30
v_accvgpr_read_b32 v147, a31
v_cvt_pk_bf16_f32 v116, v132, v133
v_lshlrev_b32 v132, 16, v116
v_and_b32 v133, 0xffff0000, v116
v_lshlrev_b32 v117, 16, v124
v_and_b32 v118, 0xffff0000, v124
v_add_f32 v132, v132, v117
v_add_f32 v133, v133, v118
v_cvt_pk_bf16_f32 v116, v132, v133
v_lshlrev_b32 v132, 16, v116
v_and_b32 v133, 0xffff0000, v116
v_max_f32 v132, 0, v132
v_max_f32 v133, 0, v133
v_mul_f32 v132, v132, v132
v_mul_f32 v133, v133, v133
v_cvt_pk_bf16_f32 v116, v134, v135
v_lshlrev_b32 v134, 16, v116
v_and_b32 v135, 0xffff0000, v116
v_lshlrev_b32 v117, 16, v125
v_and_b32 v118, 0xffff0000, v125
v_add_f32 v134, v134, v117
v_add_f32 v135, v135, v118
v_cvt_pk_bf16_f32 v116, v134, v135
v_lshlrev_b32 v134, 16, v116
v_and_b32 v135, 0xffff0000, v116
v_max_f32 v134, 0, v134
v_max_f32 v135, 0, v135
v_mul_f32 v134, v134, v134
v_mul_f32 v135, v135, v135
v_cvt_pk_bf16_f32 v116, v136, v137
v_lshlrev_b32 v136, 16, v116
v_and_b32 v137, 0xffff0000, v116
v_lshlrev_b32 v117, 16, v126
v_and_b32 v118, 0xffff0000, v126
v_add_f32 v136, v136, v117
v_add_f32 v137, v137, v118
v_cvt_pk_bf16_f32 v116, v136, v137
v_lshlrev_b32 v136, 16, v116
v_and_b32 v137, 0xffff0000, v116
v_max_f32 v136, 0, v136
v_max_f32 v137, 0, v137
v_mul_f32 v136, v136, v136
v_mul_f32 v137, v137, v137
v_cvt_pk_bf16_f32 v116, v138, v139
v_lshlrev_b32 v138, 16, v116
v_and_b32 v139, 0xffff0000, v116
v_lshlrev_b32 v117, 16, v127
v_and_b32 v118, 0xffff0000, v127
v_add_f32 v138, v138, v117
v_add_f32 v139, v139, v118
v_cvt_pk_bf16_f32 v116, v138, v139
v_lshlrev_b32 v138, 16, v116
v_and_b32 v139, 0xffff0000, v116
v_max_f32 v138, 0, v138
v_max_f32 v139, 0, v139
v_mul_f32 v138, v138, v138
v_mul_f32 v139, v139, v139
v_cvt_pk_bf16_f32 v116, v140, v141
v_lshlrev_b32 v140, 16, v116
v_and_b32 v141, 0xffff0000, v116
v_lshlrev_b32 v117, 16, v128
v_and_b32 v118, 0xffff0000, v128
v_add_f32 v140, v140, v117
v_add_f32 v141, v141, v118
v_cvt_pk_bf16_f32 v116, v140, v141
v_lshlrev_b32 v140, 16, v116
v_and_b32 v141, 0xffff0000, v116
v_max_f32 v140, 0, v140
v_max_f32 v141, 0, v141
v_mul_f32 v140, v140, v140
v_mul_f32 v141, v141, v141
v_cvt_pk_bf16_f32 v116, v142, v143
v_lshlrev_b32 v142, 16, v116
v_and_b32 v143, 0xffff0000, v116
v_lshlrev_b32 v117, 16, v129
v_and_b32 v118, 0xffff0000, v129
v_add_f32 v142, v142, v117
v_add_f32 v143, v143, v118
v_cvt_pk_bf16_f32 v116, v142, v143
v_lshlrev_b32 v142, 16, v116
v_and_b32 v143, 0xffff0000, v116
v_max_f32 v142, 0, v142
v_max_f32 v143, 0, v143
v_mul_f32 v142, v142, v142
v_mul_f32 v143, v143, v143
v_cvt_pk_bf16_f32 v116, v144, v145
v_lshlrev_b32 v144, 16, v116
v_and_b32 v145, 0xffff0000, v116
v_lshlrev_b32 v117, 16, v130
v_and_b32 v118, 0xffff0000, v130
v_add_f32 v144, v144, v117
v_add_f32 v145, v145, v118
v_cvt_pk_bf16_f32 v116, v144, v145
v_lshlrev_b32 v144, 16, v116
v_and_b32 v145, 0xffff0000, v116
v_max_f32 v144, 0, v144
v_max_f32 v145, 0, v145
v_mul_f32 v144, v144, v144
v_mul_f32 v145, v145, v145
v_cvt_pk_bf16_f32 v116, v146, v147
v_lshlrev_b32 v146, 16, v116
v_and_b32 v147, 0xffff0000, v116
v_lshlrev_b32 v117, 16, v131
v_and_b32 v118, 0xffff0000, v131
v_add_f32 v146, v146, v117
v_add_f32 v147, v147, v118
v_cvt_pk_bf16_f32 v116, v146, v147
v_lshlrev_b32 v146, 16, v116
v_and_b32 v147, 0xffff0000, v116
v_max_f32 v146, 0, v146
v_max_f32 v147, 0, v147
v_mul_f32 v146, v146, v146
v_mul_f32 v147, v147, v147
v_cvt_pk_bf16_f32 v116, v132, v133
v_cvt_pk_bf16_f32 v117, v134, v135
v_cvt_pk_bf16_f32 v118, v140, v141
v_cvt_pk_bf16_f32 v119, v142, v143
v_cvt_pk_bf16_f32 v120, v136, v137
v_cvt_pk_bf16_f32 v121, v138, v139
v_cvt_pk_bf16_f32 v122, v144, v145
v_cvt_pk_bf16_f32 v123, v146, v147
s_add_u32 s41, s40, 16384
buffer_store_dwordx4 v[116:119], v112, s[20:23], s41 offen sc1
buffer_store_dwordx4 v[120:123], v148, s[20:23], s41 offen sc1
v_accvgpr_read_b32 v132, a64
v_accvgpr_read_b32 v133, a65
v_accvgpr_read_b32 v134, a66
v_accvgpr_read_b32 v135, a67
v_accvgpr_read_b32 v136, a68
v_accvgpr_read_b32 v137, a69
v_accvgpr_read_b32 v138, a70
v_accvgpr_read_b32 v139, a71
v_accvgpr_read_b32 v140, a72
v_accvgpr_read_b32 v141, a73
v_accvgpr_read_b32 v142, a74
v_accvgpr_read_b32 v143, a75
v_accvgpr_read_b32 v144, a76
v_accvgpr_read_b32 v145, a77
v_accvgpr_read_b32 v146, a78
v_accvgpr_read_b32 v147, a79
v_cvt_pk_bf16_f32 v116, v132, v133
v_lshlrev_b32 v132, 16, v116
v_and_b32 v133, 0xffff0000, v116
v_lshlrev_b32 v117, 16, v124
v_and_b32 v118, 0xffff0000, v124
v_add_f32 v132, v132, v117
v_add_f32 v133, v133, v118
v_cvt_pk_bf16_f32 v116, v132, v133
v_lshlrev_b32 v132, 16, v116
v_and_b32 v133, 0xffff0000, v116
v_max_f32 v132, 0, v132
v_max_f32 v133, 0, v133
v_mul_f32 v132, v132, v132
v_mul_f32 v133, v133, v133
v_cvt_pk_bf16_f32 v116, v134, v135
v_lshlrev_b32 v134, 16, v116
v_and_b32 v135, 0xffff0000, v116
v_lshlrev_b32 v117, 16, v125
v_and_b32 v118, 0xffff0000, v125
v_add_f32 v134, v134, v117
v_add_f32 v135, v135, v118
v_cvt_pk_bf16_f32 v116, v134, v135
v_lshlrev_b32 v134, 16, v116
v_and_b32 v135, 0xffff0000, v116
v_max_f32 v134, 0, v134
v_max_f32 v135, 0, v135
v_mul_f32 v134, v134, v134
v_mul_f32 v135, v135, v135
v_cvt_pk_bf16_f32 v116, v136, v137
v_lshlrev_b32 v136, 16, v116
v_and_b32 v137, 0xffff0000, v116
v_lshlrev_b32 v117, 16, v126
v_and_b32 v118, 0xffff0000, v126
v_add_f32 v136, v136, v117
v_add_f32 v137, v137, v118
v_cvt_pk_bf16_f32 v116, v136, v137
v_lshlrev_b32 v136, 16, v116
v_and_b32 v137, 0xffff0000, v116
v_max_f32 v136, 0, v136
v_max_f32 v137, 0, v137
v_mul_f32 v136, v136, v136
v_mul_f32 v137, v137, v137
v_cvt_pk_bf16_f32 v116, v138, v139
v_lshlrev_b32 v138, 16, v116
v_and_b32 v139, 0xffff0000, v116
v_lshlrev_b32 v117, 16, v127
v_and_b32 v118, 0xffff0000, v127
v_add_f32 v138, v138, v117
v_add_f32 v139, v139, v118
v_cvt_pk_bf16_f32 v116, v138, v139
v_lshlrev_b32 v138, 16, v116
v_and_b32 v139, 0xffff0000, v116
v_max_f32 v138, 0, v138
v_max_f32 v139, 0, v139
v_mul_f32 v138, v138, v138
v_mul_f32 v139, v139, v139
v_cvt_pk_bf16_f32 v116, v140, v141
v_lshlrev_b32 v140, 16, v116
v_and_b32 v141, 0xffff0000, v116
v_lshlrev_b32 v117, 16, v128
v_and_b32 v118, 0xffff0000, v128
v_add_f32 v140, v140, v117
v_add_f32 v141, v141, v118
v_cvt_pk_bf16_f32 v116, v140, v141
v_lshlrev_b32 v140, 16, v116
v_and_b32 v141, 0xffff0000, v116
v_max_f32 v140, 0, v140
v_max_f32 v141, 0, v141
v_mul_f32 v140, v140, v140
v_mul_f32 v141, v141, v141
v_cvt_pk_bf16_f32 v116, v142, v143
v_lshlrev_b32 v142, 16, v116
v_and_b32 v143, 0xffff0000, v116
v_lshlrev_b32 v117, 16, v129
v_and_b32 v118, 0xffff0000, v129
v_add_f32 v142, v142, v117
v_add_f32 v143, v143, v118
v_cvt_pk_bf16_f32 v116, v142, v143
v_lshlrev_b32 v142, 16, v116
v_and_b32 v143, 0xffff0000, v116
v_max_f32 v142, 0, v142
v_max_f32 v143, 0, v143
v_mul_f32 v142, v142, v142
v_mul_f32 v143, v143, v143
v_cvt_pk_bf16_f32 v116, v144, v145
v_lshlrev_b32 v144, 16, v116
v_and_b32 v145, 0xffff0000, v116
v_lshlrev_b32 v117, 16, v130
v_and_b32 v118, 0xffff0000, v130
v_add_f32 v144, v144, v117
v_add_f32 v145, v145, v118
v_cvt_pk_bf16_f32 v116, v144, v145
v_lshlrev_b32 v144, 16, v116
v_and_b32 v145, 0xffff0000, v116
v_max_f32 v144, 0, v144
v_max_f32 v145, 0, v145
v_mul_f32 v144, v144, v144
v_mul_f32 v145, v145, v145
v_cvt_pk_bf16_f32 v116, v146, v147
v_lshlrev_b32 v146, 16, v116
v_and_b32 v147, 0xffff0000, v116
v_lshlrev_b32 v117, 16, v131
v_and_b32 v118, 0xffff0000, v131
v_add_f32 v146, v146, v117
v_add_f32 v147, v147, v118
v_cvt_pk_bf16_f32 v116, v146, v147
v_lshlrev_b32 v146, 16, v116
v_and_b32 v147, 0xffff0000, v116
v_max_f32 v146, 0, v146
v_max_f32 v147, 0, v147
v_mul_f32 v146, v146, v146
v_mul_f32 v147, v147, v147
v_cvt_pk_bf16_f32 v116, v132, v133
v_cvt_pk_bf16_f32 v117, v134, v135
v_cvt_pk_bf16_f32 v118, v140, v141
v_cvt_pk_bf16_f32 v119, v142, v143
v_cvt_pk_bf16_f32 v120, v136, v137
v_cvt_pk_bf16_f32 v121, v138, v139
v_cvt_pk_bf16_f32 v122, v144, v145
v_cvt_pk_bf16_f32 v123, v146, v147
s_add_u32 s41, s40, 18432
buffer_store_dwordx4 v[116:119], v112, s[20:23], s41 offen sc1
buffer_store_dwordx4 v[120:123], v148, s[20:23], s41 offen sc1
v_accvgpr_read_b32 v132, a112
v_accvgpr_read_b32 v133, a113
v_accvgpr_read_b32 v134, a114
v_accvgpr_read_b32 v135, a115
v_accvgpr_read_b32 v136, a116
v_accvgpr_read_b32 v137, a117
v_accvgpr_read_b32 v138, a118
v_accvgpr_read_b32 v139, a119
v_accvgpr_read_b32 v140, a120
v_accvgpr_read_b32 v141, a121
v_accvgpr_read_b32 v142, a122
v_accvgpr_read_b32 v143, a123
v_accvgpr_read_b32 v144, a124
v_accvgpr_read_b32 v145, a125
v_accvgpr_read_b32 v146, a126
v_accvgpr_read_b32 v147, a127
v_cvt_pk_bf16_f32 v116, v132, v133
v_lshlrev_b32 v132, 16, v116
v_and_b32 v133, 0xffff0000, v116
v_lshlrev_b32 v117, 16, v124
v_and_b32 v118, 0xffff0000, v124
v_add_f32 v132, v132, v117
v_add_f32 v133, v133, v118
v_cvt_pk_bf16_f32 v116, v132, v133
v_lshlrev_b32 v132, 16, v116
v_and_b32 v133, 0xffff0000, v116
v_max_f32 v132, 0, v132
v_max_f32 v133, 0, v133
v_mul_f32 v132, v132, v132
v_mul_f32 v133, v133, v133
v_cvt_pk_bf16_f32 v116, v134, v135
v_lshlrev_b32 v134, 16, v116
v_and_b32 v135, 0xffff0000, v116
v_lshlrev_b32 v117, 16, v125
v_and_b32 v118, 0xffff0000, v125
v_add_f32 v134, v134, v117
v_add_f32 v135, v135, v118
v_cvt_pk_bf16_f32 v116, v134, v135
v_lshlrev_b32 v134, 16, v116
v_and_b32 v135, 0xffff0000, v116
v_max_f32 v134, 0, v134
v_max_f32 v135, 0, v135
v_mul_f32 v134, v134, v134
v_mul_f32 v135, v135, v135
v_cvt_pk_bf16_f32 v116, v136, v137
v_lshlrev_b32 v136, 16, v116
v_and_b32 v137, 0xffff0000, v116
v_lshlrev_b32 v117, 16, v126
v_and_b32 v118, 0xffff0000, v126
v_add_f32 v136, v136, v117
v_add_f32 v137, v137, v118
v_cvt_pk_bf16_f32 v116, v136, v137
v_lshlrev_b32 v136, 16, v116
v_and_b32 v137, 0xffff0000, v116
v_max_f32 v136, 0, v136
v_max_f32 v137, 0, v137
v_mul_f32 v136, v136, v136
v_mul_f32 v137, v137, v137
v_cvt_pk_bf16_f32 v116, v138, v139
v_lshlrev_b32 v138, 16, v116
v_and_b32 v139, 0xffff0000, v116
v_lshlrev_b32 v117, 16, v127
v_and_b32 v118, 0xffff0000, v127
v_add_f32 v138, v138, v117
v_add_f32 v139, v139, v118
v_cvt_pk_bf16_f32 v116, v138, v139
v_lshlrev_b32 v138, 16, v116
v_and_b32 v139, 0xffff0000, v116
v_max_f32 v138, 0, v138
v_max_f32 v139, 0, v139
v_mul_f32 v138, v138, v138
v_mul_f32 v139, v139, v139
v_cvt_pk_bf16_f32 v116, v140, v141
v_lshlrev_b32 v140, 16, v116
v_and_b32 v141, 0xffff0000, v116
v_lshlrev_b32 v117, 16, v128
v_and_b32 v118, 0xffff0000, v128
v_add_f32 v140, v140, v117
v_add_f32 v141, v141, v118
v_cvt_pk_bf16_f32 v116, v140, v141
v_lshlrev_b32 v140, 16, v116
v_and_b32 v141, 0xffff0000, v116
v_max_f32 v140, 0, v140
v_max_f32 v141, 0, v141
v_mul_f32 v140, v140, v140
v_mul_f32 v141, v141, v141
v_cvt_pk_bf16_f32 v116, v142, v143
v_lshlrev_b32 v142, 16, v116
v_and_b32 v143, 0xffff0000, v116
v_lshlrev_b32 v117, 16, v129
v_and_b32 v118, 0xffff0000, v129
v_add_f32 v142, v142, v117
v_add_f32 v143, v143, v118
v_cvt_pk_bf16_f32 v116, v142, v143
v_lshlrev_b32 v142, 16, v116
v_and_b32 v143, 0xffff0000, v116
v_max_f32 v142, 0, v142
v_max_f32 v143, 0, v143
v_mul_f32 v142, v142, v142
v_mul_f32 v143, v143, v143
v_cvt_pk_bf16_f32 v116, v144, v145
v_lshlrev_b32 v144, 16, v116
v_and_b32 v145, 0xffff0000, v116
v_lshlrev_b32 v117, 16, v130
v_and_b32 v118, 0xffff0000, v130
v_add_f32 v144, v144, v117
v_add_f32 v145, v145, v118
v_cvt_pk_bf16_f32 v116, v144, v145
v_lshlrev_b32 v144, 16, v116
v_and_b32 v145, 0xffff0000, v116
v_max_f32 v144, 0, v144
v_max_f32 v145, 0, v145
v_mul_f32 v144, v144, v144
v_mul_f32 v145, v145, v145
v_cvt_pk_bf16_f32 v116, v146, v147
v_lshlrev_b32 v146, 16, v116
v_and_b32 v147, 0xffff0000, v116
v_lshlrev_b32 v117, 16, v131
v_and_b32 v118, 0xffff0000, v131
v_add_f32 v146, v146, v117
v_add_f32 v147, v147, v118
v_cvt_pk_bf16_f32 v116, v146, v147
v_lshlrev_b32 v146, 16, v116
v_and_b32 v147, 0xffff0000, v116
v_max_f32 v146, 0, v146
v_max_f32 v147, 0, v147
v_mul_f32 v146, v146, v146
v_mul_f32 v147, v147, v147
v_cvt_pk_bf16_f32 v116, v132, v133
v_cvt_pk_bf16_f32 v117, v134, v135
v_cvt_pk_bf16_f32 v118, v140, v141
v_cvt_pk_bf16_f32 v119, v142, v143
v_cvt_pk_bf16_f32 v120, v136, v137
v_cvt_pk_bf16_f32 v121, v138, v139
v_cvt_pk_bf16_f32 v122, v144, v145
v_cvt_pk_bf16_f32 v123, v146, v147
s_add_u32 s41, s40, 20480
buffer_store_dwordx4 v[116:119], v112, s[20:23], s41 offen sc1
buffer_store_dwordx4 v[120:123], v148, s[20:23], s41 offen sc1
v_accvgpr_read_b32 v132, a160
v_accvgpr_read_b32 v133, a161
v_accvgpr_read_b32 v134, a162
v_accvgpr_read_b32 v135, a163
v_accvgpr_read_b32 v136, a164
v_accvgpr_read_b32 v137, a165
v_accvgpr_read_b32 v138, a166
v_accvgpr_read_b32 v139, a167
v_accvgpr_read_b32 v140, a168
v_accvgpr_read_b32 v141, a169
v_accvgpr_read_b32 v142, a170
v_accvgpr_read_b32 v143, a171
v_accvgpr_read_b32 v144, a172
v_accvgpr_read_b32 v145, a173
v_accvgpr_read_b32 v146, a174
v_accvgpr_read_b32 v147, a175
v_cvt_pk_bf16_f32 v116, v132, v133
v_lshlrev_b32 v132, 16, v116
v_and_b32 v133, 0xffff0000, v116
v_lshlrev_b32 v117, 16, v124
v_and_b32 v118, 0xffff0000, v124
v_add_f32 v132, v132, v117
v_add_f32 v133, v133, v118
v_cvt_pk_bf16_f32 v116, v132, v133
v_lshlrev_b32 v132, 16, v116
v_and_b32 v133, 0xffff0000, v116
v_max_f32 v132, 0, v132
v_max_f32 v133, 0, v133
v_mul_f32 v132, v132, v132
v_mul_f32 v133, v133, v133
v_cvt_pk_bf16_f32 v116, v134, v135
v_lshlrev_b32 v134, 16, v116
v_and_b32 v135, 0xffff0000, v116
v_lshlrev_b32 v117, 16, v125
v_and_b32 v118, 0xffff0000, v125
v_add_f32 v134, v134, v117
v_add_f32 v135, v135, v118
v_cvt_pk_bf16_f32 v116, v134, v135
v_lshlrev_b32 v134, 16, v116
v_and_b32 v135, 0xffff0000, v116
v_max_f32 v134, 0, v134
v_max_f32 v135, 0, v135
v_mul_f32 v134, v134, v134
v_mul_f32 v135, v135, v135
v_cvt_pk_bf16_f32 v116, v136, v137
v_lshlrev_b32 v136, 16, v116
v_and_b32 v137, 0xffff0000, v116
v_lshlrev_b32 v117, 16, v126
v_and_b32 v118, 0xffff0000, v126
v_add_f32 v136, v136, v117
v_add_f32 v137, v137, v118
v_cvt_pk_bf16_f32 v116, v136, v137
v_lshlrev_b32 v136, 16, v116
v_and_b32 v137, 0xffff0000, v116
v_max_f32 v136, 0, v136
v_max_f32 v137, 0, v137
v_mul_f32 v136, v136, v136
v_mul_f32 v137, v137, v137
v_cvt_pk_bf16_f32 v116, v138, v139
v_lshlrev_b32 v138, 16, v116
v_and_b32 v139, 0xffff0000, v116
v_lshlrev_b32 v117, 16, v127
v_and_b32 v118, 0xffff0000, v127
v_add_f32 v138, v138, v117
v_add_f32 v139, v139, v118
v_cvt_pk_bf16_f32 v116, v138, v139
v_lshlrev_b32 v138, 16, v116
v_and_b32 v139, 0xffff0000, v116
v_max_f32 v138, 0, v138
v_max_f32 v139, 0, v139
v_mul_f32 v138, v138, v138
v_mul_f32 v139, v139, v139
v_cvt_pk_bf16_f32 v116, v140, v141
v_lshlrev_b32 v140, 16, v116
v_and_b32 v141, 0xffff0000, v116
v_lshlrev_b32 v117, 16, v128
v_and_b32 v118, 0xffff0000, v128
v_add_f32 v140, v140, v117
v_add_f32 v141, v141, v118
v_cvt_pk_bf16_f32 v116, v140, v141
v_lshlrev_b32 v140, 16, v116
v_and_b32 v141, 0xffff0000, v116
v_max_f32 v140, 0, v140
v_max_f32 v141, 0, v141
v_mul_f32 v140, v140, v140
v_mul_f32 v141, v141, v141
v_cvt_pk_bf16_f32 v116, v142, v143
v_lshlrev_b32 v142, 16, v116
v_and_b32 v143, 0xffff0000, v116
v_lshlrev_b32 v117, 16, v129
v_and_b32 v118, 0xffff0000, v129
v_add_f32 v142, v142, v117
v_add_f32 v143, v143, v118
v_cvt_pk_bf16_f32 v116, v142, v143
v_lshlrev_b32 v142, 16, v116
v_and_b32 v143, 0xffff0000, v116
v_max_f32 v142, 0, v142
v_max_f32 v143, 0, v143
v_mul_f32 v142, v142, v142
v_mul_f32 v143, v143, v143
v_cvt_pk_bf16_f32 v116, v144, v145
v_lshlrev_b32 v144, 16, v116
v_and_b32 v145, 0xffff0000, v116
v_lshlrev_b32 v117, 16, v130
v_and_b32 v118, 0xffff0000, v130
v_add_f32 v144, v144, v117
v_add_f32 v145, v145, v118
v_cvt_pk_bf16_f32 v116, v144, v145
v_lshlrev_b32 v144, 16, v116
v_and_b32 v145, 0xffff0000, v116
v_max_f32 v144, 0, v144
v_max_f32 v145, 0, v145
v_mul_f32 v144, v144, v144
v_mul_f32 v145, v145, v145
v_cvt_pk_bf16_f32 v116, v146, v147
v_lshlrev_b32 v146, 16, v116
v_and_b32 v147, 0xffff0000, v116
v_lshlrev_b32 v117, 16, v131
v_and_b32 v118, 0xffff0000, v131
v_add_f32 v146, v146, v117
v_add_f32 v147, v147, v118
v_cvt_pk_bf16_f32 v116, v146, v147
v_lshlrev_b32 v146, 16, v116
v_and_b32 v147, 0xffff0000, v116
v_max_f32 v146, 0, v146
v_max_f32 v147, 0, v147
v_mul_f32 v146, v146, v146
v_mul_f32 v147, v147, v147
v_cvt_pk_bf16_f32 v116, v132, v133
v_cvt_pk_bf16_f32 v117, v134, v135
v_cvt_pk_bf16_f32 v118, v140, v141
v_cvt_pk_bf16_f32 v119, v142, v143
v_cvt_pk_bf16_f32 v120, v136, v137
v_cvt_pk_bf16_f32 v121, v138, v139
v_cvt_pk_bf16_f32 v122, v144, v145
v_cvt_pk_bf16_f32 v123, v146, v147
s_add_u32 s41, s40, 22528
buffer_store_dwordx4 v[116:119], v112, s[20:23], s41 offen sc1
buffer_store_dwordx4 v[120:123], v148, s[20:23], s41 offen sc1
s_add_u32 s41, s61, 128
buffer_load_dwordx2 v[124:125], v4, s[80:83], s41 offen offset:0
buffer_load_dwordx2 v[126:127], v4, s[80:83], s41 offen offset:16
buffer_load_dwordx2 v[128:129], v4, s[80:83], s41 offen offset:32
buffer_load_dwordx2 v[130:131], v4, s[80:83], s41 offen offset:48
s_waitcnt vmcnt(0)
v_accvgpr_read_b32 v132, a32
v_accvgpr_read_b32 v133, a33
v_accvgpr_read_b32 v134, a34
v_accvgpr_read_b32 v135, a35
v_accvgpr_read_b32 v136, a36
v_accvgpr_read_b32 v137, a37
v_accvgpr_read_b32 v138, a38
v_accvgpr_read_b32 v139, a39
v_accvgpr_read_b32 v140, a40
v_accvgpr_read_b32 v141, a41
v_accvgpr_read_b32 v142, a42
v_accvgpr_read_b32 v143, a43
v_accvgpr_read_b32 v144, a44
v_accvgpr_read_b32 v145, a45
v_accvgpr_read_b32 v146, a46
v_accvgpr_read_b32 v147, a47
v_cvt_pk_bf16_f32 v116, v132, v133
v_lshlrev_b32 v132, 16, v116
v_and_b32 v133, 0xffff0000, v116
v_lshlrev_b32 v117, 16, v124
v_and_b32 v118, 0xffff0000, v124
v_add_f32 v132, v132, v117
v_add_f32 v133, v133, v118
v_cvt_pk_bf16_f32 v116, v132, v133
v_lshlrev_b32 v132, 16, v116
v_and_b32 v133, 0xffff0000, v116
v_max_f32 v132, 0, v132
v_max_f32 v133, 0, v133
v_mul_f32 v132, v132, v132
v_mul_f32 v133, v133, v133
v_cvt_pk_bf16_f32 v116, v134, v135
v_lshlrev_b32 v134, 16, v116
v_and_b32 v135, 0xffff0000, v116
v_lshlrev_b32 v117, 16, v125
v_and_b32 v118, 0xffff0000, v125
v_add_f32 v134, v134, v117
v_add_f32 v135, v135, v118
v_cvt_pk_bf16_f32 v116, v134, v135
v_lshlrev_b32 v134, 16, v116
v_and_b32 v135, 0xffff0000, v116
v_max_f32 v134, 0, v134
v_max_f32 v135, 0, v135
v_mul_f32 v134, v134, v134
v_mul_f32 v135, v135, v135
v_cvt_pk_bf16_f32 v116, v136, v137
v_lshlrev_b32 v136, 16, v116
v_and_b32 v137, 0xffff0000, v116
v_lshlrev_b32 v117, 16, v126
v_and_b32 v118, 0xffff0000, v126
v_add_f32 v136, v136, v117
v_add_f32 v137, v137, v118
v_cvt_pk_bf16_f32 v116, v136, v137
v_lshlrev_b32 v136, 16, v116
v_and_b32 v137, 0xffff0000, v116
v_max_f32 v136, 0, v136
v_max_f32 v137, 0, v137
v_mul_f32 v136, v136, v136
v_mul_f32 v137, v137, v137
v_cvt_pk_bf16_f32 v116, v138, v139
v_lshlrev_b32 v138, 16, v116
v_and_b32 v139, 0xffff0000, v116
v_lshlrev_b32 v117, 16, v127
v_and_b32 v118, 0xffff0000, v127
v_add_f32 v138, v138, v117
v_add_f32 v139, v139, v118
v_cvt_pk_bf16_f32 v116, v138, v139
v_lshlrev_b32 v138, 16, v116
v_and_b32 v139, 0xffff0000, v116
v_max_f32 v138, 0, v138
v_max_f32 v139, 0, v139
v_mul_f32 v138, v138, v138
v_mul_f32 v139, v139, v139
v_cvt_pk_bf16_f32 v116, v140, v141
v_lshlrev_b32 v140, 16, v116
v_and_b32 v141, 0xffff0000, v116
v_lshlrev_b32 v117, 16, v128
v_and_b32 v118, 0xffff0000, v128
v_add_f32 v140, v140, v117
v_add_f32 v141, v141, v118
v_cvt_pk_bf16_f32 v116, v140, v141
v_lshlrev_b32 v140, 16, v116
v_and_b32 v141, 0xffff0000, v116
v_max_f32 v140, 0, v140
v_max_f32 v141, 0, v141
v_mul_f32 v140, v140, v140
v_mul_f32 v141, v141, v141
v_cvt_pk_bf16_f32 v116, v142, v143
v_lshlrev_b32 v142, 16, v116
v_and_b32 v143, 0xffff0000, v116
v_lshlrev_b32 v117, 16, v129
v_and_b32 v118, 0xffff0000, v129
v_add_f32 v142, v142, v117
v_add_f32 v143, v143, v118
v_cvt_pk_bf16_f32 v116, v142, v143
v_lshlrev_b32 v142, 16, v116
v_and_b32 v143, 0xffff0000, v116
v_max_f32 v142, 0, v142
v_max_f32 v143, 0, v143
v_mul_f32 v142, v142, v142
v_mul_f32 v143, v143, v143
v_cvt_pk_bf16_f32 v116, v144, v145
v_lshlrev_b32 v144, 16, v116
v_and_b32 v145, 0xffff0000, v116
v_lshlrev_b32 v117, 16, v130
v_and_b32 v118, 0xffff0000, v130
v_add_f32 v144, v144, v117
v_add_f32 v145, v145, v118
v_cvt_pk_bf16_f32 v116, v144, v145
v_lshlrev_b32 v144, 16, v116
v_and_b32 v145, 0xffff0000, v116
v_max_f32 v144, 0, v144
v_max_f32 v145, 0, v145
v_mul_f32 v144, v144, v144
v_mul_f32 v145, v145, v145
v_cvt_pk_bf16_f32 v116, v146, v147
v_lshlrev_b32 v146, 16, v116
v_and_b32 v147, 0xffff0000, v116
v_lshlrev_b32 v117, 16, v131
v_and_b32 v118, 0xffff0000, v131
v_add_f32 v146, v146, v117
v_add_f32 v147, v147, v118
v_cvt_pk_bf16_f32 v116, v146, v147
v_lshlrev_b32 v146, 16, v116
v_and_b32 v147, 0xffff0000, v116
v_max_f32 v146, 0, v146
v_max_f32 v147, 0, v147
v_mul_f32 v146, v146, v146
v_mul_f32 v147, v147, v147
v_cvt_pk_bf16_f32 v116, v132, v133
v_cvt_pk_bf16_f32 v117, v134, v135
v_cvt_pk_bf16_f32 v118, v140, v141
v_cvt_pk_bf16_f32 v119, v142, v143
v_cvt_pk_bf16_f32 v120, v136, v137
v_cvt_pk_bf16_f32 v121, v138, v139
v_cvt_pk_bf16_f32 v122, v144, v145
v_cvt_pk_bf16_f32 v123, v146, v147
s_add_u32 s41, s40, 32768
buffer_store_dwordx4 v[116:119], v112, s[20:23], s41 offen sc1
buffer_store_dwordx4 v[120:123], v148, s[20:23], s41 offen sc1
v_accvgpr_read_b32 v132, a80
v_accvgpr_read_b32 v133, a81
v_accvgpr_read_b32 v134, a82
v_accvgpr_read_b32 v135, a83
v_accvgpr_read_b32 v136, a84
v_accvgpr_read_b32 v137, a85
v_accvgpr_read_b32 v138, a86
v_accvgpr_read_b32 v139, a87
v_accvgpr_read_b32 v140, a88
v_accvgpr_read_b32 v141, a89
v_accvgpr_read_b32 v142, a90
v_accvgpr_read_b32 v143, a91
v_accvgpr_read_b32 v144, a92
v_accvgpr_read_b32 v145, a93
v_accvgpr_read_b32 v146, a94
v_accvgpr_read_b32 v147, a95
v_cvt_pk_bf16_f32 v116, v132, v133
v_lshlrev_b32 v132, 16, v116
v_and_b32 v133, 0xffff0000, v116
v_lshlrev_b32 v117, 16, v124
v_and_b32 v118, 0xffff0000, v124
v_add_f32 v132, v132, v117
v_add_f32 v133, v133, v118
v_cvt_pk_bf16_f32 v116, v132, v133
v_lshlrev_b32 v132, 16, v116
v_and_b32 v133, 0xffff0000, v116
v_max_f32 v132, 0, v132
v_max_f32 v133, 0, v133
v_mul_f32 v132, v132, v132
v_mul_f32 v133, v133, v133
v_cvt_pk_bf16_f32 v116, v134, v135
v_lshlrev_b32 v134, 16, v116
v_and_b32 v135, 0xffff0000, v116
v_lshlrev_b32 v117, 16, v125
v_and_b32 v118, 0xffff0000, v125
v_add_f32 v134, v134, v117
v_add_f32 v135, v135, v118
v_cvt_pk_bf16_f32 v116, v134, v135
v_lshlrev_b32 v134, 16, v116
v_and_b32 v135, 0xffff0000, v116
v_max_f32 v134, 0, v134
v_max_f32 v135, 0, v135
v_mul_f32 v134, v134, v134
v_mul_f32 v135, v135, v135
v_cvt_pk_bf16_f32 v116, v136, v137
v_lshlrev_b32 v136, 16, v116
v_and_b32 v137, 0xffff0000, v116
v_lshlrev_b32 v117, 16, v126
v_and_b32 v118, 0xffff0000, v126
v_add_f32 v136, v136, v117
v_add_f32 v137, v137, v118
v_cvt_pk_bf16_f32 v116, v136, v137
v_lshlrev_b32 v136, 16, v116
v_and_b32 v137, 0xffff0000, v116
v_max_f32 v136, 0, v136
v_max_f32 v137, 0, v137
v_mul_f32 v136, v136, v136
v_mul_f32 v137, v137, v137
v_cvt_pk_bf16_f32 v116, v138, v139
v_lshlrev_b32 v138, 16, v116
v_and_b32 v139, 0xffff0000, v116
v_lshlrev_b32 v117, 16, v127
v_and_b32 v118, 0xffff0000, v127
v_add_f32 v138, v138, v117
v_add_f32 v139, v139, v118
v_cvt_pk_bf16_f32 v116, v138, v139
v_lshlrev_b32 v138, 16, v116
v_and_b32 v139, 0xffff0000, v116
v_max_f32 v138, 0, v138
v_max_f32 v139, 0, v139
v_mul_f32 v138, v138, v138
v_mul_f32 v139, v139, v139
v_cvt_pk_bf16_f32 v116, v140, v141
v_lshlrev_b32 v140, 16, v116
v_and_b32 v141, 0xffff0000, v116
v_lshlrev_b32 v117, 16, v128
v_and_b32 v118, 0xffff0000, v128
v_add_f32 v140, v140, v117
v_add_f32 v141, v141, v118
v_cvt_pk_bf16_f32 v116, v140, v141
v_lshlrev_b32 v140, 16, v116
v_and_b32 v141, 0xffff0000, v116
v_max_f32 v140, 0, v140
v_max_f32 v141, 0, v141
v_mul_f32 v140, v140, v140
v_mul_f32 v141, v141, v141
v_cvt_pk_bf16_f32 v116, v142, v143
v_lshlrev_b32 v142, 16, v116
v_and_b32 v143, 0xffff0000, v116
v_lshlrev_b32 v117, 16, v129
v_and_b32 v118, 0xffff0000, v129
v_add_f32 v142, v142, v117
v_add_f32 v143, v143, v118
v_cvt_pk_bf16_f32 v116, v142, v143
v_lshlrev_b32 v142, 16, v116
v_and_b32 v143, 0xffff0000, v116
v_max_f32 v142, 0, v142
v_max_f32 v143, 0, v143
v_mul_f32 v142, v142, v142
v_mul_f32 v143, v143, v143
v_cvt_pk_bf16_f32 v116, v144, v145
v_lshlrev_b32 v144, 16, v116
v_and_b32 v145, 0xffff0000, v116
v_lshlrev_b32 v117, 16, v130
v_and_b32 v118, 0xffff0000, v130
v_add_f32 v144, v144, v117
v_add_f32 v145, v145, v118
v_cvt_pk_bf16_f32 v116, v144, v145
v_lshlrev_b32 v144, 16, v116
v_and_b32 v145, 0xffff0000, v116
v_max_f32 v144, 0, v144
v_max_f32 v145, 0, v145
v_mul_f32 v144, v144, v144
v_mul_f32 v145, v145, v145
v_cvt_pk_bf16_f32 v116, v146, v147
v_lshlrev_b32 v146, 16, v116
v_and_b32 v147, 0xffff0000, v116
v_lshlrev_b32 v117, 16, v131
v_and_b32 v118, 0xffff0000, v131
v_add_f32 v146, v146, v117
v_add_f32 v147, v147, v118
v_cvt_pk_bf16_f32 v116, v146, v147
v_lshlrev_b32 v146, 16, v116
v_and_b32 v147, 0xffff0000, v116
v_max_f32 v146, 0, v146
v_max_f32 v147, 0, v147
v_mul_f32 v146, v146, v146
v_mul_f32 v147, v147, v147
v_cvt_pk_bf16_f32 v116, v132, v133
v_cvt_pk_bf16_f32 v117, v134, v135
v_cvt_pk_bf16_f32 v118, v140, v141
v_cvt_pk_bf16_f32 v119, v142, v143
v_cvt_pk_bf16_f32 v120, v136, v137
v_cvt_pk_bf16_f32 v121, v138, v139
v_cvt_pk_bf16_f32 v122, v144, v145
v_cvt_pk_bf16_f32 v123, v146, v147
s_add_u32 s41, s40, 34816
buffer_store_dwordx4 v[116:119], v112, s[20:23], s41 offen sc1
buffer_store_dwordx4 v[120:123], v148, s[20:23], s41 offen sc1
v_accvgpr_read_b32 v132, a128
v_accvgpr_read_b32 v133, a129
v_accvgpr_read_b32 v134, a130
v_accvgpr_read_b32 v135, a131
v_accvgpr_read_b32 v136, a132
v_accvgpr_read_b32 v137, a133
v_accvgpr_read_b32 v138, a134
v_accvgpr_read_b32 v139, a135
v_accvgpr_read_b32 v140, a136
v_accvgpr_read_b32 v141, a137
v_accvgpr_read_b32 v142, a138
v_accvgpr_read_b32 v143, a139
v_accvgpr_read_b32 v144, a140
v_accvgpr_read_b32 v145, a141
v_accvgpr_read_b32 v146, a142
v_accvgpr_read_b32 v147, a143
v_cvt_pk_bf16_f32 v116, v132, v133
v_lshlrev_b32 v132, 16, v116
v_and_b32 v133, 0xffff0000, v116
v_lshlrev_b32 v117, 16, v124
v_and_b32 v118, 0xffff0000, v124
v_add_f32 v132, v132, v117
v_add_f32 v133, v133, v118
v_cvt_pk_bf16_f32 v116, v132, v133
v_lshlrev_b32 v132, 16, v116
v_and_b32 v133, 0xffff0000, v116
v_max_f32 v132, 0, v132
v_max_f32 v133, 0, v133
v_mul_f32 v132, v132, v132
v_mul_f32 v133, v133, v133
v_cvt_pk_bf16_f32 v116, v134, v135
v_lshlrev_b32 v134, 16, v116
v_and_b32 v135, 0xffff0000, v116
v_lshlrev_b32 v117, 16, v125
v_and_b32 v118, 0xffff0000, v125
v_add_f32 v134, v134, v117
v_add_f32 v135, v135, v118
v_cvt_pk_bf16_f32 v116, v134, v135
v_lshlrev_b32 v134, 16, v116
v_and_b32 v135, 0xffff0000, v116
v_max_f32 v134, 0, v134
v_max_f32 v135, 0, v135
v_mul_f32 v134, v134, v134
v_mul_f32 v135, v135, v135
v_cvt_pk_bf16_f32 v116, v136, v137
v_lshlrev_b32 v136, 16, v116
v_and_b32 v137, 0xffff0000, v116
v_lshlrev_b32 v117, 16, v126
v_and_b32 v118, 0xffff0000, v126
v_add_f32 v136, v136, v117
v_add_f32 v137, v137, v118
v_cvt_pk_bf16_f32 v116, v136, v137
v_lshlrev_b32 v136, 16, v116
v_and_b32 v137, 0xffff0000, v116
v_max_f32 v136, 0, v136
v_max_f32 v137, 0, v137
v_mul_f32 v136, v136, v136
v_mul_f32 v137, v137, v137
v_cvt_pk_bf16_f32 v116, v138, v139
v_lshlrev_b32 v138, 16, v116
v_and_b32 v139, 0xffff0000, v116
v_lshlrev_b32 v117, 16, v127
v_and_b32 v118, 0xffff0000, v127
v_add_f32 v138, v138, v117
v_add_f32 v139, v139, v118
v_cvt_pk_bf16_f32 v116, v138, v139
v_lshlrev_b32 v138, 16, v116
v_and_b32 v139, 0xffff0000, v116
v_max_f32 v138, 0, v138
v_max_f32 v139, 0, v139
v_mul_f32 v138, v138, v138
v_mul_f32 v139, v139, v139
v_cvt_pk_bf16_f32 v116, v140, v141
v_lshlrev_b32 v140, 16, v116
v_and_b32 v141, 0xffff0000, v116
v_lshlrev_b32 v117, 16, v128
v_and_b32 v118, 0xffff0000, v128
v_add_f32 v140, v140, v117
v_add_f32 v141, v141, v118
v_cvt_pk_bf16_f32 v116, v140, v141
v_lshlrev_b32 v140, 16, v116
v_and_b32 v141, 0xffff0000, v116
v_max_f32 v140, 0, v140
v_max_f32 v141, 0, v141
v_mul_f32 v140, v140, v140
v_mul_f32 v141, v141, v141
v_cvt_pk_bf16_f32 v116, v142, v143
v_lshlrev_b32 v142, 16, v116
v_and_b32 v143, 0xffff0000, v116
v_lshlrev_b32 v117, 16, v129
v_and_b32 v118, 0xffff0000, v129
v_add_f32 v142, v142, v117
v_add_f32 v143, v143, v118
v_cvt_pk_bf16_f32 v116, v142, v143
v_lshlrev_b32 v142, 16, v116
v_and_b32 v143, 0xffff0000, v116
v_max_f32 v142, 0, v142
v_max_f32 v143, 0, v143
v_mul_f32 v142, v142, v142
v_mul_f32 v143, v143, v143
v_cvt_pk_bf16_f32 v116, v144, v145
v_lshlrev_b32 v144, 16, v116
v_and_b32 v145, 0xffff0000, v116
v_lshlrev_b32 v117, 16, v130
v_and_b32 v118, 0xffff0000, v130
v_add_f32 v144, v144, v117
v_add_f32 v145, v145, v118
v_cvt_pk_bf16_f32 v116, v144, v145
v_lshlrev_b32 v144, 16, v116
v_and_b32 v145, 0xffff0000, v116
v_max_f32 v144, 0, v144
v_max_f32 v145, 0, v145
v_mul_f32 v144, v144, v144
v_mul_f32 v145, v145, v145
v_cvt_pk_bf16_f32 v116, v146, v147
v_lshlrev_b32 v146, 16, v116
v_and_b32 v147, 0xffff0000, v116
v_lshlrev_b32 v117, 16, v131
v_and_b32 v118, 0xffff0000, v131
v_add_f32 v146, v146, v117
v_add_f32 v147, v147, v118
v_cvt_pk_bf16_f32 v116, v146, v147
v_lshlrev_b32 v146, 16, v116
v_and_b32 v147, 0xffff0000, v116
v_max_f32 v146, 0, v146
v_max_f32 v147, 0, v147
v_mul_f32 v146, v146, v146
v_mul_f32 v147, v147, v147
v_cvt_pk_bf16_f32 v116, v132, v133
v_cvt_pk_bf16_f32 v117, v134, v135
v_cvt_pk_bf16_f32 v118, v140, v141
v_cvt_pk_bf16_f32 v119, v142, v143
v_cvt_pk_bf16_f32 v120, v136, v137
v_cvt_pk_bf16_f32 v121, v138, v139
v_cvt_pk_bf16_f32 v122, v144, v145
v_cvt_pk_bf16_f32 v123, v146, v147
s_add_u32 s41, s40, 36864
buffer_store_dwordx4 v[116:119], v112, s[20:23], s41 offen sc1
buffer_store_dwordx4 v[120:123], v148, s[20:23], s41 offen sc1
v_accvgpr_read_b32 v132, a176
v_accvgpr_read_b32 v133, a177
v_accvgpr_read_b32 v134, a178
v_accvgpr_read_b32 v135, a179
v_accvgpr_read_b32 v136, a180
v_accvgpr_read_b32 v137, a181
v_accvgpr_read_b32 v138, a182
v_accvgpr_read_b32 v139, a183
v_accvgpr_read_b32 v140, a184
v_accvgpr_read_b32 v141, a185
v_accvgpr_read_b32 v142, a186
v_accvgpr_read_b32 v143, a187
v_accvgpr_read_b32 v144, a188
v_accvgpr_read_b32 v145, a189
v_accvgpr_read_b32 v146, a190
v_accvgpr_read_b32 v147, a191
v_cvt_pk_bf16_f32 v116, v132, v133
v_lshlrev_b32 v132, 16, v116
v_and_b32 v133, 0xffff0000, v116
v_lshlrev_b32 v117, 16, v124
v_and_b32 v118, 0xffff0000, v124
v_add_f32 v132, v132, v117
v_add_f32 v133, v133, v118
v_cvt_pk_bf16_f32 v116, v132, v133
v_lshlrev_b32 v132, 16, v116
v_and_b32 v133, 0xffff0000, v116
v_max_f32 v132, 0, v132
v_max_f32 v133, 0, v133
v_mul_f32 v132, v132, v132
v_mul_f32 v133, v133, v133
v_cvt_pk_bf16_f32 v116, v134, v135
v_lshlrev_b32 v134, 16, v116
v_and_b32 v135, 0xffff0000, v116
v_lshlrev_b32 v117, 16, v125
v_and_b32 v118, 0xffff0000, v125
v_add_f32 v134, v134, v117
v_add_f32 v135, v135, v118
v_cvt_pk_bf16_f32 v116, v134, v135
v_lshlrev_b32 v134, 16, v116
v_and_b32 v135, 0xffff0000, v116
v_max_f32 v134, 0, v134
v_max_f32 v135, 0, v135
v_mul_f32 v134, v134, v134
v_mul_f32 v135, v135, v135
v_cvt_pk_bf16_f32 v116, v136, v137
v_lshlrev_b32 v136, 16, v116
v_and_b32 v137, 0xffff0000, v116
v_lshlrev_b32 v117, 16, v126
v_and_b32 v118, 0xffff0000, v126
v_add_f32 v136, v136, v117
v_add_f32 v137, v137, v118
v_cvt_pk_bf16_f32 v116, v136, v137
v_lshlrev_b32 v136, 16, v116
v_and_b32 v137, 0xffff0000, v116
v_max_f32 v136, 0, v136
v_max_f32 v137, 0, v137
v_mul_f32 v136, v136, v136
v_mul_f32 v137, v137, v137
v_cvt_pk_bf16_f32 v116, v138, v139
v_lshlrev_b32 v138, 16, v116
v_and_b32 v139, 0xffff0000, v116
v_lshlrev_b32 v117, 16, v127
v_and_b32 v118, 0xffff0000, v127
v_add_f32 v138, v138, v117
v_add_f32 v139, v139, v118
v_cvt_pk_bf16_f32 v116, v138, v139
v_lshlrev_b32 v138, 16, v116
v_and_b32 v139, 0xffff0000, v116
v_max_f32 v138, 0, v138
v_max_f32 v139, 0, v139
v_mul_f32 v138, v138, v138
v_mul_f32 v139, v139, v139
v_cvt_pk_bf16_f32 v116, v140, v141
v_lshlrev_b32 v140, 16, v116
v_and_b32 v141, 0xffff0000, v116
v_lshlrev_b32 v117, 16, v128
v_and_b32 v118, 0xffff0000, v128
v_add_f32 v140, v140, v117
v_add_f32 v141, v141, v118
v_cvt_pk_bf16_f32 v116, v140, v141
v_lshlrev_b32 v140, 16, v116
v_and_b32 v141, 0xffff0000, v116
v_max_f32 v140, 0, v140
v_max_f32 v141, 0, v141
v_mul_f32 v140, v140, v140
v_mul_f32 v141, v141, v141
v_cvt_pk_bf16_f32 v116, v142, v143
v_lshlrev_b32 v142, 16, v116
v_and_b32 v143, 0xffff0000, v116
v_lshlrev_b32 v117, 16, v129
v_and_b32 v118, 0xffff0000, v129
v_add_f32 v142, v142, v117
v_add_f32 v143, v143, v118
v_cvt_pk_bf16_f32 v116, v142, v143
v_lshlrev_b32 v142, 16, v116
v_and_b32 v143, 0xffff0000, v116
v_max_f32 v142, 0, v142
v_max_f32 v143, 0, v143
v_mul_f32 v142, v142, v142
v_mul_f32 v143, v143, v143
v_cvt_pk_bf16_f32 v116, v144, v145
v_lshlrev_b32 v144, 16, v116
v_and_b32 v145, 0xffff0000, v116
v_lshlrev_b32 v117, 16, v130
v_and_b32 v118, 0xffff0000, v130
v_add_f32 v144, v144, v117
v_add_f32 v145, v145, v118
v_cvt_pk_bf16_f32 v116, v144, v145
v_lshlrev_b32 v144, 16, v116
v_and_b32 v145, 0xffff0000, v116
v_max_f32 v144, 0, v144
v_max_f32 v145, 0, v145
v_mul_f32 v144, v144, v144
v_mul_f32 v145, v145, v145
v_cvt_pk_bf16_f32 v116, v146, v147
v_lshlrev_b32 v146, 16, v116
v_and_b32 v147, 0xffff0000, v116
v_lshlrev_b32 v117, 16, v131
v_and_b32 v118, 0xffff0000, v131
v_add_f32 v146, v146, v117
v_add_f32 v147, v147, v118
v_cvt_pk_bf16_f32 v116, v146, v147
v_lshlrev_b32 v146, 16, v116
v_and_b32 v147, 0xffff0000, v116
v_max_f32 v146, 0, v146
v_max_f32 v147, 0, v147
v_mul_f32 v146, v146, v146
v_mul_f32 v147, v147, v147
v_cvt_pk_bf16_f32 v116, v132, v133
v_cvt_pk_bf16_f32 v117, v134, v135
v_cvt_pk_bf16_f32 v118, v140, v141
v_cvt_pk_bf16_f32 v119, v142, v143
v_cvt_pk_bf16_f32 v120, v136, v137
v_cvt_pk_bf16_f32 v121, v138, v139
v_cvt_pk_bf16_f32 v122, v144, v145
v_cvt_pk_bf16_f32 v123, v146, v147
s_add_u32 s41, s40, 38912
buffer_store_dwordx4 v[116:119], v112, s[20:23], s41 offen sc1
buffer_store_dwordx4 v[120:123], v148, s[20:23], s41 offen sc1
s_mov_b32 s60, 178479104
s_branch L_g1_next_B
L_g1_v_B:
s_waitcnt vmcnt(21)
s_barrier
ds_read_b128 v[44:47], v34 offset:0
ds_read_b128 v[48:51], v34 offset:2048
ds_read_b128 v[52:55], v34 offset:4096
ds_read_b128 v[56:59], v34 offset:6144
ds_read_b64_tr_b16 v[76:77], v36 offset:0
ds_read_b64_tr_b16 v[78:79], v37 offset:0
ds_read_b64_tr_b16 v[80:81], v40 offset:0
ds_read_b64_tr_b16 v[82:83], v41 offset:0
ds_read_b64_tr_b16 v[84:85], v36 offset:128
ds_read_b64_tr_b16 v[86:87], v37 offset:128
s_waitcnt lgkmcnt(0)
v_mfma_f32_32x32x16_bf16 a[0:15], v[44:47], v[76:79], 0
ds_read_b128 v[60:63], v35 offset:0
v_mfma_f32_32x32x16_bf16 a[16:31], v[44:47], v[80:83], 0
ds_read_b128 v[64:67], v35 offset:2048
v_mfma_f32_32x32x16_bf16 a[32:47], v[44:47], v[84:87], 0
ds_read_b128 v[68:71], v35 offset:4096
v_mfma_f32_32x32x16_bf16 a[48:63], v[48:51], v[76:79], 0
ds_read_b128 v[72:75], v35 offset:6144
v_mfma_f32_32x32x16_bf16 a[64:79], v[48:51], v[80:83], 0
ds_read_b64_tr_b16 v[88:89], v38 offset:0
ds_read_b64_tr_b16 v[90:91], v39 offset:0
v_mfma_f32_32x32x16_bf16 a[80:95], v[48:51], v[84:87], 0
ds_read_b64_tr_b16 v[92:93], v42 offset:0
ds_read_b64_tr_b16 v[94:95], v43 offset:0
v_mfma_f32_32x32x16_bf16 a[96:111], v[52:55], v[76:79], 0
ds_read_b64_tr_b16 v[96:97], v38 offset:128
ds_read_b64_tr_b16 v[98:99], v39 offset:128
v_mfma_f32_32x32x16_bf16 a[112:127], v[52:55], v[80:83], 0
v_mfma_f32_32x32x16_bf16 a[128:143], v[52:55], v[84:87], 0
v_mfma_f32_32x32x16_bf16 a[144:159], v[56:59], v[76:79], 0
v_mfma_f32_32x32x16_bf16 a[160:175], v[56:59], v[80:83], 0
v_mfma_f32_32x32x16_bf16 a[176:191], v[56:59], v[84:87], 0
s_waitcnt lgkmcnt(0)
s_waitcnt vmcnt(14)
s_barrier
v_mfma_f32_32x32x16_bf16 a[0:15], v[60:63], v[88:91], a[0:15]
ds_read_b128 v[44:47], v34 offset:28672
ds_read_b128 v[48:51], v34 offset:30720
v_mfma_f32_32x32x16_bf16 a[16:31], v[60:63], v[92:95], a[16:31]
ds_read_b128 v[52:55], v34 offset:32768
ds_read_b128 v[56:59], v34 offset:34816
v_mfma_f32_32x32x16_bf16 a[32:47], v[60:63], v[96:99], a[32:47]
ds_read_b64_tr_b16 v[76:77], v36 offset:28672
ds_read_b64_tr_b16 v[78:79], v37 offset:28672
ds_read_b64_tr_b16 v[80:81], v40 offset:28672
ds_read_b64_tr_b16 v[82:83], v41 offset:28672
v_mfma_f32_32x32x16_bf16 a[48:63], v[64:67], v[88:91], a[48:63]
ds_read_b64_tr_b16 v[84:85], v36 offset:28800
ds_read_b64_tr_b16 v[86:87], v37 offset:28800
s_add_u32 m0, s45, 0
s_nop 0
buffer_load_dwordx4 v21, s[20:23], s53 offen lds
v_mfma_f32_32x32x16_bf16 a[64:79], v[64:67], v[92:95], a[64:79]
s_add_u32 m0, s45, 1024
s_nop 0
buffer_load_dwordx4 v22, s[20:23], s53 offen lds
s_add_u32 m0, s45, 2048
s_nop 0
buffer_load_dwordx4 v23, s[20:23], s53 offen lds
v_mfma_f32_32x32x16_bf16 a[80:95], v[64:67], v[96:99], a[80:95]
s_add_u32 m0, s45, 3072
s_nop 0
buffer_load_dwordx4 v24, s[20:23], s53 offen lds
s_add_u32 m0, s46, 0
s_nop 0
buffer_load_dwordx4 v31, s[32:35], s54 offen lds
v_mfma_f32_32x32x16_bf16 a[96:111], v[68:71], v[88:91], a[96:111]
s_add_u32 m0, s46, 1024
s_nop 0
buffer_load_dwordx4 v32, s[32:35], s54 offen lds
s_add_u32 m0, s46, 2048
s_nop 0
buffer_load_dwordx4 v33, s[32:35], s54 offen lds
s_add_u32 s53, s53, 16384
s_add_u32 s54, s54, s57
v_mfma_f32_32x32x16_bf16 a[112:127], v[68:71], v[92:95], a[112:127]
v_mfma_f32_32x32x16_bf16 a[128:143], v[68:71], v[96:99], a[128:143]
v_mfma_f32_32x32x16_bf16 a[144:159], v[72:75], v[88:91], a[144:159]
v_mfma_f32_32x32x16_bf16 a[160:175], v[72:75], v[92:95], a[160:175]
v_mfma_f32_32x32x16_bf16 a[176:191], v[72:75], v[96:99], a[176:191]
s_waitcnt lgkmcnt(0)
v_mfma_f32_32x32x16_bf16 a[0:15], v[44:47], v[76:79], a[0:15]
ds_read_b128 v[60:63], v35 offset:28672
v_mfma_f32_32x32x16_bf16 a[16:31], v[44:47], v[80:83], a[16:31]
ds_read_b128 v[64:67], v35 offset:30720
v_mfma_f32_32x32x16_bf16 a[32:47], v[44:47], v[84:87], a[32:47]
ds_read_b128 v[68:71], v35 offset:32768
v_mfma_f32_32x32x16_bf16 a[48:63], v[48:51], v[76:79], a[48:63]
ds_read_b128 v[72:75], v35 offset:34816
v_mfma_f32_32x32x16_bf16 a[64:79], v[48:51], v[80:83], a[64:79]
ds_read_b64_tr_b16 v[88:89], v38 offset:28672
ds_read_b64_tr_b16 v[90:91], v39 offset:28672
v_mfma_f32_32x32x16_bf16 a[80:95], v[48:51], v[84:87], a[80:95]
ds_read_b64_tr_b16 v[92:93], v42 offset:28672
ds_read_b64_tr_b16 v[94:95], v43 offset:28672
v_mfma_f32_32x32x16_bf16 a[96:111], v[52:55], v[76:79], a[96:111]
ds_read_b64_tr_b16 v[96:97], v38 offset:28800
ds_read_b64_tr_b16 v[98:99], v39 offset:28800
v_mfma_f32_32x32x16_bf16 a[112:127], v[52:55], v[80:83], a[112:127]
v_mfma_f32_32x32x16_bf16 a[128:143], v[52:55], v[84:87], a[128:143]
v_mfma_f32_32x32x16_bf16 a[144:159], v[56:59], v[76:79], a[144:159]
v_mfma_f32_32x32x16_bf16 a[160:175], v[56:59], v[80:83], a[160:175]
v_mfma_f32_32x32x16_bf16 a[176:191], v[56:59], v[84:87], a[176:191]
s_waitcnt lgkmcnt(0)
s_waitcnt vmcnt(14)
s_barrier
v_mfma_f32_32x32x16_bf16 a[0:15], v[60:63], v[88:91], a[0:15]
ds_read_b128 v[44:47], v100 offset:0
ds_read_b128 v[48:51], v100 offset:2048
v_mfma_f32_32x32x16_bf16 a[16:31], v[60:63], v[92:95], a[16:31]
ds_read_b128 v[52:55], v100 offset:4096
ds_read_b128 v[56:59], v100 offset:6144
v_mfma_f32_32x32x16_bf16 a[32:47], v[60:63], v[96:99], a[32:47]
ds_read_b64_tr_b16 v[76:77], v102 offset:0
ds_read_b64_tr_b16 v[78:79], v103 offset:0
ds_read_b64_tr_b16 v[80:81], v106 offset:0
ds_read_b64_tr_b16 v[82:83], v107 offset:0
v_mfma_f32_32x32x16_bf16 a[48:63], v[64:67], v[88:91], a[48:63]
ds_read_b64_tr_b16 v[84:85], v102 offset:128
ds_read_b64_tr_b16 v[86:87], v103 offset:128
s_add_u32 m0, s45, 28672
s_nop 0
buffer_load_dwordx4 v21, s[20:23], s53 offen lds
v_mfma_f32_32x32x16_bf16 a[64:79], v[64:67], v[92:95], a[64:79]
s_add_u32 m0, s45, 29696
s_nop 0
buffer_load_dwordx4 v22, s[20:23], s53 offen lds
s_add_u32 m0, s45, 30720
s_nop 0
buffer_load_dwordx4 v23, s[20:23], s53 offen lds
v_mfma_f32_32x32x16_bf16 a[80:95], v[64:67], v[96:99], a[80:95]
s_add_u32 m0, s45, 31744
s_nop 0
buffer_load_dwordx4 v24, s[20:23], s53 offen lds
s_add_u32 m0, s46, 28672
s_nop 0
buffer_load_dwordx4 v31, s[32:35], s54 offen lds
v_mfma_f32_32x32x16_bf16 a[96:111], v[68:71], v[88:91], a[96:111]
s_add_u32 m0, s46, 29696
s_nop 0
buffer_load_dwordx4 v32, s[32:35], s54 offen lds
s_add_u32 m0, s46, 30720
s_nop 0
buffer_load_dwordx4 v33, s[32:35], s54 offen lds
s_add_u32 s53, s53, 16384
s_add_u32 s54, s54, s57
v_mfma_f32_32x32x16_bf16 a[112:127], v[68:71], v[92:95], a[112:127]
v_mfma_f32_32x32x16_bf16 a[128:143], v[68:71], v[96:99], a[128:143]
v_mfma_f32_32x32x16_bf16 a[144:159], v[72:75], v[88:91], a[144:159]
v_mfma_f32_32x32x16_bf16 a[160:175], v[72:75], v[92:95], a[160:175]
v_mfma_f32_32x32x16_bf16 a[176:191], v[72:75], v[96:99], a[176:191]
s_waitcnt lgkmcnt(0)
v_mfma_f32_32x32x16_bf16 a[0:15], v[44:47], v[76:79], a[0:15]
ds_read_b128 v[60:63], v101 offset:0
v_mfma_f32_32x32x16_bf16 a[16:31], v[44:47], v[80:83], a[16:31]
ds_read_b128 v[64:67], v101 offset:2048
v_mfma_f32_32x32x16_bf16 a[32:47], v[44:47], v[84:87], a[32:47]
ds_read_b128 v[68:71], v101 offset:4096
v_mfma_f32_32x32x16_bf16 a[48:63], v[48:51], v[76:79], a[48:63]
ds_read_b128 v[72:75], v101 offset:6144
v_mfma_f32_32x32x16_bf16 a[64:79], v[48:51], v[80:83], a[64:79]
ds_read_b64_tr_b16 v[88:89], v104 offset:0
ds_read_b64_tr_b16 v[90:91], v105 offset:0
v_mfma_f32_32x32x16_bf16 a[80:95], v[48:51], v[84:87], a[80:95]
ds_read_b64_tr_b16 v[92:93], v108 offset:0
ds_read_b64_tr_b16 v[94:95], v109 offset:0
v_mfma_f32_32x32x16_bf16 a[96:111], v[52:55], v[76:79], a[96:111]
ds_read_b64_tr_b16 v[96:97], v104 offset:128
ds_read_b64_tr_b16 v[98:99], v105 offset:128
v_mfma_f32_32x32x16_bf16 a[112:127], v[52:55], v[80:83], a[112:127]
v_mfma_f32_32x32x16_bf16 a[128:143], v[52:55], v[84:87], a[128:143]
v_mfma_f32_32x32x16_bf16 a[144:159], v[56:59], v[76:79], a[144:159]
v_mfma_f32_32x32x16_bf16 a[160:175], v[56:59], v[80:83], a[160:175]
v_mfma_f32_32x32x16_bf16 a[176:191], v[56:59], v[84:87], a[176:191]
s_waitcnt lgkmcnt(0)
s_waitcnt vmcnt(14)
s_barrier
v_mfma_f32_32x32x16_bf16 a[0:15], v[60:63], v[88:91], a[0:15]
ds_read_b128 v[44:47], v100 offset:28672
ds_read_b128 v[48:51], v100 offset:30720
v_mfma_f32_32x32x16_bf16 a[16:31], v[60:63], v[92:95], a[16:31]
ds_read_b128 v[52:55], v100 offset:32768
ds_read_b128 v[56:59], v100 offset:34816
v_mfma_f32_32x32x16_bf16 a[32:47], v[60:63], v[96:99], a[32:47]
ds_read_b64_tr_b16 v[76:77], v102 offset:28672
ds_read_b64_tr_b16 v[78:79], v103 offset:28672
ds_read_b64_tr_b16 v[80:81], v106 offset:28672
ds_read_b64_tr_b16 v[82:83], v107 offset:28672
v_mfma_f32_32x32x16_bf16 a[48:63], v[64:67], v[88:91], a[48:63]
ds_read_b64_tr_b16 v[84:85], v102 offset:28800
ds_read_b64_tr_b16 v[86:87], v103 offset:28800
s_add_u32 m0, s45, 57344
s_nop 0
buffer_load_dwordx4 v21, s[20:23], s53 offen lds
v_mfma_f32_32x32x16_bf16 a[64:79], v[64:67], v[92:95], a[64:79]
s_add_u32 m0, s45, 58368
s_nop 0
buffer_load_dwordx4 v22, s[20:23], s53 offen lds
s_add_u32 m0, s45, 59392
s_nop 0
buffer_load_dwordx4 v23, s[20:23], s53 offen lds
v_mfma_f32_32x32x16_bf16 a[80:95], v[64:67], v[96:99], a[80:95]
s_add_u32 m0, s45, 60416
s_nop 0
buffer_load_dwordx4 v24, s[20:23], s53 offen lds
s_add_u32 m0, s46, 57344
s_nop 0
buffer_load_dwordx4 v31, s[32:35], s54 offen lds
v_mfma_f32_32x32x16_bf16 a[96:111], v[68:71], v[88:91], a[96:111]
s_add_u32 m0, s46, 58368
s_nop 0
buffer_load_dwordx4 v32, s[32:35], s54 offen lds
s_add_u32 m0, s46, 59392
s_nop 0
buffer_load_dwordx4 v33, s[32:35], s54 offen lds
s_add_u32 s53, s53, 16384
s_add_u32 s54, s54, s57
v_mfma_f32_32x32x16_bf16 a[112:127], v[68:71], v[92:95], a[112:127]
v_mfma_f32_32x32x16_bf16 a[128:143], v[68:71], v[96:99], a[128:143]
v_mfma_f32_32x32x16_bf16 a[144:159], v[72:75], v[88:91], a[144:159]
v_mfma_f32_32x32x16_bf16 a[160:175], v[72:75], v[92:95], a[160:175]
v_mfma_f32_32x32x16_bf16 a[176:191], v[72:75], v[96:99], a[176:191]
s_waitcnt lgkmcnt(0)
v_mfma_f32_32x32x16_bf16 a[0:15], v[44:47], v[76:79], a[0:15]
ds_read_b128 v[60:63], v101 offset:28672
v_mfma_f32_32x32x16_bf16 a[16:31], v[44:47], v[80:83], a[16:31]
ds_read_b128 v[64:67], v101 offset:30720
v_mfma_f32_32x32x16_bf16 a[32:47], v[44:47], v[84:87], a[32:47]
ds_read_b128 v[68:71], v101 offset:32768
v_mfma_f32_32x32x16_bf16 a[48:63], v[48:51], v[76:79], a[48:63]
ds_read_b128 v[72:75], v101 offset:34816
v_mfma_f32_32x32x16_bf16 a[64:79], v[48:51], v[80:83], a[64:79]
ds_read_b64_tr_b16 v[88:89], v104 offset:28672
ds_read_b64_tr_b16 v[90:91], v105 offset:28672
v_mfma_f32_32x32x16_bf16 a[80:95], v[48:51], v[84:87], a[80:95]
ds_read_b64_tr_b16 v[92:93], v108 offset:28672
ds_read_b64_tr_b16 v[94:95], v109 offset:28672
v_mfma_f32_32x32x16_bf16 a[96:111], v[52:55], v[76:79], a[96:111]
ds_read_b64_tr_b16 v[96:97], v104 offset:28800
ds_read_b64_tr_b16 v[98:99], v105 offset:28800
v_mfma_f32_32x32x16_bf16 a[112:127], v[52:55], v[80:83], a[112:127]
v_mfma_f32_32x32x16_bf16 a[128:143], v[52:55], v[84:87], a[128:143]
v_mfma_f32_32x32x16_bf16 a[144:159], v[56:59], v[76:79], a[144:159]
v_mfma_f32_32x32x16_bf16 a[160:175], v[56:59], v[80:83], a[160:175]
v_mfma_f32_32x32x16_bf16 a[176:191], v[56:59], v[84:87], a[176:191]
s_waitcnt lgkmcnt(0)
s_waitcnt vmcnt(14)
s_barrier
v_mfma_f32_32x32x16_bf16 a[0:15], v[60:63], v[88:91], a[0:15]
ds_read_b128 v[44:47], v34 offset:0
ds_read_b128 v[48:51], v34 offset:2048
v_mfma_f32_32x32x16_bf16 a[16:31], v[60:63], v[92:95], a[16:31]
ds_read_b128 v[52:55], v34 offset:4096
ds_read_b128 v[56:59], v34 offset:6144
v_mfma_f32_32x32x16_bf16 a[32:47], v[60:63], v[96:99], a[32:47]
ds_read_b64_tr_b16 v[76:77], v36 offset:0
ds_read_b64_tr_b16 v[78:79], v37 offset:0
ds_read_b64_tr_b16 v[80:81], v40 offset:0
ds_read_b64_tr_b16 v[82:83], v41 offset:0
v_mfma_f32_32x32x16_bf16 a[48:63], v[64:67], v[88:91], a[48:63]
ds_read_b64_tr_b16 v[84:85], v36 offset:128
ds_read_b64_tr_b16 v[86:87], v37 offset:128
s_add_u32 m0, s45, 86016
s_nop 0
buffer_load_dwordx4 v21, s[20:23], s53 offen lds
v_mfma_f32_32x32x16_bf16 a[64:79], v[64:67], v[92:95], a[64:79]
s_add_u32 m0, s45, 87040
s_nop 0
buffer_load_dwordx4 v22, s[20:23], s53 offen lds
s_add_u32 m0, s45, 88064
s_nop 0
buffer_load_dwordx4 v23, s[20:23], s53 offen lds
v_mfma_f32_32x32x16_bf16 a[80:95], v[64:67], v[96:99], a[80:95]
s_add_u32 m0, s45, 89088
s_nop 0
buffer_load_dwordx4 v24, s[20:23], s53 offen lds
s_add_u32 m0, s46, 86016
s_nop 0
buffer_load_dwordx4 v31, s[32:35], s54 offen lds
v_mfma_f32_32x32x16_bf16 a[96:111], v[68:71], v[88:91], a[96:111]
s_add_u32 m0, s46, 87040
s_nop 0
buffer_load_dwordx4 v32, s[32:35], s54 offen lds
s_add_u32 m0, s46, 88064
s_nop 0
buffer_load_dwordx4 v33, s[32:35], s54 offen lds
s_add_u32 s53, s53, 16384
s_add_u32 s54, s54, s57
v_mfma_f32_32x32x16_bf16 a[112:127], v[68:71], v[92:95], a[112:127]
v_mfma_f32_32x32x16_bf16 a[128:143], v[68:71], v[96:99], a[128:143]
v_mfma_f32_32x32x16_bf16 a[144:159], v[72:75], v[88:91], a[144:159]
v_mfma_f32_32x32x16_bf16 a[160:175], v[72:75], v[92:95], a[160:175]
v_mfma_f32_32x32x16_bf16 a[176:191], v[72:75], v[96:99], a[176:191]
s_mov_b32 s42, 3
s_cmp_eq_u32 s42, 0
s_cbranch_scc1 L_g1_xw_last_B
s_nop 8
L_g1_xw_B:
s_waitcnt lgkmcnt(0)
v_mfma_f32_32x32x16_bf16 a[0:15], v[44:47], v[76:79], a[0:15]
ds_read_b128 v[60:63], v35 offset:0
v_mfma_f32_32x32x16_bf16 a[16:31], v[44:47], v[80:83], a[16:31]
ds_read_b128 v[64:67], v35 offset:2048
v_mfma_f32_32x32x16_bf16 a[32:47], v[44:47], v[84:87], a[32:47]
ds_read_b128 v[68:71], v35 offset:4096
v_mfma_f32_32x32x16_bf16 a[48:63], v[48:51], v[76:79], a[48:63]
ds_read_b128 v[72:75], v35 offset:6144
v_mfma_f32_32x32x16_bf16 a[64:79], v[48:51], v[80:83], a[64:79]
ds_read_b64_tr_b16 v[88:89], v38 offset:0
ds_read_b64_tr_b16 v[90:91], v39 offset:0
v_mfma_f32_32x32x16_bf16 a[80:95], v[48:51], v[84:87], a[80:95]
ds_read_b64_tr_b16 v[92:93], v42 offset:0
ds_read_b64_tr_b16 v[94:95], v43 offset:0
v_mfma_f32_32x32x16_bf16 a[96:111], v[52:55], v[76:79], a[96:111]
ds_read_b64_tr_b16 v[96:97], v38 offset:128
ds_read_b64_tr_b16 v[98:99], v39 offset:128
v_mfma_f32_32x32x16_bf16 a[112:127], v[52:55], v[80:83], a[112:127]
v_mfma_f32_32x32x16_bf16 a[128:143], v[52:55], v[84:87], a[128:143]
v_mfma_f32_32x32x16_bf16 a[144:159], v[56:59], v[76:79], a[144:159]
v_mfma_f32_32x32x16_bf16 a[160:175], v[56:59], v[80:83], a[160:175]
v_mfma_f32_32x32x16_bf16 a[176:191], v[56:59], v[84:87], a[176:191]
s_waitcnt lgkmcnt(0)
s_waitcnt vmcnt(14)
s_barrier
v_mfma_f32_32x32x16_bf16 a[0:15], v[60:63], v[88:91], a[0:15]
ds_read_b128 v[44:47], v34 offset:28672
ds_read_b128 v[48:51], v34 offset:30720
v_mfma_f32_32x32x16_bf16 a[16:31], v[60:63], v[92:95], a[16:31]
ds_read_b128 v[52:55], v34 offset:32768
ds_read_b128 v[56:59], v34 offset:34816
v_mfma_f32_32x32x16_bf16 a[32:47], v[60:63], v[96:99], a[32:47]
ds_read_b64_tr_b16 v[76:77], v36 offset:28672
ds_read_b64_tr_b16 v[78:79], v37 offset:28672
ds_read_b64_tr_b16 v[80:81], v40 offset:28672
ds_read_b64_tr_b16 v[82:83], v41 offset:28672
v_mfma_f32_32x32x16_bf16 a[48:63], v[64:67], v[88:91], a[48:63]
ds_read_b64_tr_b16 v[84:85], v36 offset:28800
ds_read_b64_tr_b16 v[86:87], v37 offset:28800
s_add_u32 m0, s45, 0
s_nop 0
buffer_load_dwordx4 v21, s[20:23], s53 offen lds
v_mfma_f32_32x32x16_bf16 a[64:79], v[64:67], v[92:95], a[64:79]
s_add_u32 m0, s45, 1024
s_nop 0
buffer_load_dwordx4 v22, s[20:23], s53 offen lds
s_add_u32 m0, s45, 2048
s_nop 0
buffer_load_dwordx4 v23, s[20:23], s53 offen lds
v_mfma_f32_32x32x16_bf16 a[80:95], v[64:67], v[96:99], a[80:95]
s_add_u32 m0, s45, 3072
s_nop 0
buffer_load_dwordx4 v24, s[20:23], s53 offen lds
s_add_u32 m0, s46, 0
s_nop 0
buffer_load_dwordx4 v31, s[32:35], s54 offen lds
v_mfma_f32_32x32x16_bf16 a[96:111], v[68:71], v[88:91], a[96:111]
s_add_u32 m0, s46, 1024
s_nop 0
buffer_load_dwordx4 v32, s[32:35], s54 offen lds
s_add_u32 m0, s46, 2048
s_nop 0
buffer_load_dwordx4 v33, s[32:35], s54 offen lds
s_add_u32 s53, s53, 16384
s_add_u32 s54, s54, s57
v_mfma_f32_32x32x16_bf16 a[112:127], v[68:71], v[92:95], a[112:127]
v_mfma_f32_32x32x16_bf16 a[128:143], v[68:71], v[96:99], a[128:143]
v_mfma_f32_32x32x16_bf16 a[144:159], v[72:75], v[88:91], a[144:159]
v_mfma_f32_32x32x16_bf16 a[160:175], v[72:75], v[92:95], a[160:175]
v_mfma_f32_32x32x16_bf16 a[176:191], v[72:75], v[96:99], a[176:191]
s_waitcnt lgkmcnt(0)
v_mfma_f32_32x32x16_bf16 a[0:15], v[44:47], v[76:79], a[0:15]
ds_read_b128 v[60:63], v35 offset:28672
v_mfma_f32_32x32x16_bf16 a[16:31], v[44:47], v[80:83], a[16:31]
ds_read_b128 v[64:67], v35 offset:30720
v_mfma_f32_32x32x16_bf16 a[32:47], v[44:47], v[84:87], a[32:47]
ds_read_b128 v[68:71], v35 offset:32768
v_mfma_f32_32x32x16_bf16 a[48:63], v[48:51], v[76:79], a[48:63]
ds_read_b128 v[72:75], v35 offset:34816
v_mfma_f32_32x32x16_bf16 a[64:79], v[48:51], v[80:83], a[64:79]
ds_read_b64_tr_b16 v[88:89], v38 offset:28672
ds_read_b64_tr_b16 v[90:91], v39 offset:28672
v_mfma_f32_32x32x16_bf16 a[80:95], v[48:51], v[84:87], a[80:95]
ds_read_b64_tr_b16 v[92:93], v42 offset:28672
ds_read_b64_tr_b16 v[94:95], v43 offset:28672
v_mfma_f32_32x32x16_bf16 a[96:111], v[52:55], v[76:79], a[96:111]
ds_read_b64_tr_b16 v[96:97], v38 offset:28800
ds_read_b64_tr_b16 v[98:99], v39 offset:28800
v_mfma_f32_32x32x16_bf16 a[112:127], v[52:55], v[80:83], a[112:127]
v_mfma_f32_32x32x16_bf16 a[128:143], v[52:55], v[84:87], a[128:143]
v_mfma_f32_32x32x16_bf16 a[144:159], v[56:59], v[76:79], a[144:159]
v_mfma_f32_32x32x16_bf16 a[160:175], v[56:59], v[80:83], a[160:175]
v_mfma_f32_32x32x16_bf16 a[176:191], v[56:59], v[84:87], a[176:191]
s_waitcnt lgkmcnt(0)
s_waitcnt vmcnt(14)
s_barrier
v_mfma_f32_32x32x16_bf16 a[0:15], v[60:63], v[88:91], a[0:15]
ds_read_b128 v[44:47], v100 offset:0
ds_read_b128 v[48:51], v100 offset:2048
v_mfma_f32_32x32x16_bf16 a[16:31], v[60:63], v[92:95], a[16:31]
ds_read_b128 v[52:55], v100 offset:4096
ds_read_b128 v[56:59], v100 offset:6144
v_mfma_f32_32x32x16_bf16 a[32:47], v[60:63], v[96:99], a[32:47]
ds_read_b64_tr_b16 v[76:77], v102 offset:0
ds_read_b64_tr_b16 v[78:79], v103 offset:0
ds_read_b64_tr_b16 v[80:81], v106 offset:0
ds_read_b64_tr_b16 v[82:83], v107 offset:0
v_mfma_f32_32x32x16_bf16 a[48:63], v[64:67], v[88:91], a[48:63]
ds_read_b64_tr_b16 v[84:85], v102 offset:128
ds_read_b64_tr_b16 v[86:87], v103 offset:128
s_add_u32 m0, s45, 28672
s_nop 0
buffer_load_dwordx4 v21, s[20:23], s53 offen lds
v_mfma_f32_32x32x16_bf16 a[64:79], v[64:67], v[92:95], a[64:79]
s_add_u32 m0, s45, 29696
s_nop 0
buffer_load_dwordx4 v22, s[20:23], s53 offen lds
s_add_u32 m0, s45, 30720
s_nop 0
buffer_load_dwordx4 v23, s[20:23], s53 offen lds
v_mfma_f32_32x32x16_bf16 a[80:95], v[64:67], v[96:99], a[80:95]
s_add_u32 m0, s45, 31744
s_nop 0
buffer_load_dwordx4 v24, s[20:23], s53 offen lds
s_add_u32 m0, s46, 28672
s_nop 0
buffer_load_dwordx4 v31, s[32:35], s54 offen lds
v_mfma_f32_32x32x16_bf16 a[96:111], v[68:71], v[88:91], a[96:111]
s_add_u32 m0, s46, 29696
s_nop 0
buffer_load_dwordx4 v32, s[32:35], s54 offen lds
s_add_u32 m0, s46, 30720
s_nop 0
buffer_load_dwordx4 v33, s[32:35], s54 offen lds
s_add_u32 s53, s53, 16384
s_add_u32 s54, s54, s57
v_mfma_f32_32x32x16_bf16 a[112:127], v[68:71], v[92:95], a[112:127]
v_mfma_f32_32x32x16_bf16 a[128:143], v[68:71], v[96:99], a[128:143]
v_mfma_f32_32x32x16_bf16 a[144:159], v[72:75], v[88:91], a[144:159]
v_mfma_f32_32x32x16_bf16 a[160:175], v[72:75], v[92:95], a[160:175]
v_mfma_f32_32x32x16_bf16 a[176:191], v[72:75], v[96:99], a[176:191]
s_waitcnt lgkmcnt(0)
v_mfma_f32_32x32x16_bf16 a[0:15], v[44:47], v[76:79], a[0:15]
ds_read_b128 v[60:63], v101 offset:0
v_mfma_f32_32x32x16_bf16 a[16:31], v[44:47], v[80:83], a[16:31]
ds_read_b128 v[64:67], v101 offset:2048
v_mfma_f32_32x32x16_bf16 a[32:47], v[44:47], v[84:87], a[32:47]
ds_read_b128 v[68:71], v101 offset:4096
v_mfma_f32_32x32x16_bf16 a[48:63], v[48:51], v[76:79], a[48:63]
ds_read_b128 v[72:75], v101 offset:6144
v_mfma_f32_32x32x16_bf16 a[64:79], v[48:51], v[80:83], a[64:79]
ds_read_b64_tr_b16 v[88:89], v104 offset:0
ds_read_b64_tr_b16 v[90:91], v105 offset:0
v_mfma_f32_32x32x16_bf16 a[80:95], v[48:51], v[84:87], a[80:95]
ds_read_b64_tr_b16 v[92:93], v108 offset:0
ds_read_b64_tr_b16 v[94:95], v109 offset:0
v_mfma_f32_32x32x16_bf16 a[96:111], v[52:55], v[76:79], a[96:111]
ds_read_b64_tr_b16 v[96:97], v104 offset:128
ds_read_b64_tr_b16 v[98:99], v105 offset:128
v_mfma_f32_32x32x16_bf16 a[112:127], v[52:55], v[80:83], a[112:127]
v_mfma_f32_32x32x16_bf16 a[128:143], v[52:55], v[84:87], a[128:143]
v_mfma_f32_32x32x16_bf16 a[144:159], v[56:59], v[76:79], a[144:159]
v_mfma_f32_32x32x16_bf16 a[160:175], v[56:59], v[80:83], a[160:175]
v_mfma_f32_32x32x16_bf16 a[176:191], v[56:59], v[84:87], a[176:191]
s_waitcnt lgkmcnt(0)
s_waitcnt vmcnt(14)
s_barrier
v_mfma_f32_32x32x16_bf16 a[0:15], v[60:63], v[88:91], a[0:15]
ds_read_b128 v[44:47], v100 offset:28672
ds_read_b128 v[48:51], v100 offset:30720
v_mfma_f32_32x32x16_bf16 a[16:31], v[60:63], v[92:95], a[16:31]
ds_read_b128 v[52:55], v100 offset:32768
ds_read_b128 v[56:59], v100 offset:34816
v_mfma_f32_32x32x16_bf16 a[32:47], v[60:63], v[96:99], a[32:47]
ds_read_b64_tr_b16 v[76:77], v102 offset:28672
ds_read_b64_tr_b16 v[78:79], v103 offset:28672
ds_read_b64_tr_b16 v[80:81], v106 offset:28672
ds_read_b64_tr_b16 v[82:83], v107 offset:28672
v_mfma_f32_32x32x16_bf16 a[48:63], v[64:67], v[88:91], a[48:63]
ds_read_b64_tr_b16 v[84:85], v102 offset:28800
ds_read_b64_tr_b16 v[86:87], v103 offset:28800
s_add_u32 m0, s45, 57344
s_nop 0
buffer_load_dwordx4 v21, s[20:23], s53 offen lds
v_mfma_f32_32x32x16_bf16 a[64:79], v[64:67], v[92:95], a[64:79]
s_add_u32 m0, s45, 58368
s_nop 0
buffer_load_dwordx4 v22, s[20:23], s53 offen lds
s_add_u32 m0, s45, 59392
s_nop 0
buffer_load_dwordx4 v23, s[20:23], s53 offen lds
v_mfma_f32_32x32x16_bf16 a[80:95], v[64:67], v[96:99], a[80:95]
s_add_u32 m0, s45, 60416
s_nop 0
buffer_load_dwordx4 v24, s[20:23], s53 offen lds
s_add_u32 m0, s46, 57344
s_nop 0
buffer_load_dwordx4 v31, s[32:35], s54 offen lds
v_mfma_f32_32x32x16_bf16 a[96:111], v[68:71], v[88:91], a[96:111]
s_add_u32 m0, s46, 58368
s_nop 0
buffer_load_dwordx4 v32, s[32:35], s54 offen lds
s_add_u32 m0, s46, 59392
s_nop 0
buffer_load_dwordx4 v33, s[32:35], s54 offen lds
s_add_u32 s53, s53, 16384
s_add_u32 s54, s54, s57
v_mfma_f32_32x32x16_bf16 a[112:127], v[68:71], v[92:95], a[112:127]
v_mfma_f32_32x32x16_bf16 a[128:143], v[68:71], v[96:99], a[128:143]
v_mfma_f32_32x32x16_bf16 a[144:159], v[72:75], v[88:91], a[144:159]
v_mfma_f32_32x32x16_bf16 a[160:175], v[72:75], v[92:95], a[160:175]
v_mfma_f32_32x32x16_bf16 a[176:191], v[72:75], v[96:99], a[176:191]
s_waitcnt lgkmcnt(0)
v_mfma_f32_32x32x16_bf16 a[0:15], v[44:47], v[76:79], a[0:15]
ds_read_b128 v[60:63], v101 offset:28672
v_mfma_f32_32x32x16_bf16 a[16:31], v[44:47], v[80:83], a[16:31]
ds_read_b128 v[64:67], v101 offset:30720
v_mfma_f32_32x32x16_bf16 a[32:47], v[44:47], v[84:87], a[32:47]
ds_read_b128 v[68:71], v101 offset:32768
v_mfma_f32_32x32x16_bf16 a[48:63], v[48:51], v[76:79], a[48:63]
ds_read_b128 v[72:75], v101 offset:34816
v_mfma_f32_32x32x16_bf16 a[64:79], v[48:51], v[80:83], a[64:79]
ds_read_b64_tr_b16 v[88:89], v104 offset:28672
ds_read_b64_tr_b16 v[90:91], v105 offset:28672
v_mfma_f32_32x32x16_bf16 a[80:95], v[48:51], v[84:87], a[80:95]
ds_read_b64_tr_b16 v[92:93], v108 offset:28672
ds_read_b64_tr_b16 v[94:95], v109 offset:28672
v_mfma_f32_32x32x16_bf16 a[96:111], v[52:55], v[76:79], a[96:111]
ds_read_b64_tr_b16 v[96:97], v104 offset:28800
ds_read_b64_tr_b16 v[98:99], v105 offset:28800
v_mfma_f32_32x32x16_bf16 a[112:127], v[52:55], v[80:83], a[112:127]
v_mfma_f32_32x32x16_bf16 a[128:143], v[52:55], v[84:87], a[128:143]
v_mfma_f32_32x32x16_bf16 a[144:159], v[56:59], v[76:79], a[144:159]
v_mfma_f32_32x32x16_bf16 a[160:175], v[56:59], v[80:83], a[160:175]
v_mfma_f32_32x32x16_bf16 a[176:191], v[56:59], v[84:87], a[176:191]
s_waitcnt lgkmcnt(0)
s_waitcnt vmcnt(14)
s_barrier
v_mfma_f32_32x32x16_bf16 a[0:15], v[60:63], v[88:91], a[0:15]
ds_read_b128 v[44:47], v34 offset:0
ds_read_b128 v[48:51], v34 offset:2048
v_mfma_f32_32x32x16_bf16 a[16:31], v[60:63], v[92:95], a[16:31]
ds_read_b128 v[52:55], v34 offset:4096
ds_read_b128 v[56:59], v34 offset:6144
v_mfma_f32_32x32x16_bf16 a[32:47], v[60:63], v[96:99], a[32:47]
ds_read_b64_tr_b16 v[76:77], v36 offset:0
ds_read_b64_tr_b16 v[78:79], v37 offset:0
ds_read_b64_tr_b16 v[80:81], v40 offset:0
ds_read_b64_tr_b16 v[82:83], v41 offset:0
v_mfma_f32_32x32x16_bf16 a[48:63], v[64:67], v[88:91], a[48:63]
ds_read_b64_tr_b16 v[84:85], v36 offset:128
ds_read_b64_tr_b16 v[86:87], v37 offset:128
s_add_u32 m0, s45, 86016
s_nop 0
buffer_load_dwordx4 v21, s[20:23], s53 offen lds
v_mfma_f32_32x32x16_bf16 a[64:79], v[64:67], v[92:95], a[64:79]
s_add_u32 m0, s45, 87040
s_nop 0
buffer_load_dwordx4 v22, s[20:23], s53 offen lds
s_add_u32 m0, s45, 88064
s_nop 0
buffer_load_dwordx4 v23, s[20:23], s53 offen lds
v_mfma_f32_32x32x16_bf16 a[80:95], v[64:67], v[96:99], a[80:95]
s_add_u32 m0, s45, 89088
s_nop 0
buffer_load_dwordx4 v24, s[20:23], s53 offen lds
s_add_u32 m0, s46, 86016
s_nop 0
buffer_load_dwordx4 v31, s[32:35], s54 offen lds
v_mfma_f32_32x32x16_bf16 a[96:111], v[68:71], v[88:91], a[96:111]
s_add_u32 m0, s46, 87040
s_nop 0
buffer_load_dwordx4 v32, s[32:35], s54 offen lds
s_add_u32 m0, s46, 88064
s_nop 0
buffer_load_dwordx4 v33, s[32:35], s54 offen lds
s_add_u32 s53, s53, 16384
s_add_u32 s54, s54, s57
v_mfma_f32_32x32x16_bf16 a[112:127], v[68:71], v[92:95], a[112:127]
v_mfma_f32_32x32x16_bf16 a[128:143], v[68:71], v[96:99], a[128:143]
v_mfma_f32_32x32x16_bf16 a[144:159], v[72:75], v[88:91], a[144:159]
v_mfma_f32_32x32x16_bf16 a[160:175], v[72:75], v[92:95], a[160:175]
v_mfma_f32_32x32x16_bf16 a[176:191], v[72:75], v[96:99], a[176:191]
s_sub_u32 s42, s42, 1
s_cmp_lg_u32 s42, 0
s_nop 9
s_cbranch_scc1 L_g1_xw_B
L_g1_xw_last_B:
s_waitcnt lgkmcnt(0)
v_mfma_f32_32x32x16_bf16 a[0:15], v[44:47], v[76:79], a[0:15]
ds_read_b128 v[60:63], v35 offset:0
v_mfma_f32_32x32x16_bf16 a[16:31], v[44:47], v[80:83], a[16:31]
ds_read_b128 v[64:67], v35 offset:2048
v_mfma_f32_32x32x16_bf16 a[32:47], v[44:47], v[84:87], a[32:47]
ds_read_b128 v[68:71], v35 offset:4096
v_mfma_f32_32x32x16_bf16 a[48:63], v[48:51], v[76:79], a[48:63]
ds_read_b128 v[72:75], v35 offset:6144
v_mfma_f32_32x32x16_bf16 a[64:79], v[48:51], v[80:83], a[64:79]
ds_read_b64_tr_b16 v[88:89], v38 offset:0
ds_read_b64_tr_b16 v[90:91], v39 offset:0
v_mfma_f32_32x32x16_bf16 a[80:95], v[48:51], v[84:87], a[80:95]
ds_read_b64_tr_b16 v[92:93], v42 offset:0
ds_read_b64_tr_b16 v[94:95], v43 offset:0
v_mfma_f32_32x32x16_bf16 a[96:111], v[52:55], v[76:79], a[96:111]
ds_read_b64_tr_b16 v[96:97], v38 offset:128
ds_read_b64_tr_b16 v[98:99], v39 offset:128
v_mfma_f32_32x32x16_bf16 a[112:127], v[52:55], v[80:83], a[112:127]
v_mfma_f32_32x32x16_bf16 a[128:143], v[52:55], v[84:87], a[128:143]
v_mfma_f32_32x32x16_bf16 a[144:159], v[56:59], v[76:79], a[144:159]
v_mfma_f32_32x32x16_bf16 a[160:175], v[56:59], v[80:83], a[160:175]
v_mfma_f32_32x32x16_bf16 a[176:191], v[56:59], v[84:87], a[176:191]
s_waitcnt lgkmcnt(0)
s_waitcnt vmcnt(14)
s_barrier
v_mfma_f32_32x32x16_bf16 a[0:15], v[60:63], v[88:91], a[0:15]
ds_read_b128 v[44:47], v34 offset:28672
v_mfma_f32_32x32x16_bf16 a[16:31], v[60:63], v[92:95], a[16:31]
ds_read_b128 v[48:51], v34 offset:30720
v_mfma_f32_32x32x16_bf16 a[32:47], v[60:63], v[96:99], a[32:47]
ds_read_b128 v[52:55], v34 offset:32768
v_mfma_f32_32x32x16_bf16 a[48:63], v[64:67], v[88:91], a[48:63]
ds_read_b128 v[56:59], v34 offset:34816
v_mfma_f32_32x32x16_bf16 a[64:79], v[64:67], v[92:95], a[64:79]
ds_read_b64_tr_b16 v[76:77], v36 offset:28672
ds_read_b64_tr_b16 v[78:79], v37 offset:28672
v_mfma_f32_32x32x16_bf16 a[80:95], v[64:67], v[96:99], a[80:95]
ds_read_b64_tr_b16 v[80:81], v40 offset:28672
ds_read_b64_tr_b16 v[82:83], v41 offset:28672
v_mfma_f32_32x32x16_bf16 a[96:111], v[68:71], v[88:91], a[96:111]
ds_read_b64_tr_b16 v[84:85], v36 offset:28800
ds_read_b64_tr_b16 v[86:87], v37 offset:28800
v_mfma_f32_32x32x16_bf16 a[112:127], v[68:71], v[92:95], a[112:127]
v_mfma_f32_32x32x16_bf16 a[128:143], v[68:71], v[96:99], a[128:143]
v_mfma_f32_32x32x16_bf16 a[144:159], v[72:75], v[88:91], a[144:159]
v_mfma_f32_32x32x16_bf16 a[160:175], v[72:75], v[92:95], a[160:175]
v_mfma_f32_32x32x16_bf16 a[176:191], v[72:75], v[96:99], a[176:191]
s_waitcnt lgkmcnt(0)
v_mfma_f32_32x32x16_bf16 a[0:15], v[44:47], v[76:79], a[0:15]
ds_read_b128 v[60:63], v35 offset:28672
v_mfma_f32_32x32x16_bf16 a[16:31], v[44:47], v[80:83], a[16:31]
ds_read_b128 v[64:67], v35 offset:30720
v_mfma_f32_32x32x16_bf16 a[32:47], v[44:47], v[84:87], a[32:47]
ds_read_b128 v[68:71], v35 offset:32768
v_mfma_f32_32x32x16_bf16 a[48:63], v[48:51], v[76:79], a[48:63]
ds_read_b128 v[72:75], v35 offset:34816
v_mfma_f32_32x32x16_bf16 a[64:79], v[48:51], v[80:83], a[64:79]
ds_read_b64_tr_b16 v[88:89], v38 offset:28672
ds_read_b64_tr_b16 v[90:91], v39 offset:28672
v_mfma_f32_32x32x16_bf16 a[80:95], v[48:51], v[84:87], a[80:95]
ds_read_b64_tr_b16 v[92:93], v42 offset:28672
ds_read_b64_tr_b16 v[94:95], v43 offset:28672
v_mfma_f32_32x32x16_bf16 a[96:111], v[52:55], v[76:79], a[96:111]
ds_read_b64_tr_b16 v[96:97], v38 offset:28800
ds_read_b64_tr_b16 v[98:99], v39 offset:28800
v_mfma_f32_32x32x16_bf16 a[112:127], v[52:55], v[80:83], a[112:127]
v_mfma_f32_32x32x16_bf16 a[128:143], v[52:55], v[84:87], a[128:143]
v_mfma_f32_32x32x16_bf16 a[144:159], v[56:59], v[76:79], a[144:159]
v_mfma_f32_32x32x16_bf16 a[160:175], v[56:59], v[80:83], a[160:175]
v_mfma_f32_32x32x16_bf16 a[176:191], v[56:59], v[84:87], a[176:191]
s_waitcnt lgkmcnt(0)
s_waitcnt vmcnt(7)
s_barrier
v_mfma_f32_32x32x16_bf16 a[0:15], v[60:63], v[88:91], a[0:15]
ds_read_b128 v[44:47], v100 offset:0
v_mfma_f32_32x32x16_bf16 a[16:31], v[60:63], v[92:95], a[16:31]
ds_read_b128 v[48:51], v100 offset:2048
v_mfma_f32_32x32x16_bf16 a[32:47], v[60:63], v[96:99], a[32:47]
ds_read_b128 v[52:55], v100 offset:4096
v_mfma_f32_32x32x16_bf16 a[48:63], v[64:67], v[88:91], a[48:63]
ds_read_b128 v[56:59], v100 offset:6144
v_mfma_f32_32x32x16_bf16 a[64:79], v[64:67], v[92:95], a[64:79]
ds_read_b64_tr_b16 v[76:77], v102 offset:0
ds_read_b64_tr_b16 v[78:79], v103 offset:0
v_mfma_f32_32x32x16_bf16 a[80:95], v[64:67], v[96:99], a[80:95]
ds_read_b64_tr_b16 v[80:81], v106 offset:0
ds_read_b64_tr_b16 v[82:83], v107 offset:0
v_mfma_f32_32x32x16_bf16 a[96:111], v[68:71], v[88:91], a[96:111]
ds_read_b64_tr_b16 v[84:85], v102 offset:128
ds_read_b64_tr_b16 v[86:87], v103 offset:128
v_mfma_f32_32x32x16_bf16 a[112:127], v[68:71], v[92:95], a[112:127]
v_mfma_f32_32x32x16_bf16 a[128:143], v[68:71], v[96:99], a[128:143]
v_mfma_f32_32x32x16_bf16 a[144:159], v[72:75], v[88:91], a[144:159]
v_mfma_f32_32x32x16_bf16 a[160:175], v[72:75], v[92:95], a[160:175]
v_mfma_f32_32x32x16_bf16 a[176:191], v[72:75], v[96:99], a[176:191]
s_waitcnt lgkmcnt(0)
v_mfma_f32_32x32x16_bf16 a[0:15], v[44:47], v[76:79], a[0:15]
ds_read_b128 v[60:63], v101 offset:0
v_mfma_f32_32x32x16_bf16 a[16:31], v[44:47], v[80:83], a[16:31]
ds_read_b128 v[64:67], v101 offset:2048
v_mfma_f32_32x32x16_bf16 a[32:47], v[44:47], v[84:87], a[32:47]
ds_read_b128 v[68:71], v101 offset:4096
v_mfma_f32_32x32x16_bf16 a[48:63], v[48:51], v[76:79], a[48:63]
ds_read_b128 v[72:75], v101 offset:6144
v_mfma_f32_32x32x16_bf16 a[64:79], v[48:51], v[80:83], a[64:79]
ds_read_b64_tr_b16 v[88:89], v104 offset:0
ds_read_b64_tr_b16 v[90:91], v105 offset:0
v_mfma_f32_32x32x16_bf16 a[80:95], v[48:51], v[84:87], a[80:95]
ds_read_b64_tr_b16 v[92:93], v108 offset:0
ds_read_b64_tr_b16 v[94:95], v109 offset:0
v_mfma_f32_32x32x16_bf16 a[96:111], v[52:55], v[76:79], a[96:111]
ds_read_b64_tr_b16 v[96:97], v104 offset:128
ds_read_b64_tr_b16 v[98:99], v105 offset:128
v_mfma_f32_32x32x16_bf16 a[112:127], v[52:55], v[80:83], a[112:127]
v_mfma_f32_32x32x16_bf16 a[128:143], v[52:55], v[84:87], a[128:143]
v_mfma_f32_32x32x16_bf16 a[144:159], v[56:59], v[76:79], a[144:159]
v_mfma_f32_32x32x16_bf16 a[160:175], v[56:59], v[80:83], a[160:175]
v_mfma_f32_32x32x16_bf16 a[176:191], v[56:59], v[84:87], a[176:191]
s_waitcnt lgkmcnt(0)
s_waitcnt vmcnt(0)
s_barrier
v_mfma_f32_32x32x16_bf16 a[0:15], v[60:63], v[88:91], a[0:15]
ds_read_b128 v[44:47], v100 offset:28672
v_mfma_f32_32x32x16_bf16 a[16:31], v[60:63], v[92:95], a[16:31]
ds_read_b128 v[48:51], v100 offset:30720
v_mfma_f32_32x32x16_bf16 a[32:47], v[60:63], v[96:99], a[32:47]
ds_read_b128 v[52:55], v100 offset:32768
v_mfma_f32_32x32x16_bf16 a[48:63], v[64:67], v[88:91], a[48:63]
ds_read_b128 v[56:59], v100 offset:34816
v_mfma_f32_32x32x16_bf16 a[64:79], v[64:67], v[92:95], a[64:79]
ds_read_b64_tr_b16 v[76:77], v102 offset:28672
ds_read_b64_tr_b16 v[78:79], v103 offset:28672
v_mfma_f32_32x32x16_bf16 a[80:95], v[64:67], v[96:99], a[80:95]
ds_read_b64_tr_b16 v[80:81], v106 offset:28672
ds_read_b64_tr_b16 v[82:83], v107 offset:28672
v_mfma_f32_32x32x16_bf16 a[96:111], v[68:71], v[88:91], a[96:111]
ds_read_b64_tr_b16 v[84:85], v102 offset:28800
ds_read_b64_tr_b16 v[86:87], v103 offset:28800
v_mfma_f32_32x32x16_bf16 a[112:127], v[68:71], v[92:95], a[112:127]
v_mfma_f32_32x32x16_bf16 a[128:143], v[68:71], v[96:99], a[128:143]
v_mfma_f32_32x32x16_bf16 a[144:159], v[72:75], v[88:91], a[144:159]
v_mfma_f32_32x32x16_bf16 a[160:175], v[72:75], v[92:95], a[160:175]
v_mfma_f32_32x32x16_bf16 a[176:191], v[72:75], v[96:99], a[176:191]
s_waitcnt lgkmcnt(0)
v_mfma_f32_32x32x16_bf16 a[0:15], v[44:47], v[76:79], a[0:15]
ds_read_b128 v[60:63], v101 offset:28672
v_mfma_f32_32x32x16_bf16 a[16:31], v[44:47], v[80:83], a[16:31]
ds_read_b128 v[64:67], v101 offset:30720
v_mfma_f32_32x32x16_bf16 a[32:47], v[44:47], v[84:87], a[32:47]
ds_read_b128 v[68:71], v101 offset:32768
v_mfma_f32_32x32x16_bf16 a[48:63], v[48:51], v[76:79], a[48:63]
ds_read_b128 v[72:75], v101 offset:34816
v_mfma_f32_32x32x16_bf16 a[64:79], v[48:51], v[80:83], a[64:79]
ds_read_b64_tr_b16 v[88:89], v104 offset:28672
ds_read_b64_tr_b16 v[90:91], v105 offset:28672
v_mfma_f32_32x32x16_bf16 a[80:95], v[48:51], v[84:87], a[80:95]
ds_read_b64_tr_b16 v[92:93], v108 offset:28672
ds_read_b64_tr_b16 v[94:95], v109 offset:28672
v_mfma_f32_32x32x16_bf16 a[96:111], v[52:55], v[76:79], a[96:111]
ds_read_b64_tr_b16 v[96:97], v104 offset:28800
ds_read_b64_tr_b16 v[98:99], v105 offset:28800
v_mfma_f32_32x32x16_bf16 a[112:127], v[52:55], v[80:83], a[112:127]
v_mfma_f32_32x32x16_bf16 a[128:143], v[52:55], v[84:87], a[128:143]
v_mfma_f32_32x32x16_bf16 a[144:159], v[56:59], v[76:79], a[144:159]
v_mfma_f32_32x32x16_bf16 a[160:175], v[56:59], v[80:83], a[160:175]
v_mfma_f32_32x32x16_bf16 a[176:191], v[56:59], v[84:87], a[176:191]
s_waitcnt lgkmcnt(0)
s_waitcnt vmcnt(0)
s_barrier
v_mfma_f32_32x32x16_bf16 a[0:15], v[60:63], v[88:91], a[0:15]
v_mfma_f32_32x32x16_bf16 a[16:31], v[60:63], v[92:95], a[16:31]
v_mfma_f32_32x32x16_bf16 a[32:47], v[60:63], v[96:99], a[32:47]
v_mfma_f32_32x32x16_bf16 a[48:63], v[64:67], v[88:91], a[48:63]
v_mfma_f32_32x32x16_bf16 a[64:79], v[64:67], v[92:95], a[64:79]
v_mfma_f32_32x32x16_bf16 a[80:95], v[64:67], v[96:99], a[80:95]
v_mfma_f32_32x32x16_bf16 a[96:111], v[68:71], v[88:91], a[96:111]
v_mfma_f32_32x32x16_bf16 a[112:127], v[68:71], v[92:95], a[112:127]
v_mfma_f32_32x32x16_bf16 a[128:143], v[68:71], v[96:99], a[128:143]
v_mfma_f32_32x32x16_bf16 a[144:159], v[72:75], v[88:91], a[144:159]
v_mfma_f32_32x32x16_bf16 a[160:175], v[72:75], v[92:95], a[160:175]
v_mfma_f32_32x32x16_bf16 a[176:191], v[72:75], v[96:99], a[176:191]
s_nop 11
s_barrier
s_add_u32 s50, s50, 16
s_cmp_lt_u32 s50, 96
s_cselect_b32 s87, 1, 0
s_cbranch_scc0 L_g1_nonc_B
s_cmp_ge_u32 s50, 56
s_cbranch_scc1 L_g1_dqc_B
s_mov_b32 s84, 1
s_mov_b32 s60, s50
s_cmp_lt_u32 s50, 8
s_cbranch_scc1 L_g1_d0c_B
s_sub_u32 s61, s50, 8
s_mul_i32 s60, s61, 43
s_lshr_b32 s60, s60, 8
s_mul_i32 s84, s60, 6
s_sub_u32 s84, s61, s84
s_add_u32 s84, s84, 2
L_g1_d0c_B:
s_lshr_b32 s86, s60, 2
s_and_b32 s60, s60, 3
s_lshl_b32 s85, s29, 2
s_add_u32 s85, s85, s60
s_branch L_g1_ddc_B
L_g1_dqc_B:
s_cmp_ge_u32 s50, 88
s_cbranch_scc1 L_g1_dhc_B
s_sub_u32 s60, s50, 56
s_and_b32 s84, s60, 7
s_lshr_b32 s60, s60, 3
s_lshl_b32 s85, s29, 2
s_add_u32 s85, s85, s60
s_mov_b32 s86, 2
s_branch L_g1_ddc_B
L_g1_dhc_B:
s_sub_u32 s84, s50, 88
s_mov_b32 s85, s29
s_mov_b32 s86, 3
L_g1_ddc_B:
s_mov_b32 s56, 12288
s_mov_b32 s34, 7864320
s_mov_b32 s35, 0x00020000
s_mov_b32 s32, s10
s_mov_b32 s33, s11
s_cmp_lg_u32 s86, 1
s_cbranch_scc1 L_g1_n1c_B
s_mov_b32 s32, s12
s_mov_b32 s33, s13
L_g1_n1c_B:
s_cmp_lg_u32 s86, 2
s_cbranch_scc1 L_g1_n2c_B
s_mov_b32 s32, s8
s_mov_b32 s33, s9
L_g1_n2c_B:
s_cmp_lg_u32 s86, 3
s_cbranch_scc1 L_g1_n3c_B
s_mov_b32 s32, s16
s_mov_b32 s33, s17
s_mov_b32 s56, 3072
s_mov_b32 s34, 1966080
L_g1_n3c_B:
s_mov_b32 s55, 1280
s_lshl_b32 s57, s56, 5
s_mul_i32 s54, s85, 384
s_mul_i32 s53, s84, 327680
s_add_u32 s53, s53, 90910720
s_mul_i32 s40, s28, 4096
s_add_u32 s40, s40, 0
v_lshlrev_b32 v4, 4, v1
v_add_u32 v21, s40, v4
s_mul_i32 s40, s28, 4096
s_add_u32 s40, s40, 1024
v_lshlrev_b32 v4, 4, v1
v_add_u32 v22, s40, v4
s_mul_i32 s40, s28, 4096
s_add_u32 s40, s40, 2048
v_lshlrev_b32 v4, 4, v1
v_add_u32 v23, s40, v4
s_mul_i32 s40, s28, 4096
s_add_u32 s40, s40, 3072
v_lshlrev_b32 v4, 4, v1
v_add_u32 v24, s40, v4
v_mul_lo_u32 v4, v25, s56
v_add_u32 v31, v4, v28
v_mul_lo_u32 v4, v26, s56
v_add_u32 v32, v4, v29
v_mul_lo_u32 v4, v27, s56
v_add_u32 v33, v4, v30
s_add_u32 m0, s45, 0
s_nop 0
buffer_load_dwordx4 v21, s[20:23], s53 offen lds
s_add_u32 m0, s45, 1024
s_nop 0
buffer_load_dwordx4 v22, s[20:23], s53 offen lds
s_add_u32 m0, s45, 2048
s_nop 0
buffer_load_dwordx4 v23, s[20:23], s53 offen lds
s_add_u32 m0, s45, 3072
s_nop 0
buffer_load_dwordx4 v24, s[20:23], s53 offen lds
s_add_u32 m0, s46, 0
s_nop 0
buffer_load_dwordx4 v31, s[32:35], s54 offen lds
s_add_u32 m0, s46, 1024
s_nop 0
buffer_load_dwordx4 v32, s[32:35], s54 offen lds
s_add_u32 m0, s46, 2048
s_nop 0
buffer_load_dwordx4 v33, s[32:35], s54 offen lds
s_add_u32 s53, s53, 16384
s_add_u32 s54, s54, s57
s_add_u32 m0, s45, 28672
s_nop 0
buffer_load_dwordx4 v21, s[20:23], s53 offen lds
s_add_u32 m0, s45, 29696
s_nop 0
buffer_load_dwordx4 v22, s[20:23], s53 offen lds
s_add_u32 m0, s45, 30720
s_nop 0
buffer_load_dwordx4 v23, s[20:23], s53 offen lds
s_add_u32 m0, s45, 31744
s_nop 0
buffer_load_dwordx4 v24, s[20:23], s53 offen lds
s_add_u32 m0, s46, 28672
s_nop 0
buffer_load_dwordx4 v31, s[32:35], s54 offen lds
s_add_u32 m0, s46, 29696
s_nop 0
buffer_load_dwordx4 v32, s[32:35], s54 offen lds
s_add_u32 m0, s46, 30720
s_nop 0
buffer_load_dwordx4 v33, s[32:35], s54 offen lds
s_add_u32 s53, s53, 16384
s_add_u32 s54, s54, s57
s_add_u32 m0, s45, 57344
s_nop 0
buffer_load_dwordx4 v21, s[20:23], s53 offen lds
s_add_u32 m0, s45, 58368
s_nop 0
buffer_load_dwordx4 v22, s[20:23], s53 offen lds
s_add_u32 m0, s45, 59392
s_nop 0
buffer_load_dwordx4 v23, s[20:23], s53 offen lds
s_add_u32 m0, s45, 60416
s_nop 0
buffer_load_dwordx4 v24, s[20:23], s53 offen lds
s_add_u32 m0, s46, 57344
s_nop 0
buffer_load_dwordx4 v31, s[32:35], s54 offen lds
s_add_u32 m0, s46, 58368
s_nop 0
buffer_load_dwordx4 v32, s[32:35], s54 offen lds
s_add_u32 m0, s46, 59392
s_nop 0
buffer_load_dwordx4 v33, s[32:35], s54 offen lds
s_add_u32 s53, s53, 16384
s_add_u32 s54, s54, s57
s_add_u32 m0, s45, 86016
s_nop 0
buffer_load_dwordx4 v21, s[20:23], s53 offen lds
s_add_u32 m0, s45, 87040
s_nop 0
buffer_load_dwordx4 v22, s[20:23], s53 offen lds
s_add_u32 m0, s45, 88064
s_nop 0
buffer_load_dwordx4 v23, s[20:23], s53 offen lds
s_add_u32 m0, s45, 89088
s_nop 0
buffer_load_dwordx4 v24, s[20:23], s53 offen lds
s_add_u32 m0, s46, 86016
s_nop 0
buffer_load_dwordx4 v31, s[32:35], s54 offen lds
s_add_u32 m0, s46, 87040
s_nop 0
buffer_load_dwordx4 v32, s[32:35], s54 offen lds
s_add_u32 m0, s46, 88064
s_nop 0
buffer_load_dwordx4 v33, s[32:35], s54 offen lds
s_add_u32 s53, s53, 16384
s_add_u32 s54, s54, s57
L_g1_nonc_B:
s_lshr_b32 s60, s28, 1
s_and_b32 s61, s28, 1
s_lshl_b32 s40, s52, 3
s_lshl_b32 s60, s60, 2
s_add_u32 s40, s40, s60
s_lshl_b32 s40, s40, 5
s_add_u32 s40, s40, s59
s_mul_i32 s40, s40, 12288
s_mul_i32 s61, s61, 6144
s_add_u32 s40, s40, s61
s_add_u32 s40, s40, 25165824
s_add_u32 s41, s40, 0
v_accvgpr_read_b32 v132, a0
v_accvgpr_read_b32 v133, a1
v_accvgpr_read_b32 v134, a2
v_accvgpr_read_b32 v135, a3
v_accvgpr_read_b32 v136, a4
v_accvgpr_read_b32 v137, a5
v_accvgpr_read_b32 v138, a6
v_accvgpr_read_b32 v139, a7
v_accvgpr_read_b32 v140, a8
v_accvgpr_read_b32 v141, a9
v_accvgpr_read_b32 v142, a10
v_accvgpr_read_b32 v143, a11
v_accvgpr_read_b32 v144, a12
v_accvgpr_read_b32 v145, a13
v_accvgpr_read_b32 v146, a14
v_accvgpr_read_b32 v147, a15
v_cvt_pk_bf16_f32 v116, v132, v133
v_cvt_pk_bf16_f32 v117, v134, v135
v_cvt_pk_bf16_f32 v118, v140, v141
v_cvt_pk_bf16_f32 v119, v142, v143
v_cvt_pk_bf16_f32 v120, v136, v137
v_cvt_pk_bf16_f32 v121, v138, v139
v_cvt_pk_bf16_f32 v122, v144, v145
v_cvt_pk_bf16_f32 v123, v146, v147
buffer_store_dwordx4 v[116:119], v111, s[20:23], s41 offen sc1
buffer_store_dwordx4 v[120:123], v111, s[20:23], s41 offen offset:512 sc1
s_add_u32 s41, s40, 2048
v_accvgpr_read_b32 v132, a16
v_accvgpr_read_b32 v133, a17
v_accvgpr_read_b32 v134, a18
v_accvgpr_read_b32 v135, a19
v_accvgpr_read_b32 v136, a20
v_accvgpr_read_b32 v137, a21
v_accvgpr_read_b32 v138, a22
v_accvgpr_read_b32 v139, a23
v_accvgpr_read_b32 v140, a24
v_accvgpr_read_b32 v141, a25
v_accvgpr_read_b32 v142, a26
v_accvgpr_read_b32 v143, a27
v_accvgpr_read_b32 v144, a28
v_accvgpr_read_b32 v145, a29
v_accvgpr_read_b32 v146, a30
v_accvgpr_read_b32 v147, a31
v_cvt_pk_bf16_f32 v116, v132, v133
v_cvt_pk_bf16_f32 v117, v134, v135
v_cvt_pk_bf16_f32 v118, v140, v141
v_cvt_pk_bf16_f32 v119, v142, v143
v_cvt_pk_bf16_f32 v120, v136, v137
v_cvt_pk_bf16_f32 v121, v138, v139
v_cvt_pk_bf16_f32 v122, v144, v145
v_cvt_pk_bf16_f32 v123, v146, v147
buffer_store_dwordx4 v[116:119], v111, s[20:23], s41 offen sc1
buffer_store_dwordx4 v[120:123], v111, s[20:23], s41 offen offset:512 sc1
s_add_u32 s41, s40, 4096
v_accvgpr_read_b32 v132, a32
v_accvgpr_read_b32 v133, a33
v_accvgpr_read_b32 v134, a34
v_accvgpr_read_b32 v135, a35
v_accvgpr_read_b32 v136, a36
v_accvgpr_read_b32 v137, a37
v_accvgpr_read_b32 v138, a38
v_accvgpr_read_b32 v139, a39
v_accvgpr_read_b32 v140, a40
v_accvgpr_read_b32 v141, a41
v_accvgpr_read_b32 v142, a42
v_accvgpr_read_b32 v143, a43
v_accvgpr_read_b32 v144, a44
v_accvgpr_read_b32 v145, a45
v_accvgpr_read_b32 v146, a46
v_accvgpr_read_b32 v147, a47
v_cvt_pk_bf16_f32 v116, v132, v133
v_cvt_pk_bf16_f32 v117, v134, v135
v_cvt_pk_bf16_f32 v118, v140, v141
v_cvt_pk_bf16_f32 v119, v142, v143
v_cvt_pk_bf16_f32 v120, v136, v137
v_cvt_pk_bf16_f32 v121, v138, v139
v_cvt_pk_bf16_f32 v122, v144, v145
v_cvt_pk_bf16_f32 v123, v146, v147
buffer_store_dwordx4 v[116:119], v111, s[20:23], s41 offen sc1
buffer_store_dwordx4 v[120:123], v111, s[20:23], s41 offen offset:512 sc1
s_add_u32 s41, s40, 393216
v_accvgpr_read_b32 v132, a48
v_accvgpr_read_b32 v133, a49
v_accvgpr_read_b32 v134, a50
v_accvgpr_read_b32 v135, a51
v_accvgpr_read_b32 v136, a52
v_accvgpr_read_b32 v137, a53
v_accvgpr_read_b32 v138, a54
v_accvgpr_read_b32 v139, a55
v_accvgpr_read_b32 v140, a56
v_accvgpr_read_b32 v141, a57
v_accvgpr_read_b32 v142, a58
v_accvgpr_read_b32 v143, a59
v_accvgpr_read_b32 v144, a60
v_accvgpr_read_b32 v145, a61
v_accvgpr_read_b32 v146, a62
v_accvgpr_read_b32 v147, a63
v_cvt_pk_bf16_f32 v116, v132, v133
v_cvt_pk_bf16_f32 v117, v134, v135
v_cvt_pk_bf16_f32 v118, v140, v141
v_cvt_pk_bf16_f32 v119, v142, v143
v_cvt_pk_bf16_f32 v120, v136, v137
v_cvt_pk_bf16_f32 v121, v138, v139
v_cvt_pk_bf16_f32 v122, v144, v145
v_cvt_pk_bf16_f32 v123, v146, v147
buffer_store_dwordx4 v[116:119], v111, s[20:23], s41 offen sc1
buffer_store_dwordx4 v[120:123], v111, s[20:23], s41 offen offset:512 sc1
s_add_u32 s41, s40, 395264
v_accvgpr_read_b32 v132, a64
v_accvgpr_read_b32 v133, a65
v_accvgpr_read_b32 v134, a66
v_accvgpr_read_b32 v135, a67
v_accvgpr_read_b32 v136, a68
v_accvgpr_read_b32 v137, a69
v_accvgpr_read_b32 v138, a70
v_accvgpr_read_b32 v139, a71
v_accvgpr_read_b32 v140, a72
v_accvgpr_read_b32 v141, a73
v_accvgpr_read_b32 v142, a74
v_accvgpr_read_b32 v143, a75
v_accvgpr_read_b32 v144, a76
v_accvgpr_read_b32 v145, a77
v_accvgpr_read_b32 v146, a78
v_accvgpr_read_b32 v147, a79
v_cvt_pk_bf16_f32 v116, v132, v133
v_cvt_pk_bf16_f32 v117, v134, v135
v_cvt_pk_bf16_f32 v118, v140, v141
v_cvt_pk_bf16_f32 v119, v142, v143
v_cvt_pk_bf16_f32 v120, v136, v137
v_cvt_pk_bf16_f32 v121, v138, v139
v_cvt_pk_bf16_f32 v122, v144, v145
v_cvt_pk_bf16_f32 v123, v146, v147
buffer_store_dwordx4 v[116:119], v111, s[20:23], s41 offen sc1
buffer_store_dwordx4 v[120:123], v111, s[20:23], s41 offen offset:512 sc1
s_add_u32 s41, s40, 397312
v_accvgpr_read_b32 v132, a80
v_accvgpr_read_b32 v133, a81
v_accvgpr_read_b32 v134, a82
v_accvgpr_read_b32 v135, a83
v_accvgpr_read_b32 v136, a84
v_accvgpr_read_b32 v137, a85
v_accvgpr_read_b32 v138, a86
v_accvgpr_read_b32 v139, a87
v_accvgpr_read_b32 v140, a88
v_accvgpr_read_b32 v141, a89
v_accvgpr_read_b32 v142, a90
v_accvgpr_read_b32 v143, a91
v_accvgpr_read_b32 v144, a92
v_accvgpr_read_b32 v145, a93
v_accvgpr_read_b32 v146, a94
v_accvgpr_read_b32 v147, a95
v_cvt_pk_bf16_f32 v116, v132, v133
v_cvt_pk_bf16_f32 v117, v134, v135
v_cvt_pk_bf16_f32 v118, v140, v141
v_cvt_pk_bf16_f32 v119, v142, v143
v_cvt_pk_bf16_f32 v120, v136, v137
v_cvt_pk_bf16_f32 v121, v138, v139
v_cvt_pk_bf16_f32 v122, v144, v145
v_cvt_pk_bf16_f32 v123, v146, v147
buffer_store_dwordx4 v[116:119], v111, s[20:23], s41 offen sc1
buffer_store_dwordx4 v[120:123], v111, s[20:23], s41 offen offset:512 sc1
s_add_u32 s41, s40, 786432
v_accvgpr_read_b32 v132, a96
v_accvgpr_read_b32 v133, a97
v_accvgpr_read_b32 v134, a98
v_accvgpr_read_b32 v135, a99
v_accvgpr_read_b32 v136, a100
v_accvgpr_read_b32 v137, a101
v_accvgpr_read_b32 v138, a102
v_accvgpr_read_b32 v139, a103
v_accvgpr_read_b32 v140, a104
v_accvgpr_read_b32 v141, a105
v_accvgpr_read_b32 v142, a106
v_accvgpr_read_b32 v143, a107
v_accvgpr_read_b32 v144, a108
v_accvgpr_read_b32 v145, a109
v_accvgpr_read_b32 v146, a110
v_accvgpr_read_b32 v147, a111
v_cvt_pk_bf16_f32 v116, v132, v133
v_cvt_pk_bf16_f32 v117, v134, v135
v_cvt_pk_bf16_f32 v118, v140, v141
v_cvt_pk_bf16_f32 v119, v142, v143
v_cvt_pk_bf16_f32 v120, v136, v137
v_cvt_pk_bf16_f32 v121, v138, v139
v_cvt_pk_bf16_f32 v122, v144, v145
v_cvt_pk_bf16_f32 v123, v146, v147
buffer_store_dwordx4 v[116:119], v111, s[20:23], s41 offen sc1
buffer_store_dwordx4 v[120:123], v111, s[20:23], s41 offen offset:512 sc1
s_add_u32 s41, s40, 788480
v_accvgpr_read_b32 v132, a112
v_accvgpr_read_b32 v133, a113
v_accvgpr_read_b32 v134, a114
v_accvgpr_read_b32 v135, a115
v_accvgpr_read_b32 v136, a116
v_accvgpr_read_b32 v137, a117
v_accvgpr_read_b32 v138, a118
v_accvgpr_read_b32 v139, a119
v_accvgpr_read_b32 v140, a120
v_accvgpr_read_b32 v141, a121
v_accvgpr_read_b32 v142, a122
v_accvgpr_read_b32 v143, a123
v_accvgpr_read_b32 v144, a124
v_accvgpr_read_b32 v145, a125
v_accvgpr_read_b32 v146, a126
v_accvgpr_read_b32 v147, a127
v_cvt_pk_bf16_f32 v116, v132, v133
v_cvt_pk_bf16_f32 v117, v134, v135
v_cvt_pk_bf16_f32 v118, v140, v141
v_cvt_pk_bf16_f32 v119, v142, v143
v_cvt_pk_bf16_f32 v120, v136, v137
v_cvt_pk_bf16_f32 v121, v138, v139
v_cvt_pk_bf16_f32 v122, v144, v145
v_cvt_pk_bf16_f32 v123, v146, v147
buffer_store_dwordx4 v[116:119], v111, s[20:23], s41 offen sc1
buffer_store_dwordx4 v[120:123], v111, s[20:23], s41 offen offset:512 sc1
s_add_u32 s41, s40, 790528
v_accvgpr_read_b32 v132, a128
v_accvgpr_read_b32 v133, a129
v_accvgpr_read_b32 v134, a130
v_accvgpr_read_b32 v135, a131
v_accvgpr_read_b32 v136, a132
v_accvgpr_read_b32 v137, a133
v_accvgpr_read_b32 v138, a134
v_accvgpr_read_b32 v139, a135
v_accvgpr_read_b32 v140, a136
v_accvgpr_read_b32 v141, a137
v_accvgpr_read_b32 v142, a138
v_accvgpr_read_b32 v143, a139
v_accvgpr_read_b32 v144, a140
v_accvgpr_read_b32 v145, a141
v_accvgpr_read_b32 v146, a142
v_accvgpr_read_b32 v147, a143
v_cvt_pk_bf16_f32 v116, v132, v133
v_cvt_pk_bf16_f32 v117, v134, v135
v_cvt_pk_bf16_f32 v118, v140, v141
v_cvt_pk_bf16_f32 v119, v142, v143
v_cvt_pk_bf16_f32 v120, v136, v137
v_cvt_pk_bf16_f32 v121, v138, v139
v_cvt_pk_bf16_f32 v122, v144, v145
v_cvt_pk_bf16_f32 v123, v146, v147
buffer_store_dwordx4 v[116:119], v111, s[20:23], s41 offen sc1
buffer_store_dwordx4 v[120:123], v111, s[20:23], s41 offen offset:512 sc1
s_add_u32 s41, s40, 1179648
v_accvgpr_read_b32 v132, a144
v_accvgpr_read_b32 v133, a145
v_accvgpr_read_b32 v134, a146
v_accvgpr_read_b32 v135, a147
v_accvgpr_read_b32 v136, a148
v_accvgpr_read_b32 v137, a149
v_accvgpr_read_b32 v138, a150
v_accvgpr_read_b32 v139, a151
v_accvgpr_read_b32 v140, a152
v_accvgpr_read_b32 v141, a153
v_accvgpr_read_b32 v142, a154
v_accvgpr_read_b32 v143, a155
v_accvgpr_read_b32 v144, a156
v_accvgpr_read_b32 v145, a157
v_accvgpr_read_b32 v146, a158
v_accvgpr_read_b32 v147, a159
v_cvt_pk_bf16_f32 v116, v132, v133
v_cvt_pk_bf16_f32 v117, v134, v135
v_cvt_pk_bf16_f32 v118, v140, v141
v_cvt_pk_bf16_f32 v119, v142, v143
v_cvt_pk_bf16_f32 v120, v136, v137
v_cvt_pk_bf16_f32 v121, v138, v139
v_cvt_pk_bf16_f32 v122, v144, v145
v_cvt_pk_bf16_f32 v123, v146, v147
buffer_store_dwordx4 v[116:119], v111, s[20:23], s41 offen sc1
buffer_store_dwordx4 v[120:123], v111, s[20:23], s41 offen offset:512 sc1
s_add_u32 s41, s40, 1181696
v_accvgpr_read_b32 v132, a160
v_accvgpr_read_b32 v133, a161
v_accvgpr_read_b32 v134, a162
v_accvgpr_read_b32 v135, a163
v_accvgpr_read_b32 v136, a164
v_accvgpr_read_b32 v137, a165
v_accvgpr_read_b32 v138, a166
v_accvgpr_read_b32 v139, a167
v_accvgpr_read_b32 v140, a168
v_accvgpr_read_b32 v141, a169
v_accvgpr_read_b32 v142, a170
v_accvgpr_read_b32 v143, a171
v_accvgpr_read_b32 v144, a172
v_accvgpr_read_b32 v145, a173
v_accvgpr_read_b32 v146, a174
v_accvgpr_read_b32 v147, a175
v_cvt_pk_bf16_f32 v116, v132, v133
v_cvt_pk_bf16_f32 v117, v134, v135
v_cvt_pk_bf16_f32 v118, v140, v141
v_cvt_pk_bf16_f32 v119, v142, v143
v_cvt_pk_bf16_f32 v120, v136, v137
v_cvt_pk_bf16_f32 v121, v138, v139
v_cvt_pk_bf16_f32 v122, v144, v145
v_cvt_pk_bf16_f32 v123, v146, v147
buffer_store_dwordx4 v[116:119], v111, s[20:23], s41 offen sc1
buffer_store_dwordx4 v[120:123], v111, s[20:23], s41 offen offset:512 sc1
s_add_u32 s41, s40, 1183744
v_accvgpr_read_b32 v132, a176
v_accvgpr_read_b32 v133, a177
v_accvgpr_read_b32 v134, a178
v_accvgpr_read_b32 v135, a179
v_accvgpr_read_b32 v136, a180
v_accvgpr_read_b32 v137, a181
v_accvgpr_read_b32 v138, a182
v_accvgpr_read_b32 v139, a183
v_accvgpr_read_b32 v140, a184
v_accvgpr_read_b32 v141, a185
v_accvgpr_read_b32 v142, a186
v_accvgpr_read_b32 v143, a187
v_accvgpr_read_b32 v144, a188
v_accvgpr_read_b32 v145, a189
v_accvgpr_read_b32 v146, a190
v_accvgpr_read_b32 v147, a191
v_cvt_pk_bf16_f32 v116, v132, v133
v_cvt_pk_bf16_f32 v117, v134, v135
v_cvt_pk_bf16_f32 v118, v140, v141
v_cvt_pk_bf16_f32 v119, v142, v143
v_cvt_pk_bf16_f32 v120, v136, v137
v_cvt_pk_bf16_f32 v121, v138, v139
v_cvt_pk_bf16_f32 v122, v144, v145
v_cvt_pk_bf16_f32 v123, v146, v147
buffer_store_dwordx4 v[116:119], v111, s[20:23], s41 offen sc1
buffer_store_dwordx4 v[120:123], v111, s[20:23], s41 offen offset:512 sc1
s_mov_b32 s60, 178466816
s_lshl_b32 s61, s29, 9
s_add_u32 s60, s60, s61
L_g1_next_B:
s_lshl_b32 s61, s52, 6
s_add_u32 s60, s60, s61
s_cmp_eq_u32 s58, 3
s_cbranch_scc1 L_g1_sigat_B
s_and_b32 s61, s59, 3
s_cmp_eq_u32 s58, 1
s_cselect_b32 s41, 4, 0
s_add_u32 s61, s61, s41
s_lshl_b32 s61, s61, 2
s_add_u32 s60, s60, s61
s_cmp_lt_u32 s58, 2
s_cselect_b32 s61, 1, 0
s_waitcnt vmcnt(0)
s_barrier
s_cmp_lg_u32 s28, 0
s_cbranch_scc1 L_sigf_9_B
s_mov_b64 exec, 1
s_cmp_lg_u32 s61, 0
s_cselect_b32 exec_lo, 3, 1
v_lshlrev_b32 v17, 5, v1
v_add_u32 v17, s60, v17
buffer_store_dword v16, v17, s[20:23], 0 offen sc1
s_mov_b64 exec, -1
L_sigf_9_B:
s_branch L_g1_sigx_B
L_g1_sigat_B:
s_waitcnt vmcnt(0)
s_barrier
s_cmp_lg_u32 s28, 0
s_cbranch_scc1 L_sig_10_B
s_mov_b64 exec, 1
v_mov_b32 v17, s60
buffer_atomic_add v16, v17, s[20:23], 0 offen sc1
s_mov_b64 exec, -1
L_sig_10_B:
L_g1_sigx_B:
s_cmp_eq_u32 s87, 1
s_cbranch_scc1 L_g1_task_B
L_g1_done_B:
s_mul_i32 s46, s28, 3072
s_add_u32 s46, s46, 16384
v_lshrrev_b32 v19, 2, v1
v_and_b32 v4, 3, v1
v_lshrrev_b32 v5, 4, v1
v_xor_b32 v4, v4, v5
v_lshlrev_b32 v20, 4, v4
s_mul_i32 s40, s28, 192
s_add_u32 s40, s40, 0
v_add_u32 v4, s40, v1
s_mov_b32 s41, 52429
v_mul_u32_u24 v5, s41, v4
v_lshrrev_b32 v25, 20, v5
v_mul_u32_u24 v5, 20, v25
v_sub_u32 v5, v4, v5
v_lshlrev_b32 v28, 4, v5
s_mul_i32 s40, s28, 192
s_add_u32 s40, s40, 64
v_add_u32 v4, s40, v1
s_mov_b32 s41, 52429
v_mul_u32_u24 v5, s41, v4
v_lshrrev_b32 v26, 20, v5
v_mul_u32_u24 v5, 20, v26
v_sub_u32 v5, v4, v5
v_lshlrev_b32 v29, 4, v5
s_mul_i32 s40, s28, 192
s_add_u32 s40, s40, 128
v_add_u32 v4, s40, v1
s_mov_b32 s41, 52429
v_mul_u32_u24 v5, s41, v4
v_lshrrev_b32 v27, 20, v5
v_mul_u32_u24 v5, 20, v27
v_sub_u32 v5, v4, v5
v_lshlrev_b32 v30, 4, v5
v_and_b32 v4, 31, v1
v_lshrrev_b32 v5, 5, v1
v_bfe_u32 v6, v4, 2, 2
s_lshr_b32 s40, s28, 0
s_mul_i32 s40, s40, 4096
v_add_u32 v7, 0, v5
v_xor_b32 v7, v7, v6
v_lshlrev_b32 v7, 4, v7
v_lshl_add_u32 v7, v4, 6, v7
v_add_u32 v34, s40, v7
v_add_u32 v7, 2, v5
v_xor_b32 v7, v7, v6
v_lshlrev_b32 v7, 4, v7
v_lshl_add_u32 v7, v4, 6, v7
v_add_u32 v35, s40, v7
v_and_b32 v4, 15, v1
v_lshrrev_b32 v5, 4, v1
v_and_b32 v6, 1, v5
v_lshrrev_b32 v5, 1, v5
v_bfe_u32 v7, v4, 1, 1
v_lshl_add_u32 v6, v6, 1, v7
v_bfe_u32 v8, v4, 3, 1
v_lshlrev_b32 v8, 2, v8
v_and_b32 v9, 1, v4
v_lshlrev_b32 v9, 3, v9
v_lshrrev_b32 v10, 2, v4
v_lshlrev_b32 v11, 2, v5
v_add_u32 v11, 0, v11
v_add_u32 v11, v11, v10
v_mul_u32_u24 v11, 320, v11
v_add_u32 v11, v11, v9
v_add_u32 v12, 0, v6
v_lshl_add_u32 v36, v12, 4, v11
v_add_u32 v36, 16384, v36
v_add_u32 v12, 4, v6
v_lshl_add_u32 v40, v12, 4, v11
v_add_u32 v40, 16384, v40
v_lshlrev_b32 v11, 2, v5
v_add_u32 v11, 16, v11
v_add_u32 v11, v11, v10
v_mul_u32_u24 v11, 320, v11
v_add_u32 v11, v11, v9
v_add_u32 v12, 0, v6
v_lshl_add_u32 v37, v12, 4, v11
v_add_u32 v37, 16384, v37
v_add_u32 v12, 4, v6
v_lshl_add_u32 v41, v12, 4, v11
v_add_u32 v41, 16384, v41
v_lshlrev_b32 v11, 2, v5
v_add_u32 v11, 8, v11
v_add_u32 v11, v11, v10
v_mul_u32_u24 v11, 320, v11
v_add_u32 v11, v11, v9
v_add_u32 v12, 0, v6
v_lshl_add_u32 v38, v12, 4, v11
v_add_u32 v38, 16384, v38
v_add_u32 v12, 4, v6
v_lshl_add_u32 v42, v12, 4, v11
v_add_u32 v42, 16384, v42
v_lshlrev_b32 v11, 2, v5
v_add_u32 v11, 24, v11
v_add_u32 v11, v11, v10
v_mul_u32_u24 v11, 320, v11
v_add_u32 v11, v11, v9
v_add_u32 v12, 0, v6
v_lshl_add_u32 v39, v12, 4, v11
v_add_u32 v39, 16384, v39
v_add_u32 v12, 4, v6
v_lshl_add_u32 v43, v12, 4, v11
v_add_u32 v43, 16384, v43
v_add_u32 v100, 57344, v34
v_add_u32 v101, 57344, v35
v_add_u32 v102, 57344, v36
v_add_u32 v103, 57344, v37
v_add_u32 v104, 57344, v38
v_add_u32 v105, 57344, v39
v_add_u32 v106, 57344, v40
v_add_u32 v107, 57344, v41
v_add_u32 v108, 57344, v42
v_add_u32 v109, 57344, v43
v_and_b32 v4, 31, v1
v_mul_u32_u24 v4, 2560, v4
v_lshrrev_b32 v5, 5, v1
v_lshl_add_u32 v110, v5, 4, v4
v_lshlrev_b32 v128, 4, v1
v_lshrrev_b32 v4, 4, v1
v_and_b32 v5, 7, v1
v_lshlrev_b32 v129, 7, v4
v_lshl_add_u32 v129, v5, 4, v129
v_and_b32 v5, 31, v1
v_lshlrev_b32 v130, 3, v5
v_and_b32 v132, 15, v1
v_bfe_u32 v6, v132, 2, 2
v_xor_b32 v6, v6, v4
v_lshlrev_b32 v6, 4, v6
v_lshl_add_u32 v131, v132, 6, v6
v_lshlrev_b32 v4, 2, v4
v_sub_u32 v132, v132, v4
v_mov_b32 v133, 0xce6e6b28
s_mov_b32 s66, 0x3d93cd3a
s_mov_b32 s67, 0x3fb8aa3b
s_mov_b32 s98, 0
s_mov_b32 s50, 0
s_cmp_ge_u32 s63, 8
s_cbranch_scc1 L_b_task_B
s_mov_b32 s99, 1
s_mov_b32 s52, s29
s_mov_b32 s65, s63
s_branch L_b_g2_B
L_b_task_B:
s_mov_b32 s99, 0
s_cmp_ge_u32 s50, 8
s_cbranch_scc1 L_w_done_B
s_mov_b32 s52, s50
s_cmp_eq_u32 s52, 7
s_cselect_b32 s98, 1, 0
s_cbranch_scc1 L_b_fine_B
s_lshl_b32 s60, s52, 2
s_sub_u32 s65, s63, s60
s_and_b32 s65, s65, 15
s_cmp_ge_u32 s65, 12
s_cbranch_scc1 L_b_next_B
s_cmp_lt_u32 s65, 4
s_cbranch_scc1 L_b_g2_B
s_sub_u32 s65, s65, 4
s_branch L_b_e_B
L_b_fine_B:
s_mov_b32 s65, s63
s_cmp_ge_u32 s63, 8
s_cbranch_scc1 L_b_g2_B
L_b_e_B:
s_lshl_b32 s77, s52, 3
s_add_u32 s77, s77, s65
s_lshl_b32 s59, s29, 2
s_add_u32 s59, s59, s28
s_lshl_b32 s76, s77, 5
s_add_u32 s76, s76, s59
s_lshl_b32 s60, s29, 3
s_add_u32 s60, s60, s52
s_lshl_b32 s60, s60, 6
s_add_u32 s60, s60, 178470912
s_cmp_lg_u32 s28, 0
s_cbranch_scc1 L_wf_11x_B
v_min_u32 v17, 3, v1
v_lshlrev_b32 v17, 2, v17
s_nop 1
L_wf_11_B:
buffer_load_dword v18, v17, s[20:23], s60 offen sc1
s_waitcnt vmcnt(0)
v_cmp_eq_u32 vcc, 0, v18
s_add_u32 s64, s64, 1
s_cmp_gt_u32 s64, 2000000
s_cbranch_scc1 L_w_done_B
s_cbranch_vccz L_wf_11x_B
s_cmp_eq_u32 s98, 1
s_cbranch_scc1 L_sl_12_B
s_sleep 40
L_sl_12_B:
s_sleep 4
s_branch L_wf_11_B
L_wf_11x_B:
s_barrier
s_sub_u32 s60, s60, 4096
s_cmp_lg_u32 s28, 0
s_cbranch_scc1 L_wf_13x_B
v_min_u32 v17, 15, v1
v_lshlrev_b32 v17, 2, v17
s_nop 1
L_wf_13_B:
buffer_load_dword v18, v17, s[20:23], s60 offen sc1
s_waitcnt vmcnt(0)
v_cmp_eq_u32 vcc, 0, v18
s_add_u32 s64, s64, 1
s_cmp_gt_u32 s64, 2000000
s_cbranch_scc1 L_w_done_B
s_cbranch_vccz L_wf_13x_B
s_cmp_eq_u32 s98, 1
s_cbranch_scc1 L_sl_14_B
s_sleep 40
L_sl_14_B:
s_sleep 4
s_branch L_wf_13_B
L_wf_13x_B:
s_barrier
s_mul_i32 s53, s76, 12288
s_add_u32 s40, s53, 50331648
buffer_load_dwordx4 v[44:47], v128, s[20:23], s40 offen offset:0 sc1
buffer_load_dwordx4 v[48:51], v128, s[20:23], s40 offen offset:1024 sc1
buffer_load_dwordx4 v[52:55], v128, s[20:23], s40 offen offset:2048 sc1
buffer_load_dwordx4 v[56:59], v128, s[20:23], s40 offen offset:3072 sc1
s_add_u32 s40, s53, 50335744
buffer_load_dwordx4 v[60:63], v128, s[20:23], s40 offen offset:0 sc1
buffer_load_dwordx4 v[64:67], v128, s[20:23], s40 offen offset:1024 sc1
buffer_load_dwordx4 v[68:71], v128, s[20:23], s40 offen offset:2048 sc1
buffer_load_dwordx4 v[72:75], v128, s[20:23], s40 offen offset:3072 sc1
s_add_u32 s40, s53, 50339840
buffer_load_dwordx4 v[76:79], v128, s[20:23], s40 offen offset:0 sc1
buffer_load_dwordx4 v[80:83], v128, s[20:23], s40 offen offset:1024 sc1
buffer_load_dwordx4 v[84:87], v128, s[20:23], s40 offen offset:2048 sc1
buffer_load_dwordx4 v[88:91], v128, s[20:23], s40 offen offset:3072 sc1
s_add_u32 s40, s53, 0
buffer_load_dwordx4 a[0:3], v128, s[20:23], s40 offen offset:0 sc1
buffer_load_dwordx4 a[4:7], v128, s[20:23], s40 offen offset:1024 sc1
buffer_load_dwordx4 a[8:11], v128, s[20:23], s40 offen offset:2048 sc1
buffer_load_dwordx4 a[12:15], v128, s[20:23], s40 offen offset:3072 sc1
s_add_u32 s40, s53, 4096
buffer_load_dwordx4 a[16:19], v128, s[20:23], s40 offen offset:0 sc1
buffer_load_dwordx4 a[20:23], v128, s[20:23], s40 offen offset:1024 sc1
buffer_load_dwordx4 a[24:27], v128, s[20:23], s40 offen offset:2048 sc1
buffer_load_dwordx4 a[28:31], v128, s[20:23], s40 offen offset:3072 sc1
s_add_u32 s40, s53, 8192
buffer_load_dwordx4 a[32:35], v128, s[20:23], s40 offen offset:0 sc1
buffer_load_dwordx4 a[36:39], v128, s[20:23], s40 offen offset:1024 sc1
buffer_load_dwordx4 a[40:43], v128, s[20:23], s40 offen offset:2048 sc1
buffer_load_dwordx4 a[44:47], v128, s[20:23], s40 offen offset:3072 sc1
s_add_u32 s40, s53, 25165824
buffer_load_dwordx4 a[48:51], v128, s[20:23], s40 offen offset:0 sc1
buffer_load_dwordx4 a[52:55], v128, s[20:23], s40 offen offset:1024 sc1
buffer_load_dwordx4 a[56:59], v128, s[20:23], s40 offen offset:2048 sc1
buffer_load_dwordx4 a[60:63], v128, s[20:23], s40 offen offset:3072 sc1
s_add_u32 s40, s53, 25169920
buffer_load_dwordx4 a[64:67], v128, s[20:23], s40 offen offset:0 sc1
buffer_load_dwordx4 a[68:71], v128, s[20:23], s40 offen offset:1024 sc1
buffer_load_dwordx4 a[72:75], v128, s[20:23], s40 offen offset:2048 sc1
buffer_load_dwordx4 a[76:79], v128, s[20:23], s40 offen offset:3072 sc1
s_add_u32 s40, s53, 25174016
buffer_load_dwordx4 a[80:83], v128, s[20:23], s40 offen offset:0 sc1
buffer_load_dwordx4 a[84:87], v128, s[20:23], s40 offen offset:1024 sc1
buffer_load_dwordx4 a[88:91], v128, s[20:23], s40 offen offset:2048 sc1
buffer_load_dwordx4 a[92:95], v128, s[20:23], s40 offen offset:3072 sc1
s_lshl_b32 s60, s76, 6
s_add_u32 s60, s60, 178483200
v_min_u32 v17, 11, v1
v_lshlrev_b32 v17, 2, v17
s_nop 1
L_hw_B:
buffer_load_dword v18, v17, s[20:23], s60 offen sc1
s_waitcnt vmcnt(0)
v_cmp_eq_u32 vcc, 0, v18
s_add_u32 s64, s64, 1
s_cmp_gt_u32 s64, 2000000
s_cbranch_scc1 L_w_done_B
s_cbranch_vccz L_hwx_B
s_cmp_eq_u32 s98, 1
s_cbranch_scc1 L_sl_15_B
s_sleep 40
L_sl_15_B:
s_sleep 4
s_branch L_hw_B
L_hwx_B:
s_mul_i32 s41, s76, 3072
s_add_u32 s40, s41, 77660160
buffer_load_dwordx4 v[136:139], v129, s[20:23], s40 offen offset:0 sc1
buffer_load_dwordx4 v[140:143], v129, s[20:23], s40 offen offset:512 sc1
buffer_load_dwordx4 v[144:147], v129, s[20:23], s40 offen offset:1024 sc1
buffer_load_dwordx4 v[148:151], v129, s[20:23], s40 offen offset:1536 sc1
buffer_load_dwordx4 v[152:155], v129, s[20:23], s40 offen offset:2048 sc1
buffer_load_dwordx4 v[156:159], v129, s[20:23], s40 offen offset:2560 sc1
s_add_u32 s40, s41, 83951616
buffer_load_dwordx2 v[160:161], v130, s[20:23], s40 offen offset:0 sc1
buffer_load_dwordx2 v[162:163], v130, s[20:23], s40 offen offset:256 sc1
buffer_load_dwordx2 v[164:165], v130, s[20:23], s40 offen offset:512 sc1
buffer_load_dwordx2 v[166:167], v130, s[20:23], s40 offen offset:768 sc1
buffer_load_dwordx2 v[168:169], v130, s[20:23], s40 offen offset:1024 sc1
buffer_load_dwordx2 v[170:171], v130, s[20:23], s40 offen offset:1280 sc1
buffer_load_dwordx2 v[172:173], v130, s[20:23], s40 offen offset:1536 sc1
buffer_load_dwordx2 v[174:175], v130, s[20:23], s40 offen offset:1792 sc1
buffer_load_dwordx2 v[176:177], v130, s[20:23], s40 offen offset:2048 sc1
buffer_load_dwordx2 v[178:179], v130, s[20:23], s40 offen offset:2304 sc1
buffer_load_dwordx2 v[180:181], v130, s[20:23], s40 offen offset:2560 sc1
buffer_load_dwordx2 v[182:183], v130, s[20:23], s40 offen offset:2816 sc1
s_waitcnt vmcnt(0)
v_mfma_f32_16x16x32_bf16 v[184:187], a[0:3], v[44:47], 0
v_mfma_f32_16x16x32_bf16 v[188:191], v[136:139], v[44:47], 0
v_mfma_f32_16x16x32_bf16 v[192:195], a[0:3], v[68:71], 0
v_mfma_f32_16x16x32_bf16 v[196:199], a[24:27], v[68:71], 0
v_mfma_f32_16x16x32_bf16 v[200:203], v[136:139], v[68:71], 0
v_mfma_f32_16x16x32_bf16 v[184:187], a[4:7], v[48:51], v[184:187]
v_mfma_f32_16x16x32_bf16 v[188:191], v[140:143], v[48:51], v[188:191]
v_mfma_f32_16x16x32_bf16 v[192:195], a[4:7], v[72:75], v[192:195]
v_mfma_f32_16x16x32_bf16 v[196:199], a[28:31], v[72:75], v[196:199]
v_mfma_f32_16x16x32_bf16 v[200:203], v[140:143], v[72:75], v[200:203]
v_mfma_f32_16x16x32_bf16 v[184:187], a[8:11], v[52:55], v[184:187]
v_mfma_f32_16x16x32_bf16 v[188:191], v[144:147], v[52:55], v[188:191]
v_mfma_f32_16x16x32_bf16 v[192:195], a[8:11], v[76:79], v[192:195]
v_mfma_f32_16x16x32_bf16 v[196:199], a[32:35], v[76:79], v[196:199]
v_mfma_f32_16x16x32_bf16 v[200:203], v[144:147], v[76:79], v[200:203]
v_mfma_f32_16x16x32_bf16 v[184:187], a[12:15], v[56:59], v[184:187]
v_mfma_f32_16x16x32_bf16 v[188:191], v[148:151], v[56:59], v[188:191]
v_mfma_f32_16x16x32_bf16 v[192:195], a[12:15], v[80:83], v[192:195]
v_mfma_f32_16x16x32_bf16 v[196:199], a[36:39], v[80:83], v[196:199]
v_mfma_f32_16x16x32_bf16 v[200:203], v[148:151], v[80:83], v[200:203]
v_mfma_f32_16x16x32_bf16 v[184:187], a[16:19], v[60:63], v[184:187]
v_mfma_f32_16x16x32_bf16 v[188:191], v[152:155], v[60:63], v[188:191]
v_mfma_f32_16x16x32_bf16 v[192:195], a[16:19], v[84:87], v[192:195]
v_mfma_f32_16x16x32_bf16 v[196:199], a[40:43], v[84:87], v[196:199]
v_mfma_f32_16x16x32_bf16 v[200:203], v[152:155], v[84:87], v[200:203]
v_mfma_f32_16x16x32_bf16 v[184:187], a[20:23], v[64:67], v[184:187]
v_mfma_f32_16x16x32_bf16 v[188:191], v[156:159], v[64:67], v[188:191]
v_mfma_f32_16x16x32_bf16 v[192:195], a[20:23], v[88:91], v[192:195]
v_mfma_f32_16x16x32_bf16 v[196:199], a[44:47], v[88:91], v[196:199]
v_mfma_f32_16x16x32_bf16 v[200:203], v[156:159], v[88:91], v[200:203]
s_nop 3
v_cvt_pk_bf16_f32 v4, v184, v185
v_lshlrev_b32 v184, 16, v4
v_and_b32 v185, 0xffff0000, v4
v_mul_f32 v184, s66, v184
v_mul_f32 v185, s66, v185
v_cvt_pk_bf16_f32 v4, v184, v185
v_lshlrev_b32 v184, 16, v4
v_and_b32 v185, 0xffff0000, v4
v_cvt_pk_bf16_f32 v4, v186, v187
v_lshlrev_b32 v186, 16, v4
v_and_b32 v187, 0xffff0000, v4
v_mul_f32 v186, s66, v186
v_mul_f32 v187, s66, v187
v_cvt_pk_bf16_f32 v4, v186, v187
v_lshlrev_b32 v186, 16, v4
v_and_b32 v187, 0xffff0000, v4
v_cvt_pk_bf16_f32 v4, v188, v189
v_lshlrev_b32 v188, 16, v4
v_and_b32 v189, 0xffff0000, v4
v_mul_f32 v188, s66, v188
v_mul_f32 v189, s66, v189
v_cvt_pk_bf16_f32 v4, v188, v189
v_lshlrev_b32 v188, 16, v4
v_and_b32 v189, 0xffff0000, v4
v_cvt_pk_bf16_f32 v4, v190, v191
v_lshlrev_b32 v190, 16, v4
v_and_b32 v191, 0xffff0000, v4
v_mul_f32 v190, s66, v190
v_mul_f32 v191, s66, v191
v_cvt_pk_bf16_f32 v4, v190, v191
v_lshlrev_b32 v190, 16, v4
v_and_b32 v191, 0xffff0000, v4
v_cvt_pk_bf16_f32 v4, v192, v193
v_lshlrev_b32 v192, 16, v4
v_and_b32 v193, 0xffff0000, v4
v_mul_f32 v192, s66, v192
v_mul_f32 v193, s66, v193
v_cvt_pk_bf16_f32 v4, v192, v193
v_lshlrev_b32 v192, 16, v4
v_and_b32 v193, 0xffff0000, v4
v_cvt_pk_bf16_f32 v4, v194, v195
v_lshlrev_b32 v194, 16, v4
v_and_b32 v195, 0xffff0000, v4
v_mul_f32 v194, s66, v194
v_mul_f32 v195, s66, v195
v_cvt_pk_bf16_f32 v4, v194, v195
v_lshlrev_b32 v194, 16, v4
v_and_b32 v195, 0xffff0000, v4
v_cvt_pk_bf16_f32 v4, v196, v197
v_lshlrev_b32 v196, 16, v4
v_and_b32 v197, 0xffff0000, v4
v_mul_f32 v196, s66, v196
v_mul_f32 v197, s66, v197
v_cvt_pk_bf16_f32 v4, v196, v197
v_lshlrev_b32 v196, 16, v4
v_and_b32 v197, 0xffff0000, v4
v_cvt_pk_bf16_f32 v4, v198, v199
v_lshlrev_b32 v198, 16, v4
v_and_b32 v199, 0xffff0000, v4
v_mul_f32 v198, s66, v198
v_mul_f32 v199, s66, v199
v_cvt_pk_bf16_f32 v4, v198, v199
v_lshlrev_b32 v198, 16, v4
v_and_b32 v199, 0xffff0000, v4
v_cvt_pk_bf16_f32 v4, v200, v201
v_lshlrev_b32 v200, 16, v4
v_and_b32 v201, 0xffff0000, v4
v_mul_f32 v200, s66, v200
v_mul_f32 v201, s66, v201
v_cvt_pk_bf16_f32 v4, v200, v201
v_lshlrev_b32 v200, 16, v4
v_and_b32 v201, 0xffff0000, v4
v_cvt_pk_bf16_f32 v4, v202, v203
v_lshlrev_b32 v202, 16, v4
v_and_b32 v203, 0xffff0000, v4
v_mul_f32 v202, s66, v202
v_mul_f32 v203, s66, v203
v_cvt_pk_bf16_f32 v4, v202, v203
v_lshlrev_b32 v202, 16, v4
v_and_b32 v203, 0xffff0000, v4
v_cmp_le_i32 vcc, 0, v132
s_nop 1
v_cndmask_b32 v184, v133, v184, vcc
v_cmp_le_i32 vcc, 1, v132
s_nop 1
v_cndmask_b32 v185, v133, v185, vcc
v_cmp_le_i32 vcc, 2, v132
s_nop 1
v_cndmask_b32 v186, v133, v186, vcc
v_cmp_le_i32 vcc, 3, v132
s_nop 1
v_cndmask_b32 v187, v133, v187, vcc
v_cmp_le_i32 vcc, 0, v132
s_nop 1
v_cndmask_b32 v196, v133, v196, vcc
v_cmp_le_i32 vcc, 1, v132
s_nop 1
v_cndmask_b32 v197, v133, v197, vcc
v_cmp_le_i32 vcc, 2, v132
s_nop 1
v_cndmask_b32 v198, v133, v198, vcc
v_cmp_le_i32 vcc, 3, v132
s_nop 1
v_cndmask_b32 v199, v133, v199, vcc
s_mov_b32 s78, 0
s_mov_b32 s79, -1
s_mov_b64 exec, s[78:79]
v_mov_b32 v188, v133
v_mov_b32 v189, v133
v_mov_b32 v190, v133
v_mov_b32 v191, v133
v_mov_b32 v200, v133
v_mov_b32 v201, v133
v_mov_b32 v202, v133
v_mov_b32 v203, v133
s_mov_b64 exec, -1
v_max3_f32 v4, v184, v185, v186
v_max3_f32 v4, v4, v187, v188
v_max3_f32 v4, v4, v189, v190
v_max_f32 v4, v4, v191
v_mov_b32 v5, v4
s_nop 1
v_permlane32_swap_b32 v4, v5
v_max_f32 v4, v4, v5
v_mov_b32 v5, v4
s_nop 1
v_permlane16_swap_b32 v4, v5
v_max_f32 v4, v4, v5
v_sub_f32 v184, v184, v4
v_mul_f32 v184, s67, v184
v_exp_f32 v184, v184
v_sub_f32 v185, v185, v4
v_mul_f32 v185, s67, v185
v_exp_f32 v185, v185
v_sub_f32 v186, v186, v4
v_mul_f32 v186, s67, v186
v_exp_f32 v186, v186
v_sub_f32 v187, v187, v4
v_mul_f32 v187, s67, v187
v_exp_f32 v187, v187
v_sub_f32 v188, v188, v4
v_mul_f32 v188, s67, v188
v_exp_f32 v188, v188
v_sub_f32 v189, v189, v4
v_mul_f32 v189, s67, v189
v_exp_f32 v189, v189
v_sub_f32 v190, v190, v4
v_mul_f32 v190, s67, v190
v_exp_f32 v190, v190
v_sub_f32 v191, v191, v4
v_mul_f32 v191, s67, v191
v_exp_f32 v191, v191
v_add_f32 v4, v184, v185
v_add_f32 v4, v4, v186
v_add_f32 v4, v4, v187
v_add_f32 v4, v4, v188
v_add_f32 v4, v4, v189
v_add_f32 v4, v4, v190
v_add_f32 v4, v4, v191
v_mov_b32 v5, v4
s_nop 1
v_permlane32_swap_b32 v4, v5
v_add_f32 v4, v4, v5
v_mov_b32 v5, v4
s_nop 1
v_permlane16_swap_b32 v4, v5
v_add_f32 v4, v4, v5
v_rcp_f32 v4, v4
s_nop 0
v_mul_f32 v184, v184, v4
v_mul_f32 v185, v185, v4
v_mul_f32 v186, v186, v4
v_mul_f32 v187, v187, v4
v_mul_f32 v188, v188, v4
v_mul_f32 v189, v189, v4
v_mul_f32 v190, v190, v4
v_mul_f32 v191, v191, v4
v_max3_f32 v4, v192, v193, v194
v_max3_f32 v4, v4, v195, v196
v_max3_f32 v4, v4, v197, v198
v_max3_f32 v4, v4, v199, v200
v_max3_f32 v4, v4, v201, v202
v_max_f32 v4, v4, v203
v_mov_b32 v5, v4
s_nop 1
v_permlane32_swap_b32 v4, v5
v_max_f32 v4, v4, v5
v_mov_b32 v5, v4
s_nop 1
v_permlane16_swap_b32 v4, v5
v_max_f32 v4, v4, v5
v_sub_f32 v192, v192, v4
v_mul_f32 v192, s67, v192
v_exp_f32 v192, v192
v_sub_f32 v193, v193, v4
v_mul_f32 v193, s67, v193
v_exp_f32 v193, v193
v_sub_f32 v194, v194, v4
v_mul_f32 v194, s67, v194
v_exp_f32 v194, v194
v_sub_f32 v195, v195, v4
v_mul_f32 v195, s67, v195
v_exp_f32 v195, v195
v_sub_f32 v196, v196, v4
v_mul_f32 v196, s67, v196
v_exp_f32 v196, v196
v_sub_f32 v197, v197, v4
v_mul_f32 v197, s67, v197
v_exp_f32 v197, v197
v_sub_f32 v198, v198, v4
v_mul_f32 v198, s67, v198
v_exp_f32 v198, v198
v_sub_f32 v199, v199, v4
v_mul_f32 v199, s67, v199
v_exp_f32 v199, v199
v_sub_f32 v200, v200, v4
v_mul_f32 v200, s67, v200
v_exp_f32 v200, v200
v_sub_f32 v201, v201, v4
v_mul_f32 v201, s67, v201
v_exp_f32 v201, v201
v_sub_f32 v202, v202, v4
v_mul_f32 v202, s67, v202
v_exp_f32 v202, v202
v_sub_f32 v203, v203, v4
v_mul_f32 v203, s67, v203
v_exp_f32 v203, v203
v_add_f32 v4, v192, v193
v_add_f32 v4, v4, v194
v_add_f32 v4, v4, v195
v_add_f32 v4, v4, v196
v_add_f32 v4, v4, v197
v_add_f32 v4, v4, v198
v_add_f32 v4, v4, v199
v_add_f32 v4, v4, v200
v_add_f32 v4, v4, v201
v_add_f32 v4, v4, v202
v_add_f32 v4, v4, v203
v_mov_b32 v5, v4
s_nop 1
v_permlane32_swap_b32 v4, v5
v_add_f32 v4, v4, v5
v_mov_b32 v5, v4
s_nop 1
v_permlane16_swap_b32 v4, v5
v_add_f32 v4, v4, v5
v_rcp_f32 v4, v4
s_nop 0
v_mul_f32 v192, v192, v4
v_mul_f32 v193, v193, v4
v_mul_f32 v194, v194, v4
v_mul_f32 v195, v195, v4
v_mul_f32 v196, v196, v4
v_mul_f32 v197, v197, v4
v_mul_f32 v198, v198, v4
v_mul_f32 v199, v199, v4
v_mul_f32 v200, v200, v4
v_mul_f32 v201, v201, v4
v_mul_f32 v202, v202, v4
v_mul_f32 v203, v203, v4
v_cvt_pk_bf16_f32 v204, v184, v185
v_cvt_pk_bf16_f32 v205, v186, v187
v_mov_b32 v206, 0
v_mov_b32 v207, 0
v_cvt_pk_bf16_f32 v208, v188, v189
v_cvt_pk_bf16_f32 v209, v190, v191
v_cvt_pk_bf16_f32 v212, v192, v193
v_cvt_pk_bf16_f32 v213, v194, v195
v_cvt_pk_bf16_f32 v214, v196, v197
v_cvt_pk_bf16_f32 v215, v198, v199
v_cvt_pk_bf16_f32 v210, v200, v201
v_cvt_pk_bf16_f32 v211, v202, v203
s_mul_i32 s40, s52, 3145728
s_and_b32 s41, s77, 7
s_lshl_b32 s41, s41, 11
s_add_u32 s40, s40, s41
s_mul_i32 s41, s59, 98304
s_add_u32 s40, s40, s41
s_add_u32 s40, s40, 100347904
v_mfma_f32_16x16x32_bf16 v[184:187], a[48:51], v[204:207], 0
v_mfma_f32_16x16x32_bf16 v[188:191], a[52:55], v[204:207], 0
v_mfma_f32_16x16x16_bf16 v[184:187], v[160:161], v[208:209], v[184:187]
v_mfma_f32_16x16x16_bf16 v[188:191], v[162:163], v[208:209], v[188:191]
s_nop 6
v_cvt_pk_bf16_f32 v216, v184, v185
v_cvt_pk_bf16_f32 v217, v186, v187
v_cvt_pk_bf16_f32 v218, v188, v189
v_cvt_pk_bf16_f32 v219, v190, v191
s_add_u32 s41, s40, 0
buffer_store_dwordx4 v[216:219], v131, s[20:23], s41 offen sc1
v_mfma_f32_16x16x32_bf16 v[192:195], a[56:59], v[204:207], 0
v_mfma_f32_16x16x32_bf16 v[196:199], a[60:63], v[204:207], 0
v_mfma_f32_16x16x16_bf16 v[192:195], v[164:165], v[208:209], v[192:195]
v_mfma_f32_16x16x16_bf16 v[196:199], v[166:167], v[208:209], v[196:199]
s_nop 6
v_cvt_pk_bf16_f32 v220, v192, v193
v_cvt_pk_bf16_f32 v221, v194, v195
v_cvt_pk_bf16_f32 v222, v196, v197
v_cvt_pk_bf16_f32 v223, v198, v199
s_add_u32 s41, s40, 16384
buffer_store_dwordx4 v[220:223], v131, s[20:23], s41 offen sc1
v_mfma_f32_16x16x32_bf16 v[184:187], a[64:67], v[204:207], 0
v_mfma_f32_16x16x32_bf16 v[188:191], a[68:71], v[204:207], 0
v_mfma_f32_16x16x16_bf16 v[184:187], v[168:169], v[208:209], v[184:187]
v_mfma_f32_16x16x16_bf16 v[188:191], v[170:171], v[208:209], v[188:191]
s_nop 6
v_cvt_pk_bf16_f32 v216, v184, v185
v_cvt_pk_bf16_f32 v217, v186, v187
v_cvt_pk_bf16_f32 v218, v188, v189
v_cvt_pk_bf16_f32 v219, v190, v191
s_add_u32 s41, s40, 32768
buffer_store_dwordx4 v[216:219], v131, s[20:23], s41 offen sc1
v_mfma_f32_16x16x32_bf16 v[192:195], a[72:75], v[204:207], 0
v_mfma_f32_16x16x32_bf16 v[196:199], a[76:79], v[204:207], 0
v_mfma_f32_16x16x16_bf16 v[192:195], v[172:173], v[208:209], v[192:195]
v_mfma_f32_16x16x16_bf16 v[196:199], v[174:175], v[208:209], v[196:199]
s_nop 6
v_cvt_pk_bf16_f32 v220, v192, v193
v_cvt_pk_bf16_f32 v221, v194, v195
v_cvt_pk_bf16_f32 v222, v196, v197
v_cvt_pk_bf16_f32 v223, v198, v199
s_add_u32 s41, s40, 49152
buffer_store_dwordx4 v[220:223], v131, s[20:23], s41 offen sc1
v_mfma_f32_16x16x32_bf16 v[184:187], a[80:83], v[204:207], 0
v_mfma_f32_16x16x32_bf16 v[188:191], a[84:87], v[204:207], 0
v_mfma_f32_16x16x16_bf16 v[184:187], v[176:177], v[208:209], v[184:187]
v_mfma_f32_16x16x16_bf16 v[188:191], v[178:179], v[208:209], v[188:191]
s_nop 6
v_cvt_pk_bf16_f32 v216, v184, v185
v_cvt_pk_bf16_f32 v217, v186, v187
v_cvt_pk_bf16_f32 v218, v188, v189
v_cvt_pk_bf16_f32 v219, v190, v191
s_add_u32 s41, s40, 65536
buffer_store_dwordx4 v[216:219], v131, s[20:23], s41 offen sc1
v_mfma_f32_16x16x32_bf16 v[192:195], a[88:91], v[204:207], 0
v_mfma_f32_16x16x32_bf16 v[196:199], a[92:95], v[204:207], 0
v_mfma_f32_16x16x16_bf16 v[192:195], v[180:181], v[208:209], v[192:195]
v_mfma_f32_16x16x16_bf16 v[196:199], v[182:183], v[208:209], v[196:199]
s_nop 6
v_cvt_pk_bf16_f32 v220, v192, v193
v_cvt_pk_bf16_f32 v221, v194, v195
v_cvt_pk_bf16_f32 v222, v196, v197
v_cvt_pk_bf16_f32 v223, v198, v199
s_add_u32 s41, s40, 81920
buffer_store_dwordx4 v[220:223], v131, s[20:23], s41 offen sc1
v_mfma_f32_16x16x32_bf16 v[184:187], a[48:51], v[212:215], 0
v_mfma_f32_16x16x32_bf16 v[188:191], a[52:55], v[212:215], 0
v_mfma_f32_16x16x16_bf16 v[184:187], v[160:161], v[210:211], v[184:187]
v_mfma_f32_16x16x16_bf16 v[188:191], v[162:163], v[210:211], v[188:191]
s_nop 6
v_cvt_pk_bf16_f32 v216, v184, v185
v_cvt_pk_bf16_f32 v217, v186, v187
v_cvt_pk_bf16_f32 v218, v188, v189
v_cvt_pk_bf16_f32 v219, v190, v191
s_add_u32 s41, s40, 1024
buffer_store_dwordx4 v[216:219], v131, s[20:23], s41 offen sc1
v_mfma_f32_16x16x32_bf16 v[192:195], a[56:59], v[212:215], 0
v_mfma_f32_16x16x32_bf16 v[196:199], a[60:63], v[212:215], 0
v_mfma_f32_16x16x16_bf16 v[192:195], v[164:165], v[210:211], v[192:195]
v_mfma_f32_16x16x16_bf16 v[196:199], v[166:167], v[210:211], v[196:199]
s_nop 6
v_cvt_pk_bf16_f32 v220, v192, v193
v_cvt_pk_bf16_f32 v221, v194, v195
v_cvt_pk_bf16_f32 v222, v196, v197
v_cvt_pk_bf16_f32 v223, v198, v199
s_add_u32 s41, s40, 17408
buffer_store_dwordx4 v[220:223], v131, s[20:23], s41 offen sc1
v_mfma_f32_16x16x32_bf16 v[184:187], a[64:67], v[212:215], 0
v_mfma_f32_16x16x32_bf16 v[188:191], a[68:71], v[212:215], 0
v_mfma_f32_16x16x16_bf16 v[184:187], v[168:169], v[210:211], v[184:187]
v_mfma_f32_16x16x16_bf16 v[188:191], v[170:171], v[210:211], v[188:191]
s_nop 6
v_cvt_pk_bf16_f32 v216, v184, v185
v_cvt_pk_bf16_f32 v217, v186, v187
v_cvt_pk_bf16_f32 v218, v188, v189
v_cvt_pk_bf16_f32 v219, v190, v191
s_add_u32 s41, s40, 33792
buffer_store_dwordx4 v[216:219], v131, s[20:23], s41 offen sc1
v_mfma_f32_16x16x32_bf16 v[192:195], a[72:75], v[212:215], 0
v_mfma_f32_16x16x32_bf16 v[196:199], a[76:79], v[212:215], 0
v_mfma_f32_16x16x16_bf16 v[192:195], v[172:173], v[210:211], v[192:195]
v_mfma_f32_16x16x16_bf16 v[196:199], v[174:175], v[210:211], v[196:199]
s_nop 6
v_cvt_pk_bf16_f32 v220, v192, v193
v_cvt_pk_bf16_f32 v221, v194, v195
v_cvt_pk_bf16_f32 v222, v196, v197
v_cvt_pk_bf16_f32 v223, v198, v199
s_add_u32 s41, s40, 50176
buffer_store_dwordx4 v[220:223], v131, s[20:23], s41 offen sc1
v_mfma_f32_16x16x32_bf16 v[184:187], a[80:83], v[212:215], 0
v_mfma_f32_16x16x32_bf16 v[188:191], a[84:87], v[212:215], 0
v_mfma_f32_16x16x16_bf16 v[184:187], v[176:177], v[210:211], v[184:187]
v_mfma_f32_16x16x16_bf16 v[188:191], v[178:179], v[210:211], v[188:191]
s_nop 6
v_cvt_pk_bf16_f32 v216, v184, v185
v_cvt_pk_bf16_f32 v217, v186, v187
v_cvt_pk_bf16_f32 v218, v188, v189
v_cvt_pk_bf16_f32 v219, v190, v191
s_add_u32 s41, s40, 66560
buffer_store_dwordx4 v[216:219], v131, s[20:23], s41 offen sc1
v_mfma_f32_16x16x32_bf16 v[192:195], a[88:91], v[212:215], 0
v_mfma_f32_16x16x32_bf16 v[196:199], a[92:95], v[212:215], 0
v_mfma_f32_16x16x16_bf16 v[192:195], v[180:181], v[210:211], v[192:195]
v_mfma_f32_16x16x16_bf16 v[196:199], v[182:183], v[210:211], v[196:199]
s_nop 6
v_cvt_pk_bf16_f32 v220, v192, v193
v_cvt_pk_bf16_f32 v221, v194, v195
v_cvt_pk_bf16_f32 v222, v196, v197
v_cvt_pk_bf16_f32 v223, v198, v199
s_add_u32 s41, s40, 82944
buffer_store_dwordx4 v[220:223], v131, s[20:23], s41 offen sc1
s_lshl_b32 s60, s29, 3
s_add_u32 s60, s60, s52
s_lshl_b32 s60, s60, 6
s_add_u32 s60, s60, 178475008
s_lshl_b32 s61, s65, 2
s_add_u32 s60, s60, s61
s_waitcnt vmcnt(0)
s_barrier
s_cmp_lg_u32 s28, 0
s_cbranch_scc1 L_sigf_16_B
s_mov_b64 exec, 1
v_lshlrev_b32 v17, 5, v1
v_add_u32 v17, s60, v17
buffer_store_dword v16, v17, s[20:23], 0 offen sc1
s_mov_b64 exec, -1
L_sigf_16_B:
s_cmp_eq_u32 s98, 0
s_cbranch_scc1 L_b_next_B
L_b_g2_B:
s_and_b32 s51, s65, 3
s_lshr_b32 s97, s65, 2
s_mov_b32 s34, 7864320
s_mov_b32 s35, 0x00020000
s_mov_b32 s56, 1280
s_mov_b32 s57, 40960
s_mov_b32 s62, 6
s_cmp_eq_u32 s99, 1
s_cbranch_scc1 L_g2_b_B
s_cmp_eq_u32 s97, 3
s_cbranch_scc1 L_b_final_B
s_lshl_b32 s60, s29, 3
s_add_u32 s60, s60, s52
s_lshl_b32 s60, s60, 6
s_add_u32 s60, s60, 178475008
s_cmp_lg_u32 s28, 0
s_cbranch_scc1 L_wf_17x_B
v_min_u32 v17, 7, v1
v_lshlrev_b32 v17, 2, v17
s_nop 1
L_wf_17_B:
buffer_load_dword v18, v17, s[20:23], s60 offen sc1
s_waitcnt vmcnt(0)
v_cmp_eq_u32 vcc, 0, v18
s_add_u32 s64, s64, 1
s_cmp_gt_u32 s64, 2000000
s_cbranch_scc1 L_w_done_B
s_cbranch_vccz L_wf_17x_B
s_cmp_eq_u32 s98, 1
s_cbranch_scc1 L_sl_18_B
s_sleep 40
L_sl_18_B:
s_sleep 4
s_branch L_wf_17_B
L_wf_17x_B:
s_barrier
s_mov_b32 s32, s14
s_mov_b32 s33, s15
s_mov_b32 s55, 12544
s_mul_i32 s61, s29, 768
s_lshl_b32 s60, s97, 8
s_add_u32 s61, s61, s60
s_mul_i32 s53, s52, 3145728
s_lshl_b32 s60, s61, 9
s_add_u32 s53, s53, s60
s_add_u32 s53, s53, 100347904
s_mul_i32 s54, s61, 1280
s_mul_i32 s96, s29, 5242880
s_mul_i32 s60, s52, 655360
s_add_u32 s96, s96, s60
s_add_u32 s96, s96, 126038016
s_mul_i32 s60, s29, 3
s_add_u32 s60, s60, s97
s_mul_i32 s60, s60, 655360
s_add_u32 s60, s60, 178614272
s_cmp_eq_u32 s98, 1
s_cselect_b32 s96, s60, s96
s_cselect_b32 s62, 2, s62
s_branch L_g2_c_B
L_g2_b_B:
s_lshl_b32 s60, s52, 6
s_add_u32 s60, s60, 178479104
s_cmp_lg_u32 s28, 0
s_cbranch_scc1 L_wc_19x_B
v_mov_b32 v17, s60
s_nop 1
L_wc_19_B:
buffer_load_dword v18, v17, s[20:23], 0 offen sc1
s_waitcnt vmcnt(0)
v_readfirstlane_b32 s41, v18
s_add_u32 s64, s64, 1
s_cmp_gt_u32 s64, 2000000
s_cbranch_scc1 L_w_done_B
s_cmp_ge_u32 s41, 8
s_cbranch_scc1 L_wc_19x_B
s_cmp_eq_u32 s98, 1
s_cbranch_scc1 L_sl_20_B
s_sleep 40
L_sl_20_B:
s_sleep 4
s_branch L_wc_19_B
L_wc_19x_B:
s_barrier
s_mov_b32 s32, s68
s_mov_b32 s33, s69
s_mov_b32 s34, 1966080
s_mov_b32 s55, 3328
s_mul_i32 s61, s97, 768
s_mul_i32 s53, s52, 786432
s_lshl_b32 s60, s61, 9
s_add_u32 s53, s53, s60
s_add_u32 s53, s53, 93532160
s_mul_i32 s54, s61, 1280
s_add_u32 s60, s97, 8
s_mul_i32 s96, s60, 5242880
s_mul_i32 s60, s52, 655360
s_add_u32 s96, s96, s60
s_add_u32 s96, s96, 126038016
L_g2_c_B:
s_mul_i32 s60, s51, 320
s_add_u32 s54, s54, s60
s_mul_i32 s40, s28, 4096
s_add_u32 s40, s40, 0
v_lshlrev_b32 v4, 4, v1
v_add_u32 v21, s40, v4
s_mul_i32 s40, s28, 4096
s_add_u32 s40, s40, 1024
v_lshlrev_b32 v4, 4, v1
v_add_u32 v22, s40, v4
s_mul_i32 s40, s28, 4096
s_add_u32 s40, s40, 2048
v_lshlrev_b32 v4, 4, v1
v_add_u32 v23, s40, v4
s_mul_i32 s40, s28, 4096
s_add_u32 s40, s40, 3072
v_lshlrev_b32 v4, 4, v1
v_add_u32 v24, s40, v4
v_mul_lo_u32 v4, v25, s56
v_add_u32 v31, v4, v28
v_mul_lo_u32 v4, v26, s56
v_add_u32 v32, v4, v29
v_mul_lo_u32 v4, v27, s56
v_add_u32 v33, v4, v30
s_barrier
s_add_u32 m0, s45, 0
s_nop 0
buffer_load_dwordx4 v21, s[20:23], s53 offen sc1 lds
s_add_u32 m0, s45, 1024
s_nop 0
buffer_load_dwordx4 v22, s[20:23], s53 offen sc1 lds
s_add_u32 m0, s45, 2048
s_nop 0
buffer_load_dwordx4 v23, s[20:23], s53 offen sc1 lds
s_add_u32 m0, s45, 3072
s_nop 0
buffer_load_dwordx4 v24, s[20:23], s53 offen sc1 lds
s_add_u32 m0, s46, 0
s_nop 0
buffer_load_dwordx4 v31, s[32:35], s54 offen lds
s_add_u32 m0, s46, 1024
s_nop 0
buffer_load_dwordx4 v32, s[32:35], s54 offen lds
s_add_u32 m0, s46, 2048
s_nop 0
buffer_load_dwordx4 v33, s[32:35], s54 offen lds
s_add_u32 s53, s53, 16384
s_add_u32 s54, s54, s57
s_add_u32 m0, s45, 28672
s_nop 0
buffer_load_dwordx4 v21, s[20:23], s53 offen sc1 lds
s_add_u32 m0, s45, 29696
s_nop 0
buffer_load_dwordx4 v22, s[20:23], s53 offen sc1 lds
s_add_u32 m0, s45, 30720
s_nop 0
buffer_load_dwordx4 v23, s[20:23], s53 offen sc1 lds
s_add_u32 m0, s45, 31744
s_nop 0
buffer_load_dwordx4 v24, s[20:23], s53 offen sc1 lds
s_add_u32 m0, s46, 28672
s_nop 0
buffer_load_dwordx4 v31, s[32:35], s54 offen lds
s_add_u32 m0, s46, 29696
s_nop 0
buffer_load_dwordx4 v32, s[32:35], s54 offen lds
s_add_u32 m0, s46, 30720
s_nop 0
buffer_load_dwordx4 v33, s[32:35], s54 offen lds
s_add_u32 s53, s53, 16384
s_add_u32 s54, s54, s57
s_add_u32 m0, s45, 57344
s_nop 0
buffer_load_dwordx4 v21, s[20:23], s53 offen sc1 lds
s_add_u32 m0, s45, 58368
s_nop 0
buffer_load_dwordx4 v22, s[20:23], s53 offen sc1 lds
s_add_u32 m0, s45, 59392
s_nop 0
buffer_load_dwordx4 v23, s[20:23], s53 offen sc1 lds
s_add_u32 m0, s45, 60416
s_nop 0
buffer_load_dwordx4 v24, s[20:23], s53 offen sc1 lds
s_add_u32 m0, s46, 57344
s_nop 0
buffer_load_dwordx4 v31, s[32:35], s54 offen lds
s_add_u32 m0, s46, 58368
s_nop 0
buffer_load_dwordx4 v32, s[32:35], s54 offen lds
s_add_u32 m0, s46, 59392
s_nop 0
buffer_load_dwordx4 v33, s[32:35], s54 offen lds
s_add_u32 s53, s53, 16384
s_add_u32 s54, s54, s57
s_add_u32 m0, s45, 86016
s_nop 0
buffer_load_dwordx4 v21, s[20:23], s53 offen sc1 lds
s_add_u32 m0, s45, 87040
s_nop 0
buffer_load_dwordx4 v22, s[20:23], s53 offen sc1 lds
s_add_u32 m0, s45, 88064
s_nop 0
buffer_load_dwordx4 v23, s[20:23], s53 offen sc1 lds
s_add_u32 m0, s45, 89088
s_nop 0
buffer_load_dwordx4 v24, s[20:23], s53 offen sc1 lds
s_add_u32 m0, s46, 86016
s_nop 0
buffer_load_dwordx4 v31, s[32:35], s54 offen lds
s_add_u32 m0, s46, 87040
s_nop 0
buffer_load_dwordx4 v32, s[32:35], s54 offen lds
s_add_u32 m0, s46, 88064
s_nop 0
buffer_load_dwordx4 v33, s[32:35], s54 offen lds
s_add_u32 s53, s53, 16384
s_add_u32 s54, s54, s57
s_waitcnt vmcnt(21)
s_barrier
ds_read_b128 v[44:47], v34 offset:0
ds_read_b128 v[48:51], v34 offset:2048
ds_read_b64_tr_b16 v[60:61], v36 offset:0
ds_read_b64_tr_b16 v[62:63], v37 offset:0
ds_read_b64_tr_b16 v[64:65], v40 offset:0
ds_read_b64_tr_b16 v[66:67], v41 offset:0
ds_read_b64_tr_b16 v[68:69], v36 offset:128
ds_read_b64_tr_b16 v[70:71], v37 offset:128
ds_read_b64_tr_b16 v[72:73], v40 offset:128
ds_read_b64_tr_b16 v[74:75], v41 offset:128
ds_read_b64_tr_b16 v[76:77], v36 offset:256
ds_read_b64_tr_b16 v[78:79], v37 offset:256
s_waitcnt lgkmcnt(0)
v_mfma_f32_32x32x16_bf16 a[0:15], v[60:63], v[44:47], 0
ds_read_b128 v[52:55], v35 offset:0
v_mfma_f32_32x32x16_bf16 a[16:31], v[64:67], v[44:47], 0
ds_read_b128 v[56:59], v35 offset:2048
v_mfma_f32_32x32x16_bf16 a[32:47], v[68:71], v[44:47], 0
ds_read_b64_tr_b16 v[80:81], v38 offset:0
ds_read_b64_tr_b16 v[82:83], v39 offset:0
v_mfma_f32_32x32x16_bf16 a[48:63], v[72:75], v[44:47], 0
ds_read_b64_tr_b16 v[84:85], v42 offset:0
ds_read_b64_tr_b16 v[86:87], v43 offset:0
v_mfma_f32_32x32x16_bf16 a[64:79], v[76:79], v[44:47], 0
ds_read_b64_tr_b16 v[88:89], v38 offset:128
ds_read_b64_tr_b16 v[90:91], v39 offset:128
v_mfma_f32_32x32x16_bf16 a[80:95], v[60:63], v[48:51], 0
ds_read_b64_tr_b16 v[92:93], v42 offset:128
ds_read_b64_tr_b16 v[94:95], v43 offset:128
v_mfma_f32_32x32x16_bf16 a[96:111], v[64:67], v[48:51], 0
ds_read_b64_tr_b16 v[96:97], v38 offset:256
ds_read_b64_tr_b16 v[98:99], v39 offset:256
v_mfma_f32_32x32x16_bf16 a[112:127], v[68:71], v[48:51], 0
v_mfma_f32_32x32x16_bf16 a[128:143], v[72:75], v[48:51], 0
v_mfma_f32_32x32x16_bf16 a[144:159], v[76:79], v[48:51], 0
s_waitcnt lgkmcnt(0)
s_waitcnt vmcnt(14)
s_barrier
v_mfma_f32_32x32x16_bf16 a[0:15], v[80:83], v[52:55], a[0:15]
ds_read_b128 v[44:47], v34 offset:28672
ds_read_b128 v[48:51], v34 offset:30720
v_mfma_f32_32x32x16_bf16 a[16:31], v[84:87], v[52:55], a[16:31]
ds_read_b64_tr_b16 v[60:61], v36 offset:28672
ds_read_b64_tr_b16 v[62:63], v37 offset:28672
ds_read_b64_tr_b16 v[64:65], v40 offset:28672
ds_read_b64_tr_b16 v[66:67], v41 offset:28672
v_mfma_f32_32x32x16_bf16 a[32:47], v[88:91], v[52:55], a[32:47]
ds_read_b64_tr_b16 v[68:69], v36 offset:28800
ds_read_b64_tr_b16 v[70:71], v37 offset:28800
ds_read_b64_tr_b16 v[72:73], v40 offset:28800
ds_read_b64_tr_b16 v[74:75], v41 offset:28800
v_mfma_f32_32x32x16_bf16 a[48:63], v[92:95], v[52:55], a[48:63]
ds_read_b64_tr_b16 v[76:77], v36 offset:28928
ds_read_b64_tr_b16 v[78:79], v37 offset:28928
s_add_u32 m0, s45, 0
s_nop 0
buffer_load_dwordx4 v21, s[20:23], s53 offen sc1 lds
v_mfma_f32_32x32x16_bf16 a[64:79], v[96:99], v[52:55], a[64:79]
s_add_u32 m0, s45, 1024
s_nop 0
buffer_load_dwordx4 v22, s[20:23], s53 offen sc1 lds
s_add_u32 m0, s45, 2048
s_nop 0
buffer_load_dwordx4 v23, s[20:23], s53 offen sc1 lds
v_mfma_f32_32x32x16_bf16 a[80:95], v[80:83], v[56:59], a[80:95]
s_add_u32 m0, s45, 3072
s_nop 0
buffer_load_dwordx4 v24, s[20:23], s53 offen sc1 lds
s_add_u32 m0, s46, 0
s_nop 0
buffer_load_dwordx4 v31, s[32:35], s54 offen lds
v_mfma_f32_32x32x16_bf16 a[96:111], v[84:87], v[56:59], a[96:111]
s_add_u32 m0, s46, 1024
s_nop 0
buffer_load_dwordx4 v32, s[32:35], s54 offen lds
s_add_u32 m0, s46, 2048
s_nop 0
buffer_load_dwordx4 v33, s[32:35], s54 offen lds
s_add_u32 s53, s53, 16384
s_add_u32 s54, s54, s57
v_mfma_f32_32x32x16_bf16 a[112:127], v[88:91], v[56:59], a[112:127]
v_mfma_f32_32x32x16_bf16 a[128:143], v[92:95], v[56:59], a[128:143]
v_mfma_f32_32x32x16_bf16 a[144:159], v[96:99], v[56:59], a[144:159]
s_waitcnt lgkmcnt(0)
v_mfma_f32_32x32x16_bf16 a[0:15], v[60:63], v[44:47], a[0:15]
ds_read_b128 v[52:55], v35 offset:28672
v_mfma_f32_32x32x16_bf16 a[16:31], v[64:67], v[44:47], a[16:31]
ds_read_b128 v[56:59], v35 offset:30720
v_mfma_f32_32x32x16_bf16 a[32:47], v[68:71], v[44:47], a[32:47]
ds_read_b64_tr_b16 v[80:81], v38 offset:28672
ds_read_b64_tr_b16 v[82:83], v39 offset:28672
v_mfma_f32_32x32x16_bf16 a[48:63], v[72:75], v[44:47], a[48:63]
ds_read_b64_tr_b16 v[84:85], v42 offset:28672
ds_read_b64_tr_b16 v[86:87], v43 offset:28672
v_mfma_f32_32x32x16_bf16 a[64:79], v[76:79], v[44:47], a[64:79]
ds_read_b64_tr_b16 v[88:89], v38 offset:28800
ds_read_b64_tr_b16 v[90:91], v39 offset:28800
v_mfma_f32_32x32x16_bf16 a[80:95], v[60:63], v[48:51], a[80:95]
ds_read_b64_tr_b16 v[92:93], v42 offset:28800
ds_read_b64_tr_b16 v[94:95], v43 offset:28800
v_mfma_f32_32x32x16_bf16 a[96:111], v[64:67], v[48:51], a[96:111]
ds_read_b64_tr_b16 v[96:97], v38 offset:28928
ds_read_b64_tr_b16 v[98:99], v39 offset:28928
v_mfma_f32_32x32x16_bf16 a[112:127], v[68:71], v[48:51], a[112:127]
v_mfma_f32_32x32x16_bf16 a[128:143], v[72:75], v[48:51], a[128:143]
v_mfma_f32_32x32x16_bf16 a[144:159], v[76:79], v[48:51], a[144:159]
s_waitcnt lgkmcnt(0)
s_waitcnt vmcnt(14)
s_barrier
v_mfma_f32_32x32x16_bf16 a[0:15], v[80:83], v[52:55], a[0:15]
ds_read_b128 v[44:47], v100 offset:0
ds_read_b128 v[48:51], v100 offset:2048
v_mfma_f32_32x32x16_bf16 a[16:31], v[84:87], v[52:55], a[16:31]
ds_read_b64_tr_b16 v[60:61], v102 offset:0
ds_read_b64_tr_b16 v[62:63], v103 offset:0
ds_read_b64_tr_b16 v[64:65], v106 offset:0
ds_read_b64_tr_b16 v[66:67], v107 offset:0
v_mfma_f32_32x32x16_bf16 a[32:47], v[88:91], v[52:55], a[32:47]
ds_read_b64_tr_b16 v[68:69], v102 offset:128
ds_read_b64_tr_b16 v[70:71], v103 offset:128
ds_read_b64_tr_b16 v[72:73], v106 offset:128
ds_read_b64_tr_b16 v[74:75], v107 offset:128
v_mfma_f32_32x32x16_bf16 a[48:63], v[92:95], v[52:55], a[48:63]
ds_read_b64_tr_b16 v[76:77], v102 offset:256
ds_read_b64_tr_b16 v[78:79], v103 offset:256
s_add_u32 m0, s45, 28672
s_nop 0
buffer_load_dwordx4 v21, s[20:23], s53 offen sc1 lds
v_mfma_f32_32x32x16_bf16 a[64:79], v[96:99], v[52:55], a[64:79]
s_add_u32 m0, s45, 29696
s_nop 0
buffer_load_dwordx4 v22, s[20:23], s53 offen sc1 lds
s_add_u32 m0, s45, 30720
s_nop 0
buffer_load_dwordx4 v23, s[20:23], s53 offen sc1 lds
v_mfma_f32_32x32x16_bf16 a[80:95], v[80:83], v[56:59], a[80:95]
s_add_u32 m0, s45, 31744
s_nop 0
buffer_load_dwordx4 v24, s[20:23], s53 offen sc1 lds
s_add_u32 m0, s46, 28672
s_nop 0
buffer_load_dwordx4 v31, s[32:35], s54 offen lds
v_mfma_f32_32x32x16_bf16 a[96:111], v[84:87], v[56:59], a[96:111]
s_add_u32 m0, s46, 29696
s_nop 0
buffer_load_dwordx4 v32, s[32:35], s54 offen lds
s_add_u32 m0, s46, 30720
s_nop 0
buffer_load_dwordx4 v33, s[32:35], s54 offen lds
s_add_u32 s53, s53, 16384
s_add_u32 s54, s54, s57
v_mfma_f32_32x32x16_bf16 a[112:127], v[88:91], v[56:59], a[112:127]
v_mfma_f32_32x32x16_bf16 a[128:143], v[92:95], v[56:59], a[128:143]
v_mfma_f32_32x32x16_bf16 a[144:159], v[96:99], v[56:59], a[144:159]
s_waitcnt lgkmcnt(0)
v_mfma_f32_32x32x16_bf16 a[0:15], v[60:63], v[44:47], a[0:15]
ds_read_b128 v[52:55], v101 offset:0
v_mfma_f32_32x32x16_bf16 a[16:31], v[64:67], v[44:47], a[16:31]
ds_read_b128 v[56:59], v101 offset:2048
v_mfma_f32_32x32x16_bf16 a[32:47], v[68:71], v[44:47], a[32:47]
ds_read_b64_tr_b16 v[80:81], v104 offset:0
ds_read_b64_tr_b16 v[82:83], v105 offset:0
v_mfma_f32_32x32x16_bf16 a[48:63], v[72:75], v[44:47], a[48:63]
ds_read_b64_tr_b16 v[84:85], v108 offset:0
ds_read_b64_tr_b16 v[86:87], v109 offset:0
v_mfma_f32_32x32x16_bf16 a[64:79], v[76:79], v[44:47], a[64:79]
ds_read_b64_tr_b16 v[88:89], v104 offset:128
ds_read_b64_tr_b16 v[90:91], v105 offset:128
v_mfma_f32_32x32x16_bf16 a[80:95], v[60:63], v[48:51], a[80:95]
ds_read_b64_tr_b16 v[92:93], v108 offset:128
ds_read_b64_tr_b16 v[94:95], v109 offset:128
v_mfma_f32_32x32x16_bf16 a[96:111], v[64:67], v[48:51], a[96:111]
ds_read_b64_tr_b16 v[96:97], v104 offset:256
ds_read_b64_tr_b16 v[98:99], v105 offset:256
v_mfma_f32_32x32x16_bf16 a[112:127], v[68:71], v[48:51], a[112:127]
v_mfma_f32_32x32x16_bf16 a[128:143], v[72:75], v[48:51], a[128:143]
v_mfma_f32_32x32x16_bf16 a[144:159], v[76:79], v[48:51], a[144:159]
s_waitcnt lgkmcnt(0)
s_waitcnt vmcnt(14)
s_barrier
v_mfma_f32_32x32x16_bf16 a[0:15], v[80:83], v[52:55], a[0:15]
ds_read_b128 v[44:47], v100 offset:28672
ds_read_b128 v[48:51], v100 offset:30720
v_mfma_f32_32x32x16_bf16 a[16:31], v[84:87], v[52:55], a[16:31]
ds_read_b64_tr_b16 v[60:61], v102 offset:28672
ds_read_b64_tr_b16 v[62:63], v103 offset:28672
ds_read_b64_tr_b16 v[64:65], v106 offset:28672
ds_read_b64_tr_b16 v[66:67], v107 offset:28672
v_mfma_f32_32x32x16_bf16 a[32:47], v[88:91], v[52:55], a[32:47]
ds_read_b64_tr_b16 v[68:69], v102 offset:28800
ds_read_b64_tr_b16 v[70:71], v103 offset:28800
ds_read_b64_tr_b16 v[72:73], v106 offset:28800
ds_read_b64_tr_b16 v[74:75], v107 offset:28800
v_mfma_f32_32x32x16_bf16 a[48:63], v[92:95], v[52:55], a[48:63]
ds_read_b64_tr_b16 v[76:77], v102 offset:28928
ds_read_b64_tr_b16 v[78:79], v103 offset:28928
s_add_u32 m0, s45, 57344
s_nop 0
buffer_load_dwordx4 v21, s[20:23], s53 offen sc1 lds
v_mfma_f32_32x32x16_bf16 a[64:79], v[96:99], v[52:55], a[64:79]
s_add_u32 m0, s45, 58368
s_nop 0
buffer_load_dwordx4 v22, s[20:23], s53 offen sc1 lds
s_add_u32 m0, s45, 59392
s_nop 0
buffer_load_dwordx4 v23, s[20:23], s53 offen sc1 lds
v_mfma_f32_32x32x16_bf16 a[80:95], v[80:83], v[56:59], a[80:95]
s_add_u32 m0, s45, 60416
s_nop 0
buffer_load_dwordx4 v24, s[20:23], s53 offen sc1 lds
s_add_u32 m0, s46, 57344
s_nop 0
buffer_load_dwordx4 v31, s[32:35], s54 offen lds
v_mfma_f32_32x32x16_bf16 a[96:111], v[84:87], v[56:59], a[96:111]
s_add_u32 m0, s46, 58368
s_nop 0
buffer_load_dwordx4 v32, s[32:35], s54 offen lds
s_add_u32 m0, s46, 59392
s_nop 0
buffer_load_dwordx4 v33, s[32:35], s54 offen lds
s_add_u32 s53, s53, 16384
s_add_u32 s54, s54, s57
v_mfma_f32_32x32x16_bf16 a[112:127], v[88:91], v[56:59], a[112:127]
v_mfma_f32_32x32x16_bf16 a[128:143], v[92:95], v[56:59], a[128:143]
v_mfma_f32_32x32x16_bf16 a[144:159], v[96:99], v[56:59], a[144:159]
s_waitcnt lgkmcnt(0)
v_mfma_f32_32x32x16_bf16 a[0:15], v[60:63], v[44:47], a[0:15]
ds_read_b128 v[52:55], v101 offset:28672
v_mfma_f32_32x32x16_bf16 a[16:31], v[64:67], v[44:47], a[16:31]
ds_read_b128 v[56:59], v101 offset:30720
v_mfma_f32_32x32x16_bf16 a[32:47], v[68:71], v[44:47], a[32:47]
ds_read_b64_tr_b16 v[80:81], v104 offset:28672
ds_read_b64_tr_b16 v[82:83], v105 offset:28672
v_mfma_f32_32x32x16_bf16 a[48:63], v[72:75], v[44:47], a[48:63]
ds_read_b64_tr_b16 v[84:85], v108 offset:28672
ds_read_b64_tr_b16 v[86:87], v109 offset:28672
v_mfma_f32_32x32x16_bf16 a[64:79], v[76:79], v[44:47], a[64:79]
ds_read_b64_tr_b16 v[88:89], v104 offset:28800
ds_read_b64_tr_b16 v[90:91], v105 offset:28800
v_mfma_f32_32x32x16_bf16 a[80:95], v[60:63], v[48:51], a[80:95]
ds_read_b64_tr_b16 v[92:93], v108 offset:28800
ds_read_b64_tr_b16 v[94:95], v109 offset:28800
v_mfma_f32_32x32x16_bf16 a[96:111], v[64:67], v[48:51], a[96:111]
ds_read_b64_tr_b16 v[96:97], v104 offset:28928
ds_read_b64_tr_b16 v[98:99], v105 offset:28928
v_mfma_f32_32x32x16_bf16 a[112:127], v[68:71], v[48:51], a[112:127]
v_mfma_f32_32x32x16_bf16 a[128:143], v[72:75], v[48:51], a[128:143]
v_mfma_f32_32x32x16_bf16 a[144:159], v[76:79], v[48:51], a[144:159]
s_waitcnt lgkmcnt(0)
s_waitcnt vmcnt(14)
s_barrier
v_mfma_f32_32x32x16_bf16 a[0:15], v[80:83], v[52:55], a[0:15]
ds_read_b128 v[44:47], v34 offset:0
ds_read_b128 v[48:51], v34 offset:2048
v_mfma_f32_32x32x16_bf16 a[16:31], v[84:87], v[52:55], a[16:31]
ds_read_b64_tr_b16 v[60:61], v36 offset:0
ds_read_b64_tr_b16 v[62:63], v37 offset:0
ds_read_b64_tr_b16 v[64:65], v40 offset:0
ds_read_b64_tr_b16 v[66:67], v41 offset:0
v_mfma_f32_32x32x16_bf16 a[32:47], v[88:91], v[52:55], a[32:47]
ds_read_b64_tr_b16 v[68:69], v36 offset:128
ds_read_b64_tr_b16 v[70:71], v37 offset:128
ds_read_b64_tr_b16 v[72:73], v40 offset:128
ds_read_b64_tr_b16 v[74:75], v41 offset:128
v_mfma_f32_32x32x16_bf16 a[48:63], v[92:95], v[52:55], a[48:63]
ds_read_b64_tr_b16 v[76:77], v36 offset:256
ds_read_b64_tr_b16 v[78:79], v37 offset:256
s_add_u32 m0, s45, 86016
s_nop 0
buffer_load_dwordx4 v21, s[20:23], s53 offen sc1 lds
v_mfma_f32_32x32x16_bf16 a[64:79], v[96:99], v[52:55], a[64:79]
s_add_u32 m0, s45, 87040
s_nop 0
buffer_load_dwordx4 v22, s[20:23], s53 offen sc1 lds
s_add_u32 m0, s45, 88064
s_nop 0
buffer_load_dwordx4 v23, s[20:23], s53 offen sc1 lds
v_mfma_f32_32x32x16_bf16 a[80:95], v[80:83], v[56:59], a[80:95]
s_add_u32 m0, s45, 89088
s_nop 0
buffer_load_dwordx4 v24, s[20:23], s53 offen sc1 lds
s_add_u32 m0, s46, 86016
s_nop 0
buffer_load_dwordx4 v31, s[32:35], s54 offen lds
v_mfma_f32_32x32x16_bf16 a[96:111], v[84:87], v[56:59], a[96:111]
s_add_u32 m0, s46, 87040
s_nop 0
buffer_load_dwordx4 v32, s[32:35], s54 offen lds
s_add_u32 m0, s46, 88064
s_nop 0
buffer_load_dwordx4 v33, s[32:35], s54 offen lds
s_add_u32 s53, s53, 16384
s_add_u32 s54, s54, s57
v_mfma_f32_32x32x16_bf16 a[112:127], v[88:91], v[56:59], a[112:127]
v_mfma_f32_32x32x16_bf16 a[128:143], v[92:95], v[56:59], a[128:143]
v_mfma_f32_32x32x16_bf16 a[144:159], v[96:99], v[56:59], a[144:159]
s_sub_u32 s42, s62, 2
s_cmp_eq_u32 s42, 0
s_cbranch_scc1 L_g2_wx_last_B
s_nop 8
L_g2_wx_B:
s_waitcnt lgkmcnt(0)
v_mfma_f32_32x32x16_bf16 a[0:15], v[60:63], v[44:47], a[0:15]
ds_read_b128 v[52:55], v35 offset:0
v_mfma_f32_32x32x16_bf16 a[16:31], v[64:67], v[44:47], a[16:31]
ds_read_b128 v[56:59], v35 offset:2048
v_mfma_f32_32x32x16_bf16 a[32:47], v[68:71], v[44:47], a[32:47]
ds_read_b64_tr_b16 v[80:81], v38 offset:0
ds_read_b64_tr_b16 v[82:83], v39 offset:0
v_mfma_f32_32x32x16_bf16 a[48:63], v[72:75], v[44:47], a[48:63]
ds_read_b64_tr_b16 v[84:85], v42 offset:0
ds_read_b64_tr_b16 v[86:87], v43 offset:0
v_mfma_f32_32x32x16_bf16 a[64:79], v[76:79], v[44:47], a[64:79]
ds_read_b64_tr_b16 v[88:89], v38 offset:128
ds_read_b64_tr_b16 v[90:91], v39 offset:128
v_mfma_f32_32x32x16_bf16 a[80:95], v[60:63], v[48:51], a[80:95]
ds_read_b64_tr_b16 v[92:93], v42 offset:128
ds_read_b64_tr_b16 v[94:95], v43 offset:128
v_mfma_f32_32x32x16_bf16 a[96:111], v[64:67], v[48:51], a[96:111]
ds_read_b64_tr_b16 v[96:97], v38 offset:256
ds_read_b64_tr_b16 v[98:99], v39 offset:256
v_mfma_f32_32x32x16_bf16 a[112:127], v[68:71], v[48:51], a[112:127]
v_mfma_f32_32x32x16_bf16 a[128:143], v[72:75], v[48:51], a[128:143]
v_mfma_f32_32x32x16_bf16 a[144:159], v[76:79], v[48:51], a[144:159]
s_waitcnt lgkmcnt(0)
s_waitcnt vmcnt(14)
s_barrier
v_mfma_f32_32x32x16_bf16 a[0:15], v[80:83], v[52:55], a[0:15]
ds_read_b128 v[44:47], v34 offset:28672
ds_read_b128 v[48:51], v34 offset:30720
v_mfma_f32_32x32x16_bf16 a[16:31], v[84:87], v[52:55], a[16:31]
ds_read_b64_tr_b16 v[60:61], v36 offset:28672
ds_read_b64_tr_b16 v[62:63], v37 offset:28672
ds_read_b64_tr_b16 v[64:65], v40 offset:28672
ds_read_b64_tr_b16 v[66:67], v41 offset:28672
v_mfma_f32_32x32x16_bf16 a[32:47], v[88:91], v[52:55], a[32:47]
ds_read_b64_tr_b16 v[68:69], v36 offset:28800
ds_read_b64_tr_b16 v[70:71], v37 offset:28800
ds_read_b64_tr_b16 v[72:73], v40 offset:28800
ds_read_b64_tr_b16 v[74:75], v41 offset:28800
v_mfma_f32_32x32x16_bf16 a[48:63], v[92:95], v[52:55], a[48:63]
ds_read_b64_tr_b16 v[76:77], v36 offset:28928
ds_read_b64_tr_b16 v[78:79], v37 offset:28928
s_add_u32 m0, s45, 0
s_nop 0
buffer_load_dwordx4 v21, s[20:23], s53 offen sc1 lds
v_mfma_f32_32x32x16_bf16 a[64:79], v[96:99], v[52:55], a[64:79]
s_add_u32 m0, s45, 1024
s_nop 0
buffer_load_dwordx4 v22, s[20:23], s53 offen sc1 lds
s_add_u32 m0, s45, 2048
s_nop 0
buffer_load_dwordx4 v23, s[20:23], s53 offen sc1 lds
v_mfma_f32_32x32x16_bf16 a[80:95], v[80:83], v[56:59], a[80:95]
s_add_u32 m0, s45, 3072
s_nop 0
buffer_load_dwordx4 v24, s[20:23], s53 offen sc1 lds
s_add_u32 m0, s46, 0
s_nop 0
buffer_load_dwordx4 v31, s[32:35], s54 offen lds
v_mfma_f32_32x32x16_bf16 a[96:111], v[84:87], v[56:59], a[96:111]
s_add_u32 m0, s46, 1024
s_nop 0
buffer_load_dwordx4 v32, s[32:35], s54 offen lds
s_add_u32 m0, s46, 2048
s_nop 0
buffer_load_dwordx4 v33, s[32:35], s54 offen lds
s_add_u32 s53, s53, 16384
s_add_u32 s54, s54, s57
v_mfma_f32_32x32x16_bf16 a[112:127], v[88:91], v[56:59], a[112:127]
v_mfma_f32_32x32x16_bf16 a[128:143], v[92:95], v[56:59], a[128:143]
v_mfma_f32_32x32x16_bf16 a[144:159], v[96:99], v[56:59], a[144:159]
s_waitcnt lgkmcnt(0)
v_mfma_f32_32x32x16_bf16 a[0:15], v[60:63], v[44:47], a[0:15]
ds_read_b128 v[52:55], v35 offset:28672
v_mfma_f32_32x32x16_bf16 a[16:31], v[64:67], v[44:47], a[16:31]
ds_read_b128 v[56:59], v35 offset:30720
v_mfma_f32_32x32x16_bf16 a[32:47], v[68:71], v[44:47], a[32:47]
ds_read_b64_tr_b16 v[80:81], v38 offset:28672
ds_read_b64_tr_b16 v[82:83], v39 offset:28672
v_mfma_f32_32x32x16_bf16 a[48:63], v[72:75], v[44:47], a[48:63]
ds_read_b64_tr_b16 v[84:85], v42 offset:28672
ds_read_b64_tr_b16 v[86:87], v43 offset:28672
v_mfma_f32_32x32x16_bf16 a[64:79], v[76:79], v[44:47], a[64:79]
ds_read_b64_tr_b16 v[88:89], v38 offset:28800
ds_read_b64_tr_b16 v[90:91], v39 offset:28800
v_mfma_f32_32x32x16_bf16 a[80:95], v[60:63], v[48:51], a[80:95]
ds_read_b64_tr_b16 v[92:93], v42 offset:28800
ds_read_b64_tr_b16 v[94:95], v43 offset:28800
v_mfma_f32_32x32x16_bf16 a[96:111], v[64:67], v[48:51], a[96:111]
ds_read_b64_tr_b16 v[96:97], v38 offset:28928
ds_read_b64_tr_b16 v[98:99], v39 offset:28928
v_mfma_f32_32x32x16_bf16 a[112:127], v[68:71], v[48:51], a[112:127]
v_mfma_f32_32x32x16_bf16 a[128:143], v[72:75], v[48:51], a[128:143]
v_mfma_f32_32x32x16_bf16 a[144:159], v[76:79], v[48:51], a[144:159]
s_waitcnt lgkmcnt(0)
s_waitcnt vmcnt(14)
s_barrier
v_mfma_f32_32x32x16_bf16 a[0:15], v[80:83], v[52:55], a[0:15]
ds_read_b128 v[44:47], v100 offset:0
ds_read_b128 v[48:51], v100 offset:2048
v_mfma_f32_32x32x16_bf16 a[16:31], v[84:87], v[52:55], a[16:31]
ds_read_b64_tr_b16 v[60:61], v102 offset:0
ds_read_b64_tr_b16 v[62:63], v103 offset:0
ds_read_b64_tr_b16 v[64:65], v106 offset:0
ds_read_b64_tr_b16 v[66:67], v107 offset:0
v_mfma_f32_32x32x16_bf16 a[32:47], v[88:91], v[52:55], a[32:47]
ds_read_b64_tr_b16 v[68:69], v102 offset:128
ds_read_b64_tr_b16 v[70:71], v103 offset:128
ds_read_b64_tr_b16 v[72:73], v106 offset:128
ds_read_b64_tr_b16 v[74:75], v107 offset:128
v_mfma_f32_32x32x16_bf16 a[48:63], v[92:95], v[52:55], a[48:63]
ds_read_b64_tr_b16 v[76:77], v102 offset:256
ds_read_b64_tr_b16 v[78:79], v103 offset:256
s_add_u32 m0, s45, 28672
s_nop 0
buffer_load_dwordx4 v21, s[20:23], s53 offen sc1 lds
v_mfma_f32_32x32x16_bf16 a[64:79], v[96:99], v[52:55], a[64:79]
s_add_u32 m0, s45, 29696
s_nop 0
buffer_load_dwordx4 v22, s[20:23], s53 offen sc1 lds
s_add_u32 m0, s45, 30720
s_nop 0
buffer_load_dwordx4 v23, s[20:23], s53 offen sc1 lds
v_mfma_f32_32x32x16_bf16 a[80:95], v[80:83], v[56:59], a[80:95]
s_add_u32 m0, s45, 31744
s_nop 0
buffer_load_dwordx4 v24, s[20:23], s53 offen sc1 lds
s_add_u32 m0, s46, 28672
s_nop 0
buffer_load_dwordx4 v31, s[32:35], s54 offen lds
v_mfma_f32_32x32x16_bf16 a[96:111], v[84:87], v[56:59], a[96:111]
s_add_u32 m0, s46, 29696
s_nop 0
buffer_load_dwordx4 v32, s[32:35], s54 offen lds
s_add_u32 m0, s46, 30720
s_nop 0
buffer_load_dwordx4 v33, s[32:35], s54 offen lds
s_add_u32 s53, s53, 16384
s_add_u32 s54, s54, s57
v_mfma_f32_32x32x16_bf16 a[112:127], v[88:91], v[56:59], a[112:127]
v_mfma_f32_32x32x16_bf16 a[128:143], v[92:95], v[56:59], a[128:143]
v_mfma_f32_32x32x16_bf16 a[144:159], v[96:99], v[56:59], a[144:159]
s_waitcnt lgkmcnt(0)
v_mfma_f32_32x32x16_bf16 a[0:15], v[60:63], v[44:47], a[0:15]
ds_read_b128 v[52:55], v101 offset:0
v_mfma_f32_32x32x16_bf16 a[16:31], v[64:67], v[44:47], a[16:31]
ds_read_b128 v[56:59], v101 offset:2048
v_mfma_f32_32x32x16_bf16 a[32:47], v[68:71], v[44:47], a[32:47]
ds_read_b64_tr_b16 v[80:81], v104 offset:0
ds_read_b64_tr_b16 v[82:83], v105 offset:0
v_mfma_f32_32x32x16_bf16 a[48:63], v[72:75], v[44:47], a[48:63]
ds_read_b64_tr_b16 v[84:85], v108 offset:0
ds_read_b64_tr_b16 v[86:87], v109 offset:0
v_mfma_f32_32x32x16_bf16 a[64:79], v[76:79], v[44:47], a[64:79]
ds_read_b64_tr_b16 v[88:89], v104 offset:128
ds_read_b64_tr_b16 v[90:91], v105 offset:128
v_mfma_f32_32x32x16_bf16 a[80:95], v[60:63], v[48:51], a[80:95]
ds_read_b64_tr_b16 v[92:93], v108 offset:128
ds_read_b64_tr_b16 v[94:95], v109 offset:128
v_mfma_f32_32x32x16_bf16 a[96:111], v[64:67], v[48:51], a[96:111]
ds_read_b64_tr_b16 v[96:97], v104 offset:256
ds_read_b64_tr_b16 v[98:99], v105 offset:256
v_mfma_f32_32x32x16_bf16 a[112:127], v[68:71], v[48:51], a[112:127]
v_mfma_f32_32x32x16_bf16 a[128:143], v[72:75], v[48:51], a[128:143]
v_mfma_f32_32x32x16_bf16 a[144:159], v[76:79], v[48:51], a[144:159]
s_waitcnt lgkmcnt(0)
s_waitcnt vmcnt(14)
s_barrier
v_mfma_f32_32x32x16_bf16 a[0:15], v[80:83], v[52:55], a[0:15]
ds_read_b128 v[44:47], v100 offset:28672
ds_read_b128 v[48:51], v100 offset:30720
v_mfma_f32_32x32x16_bf16 a[16:31], v[84:87], v[52:55], a[16:31]
ds_read_b64_tr_b16 v[60:61], v102 offset:28672
ds_read_b64_tr_b16 v[62:63], v103 offset:28672
ds_read_b64_tr_b16 v[64:65], v106 offset:28672
ds_read_b64_tr_b16 v[66:67], v107 offset:28672
v_mfma_f32_32x32x16_bf16 a[32:47], v[88:91], v[52:55], a[32:47]
ds_read_b64_tr_b16 v[68:69], v102 offset:28800
ds_read_b64_tr_b16 v[70:71], v103 offset:28800
ds_read_b64_tr_b16 v[72:73], v106 offset:28800
ds_read_b64_tr_b16 v[74:75], v107 offset:28800
v_mfma_f32_32x32x16_bf16 a[48:63], v[92:95], v[52:55], a[48:63]
ds_read_b64_tr_b16 v[76:77], v102 offset:28928
ds_read_b64_tr_b16 v[78:79], v103 offset:28928
s_add_u32 m0, s45, 57344
s_nop 0
buffer_load_dwordx4 v21, s[20:23], s53 offen sc1 lds
v_mfma_f32_32x32x16_bf16 a[64:79], v[96:99], v[52:55], a[64:79]
s_add_u32 m0, s45, 58368
s_nop 0
buffer_load_dwordx4 v22, s[20:23], s53 offen sc1 lds
s_add_u32 m0, s45, 59392
s_nop 0
buffer_load_dwordx4 v23, s[20:23], s53 offen sc1 lds
v_mfma_f32_32x32x16_bf16 a[80:95], v[80:83], v[56:59], a[80:95]
s_add_u32 m0, s45, 60416
s_nop 0
buffer_load_dwordx4 v24, s[20:23], s53 offen sc1 lds
s_add_u32 m0, s46, 57344
s_nop 0
buffer_load_dwordx4 v31, s[32:35], s54 offen lds
v_mfma_f32_32x32x16_bf16 a[96:111], v[84:87], v[56:59], a[96:111]
s_add_u32 m0, s46, 58368
s_nop 0
buffer_load_dwordx4 v32, s[32:35], s54 offen lds
s_add_u32 m0, s46, 59392
s_nop 0
buffer_load_dwordx4 v33, s[32:35], s54 offen lds
s_add_u32 s53, s53, 16384
s_add_u32 s54, s54, s57
v_mfma_f32_32x32x16_bf16 a[112:127], v[88:91], v[56:59], a[112:127]
v_mfma_f32_32x32x16_bf16 a[128:143], v[92:95], v[56:59], a[128:143]
v_mfma_f32_32x32x16_bf16 a[144:159], v[96:99], v[56:59], a[144:159]
s_waitcnt lgkmcnt(0)
v_mfma_f32_32x32x16_bf16 a[0:15], v[60:63], v[44:47], a[0:15]
ds_read_b128 v[52:55], v101 offset:28672
v_mfma_f32_32x32x16_bf16 a[16:31], v[64:67], v[44:47], a[16:31]
ds_read_b128 v[56:59], v101 offset:30720
v_mfma_f32_32x32x16_bf16 a[32:47], v[68:71], v[44:47], a[32:47]
ds_read_b64_tr_b16 v[80:81], v104 offset:28672
ds_read_b64_tr_b16 v[82:83], v105 offset:28672
v_mfma_f32_32x32x16_bf16 a[48:63], v[72:75], v[44:47], a[48:63]
ds_read_b64_tr_b16 v[84:85], v108 offset:28672
ds_read_b64_tr_b16 v[86:87], v109 offset:28672
v_mfma_f32_32x32x16_bf16 a[64:79], v[76:79], v[44:47], a[64:79]
ds_read_b64_tr_b16 v[88:89], v104 offset:28800
ds_read_b64_tr_b16 v[90:91], v105 offset:28800
v_mfma_f32_32x32x16_bf16 a[80:95], v[60:63], v[48:51], a[80:95]
ds_read_b64_tr_b16 v[92:93], v108 offset:28800
ds_read_b64_tr_b16 v[94:95], v109 offset:28800
v_mfma_f32_32x32x16_bf16 a[96:111], v[64:67], v[48:51], a[96:111]
ds_read_b64_tr_b16 v[96:97], v104 offset:28928
ds_read_b64_tr_b16 v[98:99], v105 offset:28928
v_mfma_f32_32x32x16_bf16 a[112:127], v[68:71], v[48:51], a[112:127]
v_mfma_f32_32x32x16_bf16 a[128:143], v[72:75], v[48:51], a[128:143]
v_mfma_f32_32x32x16_bf16 a[144:159], v[76:79], v[48:51], a[144:159]
s_waitcnt lgkmcnt(0)
s_waitcnt vmcnt(14)
s_barrier
v_mfma_f32_32x32x16_bf16 a[0:15], v[80:83], v[52:55], a[0:15]
ds_read_b128 v[44:47], v34 offset:0
ds_read_b128 v[48:51], v34 offset:2048
v_mfma_f32_32x32x16_bf16 a[16:31], v[84:87], v[52:55], a[16:31]
ds_read_b64_tr_b16 v[60:61], v36 offset:0
ds_read_b64_tr_b16 v[62:63], v37 offset:0
ds_read_b64_tr_b16 v[64:65], v40 offset:0
ds_read_b64_tr_b16 v[66:67], v41 offset:0
v_mfma_f32_32x32x16_bf16 a[32:47], v[88:91], v[52:55], a[32:47]
ds_read_b64_tr_b16 v[68:69], v36 offset:128
ds_read_b64_tr_b16 v[70:71], v37 offset:128
ds_read_b64_tr_b16 v[72:73], v40 offset:128
ds_read_b64_tr_b16 v[74:75], v41 offset:128
v_mfma_f32_32x32x16_bf16 a[48:63], v[92:95], v[52:55], a[48:63]
ds_read_b64_tr_b16 v[76:77], v36 offset:256
ds_read_b64_tr_b16 v[78:79], v37 offset:256
s_add_u32 m0, s45, 86016
s_nop 0
buffer_load_dwordx4 v21, s[20:23], s53 offen sc1 lds
v_mfma_f32_32x32x16_bf16 a[64:79], v[96:99], v[52:55], a[64:79]
s_add_u32 m0, s45, 87040
s_nop 0
buffer_load_dwordx4 v22, s[20:23], s53 offen sc1 lds
s_add_u32 m0, s45, 88064
s_nop 0
buffer_load_dwordx4 v23, s[20:23], s53 offen sc1 lds
v_mfma_f32_32x32x16_bf16 a[80:95], v[80:83], v[56:59], a[80:95]
s_add_u32 m0, s45, 89088
s_nop 0
buffer_load_dwordx4 v24, s[20:23], s53 offen sc1 lds
s_add_u32 m0, s46, 86016
s_nop 0
buffer_load_dwordx4 v31, s[32:35], s54 offen lds
v_mfma_f32_32x32x16_bf16 a[96:111], v[84:87], v[56:59], a[96:111]
s_add_u32 m0, s46, 87040
s_nop 0
buffer_load_dwordx4 v32, s[32:35], s54 offen lds
s_add_u32 m0, s46, 88064
s_nop 0
buffer_load_dwordx4 v33, s[32:35], s54 offen lds
s_add_u32 s53, s53, 16384
s_add_u32 s54, s54, s57
v_mfma_f32_32x32x16_bf16 a[112:127], v[88:91], v[56:59], a[112:127]
v_mfma_f32_32x32x16_bf16 a[128:143], v[92:95], v[56:59], a[128:143]
v_mfma_f32_32x32x16_bf16 a[144:159], v[96:99], v[56:59], a[144:159]
s_sub_u32 s42, s42, 1
s_cmp_lg_u32 s42, 0
s_nop 9
s_cbranch_scc1 L_g2_wx_B
L_g2_wx_last_B:
s_waitcnt lgkmcnt(0)
v_mfma_f32_32x32x16_bf16 a[0:15], v[60:63], v[44:47], a[0:15]
ds_read_b128 v[52:55], v35 offset:0
v_mfma_f32_32x32x16_bf16 a[16:31], v[64:67], v[44:47], a[16:31]
ds_read_b128 v[56:59], v35 offset:2048
v_mfma_f32_32x32x16_bf16 a[32:47], v[68:71], v[44:47], a[32:47]
ds_read_b64_tr_b16 v[80:81], v38 offset:0
ds_read_b64_tr_b16 v[82:83], v39 offset:0
v_mfma_f32_32x32x16_bf16 a[48:63], v[72:75], v[44:47], a[48:63]
ds_read_b64_tr_b16 v[84:85], v42 offset:0
ds_read_b64_tr_b16 v[86:87], v43 offset:0
v_mfma_f32_32x32x16_bf16 a[64:79], v[76:79], v[44:47], a[64:79]
ds_read_b64_tr_b16 v[88:89], v38 offset:128
ds_read_b64_tr_b16 v[90:91], v39 offset:128
v_mfma_f32_32x32x16_bf16 a[80:95], v[60:63], v[48:51], a[80:95]
ds_read_b64_tr_b16 v[92:93], v42 offset:128
ds_read_b64_tr_b16 v[94:95], v43 offset:128
v_mfma_f32_32x32x16_bf16 a[96:111], v[64:67], v[48:51], a[96:111]
ds_read_b64_tr_b16 v[96:97], v38 offset:256
ds_read_b64_tr_b16 v[98:99], v39 offset:256
v_mfma_f32_32x32x16_bf16 a[112:127], v[68:71], v[48:51], a[112:127]
v_mfma_f32_32x32x16_bf16 a[128:143], v[72:75], v[48:51], a[128:143]
v_mfma_f32_32x32x16_bf16 a[144:159], v[76:79], v[48:51], a[144:159]
s_waitcnt lgkmcnt(0)
s_waitcnt vmcnt(14)
s_barrier
v_mfma_f32_32x32x16_bf16 a[0:15], v[80:83], v[52:55], a[0:15]
ds_read_b128 v[44:47], v34 offset:28672
v_mfma_f32_32x32x16_bf16 a[16:31], v[84:87], v[52:55], a[16:31]
ds_read_b128 v[48:51], v34 offset:30720
v_mfma_f32_32x32x16_bf16 a[32:47], v[88:91], v[52:55], a[32:47]
ds_read_b64_tr_b16 v[60:61], v36 offset:28672
ds_read_b64_tr_b16 v[62:63], v37 offset:28672
v_mfma_f32_32x32x16_bf16 a[48:63], v[92:95], v[52:55], a[48:63]
ds_read_b64_tr_b16 v[64:65], v40 offset:28672
ds_read_b64_tr_b16 v[66:67], v41 offset:28672
v_mfma_f32_32x32x16_bf16 a[64:79], v[96:99], v[52:55], a[64:79]
ds_read_b64_tr_b16 v[68:69], v36 offset:28800
ds_read_b64_tr_b16 v[70:71], v37 offset:28800
v_mfma_f32_32x32x16_bf16 a[80:95], v[80:83], v[56:59], a[80:95]
ds_read_b64_tr_b16 v[72:73], v40 offset:28800
ds_read_b64_tr_b16 v[74:75], v41 offset:28800
v_mfma_f32_32x32x16_bf16 a[96:111], v[84:87], v[56:59], a[96:111]
ds_read_b64_tr_b16 v[76:77], v36 offset:28928
ds_read_b64_tr_b16 v[78:79], v37 offset:28928
v_mfma_f32_32x32x16_bf16 a[112:127], v[88:91], v[56:59], a[112:127]
v_mfma_f32_32x32x16_bf16 a[128:143], v[92:95], v[56:59], a[128:143]
v_mfma_f32_32x32x16_bf16 a[144:159], v[96:99], v[56:59], a[144:159]
s_waitcnt lgkmcnt(0)
v_mfma_f32_32x32x16_bf16 a[0:15], v[60:63], v[44:47], a[0:15]
ds_read_b128 v[52:55], v35 offset:28672
v_mfma_f32_32x32x16_bf16 a[16:31], v[64:67], v[44:47], a[16:31]
ds_read_b128 v[56:59], v35 offset:30720
v_mfma_f32_32x32x16_bf16 a[32:47], v[68:71], v[44:47], a[32:47]
ds_read_b64_tr_b16 v[80:81], v38 offset:28672
ds_read_b64_tr_b16 v[82:83], v39 offset:28672
v_mfma_f32_32x32x16_bf16 a[48:63], v[72:75], v[44:47], a[48:63]
ds_read_b64_tr_b16 v[84:85], v42 offset:28672
ds_read_b64_tr_b16 v[86:87], v43 offset:28672
v_mfma_f32_32x32x16_bf16 a[64:79], v[76:79], v[44:47], a[64:79]
ds_read_b64_tr_b16 v[88:89], v38 offset:28800
ds_read_b64_tr_b16 v[90:91], v39 offset:28800
v_mfma_f32_32x32x16_bf16 a[80:95], v[60:63], v[48:51], a[80:95]
ds_read_b64_tr_b16 v[92:93], v42 offset:28800
ds_read_b64_tr_b16 v[94:95], v43 offset:28800
v_mfma_f32_32x32x16_bf16 a[96:111], v[64:67], v[48:51], a[96:111]
ds_read_b64_tr_b16 v[96:97], v38 offset:28928
ds_read_b64_tr_b16 v[98:99], v39 offset:28928
v_mfma_f32_32x32x16_bf16 a[112:127], v[68:71], v[48:51], a[112:127]
v_mfma_f32_32x32x16_bf16 a[128:143], v[72:75], v[48:51], a[128:143]
v_mfma_f32_32x32x16_bf16 a[144:159], v[76:79], v[48:51], a[144:159]
s_waitcnt lgkmcnt(0)
s_waitcnt vmcnt(7)
s_barrier
v_mfma_f32_32x32x16_bf16 a[0:15], v[80:83], v[52:55], a[0:15]
ds_read_b128 v[44:47], v100 offset:0
v_mfma_f32_32x32x16_bf16 a[16:31], v[84:87], v[52:55], a[16:31]
ds_read_b128 v[48:51], v100 offset:2048
v_mfma_f32_32x32x16_bf16 a[32:47], v[88:91], v[52:55], a[32:47]
ds_read_b64_tr_b16 v[60:61], v102 offset:0
ds_read_b64_tr_b16 v[62:63], v103 offset:0
v_mfma_f32_32x32x16_bf16 a[48:63], v[92:95], v[52:55], a[48:63]
ds_read_b64_tr_b16 v[64:65], v106 offset:0
ds_read_b64_tr_b16 v[66:67], v107 offset:0
v_mfma_f32_32x32x16_bf16 a[64:79], v[96:99], v[52:55], a[64:79]
ds_read_b64_tr_b16 v[68:69], v102 offset:128
ds_read_b64_tr_b16 v[70:71], v103 offset:128
v_mfma_f32_32x32x16_bf16 a[80:95], v[80:83], v[56:59], a[80:95]
ds_read_b64_tr_b16 v[72:73], v106 offset:128
ds_read_b64_tr_b16 v[74:75], v107 offset:128
v_mfma_f32_32x32x16_bf16 a[96:111], v[84:87], v[56:59], a[96:111]
ds_read_b64_tr_b16 v[76:77], v102 offset:256
ds_read_b64_tr_b16 v[78:79], v103 offset:256
v_mfma_f32_32x32x16_bf16 a[112:127], v[88:91], v[56:59], a[112:127]
v_mfma_f32_32x32x16_bf16 a[128:143], v[92:95], v[56:59], a[128:143]
v_mfma_f32_32x32x16_bf16 a[144:159], v[96:99], v[56:59], a[144:159]
s_waitcnt lgkmcnt(0)
v_mfma_f32_32x32x16_bf16 a[0:15], v[60:63], v[44:47], a[0:15]
ds_read_b128 v[52:55], v101 offset:0
v_mfma_f32_32x32x16_bf16 a[16:31], v[64:67], v[44:47], a[16:31]
ds_read_b128 v[56:59], v101 offset:2048
v_mfma_f32_32x32x16_bf16 a[32:47], v[68:71], v[44:47], a[32:47]
ds_read_b64_tr_b16 v[80:81], v104 offset:0
ds_read_b64_tr_b16 v[82:83], v105 offset:0
v_mfma_f32_32x32x16_bf16 a[48:63], v[72:75], v[44:47], a[48:63]
ds_read_b64_tr_b16 v[84:85], v108 offset:0
ds_read_b64_tr_b16 v[86:87], v109 offset:0
v_mfma_f32_32x32x16_bf16 a[64:79], v[76:79], v[44:47], a[64:79]
ds_read_b64_tr_b16 v[88:89], v104 offset:128
ds_read_b64_tr_b16 v[90:91], v105 offset:128
v_mfma_f32_32x32x16_bf16 a[80:95], v[60:63], v[48:51], a[80:95]
ds_read_b64_tr_b16 v[92:93], v108 offset:128
ds_read_b64_tr_b16 v[94:95], v109 offset:128
v_mfma_f32_32x32x16_bf16 a[96:111], v[64:67], v[48:51], a[96:111]
ds_read_b64_tr_b16 v[96:97], v104 offset:256
ds_read_b64_tr_b16 v[98:99], v105 offset:256
v_mfma_f32_32x32x16_bf16 a[112:127], v[68:71], v[48:51], a[112:127]
v_mfma_f32_32x32x16_bf16 a[128:143], v[72:75], v[48:51], a[128:143]
v_mfma_f32_32x32x16_bf16 a[144:159], v[76:79], v[48:51], a[144:159]
s_waitcnt lgkmcnt(0)
s_waitcnt vmcnt(0)
s_barrier
v_mfma_f32_32x32x16_bf16 a[0:15], v[80:83], v[52:55], a[0:15]
ds_read_b128 v[44:47], v100 offset:28672
v_mfma_f32_32x32x16_bf16 a[16:31], v[84:87], v[52:55], a[16:31]
ds_read_b128 v[48:51], v100 offset:30720
v_mfma_f32_32x32x16_bf16 a[32:47], v[88:91], v[52:55], a[32:47]
ds_read_b64_tr_b16 v[60:61], v102 offset:28672
ds_read_b64_tr_b16 v[62:63], v103 offset:28672
v_mfma_f32_32x32x16_bf16 a[48:63], v[92:95], v[52:55], a[48:63]
ds_read_b64_tr_b16 v[64:65], v106 offset:28672
ds_read_b64_tr_b16 v[66:67], v107 offset:28672
v_mfma_f32_32x32x16_bf16 a[64:79], v[96:99], v[52:55], a[64:79]
ds_read_b64_tr_b16 v[68:69], v102 offset:28800
ds_read_b64_tr_b16 v[70:71], v103 offset:28800
v_mfma_f32_32x32x16_bf16 a[80:95], v[80:83], v[56:59], a[80:95]
ds_read_b64_tr_b16 v[72:73], v106 offset:28800
ds_read_b64_tr_b16 v[74:75], v107 offset:28800
v_mfma_f32_32x32x16_bf16 a[96:111], v[84:87], v[56:59], a[96:111]
ds_read_b64_tr_b16 v[76:77], v102 offset:28928
ds_read_b64_tr_b16 v[78:79], v103 offset:28928
v_mfma_f32_32x32x16_bf16 a[112:127], v[88:91], v[56:59], a[112:127]
v_mfma_f32_32x32x16_bf16 a[128:143], v[92:95], v[56:59], a[128:143]
v_mfma_f32_32x32x16_bf16 a[144:159], v[96:99], v[56:59], a[144:159]
s_waitcnt lgkmcnt(0)
v_mfma_f32_32x32x16_bf16 a[0:15], v[60:63], v[44:47], a[0:15]
ds_read_b128 v[52:55], v101 offset:28672
v_mfma_f32_32x32x16_bf16 a[16:31], v[64:67], v[44:47], a[16:31]
ds_read_b128 v[56:59], v101 offset:30720
v_mfma_f32_32x32x16_bf16 a[32:47], v[68:71], v[44:47], a[32:47]
ds_read_b64_tr_b16 v[80:81], v104 offset:28672
ds_read_b64_tr_b16 v[82:83], v105 offset:28672
v_mfma_f32_32x32x16_bf16 a[48:63], v[72:75], v[44:47], a[48:63]
ds_read_b64_tr_b16 v[84:85], v108 offset:28672
ds_read_b64_tr_b16 v[86:87], v109 offset:28672
v_mfma_f32_32x32x16_bf16 a[64:79], v[76:79], v[44:47], a[64:79]
ds_read_b64_tr_b16 v[88:89], v104 offset:28800
ds_read_b64_tr_b16 v[90:91], v105 offset:28800
v_mfma_f32_32x32x16_bf16 a[80:95], v[60:63], v[48:51], a[80:95]
ds_read_b64_tr_b16 v[92:93], v108 offset:28800
ds_read_b64_tr_b16 v[94:95], v109 offset:28800
v_mfma_f32_32x32x16_bf16 a[96:111], v[64:67], v[48:51], a[96:111]
ds_read_b64_tr_b16 v[96:97], v104 offset:28928
ds_read_b64_tr_b16 v[98:99], v105 offset:28928
v_mfma_f32_32x32x16_bf16 a[112:127], v[68:71], v[48:51], a[112:127]
v_mfma_f32_32x32x16_bf16 a[128:143], v[72:75], v[48:51], a[128:143]
v_mfma_f32_32x32x16_bf16 a[144:159], v[76:79], v[48:51], a[144:159]
s_waitcnt lgkmcnt(0)
s_waitcnt vmcnt(0)
s_barrier
v_mfma_f32_32x32x16_bf16 a[0:15], v[80:83], v[52:55], a[0:15]
v_mfma_f32_32x32x16_bf16 a[16:31], v[84:87], v[52:55], a[16:31]
v_mfma_f32_32x32x16_bf16 a[32:47], v[88:91], v[52:55], a[32:47]
v_mfma_f32_32x32x16_bf16 a[48:63], v[92:95], v[52:55], a[48:63]
v_mfma_f32_32x32x16_bf16 a[64:79], v[96:99], v[52:55], a[64:79]
v_mfma_f32_32x32x16_bf16 a[80:95], v[80:83], v[56:59], a[80:95]
v_mfma_f32_32x32x16_bf16 a[96:111], v[84:87], v[56:59], a[96:111]
v_mfma_f32_32x32x16_bf16 a[112:127], v[88:91], v[56:59], a[112:127]
v_mfma_f32_32x32x16_bf16 a[128:143], v[92:95], v[56:59], a[128:143]
v_mfma_f32_32x32x16_bf16 a[144:159], v[96:99], v[56:59], a[144:159]
s_nop 11
s_lshl_b32 s60, s51, 2
s_add_u32 s60, s60, s28
s_mul_i32 s60, s60, 40960
s_add_u32 s40, s96, s60
v_accvgpr_read_b32 v112, a0
v_accvgpr_read_b32 v113, a1
v_accvgpr_read_b32 v114, a2
v_accvgpr_read_b32 v115, a3
v_accvgpr_read_b32 v116, a4
v_accvgpr_read_b32 v117, a5
v_accvgpr_read_b32 v118, a6
v_accvgpr_read_b32 v119, a7
v_accvgpr_read_b32 v120, a8
v_accvgpr_read_b32 v121, a9
v_accvgpr_read_b32 v122, a10
v_accvgpr_read_b32 v123, a11
v_accvgpr_read_b32 v124, a12
v_accvgpr_read_b32 v125, a13
v_accvgpr_read_b32 v126, a14
v_accvgpr_read_b32 v127, a15
s_add_u32 s41, s40, 0
buffer_store_dwordx4 v[112:115], v128, s[20:23], s41 offen offset:0 sc1
buffer_store_dwordx4 v[116:119], v128, s[20:23], s41 offen offset:1024 sc1
buffer_store_dwordx4 v[120:123], v128, s[20:23], s41 offen offset:2048 sc1
buffer_store_dwordx4 v[124:127], v128, s[20:23], s41 offen offset:3072 sc1
v_accvgpr_read_b32 v112, a16
v_accvgpr_read_b32 v113, a17
v_accvgpr_read_b32 v114, a18
v_accvgpr_read_b32 v115, a19
v_accvgpr_read_b32 v116, a20
v_accvgpr_read_b32 v117, a21
v_accvgpr_read_b32 v118, a22
v_accvgpr_read_b32 v119, a23
v_accvgpr_read_b32 v120, a24
v_accvgpr_read_b32 v121, a25
v_accvgpr_read_b32 v122, a26
v_accvgpr_read_b32 v123, a27
v_accvgpr_read_b32 v124, a28
v_accvgpr_read_b32 v125, a29
v_accvgpr_read_b32 v126, a30
v_accvgpr_read_b32 v127, a31
s_add_u32 s41, s40, 4096
buffer_store_dwordx4 v[112:115], v128, s[20:23], s41 offen offset:0 sc1
buffer_store_dwordx4 v[116:119], v128, s[20:23], s41 offen offset:1024 sc1
buffer_store_dwordx4 v[120:123], v128, s[20:23], s41 offen offset:2048 sc1
buffer_store_dwordx4 v[124:127], v128, s[20:23], s41 offen offset:3072 sc1
v_accvgpr_read_b32 v112, a32
v_accvgpr_read_b32 v113, a33
v_accvgpr_read_b32 v114, a34
v_accvgpr_read_b32 v115, a35
v_accvgpr_read_b32 v116, a36
v_accvgpr_read_b32 v117, a37
v_accvgpr_read_b32 v118, a38
v_accvgpr_read_b32 v119, a39
v_accvgpr_read_b32 v120, a40
v_accvgpr_read_b32 v121, a41
v_accvgpr_read_b32 v122, a42
v_accvgpr_read_b32 v123, a43
v_accvgpr_read_b32 v124, a44
v_accvgpr_read_b32 v125, a45
v_accvgpr_read_b32 v126, a46
v_accvgpr_read_b32 v127, a47
s_add_u32 s41, s40, 8192
buffer_store_dwordx4 v[112:115], v128, s[20:23], s41 offen offset:0 sc1
buffer_store_dwordx4 v[116:119], v128, s[20:23], s41 offen offset:1024 sc1
buffer_store_dwordx4 v[120:123], v128, s[20:23], s41 offen offset:2048 sc1
buffer_store_dwordx4 v[124:127], v128, s[20:23], s41 offen offset:3072 sc1
v_accvgpr_read_b32 v112, a48
v_accvgpr_read_b32 v113, a49
v_accvgpr_read_b32 v114, a50
v_accvgpr_read_b32 v115, a51
v_accvgpr_read_b32 v116, a52
v_accvgpr_read_b32 v117, a53
v_accvgpr_read_b32 v118, a54
v_accvgpr_read_b32 v119, a55
v_accvgpr_read_b32 v120, a56
v_accvgpr_read_b32 v121, a57
v_accvgpr_read_b32 v122, a58
v_accvgpr_read_b32 v123, a59
v_accvgpr_read_b32 v124, a60
v_accvgpr_read_b32 v125, a61
v_accvgpr_read_b32 v126, a62
v_accvgpr_read_b32 v127, a63
s_add_u32 s41, s40, 12288
buffer_store_dwordx4 v[112:115], v128, s[20:23], s41 offen offset:0 sc1
buffer_store_dwordx4 v[116:119], v128, s[20:23], s41 offen offset:1024 sc1
buffer_store_dwordx4 v[120:123], v128, s[20:23], s41 offen offset:2048 sc1
buffer_store_dwordx4 v[124:127], v128, s[20:23], s41 offen offset:3072 sc1
v_accvgpr_read_b32 v112, a64
v_accvgpr_read_b32 v113, a65
v_accvgpr_read_b32 v114, a66
v_accvgpr_read_b32 v115, a67
v_accvgpr_read_b32 v116, a68
v_accvgpr_read_b32 v117, a69
v_accvgpr_read_b32 v118, a70
v_accvgpr_read_b32 v119, a71
v_accvgpr_read_b32 v120, a72
v_accvgpr_read_b32 v121, a73
v_accvgpr_read_b32 v122, a74
v_accvgpr_read_b32 v123, a75
v_accvgpr_read_b32 v124, a76
v_accvgpr_read_b32 v125, a77
v_accvgpr_read_b32 v126, a78
v_accvgpr_read_b32 v127, a79
s_add_u32 s41, s40, 16384
buffer_store_dwordx4 v[112:115], v128, s[20:23], s41 offen offset:0 sc1
buffer_store_dwordx4 v[116:119], v128, s[20:23], s41 offen offset:1024 sc1
buffer_store_dwordx4 v[120:123], v128, s[20:23], s41 offen offset:2048 sc1
buffer_store_dwordx4 v[124:127], v128, s[20:23], s41 offen offset:3072 sc1
v_accvgpr_read_b32 v112, a80
v_accvgpr_read_b32 v113, a81
v_accvgpr_read_b32 v114, a82
v_accvgpr_read_b32 v115, a83
v_accvgpr_read_b32 v116, a84
v_accvgpr_read_b32 v117, a85
v_accvgpr_read_b32 v118, a86
v_accvgpr_read_b32 v119, a87
v_accvgpr_read_b32 v120, a88
v_accvgpr_read_b32 v121, a89
v_accvgpr_read_b32 v122, a90
v_accvgpr_read_b32 v123, a91
v_accvgpr_read_b32 v124, a92
v_accvgpr_read_b32 v125, a93
v_accvgpr_read_b32 v126, a94
v_accvgpr_read_b32 v127, a95
s_add_u32 s41, s40, 20480
buffer_store_dwordx4 v[112:115], v128, s[20:23], s41 offen offset:0 sc1
buffer_store_dwordx4 v[116:119], v128, s[20:23], s41 offen offset:1024 sc1
buffer_store_dwordx4 v[120:123], v128, s[20:23], s41 offen offset:2048 sc1
buffer_store_dwordx4 v[124:127], v128, s[20:23], s41 offen offset:3072 sc1
v_accvgpr_read_b32 v112, a96
v_accvgpr_read_b32 v113, a97
v_accvgpr_read_b32 v114, a98
v_accvgpr_read_b32 v115, a99
v_accvgpr_read_b32 v116, a100
v_accvgpr_read_b32 v117, a101
v_accvgpr_read_b32 v118, a102
v_accvgpr_read_b32 v119, a103
v_accvgpr_read_b32 v120, a104
v_accvgpr_read_b32 v121, a105
v_accvgpr_read_b32 v122, a106
v_accvgpr_read_b32 v123, a107
v_accvgpr_read_b32 v124, a108
v_accvgpr_read_b32 v125, a109
v_accvgpr_read_b32 v126, a110
v_accvgpr_read_b32 v127, a111
s_add_u32 s41, s40, 24576
buffer_store_dwordx4 v[112:115], v128, s[20:23], s41 offen offset:0 sc1
buffer_store_dwordx4 v[116:119], v128, s[20:23], s41 offen offset:1024 sc1
buffer_store_dwordx4 v[120:123], v128, s[20:23], s41 offen offset:2048 sc1
buffer_store_dwordx4 v[124:127], v128, s[20:23], s41 offen offset:3072 sc1
v_accvgpr_read_b32 v112, a112
v_accvgpr_read_b32 v113, a113
v_accvgpr_read_b32 v114, a114
v_accvgpr_read_b32 v115, a115
v_accvgpr_read_b32 v116, a116
v_accvgpr_read_b32 v117, a117
v_accvgpr_read_b32 v118, a118
v_accvgpr_read_b32 v119, a119
v_accvgpr_read_b32 v120, a120
v_accvgpr_read_b32 v121, a121
v_accvgpr_read_b32 v122, a122
v_accvgpr_read_b32 v123, a123
v_accvgpr_read_b32 v124, a124
v_accvgpr_read_b32 v125, a125
v_accvgpr_read_b32 v126, a126
v_accvgpr_read_b32 v127, a127
s_add_u32 s41, s40, 28672
buffer_store_dwordx4 v[112:115], v128, s[20:23], s41 offen offset:0 sc1
buffer_store_dwordx4 v[116:119], v128, s[20:23], s41 offen offset:1024 sc1
buffer_store_dwordx4 v[120:123], v128, s[20:23], s41 offen offset:2048 sc1
buffer_store_dwordx4 v[124:127], v128, s[20:23], s41 offen offset:3072 sc1
v_accvgpr_read_b32 v112, a128
v_accvgpr_read_b32 v113, a129
v_accvgpr_read_b32 v114, a130
v_accvgpr_read_b32 v115, a131
v_accvgpr_read_b32 v116, a132
v_accvgpr_read_b32 v117, a133
v_accvgpr_read_b32 v118, a134
v_accvgpr_read_b32 v119, a135
v_accvgpr_read_b32 v120, a136
v_accvgpr_read_b32 v121, a137
v_accvgpr_read_b32 v122, a138
v_accvgpr_read_b32 v123, a139
v_accvgpr_read_b32 v124, a140
v_accvgpr_read_b32 v125, a141
v_accvgpr_read_b32 v126, a142
v_accvgpr_read_b32 v127, a143
s_add_u32 s41, s40, 32768
buffer_store_dwordx4 v[112:115], v128, s[20:23], s41 offen offset:0 sc1
buffer_store_dwordx4 v[116:119], v128, s[20:23], s41 offen offset:1024 sc1
buffer_store_dwordx4 v[120:123], v128, s[20:23], s41 offen offset:2048 sc1
buffer_store_dwordx4 v[124:127], v128, s[20:23], s41 offen offset:3072 sc1
v_accvgpr_read_b32 v112, a144
v_accvgpr_read_b32 v113, a145
v_accvgpr_read_b32 v114, a146
v_accvgpr_read_b32 v115, a147
v_accvgpr_read_b32 v116, a148
v_accvgpr_read_b32 v117, a149
v_accvgpr_read_b32 v118, a150
v_accvgpr_read_b32 v119, a151
v_accvgpr_read_b32 v120, a152
v_accvgpr_read_b32 v121, a153
v_accvgpr_read_b32 v122, a154
v_accvgpr_read_b32 v123, a155
v_accvgpr_read_b32 v124, a156
v_accvgpr_read_b32 v125, a157
v_accvgpr_read_b32 v126, a158
v_accvgpr_read_b32 v127, a159
s_add_u32 s41, s40, 36864
buffer_store_dwordx4 v[112:115], v128, s[20:23], s41 offen offset:0 sc1
buffer_store_dwordx4 v[116:119], v128, s[20:23], s41 offen offset:1024 sc1
buffer_store_dwordx4 v[120:123], v128, s[20:23], s41 offen offset:2048 sc1
buffer_store_dwordx4 v[124:127], v128, s[20:23], s41 offen offset:3072 sc1
s_lshl_b32 s60, s52, 6
s_add_u32 s60, s60, 178479616
s_waitcnt vmcnt(0)
s_barrier
s_cmp_lg_u32 s28, 0
s_cbranch_scc1 L_sig_21_B
s_mov_b64 exec, 1
v_mov_b32 v17, s60
buffer_atomic_add v16, v17, s[20:23], 0 offen sc1
s_mov_b64 exec, -1
L_sig_21_B:
s_cmp_eq_u32 s99, 1
s_cbranch_scc1 L_b_task_B
L_b_final_B:
s_lshl_b32 s60, s52, 6
s_add_u32 s60, s60, 178479616
s_cmp_eq_u32 s98, 1
s_cbranch_scc1 L_b_fw120_B
s_cmp_lg_u32 s28, 0
s_cbranch_scc1 L_wc_22x_B
v_mov_b32 v17, s60
s_nop 1
L_wc_22_B:
buffer_load_dword v18, v17, s[20:23], 0 offen sc1
s_waitcnt vmcnt(0)
v_readfirstlane_b32 s41, v18
s_add_u32 s64, s64, 1
s_cmp_gt_u32 s64, 2000000
s_cbranch_scc1 L_w_done_B
s_cmp_ge_u32 s41, 40
s_cbranch_scc1 L_wc_22x_B
s_cmp_eq_u32 s98, 1
s_cbranch_scc1 L_sl_23_B
s_sleep 40
L_sl_23_B:
s_sleep 4
s_branch L_wc_22_B
L_wc_22x_B:
s_barrier
s_branch L_b_fgo_B
L_b_fw120_B:
s_cmp_lg_u32 s28, 0
s_cbranch_scc1 L_wc_24x_B
v_mov_b32 v17, s60
s_nop 1
L_wc_24_B:
buffer_load_dword v18, v17, s[20:23], 0 offen sc1
s_waitcnt vmcnt(0)
v_readfirstlane_b32 s41, v18
s_add_u32 s64, s64, 1
s_cmp_gt_u32 s64, 2000000
s_cbranch_scc1 L_w_done_B
s_cmp_ge_u32 s41, 104
s_cbranch_scc1 L_wc_24x_B
s_cmp_eq_u32 s98, 1
s_cbranch_scc1 L_sl_25_B
s_sleep 40
L_sl_25_B:
s_sleep 4
s_branch L_wc_24_B
L_wc_24x_B:
s_barrier
L_b_fgo_B:
s_mov_b32 s80, s72
s_mov_b32 s81, s73
s_mov_b32 s82, 2621440
s_mov_b32 s83, 0x00020000
s_mov_b32 s84, s70
s_mov_b32 s85, s71
s_mov_b32 s86, 1280
s_mov_b32 s87, 0x00020000
s_mov_b32 s88, s74
s_mov_b32 s89, s75
s_mov_b32 s90, 2621440
s_mov_b32 s91, 0x00020000
v_and_b32 v134, 31, v1
v_mul_u32_u24 v134, 1280, v134
v_lshrrev_b32 v135, 5, v1
v_lshlrev_b32 v135, 3, v135
s_cmp_eq_u32 s98, 1
s_cbranch_scc1 L_f_fine_B
s_lshl_b32 s101, s65, 3
s_add_u32 s101, s101, s29
s_mul_i32 s101, s101, 20
s_add_u32 s101, s101, s28
s_add_u32 s100, s101, 0
s_mul_i32 s40, s52, 655360
s_add_u32 s40, s40, 126038016
s_lshl_b32 s41, s100, 10
s_add_u32 s40, s40, s41
buffer_load_dwordx4 v[136:139], v128, s[20:23], s40 offen sc1
s_mul_i32 s40, s52, 655360
s_add_u32 s40, s40, 131280896
s_lshl_b32 s41, s100, 10
s_add_u32 s40, s40, s41
buffer_load_dwordx4 v[140:143], v128, s[20:23], s40 offen sc1
s_mul_i32 s40, s52, 655360
s_add_u32 s40, s40, 136523776
s_lshl_b32 s41, s100, 10
s_add_u32 s40, s40, s41
buffer_load_dwordx4 v[144:147], v128, s[20:23], s40 offen sc1
s_mul_i32 s40, s52, 655360
s_add_u32 s40, s40, 141766656
s_lshl_b32 s41, s100, 10
s_add_u32 s40, s40, s41
buffer_load_dwordx4 v[148:151], v128, s[20:23], s40 offen sc1
s_mul_i32 s40, s52, 655360
s_add_u32 s40, s40, 147009536
s_lshl_b32 s41, s100, 10
s_add_u32 s40, s40, s41
buffer_load_dwordx4 v[152:155], v128, s[20:23], s40 offen sc1
s_mul_i32 s40, s52, 655360
s_add_u32 s40, s40, 152252416
s_lshl_b32 s41, s100, 10
s_add_u32 s40, s40, s41
buffer_load_dwordx4 v[156:159], v128, s[20:23], s40 offen sc1
s_mul_i32 s40, s52, 655360
s_add_u32 s40, s40, 157495296
s_lshl_b32 s41, s100, 10
s_add_u32 s40, s40, s41
buffer_load_dwordx4 v[160:163], v128, s[20:23], s40 offen sc1
s_mul_i32 s40, s52, 655360
s_add_u32 s40, s40, 162738176
s_lshl_b32 s41, s100, 10
s_add_u32 s40, s40, s41
buffer_load_dwordx4 v[164:167], v128, s[20:23], s40 offen sc1
s_mul_i32 s40, s52, 655360
s_add_u32 s40, s40, 167981056
s_lshl_b32 s41, s100, 10
s_add_u32 s40, s40, s41
buffer_load_dwordx4 v[168:171], v128, s[20:23], s40 offen sc1
s_mul_i32 s40, s52, 655360
s_add_u32 s40, s40, 173223936
s_lshl_b32 s41, s100, 10
s_add_u32 s40, s40, s41
buffer_load_dwordx4 v[172:175], v128, s[20:23], s40 offen sc1
s_and_b32 s60, s100, 3
s_lshr_b32 s61, s100, 2
s_mul_i32 s40, s61, 52429
s_lshr_b32 s40, s40, 18
s_mul_i32 s41, s40, 5
s_sub_u32 s61, s61, s41
s_lshl_b32 s61, s61, 5
s_lshl_b32 s60, s60, 3
s_add_u32 s61, s61, s60
s_lshr_b32 s41, s40, 3
s_mul_i32 s41, s41, 160
s_add_u32 s61, s61, s41
s_lshl_b32 s61, s61, 1
s_and_b32 s40, s40, 7
s_lshl_b32 s40, s40, 5
s_lshl_b32 s41, s52, 8
s_add_u32 s40, s40, s41
s_mul_i32 s40, s40, 1280
v_add_u32 v181, s61, v135
v_add3_u32 v180, v134, v181, s40
buffer_load_dwordx2 v[176:177], v180, s[80:83], 0 offen
buffer_load_dwordx2 v[178:179], v181, s[84:87], 0 offen
s_add_u32 s100, s101, 4
s_mul_i32 s40, s52, 655360
s_add_u32 s40, s40, 126038016
s_lshl_b32 s41, s100, 10
s_add_u32 s40, s40, s41
buffer_load_dwordx4 v[184:187], v128, s[20:23], s40 offen sc1
s_mul_i32 s40, s52, 655360
s_add_u32 s40, s40, 131280896
s_lshl_b32 s41, s100, 10
s_add_u32 s40, s40, s41
buffer_load_dwordx4 v[188:191], v128, s[20:23], s40 offen sc1
s_mul_i32 s40, s52, 655360
s_add_u32 s40, s40, 136523776
s_lshl_b32 s41, s100, 10
s_add_u32 s40, s40, s41
buffer_load_dwordx4 v[192:195], v128, s[20:23], s40 offen sc1
s_mul_i32 s40, s52, 655360
s_add_u32 s40, s40, 141766656
s_lshl_b32 s41, s100, 10
s_add_u32 s40, s40, s41
buffer_load_dwordx4 v[196:199], v128, s[20:23], s40 offen sc1
s_mul_i32 s40, s52, 655360
s_add_u32 s40, s40, 147009536
s_lshl_b32 s41, s100, 10
s_add_u32 s40, s40, s41
buffer_load_dwordx4 v[200:203], v128, s[20:23], s40 offen sc1
s_mul_i32 s40, s52, 655360
s_add_u32 s40, s40, 152252416
s_lshl_b32 s41, s100, 10
s_add_u32 s40, s40, s41
buffer_load_dwordx4 v[204:207], v128, s[20:23], s40 offen sc1
s_mul_i32 s40, s52, 655360
s_add_u32 s40, s40, 157495296
s_lshl_b32 s41, s100, 10
s_add_u32 s40, s40, s41
buffer_load_dwordx4 v[208:211], v128, s[20:23], s40 offen sc1
s_mul_i32 s40, s52, 655360
s_add_u32 s40, s40, 162738176
s_lshl_b32 s41, s100, 10
s_add_u32 s40, s40, s41
buffer_load_dwordx4 v[212:215], v128, s[20:23], s40 offen sc1
s_mul_i32 s40, s52, 655360
s_add_u32 s40, s40, 167981056
s_lshl_b32 s41, s100, 10
s_add_u32 s40, s40, s41
buffer_load_dwordx4 v[216:219], v128, s[20:23], s40 offen sc1
s_mul_i32 s40, s52, 655360
s_add_u32 s40, s40, 173223936
s_lshl_b32 s41, s100, 10
s_add_u32 s40, s40, s41
buffer_load_dwordx4 v[220:223], v128, s[20:23], s40 offen sc1
s_and_b32 s60, s100, 3
s_lshr_b32 s61, s100, 2
s_mul_i32 s40, s61, 52429
s_lshr_b32 s40, s40, 18
s_mul_i32 s41, s40, 5
s_sub_u32 s61, s61, s41
s_lshl_b32 s61, s61, 5
s_lshl_b32 s60, s60, 3
s_add_u32 s61, s61, s60
s_lshr_b32 s41, s40, 3
s_mul_i32 s41, s41, 160
s_add_u32 s61, s61, s41
s_lshl_b32 s61, s61, 1
s_and_b32 s40, s40, 7
s_lshl_b32 s40, s40, 5
s_lshl_b32 s41, s52, 8
s_add_u32 s40, s40, s41
s_mul_i32 s40, s40, 1280
v_add_u32 v229, s61, v135
v_add3_u32 v228, v134, v229, s40
buffer_load_dwordx2 v[224:225], v228, s[80:83], 0 offen
buffer_load_dwordx2 v[226:227], v229, s[84:87], 0 offen
s_waitcnt vmcnt(0)
v_pk_add_f32 v[136:137], v[136:137], v[164:165]
v_pk_add_f32 v[138:139], v[138:139], v[166:167]
v_pk_add_f32 v[140:141], v[140:141], v[160:161]
v_pk_add_f32 v[142:143], v[142:143], v[162:163]
v_pk_add_f32 v[144:145], v[144:145], v[156:157]
v_pk_add_f32 v[146:147], v[146:147], v[158:159]
v_pk_add_f32 v[148:149], v[148:149], v[152:153]
v_pk_add_f32 v[150:151], v[150:151], v[154:155]
v_pk_add_f32 v[136:137], v[136:137], v[148:149]
v_pk_add_f32 v[138:139], v[138:139], v[150:151]
v_pk_add_f32 v[140:141], v[140:141], v[144:145]
v_pk_add_f32 v[142:143], v[142:143], v[146:147]
v_pk_add_f32 v[136:137], v[136:137], v[140:141]
v_pk_add_f32 v[138:139], v[138:139], v[142:143]
v_pk_add_f32 v[168:169], v[168:169], v[172:173]
v_pk_add_f32 v[170:171], v[170:171], v[174:175]
v_cvt_pk_bf16_f32 v12, v136, v137
v_lshlrev_b32 v136, 16, v12
v_and_b32 v137, 0xffff0000, v12
v_cvt_pk_bf16_f32 v12, v138, v139
v_lshlrev_b32 v138, 16, v12
v_and_b32 v139, 0xffff0000, v12
v_cvt_pk_bf16_f32 v12, v168, v169
v_lshlrev_b32 v168, 16, v12
v_and_b32 v169, 0xffff0000, v12
v_cvt_pk_bf16_f32 v12, v170, v171
v_lshlrev_b32 v170, 16, v12
v_and_b32 v171, 0xffff0000, v12
v_lshlrev_b32 v4, 16, v176
v_and_b32 v5, 0xffff0000, v176
v_lshlrev_b32 v6, 16, v177
v_and_b32 v7, 0xffff0000, v177
v_lshlrev_b32 v8, 16, v178
v_and_b32 v9, 0xffff0000, v178
v_lshlrev_b32 v10, 16, v179
v_and_b32 v11, 0xffff0000, v179
v_add_f32 v136, v4, v136
v_add_f32 v168, v168, v8
v_add_f32 v137, v5, v137
v_add_f32 v169, v169, v9
v_add_f32 v138, v6, v138
v_add_f32 v170, v170, v10
v_add_f32 v139, v7, v139
v_add_f32 v171, v171, v11
v_cvt_pk_bf16_f32 v12, v136, v137
v_lshlrev_b32 v136, 16, v12
v_and_b32 v137, 0xffff0000, v12
v_cvt_pk_bf16_f32 v12, v138, v139
v_lshlrev_b32 v138, 16, v12
v_and_b32 v139, 0xffff0000, v12
v_cvt_pk_bf16_f32 v12, v168, v169
v_lshlrev_b32 v168, 16, v12
v_and_b32 v169, 0xffff0000, v12
v_cvt_pk_bf16_f32 v12, v170, v171
v_lshlrev_b32 v170, 16, v12
v_and_b32 v171, 0xffff0000, v12
v_add_f32 v136, v136, v168
v_add_f32 v137, v137, v169
v_add_f32 v138, v138, v170
v_add_f32 v139, v139, v171
v_cvt_pk_bf16_f32 v12, v136, v137
v_cvt_pk_bf16_f32 v13, v138, v139
buffer_store_dwordx2 v[12:13], v180, s[88:91], 0 offen
v_pk_add_f32 v[184:185], v[184:185], v[212:213]
v_pk_add_f32 v[186:187], v[186:187], v[214:215]
v_pk_add_f32 v[188:189], v[188:189], v[208:209]
v_pk_add_f32 v[190:191], v[190:191], v[210:211]
v_pk_add_f32 v[192:193], v[192:193], v[204:205]
v_pk_add_f32 v[194:195], v[194:195], v[206:207]
v_pk_add_f32 v[196:197], v[196:197], v[200:201]
v_pk_add_f32 v[198:199], v[198:199], v[202:203]
v_pk_add_f32 v[184:185], v[184:185], v[196:197]
v_pk_add_f32 v[186:187], v[186:187], v[198:199]
v_pk_add_f32 v[188:189], v[188:189], v[192:193]
v_pk_add_f32 v[190:191], v[190:191], v[194:195]
v_pk_add_f32 v[184:185], v[184:185], v[188:189]
v_pk_add_f32 v[186:187], v[186:187], v[190:191]
v_pk_add_f32 v[216:217], v[216:217], v[220:221]
v_pk_add_f32 v[218:219], v[218:219], v[222:223]
v_cvt_pk_bf16_f32 v12, v184, v185
v_lshlrev_b32 v184, 16, v12
v_and_b32 v185, 0xffff0000, v12
v_cvt_pk_bf16_f32 v12, v186, v187
v_lshlrev_b32 v186, 16, v12
v_and_b32 v187, 0xffff0000, v12
v_cvt_pk_bf16_f32 v12, v216, v217
v_lshlrev_b32 v216, 16, v12
v_and_b32 v217, 0xffff0000, v12
v_cvt_pk_bf16_f32 v12, v218, v219
v_lshlrev_b32 v218, 16, v12
v_and_b32 v219, 0xffff0000, v12
v_lshlrev_b32 v4, 16, v224
v_and_b32 v5, 0xffff0000, v224
v_lshlrev_b32 v6, 16, v225
v_and_b32 v7, 0xffff0000, v225
v_lshlrev_b32 v8, 16, v226
v_and_b32 v9, 0xffff0000, v226
v_lshlrev_b32 v10, 16, v227
v_and_b32 v11, 0xffff0000, v227
v_add_f32 v184, v4, v184
v_add_f32 v216, v216, v8
v_add_f32 v185, v5, v185
v_add_f32 v217, v217, v9
v_add_f32 v186, v6, v186
v_add_f32 v218, v218, v10
v_add_f32 v187, v7, v187
v_add_f32 v219, v219, v11
v_cvt_pk_bf16_f32 v12, v184, v185
v_lshlrev_b32 v184, 16, v12
v_and_b32 v185, 0xffff0000, v12
v_cvt_pk_bf16_f32 v12, v186, v187
v_lshlrev_b32 v186, 16, v12
v_and_b32 v187, 0xffff0000, v12
v_cvt_pk_bf16_f32 v12, v216, v217
v_lshlrev_b32 v216, 16, v12
v_and_b32 v217, 0xffff0000, v12
v_cvt_pk_bf16_f32 v12, v218, v219
v_lshlrev_b32 v218, 16, v12
v_and_b32 v219, 0xffff0000, v12
v_add_f32 v184, v184, v216
v_add_f32 v185, v185, v217
v_add_f32 v186, v186, v218
v_add_f32 v187, v187, v219
v_cvt_pk_bf16_f32 v12, v184, v185
v_cvt_pk_bf16_f32 v13, v186, v187
buffer_store_dwordx2 v[12:13], v228, s[88:91], 0 offen
s_add_u32 s100, s101, 8
s_mul_i32 s40, s52, 655360
s_add_u32 s40, s40, 126038016
s_lshl_b32 s41, s100, 10
s_add_u32 s40, s40, s41
buffer_load_dwordx4 v[136:139], v128, s[20:23], s40 offen sc1
s_mul_i32 s40, s52, 655360
s_add_u32 s40, s40, 131280896
s_lshl_b32 s41, s100, 10
s_add_u32 s40, s40, s41
buffer_load_dwordx4 v[140:143], v128, s[20:23], s40 offen sc1
s_mul_i32 s40, s52, 655360
s_add_u32 s40, s40, 136523776
s_lshl_b32 s41, s100, 10
s_add_u32 s40, s40, s41
buffer_load_dwordx4 v[144:147], v128, s[20:23], s40 offen sc1
s_mul_i32 s40, s52, 655360
s_add_u32 s40, s40, 141766656
s_lshl_b32 s41, s100, 10
s_add_u32 s40, s40, s41
buffer_load_dwordx4 v[148:151], v128, s[20:23], s40 offen sc1
s_mul_i32 s40, s52, 655360
s_add_u32 s40, s40, 147009536
s_lshl_b32 s41, s100, 10
s_add_u32 s40, s40, s41
buffer_load_dwordx4 v[152:155], v128, s[20:23], s40 offen sc1
s_mul_i32 s40, s52, 655360
s_add_u32 s40, s40, 152252416
s_lshl_b32 s41, s100, 10
s_add_u32 s40, s40, s41
buffer_load_dwordx4 v[156:159], v128, s[20:23], s40 offen sc1
s_mul_i32 s40, s52, 655360
s_add_u32 s40, s40, 157495296
s_lshl_b32 s41, s100, 10
s_add_u32 s40, s40, s41
buffer_load_dwordx4 v[160:163], v128, s[20:23], s40 offen sc1
s_mul_i32 s40, s52, 655360
s_add_u32 s40, s40, 162738176
s_lshl_b32 s41, s100, 10
s_add_u32 s40, s40, s41
buffer_load_dwordx4 v[164:167], v128, s[20:23], s40 offen sc1
s_mul_i32 s40, s52, 655360
s_add_u32 s40, s40, 167981056
s_lshl_b32 s41, s100, 10
s_add_u32 s40, s40, s41
buffer_load_dwordx4 v[168:171], v128, s[20:23], s40 offen sc1
s_mul_i32 s40, s52, 655360
s_add_u32 s40, s40, 173223936
s_lshl_b32 s41, s100, 10
s_add_u32 s40, s40, s41
buffer_load_dwordx4 v[172:175], v128, s[20:23], s40 offen sc1
s_and_b32 s60, s100, 3
s_lshr_b32 s61, s100, 2
s_mul_i32 s40, s61, 52429
s_lshr_b32 s40, s40, 18
s_mul_i32 s41, s40, 5
s_sub_u32 s61, s61, s41
s_lshl_b32 s61, s61, 5
s_lshl_b32 s60, s60, 3
s_add_u32 s61, s61, s60
s_lshr_b32 s41, s40, 3
s_mul_i32 s41, s41, 160
s_add_u32 s61, s61, s41
s_lshl_b32 s61, s61, 1
s_and_b32 s40, s40, 7
s_lshl_b32 s40, s40, 5
s_lshl_b32 s41, s52, 8
s_add_u32 s40, s40, s41
s_mul_i32 s40, s40, 1280
v_add_u32 v181, s61, v135
v_add3_u32 v180, v134, v181, s40
buffer_load_dwordx2 v[176:177], v180, s[80:83], 0 offen
buffer_load_dwordx2 v[178:179], v181, s[84:87], 0 offen
s_add_u32 s100, s101, 12
s_mul_i32 s40, s52, 655360
s_add_u32 s40, s40, 126038016
s_lshl_b32 s41, s100, 10
s_add_u32 s40, s40, s41
buffer_load_dwordx4 v[184:187], v128, s[20:23], s40 offen sc1
s_mul_i32 s40, s52, 655360
s_add_u32 s40, s40, 131280896
s_lshl_b32 s41, s100, 10
s_add_u32 s40, s40, s41
buffer_load_dwordx4 v[188:191], v128, s[20:23], s40 offen sc1
s_mul_i32 s40, s52, 655360
s_add_u32 s40, s40, 136523776
s_lshl_b32 s41, s100, 10
s_add_u32 s40, s40, s41
buffer_load_dwordx4 v[192:195], v128, s[20:23], s40 offen sc1
s_mul_i32 s40, s52, 655360
s_add_u32 s40, s40, 141766656
s_lshl_b32 s41, s100, 10
s_add_u32 s40, s40, s41
buffer_load_dwordx4 v[196:199], v128, s[20:23], s40 offen sc1
s_mul_i32 s40, s52, 655360
s_add_u32 s40, s40, 147009536
s_lshl_b32 s41, s100, 10
s_add_u32 s40, s40, s41
buffer_load_dwordx4 v[200:203], v128, s[20:23], s40 offen sc1
s_mul_i32 s40, s52, 655360
s_add_u32 s40, s40, 152252416
s_lshl_b32 s41, s100, 10
s_add_u32 s40, s40, s41
buffer_load_dwordx4 v[204:207], v128, s[20:23], s40 offen sc1
s_mul_i32 s40, s52, 655360
s_add_u32 s40, s40, 157495296
s_lshl_b32 s41, s100, 10
s_add_u32 s40, s40, s41
buffer_load_dwordx4 v[208:211], v128, s[20:23], s40 offen sc1
s_mul_i32 s40, s52, 655360
s_add_u32 s40, s40, 162738176
s_lshl_b32 s41, s100, 10
s_add_u32 s40, s40, s41
buffer_load_dwordx4 v[212:215], v128, s[20:23], s40 offen sc1
s_mul_i32 s40, s52, 655360
s_add_u32 s40, s40, 167981056
s_lshl_b32 s41, s100, 10
s_add_u32 s40, s40, s41
buffer_load_dwordx4 v[216:219], v128, s[20:23], s40 offen sc1
s_mul_i32 s40, s52, 655360
s_add_u32 s40, s40, 173223936
s_lshl_b32 s41, s100, 10
s_add_u32 s40, s40, s41
buffer_load_dwordx4 v[220:223], v128, s[20:23], s40 offen sc1
s_and_b32 s60, s100, 3
s_lshr_b32 s61, s100, 2
s_mul_i32 s40, s61, 52429
s_lshr_b32 s40, s40, 18
s_mul_i32 s41, s40, 5
s_sub_u32 s61, s61, s41
s_lshl_b32 s61, s61, 5
s_lshl_b32 s60, s60, 3
s_add_u32 s61, s61, s60
s_lshr_b32 s41, s40, 3
s_mul_i32 s41, s41, 160
s_add_u32 s61, s61, s41
s_lshl_b32 s61, s61, 1
s_and_b32 s40, s40, 7
s_lshl_b32 s40, s40, 5
s_lshl_b32 s41, s52, 8
s_add_u32 s40, s40, s41
s_mul_i32 s40, s40, 1280
v_add_u32 v229, s61, v135
v_add3_u32 v228, v134, v229, s40
buffer_load_dwordx2 v[224:225], v228, s[80:83], 0 offen
buffer_load_dwordx2 v[226:227], v229, s[84:87], 0 offen
s_waitcnt vmcnt(0)
v_pk_add_f32 v[136:137], v[136:137], v[164:165]
v_pk_add_f32 v[138:139], v[138:139], v[166:167]
v_pk_add_f32 v[140:141], v[140:141], v[160:161]
v_pk_add_f32 v[142:143], v[142:143], v[162:163]
v_pk_add_f32 v[144:145], v[144:145], v[156:157]
v_pk_add_f32 v[146:147], v[146:147], v[158:159]
v_pk_add_f32 v[148:149], v[148:149], v[152:153]
v_pk_add_f32 v[150:151], v[150:151], v[154:155]
v_pk_add_f32 v[136:137], v[136:137], v[148:149]
v_pk_add_f32 v[138:139], v[138:139], v[150:151]
v_pk_add_f32 v[140:141], v[140:141], v[144:145]
v_pk_add_f32 v[142:143], v[142:143], v[146:147]
v_pk_add_f32 v[136:137], v[136:137], v[140:141]
v_pk_add_f32 v[138:139], v[138:139], v[142:143]
v_pk_add_f32 v[168:169], v[168:169], v[172:173]
v_pk_add_f32 v[170:171], v[170:171], v[174:175]
v_cvt_pk_bf16_f32 v12, v136, v137
v_lshlrev_b32 v136, 16, v12
v_and_b32 v137, 0xffff0000, v12
v_cvt_pk_bf16_f32 v12, v138, v139
v_lshlrev_b32 v138, 16, v12
v_and_b32 v139, 0xffff0000, v12
v_cvt_pk_bf16_f32 v12, v168, v169
v_lshlrev_b32 v168, 16, v12
v_and_b32 v169, 0xffff0000, v12
v_cvt_pk_bf16_f32 v12, v170, v171
v_lshlrev_b32 v170, 16, v12
v_and_b32 v171, 0xffff0000, v12
v_lshlrev_b32 v4, 16, v176
v_and_b32 v5, 0xffff0000, v176
v_lshlrev_b32 v6, 16, v177
v_and_b32 v7, 0xffff0000, v177
v_lshlrev_b32 v8, 16, v178
v_and_b32 v9, 0xffff0000, v178
v_lshlrev_b32 v10, 16, v179
v_and_b32 v11, 0xffff0000, v179
v_add_f32 v136, v4, v136
v_add_f32 v168, v168, v8
v_add_f32 v137, v5, v137
v_add_f32 v169, v169, v9
v_add_f32 v138, v6, v138
v_add_f32 v170, v170, v10
v_add_f32 v139, v7, v139
v_add_f32 v171, v171, v11
v_cvt_pk_bf16_f32 v12, v136, v137
v_lshlrev_b32 v136, 16, v12
v_and_b32 v137, 0xffff0000, v12
v_cvt_pk_bf16_f32 v12, v138, v139
v_lshlrev_b32 v138, 16, v12
v_and_b32 v139, 0xffff0000, v12
v_cvt_pk_bf16_f32 v12, v168, v169
v_lshlrev_b32 v168, 16, v12
v_and_b32 v169, 0xffff0000, v12
v_cvt_pk_bf16_f32 v12, v170, v171
v_lshlrev_b32 v170, 16, v12
v_and_b32 v171, 0xffff0000, v12
v_add_f32 v136, v136, v168
v_add_f32 v137, v137, v169
v_add_f32 v138, v138, v170
v_add_f32 v139, v139, v171
v_cvt_pk_bf16_f32 v12, v136, v137
v_cvt_pk_bf16_f32 v13, v138, v139
buffer_store_dwordx2 v[12:13], v180, s[88:91], 0 offen
v_pk_add_f32 v[184:185], v[184:185], v[212:213]
v_pk_add_f32 v[186:187], v[186:187], v[214:215]
v_pk_add_f32 v[188:189], v[188:189], v[208:209]
v_pk_add_f32 v[190:191], v[190:191], v[210:211]
v_pk_add_f32 v[192:193], v[192:193], v[204:205]
v_pk_add_f32 v[194:195], v[194:195], v[206:207]
v_pk_add_f32 v[196:197], v[196:197], v[200:201]
v_pk_add_f32 v[198:199], v[198:199], v[202:203]
v_pk_add_f32 v[184:185], v[184:185], v[196:197]
v_pk_add_f32 v[186:187], v[186:187], v[198:199]
v_pk_add_f32 v[188:189], v[188:189], v[192:193]
v_pk_add_f32 v[190:191], v[190:191], v[194:195]
v_pk_add_f32 v[184:185], v[184:185], v[188:189]
v_pk_add_f32 v[186:187], v[186:187], v[190:191]
v_pk_add_f32 v[216:217], v[216:217], v[220:221]
v_pk_add_f32 v[218:219], v[218:219], v[222:223]
v_cvt_pk_bf16_f32 v12, v184, v185
v_lshlrev_b32 v184, 16, v12
v_and_b32 v185, 0xffff0000, v12
v_cvt_pk_bf16_f32 v12, v186, v187
v_lshlrev_b32 v186, 16, v12
v_and_b32 v187, 0xffff0000, v12
v_cvt_pk_bf16_f32 v12, v216, v217
v_lshlrev_b32 v216, 16, v12
v_and_b32 v217, 0xffff0000, v12
v_cvt_pk_bf16_f32 v12, v218, v219
v_lshlrev_b32 v218, 16, v12
v_and_b32 v219, 0xffff0000, v12
v_lshlrev_b32 v4, 16, v224
v_and_b32 v5, 0xffff0000, v224
v_lshlrev_b32 v6, 16, v225
v_and_b32 v7, 0xffff0000, v225
v_lshlrev_b32 v8, 16, v226
v_and_b32 v9, 0xffff0000, v226
v_lshlrev_b32 v10, 16, v227
v_and_b32 v11, 0xffff0000, v227
v_add_f32 v184, v4, v184
v_add_f32 v216, v216, v8
v_add_f32 v185, v5, v185
v_add_f32 v217, v217, v9
v_add_f32 v186, v6, v186
v_add_f32 v218, v218, v10
v_add_f32 v187, v7, v187
v_add_f32 v219, v219, v11
v_cvt_pk_bf16_f32 v12, v184, v185
v_lshlrev_b32 v184, 16, v12
v_and_b32 v185, 0xffff0000, v12
v_cvt_pk_bf16_f32 v12, v186, v187
v_lshlrev_b32 v186, 16, v12
v_and_b32 v187, 0xffff0000, v12
v_cvt_pk_bf16_f32 v12, v216, v217
v_lshlrev_b32 v216, 16, v12
v_and_b32 v217, 0xffff0000, v12
v_cvt_pk_bf16_f32 v12, v218, v219
v_lshlrev_b32 v218, 16, v12
v_and_b32 v219, 0xffff0000, v12
v_add_f32 v184, v184, v216
v_add_f32 v185, v185, v217
v_add_f32 v186, v186, v218
v_add_f32 v187, v187, v219
v_cvt_pk_bf16_f32 v12, v184, v185
v_cvt_pk_bf16_f32 v13, v186, v187
buffer_store_dwordx2 v[12:13], v228, s[88:91], 0 offen
s_add_u32 s100, s101, 16
s_mul_i32 s40, s52, 655360
s_add_u32 s40, s40, 126038016
s_lshl_b32 s41, s100, 10
s_add_u32 s40, s40, s41
buffer_load_dwordx4 v[136:139], v128, s[20:23], s40 offen sc1
s_mul_i32 s40, s52, 655360
s_add_u32 s40, s40, 131280896
s_lshl_b32 s41, s100, 10
s_add_u32 s40, s40, s41
buffer_load_dwordx4 v[140:143], v128, s[20:23], s40 offen sc1
s_mul_i32 s40, s52, 655360
s_add_u32 s40, s40, 136523776
s_lshl_b32 s41, s100, 10
s_add_u32 s40, s40, s41
buffer_load_dwordx4 v[144:147], v128, s[20:23], s40 offen sc1
s_mul_i32 s40, s52, 655360
s_add_u32 s40, s40, 141766656
s_lshl_b32 s41, s100, 10
s_add_u32 s40, s40, s41
buffer_load_dwordx4 v[148:151], v128, s[20:23], s40 offen sc1
s_mul_i32 s40, s52, 655360
s_add_u32 s40, s40, 147009536
s_lshl_b32 s41, s100, 10
s_add_u32 s40, s40, s41
buffer_load_dwordx4 v[152:155], v128, s[20:23], s40 offen sc1
s_mul_i32 s40, s52, 655360
s_add_u32 s40, s40, 152252416
s_lshl_b32 s41, s100, 10
s_add_u32 s40, s40, s41
buffer_load_dwordx4 v[156:159], v128, s[20:23], s40 offen sc1
s_mul_i32 s40, s52, 655360
s_add_u32 s40, s40, 157495296
s_lshl_b32 s41, s100, 10
s_add_u32 s40, s40, s41
buffer_load_dwordx4 v[160:163], v128, s[20:23], s40 offen sc1
s_mul_i32 s40, s52, 655360
s_add_u32 s40, s40, 162738176
s_lshl_b32 s41, s100, 10
s_add_u32 s40, s40, s41
buffer_load_dwordx4 v[164:167], v128, s[20:23], s40 offen sc1
s_mul_i32 s40, s52, 655360
s_add_u32 s40, s40, 167981056
s_lshl_b32 s41, s100, 10
s_add_u32 s40, s40, s41
buffer_load_dwordx4 v[168:171], v128, s[20:23], s40 offen sc1
s_mul_i32 s40, s52, 655360
s_add_u32 s40, s40, 173223936
s_lshl_b32 s41, s100, 10
s_add_u32 s40, s40, s41
buffer_load_dwordx4 v[172:175], v128, s[20:23], s40 offen sc1
s_and_b32 s60, s100, 3
s_lshr_b32 s61, s100, 2
s_mul_i32 s40, s61, 52429
s_lshr_b32 s40, s40, 18
s_mul_i32 s41, s40, 5
s_sub_u32 s61, s61, s41
s_lshl_b32 s61, s61, 5
s_lshl_b32 s60, s60, 3
s_add_u32 s61, s61, s60
s_lshr_b32 s41, s40, 3
s_mul_i32 s41, s41, 160
s_add_u32 s61, s61, s41
s_lshl_b32 s61, s61, 1
s_and_b32 s40, s40, 7
s_lshl_b32 s40, s40, 5
s_lshl_b32 s41, s52, 8
s_add_u32 s40, s40, s41
s_mul_i32 s40, s40, 1280
v_add_u32 v181, s61, v135
v_add3_u32 v180, v134, v181, s40
buffer_load_dwordx2 v[176:177], v180, s[80:83], 0 offen
buffer_load_dwordx2 v[178:179], v181, s[84:87], 0 offen
s_waitcnt vmcnt(0)
v_pk_add_f32 v[136:137], v[136:137], v[164:165]
v_pk_add_f32 v[138:139], v[138:139], v[166:167]
v_pk_add_f32 v[140:141], v[140:141], v[160:161]
v_pk_add_f32 v[142:143], v[142:143], v[162:163]
v_pk_add_f32 v[144:145], v[144:145], v[156:157]
v_pk_add_f32 v[146:147], v[146:147], v[158:159]
v_pk_add_f32 v[148:149], v[148:149], v[152:153]
v_pk_add_f32 v[150:151], v[150:151], v[154:155]
v_pk_add_f32 v[136:137], v[136:137], v[148:149]
v_pk_add_f32 v[138:139], v[138:139], v[150:151]
v_pk_add_f32 v[140:141], v[140:141], v[144:145]
v_pk_add_f32 v[142:143], v[142:143], v[146:147]
v_pk_add_f32 v[136:137], v[136:137], v[140:141]
v_pk_add_f32 v[138:139], v[138:139], v[142:143]
v_pk_add_f32 v[168:169], v[168:169], v[172:173]
v_pk_add_f32 v[170:171], v[170:171], v[174:175]
v_cvt_pk_bf16_f32 v12, v136, v137
v_lshlrev_b32 v136, 16, v12
v_and_b32 v137, 0xffff0000, v12
v_cvt_pk_bf16_f32 v12, v138, v139
v_lshlrev_b32 v138, 16, v12
v_and_b32 v139, 0xffff0000, v12
v_cvt_pk_bf16_f32 v12, v168, v169
v_lshlrev_b32 v168, 16, v12
v_and_b32 v169, 0xffff0000, v12
v_cvt_pk_bf16_f32 v12, v170, v171
v_lshlrev_b32 v170, 16, v12
v_and_b32 v171, 0xffff0000, v12
v_lshlrev_b32 v4, 16, v176
v_and_b32 v5, 0xffff0000, v176
v_lshlrev_b32 v6, 16, v177
v_and_b32 v7, 0xffff0000, v177
v_lshlrev_b32 v8, 16, v178
v_and_b32 v9, 0xffff0000, v178
v_lshlrev_b32 v10, 16, v179
v_and_b32 v11, 0xffff0000, v179
v_add_f32 v136, v4, v136
v_add_f32 v168, v168, v8
v_add_f32 v137, v5, v137
v_add_f32 v169, v169, v9
v_add_f32 v138, v6, v138
v_add_f32 v170, v170, v10
v_add_f32 v139, v7, v139
v_add_f32 v171, v171, v11
v_cvt_pk_bf16_f32 v12, v136, v137
v_lshlrev_b32 v136, 16, v12
v_and_b32 v137, 0xffff0000, v12
v_cvt_pk_bf16_f32 v12, v138, v139
v_lshlrev_b32 v138, 16, v12
v_and_b32 v139, 0xffff0000, v12
v_cvt_pk_bf16_f32 v12, v168, v169
v_lshlrev_b32 v168, 16, v12
v_and_b32 v169, 0xffff0000, v12
v_cvt_pk_bf16_f32 v12, v170, v171
v_lshlrev_b32 v170, 16, v12
v_and_b32 v171, 0xffff0000, v12
v_add_f32 v136, v136, v168
v_add_f32 v137, v137, v169
v_add_f32 v138, v138, v170
v_add_f32 v139, v139, v171
v_cvt_pk_bf16_f32 v12, v136, v137
v_cvt_pk_bf16_f32 v13, v138, v139
buffer_store_dwordx2 v[12:13], v180, s[88:91], 0 offen
s_branch L_b_next_B
L_f_fine_B:
s_lshl_b32 s101, s29, 4
s_add_u32 s101, s101, s63
s_mul_i32 s101, s101, 5
s_add_u32 s100, s101, s28
s_mov_b32 s40, 178614272
s_lshl_b32 s41, s100, 10
s_add_u32 s40, s40, s41
buffer_load_dwordx4 v[136:139], v128, s[20:23], s40 offen sc1
s_mov_b32 s40, 179269632
s_lshl_b32 s41, s100, 10
s_add_u32 s40, s40, s41
buffer_load_dwordx4 v[140:143], v128, s[20:23], s40 offen sc1
s_mov_b32 s40, 179924992
s_lshl_b32 s41, s100, 10
s_add_u32 s40, s40, s41
buffer_load_dwordx4 v[144:147], v128, s[20:23], s40 offen sc1
s_mov_b32 s40, 180580352
s_lshl_b32 s41, s100, 10
s_add_u32 s40, s40, s41
buffer_load_dwordx4 v[148:151], v128, s[20:23], s40 offen sc1
s_mov_b32 s40, 181235712
s_lshl_b32 s41, s100, 10
s_add_u32 s40, s40, s41
buffer_load_dwordx4 v[152:155], v128, s[20:23], s40 offen sc1
s_mov_b32 s40, 181891072
s_lshl_b32 s41, s100, 10
s_add_u32 s40, s40, s41
buffer_load_dwordx4 v[156:159], v128, s[20:23], s40 offen sc1
s_mov_b32 s40, 182546432
s_lshl_b32 s41, s100, 10
s_add_u32 s40, s40, s41
buffer_load_dwordx4 v[160:163], v128, s[20:23], s40 offen sc1
s_mov_b32 s40, 183201792
s_lshl_b32 s41, s100, 10
s_add_u32 s40, s40, s41
buffer_load_dwordx4 v[164:167], v128, s[20:23], s40 offen sc1
s_mov_b32 s40, 183857152
s_lshl_b32 s41, s100, 10
s_add_u32 s40, s40, s41
buffer_load_dwordx4 v[168:171], v128, s[20:23], s40 offen sc1
s_mov_b32 s40, 184512512
s_lshl_b32 s41, s100, 10
s_add_u32 s40, s40, s41
buffer_load_dwordx4 v[172:175], v128, s[20:23], s40 offen sc1
s_mov_b32 s40, 185167872
s_lshl_b32 s41, s100, 10
s_add_u32 s40, s40, s41
buffer_load_dwordx4 v[176:179], v128, s[20:23], s40 offen sc1
s_mov_b32 s40, 185823232
s_lshl_b32 s41, s100, 10
s_add_u32 s40, s40, s41
buffer_load_dwordx4 v[180:183], v128, s[20:23], s40 offen sc1
s_mov_b32 s40, 186478592
s_lshl_b32 s41, s100, 10
s_add_u32 s40, s40, s41
buffer_load_dwordx4 v[184:187], v128, s[20:23], s40 offen sc1
s_mov_b32 s40, 187133952
s_lshl_b32 s41, s100, 10
s_add_u32 s40, s40, s41
buffer_load_dwordx4 v[188:191], v128, s[20:23], s40 offen sc1
s_mov_b32 s40, 187789312
s_lshl_b32 s41, s100, 10
s_add_u32 s40, s40, s41
buffer_load_dwordx4 v[192:195], v128, s[20:23], s40 offen sc1
s_mov_b32 s40, 188444672
s_lshl_b32 s41, s100, 10
s_add_u32 s40, s40, s41
buffer_load_dwordx4 v[196:199], v128, s[20:23], s40 offen sc1
s_mov_b32 s40, 189100032
s_lshl_b32 s41, s100, 10
s_add_u32 s40, s40, s41
buffer_load_dwordx4 v[200:203], v128, s[20:23], s40 offen sc1
s_mov_b32 s40, 189755392
s_lshl_b32 s41, s100, 10
s_add_u32 s40, s40, s41
buffer_load_dwordx4 v[204:207], v128, s[20:23], s40 offen sc1
s_mov_b32 s40, 190410752
s_lshl_b32 s41, s100, 10
s_add_u32 s40, s40, s41
buffer_load_dwordx4 v[208:211], v128, s[20:23], s40 offen sc1
s_mov_b32 s40, 191066112
s_lshl_b32 s41, s100, 10
s_add_u32 s40, s40, s41
buffer_load_dwordx4 v[212:215], v128, s[20:23], s40 offen sc1
s_mov_b32 s40, 191721472
s_lshl_b32 s41, s100, 10
s_add_u32 s40, s40, s41
buffer_load_dwordx4 v[216:219], v128, s[20:23], s40 offen sc1
s_mov_b32 s40, 192376832
s_lshl_b32 s41, s100, 10
s_add_u32 s40, s40, s41
buffer_load_dwordx4 v[220:223], v128, s[20:23], s40 offen sc1
s_mov_b32 s40, 193032192
s_lshl_b32 s41, s100, 10
s_add_u32 s40, s40, s41
buffer_load_dwordx4 v[224:227], v128, s[20:23], s40 offen sc1
s_mov_b32 s40, 193687552
s_lshl_b32 s41, s100, 10
s_add_u32 s40, s40, s41
buffer_load_dwordx4 v[228:231], v128, s[20:23], s40 offen sc1
s_mov_b32 s40, 172568576
s_lshl_b32 s41, s100, 10
s_add_u32 s40, s40, s41
buffer_load_dwordx4 v[232:235], v128, s[20:23], s40 offen sc1
s_mov_b32 s40, 177811456
s_lshl_b32 s41, s100, 10
s_add_u32 s40, s40, s41
buffer_load_dwordx4 v[236:239], v128, s[20:23], s40 offen sc1
s_and_b32 s60, s100, 3
s_lshr_b32 s61, s100, 2
s_mul_i32 s40, s61, 52429
s_lshr_b32 s40, s40, 18
s_mul_i32 s41, s40, 5
s_sub_u32 s61, s61, s41
s_lshl_b32 s61, s61, 5
s_lshl_b32 s60, s60, 3
s_add_u32 s61, s61, s60
s_lshr_b32 s41, s40, 3
s_mul_i32 s41, s41, 160
s_add_u32 s61, s61, s41
s_lshl_b32 s61, s61, 1
s_and_b32 s40, s40, 7
s_lshl_b32 s40, s40, 5
s_lshl_b32 s41, s52, 8
s_add_u32 s40, s40, s41
s_mul_i32 s40, s40, 1280
v_add_u32 v245, s61, v135
v_add3_u32 v244, v134, v245, s40
buffer_load_dwordx2 v[240:241], v244, s[80:83], 0 offen
buffer_load_dwordx2 v[242:243], v245, s[84:87], 0 offen
s_waitcnt vmcnt(0)
v_pk_add_f32 v[136:137], v[136:137], v[228:229]
v_pk_add_f32 v[138:139], v[138:139], v[230:231]
v_pk_add_f32 v[140:141], v[140:141], v[224:225]
v_pk_add_f32 v[142:143], v[142:143], v[226:227]
v_pk_add_f32 v[144:145], v[144:145], v[220:221]
v_pk_add_f32 v[146:147], v[146:147], v[222:223]
v_pk_add_f32 v[148:149], v[148:149], v[216:217]
v_pk_add_f32 v[150:151], v[150:151], v[218:219]
v_pk_add_f32 v[152:153], v[152:153], v[212:213]
v_pk_add_f32 v[154:155], v[154:155], v[214:215]
v_pk_add_f32 v[156:157], v[156:157], v[208:209]
v_pk_add_f32 v[158:159], v[158:159], v[210:211]
v_pk_add_f32 v[160:161], v[160:161], v[204:205]
v_pk_add_f32 v[162:163], v[162:163], v[206:207]
v_pk_add_f32 v[164:165], v[164:165], v[200:201]
v_pk_add_f32 v[166:167], v[166:167], v[202:203]
v_pk_add_f32 v[168:169], v[168:169], v[196:197]
v_pk_add_f32 v[170:171], v[170:171], v[198:199]
v_pk_add_f32 v[172:173], v[172:173], v[192:193]
v_pk_add_f32 v[174:175], v[174:175], v[194:195]
v_pk_add_f32 v[176:177], v[176:177], v[188:189]
v_pk_add_f32 v[178:179], v[178:179], v[190:191]
v_pk_add_f32 v[180:181], v[180:181], v[184:185]
v_pk_add_f32 v[182:183], v[182:183], v[186:187]
v_pk_add_f32 v[136:137], v[136:137], v[180:181]
v_pk_add_f32 v[138:139], v[138:139], v[182:183]
v_pk_add_f32 v[140:141], v[140:141], v[176:177]
v_pk_add_f32 v[142:143], v[142:143], v[178:179]
v_pk_add_f32 v[144:145], v[144:145], v[172:173]
v_pk_add_f32 v[146:147], v[146:147], v[174:175]
v_pk_add_f32 v[148:149], v[148:149], v[168:169]
v_pk_add_f32 v[150:151], v[150:151], v[170:171]
v_pk_add_f32 v[152:153], v[152:153], v[164:165]
v_pk_add_f32 v[154:155], v[154:155], v[166:167]
v_pk_add_f32 v[156:157], v[156:157], v[160:161]
v_pk_add_f32 v[158:159], v[158:159], v[162:163]
v_pk_add_f32 v[136:137], v[136:137], v[156:157]
v_pk_add_f32 v[138:139], v[138:139], v[158:159]
v_pk_add_f32 v[140:141], v[140:141], v[152:153]
v_pk_add_f32 v[142:143], v[142:143], v[154:155]
v_pk_add_f32 v[144:145], v[144:145], v[148:149]
v_pk_add_f32 v[146:147], v[146:147], v[150:151]
v_pk_add_f32 v[136:137], v[136:137], v[144:145]
v_pk_add_f32 v[138:139], v[138:139], v[146:147]
v_pk_add_f32 v[136:137], v[136:137], v[140:141]
v_pk_add_f32 v[138:139], v[138:139], v[142:143]
v_pk_add_f32 v[232:233], v[232:233], v[236:237]
v_pk_add_f32 v[234:235], v[234:235], v[238:239]
v_cvt_pk_bf16_f32 v12, v136, v137
v_lshlrev_b32 v136, 16, v12
v_and_b32 v137, 0xffff0000, v12
v_cvt_pk_bf16_f32 v12, v138, v139
v_lshlrev_b32 v138, 16, v12
v_and_b32 v139, 0xffff0000, v12
v_cvt_pk_bf16_f32 v12, v232, v233
v_lshlrev_b32 v232, 16, v12
v_and_b32 v233, 0xffff0000, v12
v_cvt_pk_bf16_f32 v12, v234, v235
v_lshlrev_b32 v234, 16, v12
v_and_b32 v235, 0xffff0000, v12
v_lshlrev_b32 v4, 16, v240
v_and_b32 v5, 0xffff0000, v240
v_lshlrev_b32 v6, 16, v241
v_and_b32 v7, 0xffff0000, v241
v_lshlrev_b32 v8, 16, v242
v_and_b32 v9, 0xffff0000, v242
v_lshlrev_b32 v10, 16, v243
v_and_b32 v11, 0xffff0000, v243
v_add_f32 v136, v4, v136
v_add_f32 v232, v232, v8
v_add_f32 v137, v5, v137
v_add_f32 v233, v233, v9
v_add_f32 v138, v6, v138
v_add_f32 v234, v234, v10
v_add_f32 v139, v7, v139
v_add_f32 v235, v235, v11
v_cvt_pk_bf16_f32 v12, v136, v137
v_lshlrev_b32 v136, 16, v12
v_and_b32 v137, 0xffff0000, v12
v_cvt_pk_bf16_f32 v12, v138, v139
v_lshlrev_b32 v138, 16, v12
v_and_b32 v139, 0xffff0000, v12
v_cvt_pk_bf16_f32 v12, v232, v233
v_lshlrev_b32 v232, 16, v12
v_and_b32 v233, 0xffff0000, v12
v_cvt_pk_bf16_f32 v12, v234, v235
v_lshlrev_b32 v234, 16, v12
v_and_b32 v235, 0xffff0000, v12
v_add_f32 v136, v136, v232
v_add_f32 v137, v137, v233
v_add_f32 v138, v138, v234
v_add_f32 v139, v139, v235
v_cvt_pk_bf16_f32 v12, v136, v137
v_cvt_pk_bf16_f32 v13, v138, v139
buffer_store_dwordx2 v[12:13], v244, s[88:91], 0 offen
s_cmp_lg_u32 s28, 0
s_cbranch_scc1 L_b_next_B
s_add_u32 s100, s101, 4
s_mov_b32 s40, 178614272
s_lshl_b32 s41, s100, 10
s_add_u32 s40, s40, s41
buffer_load_dwordx4 v[136:139], v128, s[20:23], s40 offen sc1
s_mov_b32 s40, 179269632
s_lshl_b32 s41, s100, 10
s_add_u32 s40, s40, s41
buffer_load_dwordx4 v[140:143], v128, s[20:23], s40 offen sc1
s_mov_b32 s40, 179924992
s_lshl_b32 s41, s100, 10
s_add_u32 s40, s40, s41
buffer_load_dwordx4 v[144:147], v128, s[20:23], s40 offen sc1
s_mov_b32 s40, 180580352
s_lshl_b32 s41, s100, 10
s_add_u32 s40, s40, s41
buffer_load_dwordx4 v[148:151], v128, s[20:23], s40 offen sc1
s_mov_b32 s40, 181235712
s_lshl_b32 s41, s100, 10
s_add_u32 s40, s40, s41
buffer_load_dwordx4 v[152:155], v128, s[20:23], s40 offen sc1
s_mov_b32 s40, 181891072
s_lshl_b32 s41, s100, 10
s_add_u32 s40, s40, s41
buffer_load_dwordx4 v[156:159], v128, s[20:23], s40 offen sc1
s_mov_b32 s40, 182546432
s_lshl_b32 s41, s100, 10
s_add_u32 s40, s40, s41
buffer_load_dwordx4 v[160:163], v128, s[20:23], s40 offen sc1
s_mov_b32 s40, 183201792
s_lshl_b32 s41, s100, 10
s_add_u32 s40, s40, s41
buffer_load_dwordx4 v[164:167], v128, s[20:23], s40 offen sc1
s_mov_b32 s40, 183857152
s_lshl_b32 s41, s100, 10
s_add_u32 s40, s40, s41
buffer_load_dwordx4 v[168:171], v128, s[20:23], s40 offen sc1
s_mov_b32 s40, 184512512
s_lshl_b32 s41, s100, 10
s_add_u32 s40, s40, s41
buffer_load_dwordx4 v[172:175], v128, s[20:23], s40 offen sc1
s_mov_b32 s40, 185167872
s_lshl_b32 s41, s100, 10
s_add_u32 s40, s40, s41
buffer_load_dwordx4 v[176:179], v128, s[20:23], s40 offen sc1
s_mov_b32 s40, 185823232
s_lshl_b32 s41, s100, 10
s_add_u32 s40, s40, s41
buffer_load_dwordx4 v[180:183], v128, s[20:23], s40 offen sc1
s_mov_b32 s40, 186478592
s_lshl_b32 s41, s100, 10
s_add_u32 s40, s40, s41
buffer_load_dwordx4 v[184:187], v128, s[20:23], s40 offen sc1
s_mov_b32 s40, 187133952
s_lshl_b32 s41, s100, 10
s_add_u32 s40, s40, s41
buffer_load_dwordx4 v[188:191], v128, s[20:23], s40 offen sc1
s_mov_b32 s40, 187789312
s_lshl_b32 s41, s100, 10
s_add_u32 s40, s40, s41
buffer_load_dwordx4 v[192:195], v128, s[20:23], s40 offen sc1
s_mov_b32 s40, 188444672
s_lshl_b32 s41, s100, 10
s_add_u32 s40, s40, s41
buffer_load_dwordx4 v[196:199], v128, s[20:23], s40 offen sc1
s_mov_b32 s40, 189100032
s_lshl_b32 s41, s100, 10
s_add_u32 s40, s40, s41
buffer_load_dwordx4 v[200:203], v128, s[20:23], s40 offen sc1
s_mov_b32 s40, 189755392
s_lshl_b32 s41, s100, 10
s_add_u32 s40, s40, s41
buffer_load_dwordx4 v[204:207], v128, s[20:23], s40 offen sc1
s_mov_b32 s40, 190410752
s_lshl_b32 s41, s100, 10
s_add_u32 s40, s40, s41
buffer_load_dwordx4 v[208:211], v128, s[20:23], s40 offen sc1
s_mov_b32 s40, 191066112
s_lshl_b32 s41, s100, 10
s_add_u32 s40, s40, s41
buffer_load_dwordx4 v[212:215], v128, s[20:23], s40 offen sc1
s_mov_b32 s40, 191721472
s_lshl_b32 s41, s100, 10
s_add_u32 s40, s40, s41
buffer_load_dwordx4 v[216:219], v128, s[20:23], s40 offen sc1
s_mov_b32 s40, 192376832
s_lshl_b32 s41, s100, 10
s_add_u32 s40, s40, s41
buffer_load_dwordx4 v[220:223], v128, s[20:23], s40 offen sc1
s_mov_b32 s40, 193032192
s_lshl_b32 s41, s100, 10
s_add_u32 s40, s40, s41
buffer_load_dwordx4 v[224:227], v128, s[20:23], s40 offen sc1
s_mov_b32 s40, 193687552
s_lshl_b32 s41, s100, 10
s_add_u32 s40, s40, s41
buffer_load_dwordx4 v[228:231], v128, s[20:23], s40 offen sc1
s_mov_b32 s40, 172568576
s_lshl_b32 s41, s100, 10
s_add_u32 s40, s40, s41
buffer_load_dwordx4 v[232:235], v128, s[20:23], s40 offen sc1
s_mov_b32 s40, 177811456
s_lshl_b32 s41, s100, 10
s_add_u32 s40, s40, s41
buffer_load_dwordx4 v[236:239], v128, s[20:23], s40 offen sc1
s_and_b32 s60, s100, 3
s_lshr_b32 s61, s100, 2
s_mul_i32 s40, s61, 52429
s_lshr_b32 s40, s40, 18
s_mul_i32 s41, s40, 5
s_sub_u32 s61, s61, s41
s_lshl_b32 s61, s61, 5
s_lshl_b32 s60, s60, 3
s_add_u32 s61, s61, s60
s_lshr_b32 s41, s40, 3
s_mul_i32 s41, s41, 160
s_add_u32 s61, s61, s41
s_lshl_b32 s61, s61, 1
s_and_b32 s40, s40, 7
s_lshl_b32 s40, s40, 5
s_lshl_b32 s41, s52, 8
s_add_u32 s40, s40, s41
s_mul_i32 s40, s40, 1280
v_add_u32 v245, s61, v135
v_add3_u32 v244, v134, v245, s40
buffer_load_dwordx2 v[240:241], v244, s[80:83], 0 offen
buffer_load_dwordx2 v[242:243], v245, s[84:87], 0 offen
s_waitcnt vmcnt(0)
v_pk_add_f32 v[136:137], v[136:137], v[228:229]
v_pk_add_f32 v[138:139], v[138:139], v[230:231]
v_pk_add_f32 v[140:141], v[140:141], v[224:225]
v_pk_add_f32 v[142:143], v[142:143], v[226:227]
v_pk_add_f32 v[144:145], v[144:145], v[220:221]
v_pk_add_f32 v[146:147], v[146:147], v[222:223]
v_pk_add_f32 v[148:149], v[148:149], v[216:217]
v_pk_add_f32 v[150:151], v[150:151], v[218:219]
v_pk_add_f32 v[152:153], v[152:153], v[212:213]
v_pk_add_f32 v[154:155], v[154:155], v[214:215]
v_pk_add_f32 v[156:157], v[156:157], v[208:209]
v_pk_add_f32 v[158:159], v[158:159], v[210:211]
v_pk_add_f32 v[160:161], v[160:161], v[204:205]
v_pk_add_f32 v[162:163], v[162:163], v[206:207]
v_pk_add_f32 v[164:165], v[164:165], v[200:201]
v_pk_add_f32 v[166:167], v[166:167], v[202:203]
v_pk_add_f32 v[168:169], v[168:169], v[196:197]
v_pk_add_f32 v[170:171], v[170:171], v[198:199]
v_pk_add_f32 v[172:173], v[172:173], v[192:193]
v_pk_add_f32 v[174:175], v[174:175], v[194:195]
v_pk_add_f32 v[176:177], v[176:177], v[188:189]
v_pk_add_f32 v[178:179], v[178:179], v[190:191]
v_pk_add_f32 v[180:181], v[180:181], v[184:185]
v_pk_add_f32 v[182:183], v[182:183], v[186:187]
v_pk_add_f32 v[136:137], v[136:137], v[180:181]
v_pk_add_f32 v[138:139], v[138:139], v[182:183]
v_pk_add_f32 v[140:141], v[140:141], v[176:177]
v_pk_add_f32 v[142:143], v[142:143], v[178:179]
v_pk_add_f32 v[144:145], v[144:145], v[172:173]
v_pk_add_f32 v[146:147], v[146:147], v[174:175]
v_pk_add_f32 v[148:149], v[148:149], v[168:169]
v_pk_add_f32 v[150:151], v[150:151], v[170:171]
v_pk_add_f32 v[152:153], v[152:153], v[164:165]
v_pk_add_f32 v[154:155], v[154:155], v[166:167]
v_pk_add_f32 v[156:157], v[156:157], v[160:161]
v_pk_add_f32 v[158:159], v[158:159], v[162:163]
v_pk_add_f32 v[136:137], v[136:137], v[156:157]
v_pk_add_f32 v[138:139], v[138:139], v[158:159]
v_pk_add_f32 v[140:141], v[140:141], v[152:153]
v_pk_add_f32 v[142:143], v[142:143], v[154:155]
v_pk_add_f32 v[144:145], v[144:145], v[148:149]
v_pk_add_f32 v[146:147], v[146:147], v[150:151]
v_pk_add_f32 v[136:137], v[136:137], v[144:145]
v_pk_add_f32 v[138:139], v[138:139], v[146:147]
v_pk_add_f32 v[136:137], v[136:137], v[140:141]
v_pk_add_f32 v[138:139], v[138:139], v[142:143]
v_pk_add_f32 v[232:233], v[232:233], v[236:237]
v_pk_add_f32 v[234:235], v[234:235], v[238:239]
v_cvt_pk_bf16_f32 v12, v136, v137
v_lshlrev_b32 v136, 16, v12
v_and_b32 v137, 0xffff0000, v12
v_cvt_pk_bf16_f32 v12, v138, v139
v_lshlrev_b32 v138, 16, v12
v_and_b32 v139, 0xffff0000, v12
v_cvt_pk_bf16_f32 v12, v232, v233
v_lshlrev_b32 v232, 16, v12
v_and_b32 v233, 0xffff0000, v12
v_cvt_pk_bf16_f32 v12, v234, v235
v_lshlrev_b32 v234, 16, v12
v_and_b32 v235, 0xffff0000, v12
v_lshlrev_b32 v4, 16, v240
v_and_b32 v5, 0xffff0000, v240
v_lshlrev_b32 v6, 16, v241
v_and_b32 v7, 0xffff0000, v241
v_lshlrev_b32 v8, 16, v242
v_and_b32 v9, 0xffff0000, v242
v_lshlrev_b32 v10, 16, v243
v_and_b32 v11, 0xffff0000, v243
v_add_f32 v136, v4, v136
v_add_f32 v232, v232, v8
v_add_f32 v137, v5, v137
v_add_f32 v233, v233, v9
v_add_f32 v138, v6, v138
v_add_f32 v234, v234, v10
v_add_f32 v139, v7, v139
v_add_f32 v235, v235, v11
v_cvt_pk_bf16_f32 v12, v136, v137
v_lshlrev_b32 v136, 16, v12
v_and_b32 v137, 0xffff0000, v12
v_cvt_pk_bf16_f32 v12, v138, v139
v_lshlrev_b32 v138, 16, v12
v_and_b32 v139, 0xffff0000, v12
v_cvt_pk_bf16_f32 v12, v232, v233
v_lshlrev_b32 v232, 16, v12
v_and_b32 v233, 0xffff0000, v12
v_cvt_pk_bf16_f32 v12, v234, v235
v_lshlrev_b32 v234, 16, v12
v_and_b32 v235, 0xffff0000, v12
v_add_f32 v136, v136, v232
v_add_f32 v137, v137, v233
v_add_f32 v138, v138, v234
v_add_f32 v139, v139, v235
v_cvt_pk_bf16_f32 v12, v136, v137
v_cvt_pk_bf16_f32 v13, v138, v139
buffer_store_dwordx2 v[12:13], v244, s[88:91], 0 offen
s_nop 0
L_b_next_B:
s_add_u32 s50, s50, 1
s_branch L_b_task_B
L_w_done_B:
s_endpgm
.section .rodata,"a"
.p2align 6
.amdhsa_kernel mega_kernel
  .amdhsa_next_free_vgpr 512
  .amdhsa_next_free_sgpr 102
  .amdhsa_accum_offset 256
  .amdhsa_group_segment_fixed_size 0
  .amdhsa_kernarg_size 120
  .amdhsa_user_sgpr_count 2
  .amdhsa_user_sgpr_kernarg_segment_ptr 1
  .amdhsa_system_sgpr_workgroup_id_x 1
.end_amdhsa_kernel
.text
```
